```python
import torch

def _softmax(x, axis=-1):
    return torch.softmax(x, dim=axis)
def _gelu(x):
    return torch.nn.functional.gelu(x, approximate="tanh")
def _silu(x):
    return torch.nn.functional.silu(x)
def _sigmoid(x):
    return torch.sigmoid(x)
def _layernorm(x, axis=-1, eps=1e-5):
    m = x.mean(dim=axis, keepdim=True)
    v = x.var(dim=axis, keepdim=True, unbiased=False)
    return (x - m) / torch.sqrt(v + eps)
def _scatter_add(tgt, idx, src, axis=0):
    return tgt.clone().index_add_(axis, idx, src)
def _segment_sum(src, seg, n):
    out = torch.zeros((n,) + src.shape[1:], dtype=src.dtype)
    return out.index_add_(0, seg, src)
def _pad(x, pw):
    flat = tuple(v for pair in reversed(pw) for v in pair)
    return torch.nn.functional.pad(x, flat)

kernel_name = 'sequential_preLN__mha_block__swiglu_ffn__prompt'

def setup_inputs():

    _w = (lambda a: (lambda t: t.to(torch.bfloat16) if t.is_floating_point() else t)(torch.as_tensor(a)))
    def _A_setup():
        B, S, D, H = 1, 2048, 1024, 32
        return {
            "x": _w((lambda *s: torch.randn(*s, dtype=torch.bfloat16) * 0.05)(B, S, D)),
            "wqkv": _w((lambda *s: torch.randn(*s, dtype=torch.bfloat16) * 0.05)(D, 3 * D)),
            "wo": _w((lambda *s: torch.randn(*s, dtype=torch.bfloat16) * 0.05)(D, D)),
        }
    _A_in = _A_setup()

    def _B_setup():
        B, S, D, F = 1, 2048, 1024, 3584
        return {
            "x": _w((lambda *s: torch.randn(*s, dtype=torch.bfloat16) * 0.05)(B, S, D)),
            "w_gate": _w((lambda *s: torch.randn(*s, dtype=torch.bfloat16) * 0.05)(D, F)),
            "w_up": _w((lambda *s: torch.randn(*s, dtype=torch.bfloat16) * 0.05)(D, F)),
            "w_down": _w((lambda *s: torch.randn(*s, dtype=torch.bfloat16) * 0.05)(F, D)),
        }
    _B_in = _B_setup()

    return {
        "A_x": _A_in["x"],
        "A_wqkv": _A_in["wqkv"],
        "A_wo": _A_in["wo"],
        "B_x": _B_in["x"],
        "B_w_gate": _B_in["w_gate"],
        "B_w_up": _B_in["w_up"],
        "B_w_down": _B_in["w_down"],
    }

def reference(A_x, A_wqkv, A_wo, B_x, B_w_gate, B_w_up, B_w_down):
    def _A_ref(x, wqkv, wo):
        B, S, D = x.shape
        H = 32
        Dh = D // H
        qkv = (lambda x, *d: x.permute(*d))((x @ wqkv).reshape(B, S, 3, H, Dh), 2, 0, 3, 1, 4)
        q, k, v = qkv[0], qkv[1], qkv[2]
        scores = torch.einsum("bhqd,bhkd->bhqk", q, k) * (Dh ** -0.5)
        p = _softmax(scores, axis=-1)
        o = torch.einsum("bhqk,bhkd->bhqd", p, v)
        return (lambda x, *d: x.permute(*d))(o, 0, 2, 1, 3).reshape(B, S, D) @ wo

    def _B_ref(x, w_gate, w_up, w_down):
        g = _silu(x @ w_gate)
        u = x @ w_up
        return (g * u) @ w_down

    x = A_x
    h = x + _A_ref(_layernorm(x, axis=-1), A_wqkv, A_wo)
    h2 = h + _B_ref(_layernorm(h, axis=-1), B_w_gate, B_w_up, B_w_down)
    return h2
```

```asm
; @launch kernel=qa_kernel grid=(256,1,1) block=(512,1,1) lds=163840
.amdgcn_target "amdgcn-amd-amdhsa--gfx950"
.text
.globl qa_kernel
.p2align 12
.type qa_kernel,@function
qa_kernel:
    s_cmp_lt_u32 s2, 256
    s_cbranch_scc1 qa_kernel_GO
    s_endpgm
qa_kernel_GO:
    s_load_dwordx16 s[4:19], s[0:1], 0
    s_load_dwordx4 s[20:23], s[0:1], 64
    v_lshrrev_b32 v1, 6, v0
    s_nop 0
    v_readfirstlane_b32 s24, v1
    v_and_b32 v1, 63, v0
    s_and_b32 s44, s2, 7
    s_lshl_b32 s44, s44, 2
    s_bfe_u32 s47, s2, 0x20003
    s_add_u32 s44, s44, s47
    s_lshr_b32 s45, s2, 5
    s_lshl_b32 s46, s45, 3
    s_add_u32 s46, s46, s24
    v_lshlrev_b32 v2, 4, v1
    v_lshrrev_b32 v5, 4, v1
    v_and_b32 v6, 15, v1
    v_lshrrev_b32 v3, 3, v1
    v_lshlrev_b32 v16, 11, v3
    v_and_b32 v3, 3, v5
    v_and_b32 v4, 7, v1
    v_xor_b32 v3, v3, v4
    v_lshl_add_u32 v16, v3, 4, v16
    s_lshl_b32 s47, s46, 16
    v_add_u32 v16, s47, v16
    v_xor_b32 v17, 64, v16
    v_add_u32 v17, 16384, v17
    v_add_u32 v18, 32768, v16
    v_add_u32 v19, 32768, v17
    s_and_b32 s51, s45, 7
    s_mul_i32 s51, s51, 2
    s_and_b32 s51, s51, 15
    s_lshl_b32 s49, s51, 7
    s_lshl_b32 s50, s24, 12
    s_mul_i32 s52, s51, 393216
    s_mov_b32 s54, 6144
    v_lshrrev_b32 v3, 2, v1
    v_mul_lo_u32 v20, v3, s54
    v_lshrrev_b32 v3, 5, v1
    v_lshlrev_b32 v3, 1, v3
    v_and_b32 v4, 3, v1
    v_xor_b32 v3, v3, v4
    v_lshl_add_u32 v20, v3, 4, v20
    s_and_b32 s47, s24, 3
    s_lshl_b32 s53, s47, 10
    s_mul_i32 s47, s47, 98304
    s_lshl_b32 s48, s44, 6
    s_add_u32 s47, s47, s48
    s_cmp_ge_u32 s24, 4
    s_cselect_b32 s54, 0, 2048
    s_cselect_b32 s48, 8192, 0
    s_add_u32 s47, s47, s54
    s_add_u32 s53, s53, s48
    s_add_u32 s53, s53, 98304
    v_add_u32 v20, s47, v20
    v_add_u32 v21, 2048, v20
    s_lshl_b32 s47, s45, 8
    s_lshl_b32 s48, s44, 3
    s_add_u32 s47, s47, s48
    s_add_u32 s47, s47, s24
    s_lshl_b32 s56, s47, 3
    s_lshl_b32 s47, s47, 11
    v_add_u32 v22, s47, v2
    s_waitcnt lgkmcnt(0)
    s_mov_b32 s32, s6
    s_mov_b32 s33, s7
    s_mov_b32 s34, 6291456
    s_mov_b32 s35, 0x20000
    s_mov_b32 s28, s4
    s_mov_b32 s29, s5
    s_mov_b32 s30, 4194304
    s_mov_b32 s31, 0x20000
    s_add_u32 m0, s53, 0
    s_nop 0
    buffer_load_dwordx4 v20, s[32:35], s52 offen lds
    s_cmp_ge_u32 s24, 4
    s_cbranch_scc1 qa_kernel_WP0
    s_add_u32 m0, s53, 4096
    s_nop 0
    buffer_load_dwordx4 v21, s[32:35], s52 offen lds
qa_kernel_WP0:
    s_add_u32 s51, s51, 1
    s_and_b32 s51, s51, 15
    s_mul_i32 s52, s51, 393216
    s_add_u32 m0, s50, 0
    s_nop 0
    buffer_load_dwordx4 v16, s[28:31], s49 offen lds
    s_add_u32 m0, s50, 1024
    s_nop 0
    buffer_load_dwordx4 v17, s[28:31], s49 offen lds
    s_add_u32 m0, s50, 2048
    s_nop 0
    buffer_load_dwordx4 v18, s[28:31], s49 offen lds
    s_add_u32 m0, s50, 3072
    s_nop 0
    buffer_load_dwordx4 v19, s[28:31], s49 offen lds
    s_add_u32 s49, s49, 128
    s_and_b32 s49, s49, 2047
    s_mov_b32 s36, s22
    s_mov_b32 s37, s23
    s_mov_b32 s38, 67108864
    s_mov_b32 s39, 0x20000
    s_mov_b32 s40, s20
    s_mov_b32 s41, s21
    s_mov_b32 s42, 256
    s_mov_b32 s43, 0x20000
    s_mov_b64 exec, 0
    s_cmp_eq_u32 s24, 0
    s_cbranch_scc1 qa_kernel_WS0_0
    s_cmp_eq_u32 s24, 1
    s_cbranch_scc1 qa_kernel_WS0_1
    s_cmp_eq_u32 s24, 2
    s_cbranch_scc1 qa_kernel_WS0_2
    s_cmp_eq_u32 s24, 3
    s_cbranch_scc1 qa_kernel_WS0_3
    s_cmp_eq_u32 s24, 4
    s_cbranch_scc1 qa_kernel_WS0_4
    s_cmp_eq_u32 s24, 5
    s_cbranch_scc1 qa_kernel_WS0_5
    s_cmp_eq_u32 s24, 6
    s_cbranch_scc1 qa_kernel_WS0_6
    s_cmp_eq_u32 s24, 7
    s_cbranch_scc1 qa_kernel_WS0_7
qa_kernel_WRET0:
    s_mov_b64 exec, -1
    s_add_u32 m0, s53, 12288
    s_nop 0
    buffer_load_dwordx4 v20, s[32:35], s52 offen lds
    s_cmp_ge_u32 s24, 4
    s_cbranch_scc1 qa_kernel_WP1
    s_add_u32 m0, s53, 16384
    s_nop 0
    buffer_load_dwordx4 v21, s[32:35], s52 offen lds
qa_kernel_WP1:
    s_add_u32 s51, s51, 1
    s_and_b32 s51, s51, 15
    s_mul_i32 s52, s51, 393216
    s_add_u32 m0, s50, 32768
    s_nop 0
    buffer_load_dwordx4 v16, s[28:31], s49 offen lds
    s_add_u32 m0, s50, 33792
    s_nop 0
    buffer_load_dwordx4 v17, s[28:31], s49 offen lds
    s_add_u32 m0, s50, 34816
    s_nop 0
    buffer_load_dwordx4 v18, s[28:31], s49 offen lds
    s_add_u32 m0, s50, 35840
    s_nop 0
    buffer_load_dwordx4 v19, s[28:31], s49 offen lds
    s_add_u32 s49, s49, 128
    s_and_b32 s49, s49, 2047
    buffer_load_dwordx4 v[208:211], v22, s[28:31], 0 offen offset:0
    buffer_load_dwordx4 v[212:215], v22, s[28:31], 0 offen offset:1024
    s_mov_b32 s55, 0x10000000
    s_lshl_b32 s57, s44, 13
    s_add_u32 s57, s57, 262144
    s_lshl_b32 s47, s46, 7
    v_lshl_add_u32 v23, v1, 2, s47
    v_mov_b32 v3, s55
    v_cmp_gt_u32 vcc, 32, v1
    s_nop 1
    v_cndmask_b32 v23, v3, v23, vcc
    v_mov_b32 v24, 0
    v_mov_b32 v25, 0
    buffer_store_dword v24, v23, s[36:39], s57 offen sc1
    v_lshlrev_b32 v3, 3, v1
    v_add_u32 v3, 159744, v3
    ds_write_b64 v3, v[24:25]
    s_lshl_b32 s61, s24, 11
    v_add_u32 v26, s61, v2
    s_lshl_b32 s58, s44, 18
    s_add_u32 s58, s58, 8388608
    s_lshl_b32 s63, s46, 12
    s_add_u32 s63, s63, s58
    s_lshl_b32 s60, s45, 15
    s_add_u32 s60, s60, 32768
    s_and_b32 s60, s60, 0x3ffff
    s_add_u32 s59, s58, s60
    v_and_b32 v27, 3, v1
    v_bfe_u32 v3, v1, 2, 1
    v_lshl_add_u32 v27, v3, 3, v27
    v_bfe_u32 v3, v1, 3, 1
    v_lshl_add_u32 v27, v3, 2, v27
    v_lshlrev_b32 v27, 4, v27
    v_and_b32 v3, 1, v5
    v_lshl_add_u32 v27, v3, 10, v27
    v_lshrrev_b32 v3, 1, v5
    v_lshl_add_u32 v27, v3, 9, v27
    s_lshl_b32 s47, s45, 3
    s_lshr_b32 s48, s24, 1
    s_add_u32 s47, s47, s48
    v_lshl_add_u32 v28, v1, 2, s47
    v_and_b32 v28, 63, v28
    v_lshlrev_b32 v28, 7, v28
    s_lshl_b32 s64, s2, 13
    v_lshlrev_b32 v30, 4, v0
    v_add_u32 v30, s64, v30
    s_lshr_b32 s47, s2, 3
    s_cmp_ge_u32 s47, 14
    s_cselect_b32 s68, s14, s12
    s_cselect_b32 s69, s15, s13
    s_mov_b32 s70, 7340032
    s_mov_b32 s71, 0x20000
    s_cselect_b32 s48, 14, 0
    s_cselect_b32 s72, 14336, 0
    s_sub_u32 s73, s47, s48
    s_lshl_b32 s73, s73, 5
    s_and_b32 s48, s2, 7
    s_mul_i32 s48, s48, 448
    s_add_u32 s73, s73, s48
    s_cmp_ge_u32 s47, 28
    s_cselect_b32 s47, 0x4000000, 0
    s_add_u32 s73, s73, s47
    s_mul_i32 s47, s24, 917504
    s_lshl_b32 s48, s73, 1
    s_add_u32 s47, s47, s48
    s_mov_b32 s48, 7168
    v_lshrrev_b32 v31, 2, v1
    v_mul_lo_u32 v31, v31, s48
    v_and_b32 v3, 3, v1
    v_lshl_add_u32 v31, v3, 4, v31
    v_add_u32 v31, s47, v31
    s_lshl_b32 s47, s24, 8
    s_add_u32 s47, s47, 161792
    v_lshl_add_u32 v40, v3, 4, s47
    v_lshl_add_u32 v40, v5, 6, v40
    v_and_b32 v41, 31, v1
    v_lshlrev_b32 v41, 2, v41
    v_lshrrev_b32 v4, 5, v1
    v_lshl_add_u32 v41, v4, 10, v41
    v_add_u32 v41, 161792, v41
    v_bfe_u32 v42, v1, 2, 2
    v_lshl_add_u32 v42, v42, 3, v3
    v_bfe_u32 v4, v1, 4, 1
    v_lshl_add_u32 v42, v4, 2, v42
    v_add_u32 v42, s73, v42
    v_lshlrev_b32 v42, 2, v42
    v_add_u32 v42, s72, v42
    v_and_b32 v3, 1, v1
    v_lshlrev_b32 v3, 4, v3
    v_mov_b32 v4, 0x3f80
    v_lshlrev_b32 v4, v3, v4
    v_bfe_u32 v3, v1, 1, 3
    v_cmp_eq_u32 vcc, 0, v3
    s_nop 1
    v_cndmask_b32 v32, 0, v4, vcc
    v_cmp_eq_u32 vcc, 1, v3
    s_nop 1
    v_cndmask_b32 v33, 0, v4, vcc
    v_cmp_eq_u32 vcc, 2, v3
    s_nop 1
    v_cndmask_b32 v34, 0, v4, vcc
    v_cmp_eq_u32 vcc, 3, v3
    s_nop 1
    v_cndmask_b32 v35, 0, v4, vcc
    s_mov_b32 s72, 0
    v_lshrrev_b32 v3, 2, v1
    v_xor_b32 v3, v3, v5
    v_and_b32 v3, 1, v3
    v_cmp_eq_u32 vcc, 0, v3
    v_mov_b32 v4, 0x3f803f80
    v_bfe_u32 v3, v1, 2, 1
    v_cmp_eq_u32 vcc, 0, v3
    s_nop 1
    v_cndmask_b32 v36, 0, v4, vcc
    v_xor_b32 v38, v36, v4
    v_mov_b32 v37, v36
    v_mov_b32 v39, v38
    v_add_u32 v43, s50, v27
    v_add_u32 v44, s50, v2
    v_lshrrev_b32 v3, 1, v6
    v_xor_b32 v3, v3, v5
    v_lshlrev_b32 v3, 4, v3
    v_lshl_add_u32 v45, v6, 7, v3
    v_add_u32 v45, s50, v45
    v_xor_b32 v46, 64, v45
    v_add_u32 v49, 65536, v45
    v_add_u32 v50, 65536, v46
    v_bfe_u32 v3, v1, 2, 2
    v_lshl_add_u32 v3, v5, 3, v3
    v_lshlrev_b32 v47, 6, v3
    v_and_b32 v3, 3, v1
    v_lshl_add_u32 v47, v3, 3, v47
    v_and_b32 v3, 1, v5
    v_lshl_add_u32 v47, v3, 5, v47
    v_add_u32 v47, 98304, v47
    v_xor_b32 v48, 32, v47
    v_mov_b32 v152, 0x3f803f80
    v_mov_b32 v153, 0x3f803f80
    v_mov_b32 v154, 0x3f803f80
    v_mov_b32 v155, 0x3f803f80
    s_add_u32 s47, s24, 0
    s_cmp_ge_u32 s47, 6
    s_cselect_b32 s48, 6, 0
    s_cselect_b32 s54, 2048, 0
    s_sub_u32 s47, s47, s48
    s_lshl_b32 s48, s47, 6
    s_add_u32 s48, s48, 159744
    v_lshl_add_u32 v174, v5, 4, s48
    s_lshr_b32 s48, s47, 1
    s_lshl_b32 s48, s48, 12
    s_add_u32 s54, s54, s48
    s_and_b32 s47, s47, 1
    s_lshl_b32 s47, s47, 5
    v_xor_b32 v172, s47, v47
    v_add_u32 v172, s54, v172
    s_add_u32 s47, s24, 4
    s_cmp_ge_u32 s47, 6
    s_cselect_b32 s48, 6, 0
    s_cselect_b32 s54, 2048, 0
    s_sub_u32 s47, s47, s48
    s_lshl_b32 s48, s47, 6
    s_add_u32 s48, s48, 159744
    v_lshl_add_u32 v175, v5, 4, s48
    s_lshr_b32 s48, s47, 1
    s_lshl_b32 s48, s48, 12
    s_add_u32 s54, s54, s48
    s_and_b32 s47, s47, 1
    s_lshl_b32 s47, s47, 5
    v_xor_b32 v173, s47, v47
    v_add_u32 v173, s54, v173
    s_lshl_b32 s47, s24, 6
    v_lshl_add_u32 v175, v5, 4, s47
    v_lshrrev_b32 v3, 1, v6
    v_mul_u32_u24 v3, 768, v3
    v_and_b32 v4, 1, v6
    v_mul_u32_u24 v4, 384, v4
    v_add_u32 v3, v3, v4
    s_mul_i32 s47, s24, 48
    v_lshl_add_u32 v174, v5, 4, s47
    v_add_u32 v174, v174, v3
    v_mov_b32 v3, s55
    v_mov_b32 v236, 0
    v_cmp_eq_u32 vcc, 0, v1
    s_nop 1
    v_cndmask_b32 v236, v3, v236, vcc
    s_add_u32 s56, s56, 0
    s_cmp_eq_u32 s24, 0
    s_cselect_b32 s76, 0xff, 0
    s_mov_b32 s77, 0
    s_lshl_b32 s74, s46, 8
    s_add_u32 s74, s74, 0
    v_lshlrev_b32 v176, 3, v6
    v_lshlrev_b32 v177, 5, v5
    v_lshlrev_b32 v178, 4, v5
    v_add_u32 v178, 159744, v178
    v_lshlrev_b32 v179, 2, v6
    v_add_u32 v179, 159744, v179
    v_and_b32 v238, 7, v1
    v_lshlrev_b32 v238, 5, v238
    v_mov_b32 v239, 1
    s_and_b32 s47, s2, 7
    s_lshl_b32 s47, s47, 5
    v_mov_b32 v237, s47
    s_cmp_ge_u32 s24, 4
    s_cbranch_scc1 qa_kernel_G1
    s_waitcnt vmcnt(12)
    s_waitcnt vmcnt(8)
    s_waitcnt lgkmcnt(0)
    s_barrier
    ds_read_b128 v[52:55], v45 offset:0
    ds_read_b128 v[56:59], v45 offset:2048
    ds_read_b128 v[60:63], v46 offset:0
    ds_read_b128 v[64:67], v46 offset:2048
    ds_read_b64_tr_b16 v[84:85], v47 offset:0
    ds_read_b64_tr_b16 v[86:87], v47 offset:256
    ds_read_b64_tr_b16 v[88:89], v47 offset:2048
    ds_read_b64_tr_b16 v[90:91], v47 offset:2304
    ds_read_b64_tr_b16 v[92:93], v48 offset:0
    ds_read_b64_tr_b16 v[94:95], v48 offset:256
    ds_read_b64_tr_b16 v[96:97], v48 offset:2048
    ds_read_b64_tr_b16 v[98:99], v48 offset:2304
    s_waitcnt lgkmcnt(4)
    v_mfma_f32_16x16x32_bf16 v[104:107], v[84:87], v[52:55], 0
    ds_read_b64_tr_b16 v[100:101], v47 offset:4096
    v_mfma_f32_16x16x32_bf16 v[104:107], v[88:91], v[60:63], v[104:107]
    ds_read_b64_tr_b16 v[102:103], v47 offset:4352
    s_setprio 3
    s_add_u32 m0, s53, 24576
    s_nop 0
    buffer_load_dwordx4 v20, s[32:35], s52 offen lds
    v_mfma_f32_16x16x32_bf16 v[108:111], v[84:87], v[56:59], 0
    ds_read_b64_tr_b16 v[84:85], v47 offset:6144
    v_mfma_f32_16x16x32_bf16 v[108:111], v[88:91], v[64:67], v[108:111]
    ds_read_b64_tr_b16 v[86:87], v47 offset:6400
    s_add_u32 m0, s53, 28672
    s_nop 0
    buffer_load_dwordx4 v21, s[32:35], s52 offen lds
    s_add_u32 s51, s51, 1
    s_and_b32 s51, s51, 15
    s_mul_i32 s52, s51, 393216
    ds_read_b64_tr_b16 v[156:157], v172 offset:0
    ds_read_b64_tr_b16 v[158:159], v172 offset:256
    s_waitcnt lgkmcnt(6)
    v_mfma_f32_16x16x32_bf16 v[112:115], v[92:95], v[52:55], 0
    ds_read_b64_tr_b16 v[88:89], v48 offset:4096
    v_mfma_f32_16x16x32_bf16 v[112:115], v[96:99], v[60:63], v[112:115]
    ds_read_b64_tr_b16 v[90:91], v48 offset:4352
    s_setprio 2
    s_add_u32 m0, s50, 65536
    s_nop 0
    buffer_load_dwordx4 v16, s[28:31], s49 offen lds
    v_mfma_f32_16x16x32_bf16 v[116:119], v[92:95], v[56:59], 0
    ds_read_b64_tr_b16 v[92:93], v48 offset:6144
    v_mfma_f32_16x16x32_bf16 v[116:119], v[96:99], v[64:67], v[116:119]
    ds_read_b64_tr_b16 v[94:95], v48 offset:6400
    s_add_u32 m0, s50, 66560
    s_nop 0
    buffer_load_dwordx4 v17, s[28:31], s49 offen lds
    s_waitcnt lgkmcnt(6)
    v_mfma_f32_16x16x32_bf16 v[120:123], v[52:55], v[100:103], 0
    ds_read_b64_tr_b16 v[96:97], v47 offset:8192
    v_mfma_f32_16x16x32_bf16 v[120:123], v[60:63], v[84:87], v[120:123]
    ds_read_b64_tr_b16 v[98:99], v47 offset:8448
    s_setprio 1
    s_add_u32 m0, s50, 67584
    s_nop 0
    buffer_load_dwordx4 v18, s[28:31], s49 offen lds
    v_mfma_f32_16x16x32_bf16 v[124:127], v[56:59], v[100:103], 0
    ds_read_b64_tr_b16 v[100:101], v47 offset:10240
    v_mfma_f32_16x16x32_bf16 v[124:127], v[64:67], v[84:87], v[124:127]
    ds_read_b64_tr_b16 v[102:103], v47 offset:10496
    s_add_u32 m0, s50, 68608
    s_nop 0
    buffer_load_dwordx4 v19, s[28:31], s49 offen lds
    s_add_u32 s49, s49, 128
    s_and_b32 s49, s49, 2047
    s_waitcnt lgkmcnt(4)
    v_mfma_f32_16x16x32_bf16 v[128:131], v[52:55], v[88:91], 0
    ds_read_b64_tr_b16 v[84:85], v48 offset:8192
    v_mfma_f32_16x16x32_bf16 v[128:131], v[60:63], v[92:95], v[128:131]
    ds_read_b64_tr_b16 v[86:87], v48 offset:8448
    s_setprio 0
    s_add_u32 m0, s53, 36864
    s_nop 0
    buffer_load_dwordx4 v20, s[32:35], s52 offen lds
    v_mfma_f32_16x16x32_bf16 v[132:135], v[56:59], v[88:91], 0
    ds_read_b64_tr_b16 v[88:89], v48 offset:10240
    v_mfma_f32_16x16x32_bf16 v[132:135], v[64:67], v[92:95], v[132:135]
    ds_read_b64_tr_b16 v[90:91], v48 offset:10496
    s_add_u32 m0, s53, 40960
    s_nop 0
    buffer_load_dwordx4 v21, s[32:35], s52 offen lds
    s_add_u32 s51, s51, 1
    s_and_b32 s51, s51, 15
    s_mul_i32 s52, s51, 393216
    v_mfma_f32_16x16x32_bf16 v[164:167], v[156:159], v[152:155], 0
    s_waitcnt lgkmcnt(4)
    v_mfma_f32_16x16x32_bf16 v[136:139], v[96:99], v[52:55], 0
    s_waitcnt vmcnt(15)
    s_waitcnt vmcnt(11)
    s_barrier
    ds_read_b128 v[68:71], v45 offset:32768
    ds_read_b128 v[72:75], v45 offset:34816
    ds_read_b128 v[76:79], v46 offset:32768
    ds_read_b128 v[80:83], v46 offset:34816
    ds_read_b64_tr_b16 v[92:93], v47 offset:12288
    v_mfma_f32_16x16x32_bf16 v[136:139], v[100:103], v[60:63], v[136:139]
    ds_read_b64_tr_b16 v[94:95], v47 offset:12544
    s_setprio 3
    s_add_u32 m0, s50, 0
    s_nop 0
    buffer_load_dwordx4 v16, s[28:31], s49 offen lds
    v_mfma_f32_16x16x32_bf16 v[140:143], v[96:99], v[56:59], 0
    ds_read_b64_tr_b16 v[96:97], v47 offset:14336
    v_mfma_f32_16x16x32_bf16 v[140:143], v[100:103], v[64:67], v[140:143]
    ds_read_b64_tr_b16 v[98:99], v47 offset:14592
    s_add_u32 m0, s50, 1024
    s_nop 0
    buffer_load_dwordx4 v17, s[28:31], s49 offen lds
    ds_read_b64_tr_b16 v[156:157], v172 offset:12288
    ds_read_b64_tr_b16 v[158:159], v172 offset:12544
    s_waitcnt lgkmcnt(10)
    v_mfma_f32_16x16x32_bf16 v[144:147], v[84:87], v[52:55], 0
    ds_read_b64_tr_b16 v[100:101], v48 offset:12288
    v_mfma_f32_16x16x32_bf16 v[144:147], v[88:91], v[60:63], v[144:147]
    ds_read_b64_tr_b16 v[102:103], v48 offset:12544
    s_add_u32 m0, s50, 2048
    s_nop 0
    buffer_load_dwordx4 v18, s[28:31], s49 offen lds
    v_mfma_f32_16x16x32_bf16 v[148:151], v[84:87], v[56:59], 0
    ds_read_b64_tr_b16 v[84:85], v48 offset:14336
    v_mfma_f32_16x16x32_bf16 v[148:151], v[88:91], v[64:67], v[148:151]
    ds_read_b64_tr_b16 v[86:87], v48 offset:14592
    s_setprio 2
    s_add_u32 m0, s50, 3072
    s_nop 0
    buffer_load_dwordx4 v19, s[28:31], s49 offen lds
    s_add_u32 s49, s49, 128
    s_and_b32 s49, s49, 2047
    s_waitcnt lgkmcnt(6)
    v_mfma_f32_16x16x32_bf16 v[104:107], v[92:95], v[68:71], v[104:107]
    ds_read_b64_tr_b16 v[88:89], v47 offset:16384
    v_mfma_f32_16x16x32_bf16 v[104:107], v[96:99], v[76:79], v[104:107]
    ds_read_b64_tr_b16 v[90:91], v47 offset:16640
    s_add_u32 m0, s53, 49152
    s_nop 0
    buffer_load_dwordx4 v20, s[32:35], s52 offen lds
    v_mfma_f32_16x16x32_bf16 v[108:111], v[92:95], v[72:75], v[108:111]
    ds_read_b64_tr_b16 v[92:93], v47 offset:18432
    v_mfma_f32_16x16x32_bf16 v[108:111], v[96:99], v[80:83], v[108:111]
    ds_read_b64_tr_b16 v[94:95], v47 offset:18688
    s_add_u32 m0, s53, 53248
    s_nop 0
    buffer_load_dwordx4 v21, s[32:35], s52 offen lds
    s_add_u32 s51, s51, 1
    s_and_b32 s51, s51, 15
    s_mul_i32 s52, s51, 393216
    s_waitcnt lgkmcnt(4)
    v_mfma_f32_16x16x32_bf16 v[112:115], v[100:103], v[68:71], v[112:115]
    ds_read_b64_tr_b16 v[96:97], v48 offset:16384
    v_mfma_f32_16x16x32_bf16 v[112:115], v[84:87], v[76:79], v[112:115]
    ds_read_b64_tr_b16 v[98:99], v48 offset:16640
    s_setprio 1
    s_add_u32 m0, s50, 32768
    s_nop 0
    buffer_load_dwordx4 v16, s[28:31], s49 offen lds
    v_mfma_f32_16x16x32_bf16 v[116:119], v[100:103], v[72:75], v[116:119]
    ds_read_b64_tr_b16 v[100:101], v48 offset:18432
    v_mfma_f32_16x16x32_bf16 v[116:119], v[84:87], v[80:83], v[116:119]
    ds_read_b64_tr_b16 v[102:103], v48 offset:18688
    s_add_u32 m0, s50, 33792
    s_nop 0
    buffer_load_dwordx4 v17, s[28:31], s49 offen lds
    v_mfma_f32_16x16x32_bf16 v[164:167], v[156:159], v[152:155], v[164:167]
    s_waitcnt lgkmcnt(4)
    v_mfma_f32_16x16x32_bf16 v[120:123], v[68:71], v[88:91], v[120:123]
    ds_read_b64_tr_b16 v[84:85], v47 offset:20480
    v_mfma_f32_16x16x32_bf16 v[120:123], v[76:79], v[92:95], v[120:123]
    ds_read_b64_tr_b16 v[86:87], v47 offset:20736
    s_add_u32 m0, s50, 34816
    s_nop 0
    buffer_load_dwordx4 v18, s[28:31], s49 offen lds
    v_mfma_f32_16x16x32_bf16 v[124:127], v[72:75], v[88:91], v[124:127]
    ds_read_b64_tr_b16 v[88:89], v47 offset:22528
    v_mfma_f32_16x16x32_bf16 v[124:127], v[80:83], v[92:95], v[124:127]
    ds_read_b64_tr_b16 v[90:91], v47 offset:22784
    s_setprio 0
    s_add_u32 m0, s50, 35840
    s_nop 0
    buffer_load_dwordx4 v19, s[28:31], s49 offen lds
    s_add_u32 s49, s49, 128
    s_and_b32 s49, s49, 2047
    s_waitcnt lgkmcnt(4)
    v_mfma_f32_16x16x32_bf16 v[128:131], v[68:71], v[96:99], v[128:131]
    ds_read_b64_tr_b16 v[92:93], v48 offset:20480
    v_mfma_f32_16x16x32_bf16 v[128:131], v[76:79], v[100:103], v[128:131]
    ds_read_b64_tr_b16 v[94:95], v48 offset:20736
    v_mfma_f32_16x16x32_bf16 v[132:135], v[72:75], v[96:99], v[132:135]
    ds_read_b64_tr_b16 v[96:97], v48 offset:22528
    v_mfma_f32_16x16x32_bf16 v[132:135], v[80:83], v[100:103], v[132:135]
    ds_read_b64_tr_b16 v[98:99], v48 offset:22784
    s_waitcnt lgkmcnt(4)
    v_mfma_f32_16x16x32_bf16 v[136:139], v[84:87], v[68:71], v[136:139]
    s_waitcnt vmcnt(16)
    s_waitcnt vmcnt(12)
    s_barrier
    ds_read_b128 v[52:55], v49 offset:0
    ds_read_b128 v[56:59], v49 offset:2048
    ds_read_b128 v[60:63], v50 offset:0
    ds_read_b128 v[64:67], v50 offset:2048
    ds_read_b64_tr_b16 v[100:101], v47 offset:24576
    v_mfma_f32_16x16x32_bf16 v[136:139], v[88:91], v[76:79], v[136:139]
    ds_read_b64_tr_b16 v[102:103], v47 offset:24832
    s_setprio 3
    s_add_u32 m0, s53, 0
    s_nop 0
    buffer_load_dwordx4 v20, s[32:35], s52 offen lds
    v_mfma_f32_16x16x32_bf16 v[140:143], v[84:87], v[72:75], v[140:143]
    ds_read_b64_tr_b16 v[84:85], v47 offset:26624
    v_mfma_f32_16x16x32_bf16 v[140:143], v[88:91], v[80:83], v[140:143]
    ds_read_b64_tr_b16 v[86:87], v47 offset:26880
    s_add_u32 m0, s53, 4096
    s_nop 0
    buffer_load_dwordx4 v21, s[32:35], s52 offen lds
    s_add_u32 s51, s51, 1
    s_and_b32 s51, s51, 15
    s_mul_i32 s52, s51, 393216
    v_lshlrev_b32 v216, 16, v208
    v_and_b32 v217, 0xffff0000, v208
    s_waitcnt lgkmcnt(8)
    v_mfma_f32_16x16x32_bf16 v[144:147], v[92:95], v[68:71], v[144:147]
    ds_read_b64_tr_b16 v[88:89], v48 offset:24576
    v_mfma_f32_16x16x32_bf16 v[144:147], v[96:99], v[76:79], v[144:147]
    ds_read_b64_tr_b16 v[90:91], v48 offset:24832
    v_lshlrev_b32 v218, 16, v209
    v_and_b32 v219, 0xffff0000, v209
    v_lshlrev_b32 v220, 16, v210
    v_mfma_f32_16x16x32_bf16 v[148:151], v[92:95], v[72:75], v[148:151]
    ds_read_b64_tr_b16 v[92:93], v48 offset:26624
    v_mfma_f32_16x16x32_bf16 v[148:151], v[96:99], v[80:83], v[148:151]
    ds_read_b64_tr_b16 v[94:95], v48 offset:26880
    s_setprio 2
    v_and_b32 v221, 0xffff0000, v210
    v_lshlrev_b32 v222, 16, v211
    v_and_b32 v223, 0xffff0000, v211
    s_waitcnt lgkmcnt(4)
    v_mfma_f32_16x16x32_bf16 v[104:107], v[100:103], v[52:55], v[104:107]
    ds_read_b64_tr_b16 v[96:97], v47 offset:28672
    v_mfma_f32_16x16x32_bf16 v[104:107], v[84:87], v[60:63], v[104:107]
    ds_read_b64_tr_b16 v[98:99], v47 offset:28928
    s_add_u32 m0, s50, 65536
    s_nop 0
    buffer_load_dwordx4 v16, s[28:31], s49 offen lds
    v_lshlrev_b32 v224, 16, v212
    v_and_b32 v225, 0xffff0000, v212
    v_lshlrev_b32 v226, 16, v213
    v_mfma_f32_16x16x32_bf16 v[108:111], v[100:103], v[56:59], v[108:111]
    ds_read_b64_tr_b16 v[100:101], v47 offset:30720
    v_mfma_f32_16x16x32_bf16 v[108:111], v[84:87], v[64:67], v[108:111]
    ds_read_b64_tr_b16 v[102:103], v47 offset:30976
    s_add_u32 m0, s50, 66560
    s_nop 0
    buffer_load_dwordx4 v17, s[28:31], s49 offen lds
    v_and_b32 v227, 0xffff0000, v213
    v_lshlrev_b32 v228, 16, v214
    v_and_b32 v229, 0xffff0000, v214
    s_waitcnt lgkmcnt(4)
    v_mfma_f32_16x16x32_bf16 v[112:115], v[88:91], v[52:55], v[112:115]
    ds_read_b64_tr_b16 v[84:85], v48 offset:28672
    v_mfma_f32_16x16x32_bf16 v[112:115], v[92:95], v[60:63], v[112:115]
    ds_read_b64_tr_b16 v[86:87], v48 offset:28928
    s_setprio 1
    s_add_u32 m0, s50, 67584
    s_nop 0
    buffer_load_dwordx4 v18, s[28:31], s49 offen lds
    v_lshlrev_b32 v230, 16, v215
    v_and_b32 v231, 0xffff0000, v215
    v_add_f32 v232, v216, v217
    v_mfma_f32_16x16x32_bf16 v[116:119], v[88:91], v[56:59], v[116:119]
    ds_read_b64_tr_b16 v[88:89], v48 offset:30720
    v_mfma_f32_16x16x32_bf16 v[116:119], v[92:95], v[64:67], v[116:119]
    ds_read_b64_tr_b16 v[90:91], v48 offset:30976
    s_add_u32 m0, s50, 68608
    s_nop 0
    buffer_load_dwordx4 v19, s[28:31], s49 offen lds
    s_add_u32 s49, s49, 128
    s_and_b32 s49, s49, 2047
    v_add_f32 v233, v218, v219
    v_add_f32 v232, v232, v220
    v_add_f32 v233, v233, v221
    s_waitcnt lgkmcnt(4)
    v_mfma_f32_16x16x32_bf16 v[120:123], v[52:55], v[96:99], v[120:123]
    ds_read_b64_tr_b16 v[92:93], v47 offset:32768
    v_mfma_f32_16x16x32_bf16 v[120:123], v[60:63], v[100:103], v[120:123]
    ds_read_b64_tr_b16 v[94:95], v47 offset:33024
    v_add_f32 v232, v232, v222
    v_add_f32 v233, v233, v223
    v_add_f32 v232, v232, v224
    v_mfma_f32_16x16x32_bf16 v[124:127], v[56:59], v[96:99], v[124:127]
    ds_read_b64_tr_b16 v[96:97], v47 offset:34816
    v_mfma_f32_16x16x32_bf16 v[124:127], v[64:67], v[100:103], v[124:127]
    ds_read_b64_tr_b16 v[98:99], v47 offset:35072
    s_setprio 0
    v_add_f32 v233, v233, v225
    v_add_f32 v232, v232, v226
    v_add_f32 v233, v233, v227
    s_waitcnt lgkmcnt(4)
    v_mfma_f32_16x16x32_bf16 v[128:131], v[52:55], v[84:87], v[128:131]
    ds_read_b64_tr_b16 v[100:101], v48 offset:32768
    v_mfma_f32_16x16x32_bf16 v[128:131], v[60:63], v[88:91], v[128:131]
    ds_read_b64_tr_b16 v[102:103], v48 offset:33024
    v_add_f32 v232, v232, v228
    v_add_f32 v233, v233, v229
    v_add_f32 v232, v232, v230
    v_mfma_f32_16x16x32_bf16 v[132:135], v[56:59], v[84:87], v[132:135]
    ds_read_b64_tr_b16 v[84:85], v48 offset:34816
    v_mfma_f32_16x16x32_bf16 v[132:135], v[64:67], v[88:91], v[132:135]
    ds_read_b64_tr_b16 v[86:87], v48 offset:35072
    v_add_f32 v233, v233, v231
    v_add_f32 v232, v232, v233
    s_waitcnt lgkmcnt(4)
    v_mfma_f32_16x16x32_bf16 v[136:139], v[92:95], v[52:55], v[136:139]
    s_waitcnt vmcnt(16)
    s_waitcnt vmcnt(12)
    s_barrier
    ds_read_b128 v[68:71], v45 offset:0
    ds_read_b128 v[72:75], v45 offset:2048
    ds_read_b128 v[76:79], v46 offset:0
    ds_read_b128 v[80:83], v46 offset:2048
    ds_read_b64_tr_b16 v[88:89], v47 offset:36864
qa_kernel_WS0_0:
    s_cbranch_execz qa_kernel_WS0_8
    v_mfma_f32_16x16x32_bf16 v[136:139], v[96:99], v[60:63], v[136:139]
    ds_read_b64_tr_b16 v[90:91], v47 offset:37120
    s_setprio 3
    s_add_u32 m0, s53, 12288
    s_nop 0
    buffer_load_dwordx4 v20, s[32:35], s52 offen lds
    v_add_f32_dpp v232, v232, v232 quad_perm:[1,0,3,2] row_mask:0xf bank_mask:0xf
    s_nop 1
    v_add_f32_dpp v232, v232, v232 quad_perm:[2,3,0,1] row_mask:0xf bank_mask:0xf
    v_mfma_f32_16x16x32_bf16 v[140:143], v[92:95], v[56:59], v[140:143]
    ds_read_b64_tr_b16 v[92:93], v47 offset:38912
    v_mfma_f32_16x16x32_bf16 v[140:143], v[96:99], v[64:67], v[140:143]
    ds_read_b64_tr_b16 v[94:95], v47 offset:39168
    s_add_u32 m0, s53, 16384
    s_nop 0
    buffer_load_dwordx4 v21, s[32:35], s52 offen lds
    s_add_u32 s51, s51, 1
    s_and_b32 s51, s51, 15
    s_mul_i32 s52, s51, 393216
    v_add_f32_dpp v232, v232, v232 row_half_mirror row_mask:0xf bank_mask:0xf
    s_nop 1
    v_add_f32_dpp v232, v232, v232 row_mirror row_mask:0xf bank_mask:0xf
    s_waitcnt lgkmcnt(8)
    v_mfma_f32_16x16x32_bf16 v[144:147], v[100:103], v[52:55], v[144:147]
    ds_read_b64_tr_b16 v[96:97], v48 offset:36864
    v_mfma_f32_16x16x32_bf16 v[144:147], v[84:87], v[60:63], v[144:147]
    ds_read_b64_tr_b16 v[98:99], v48 offset:37120
    v_mov_b32 v233, v232
    s_nop 1
    v_permlane16_swap_b32 v232, v233
    v_mfma_f32_16x16x32_bf16 v[148:151], v[100:103], v[56:59], v[148:151]
    ds_read_b64_tr_b16 v[100:101], v48 offset:38912
    v_mfma_f32_16x16x32_bf16 v[148:151], v[84:87], v[64:67], v[148:151]
    ds_read_b64_tr_b16 v[102:103], v48 offset:39168
    s_setprio 2
    v_add_f32 v232, v232, v233
    v_mov_b32 v233, v232
    s_waitcnt lgkmcnt(4)
    v_mfma_f32_16x16x32_bf16 v[104:107], v[88:91], v[68:71], v[104:107]
    ds_read_b64_tr_b16 v[84:85], v47 offset:40960
    v_mfma_f32_16x16x32_bf16 v[104:107], v[92:95], v[76:79], v[104:107]
    ds_read_b64_tr_b16 v[86:87], v47 offset:41216
    s_add_u32 m0, s50, 0
    s_nop 0
    buffer_load_dwordx4 v16, s[28:31], s49 offen lds
    v_permlane32_swap_b32 v232, v233
    v_add_f32 v232, v232, v233
    v_mfma_f32_16x16x32_bf16 v[108:111], v[88:91], v[72:75], v[108:111]
    ds_read_b64_tr_b16 v[88:89], v47 offset:43008
    v_mfma_f32_16x16x32_bf16 v[108:111], v[92:95], v[80:83], v[108:111]
    ds_read_b64_tr_b16 v[90:91], v47 offset:43264
    s_add_u32 m0, s50, 1024
    s_nop 0
    buffer_load_dwordx4 v17, s[28:31], s49 offen lds
    v_mul_f32 v232, 0xba800000, v232
    v_add_f32 v216, v216, v232
    v_add_f32 v217, v217, v232
    s_waitcnt lgkmcnt(4)
    v_mfma_f32_16x16x32_bf16 v[112:115], v[96:99], v[68:71], v[112:115]
    ds_read_b64_tr_b16 v[92:93], v48 offset:40960
    v_mfma_f32_16x16x32_bf16 v[112:115], v[100:103], v[76:79], v[112:115]
    ds_read_b64_tr_b16 v[94:95], v48 offset:41216
    s_setprio 1
    s_add_u32 m0, s50, 2048
    s_nop 0
    buffer_load_dwordx4 v18, s[28:31], s49 offen lds
    v_add_f32 v218, v218, v232
    v_add_f32 v219, v219, v232
    v_add_f32 v220, v220, v232
    v_mfma_f32_16x16x32_bf16 v[116:119], v[96:99], v[72:75], v[116:119]
    ds_read_b64_tr_b16 v[96:97], v48 offset:43008
    v_mfma_f32_16x16x32_bf16 v[116:119], v[100:103], v[80:83], v[116:119]
    ds_read_b64_tr_b16 v[98:99], v48 offset:43264
    s_add_u32 m0, s50, 3072
    s_nop 0
    buffer_load_dwordx4 v19, s[28:31], s49 offen lds
    s_add_u32 s49, s49, 128
    s_and_b32 s49, s49, 2047
    v_add_f32 v221, v221, v232
    v_add_f32 v222, v222, v232
    v_add_f32 v223, v223, v232
    s_waitcnt lgkmcnt(4)
    v_mfma_f32_16x16x32_bf16 v[120:123], v[68:71], v[84:87], v[120:123]
    ds_read_b64_tr_b16 v[100:101], v47 offset:45056
    v_mfma_f32_16x16x32_bf16 v[120:123], v[76:79], v[88:91], v[120:123]
    ds_read_b64_tr_b16 v[102:103], v47 offset:45312
    v_add_f32 v224, v224, v232
    v_add_f32 v225, v225, v232
    v_add_f32 v226, v226, v232
    v_mfma_f32_16x16x32_bf16 v[124:127], v[72:75], v[84:87], v[124:127]
    ds_read_b64_tr_b16 v[84:85], v47 offset:47104
    v_mfma_f32_16x16x32_bf16 v[124:127], v[80:83], v[88:91], v[124:127]
    ds_read_b64_tr_b16 v[86:87], v47 offset:47360
    s_setprio 0
    v_add_f32 v227, v227, v232
    v_add_f32 v228, v228, v232
    v_add_f32 v229, v229, v232
    s_waitcnt lgkmcnt(4)
    v_mfma_f32_16x16x32_bf16 v[128:131], v[68:71], v[92:95], v[128:131]
    ds_read_b64_tr_b16 v[88:89], v48 offset:45056
    v_mfma_f32_16x16x32_bf16 v[128:131], v[76:79], v[96:99], v[128:131]
    ds_read_b64_tr_b16 v[90:91], v48 offset:45312
    v_add_f32 v230, v230, v232
    v_add_f32 v231, v231, v232
    v_mul_f32 v234, v216, v216
    v_mfma_f32_16x16x32_bf16 v[132:135], v[72:75], v[92:95], v[132:135]
    ds_read_b64_tr_b16 v[92:93], v48 offset:47104
    v_mfma_f32_16x16x32_bf16 v[132:135], v[80:83], v[96:99], v[132:135]
    ds_read_b64_tr_b16 v[94:95], v48 offset:47360
    v_mul_f32 v233, v217, v217
    v_fmac_f32 v234, v218, v218
    v_fmac_f32 v233, v219, v219
    s_waitcnt lgkmcnt(4)
    v_mfma_f32_16x16x32_bf16 v[136:139], v[100:103], v[68:71], v[136:139]
    s_waitcnt vmcnt(16)
    s_waitcnt vmcnt(12)
    s_barrier
    ds_read_b128 v[52:55], v45 offset:32768
    ds_read_b128 v[56:59], v45 offset:34816
    ds_read_b128 v[60:63], v46 offset:32768
    ds_read_b128 v[64:67], v46 offset:34816
    ds_read_b64_tr_b16 v[96:97], v47 offset:49152
    v_mfma_f32_16x16x32_bf16 v[136:139], v[84:87], v[76:79], v[136:139]
    ds_read_b64_tr_b16 v[98:99], v47 offset:49408
    s_setprio 3
    s_add_u32 m0, s53, 24576
    s_nop 0
    buffer_load_dwordx4 v20, s[32:35], s52 offen lds
    v_fmac_f32 v234, v220, v220
    v_fmac_f32 v233, v221, v221
    v_fmac_f32 v234, v222, v222
    v_mfma_f32_16x16x32_bf16 v[140:143], v[100:103], v[72:75], v[140:143]
    ds_read_b64_tr_b16 v[100:101], v47 offset:51200
    v_mfma_f32_16x16x32_bf16 v[140:143], v[84:87], v[80:83], v[140:143]
    ds_read_b64_tr_b16 v[102:103], v47 offset:51456
    s_add_u32 m0, s53, 28672
    s_nop 0
    buffer_load_dwordx4 v21, s[32:35], s52 offen lds
    s_add_u32 s51, s51, 1
    s_and_b32 s51, s51, 15
    s_mul_i32 s52, s51, 393216
    v_fmac_f32 v233, v223, v223
    v_fmac_f32 v234, v224, v224
    v_fmac_f32 v233, v225, v225
    s_waitcnt lgkmcnt(8)
    v_mfma_f32_16x16x32_bf16 v[144:147], v[88:91], v[68:71], v[144:147]
    ds_read_b64_tr_b16 v[84:85], v48 offset:49152
    v_mfma_f32_16x16x32_bf16 v[144:147], v[92:95], v[76:79], v[144:147]
    ds_read_b64_tr_b16 v[86:87], v48 offset:49408
    v_fmac_f32 v234, v226, v226
    v_fmac_f32 v233, v227, v227
    v_fmac_f32 v234, v228, v228
    v_mfma_f32_16x16x32_bf16 v[148:151], v[88:91], v[72:75], v[148:151]
    ds_read_b64_tr_b16 v[88:89], v48 offset:51200
    v_mfma_f32_16x16x32_bf16 v[148:151], v[92:95], v[80:83], v[148:151]
    ds_read_b64_tr_b16 v[90:91], v48 offset:51456
    s_setprio 2
    v_fmac_f32 v233, v229, v229
    v_fmac_f32 v234, v230, v230
    v_fmac_f32 v233, v231, v231
    s_waitcnt lgkmcnt(4)
    v_mfma_f32_16x16x32_bf16 v[104:107], v[96:99], v[52:55], v[104:107]
    ds_read_b64_tr_b16 v[92:93], v47 offset:53248
    v_mfma_f32_16x16x32_bf16 v[104:107], v[100:103], v[60:63], v[104:107]
    ds_read_b64_tr_b16 v[94:95], v47 offset:53504
    s_add_u32 m0, s50, 32768
    s_nop 0
    buffer_load_dwordx4 v16, s[28:31], s49 offen lds
    v_add_f32 v234, v234, v233
    v_mfma_f32_16x16x32_bf16 v[108:111], v[96:99], v[56:59], v[108:111]
    ds_read_b64_tr_b16 v[96:97], v47 offset:55296
    v_mfma_f32_16x16x32_bf16 v[108:111], v[100:103], v[64:67], v[108:111]
    ds_read_b64_tr_b16 v[98:99], v47 offset:55552
    s_add_u32 m0, s50, 33792
    s_nop 0
    buffer_load_dwordx4 v17, s[28:31], s49 offen lds
    v_add_f32_dpp v234, v234, v234 quad_perm:[1,0,3,2] row_mask:0xf bank_mask:0xf
    s_nop 1
    v_add_f32_dpp v234, v234, v234 quad_perm:[2,3,0,1] row_mask:0xf bank_mask:0xf
    s_waitcnt lgkmcnt(4)
    v_mfma_f32_16x16x32_bf16 v[112:115], v[84:87], v[52:55], v[112:115]
    ds_read_b64_tr_b16 v[100:101], v48 offset:53248
    v_mfma_f32_16x16x32_bf16 v[112:115], v[88:91], v[60:63], v[112:115]
    ds_read_b64_tr_b16 v[102:103], v48 offset:53504
    s_setprio 1
    s_add_u32 m0, s50, 34816
    s_nop 0
    buffer_load_dwordx4 v18, s[28:31], s49 offen lds
    v_add_f32_dpp v234, v234, v234 row_half_mirror row_mask:0xf bank_mask:0xf
    s_nop 1
    v_add_f32_dpp v234, v234, v234 row_mirror row_mask:0xf bank_mask:0xf
    v_mfma_f32_16x16x32_bf16 v[116:119], v[84:87], v[56:59], v[116:119]
    ds_read_b64_tr_b16 v[84:85], v48 offset:55296
    v_mfma_f32_16x16x32_bf16 v[116:119], v[88:91], v[64:67], v[116:119]
    ds_read_b64_tr_b16 v[86:87], v48 offset:55552
    s_add_u32 m0, s50, 35840
    s_nop 0
    buffer_load_dwordx4 v19, s[28:31], s49 offen lds
    s_add_u32 s49, s49, 128
    s_and_b32 s49, s49, 2047
    v_mov_b32 v233, v234
    s_nop 1
    v_permlane16_swap_b32 v234, v233
    s_waitcnt lgkmcnt(4)
    v_mfma_f32_16x16x32_bf16 v[120:123], v[52:55], v[92:95], v[120:123]
    ds_read_b64_tr_b16 v[88:89], v47 offset:57344
    v_mfma_f32_16x16x32_bf16 v[120:123], v[60:63], v[96:99], v[120:123]
    ds_read_b64_tr_b16 v[90:91], v47 offset:57600
    v_add_f32 v234, v234, v233
    v_mov_b32 v233, v234
    v_mfma_f32_16x16x32_bf16 v[124:127], v[56:59], v[92:95], v[124:127]
    ds_read_b64_tr_b16 v[92:93], v47 offset:59392
    v_mfma_f32_16x16x32_bf16 v[124:127], v[64:67], v[96:99], v[124:127]
    ds_read_b64_tr_b16 v[94:95], v47 offset:59648
    s_setprio 0
    v_permlane32_swap_b32 v234, v233
    v_add_f32 v234, v234, v233
    s_waitcnt lgkmcnt(4)
    v_mfma_f32_16x16x32_bf16 v[128:131], v[52:55], v[100:103], v[128:131]
    ds_read_b64_tr_b16 v[96:97], v48 offset:57344
    v_mfma_f32_16x16x32_bf16 v[128:131], v[60:63], v[84:87], v[128:131]
    ds_read_b64_tr_b16 v[98:99], v48 offset:57600
    v_mul_f32 v234, 0x3a800000, v234
    v_add_f32 v234, 0x3727c5ac, v234
    v_mfma_f32_16x16x32_bf16 v[132:135], v[56:59], v[100:103], v[132:135]
    ds_read_b64_tr_b16 v[100:101], v48 offset:59392
    v_mfma_f32_16x16x32_bf16 v[132:135], v[64:67], v[84:87], v[132:135]
    ds_read_b64_tr_b16 v[102:103], v48 offset:59648
    v_rsq_f32 v234, v234
    s_nop 0
    v_mul_f32 v235, v232, v234
    s_lshl_b32 s78, s44, 3
    s_add_u32 s78, s78, s45
    s_mul_i32 s78, s78, 768
    s_add_u32 s78, s78, 65536
    s_mov_b32 exec_lo, 0x00010001
    s_mov_b32 exec_hi, 0x00010001
    buffer_store_dwordx4 v[164:167], v175, s[36:39], s78 offen offset:0 sc1
    s_mov_b64 exec, -1
    s_waitcnt lgkmcnt(4)
    v_mfma_f32_16x16x32_bf16 v[136:139], v[88:91], v[52:55], v[136:139]
    s_waitcnt vmcnt(17)
    s_waitcnt vmcnt(13)
    s_barrier
    ds_read_b128 v[68:71], v49 offset:0
    ds_read_b128 v[72:75], v49 offset:2048
    ds_read_b128 v[76:79], v50 offset:0
    ds_read_b128 v[80:83], v50 offset:2048
    ds_read_b64_tr_b16 v[84:85], v47 offset:0
    v_mfma_f32_16x16x32_bf16 v[136:139], v[92:95], v[60:63], v[136:139]
    ds_read_b64_tr_b16 v[86:87], v47 offset:256
    s_setprio 3
    s_add_u32 m0, s53, 36864
    s_nop 0
    buffer_load_dwordx4 v20, s[32:35], s52 offen lds
    buffer_store_dwordx2 v[234:235], v236, s[36:39], s56 offen sc1
    v_mfma_f32_16x16x32_bf16 v[140:143], v[88:91], v[56:59], v[140:143]
    ds_read_b64_tr_b16 v[88:89], v47 offset:2048
    v_mfma_f32_16x16x32_bf16 v[140:143], v[92:95], v[64:67], v[140:143]
    ds_read_b64_tr_b16 v[90:91], v47 offset:2304
    s_add_u32 m0, s53, 40960
    s_nop 0
    buffer_load_dwordx4 v21, s[32:35], s52 offen lds
    s_add_u32 s51, s51, 1
    s_and_b32 s51, s51, 15
    s_mul_i32 s52, s51, 393216
    s_waitcnt lgkmcnt(8)
    v_mfma_f32_16x16x32_bf16 v[144:147], v[96:99], v[52:55], v[144:147]
    ds_read_b64_tr_b16 v[92:93], v48 offset:0
    v_mfma_f32_16x16x32_bf16 v[144:147], v[100:103], v[60:63], v[144:147]
    ds_read_b64_tr_b16 v[94:95], v48 offset:256
    v_mfma_f32_16x16x32_bf16 v[148:151], v[96:99], v[56:59], v[148:151]
    ds_read_b64_tr_b16 v[96:97], v48 offset:2048
    v_mfma_f32_16x16x32_bf16 v[148:151], v[100:103], v[64:67], v[148:151]
    ds_read_b64_tr_b16 v[98:99], v48 offset:2304
    s_setprio 2
    s_waitcnt lgkmcnt(4)
    v_mfma_f32_16x16x32_bf16 v[104:107], v[84:87], v[68:71], v[104:107]
    ds_read_b64_tr_b16 v[100:101], v47 offset:4096
    v_mfma_f32_16x16x32_bf16 v[104:107], v[88:91], v[76:79], v[104:107]
    ds_read_b64_tr_b16 v[102:103], v47 offset:4352
    s_add_u32 m0, s50, 65536
    s_nop 0
    buffer_load_dwordx4 v16, s[28:31], s49 offen lds
    v_mfma_f32_16x16x32_bf16 v[108:111], v[84:87], v[72:75], v[108:111]
    ds_read_b64_tr_b16 v[84:85], v47 offset:6144
    v_mfma_f32_16x16x32_bf16 v[108:111], v[88:91], v[80:83], v[108:111]
    ds_read_b64_tr_b16 v[86:87], v47 offset:6400
    s_add_u32 m0, s50, 66560
    s_nop 0
    buffer_load_dwordx4 v17, s[28:31], s49 offen lds
    s_waitcnt lgkmcnt(4)
    v_mfma_f32_16x16x32_bf16 v[112:115], v[92:95], v[68:71], v[112:115]
    ds_read_b64_tr_b16 v[88:89], v48 offset:4096
    v_mfma_f32_16x16x32_bf16 v[112:115], v[96:99], v[76:79], v[112:115]
    ds_read_b64_tr_b16 v[90:91], v48 offset:4352
    s_setprio 1
    s_add_u32 m0, s50, 67584
    s_nop 0
    buffer_load_dwordx4 v18, s[28:31], s49 offen lds
    v_mfma_f32_16x16x32_bf16 v[116:119], v[92:95], v[72:75], v[116:119]
    ds_read_b64_tr_b16 v[92:93], v48 offset:6144
    v_mfma_f32_16x16x32_bf16 v[116:119], v[96:99], v[80:83], v[116:119]
    ds_read_b64_tr_b16 v[94:95], v48 offset:6400
    s_add_u32 m0, s50, 68608
    s_nop 0
    buffer_load_dwordx4 v19, s[28:31], s49 offen lds
    s_add_u32 s49, s49, 128
    s_and_b32 s49, s49, 2047
    s_waitcnt lgkmcnt(4)
    v_mfma_f32_16x16x32_bf16 v[120:123], v[68:71], v[100:103], v[120:123]
    ds_read_b64_tr_b16 v[96:97], v47 offset:8192
    v_mfma_f32_16x16x32_bf16 v[120:123], v[76:79], v[84:87], v[120:123]
    ds_read_b64_tr_b16 v[98:99], v47 offset:8448
    v_mfma_f32_16x16x32_bf16 v[124:127], v[72:75], v[100:103], v[124:127]
    ds_read_b64_tr_b16 v[100:101], v47 offset:10240
    v_mfma_f32_16x16x32_bf16 v[124:127], v[80:83], v[84:87], v[124:127]
    ds_read_b64_tr_b16 v[102:103], v47 offset:10496
    s_setprio 0
    s_waitcnt lgkmcnt(4)
    v_mfma_f32_16x16x32_bf16 v[128:131], v[68:71], v[88:91], v[128:131]
    ds_read_b64_tr_b16 v[84:85], v48 offset:8192
    v_mfma_f32_16x16x32_bf16 v[128:131], v[76:79], v[92:95], v[128:131]
    ds_read_b64_tr_b16 v[86:87], v48 offset:8448
    v_mfma_f32_16x16x32_bf16 v[132:135], v[72:75], v[88:91], v[132:135]
    ds_read_b64_tr_b16 v[88:89], v48 offset:10240
    v_mfma_f32_16x16x32_bf16 v[132:135], v[80:83], v[92:95], v[132:135]
    ds_read_b64_tr_b16 v[90:91], v48 offset:10496
    s_waitcnt lgkmcnt(4)
    v_mfma_f32_16x16x32_bf16 v[136:139], v[96:99], v[68:71], v[136:139]
    s_waitcnt vmcnt(18)
    s_waitcnt vmcnt(14)
    s_waitcnt vmcnt(5)
    s_barrier
    ds_read_b128 v[52:55], v45 offset:0
    ds_read_b128 v[56:59], v45 offset:2048
    ds_read_b128 v[60:63], v46 offset:0
    ds_read_b128 v[64:67], v46 offset:2048
    ds_read_b64_tr_b16 v[92:93], v47 offset:12288
    v_mfma_f32_16x16x32_bf16 v[136:139], v[100:103], v[76:79], v[136:139]
    ds_read_b64_tr_b16 v[94:95], v47 offset:12544
    s_setprio 3
    s_add_u32 m0, s53, 49152
    s_nop 0
    buffer_load_dwordx4 v20, s[32:35], s52 offen lds
    v_mfma_f32_16x16x32_bf16 v[140:143], v[96:99], v[72:75], v[140:143]
    ds_read_b64_tr_b16 v[96:97], v47 offset:14336
    v_mfma_f32_16x16x32_bf16 v[140:143], v[100:103], v[80:83], v[140:143]
    ds_read_b64_tr_b16 v[98:99], v47 offset:14592
    s_add_u32 m0, s53, 53248
    s_nop 0
    buffer_load_dwordx4 v21, s[32:35], s52 offen lds
    s_add_u32 s51, s51, 1
    s_and_b32 s51, s51, 15
    s_mul_i32 s52, s51, 393216
    s_cmp_lg_u32 s24, 0
    s_cbranch_scc1 qa_kernel_SG0
    s_mov_b64 exec, 1
    buffer_atomic_add v239, v237, s[40:43], 0 offen
    s_mov_b64 exec, -1
qa_kernel_SG0:
    s_waitcnt lgkmcnt(8)
    v_mfma_f32_16x16x32_bf16 v[144:147], v[84:87], v[68:71], v[144:147]
    ds_read_b64_tr_b16 v[100:101], v48 offset:12288
    v_mfma_f32_16x16x32_bf16 v[144:147], v[88:91], v[76:79], v[144:147]
    ds_read_b64_tr_b16 v[102:103], v48 offset:12544
    v_mfma_f32_16x16x32_bf16 v[148:151], v[84:87], v[72:75], v[148:151]
    ds_read_b64_tr_b16 v[84:85], v48 offset:14336
    v_mfma_f32_16x16x32_bf16 v[148:151], v[88:91], v[80:83], v[148:151]
    ds_read_b64_tr_b16 v[86:87], v48 offset:14592
    s_setprio 2
    s_waitcnt lgkmcnt(4)
    v_mfma_f32_16x16x32_bf16 v[104:107], v[92:95], v[52:55], v[104:107]
    ds_read_b64_tr_b16 v[88:89], v47 offset:16384
    v_mfma_f32_16x16x32_bf16 v[104:107], v[96:99], v[60:63], v[104:107]
    ds_read_b64_tr_b16 v[90:91], v47 offset:16640
    s_add_u32 m0, s50, 0
    s_nop 0
    buffer_load_dwordx4 v16, s[28:31], s49 offen lds
    v_mfma_f32_16x16x32_bf16 v[108:111], v[92:95], v[56:59], v[108:111]
    ds_read_b64_tr_b16 v[92:93], v47 offset:18432
    v_mfma_f32_16x16x32_bf16 v[108:111], v[96:99], v[64:67], v[108:111]
    ds_read_b64_tr_b16 v[94:95], v47 offset:18688
    s_add_u32 m0, s50, 1024
    s_nop 0
    buffer_load_dwordx4 v17, s[28:31], s49 offen lds
    s_waitcnt lgkmcnt(4)
    v_mfma_f32_16x16x32_bf16 v[112:115], v[100:103], v[52:55], v[112:115]
    ds_read_b64_tr_b16 v[96:97], v48 offset:16384
    v_mfma_f32_16x16x32_bf16 v[112:115], v[84:87], v[60:63], v[112:115]
    ds_read_b64_tr_b16 v[98:99], v48 offset:16640
    s_setprio 1
    s_add_u32 m0, s50, 2048
    s_nop 0
    buffer_load_dwordx4 v18, s[28:31], s49 offen lds
    v_mfma_f32_16x16x32_bf16 v[116:119], v[100:103], v[56:59], v[116:119]
    ds_read_b64_tr_b16 v[100:101], v48 offset:18432
    v_mfma_f32_16x16x32_bf16 v[116:119], v[84:87], v[64:67], v[116:119]
    ds_read_b64_tr_b16 v[102:103], v48 offset:18688
    s_add_u32 m0, s50, 3072
    s_nop 0
    buffer_load_dwordx4 v19, s[28:31], s49 offen lds
    s_add_u32 s49, s49, 128
    s_and_b32 s49, s49, 2047
    s_waitcnt lgkmcnt(4)
    v_mfma_f32_16x16x32_bf16 v[120:123], v[52:55], v[88:91], v[120:123]
    ds_read_b64_tr_b16 v[84:85], v47 offset:20480
    v_mfma_f32_16x16x32_bf16 v[120:123], v[60:63], v[92:95], v[120:123]
    ds_read_b64_tr_b16 v[86:87], v47 offset:20736
    v_mfma_f32_16x16x32_bf16 v[124:127], v[56:59], v[88:91], v[124:127]
    ds_read_b64_tr_b16 v[88:89], v47 offset:22528
    v_mfma_f32_16x16x32_bf16 v[124:127], v[64:67], v[92:95], v[124:127]
    ds_read_b64_tr_b16 v[90:91], v47 offset:22784
    s_setprio 0
    s_waitcnt lgkmcnt(4)
    v_mfma_f32_16x16x32_bf16 v[128:131], v[52:55], v[96:99], v[128:131]
    ds_read_b64_tr_b16 v[92:93], v48 offset:20480
    v_mfma_f32_16x16x32_bf16 v[128:131], v[60:63], v[100:103], v[128:131]
    ds_read_b64_tr_b16 v[94:95], v48 offset:20736
    v_mfma_f32_16x16x32_bf16 v[132:135], v[56:59], v[96:99], v[132:135]
    ds_read_b64_tr_b16 v[96:97], v48 offset:22528
    v_mfma_f32_16x16x32_bf16 v[132:135], v[64:67], v[100:103], v[132:135]
    ds_read_b64_tr_b16 v[98:99], v48 offset:22784
    s_waitcnt lgkmcnt(4)
    v_mfma_f32_16x16x32_bf16 v[136:139], v[84:87], v[52:55], v[136:139]
    s_barrier
    ds_read_b128 v[68:71], v45 offset:32768
    ds_read_b128 v[72:75], v45 offset:34816
    ds_read_b128 v[76:79], v46 offset:32768
    ds_read_b128 v[80:83], v46 offset:34816
    ds_read_b64_tr_b16 v[100:101], v47 offset:24576
    v_mfma_f32_16x16x32_bf16 v[136:139], v[88:91], v[60:63], v[136:139]
    ds_read_b64_tr_b16 v[102:103], v47 offset:24832
    s_setprio 3
    s_add_u32 m0, s53, 0
    s_nop 0
    buffer_load_dwordx4 v20, s[32:35], s52 offen lds
    v_mfma_f32_16x16x32_bf16 v[140:143], v[84:87], v[56:59], v[140:143]
    ds_read_b64_tr_b16 v[84:85], v47 offset:26624
    v_mfma_f32_16x16x32_bf16 v[140:143], v[88:91], v[64:67], v[140:143]
    ds_read_b64_tr_b16 v[86:87], v47 offset:26880
    s_add_u32 m0, s53, 4096
    s_nop 0
    buffer_load_dwordx4 v21, s[32:35], s52 offen lds
    s_add_u32 s51, s51, 1
    s_and_b32 s51, s51, 15
    s_mul_i32 s52, s51, 393216
    s_waitcnt lgkmcnt(8)
    v_mfma_f32_16x16x32_bf16 v[144:147], v[92:95], v[52:55], v[144:147]
    ds_read_b64_tr_b16 v[88:89], v48 offset:24576
    v_mfma_f32_16x16x32_bf16 v[144:147], v[96:99], v[60:63], v[144:147]
    ds_read_b64_tr_b16 v[90:91], v48 offset:24832
    v_mfma_f32_16x16x32_bf16 v[148:151], v[92:95], v[56:59], v[148:151]
    ds_read_b64_tr_b16 v[92:93], v48 offset:26624
    v_mfma_f32_16x16x32_bf16 v[148:151], v[96:99], v[64:67], v[148:151]
    ds_read_b64_tr_b16 v[94:95], v48 offset:26880
    s_setprio 2
    s_waitcnt lgkmcnt(4)
    v_mfma_f32_16x16x32_bf16 v[104:107], v[100:103], v[68:71], v[104:107]
    ds_read_b64_tr_b16 v[96:97], v47 offset:28672
    v_mfma_f32_16x16x32_bf16 v[104:107], v[84:87], v[76:79], v[104:107]
    ds_read_b64_tr_b16 v[98:99], v47 offset:28928
    s_add_u32 m0, s50, 32768
    s_nop 0
    buffer_load_dwordx4 v16, s[28:31], s49 offen lds
    v_mfma_f32_16x16x32_bf16 v[108:111], v[100:103], v[72:75], v[108:111]
    ds_read_b64_tr_b16 v[100:101], v47 offset:30720
    v_mfma_f32_16x16x32_bf16 v[108:111], v[84:87], v[80:83], v[108:111]
    ds_read_b64_tr_b16 v[102:103], v47 offset:30976
    s_add_u32 m0, s50, 33792
    s_nop 0
    buffer_load_dwordx4 v17, s[28:31], s49 offen lds
    s_waitcnt lgkmcnt(4)
    v_mfma_f32_16x16x32_bf16 v[112:115], v[88:91], v[68:71], v[112:115]
    ds_read_b64_tr_b16 v[84:85], v48 offset:28672
    v_mfma_f32_16x16x32_bf16 v[112:115], v[92:95], v[76:79], v[112:115]
    ds_read_b64_tr_b16 v[86:87], v48 offset:28928
    s_setprio 1
    s_add_u32 m0, s50, 34816
    s_nop 0
    buffer_load_dwordx4 v18, s[28:31], s49 offen lds
    v_mfma_f32_16x16x32_bf16 v[116:119], v[88:91], v[72:75], v[116:119]
    ds_read_b64_tr_b16 v[88:89], v48 offset:30720
    v_mfma_f32_16x16x32_bf16 v[116:119], v[92:95], v[80:83], v[116:119]
    ds_read_b64_tr_b16 v[90:91], v48 offset:30976
    s_add_u32 m0, s50, 35840
    s_nop 0
    buffer_load_dwordx4 v19, s[28:31], s49 offen lds
    s_add_u32 s49, s49, 128
    s_and_b32 s49, s49, 2047
    s_waitcnt lgkmcnt(4)
    v_mfma_f32_16x16x32_bf16 v[120:123], v[68:71], v[96:99], v[120:123]
    ds_read_b64_tr_b16 v[92:93], v47 offset:32768
    v_mfma_f32_16x16x32_bf16 v[120:123], v[76:79], v[100:103], v[120:123]
    ds_read_b64_tr_b16 v[94:95], v47 offset:33024
    v_mfma_f32_16x16x32_bf16 v[124:127], v[72:75], v[96:99], v[124:127]
    ds_read_b64_tr_b16 v[96:97], v47 offset:34816
    v_mfma_f32_16x16x32_bf16 v[124:127], v[80:83], v[100:103], v[124:127]
    ds_read_b64_tr_b16 v[98:99], v47 offset:35072
    s_setprio 0
    s_waitcnt lgkmcnt(4)
    v_mfma_f32_16x16x32_bf16 v[128:131], v[68:71], v[84:87], v[128:131]
    ds_read_b64_tr_b16 v[100:101], v48 offset:32768
    v_mfma_f32_16x16x32_bf16 v[128:131], v[76:79], v[88:91], v[128:131]
    ds_read_b64_tr_b16 v[102:103], v48 offset:33024
    v_mfma_f32_16x16x32_bf16 v[132:135], v[72:75], v[84:87], v[132:135]
    ds_read_b64_tr_b16 v[84:85], v48 offset:34816
    v_mfma_f32_16x16x32_bf16 v[132:135], v[80:83], v[88:91], v[132:135]
    ds_read_b64_tr_b16 v[86:87], v48 offset:35072
    s_waitcnt lgkmcnt(4)
    v_mfma_f32_16x16x32_bf16 v[136:139], v[92:95], v[68:71], v[136:139]
    s_waitcnt vmcnt(16)
    s_waitcnt vmcnt(12)
    s_barrier
    ds_read_b128 v[52:55], v49 offset:0
    ds_read_b128 v[56:59], v49 offset:2048
    ds_read_b128 v[60:63], v50 offset:0
    ds_read_b128 v[64:67], v50 offset:2048
    ds_read_b64_tr_b16 v[88:89], v47 offset:36864
    v_mfma_f32_16x16x32_bf16 v[136:139], v[96:99], v[76:79], v[136:139]
    ds_read_b64_tr_b16 v[90:91], v47 offset:37120
    s_setprio 3
    s_add_u32 m0, s53, 12288
    s_nop 0
    buffer_load_dwordx4 v20, s[32:35], s52 offen lds
    v_mfma_f32_16x16x32_bf16 v[140:143], v[92:95], v[72:75], v[140:143]
    ds_read_b64_tr_b16 v[92:93], v47 offset:38912
    v_mfma_f32_16x16x32_bf16 v[140:143], v[96:99], v[80:83], v[140:143]
    ds_read_b64_tr_b16 v[94:95], v47 offset:39168
    s_add_u32 m0, s53, 16384
    s_nop 0
    buffer_load_dwordx4 v21, s[32:35], s52 offen lds
    s_add_u32 s51, s51, 1
    s_and_b32 s51, s51, 15
    s_mul_i32 s52, s51, 393216
    s_waitcnt lgkmcnt(8)
    v_mfma_f32_16x16x32_bf16 v[144:147], v[100:103], v[68:71], v[144:147]
    ds_read_b64_tr_b16 v[96:97], v48 offset:36864
    v_mfma_f32_16x16x32_bf16 v[144:147], v[84:87], v[76:79], v[144:147]
    ds_read_b64_tr_b16 v[98:99], v48 offset:37120
    v_mfma_f32_16x16x32_bf16 v[148:151], v[100:103], v[72:75], v[148:151]
    ds_read_b64_tr_b16 v[100:101], v48 offset:38912
    v_mfma_f32_16x16x32_bf16 v[148:151], v[84:87], v[80:83], v[148:151]
    ds_read_b64_tr_b16 v[102:103], v48 offset:39168
    s_setprio 2
    s_waitcnt lgkmcnt(4)
    v_mfma_f32_16x16x32_bf16 v[104:107], v[88:91], v[52:55], v[104:107]
    ds_read_b64_tr_b16 v[84:85], v47 offset:40960
    v_mfma_f32_16x16x32_bf16 v[104:107], v[92:95], v[60:63], v[104:107]
    ds_read_b64_tr_b16 v[86:87], v47 offset:41216
    s_add_u32 m0, s50, 65536
    s_nop 0
    buffer_load_dwordx4 v16, s[28:31], s49 offen lds
    v_mfma_f32_16x16x32_bf16 v[108:111], v[88:91], v[56:59], v[108:111]
    ds_read_b64_tr_b16 v[88:89], v47 offset:43008
    v_mfma_f32_16x16x32_bf16 v[108:111], v[92:95], v[64:67], v[108:111]
    ds_read_b64_tr_b16 v[90:91], v47 offset:43264
    s_add_u32 m0, s50, 66560
    s_nop 0
    buffer_load_dwordx4 v17, s[28:31], s49 offen lds
    s_waitcnt lgkmcnt(4)
    v_mfma_f32_16x16x32_bf16 v[112:115], v[96:99], v[52:55], v[112:115]
    ds_read_b64_tr_b16 v[92:93], v48 offset:40960
    v_mfma_f32_16x16x32_bf16 v[112:115], v[100:103], v[60:63], v[112:115]
    ds_read_b64_tr_b16 v[94:95], v48 offset:41216
    s_setprio 1
    s_add_u32 m0, s50, 67584
    s_nop 0
    buffer_load_dwordx4 v18, s[28:31], s49 offen lds
    v_mfma_f32_16x16x32_bf16 v[116:119], v[96:99], v[56:59], v[116:119]
    ds_read_b64_tr_b16 v[96:97], v48 offset:43008
    v_mfma_f32_16x16x32_bf16 v[116:119], v[100:103], v[64:67], v[116:119]
    ds_read_b64_tr_b16 v[98:99], v48 offset:43264
    s_add_u32 m0, s50, 68608
    s_nop 0
    buffer_load_dwordx4 v19, s[28:31], s49 offen lds
    s_add_u32 s49, s49, 128
    s_and_b32 s49, s49, 2047
    s_waitcnt lgkmcnt(4)
    v_mfma_f32_16x16x32_bf16 v[120:123], v[52:55], v[84:87], v[120:123]
    ds_read_b64_tr_b16 v[100:101], v47 offset:45056
    v_mfma_f32_16x16x32_bf16 v[120:123], v[60:63], v[88:91], v[120:123]
    ds_read_b64_tr_b16 v[102:103], v47 offset:45312
    v_mfma_f32_16x16x32_bf16 v[124:127], v[56:59], v[84:87], v[124:127]
    ds_read_b64_tr_b16 v[84:85], v47 offset:47104
    v_mfma_f32_16x16x32_bf16 v[124:127], v[64:67], v[88:91], v[124:127]
    ds_read_b64_tr_b16 v[86:87], v47 offset:47360
    s_setprio 0
    s_waitcnt lgkmcnt(4)
    v_mfma_f32_16x16x32_bf16 v[128:131], v[52:55], v[92:95], v[128:131]
    ds_read_b64_tr_b16 v[88:89], v48 offset:45056
    v_mfma_f32_16x16x32_bf16 v[128:131], v[60:63], v[96:99], v[128:131]
    ds_read_b64_tr_b16 v[90:91], v48 offset:45312
    v_mfma_f32_16x16x32_bf16 v[132:135], v[56:59], v[92:95], v[132:135]
    ds_read_b64_tr_b16 v[92:93], v48 offset:47104
    v_mfma_f32_16x16x32_bf16 v[132:135], v[64:67], v[96:99], v[132:135]
    ds_read_b64_tr_b16 v[94:95], v48 offset:47360
    s_waitcnt lgkmcnt(4)
    v_mfma_f32_16x16x32_bf16 v[136:139], v[100:103], v[52:55], v[136:139]
    s_waitcnt vmcnt(16)
    s_waitcnt vmcnt(12)
    s_barrier
    ds_read_b128 v[68:71], v45 offset:0
    ds_read_b128 v[72:75], v45 offset:2048
    ds_read_b128 v[76:79], v46 offset:0
    ds_read_b128 v[80:83], v46 offset:2048
    ds_read_b64_tr_b16 v[96:97], v47 offset:49152
qa_kernel_WS0_1:
    s_cbranch_execz qa_kernel_WS0_9
    v_mfma_f32_16x16x32_bf16 v[136:139], v[84:87], v[60:63], v[136:139]
    ds_read_b64_tr_b16 v[98:99], v47 offset:49408
    s_setprio 3
    s_add_u32 m0, s53, 24576
    s_nop 0
    buffer_load_dwordx4 v20, s[32:35], s52 offen lds
    v_mfma_f32_16x16x32_bf16 v[140:143], v[100:103], v[56:59], v[140:143]
    ds_read_b64_tr_b16 v[100:101], v47 offset:51200
    v_mfma_f32_16x16x32_bf16 v[140:143], v[84:87], v[64:67], v[140:143]
    ds_read_b64_tr_b16 v[102:103], v47 offset:51456
    s_add_u32 m0, s53, 28672
    s_nop 0
    buffer_load_dwordx4 v21, s[32:35], s52 offen lds
    s_add_u32 s51, s51, 1
    s_and_b32 s51, s51, 15
    s_mul_i32 s52, s51, 393216
    s_waitcnt lgkmcnt(8)
    v_mfma_f32_16x16x32_bf16 v[144:147], v[88:91], v[52:55], v[144:147]
    ds_read_b64_tr_b16 v[84:85], v48 offset:49152
    v_mfma_f32_16x16x32_bf16 v[144:147], v[92:95], v[60:63], v[144:147]
    ds_read_b64_tr_b16 v[86:87], v48 offset:49408
    v_mfma_f32_16x16x32_bf16 v[148:151], v[88:91], v[56:59], v[148:151]
    ds_read_b64_tr_b16 v[88:89], v48 offset:51200
    v_mfma_f32_16x16x32_bf16 v[148:151], v[92:95], v[64:67], v[148:151]
    ds_read_b64_tr_b16 v[90:91], v48 offset:51456
    s_setprio 2
    s_waitcnt lgkmcnt(4)
    v_mfma_f32_16x16x32_bf16 v[104:107], v[96:99], v[68:71], v[104:107]
    ds_read_b64_tr_b16 v[92:93], v47 offset:53248
    v_mfma_f32_16x16x32_bf16 v[104:107], v[100:103], v[76:79], v[104:107]
    ds_read_b64_tr_b16 v[94:95], v47 offset:53504
    s_add_u32 m0, s50, 0
    s_nop 0
    buffer_load_dwordx4 v16, s[28:31], s49 offen lds
    v_mfma_f32_16x16x32_bf16 v[108:111], v[96:99], v[72:75], v[108:111]
    ds_read_b64_tr_b16 v[96:97], v47 offset:55296
    v_mfma_f32_16x16x32_bf16 v[108:111], v[100:103], v[80:83], v[108:111]
    ds_read_b64_tr_b16 v[98:99], v47 offset:55552
    s_add_u32 m0, s50, 1024
    s_nop 0
    buffer_load_dwordx4 v17, s[28:31], s49 offen lds
    s_waitcnt lgkmcnt(4)
    v_mfma_f32_16x16x32_bf16 v[112:115], v[84:87], v[68:71], v[112:115]
    ds_read_b64_tr_b16 v[100:101], v48 offset:53248
    v_mfma_f32_16x16x32_bf16 v[112:115], v[88:91], v[76:79], v[112:115]
    ds_read_b64_tr_b16 v[102:103], v48 offset:53504
    s_setprio 1
    s_add_u32 m0, s50, 2048
    s_nop 0
    buffer_load_dwordx4 v18, s[28:31], s49 offen lds
    v_mfma_f32_16x16x32_bf16 v[116:119], v[84:87], v[72:75], v[116:119]
    ds_read_b64_tr_b16 v[84:85], v48 offset:55296
    v_mfma_f32_16x16x32_bf16 v[116:119], v[88:91], v[80:83], v[116:119]
    ds_read_b64_tr_b16 v[86:87], v48 offset:55552
    s_add_u32 m0, s50, 3072
    s_nop 0
    buffer_load_dwordx4 v19, s[28:31], s49 offen lds
    s_add_u32 s49, s49, 128
    s_and_b32 s49, s49, 2047
    s_waitcnt lgkmcnt(4)
    v_mfma_f32_16x16x32_bf16 v[120:123], v[68:71], v[92:95], v[120:123]
    ds_read_b64_tr_b16 v[88:89], v47 offset:57344
    v_mfma_f32_16x16x32_bf16 v[120:123], v[76:79], v[96:99], v[120:123]
    ds_read_b64_tr_b16 v[90:91], v47 offset:57600
    v_mfma_f32_16x16x32_bf16 v[124:127], v[72:75], v[92:95], v[124:127]
    ds_read_b64_tr_b16 v[92:93], v47 offset:59392
    v_mfma_f32_16x16x32_bf16 v[124:127], v[80:83], v[96:99], v[124:127]
    ds_read_b64_tr_b16 v[94:95], v47 offset:59648
    s_setprio 0
    s_waitcnt lgkmcnt(4)
    v_mfma_f32_16x16x32_bf16 v[128:131], v[68:71], v[100:103], v[128:131]
    ds_read_b64_tr_b16 v[96:97], v48 offset:57344
    v_mfma_f32_16x16x32_bf16 v[128:131], v[76:79], v[84:87], v[128:131]
    ds_read_b64_tr_b16 v[98:99], v48 offset:57600
    v_mfma_f32_16x16x32_bf16 v[132:135], v[72:75], v[100:103], v[132:135]
    ds_read_b64_tr_b16 v[100:101], v48 offset:59392
    v_mfma_f32_16x16x32_bf16 v[132:135], v[80:83], v[84:87], v[132:135]
    ds_read_b64_tr_b16 v[102:103], v48 offset:59648
    s_waitcnt lgkmcnt(4)
    v_mfma_f32_16x16x32_bf16 v[136:139], v[88:91], v[68:71], v[136:139]
    s_waitcnt vmcnt(16)
    s_waitcnt vmcnt(12)
    s_barrier
    ds_read_b128 v[52:55], v45 offset:32768
    ds_read_b128 v[56:59], v45 offset:34816
    ds_read_b128 v[60:63], v46 offset:32768
    ds_read_b128 v[64:67], v46 offset:34816
    ds_read_b64_tr_b16 v[84:85], v47 offset:0
    v_mfma_f32_16x16x32_bf16 v[136:139], v[92:95], v[76:79], v[136:139]
    ds_read_b64_tr_b16 v[86:87], v47 offset:256
    s_setprio 3
    s_add_u32 m0, s53, 36864
    s_nop 0
    buffer_load_dwordx4 v20, s[32:35], s52 offen lds
    s_mov_b64 exec, s[76:77]
    buffer_load_dword v29, v238, s[40:43], 0 offen sc1
    s_mov_b64 exec, -1
    v_mfma_f32_16x16x32_bf16 v[140:143], v[88:91], v[72:75], v[140:143]
    ds_read_b64_tr_b16 v[88:89], v47 offset:2048
    v_mfma_f32_16x16x32_bf16 v[140:143], v[92:95], v[80:83], v[140:143]
    ds_read_b64_tr_b16 v[90:91], v47 offset:2304
    s_add_u32 m0, s53, 40960
    s_nop 0
    buffer_load_dwordx4 v21, s[32:35], s52 offen lds
    s_add_u32 s51, s51, 1
    s_and_b32 s51, s51, 15
    s_mul_i32 s52, s51, 393216
    s_waitcnt lgkmcnt(8)
    v_mfma_f32_16x16x32_bf16 v[144:147], v[96:99], v[68:71], v[144:147]
    ds_read_b64_tr_b16 v[92:93], v48 offset:0
    v_mfma_f32_16x16x32_bf16 v[144:147], v[100:103], v[76:79], v[144:147]
    ds_read_b64_tr_b16 v[94:95], v48 offset:256
    v_mfma_f32_16x16x32_bf16 v[148:151], v[96:99], v[72:75], v[148:151]
    ds_read_b64_tr_b16 v[96:97], v48 offset:2048
    v_mfma_f32_16x16x32_bf16 v[148:151], v[100:103], v[80:83], v[148:151]
    ds_read_b64_tr_b16 v[98:99], v48 offset:2304
    s_setprio 2
    s_waitcnt lgkmcnt(4)
    v_mfma_f32_16x16x32_bf16 v[104:107], v[84:87], v[52:55], v[104:107]
    ds_read_b64_tr_b16 v[100:101], v47 offset:4096
    v_mfma_f32_16x16x32_bf16 v[104:107], v[88:91], v[60:63], v[104:107]
    ds_read_b64_tr_b16 v[102:103], v47 offset:4352
    s_add_u32 m0, s50, 32768
    s_nop 0
    buffer_load_dwordx4 v16, s[28:31], s49 offen lds
    v_mfma_f32_16x16x32_bf16 v[108:111], v[84:87], v[56:59], v[108:111]
    ds_read_b64_tr_b16 v[84:85], v47 offset:6144
    v_mfma_f32_16x16x32_bf16 v[108:111], v[88:91], v[64:67], v[108:111]
    ds_read_b64_tr_b16 v[86:87], v47 offset:6400
    s_add_u32 m0, s50, 33792
    s_nop 0
    buffer_load_dwordx4 v17, s[28:31], s49 offen lds
    s_waitcnt lgkmcnt(4)
    v_mfma_f32_16x16x32_bf16 v[112:115], v[92:95], v[52:55], v[112:115]
    ds_read_b64_tr_b16 v[88:89], v48 offset:4096
    v_mfma_f32_16x16x32_bf16 v[112:115], v[96:99], v[60:63], v[112:115]
    ds_read_b64_tr_b16 v[90:91], v48 offset:4352
    s_setprio 1
    s_add_u32 m0, s50, 34816
    s_nop 0
    buffer_load_dwordx4 v18, s[28:31], s49 offen lds
    v_mfma_f32_16x16x32_bf16 v[116:119], v[92:95], v[56:59], v[116:119]
    ds_read_b64_tr_b16 v[92:93], v48 offset:6144
    v_mfma_f32_16x16x32_bf16 v[116:119], v[96:99], v[64:67], v[116:119]
    ds_read_b64_tr_b16 v[94:95], v48 offset:6400
    s_add_u32 m0, s50, 35840
    s_nop 0
    buffer_load_dwordx4 v19, s[28:31], s49 offen lds
    s_add_u32 s49, s49, 128
    s_and_b32 s49, s49, 2047
    s_waitcnt lgkmcnt(4)
    v_mfma_f32_16x16x32_bf16 v[120:123], v[52:55], v[100:103], v[120:123]
    ds_read_b64_tr_b16 v[96:97], v47 offset:8192
    v_mfma_f32_16x16x32_bf16 v[120:123], v[60:63], v[84:87], v[120:123]
    ds_read_b64_tr_b16 v[98:99], v47 offset:8448
    v_mfma_f32_16x16x32_bf16 v[124:127], v[56:59], v[100:103], v[124:127]
    ds_read_b64_tr_b16 v[100:101], v47 offset:10240
    v_mfma_f32_16x16x32_bf16 v[124:127], v[64:67], v[84:87], v[124:127]
    ds_read_b64_tr_b16 v[102:103], v47 offset:10496
    s_setprio 0
    s_waitcnt lgkmcnt(4)
    v_mfma_f32_16x16x32_bf16 v[128:131], v[52:55], v[88:91], v[128:131]
    ds_read_b64_tr_b16 v[84:85], v48 offset:8192
    v_mfma_f32_16x16x32_bf16 v[128:131], v[60:63], v[92:95], v[128:131]
    ds_read_b64_tr_b16 v[86:87], v48 offset:8448
    v_mfma_f32_16x16x32_bf16 v[132:135], v[56:59], v[88:91], v[132:135]
    ds_read_b64_tr_b16 v[88:89], v48 offset:10240
    v_mfma_f32_16x16x32_bf16 v[132:135], v[64:67], v[92:95], v[132:135]
    ds_read_b64_tr_b16 v[90:91], v48 offset:10496
    s_waitcnt lgkmcnt(4)
    v_mfma_f32_16x16x32_bf16 v[136:139], v[96:99], v[52:55], v[136:139]
    s_waitcnt vmcnt(17)
    s_waitcnt vmcnt(13)
    s_barrier
    ds_read_b128 v[68:71], v49 offset:0
    ds_read_b128 v[72:75], v49 offset:2048
    ds_read_b128 v[76:79], v50 offset:0
    ds_read_b128 v[80:83], v50 offset:2048
    ds_read_b64_tr_b16 v[92:93], v47 offset:12288
    v_mfma_f32_16x16x32_bf16 v[136:139], v[100:103], v[60:63], v[136:139]
    ds_read_b64_tr_b16 v[94:95], v47 offset:12544
    s_setprio 3
    s_add_u32 m0, s53, 49152
    s_nop 0
    buffer_load_dwordx4 v20, s[32:35], s52 offen lds
    v_mfma_f32_16x16x32_bf16 v[140:143], v[96:99], v[56:59], v[140:143]
    ds_read_b64_tr_b16 v[96:97], v47 offset:14336
    v_mfma_f32_16x16x32_bf16 v[140:143], v[100:103], v[64:67], v[140:143]
    ds_read_b64_tr_b16 v[98:99], v47 offset:14592
    s_add_u32 m0, s53, 53248
    s_nop 0
    buffer_load_dwordx4 v21, s[32:35], s52 offen lds
    s_add_u32 s51, s51, 1
    s_and_b32 s51, s51, 15
    s_mul_i32 s52, s51, 393216
    s_waitcnt lgkmcnt(8)
    v_mfma_f32_16x16x32_bf16 v[144:147], v[84:87], v[52:55], v[144:147]
    ds_read_b64_tr_b16 v[100:101], v48 offset:12288
    v_mfma_f32_16x16x32_bf16 v[144:147], v[88:91], v[60:63], v[144:147]
    ds_read_b64_tr_b16 v[102:103], v48 offset:12544
    v_mfma_f32_16x16x32_bf16 v[148:151], v[84:87], v[56:59], v[148:151]
    ds_read_b64_tr_b16 v[84:85], v48 offset:14336
    v_mfma_f32_16x16x32_bf16 v[148:151], v[88:91], v[64:67], v[148:151]
    ds_read_b64_tr_b16 v[86:87], v48 offset:14592
    s_setprio 2
    s_waitcnt lgkmcnt(4)
    v_mfma_f32_16x16x32_bf16 v[104:107], v[92:95], v[68:71], v[104:107]
    ds_read_b64_tr_b16 v[88:89], v47 offset:16384
    v_mfma_f32_16x16x32_bf16 v[104:107], v[96:99], v[76:79], v[104:107]
    ds_read_b64_tr_b16 v[90:91], v47 offset:16640
    s_add_u32 m0, s50, 65536
    s_nop 0
    buffer_load_dwordx4 v16, s[28:31], s49 offen lds
    v_mfma_f32_16x16x32_bf16 v[108:111], v[92:95], v[72:75], v[108:111]
    ds_read_b64_tr_b16 v[92:93], v47 offset:18432
    v_mfma_f32_16x16x32_bf16 v[108:111], v[96:99], v[80:83], v[108:111]
    ds_read_b64_tr_b16 v[94:95], v47 offset:18688
    s_add_u32 m0, s50, 66560
    s_nop 0
    buffer_load_dwordx4 v17, s[28:31], s49 offen lds
    s_waitcnt lgkmcnt(4)
    v_mfma_f32_16x16x32_bf16 v[112:115], v[100:103], v[68:71], v[112:115]
    ds_read_b64_tr_b16 v[96:97], v48 offset:16384
    v_mfma_f32_16x16x32_bf16 v[112:115], v[84:87], v[76:79], v[112:115]
    ds_read_b64_tr_b16 v[98:99], v48 offset:16640
    s_setprio 1
    s_add_u32 m0, s50, 67584
    s_nop 0
    buffer_load_dwordx4 v18, s[28:31], s49 offen lds
    v_mfma_f32_16x16x32_bf16 v[116:119], v[100:103], v[72:75], v[116:119]
    ds_read_b64_tr_b16 v[100:101], v48 offset:18432
    v_mfma_f32_16x16x32_bf16 v[116:119], v[84:87], v[80:83], v[116:119]
    ds_read_b64_tr_b16 v[102:103], v48 offset:18688
    s_add_u32 m0, s50, 68608
    s_nop 0
    buffer_load_dwordx4 v19, s[28:31], s49 offen lds
    s_add_u32 s49, s49, 128
    s_and_b32 s49, s49, 2047
    s_waitcnt lgkmcnt(4)
    v_mfma_f32_16x16x32_bf16 v[120:123], v[68:71], v[88:91], v[120:123]
    ds_read_b64_tr_b16 v[84:85], v47 offset:20480
    v_mfma_f32_16x16x32_bf16 v[120:123], v[76:79], v[92:95], v[120:123]
    ds_read_b64_tr_b16 v[86:87], v47 offset:20736
    v_mfma_f32_16x16x32_bf16 v[124:127], v[72:75], v[88:91], v[124:127]
    ds_read_b64_tr_b16 v[88:89], v47 offset:22528
    v_mfma_f32_16x16x32_bf16 v[124:127], v[80:83], v[92:95], v[124:127]
    ds_read_b64_tr_b16 v[90:91], v47 offset:22784
    s_setprio 0
    s_waitcnt lgkmcnt(4)
    v_mfma_f32_16x16x32_bf16 v[128:131], v[68:71], v[96:99], v[128:131]
    ds_read_b64_tr_b16 v[92:93], v48 offset:20480
    v_mfma_f32_16x16x32_bf16 v[128:131], v[76:79], v[100:103], v[128:131]
    ds_read_b64_tr_b16 v[94:95], v48 offset:20736
    v_mfma_f32_16x16x32_bf16 v[132:135], v[72:75], v[96:99], v[132:135]
    ds_read_b64_tr_b16 v[96:97], v48 offset:22528
    v_mfma_f32_16x16x32_bf16 v[132:135], v[80:83], v[100:103], v[132:135]
    ds_read_b64_tr_b16 v[98:99], v48 offset:22784
    s_waitcnt vmcnt(11)
    s_mov_b64 exec, s[76:77]
    s_mov_b32 s62, 262144
    s_branch qa_kernel_PC1_E
qa_kernel_PC1:
    buffer_load_dword v29, v238, s[40:43], 0 offen sc1
    s_waitcnt vmcnt(0)
qa_kernel_PC1_E:
    v_cmp_gt_u32 vcc, 32, v29
    s_sub_u32 s62, s62, 1
    s_cselect_b64 vcc, 0, vcc
    s_cbranch_vccnz qa_kernel_PC1
    s_mov_b64 exec, -1
    s_waitcnt lgkmcnt(4)
    v_mfma_f32_16x16x32_bf16 v[136:139], v[84:87], v[68:71], v[136:139]
    s_barrier
    ds_read_b128 v[52:55], v45 offset:0
    ds_read_b128 v[56:59], v45 offset:2048
    ds_read_b128 v[60:63], v46 offset:0
    ds_read_b128 v[64:67], v46 offset:2048
    ds_read_b64_tr_b16 v[100:101], v47 offset:24576
    v_mfma_f32_16x16x32_bf16 v[136:139], v[88:91], v[76:79], v[136:139]
    ds_read_b64_tr_b16 v[102:103], v47 offset:24832
    s_setprio 3
    s_add_u32 m0, s53, 0
    s_nop 0
    buffer_load_dwordx4 v20, s[32:35], s52 offen lds
    v_mfma_f32_16x16x32_bf16 v[140:143], v[84:87], v[72:75], v[140:143]
    ds_read_b64_tr_b16 v[84:85], v47 offset:26624
    v_mfma_f32_16x16x32_bf16 v[140:143], v[88:91], v[80:83], v[140:143]
    ds_read_b64_tr_b16 v[86:87], v47 offset:26880
    s_add_u32 m0, s53, 4096
    s_nop 0
    buffer_load_dwordx4 v21, s[32:35], s52 offen lds
    s_add_u32 s51, s51, 1
    s_and_b32 s51, s51, 15
    s_mul_i32 s52, s51, 393216
    s_waitcnt lgkmcnt(8)
    v_mfma_f32_16x16x32_bf16 v[144:147], v[92:95], v[68:71], v[144:147]
    ds_read_b64_tr_b16 v[88:89], v48 offset:24576
    v_mfma_f32_16x16x32_bf16 v[144:147], v[96:99], v[76:79], v[144:147]
    ds_read_b64_tr_b16 v[90:91], v48 offset:24832
    v_mfma_f32_16x16x32_bf16 v[148:151], v[92:95], v[72:75], v[148:151]
    ds_read_b64_tr_b16 v[92:93], v48 offset:26624
    v_mfma_f32_16x16x32_bf16 v[148:151], v[96:99], v[80:83], v[148:151]
    ds_read_b64_tr_b16 v[94:95], v48 offset:26880
    s_setprio 2
    s_waitcnt lgkmcnt(4)
    v_mfma_f32_16x16x32_bf16 v[104:107], v[100:103], v[52:55], v[104:107]
    ds_read_b64_tr_b16 v[96:97], v47 offset:28672
    v_mfma_f32_16x16x32_bf16 v[104:107], v[84:87], v[60:63], v[104:107]
    ds_read_b64_tr_b16 v[98:99], v47 offset:28928
    s_add_u32 m0, s50, 0
    s_nop 0
    buffer_load_dwordx4 v16, s[28:31], s49 offen lds
    v_mfma_f32_16x16x32_bf16 v[108:111], v[100:103], v[56:59], v[108:111]
    ds_read_b64_tr_b16 v[100:101], v47 offset:30720
    v_mfma_f32_16x16x32_bf16 v[108:111], v[84:87], v[64:67], v[108:111]
    ds_read_b64_tr_b16 v[102:103], v47 offset:30976
    s_add_u32 m0, s50, 1024
    s_nop 0
    buffer_load_dwordx4 v17, s[28:31], s49 offen lds
    s_waitcnt lgkmcnt(4)
    v_mfma_f32_16x16x32_bf16 v[112:115], v[88:91], v[52:55], v[112:115]
    ds_read_b64_tr_b16 v[84:85], v48 offset:28672
    v_mfma_f32_16x16x32_bf16 v[112:115], v[92:95], v[60:63], v[112:115]
    ds_read_b64_tr_b16 v[86:87], v48 offset:28928
    s_setprio 1
    s_add_u32 m0, s50, 2048
    s_nop 0
    buffer_load_dwordx4 v18, s[28:31], s49 offen lds
    s_mul_i32 s78, s44, 6144
    s_add_u32 s78, s78, 65536
    buffer_load_dwordx4 v[156:159], v174, s[36:39], s78 offen sc1
    s_mul_i32 s78, s24, 48
    v_add_u32 v172, s78, v178
    v_mfma_f32_16x16x32_bf16 v[116:119], v[88:91], v[56:59], v[116:119]
    ds_read_b64_tr_b16 v[88:89], v48 offset:30720
    v_mfma_f32_16x16x32_bf16 v[116:119], v[92:95], v[64:67], v[116:119]
    ds_read_b64_tr_b16 v[90:91], v48 offset:30976
    s_add_u32 m0, s50, 3072
    s_nop 0
    buffer_load_dwordx4 v19, s[28:31], s49 offen lds
    s_add_u32 s49, s49, 128
    s_and_b32 s49, s49, 2047
    s_waitcnt lgkmcnt(4)
    v_mfma_f32_16x16x32_bf16 v[120:123], v[52:55], v[96:99], v[120:123]
    ds_read_b64_tr_b16 v[92:93], v47 offset:32768
    v_mfma_f32_16x16x32_bf16 v[120:123], v[60:63], v[100:103], v[120:123]
    ds_read_b64_tr_b16 v[94:95], v47 offset:33024
    v_mfma_f32_16x16x32_bf16 v[124:127], v[56:59], v[96:99], v[124:127]
    ds_read_b64_tr_b16 v[96:97], v47 offset:34816
    v_mfma_f32_16x16x32_bf16 v[124:127], v[64:67], v[100:103], v[124:127]
    ds_read_b64_tr_b16 v[98:99], v47 offset:35072
    s_setprio 0
    s_waitcnt lgkmcnt(4)
    v_mfma_f32_16x16x32_bf16 v[128:131], v[52:55], v[84:87], v[128:131]
    ds_read_b64_tr_b16 v[100:101], v48 offset:32768
    v_mfma_f32_16x16x32_bf16 v[128:131], v[60:63], v[88:91], v[128:131]
    ds_read_b64_tr_b16 v[102:103], v48 offset:33024
    buffer_load_dwordx2 v[180:181], v176, s[36:39], s74 offen offset:0 sc1
    v_mfma_f32_16x16x32_bf16 v[132:135], v[56:59], v[84:87], v[132:135]
    ds_read_b64_tr_b16 v[84:85], v48 offset:34816
    v_mfma_f32_16x16x32_bf16 v[132:135], v[64:67], v[88:91], v[132:135]
    ds_read_b64_tr_b16 v[86:87], v48 offset:35072
    buffer_load_dwordx2 v[182:183], v176, s[36:39], s74 offen offset:128 sc1
    s_waitcnt lgkmcnt(4)
    v_mfma_f32_16x16x32_bf16 v[136:139], v[92:95], v[52:55], v[136:139]
    s_waitcnt vmcnt(19)
    s_waitcnt vmcnt(15)
    s_waitcnt vmcnt(13)
    s_barrier
    ds_read_b128 v[68:71], v45 offset:32768
    ds_read_b128 v[72:75], v45 offset:34816
    ds_read_b128 v[76:79], v46 offset:32768
    ds_read_b128 v[80:83], v46 offset:34816
    ds_read_b64_tr_b16 v[88:89], v47 offset:36864
    v_mfma_f32_16x16x32_bf16 v[136:139], v[96:99], v[60:63], v[136:139]
    ds_read_b64_tr_b16 v[90:91], v47 offset:37120
    s_setprio 3
    buffer_load_dwordx4 v[184:187], v177, s[36:39], s74 offen offset:0 sc1
    v_mfma_f32_16x16x32_bf16 v[140:143], v[92:95], v[56:59], v[140:143]
    ds_read_b64_tr_b16 v[92:93], v47 offset:38912
    v_mfma_f32_16x16x32_bf16 v[140:143], v[96:99], v[64:67], v[140:143]
    ds_read_b64_tr_b16 v[94:95], v47 offset:39168
    buffer_load_dwordx4 v[188:191], v177, s[36:39], s74 offen offset:16 sc1
    s_waitcnt lgkmcnt(8)
    v_mfma_f32_16x16x32_bf16 v[144:147], v[100:103], v[52:55], v[144:147]
    ds_read_b64_tr_b16 v[96:97], v48 offset:36864
    v_mfma_f32_16x16x32_bf16 v[144:147], v[84:87], v[60:63], v[144:147]
    ds_read_b64_tr_b16 v[98:99], v48 offset:37120
    buffer_load_dwordx4 v[192:195], v177, s[36:39], s74 offen offset:128 sc1
    v_mfma_f32_16x16x32_bf16 v[148:151], v[100:103], v[56:59], v[148:151]
    ds_read_b64_tr_b16 v[100:101], v48 offset:38912
    v_mfma_f32_16x16x32_bf16 v[148:151], v[84:87], v[64:67], v[148:151]
    ds_read_b64_tr_b16 v[102:103], v48 offset:39168
    s_setprio 2
    buffer_load_dwordx4 v[196:199], v177, s[36:39], s74 offen offset:144 sc1
    s_waitcnt lgkmcnt(4)
    v_mfma_f32_16x16x32_bf16 v[104:107], v[88:91], v[68:71], v[104:107]
    ds_read_b64_tr_b16 v[84:85], v47 offset:40960
    v_mfma_f32_16x16x32_bf16 v[104:107], v[92:95], v[76:79], v[104:107]
    ds_read_b64_tr_b16 v[86:87], v47 offset:41216
    v_mfma_f32_16x16x32_bf16 v[108:111], v[88:91], v[72:75], v[108:111]
    ds_read_b64_tr_b16 v[88:89], v47 offset:43008
    v_mfma_f32_16x16x32_bf16 v[108:111], v[92:95], v[80:83], v[108:111]
    ds_read_b64_tr_b16 v[90:91], v47 offset:43264
    s_waitcnt lgkmcnt(4)
    v_mfma_f32_16x16x32_bf16 v[112:115], v[96:99], v[68:71], v[112:115]
    ds_read_b64_tr_b16 v[92:93], v48 offset:40960
    v_mfma_f32_16x16x32_bf16 v[112:115], v[100:103], v[76:79], v[112:115]
    ds_read_b64_tr_b16 v[94:95], v48 offset:41216
    s_setprio 1
    v_mfma_f32_16x16x32_bf16 v[116:119], v[96:99], v[72:75], v[116:119]
    ds_read_b64_tr_b16 v[96:97], v48 offset:43008
    v_mfma_f32_16x16x32_bf16 v[116:119], v[100:103], v[80:83], v[116:119]
    ds_read_b64_tr_b16 v[98:99], v48 offset:43264
    s_waitcnt lgkmcnt(4)
    v_mfma_f32_16x16x32_bf16 v[120:123], v[68:71], v[84:87], v[120:123]
    ds_read_b64_tr_b16 v[100:101], v47 offset:45056
    v_mfma_f32_16x16x32_bf16 v[120:123], v[76:79], v[88:91], v[120:123]
    ds_read_b64_tr_b16 v[102:103], v47 offset:45312
    v_mfma_f32_16x16x32_bf16 v[124:127], v[72:75], v[84:87], v[124:127]
    ds_read_b64_tr_b16 v[84:85], v47 offset:47104
    v_mfma_f32_16x16x32_bf16 v[124:127], v[80:83], v[88:91], v[124:127]
    ds_read_b64_tr_b16 v[86:87], v47 offset:47360
    s_setprio 0
    s_waitcnt lgkmcnt(4)
    v_mfma_f32_16x16x32_bf16 v[128:131], v[68:71], v[92:95], v[128:131]
    ds_read_b64_tr_b16 v[88:89], v48 offset:45056
    v_mfma_f32_16x16x32_bf16 v[128:131], v[76:79], v[96:99], v[128:131]
    ds_read_b64_tr_b16 v[90:91], v48 offset:45312
    v_mfma_f32_16x16x32_bf16 v[132:135], v[72:75], v[92:95], v[132:135]
    ds_read_b64_tr_b16 v[92:93], v48 offset:47104
    v_mfma_f32_16x16x32_bf16 v[132:135], v[80:83], v[96:99], v[132:135]
    ds_read_b64_tr_b16 v[94:95], v48 offset:47360
    s_waitcnt lgkmcnt(4)
    v_mfma_f32_16x16x32_bf16 v[136:139], v[100:103], v[68:71], v[136:139]
    s_waitcnt vmcnt(13)
    s_waitcnt vmcnt(11)
    s_barrier
    ds_read_b128 v[52:55], v49 offset:0
    ds_read_b128 v[56:59], v49 offset:2048
    ds_read_b128 v[60:63], v50 offset:0
    ds_read_b128 v[64:67], v50 offset:2048
    ds_read_b64_tr_b16 v[96:97], v47 offset:49152
    v_mfma_f32_16x16x32_bf16 v[136:139], v[84:87], v[76:79], v[136:139]
    ds_read_b64_tr_b16 v[98:99], v47 offset:49408
    s_setprio 3
    s_waitcnt vmcnt(7)
    v_add_f32_dpp v156, v156, v156 row_ror:8 row_mask:0xf bank_mask:0xf
    v_add_f32_dpp v157, v157, v157 row_ror:8 row_mask:0xf bank_mask:0xf
    v_mfma_f32_16x16x32_bf16 v[140:143], v[100:103], v[72:75], v[140:143]
    ds_read_b64_tr_b16 v[100:101], v47 offset:51200
    v_mfma_f32_16x16x32_bf16 v[140:143], v[84:87], v[80:83], v[140:143]
    ds_read_b64_tr_b16 v[102:103], v47 offset:51456
    v_add_f32_dpp v158, v158, v158 row_ror:8 row_mask:0xf bank_mask:0xf
    v_add_f32_dpp v159, v159, v159 row_ror:8 row_mask:0xf bank_mask:0xf
    v_add_f32_dpp v156, v156, v156 row_ror:4 row_mask:0xf bank_mask:0xf
    s_waitcnt lgkmcnt(8)
    v_mfma_f32_16x16x32_bf16 v[144:147], v[88:91], v[68:71], v[144:147]
    ds_read_b64_tr_b16 v[84:85], v48 offset:49152
    v_mfma_f32_16x16x32_bf16 v[144:147], v[92:95], v[76:79], v[144:147]
    ds_read_b64_tr_b16 v[86:87], v48 offset:49408
    s_setprio 2
    v_add_f32_dpp v157, v157, v157 row_ror:4 row_mask:0xf bank_mask:0xf
    v_add_f32_dpp v158, v158, v158 row_ror:4 row_mask:0xf bank_mask:0xf
    v_add_f32_dpp v159, v159, v159 row_ror:4 row_mask:0xf bank_mask:0xf
    v_mfma_f32_16x16x32_bf16 v[148:151], v[88:91], v[72:75], v[148:151]
    ds_read_b64_tr_b16 v[88:89], v48 offset:51200
    v_mfma_f32_16x16x32_bf16 v[148:151], v[92:95], v[80:83], v[148:151]
    ds_read_b64_tr_b16 v[90:91], v48 offset:51456
    v_add_f32_dpp v156, v156, v156 row_ror:2 row_mask:0xf bank_mask:0xf
    v_add_f32_dpp v157, v157, v157 row_ror:2 row_mask:0xf bank_mask:0xf
    v_add_f32_dpp v158, v158, v158 row_ror:2 row_mask:0xf bank_mask:0xf
    s_waitcnt lgkmcnt(4)
    v_mfma_f32_16x16x32_bf16 v[104:107], v[96:99], v[52:55], v[104:107]
    ds_read_b64_tr_b16 v[92:93], v47 offset:53248
    v_mfma_f32_16x16x32_bf16 v[104:107], v[100:103], v[60:63], v[104:107]
    ds_read_b64_tr_b16 v[94:95], v47 offset:53504
    s_setprio 1
    v_add_f32_dpp v159, v159, v159 row_ror:2 row_mask:0xf bank_mask:0xf
    v_add_f32_dpp v156, v156, v156 row_ror:1 row_mask:0xf bank_mask:0xf
    v_add_f32_dpp v157, v157, v157 row_ror:1 row_mask:0xf bank_mask:0xf
    v_mfma_f32_16x16x32_bf16 v[108:111], v[96:99], v[56:59], v[108:111]
    ds_read_b64_tr_b16 v[96:97], v47 offset:55296
    v_mfma_f32_16x16x32_bf16 v[108:111], v[100:103], v[64:67], v[108:111]
    ds_read_b64_tr_b16 v[98:99], v47 offset:55552
    v_add_f32_dpp v158, v158, v158 row_ror:1 row_mask:0xf bank_mask:0xf
    v_add_f32_dpp v159, v159, v159 row_ror:1 row_mask:0xf bank_mask:0xf
    s_mov_b32 exec_lo, 0x00010001
    s_mov_b32 exec_hi, 1
    ds_write_b128 v172, v[156:159]
    s_mov_b64 exec, -1
    s_waitcnt lgkmcnt(5)
    v_mfma_f32_16x16x32_bf16 v[112:115], v[84:87], v[52:55], v[112:115]
    ds_read_b64_tr_b16 v[100:101], v48 offset:53248
    v_mfma_f32_16x16x32_bf16 v[112:115], v[88:91], v[60:63], v[112:115]
    ds_read_b64_tr_b16 v[102:103], v48 offset:53504
    s_setprio 0
    v_mfma_f32_16x16x32_bf16 v[116:119], v[84:87], v[56:59], v[116:119]
    ds_read_b64_tr_b16 v[84:85], v48 offset:55296
    v_mfma_f32_16x16x32_bf16 v[116:119], v[88:91], v[64:67], v[116:119]
    ds_read_b64_tr_b16 v[86:87], v48 offset:55552
    s_waitcnt lgkmcnt(5)
    v_mfma_f32_16x16x32_bf16 v[120:123], v[52:55], v[92:95], v[120:123]
    s_waitcnt vmcnt(6)
    s_waitcnt lgkmcnt(4)
    s_barrier
    ds_read_b128 v[68:71], v45 offset:0
    ds_read_b128 v[72:75], v45 offset:2048
    ds_read_b128 v[76:79], v46 offset:0
    ds_read_b128 v[80:83], v46 offset:2048
    ds_read_b64_tr_b16 v[88:89], v47 offset:0
    v_mfma_f32_16x16x32_bf16 v[120:123], v[60:63], v[96:99], v[120:123]
    ds_read_b64_tr_b16 v[90:91], v47 offset:256
    s_setprio 3
    v_mfma_f32_16x16x32_bf16 v[124:127], v[56:59], v[92:95], v[124:127]
    ds_read_b64_tr_b16 v[92:93], v47 offset:2048
    v_mfma_f32_16x16x32_bf16 v[124:127], v[64:67], v[96:99], v[124:127]
    ds_read_b64_tr_b16 v[94:95], v47 offset:2304
    ds_read_b128 v[156:159], v178 offset:0
    ds_read_b128 v[160:163], v178 offset:64
    ds_read_b32 v152, v179 offset:128
    s_waitcnt lgkmcnt(11)
    v_mfma_f32_16x16x32_bf16 v[128:131], v[52:55], v[100:103], v[128:131]
    ds_read_b64_tr_b16 v[96:97], v48 offset:0
    v_mfma_f32_16x16x32_bf16 v[128:131], v[60:63], v[84:87], v[128:131]
    ds_read_b64_tr_b16 v[98:99], v48 offset:256
    ds_read_b32 v153, v179 offset:192
    ds_read_b128 v[164:167], v178 offset:256
    ds_read_b128 v[168:171], v178 offset:320
    v_mfma_f32_16x16x32_bf16 v[132:135], v[56:59], v[100:103], v[132:135]
    ds_read_b64_tr_b16 v[100:101], v48 offset:2048
    v_mfma_f32_16x16x32_bf16 v[132:135], v[64:67], v[84:87], v[132:135]
    ds_read_b64_tr_b16 v[102:103], v48 offset:2304
    s_waitcnt lgkmcnt(10)
    v_mfma_f32_16x16x32_bf16 v[104:107], v[88:91], v[68:71], v[104:107]
    ds_read_b64_tr_b16 v[84:85], v47 offset:4096
    v_mfma_f32_16x16x32_bf16 v[104:107], v[92:95], v[76:79], v[104:107]
    ds_read_b64_tr_b16 v[86:87], v47 offset:4352
    v_mfma_f32_16x16x32_bf16 v[108:111], v[88:91], v[72:75], v[108:111]
    ds_read_b64_tr_b16 v[88:89], v47 offset:6144
    v_mfma_f32_16x16x32_bf16 v[108:111], v[92:95], v[80:83], v[108:111]
    ds_read_b64_tr_b16 v[90:91], v47 offset:6400
    s_setprio 2
    s_waitcnt vmcnt(0) lgkmcnt(6)
    v_mul_f32 v208, v181, v156
    v_mul_f32 v209, v181, v157
    v_mul_f32 v210, v181, v158
    v_mul_f32 v211, v181, v159
    v_mul_f32 v212, v183, v156
    s_waitcnt lgkmcnt(4)
    v_mfma_f32_16x16x32_bf16 v[112:115], v[96:99], v[68:71], v[112:115]
    ds_read_b64_tr_b16 v[92:93], v48 offset:4096
    v_mfma_f32_16x16x32_bf16 v[112:115], v[100:103], v[76:79], v[112:115]
    ds_read_b64_tr_b16 v[94:95], v48 offset:4352
    v_mul_f32 v213, v183, v157
    v_mul_f32 v214, v183, v158
    v_mul_f32 v215, v183, v159
    v_mul_f32 v216, v181, v160
    v_mul_f32 v217, v181, v161
    v_mul_f32 v218, v181, v162
    v_mfma_f32_16x16x32_bf16 v[116:119], v[96:99], v[72:75], v[116:119]
    ds_read_b64_tr_b16 v[96:97], v48 offset:6144
    v_mfma_f32_16x16x32_bf16 v[116:119], v[100:103], v[80:83], v[116:119]
    ds_read_b64_tr_b16 v[98:99], v48 offset:6400
    v_mul_f32 v219, v181, v163
    v_mul_f32 v220, v183, v160
    v_mul_f32 v221, v183, v161
    v_mul_f32 v222, v183, v162
    v_mul_f32 v223, v183, v163
    v_mul_f32 v224, v185, v152
    s_waitcnt lgkmcnt(4)
    v_mfma_f32_16x16x32_bf16 v[120:123], v[68:71], v[84:87], v[120:123]
    ds_read_b64_tr_b16 v[100:101], v47 offset:57344
    v_mfma_f32_16x16x32_bf16 v[120:123], v[76:79], v[88:91], v[120:123]
    ds_read_b64_tr_b16 v[102:103], v47 offset:57600
    v_mul_f32 v225, v187, v152
    v_mul_f32 v226, v189, v152
    v_mul_f32 v227, v191, v152
    v_mul_f32 v228, v193, v152
    v_mul_f32 v229, v195, v152
    v_mul_f32 v230, v197, v152
    v_mfma_f32_16x16x32_bf16 v[124:127], v[72:75], v[84:87], v[124:127]
    ds_read_b64_tr_b16 v[84:85], v47 offset:59392
    v_mfma_f32_16x16x32_bf16 v[124:127], v[80:83], v[88:91], v[124:127]
    ds_read_b64_tr_b16 v[86:87], v47 offset:59648
    v_mul_f32 v231, v199, v152
    v_mul_f32 v232, v185, v153
    v_mul_f32 v233, v187, v153
    v_mul_f32 v234, v189, v153
    v_mul_f32 v235, v191, v153
    v_mul_f32 v236, v193, v153
    s_waitcnt lgkmcnt(4)
    v_mfma_f32_16x16x32_bf16 v[128:131], v[68:71], v[92:95], v[128:131]
    ds_read_b64_tr_b16 v[88:89], v48 offset:57344
    v_mfma_f32_16x16x32_bf16 v[128:131], v[76:79], v[96:99], v[128:131]
qa_kernel_WS0_2:
    s_cbranch_execz qa_kernel_WS0_10
    ds_read_b64_tr_b16 v[90:91], v48 offset:57600
    s_setprio 1
    v_mul_f32 v237, v195, v153
    v_mul_f32 v238, v197, v153
    v_mul_f32 v239, v199, v153
    v_mul_f32 v154, 0x3e8293ee, v180
    v_mul_f32 v155, 0x3e8293ee, v182
    v_mul_f32 v181, 0x3e8293ee, v181
    v_mfma_f32_16x16x32_bf16 v[132:135], v[72:75], v[92:95], v[132:135]
    ds_read_b64_tr_b16 v[92:93], v48 offset:59392
    v_mfma_f32_16x16x32_bf16 v[132:135], v[80:83], v[96:99], v[132:135]
    ds_read_b64_tr_b16 v[94:95], v48 offset:59648
    v_mul_f32 v183, 0x3e8293ee, v183
    v_mul_f32 v240, v181, v164
    v_mul_f32 v241, v181, v165
    v_mul_f32 v242, v181, v166
    v_mul_f32 v243, v181, v167
    v_mul_f32 v244, v183, v164
    s_waitcnt lgkmcnt(4)
    v_mfma_f32_16x16x32_bf16 v[136:139], v[100:103], v[52:55], v[136:139]
    ds_read_b64_tr_b16 v[96:97], v47 offset:8192
    v_mfma_f32_16x16x32_bf16 v[136:139], v[84:87], v[60:63], v[136:139]
    ds_read_b64_tr_b16 v[98:99], v47 offset:8448
    v_mul_f32 v245, v183, v165
    v_mul_f32 v246, v183, v166
    v_mul_f32 v247, v183, v167
    v_mul_f32 v248, v181, v168
    v_mul_f32 v249, v181, v169
    v_mul_f32 v250, v181, v170
    v_mfma_f32_16x16x32_bf16 v[140:143], v[100:103], v[56:59], v[140:143]
    ds_read_b64_tr_b16 v[100:101], v47 offset:10240
    v_mfma_f32_16x16x32_bf16 v[140:143], v[84:87], v[64:67], v[140:143]
    ds_read_b64_tr_b16 v[102:103], v47 offset:10496
    v_mul_f32 v251, v181, v171
    v_mul_f32 v252, v183, v168
    v_mul_f32 v253, v183, v169
    v_mul_f32 v254, v183, v170
    v_mul_f32 v255, v183, v171
    s_waitcnt lgkmcnt(4)
    v_mfma_f32_16x16x32_bf16 v[144:147], v[88:91], v[52:55], v[144:147]
    ds_read_b64_tr_b16 v[84:85], v48 offset:8192
    v_mfma_f32_16x16x32_bf16 v[144:147], v[92:95], v[60:63], v[144:147]
    ds_read_b64_tr_b16 v[86:87], v48 offset:8448
    v_fma_f32 v104, v104, v180, v208
    v_fma_f32 v105, v105, v180, v209
    v_fma_f32 v106, v106, v180, v210
    v_fma_f32 v107, v107, v180, v211
    v_fma_f32 v112, v112, v180, v216
    v_fma_f32 v113, v113, v180, v217
    v_fma_f32 v114, v114, v180, v218
    v_fma_f32 v115, v115, v180, v219
    v_cvt_pk_bf16_f32 v208, v104, v105
    v_cvt_pk_bf16_f32 v209, v106, v107
    v_cvt_pk_bf16_f32 v210, v112, v113
    v_cvt_pk_bf16_f32 v211, v114, v115
    v_mfma_f32_16x16x32_bf16 v[148:151], v[88:91], v[56:59], v[148:151]
    ds_read_b64_tr_b16 v[88:89], v48 offset:10240
    v_mfma_f32_16x16x32_bf16 v[148:151], v[92:95], v[64:67], v[148:151]
    ds_read_b64_tr_b16 v[90:91], v48 offset:10496
    s_setprio 0
    buffer_store_dwordx4 v[208:211], v27, s[36:39], s63 offen offset:0 sc1
    ds_write_b128 v43, v[208:211] offset:0
    v_fma_f32 v108, v108, v182, v212
    v_fma_f32 v109, v109, v182, v213
    v_fma_f32 v110, v110, v182, v214
    v_fma_f32 v111, v111, v182, v215
    v_fma_f32 v116, v116, v182, v220
    v_fma_f32 v117, v117, v182, v221
    v_fma_f32 v118, v118, v182, v222
    v_fma_f32 v119, v119, v182, v223
    v_cvt_pk_bf16_f32 v212, v108, v109
    v_cvt_pk_bf16_f32 v213, v110, v111
    s_waitcnt lgkmcnt(5)
    v_mfma_f32_16x16x32_bf16 v[136:139], v[96:99], v[68:71], v[136:139]
    v_mfma_f32_16x16x32_bf16 v[136:139], v[100:103], v[76:79], v[136:139]
    v_cvt_pk_bf16_f32 v214, v116, v117
    v_cvt_pk_bf16_f32 v215, v118, v119
    buffer_store_dwordx4 v[212:215], v27, s[36:39], s63 offen offset:256 sc1
    ds_write_b128 v43, v[212:215] offset:256
    v_mfma_f32_16x16x32_bf16 v[140:143], v[96:99], v[72:75], v[140:143]
    v_mfma_f32_16x16x32_bf16 v[140:143], v[100:103], v[80:83], v[140:143]
    v_fma_f32 v120, v120, v184, v224
    v_fma_f32 v121, v121, v186, v225
    v_fma_f32 v122, v122, v188, v226
    v_fma_f32 v123, v123, v190, v227
    v_fma_f32 v128, v128, v184, v232
    v_fma_f32 v129, v129, v186, v233
    v_fma_f32 v130, v130, v188, v234
    v_fma_f32 v131, v131, v190, v235
    v_cvt_pk_bf16_f32 v224, v120, v121
    v_cvt_pk_bf16_f32 v225, v122, v123
    v_cvt_pk_bf16_f32 v226, v128, v129
    v_cvt_pk_bf16_f32 v227, v130, v131
    s_waitcnt lgkmcnt(2)
    v_mfma_f32_16x16x32_bf16 v[144:147], v[84:87], v[68:71], v[144:147]
    v_mfma_f32_16x16x32_bf16 v[144:147], v[88:91], v[76:79], v[144:147]
    v_permlane16_swap_b32 v224, v226
    v_permlane16_swap_b32 v225, v227
    buffer_store_dwordx4 v[224:227], v2, s[36:39], s63 offen offset:2048 sc1
    ds_write_b128 v44, v[224:227] offset:2048
    v_fma_f32 v124, v124, v192, v228
    v_fma_f32 v125, v125, v194, v229
    v_fma_f32 v126, v126, v196, v230
    v_fma_f32 v127, v127, v198, v231
    v_fma_f32 v132, v132, v192, v236
    v_fma_f32 v133, v133, v194, v237
    v_fma_f32 v134, v134, v196, v238
    v_fma_f32 v135, v135, v198, v239
    v_mfma_f32_16x16x32_bf16 v[148:151], v[84:87], v[72:75], v[148:151]
    v_mfma_f32_16x16x32_bf16 v[148:151], v[88:91], v[80:83], v[148:151]
    v_cvt_pk_bf16_f32 v228, v124, v125
    v_cvt_pk_bf16_f32 v229, v126, v127
    v_cvt_pk_bf16_f32 v230, v132, v133
    v_cvt_pk_bf16_f32 v231, v134, v135
    s_nop 0
    v_permlane16_swap_b32 v228, v230
    v_permlane16_swap_b32 v229, v231
    buffer_store_dwordx4 v[228:231], v2, s[36:39], s63 offen offset:3072 sc1
    ds_write_b128 v44, v[228:231] offset:3072
    v_fma_f32 v136, v136, v154, v240
    v_fma_f32 v137, v137, v154, v241
    v_fma_f32 v138, v138, v154, v242
    v_fma_f32 v139, v139, v154, v243
    v_fma_f32 v144, v144, v154, v248
    v_fma_f32 v145, v145, v154, v249
    v_fma_f32 v146, v146, v154, v250
    v_fma_f32 v147, v147, v154, v251
    v_cvt_pk_bf16_f32 v8, v136, v137
    v_cvt_pk_bf16_f32 v9, v138, v139
    v_cvt_pk_bf16_f32 v10, v144, v145
    v_cvt_pk_bf16_f32 v11, v146, v147
    v_fma_f32 v140, v140, v155, v244
    v_fma_f32 v141, v141, v155, v245
    v_fma_f32 v142, v142, v155, v246
    v_fma_f32 v143, v143, v155, v247
    v_fma_f32 v148, v148, v155, v252
    v_fma_f32 v149, v149, v155, v253
    v_fma_f32 v150, v150, v155, v254
    v_fma_f32 v151, v151, v155, v255
    v_cvt_pk_bf16_f32 v12, v140, v141
    v_cvt_pk_bf16_f32 v13, v142, v143
    v_cvt_pk_bf16_f32 v14, v148, v149
    v_cvt_pk_bf16_f32 v15, v150, v151
    s_waitcnt lgkmcnt(0)
    s_branch qa_kernel_GE
qa_kernel_G1:
    s_waitcnt vmcnt(12)
    s_waitcnt vmcnt(8)
    s_waitcnt lgkmcnt(0)
    s_barrier
    ds_read_b128 v[52:55], v45 offset:0
    ds_read_b128 v[56:59], v45 offset:2048
    ds_read_b128 v[60:63], v46 offset:0
    ds_read_b128 v[64:67], v46 offset:2048
    ds_read_b64_tr_b16 v[84:85], v47 offset:0
    ds_read_b64_tr_b16 v[86:87], v47 offset:256
    ds_read_b64_tr_b16 v[88:89], v47 offset:2048
    ds_read_b64_tr_b16 v[90:91], v47 offset:2304
    ds_read_b64_tr_b16 v[92:93], v48 offset:0
    ds_read_b64_tr_b16 v[94:95], v48 offset:256
    ds_read_b64_tr_b16 v[96:97], v48 offset:2048
    ds_read_b64_tr_b16 v[98:99], v48 offset:2304
    s_waitcnt lgkmcnt(4)
    v_mfma_f32_16x16x32_bf16 v[104:107], v[84:87], v[52:55], 0
    ds_read_b64_tr_b16 v[100:101], v47 offset:4096
    v_mfma_f32_16x16x32_bf16 v[104:107], v[88:91], v[60:63], v[104:107]
    ds_read_b64_tr_b16 v[102:103], v47 offset:4352
    s_setprio 3
    s_add_u32 m0, s53, 24576
    s_nop 0
    buffer_load_dwordx4 v20, s[32:35], s52 offen lds
    s_add_u32 s51, s51, 1
    s_and_b32 s51, s51, 15
    s_mul_i32 s52, s51, 393216
    v_mfma_f32_16x16x32_bf16 v[108:111], v[84:87], v[56:59], 0
    ds_read_b64_tr_b16 v[84:85], v47 offset:6144
    v_mfma_f32_16x16x32_bf16 v[108:111], v[88:91], v[64:67], v[108:111]
    ds_read_b64_tr_b16 v[86:87], v47 offset:6400
    s_add_u32 m0, s50, 65536
    s_nop 0
    buffer_load_dwordx4 v16, s[28:31], s49 offen lds
    ds_read_b64_tr_b16 v[156:157], v172 offset:0
    ds_read_b64_tr_b16 v[158:159], v172 offset:256
    s_waitcnt lgkmcnt(6)
    v_mfma_f32_16x16x32_bf16 v[112:115], v[92:95], v[52:55], 0
    ds_read_b64_tr_b16 v[88:89], v48 offset:4096
    v_mfma_f32_16x16x32_bf16 v[112:115], v[96:99], v[60:63], v[112:115]
    ds_read_b64_tr_b16 v[90:91], v48 offset:4352
    s_setprio 2
    s_add_u32 m0, s50, 66560
    s_nop 0
    buffer_load_dwordx4 v17, s[28:31], s49 offen lds
    ds_read_b64_tr_b16 v[160:161], v173 offset:0
    ds_read_b64_tr_b16 v[162:163], v173 offset:256
    v_mfma_f32_16x16x32_bf16 v[116:119], v[92:95], v[56:59], 0
    ds_read_b64_tr_b16 v[92:93], v48 offset:6144
    v_mfma_f32_16x16x32_bf16 v[116:119], v[96:99], v[64:67], v[116:119]
    ds_read_b64_tr_b16 v[94:95], v48 offset:6400
    s_add_u32 m0, s50, 67584
    s_nop 0
    buffer_load_dwordx4 v18, s[28:31], s49 offen lds
    s_waitcnt lgkmcnt(8)
    v_mfma_f32_16x16x32_bf16 v[120:123], v[52:55], v[100:103], 0
    ds_read_b64_tr_b16 v[96:97], v47 offset:8192
    v_mfma_f32_16x16x32_bf16 v[120:123], v[60:63], v[84:87], v[120:123]
    ds_read_b64_tr_b16 v[98:99], v47 offset:8448
    s_setprio 1
    s_add_u32 m0, s50, 68608
    s_nop 0
    buffer_load_dwordx4 v19, s[28:31], s49 offen lds
    s_add_u32 s49, s49, 128
    s_and_b32 s49, s49, 2047
    v_mfma_f32_16x16x32_bf16 v[124:127], v[56:59], v[100:103], 0
    ds_read_b64_tr_b16 v[100:101], v47 offset:10240
    v_mfma_f32_16x16x32_bf16 v[124:127], v[64:67], v[84:87], v[124:127]
    ds_read_b64_tr_b16 v[102:103], v47 offset:10496
    s_add_u32 m0, s53, 36864
    s_nop 0
    buffer_load_dwordx4 v20, s[32:35], s52 offen lds
    s_add_u32 s51, s51, 1
    s_and_b32 s51, s51, 15
    s_mul_i32 s52, s51, 393216
    s_waitcnt lgkmcnt(4)
    v_mfma_f32_16x16x32_bf16 v[128:131], v[52:55], v[88:91], 0
    ds_read_b64_tr_b16 v[84:85], v48 offset:8192
    v_mfma_f32_16x16x32_bf16 v[128:131], v[60:63], v[92:95], v[128:131]
    ds_read_b64_tr_b16 v[86:87], v48 offset:8448
    s_setprio 0
    s_add_u32 m0, s50, 0
    s_nop 0
    buffer_load_dwordx4 v16, s[28:31], s49 offen lds
    v_mfma_f32_16x16x32_bf16 v[132:135], v[56:59], v[88:91], 0
    ds_read_b64_tr_b16 v[88:89], v48 offset:10240
    v_mfma_f32_16x16x32_bf16 v[132:135], v[64:67], v[92:95], v[132:135]
    ds_read_b64_tr_b16 v[90:91], v48 offset:10496
    s_add_u32 m0, s50, 1024
    s_nop 0
    buffer_load_dwordx4 v17, s[28:31], s49 offen lds
    v_mfma_f32_16x16x32_bf16 v[164:167], v[156:159], v[152:155], 0
    s_waitcnt lgkmcnt(4)
    v_mfma_f32_16x16x32_bf16 v[136:139], v[96:99], v[52:55], 0
    s_waitcnt vmcnt(15)
    s_waitcnt vmcnt(11)
    s_barrier
    ds_read_b128 v[68:71], v45 offset:32768
    ds_read_b128 v[72:75], v45 offset:34816
    ds_read_b128 v[76:79], v46 offset:32768
    ds_read_b128 v[80:83], v46 offset:34816
    ds_read_b64_tr_b16 v[92:93], v47 offset:12288
    v_mfma_f32_16x16x32_bf16 v[136:139], v[100:103], v[60:63], v[136:139]
    ds_read_b64_tr_b16 v[94:95], v47 offset:12544
    s_setprio 3
    s_add_u32 m0, s50, 2048
    s_nop 0
    buffer_load_dwordx4 v18, s[28:31], s49 offen lds
    v_mfma_f32_16x16x32_bf16 v[168:171], v[160:163], v[152:155], 0
    v_mfma_f32_16x16x32_bf16 v[140:143], v[96:99], v[56:59], 0
    ds_read_b64_tr_b16 v[96:97], v47 offset:14336
    v_mfma_f32_16x16x32_bf16 v[140:143], v[100:103], v[64:67], v[140:143]
    ds_read_b64_tr_b16 v[98:99], v47 offset:14592
    s_add_u32 m0, s50, 3072
    s_nop 0
    buffer_load_dwordx4 v19, s[28:31], s49 offen lds
    s_add_u32 s49, s49, 128
    s_and_b32 s49, s49, 2047
    ds_read_b64_tr_b16 v[156:157], v172 offset:12288
    ds_read_b64_tr_b16 v[158:159], v172 offset:12544
    s_waitcnt lgkmcnt(10)
    v_mfma_f32_16x16x32_bf16 v[144:147], v[84:87], v[52:55], 0
    ds_read_b64_tr_b16 v[100:101], v48 offset:12288
    v_mfma_f32_16x16x32_bf16 v[144:147], v[88:91], v[60:63], v[144:147]
    ds_read_b64_tr_b16 v[102:103], v48 offset:12544
    s_add_u32 m0, s53, 49152
    s_nop 0
    buffer_load_dwordx4 v20, s[32:35], s52 offen lds
    s_add_u32 s51, s51, 1
    s_and_b32 s51, s51, 15
    s_mul_i32 s52, s51, 393216
    ds_read_b64_tr_b16 v[160:161], v173 offset:12288
    ds_read_b64_tr_b16 v[162:163], v173 offset:12544
    v_mfma_f32_16x16x32_bf16 v[148:151], v[84:87], v[56:59], 0
    ds_read_b64_tr_b16 v[84:85], v48 offset:14336
    v_mfma_f32_16x16x32_bf16 v[148:151], v[88:91], v[64:67], v[148:151]
    ds_read_b64_tr_b16 v[86:87], v48 offset:14592
    s_setprio 2
    s_waitcnt lgkmcnt(8)
    v_mfma_f32_16x16x32_bf16 v[104:107], v[92:95], v[68:71], v[104:107]
    ds_read_b64_tr_b16 v[88:89], v47 offset:16384
    v_mfma_f32_16x16x32_bf16 v[104:107], v[96:99], v[76:79], v[104:107]
    ds_read_b64_tr_b16 v[90:91], v47 offset:16640
    s_add_u32 m0, s50, 32768
    s_nop 0
    buffer_load_dwordx4 v16, s[28:31], s49 offen lds
    v_mfma_f32_16x16x32_bf16 v[108:111], v[92:95], v[72:75], v[108:111]
    ds_read_b64_tr_b16 v[92:93], v47 offset:18432
    v_mfma_f32_16x16x32_bf16 v[108:111], v[96:99], v[80:83], v[108:111]
    ds_read_b64_tr_b16 v[94:95], v47 offset:18688
    s_add_u32 m0, s50, 33792
    s_nop 0
    buffer_load_dwordx4 v17, s[28:31], s49 offen lds
    s_waitcnt lgkmcnt(4)
    v_mfma_f32_16x16x32_bf16 v[112:115], v[100:103], v[68:71], v[112:115]
    ds_read_b64_tr_b16 v[96:97], v48 offset:16384
    v_mfma_f32_16x16x32_bf16 v[112:115], v[84:87], v[76:79], v[112:115]
    ds_read_b64_tr_b16 v[98:99], v48 offset:16640
    s_setprio 1
    s_add_u32 m0, s50, 34816
    s_nop 0
    buffer_load_dwordx4 v18, s[28:31], s49 offen lds
    v_mfma_f32_16x16x32_bf16 v[116:119], v[100:103], v[72:75], v[116:119]
    ds_read_b64_tr_b16 v[100:101], v48 offset:18432
    v_mfma_f32_16x16x32_bf16 v[116:119], v[84:87], v[80:83], v[116:119]
    ds_read_b64_tr_b16 v[102:103], v48 offset:18688
    s_add_u32 m0, s50, 35840
    s_nop 0
    buffer_load_dwordx4 v19, s[28:31], s49 offen lds
    s_add_u32 s49, s49, 128
    s_and_b32 s49, s49, 2047
    v_mfma_f32_16x16x32_bf16 v[164:167], v[156:159], v[152:155], v[164:167]
    s_waitcnt lgkmcnt(4)
    v_mfma_f32_16x16x32_bf16 v[120:123], v[68:71], v[88:91], v[120:123]
    ds_read_b64_tr_b16 v[84:85], v47 offset:20480
    v_mfma_f32_16x16x32_bf16 v[120:123], v[76:79], v[92:95], v[120:123]
    ds_read_b64_tr_b16 v[86:87], v47 offset:20736
    v_mfma_f32_16x16x32_bf16 v[168:171], v[160:163], v[152:155], v[168:171]
    v_mfma_f32_16x16x32_bf16 v[124:127], v[72:75], v[88:91], v[124:127]
    ds_read_b64_tr_b16 v[88:89], v47 offset:22528
    v_mfma_f32_16x16x32_bf16 v[124:127], v[80:83], v[92:95], v[124:127]
    ds_read_b64_tr_b16 v[90:91], v47 offset:22784
    s_setprio 0
    s_waitcnt lgkmcnt(4)
    v_mfma_f32_16x16x32_bf16 v[128:131], v[68:71], v[96:99], v[128:131]
    ds_read_b64_tr_b16 v[92:93], v48 offset:20480
    v_mfma_f32_16x16x32_bf16 v[128:131], v[76:79], v[100:103], v[128:131]
    ds_read_b64_tr_b16 v[94:95], v48 offset:20736
    v_mfma_f32_16x16x32_bf16 v[132:135], v[72:75], v[96:99], v[132:135]
    ds_read_b64_tr_b16 v[96:97], v48 offset:22528
    v_mfma_f32_16x16x32_bf16 v[132:135], v[80:83], v[100:103], v[132:135]
    ds_read_b64_tr_b16 v[98:99], v48 offset:22784
    s_waitcnt lgkmcnt(4)
    v_mfma_f32_16x16x32_bf16 v[136:139], v[84:87], v[68:71], v[136:139]
    s_waitcnt vmcnt(14)
    s_waitcnt vmcnt(10)
    s_barrier
    ds_read_b128 v[52:55], v49 offset:0
    ds_read_b128 v[56:59], v49 offset:2048
    ds_read_b128 v[60:63], v50 offset:0
    ds_read_b128 v[64:67], v50 offset:2048
    ds_read_b64_tr_b16 v[100:101], v47 offset:24576
    v_mfma_f32_16x16x32_bf16 v[136:139], v[88:91], v[76:79], v[136:139]
    ds_read_b64_tr_b16 v[102:103], v47 offset:24832
    s_setprio 3
    s_add_u32 m0, s53, 0
    s_nop 0
    buffer_load_dwordx4 v20, s[32:35], s52 offen lds
    s_add_u32 s51, s51, 1
    s_and_b32 s51, s51, 15
    s_mul_i32 s52, s51, 393216
    v_mfma_f32_16x16x32_bf16 v[140:143], v[84:87], v[72:75], v[140:143]
    ds_read_b64_tr_b16 v[84:85], v47 offset:26624
    v_mfma_f32_16x16x32_bf16 v[140:143], v[88:91], v[80:83], v[140:143]
    ds_read_b64_tr_b16 v[86:87], v47 offset:26880
    v_lshlrev_b32 v216, 16, v208
    v_and_b32 v217, 0xffff0000, v208
    s_waitcnt lgkmcnt(8)
    v_mfma_f32_16x16x32_bf16 v[144:147], v[92:95], v[68:71], v[144:147]
    ds_read_b64_tr_b16 v[88:89], v48 offset:24576
    v_mfma_f32_16x16x32_bf16 v[144:147], v[96:99], v[76:79], v[144:147]
    ds_read_b64_tr_b16 v[90:91], v48 offset:24832
    v_lshlrev_b32 v218, 16, v209
    v_and_b32 v219, 0xffff0000, v209
    v_lshlrev_b32 v220, 16, v210
    v_mfma_f32_16x16x32_bf16 v[148:151], v[92:95], v[72:75], v[148:151]
    ds_read_b64_tr_b16 v[92:93], v48 offset:26624
    v_mfma_f32_16x16x32_bf16 v[148:151], v[96:99], v[80:83], v[148:151]
    ds_read_b64_tr_b16 v[94:95], v48 offset:26880
    s_setprio 2
    v_and_b32 v221, 0xffff0000, v210
    v_lshlrev_b32 v222, 16, v211
    v_and_b32 v223, 0xffff0000, v211
    s_waitcnt lgkmcnt(4)
    v_mfma_f32_16x16x32_bf16 v[104:107], v[100:103], v[52:55], v[104:107]
    ds_read_b64_tr_b16 v[96:97], v47 offset:28672
    v_mfma_f32_16x16x32_bf16 v[104:107], v[84:87], v[60:63], v[104:107]
    ds_read_b64_tr_b16 v[98:99], v47 offset:28928
    s_add_u32 m0, s50, 65536
    s_nop 0
    buffer_load_dwordx4 v16, s[28:31], s49 offen lds
    v_lshlrev_b32 v224, 16, v212
    v_and_b32 v225, 0xffff0000, v212
    v_lshlrev_b32 v226, 16, v213
    v_mfma_f32_16x16x32_bf16 v[108:111], v[100:103], v[56:59], v[108:111]
    ds_read_b64_tr_b16 v[100:101], v47 offset:30720
    v_mfma_f32_16x16x32_bf16 v[108:111], v[84:87], v[64:67], v[108:111]
    ds_read_b64_tr_b16 v[102:103], v47 offset:30976
    s_add_u32 m0, s50, 66560
    s_nop 0
    buffer_load_dwordx4 v17, s[28:31], s49 offen lds
    v_and_b32 v227, 0xffff0000, v213
    v_lshlrev_b32 v228, 16, v214
    v_and_b32 v229, 0xffff0000, v214
    s_waitcnt lgkmcnt(4)
    v_mfma_f32_16x16x32_bf16 v[112:115], v[88:91], v[52:55], v[112:115]
    ds_read_b64_tr_b16 v[84:85], v48 offset:28672
    v_mfma_f32_16x16x32_bf16 v[112:115], v[92:95], v[60:63], v[112:115]
    ds_read_b64_tr_b16 v[86:87], v48 offset:28928
    s_setprio 1
    s_add_u32 m0, s50, 67584
    s_nop 0
    buffer_load_dwordx4 v18, s[28:31], s49 offen lds
    v_lshlrev_b32 v230, 16, v215
    v_and_b32 v231, 0xffff0000, v215
    v_add_f32 v232, v216, v217
    v_mfma_f32_16x16x32_bf16 v[116:119], v[88:91], v[56:59], v[116:119]
    ds_read_b64_tr_b16 v[88:89], v48 offset:30720
    v_mfma_f32_16x16x32_bf16 v[116:119], v[92:95], v[64:67], v[116:119]
    ds_read_b64_tr_b16 v[90:91], v48 offset:30976
    s_add_u32 m0, s50, 68608
    s_nop 0
    buffer_load_dwordx4 v19, s[28:31], s49 offen lds
    s_add_u32 s49, s49, 128
    s_and_b32 s49, s49, 2047
    v_add_f32 v233, v218, v219
    v_add_f32 v232, v232, v220
    v_add_f32 v233, v233, v221
    s_waitcnt lgkmcnt(4)
    v_mfma_f32_16x16x32_bf16 v[120:123], v[52:55], v[96:99], v[120:123]
    ds_read_b64_tr_b16 v[92:93], v47 offset:32768
    v_mfma_f32_16x16x32_bf16 v[120:123], v[60:63], v[100:103], v[120:123]
    ds_read_b64_tr_b16 v[94:95], v47 offset:33024
    v_add_f32 v232, v232, v222
    v_add_f32 v233, v233, v223
    v_add_f32 v232, v232, v224
    v_mfma_f32_16x16x32_bf16 v[124:127], v[56:59], v[96:99], v[124:127]
    ds_read_b64_tr_b16 v[96:97], v47 offset:34816
    v_mfma_f32_16x16x32_bf16 v[124:127], v[64:67], v[100:103], v[124:127]
    ds_read_b64_tr_b16 v[98:99], v47 offset:35072
    s_setprio 0
    v_add_f32 v233, v233, v225
    v_add_f32 v232, v232, v226
    v_add_f32 v233, v233, v227
    s_waitcnt lgkmcnt(4)
    v_mfma_f32_16x16x32_bf16 v[128:131], v[52:55], v[84:87], v[128:131]
    ds_read_b64_tr_b16 v[100:101], v48 offset:32768
    v_mfma_f32_16x16x32_bf16 v[128:131], v[60:63], v[88:91], v[128:131]
    ds_read_b64_tr_b16 v[102:103], v48 offset:33024
    v_add_f32 v232, v232, v228
    v_add_f32 v233, v233, v229
    v_add_f32 v232, v232, v230
    v_mfma_f32_16x16x32_bf16 v[132:135], v[56:59], v[84:87], v[132:135]
    ds_read_b64_tr_b16 v[84:85], v48 offset:34816
    v_mfma_f32_16x16x32_bf16 v[132:135], v[64:67], v[88:91], v[132:135]
    ds_read_b64_tr_b16 v[86:87], v48 offset:35072
    v_add_f32 v233, v233, v231
    v_add_f32 v232, v232, v233
    s_waitcnt lgkmcnt(4)
    v_mfma_f32_16x16x32_bf16 v[136:139], v[92:95], v[52:55], v[136:139]
    s_waitcnt vmcnt(14)
    s_waitcnt vmcnt(10)
    s_barrier
    ds_read_b128 v[68:71], v45 offset:0
    ds_read_b128 v[72:75], v45 offset:2048
    ds_read_b128 v[76:79], v46 offset:0
    ds_read_b128 v[80:83], v46 offset:2048
    ds_read_b64_tr_b16 v[88:89], v47 offset:36864
    v_mfma_f32_16x16x32_bf16 v[136:139], v[96:99], v[60:63], v[136:139]
    ds_read_b64_tr_b16 v[90:91], v47 offset:37120
    s_setprio 3
    s_add_u32 m0, s53, 12288
    s_nop 0
    buffer_load_dwordx4 v20, s[32:35], s52 offen lds
    s_add_u32 s51, s51, 1
    s_and_b32 s51, s51, 15
    s_mul_i32 s52, s51, 393216
    v_add_f32_dpp v232, v232, v232 quad_perm:[1,0,3,2] row_mask:0xf bank_mask:0xf
    s_nop 1
    v_add_f32_dpp v232, v232, v232 quad_perm:[2,3,0,1] row_mask:0xf bank_mask:0xf
    v_mfma_f32_16x16x32_bf16 v[140:143], v[92:95], v[56:59], v[140:143]
    ds_read_b64_tr_b16 v[92:93], v47 offset:38912
    v_mfma_f32_16x16x32_bf16 v[140:143], v[96:99], v[64:67], v[140:143]
    ds_read_b64_tr_b16 v[94:95], v47 offset:39168
    v_add_f32_dpp v232, v232, v232 row_half_mirror row_mask:0xf bank_mask:0xf
    s_nop 1
    v_add_f32_dpp v232, v232, v232 row_mirror row_mask:0xf bank_mask:0xf
    s_waitcnt lgkmcnt(8)
    v_mfma_f32_16x16x32_bf16 v[144:147], v[100:103], v[52:55], v[144:147]
    ds_read_b64_tr_b16 v[96:97], v48 offset:36864
    v_mfma_f32_16x16x32_bf16 v[144:147], v[84:87], v[60:63], v[144:147]
    ds_read_b64_tr_b16 v[98:99], v48 offset:37120
    v_mov_b32 v233, v232
    s_nop 1
    v_permlane16_swap_b32 v232, v233
    v_mfma_f32_16x16x32_bf16 v[148:151], v[100:103], v[56:59], v[148:151]
    ds_read_b64_tr_b16 v[100:101], v48 offset:38912
    v_mfma_f32_16x16x32_bf16 v[148:151], v[84:87], v[64:67], v[148:151]
    ds_read_b64_tr_b16 v[102:103], v48 offset:39168
    s_setprio 2
    v_add_f32 v232, v232, v233
    v_mov_b32 v233, v232
    s_waitcnt lgkmcnt(4)
    v_mfma_f32_16x16x32_bf16 v[104:107], v[88:91], v[68:71], v[104:107]
    ds_read_b64_tr_b16 v[84:85], v47 offset:40960
    v_mfma_f32_16x16x32_bf16 v[104:107], v[92:95], v[76:79], v[104:107]
    ds_read_b64_tr_b16 v[86:87], v47 offset:41216
    s_add_u32 m0, s50, 0
    s_nop 0
    buffer_load_dwordx4 v16, s[28:31], s49 offen lds
    v_permlane32_swap_b32 v232, v233
    v_add_f32 v232, v232, v233
    v_mfma_f32_16x16x32_bf16 v[108:111], v[88:91], v[72:75], v[108:111]
    ds_read_b64_tr_b16 v[88:89], v47 offset:43008
    v_mfma_f32_16x16x32_bf16 v[108:111], v[92:95], v[80:83], v[108:111]
    ds_read_b64_tr_b16 v[90:91], v47 offset:43264
    s_add_u32 m0, s50, 1024
    s_nop 0
    buffer_load_dwordx4 v17, s[28:31], s49 offen lds
    v_mul_f32 v232, 0xba800000, v232
    v_add_f32 v216, v216, v232
    v_add_f32 v217, v217, v232
    s_waitcnt lgkmcnt(4)
    v_mfma_f32_16x16x32_bf16 v[112:115], v[96:99], v[68:71], v[112:115]
    ds_read_b64_tr_b16 v[92:93], v48 offset:40960
    v_mfma_f32_16x16x32_bf16 v[112:115], v[100:103], v[76:79], v[112:115]
    ds_read_b64_tr_b16 v[94:95], v48 offset:41216
    s_setprio 1
    s_add_u32 m0, s50, 2048
    s_nop 0
    buffer_load_dwordx4 v18, s[28:31], s49 offen lds
    v_add_f32 v218, v218, v232
    v_add_f32 v219, v219, v232
    v_add_f32 v220, v220, v232
    v_mfma_f32_16x16x32_bf16 v[116:119], v[96:99], v[72:75], v[116:119]
    ds_read_b64_tr_b16 v[96:97], v48 offset:43008
    v_mfma_f32_16x16x32_bf16 v[116:119], v[100:103], v[80:83], v[116:119]
    ds_read_b64_tr_b16 v[98:99], v48 offset:43264
    s_add_u32 m0, s50, 3072
    s_nop 0
    buffer_load_dwordx4 v19, s[28:31], s49 offen lds
    s_add_u32 s49, s49, 128
    s_and_b32 s49, s49, 2047
    v_add_f32 v221, v221, v232
    v_add_f32 v222, v222, v232
    v_add_f32 v223, v223, v232
    s_waitcnt lgkmcnt(4)
    v_mfma_f32_16x16x32_bf16 v[120:123], v[68:71], v[84:87], v[120:123]
    ds_read_b64_tr_b16 v[100:101], v47 offset:45056
    v_mfma_f32_16x16x32_bf16 v[120:123], v[76:79], v[88:91], v[120:123]
    ds_read_b64_tr_b16 v[102:103], v47 offset:45312
    v_add_f32 v224, v224, v232
    v_add_f32 v225, v225, v232
    v_add_f32 v226, v226, v232
    v_mfma_f32_16x16x32_bf16 v[124:127], v[72:75], v[84:87], v[124:127]
    ds_read_b64_tr_b16 v[84:85], v47 offset:47104
    v_mfma_f32_16x16x32_bf16 v[124:127], v[80:83], v[88:91], v[124:127]
    ds_read_b64_tr_b16 v[86:87], v47 offset:47360
    s_setprio 0
    v_add_f32 v227, v227, v232
    v_add_f32 v228, v228, v232
    v_add_f32 v229, v229, v232
    s_waitcnt lgkmcnt(4)
    v_mfma_f32_16x16x32_bf16 v[128:131], v[68:71], v[92:95], v[128:131]
    ds_read_b64_tr_b16 v[88:89], v48 offset:45056
    v_mfma_f32_16x16x32_bf16 v[128:131], v[76:79], v[96:99], v[128:131]
    ds_read_b64_tr_b16 v[90:91], v48 offset:45312
    v_add_f32 v230, v230, v232
    v_add_f32 v231, v231, v232
    v_mul_f32 v234, v216, v216
    v_mfma_f32_16x16x32_bf16 v[132:135], v[72:75], v[92:95], v[132:135]
    ds_read_b64_tr_b16 v[92:93], v48 offset:47104
    v_mfma_f32_16x16x32_bf16 v[132:135], v[80:83], v[96:99], v[132:135]
    ds_read_b64_tr_b16 v[94:95], v48 offset:47360
    v_mul_f32 v233, v217, v217
    v_fmac_f32 v234, v218, v218
    v_fmac_f32 v233, v219, v219
    s_waitcnt lgkmcnt(4)
    v_mfma_f32_16x16x32_bf16 v[136:139], v[100:103], v[68:71], v[136:139]
    s_waitcnt vmcnt(14)
    s_waitcnt vmcnt(10)
    s_barrier
    ds_read_b128 v[52:55], v45 offset:32768
    ds_read_b128 v[56:59], v45 offset:34816
    ds_read_b128 v[60:63], v46 offset:32768
    ds_read_b128 v[64:67], v46 offset:34816
    ds_read_b64_tr_b16 v[96:97], v47 offset:49152
    v_mfma_f32_16x16x32_bf16 v[136:139], v[84:87], v[76:79], v[136:139]
    ds_read_b64_tr_b16 v[98:99], v47 offset:49408
    s_setprio 3
    s_add_u32 m0, s53, 24576
    s_nop 0
    buffer_load_dwordx4 v20, s[32:35], s52 offen lds
    s_add_u32 s51, s51, 1
    s_and_b32 s51, s51, 15
    s_mul_i32 s52, s51, 393216
    v_fmac_f32 v234, v220, v220
    v_fmac_f32 v233, v221, v221
    v_fmac_f32 v234, v222, v222
    v_mfma_f32_16x16x32_bf16 v[140:143], v[100:103], v[72:75], v[140:143]
    ds_read_b64_tr_b16 v[100:101], v47 offset:51200
    v_mfma_f32_16x16x32_bf16 v[140:143], v[84:87], v[80:83], v[140:143]
    ds_read_b64_tr_b16 v[102:103], v47 offset:51456
    v_fmac_f32 v233, v223, v223
    v_fmac_f32 v234, v224, v224
    v_fmac_f32 v233, v225, v225
    s_waitcnt lgkmcnt(8)
    v_mfma_f32_16x16x32_bf16 v[144:147], v[88:91], v[68:71], v[144:147]
    ds_read_b64_tr_b16 v[84:85], v48 offset:49152
    v_mfma_f32_16x16x32_bf16 v[144:147], v[92:95], v[76:79], v[144:147]
qa_kernel_WS0_3:
    s_cbranch_execz qa_kernel_WS0_11
    ds_read_b64_tr_b16 v[86:87], v48 offset:49408
    v_fmac_f32 v234, v226, v226
    v_fmac_f32 v233, v227, v227
    v_fmac_f32 v234, v228, v228
    v_mfma_f32_16x16x32_bf16 v[148:151], v[88:91], v[72:75], v[148:151]
    ds_read_b64_tr_b16 v[88:89], v48 offset:51200
    v_mfma_f32_16x16x32_bf16 v[148:151], v[92:95], v[80:83], v[148:151]
    ds_read_b64_tr_b16 v[90:91], v48 offset:51456
    s_setprio 2
    v_fmac_f32 v233, v229, v229
    v_fmac_f32 v234, v230, v230
    v_fmac_f32 v233, v231, v231
    s_waitcnt lgkmcnt(4)
    v_mfma_f32_16x16x32_bf16 v[104:107], v[96:99], v[52:55], v[104:107]
    ds_read_b64_tr_b16 v[92:93], v47 offset:53248
    v_mfma_f32_16x16x32_bf16 v[104:107], v[100:103], v[60:63], v[104:107]
    ds_read_b64_tr_b16 v[94:95], v47 offset:53504
    s_add_u32 m0, s50, 32768
    s_nop 0
    buffer_load_dwordx4 v16, s[28:31], s49 offen lds
    v_add_f32 v234, v234, v233
    v_mfma_f32_16x16x32_bf16 v[108:111], v[96:99], v[56:59], v[108:111]
    ds_read_b64_tr_b16 v[96:97], v47 offset:55296
    v_mfma_f32_16x16x32_bf16 v[108:111], v[100:103], v[64:67], v[108:111]
    ds_read_b64_tr_b16 v[98:99], v47 offset:55552
    s_add_u32 m0, s50, 33792
    s_nop 0
    buffer_load_dwordx4 v17, s[28:31], s49 offen lds
    v_add_f32_dpp v234, v234, v234 quad_perm:[1,0,3,2] row_mask:0xf bank_mask:0xf
    s_nop 1
    v_add_f32_dpp v234, v234, v234 quad_perm:[2,3,0,1] row_mask:0xf bank_mask:0xf
    s_waitcnt lgkmcnt(4)
    v_mfma_f32_16x16x32_bf16 v[112:115], v[84:87], v[52:55], v[112:115]
    ds_read_b64_tr_b16 v[100:101], v48 offset:53248
    v_mfma_f32_16x16x32_bf16 v[112:115], v[88:91], v[60:63], v[112:115]
    ds_read_b64_tr_b16 v[102:103], v48 offset:53504
    s_setprio 1
    s_add_u32 m0, s50, 34816
    s_nop 0
    buffer_load_dwordx4 v18, s[28:31], s49 offen lds
    v_add_f32_dpp v234, v234, v234 row_half_mirror row_mask:0xf bank_mask:0xf
    s_nop 1
    v_add_f32_dpp v234, v234, v234 row_mirror row_mask:0xf bank_mask:0xf
    v_mfma_f32_16x16x32_bf16 v[116:119], v[84:87], v[56:59], v[116:119]
    ds_read_b64_tr_b16 v[84:85], v48 offset:55296
    v_mfma_f32_16x16x32_bf16 v[116:119], v[88:91], v[64:67], v[116:119]
    ds_read_b64_tr_b16 v[86:87], v48 offset:55552
    s_add_u32 m0, s50, 35840
    s_nop 0
    buffer_load_dwordx4 v19, s[28:31], s49 offen lds
    s_add_u32 s49, s49, 128
    s_and_b32 s49, s49, 2047
    v_mov_b32 v233, v234
    s_nop 1
    v_permlane16_swap_b32 v234, v233
    s_waitcnt lgkmcnt(4)
    v_mfma_f32_16x16x32_bf16 v[120:123], v[52:55], v[92:95], v[120:123]
    ds_read_b64_tr_b16 v[88:89], v47 offset:57344
    v_mfma_f32_16x16x32_bf16 v[120:123], v[60:63], v[96:99], v[120:123]
    ds_read_b64_tr_b16 v[90:91], v47 offset:57600
    v_add_f32 v234, v234, v233
    v_mov_b32 v233, v234
    v_mfma_f32_16x16x32_bf16 v[124:127], v[56:59], v[92:95], v[124:127]
    ds_read_b64_tr_b16 v[92:93], v47 offset:59392
    v_mfma_f32_16x16x32_bf16 v[124:127], v[64:67], v[96:99], v[124:127]
    ds_read_b64_tr_b16 v[94:95], v47 offset:59648
    s_setprio 0
    v_permlane32_swap_b32 v234, v233
    v_add_f32 v234, v234, v233
    s_waitcnt lgkmcnt(4)
    v_mfma_f32_16x16x32_bf16 v[128:131], v[52:55], v[100:103], v[128:131]
    ds_read_b64_tr_b16 v[96:97], v48 offset:57344
    v_mfma_f32_16x16x32_bf16 v[128:131], v[60:63], v[84:87], v[128:131]
    ds_read_b64_tr_b16 v[98:99], v48 offset:57600
    v_mul_f32 v234, 0x3a800000, v234
    v_add_f32 v234, 0x3727c5ac, v234
    v_mfma_f32_16x16x32_bf16 v[132:135], v[56:59], v[100:103], v[132:135]
    ds_read_b64_tr_b16 v[100:101], v48 offset:59392
    v_mfma_f32_16x16x32_bf16 v[132:135], v[64:67], v[84:87], v[132:135]
    ds_read_b64_tr_b16 v[102:103], v48 offset:59648
    v_rsq_f32 v234, v234
    s_nop 0
    v_mul_f32 v235, v232, v234
    s_lshl_b32 s78, s44, 3
    s_add_u32 s78, s78, s45
    s_mul_i32 s78, s78, 768
    s_add_u32 s78, s78, 65536
    s_mov_b32 exec_lo, 0x00010001
    s_mov_b32 exec_hi, 0x00010001
    buffer_store_dwordx4 v[164:167], v175, s[36:39], s78 offen offset:0 sc1
    buffer_store_dwordx4 v[168:171], v175, s[36:39], s78 offen offset:256 sc1
    s_mov_b64 exec, -1
    s_waitcnt lgkmcnt(4)
    v_mfma_f32_16x16x32_bf16 v[136:139], v[88:91], v[52:55], v[136:139]
    s_waitcnt vmcnt(16)
    s_waitcnt vmcnt(12)
    s_barrier
    ds_read_b128 v[68:71], v49 offset:0
    ds_read_b128 v[72:75], v49 offset:2048
    ds_read_b128 v[76:79], v50 offset:0
    ds_read_b128 v[80:83], v50 offset:2048
    ds_read_b64_tr_b16 v[84:85], v47 offset:0
    v_mfma_f32_16x16x32_bf16 v[136:139], v[92:95], v[60:63], v[136:139]
    ds_read_b64_tr_b16 v[86:87], v47 offset:256
    s_setprio 3
    s_add_u32 m0, s53, 36864
    s_nop 0
    buffer_load_dwordx4 v20, s[32:35], s52 offen lds
    s_add_u32 s51, s51, 1
    s_and_b32 s51, s51, 15
    s_mul_i32 s52, s51, 393216
    buffer_store_dwordx2 v[234:235], v236, s[36:39], s56 offen sc1
    v_mfma_f32_16x16x32_bf16 v[140:143], v[88:91], v[56:59], v[140:143]
    ds_read_b64_tr_b16 v[88:89], v47 offset:2048
    v_mfma_f32_16x16x32_bf16 v[140:143], v[92:95], v[64:67], v[140:143]
    ds_read_b64_tr_b16 v[90:91], v47 offset:2304
    s_waitcnt lgkmcnt(8)
    v_mfma_f32_16x16x32_bf16 v[144:147], v[96:99], v[52:55], v[144:147]
    ds_read_b64_tr_b16 v[92:93], v48 offset:0
    v_mfma_f32_16x16x32_bf16 v[144:147], v[100:103], v[60:63], v[144:147]
    ds_read_b64_tr_b16 v[94:95], v48 offset:256
    v_mfma_f32_16x16x32_bf16 v[148:151], v[96:99], v[56:59], v[148:151]
    ds_read_b64_tr_b16 v[96:97], v48 offset:2048
    v_mfma_f32_16x16x32_bf16 v[148:151], v[100:103], v[64:67], v[148:151]
    ds_read_b64_tr_b16 v[98:99], v48 offset:2304
    s_setprio 2
    s_waitcnt lgkmcnt(4)
    v_mfma_f32_16x16x32_bf16 v[104:107], v[84:87], v[68:71], v[104:107]
    ds_read_b64_tr_b16 v[100:101], v47 offset:4096
    v_mfma_f32_16x16x32_bf16 v[104:107], v[88:91], v[76:79], v[104:107]
    ds_read_b64_tr_b16 v[102:103], v47 offset:4352
    s_add_u32 m0, s50, 65536
    s_nop 0
    buffer_load_dwordx4 v16, s[28:31], s49 offen lds
    v_mfma_f32_16x16x32_bf16 v[108:111], v[84:87], v[72:75], v[108:111]
    ds_read_b64_tr_b16 v[84:85], v47 offset:6144
    v_mfma_f32_16x16x32_bf16 v[108:111], v[88:91], v[80:83], v[108:111]
    ds_read_b64_tr_b16 v[86:87], v47 offset:6400
    s_add_u32 m0, s50, 66560
    s_nop 0
    buffer_load_dwordx4 v17, s[28:31], s49 offen lds
    s_waitcnt lgkmcnt(4)
    v_mfma_f32_16x16x32_bf16 v[112:115], v[92:95], v[68:71], v[112:115]
    ds_read_b64_tr_b16 v[88:89], v48 offset:4096
    v_mfma_f32_16x16x32_bf16 v[112:115], v[96:99], v[76:79], v[112:115]
    ds_read_b64_tr_b16 v[90:91], v48 offset:4352
    s_setprio 1
    s_add_u32 m0, s50, 67584
    s_nop 0
    buffer_load_dwordx4 v18, s[28:31], s49 offen lds
    v_mfma_f32_16x16x32_bf16 v[116:119], v[92:95], v[72:75], v[116:119]
    ds_read_b64_tr_b16 v[92:93], v48 offset:6144
    v_mfma_f32_16x16x32_bf16 v[116:119], v[96:99], v[80:83], v[116:119]
    ds_read_b64_tr_b16 v[94:95], v48 offset:6400
    s_add_u32 m0, s50, 68608
    s_nop 0
    buffer_load_dwordx4 v19, s[28:31], s49 offen lds
    s_add_u32 s49, s49, 128
    s_and_b32 s49, s49, 2047
    s_waitcnt lgkmcnt(4)
    v_mfma_f32_16x16x32_bf16 v[120:123], v[68:71], v[100:103], v[120:123]
    ds_read_b64_tr_b16 v[96:97], v47 offset:8192
    v_mfma_f32_16x16x32_bf16 v[120:123], v[76:79], v[84:87], v[120:123]
    ds_read_b64_tr_b16 v[98:99], v47 offset:8448
    v_mfma_f32_16x16x32_bf16 v[124:127], v[72:75], v[100:103], v[124:127]
    ds_read_b64_tr_b16 v[100:101], v47 offset:10240
    v_mfma_f32_16x16x32_bf16 v[124:127], v[80:83], v[84:87], v[124:127]
    ds_read_b64_tr_b16 v[102:103], v47 offset:10496
    s_setprio 0
    s_waitcnt lgkmcnt(4)
    v_mfma_f32_16x16x32_bf16 v[128:131], v[68:71], v[88:91], v[128:131]
    ds_read_b64_tr_b16 v[84:85], v48 offset:8192
    v_mfma_f32_16x16x32_bf16 v[128:131], v[76:79], v[92:95], v[128:131]
    ds_read_b64_tr_b16 v[86:87], v48 offset:8448
    v_mfma_f32_16x16x32_bf16 v[132:135], v[72:75], v[88:91], v[132:135]
    ds_read_b64_tr_b16 v[88:89], v48 offset:10240
    v_mfma_f32_16x16x32_bf16 v[132:135], v[80:83], v[92:95], v[132:135]
    ds_read_b64_tr_b16 v[90:91], v48 offset:10496
    s_waitcnt lgkmcnt(4)
    v_mfma_f32_16x16x32_bf16 v[136:139], v[96:99], v[68:71], v[136:139]
    s_waitcnt vmcnt(17)
    s_waitcnt vmcnt(13)
    s_waitcnt vmcnt(4)
    s_barrier
    ds_read_b128 v[52:55], v45 offset:0
    ds_read_b128 v[56:59], v45 offset:2048
    ds_read_b128 v[60:63], v46 offset:0
    ds_read_b128 v[64:67], v46 offset:2048
    ds_read_b64_tr_b16 v[92:93], v47 offset:12288
    v_mfma_f32_16x16x32_bf16 v[136:139], v[100:103], v[76:79], v[136:139]
    ds_read_b64_tr_b16 v[94:95], v47 offset:12544
    s_setprio 3
    s_add_u32 m0, s53, 49152
    s_nop 0
    buffer_load_dwordx4 v20, s[32:35], s52 offen lds
    s_add_u32 s51, s51, 1
    s_and_b32 s51, s51, 15
    s_mul_i32 s52, s51, 393216
    v_mfma_f32_16x16x32_bf16 v[140:143], v[96:99], v[72:75], v[140:143]
    ds_read_b64_tr_b16 v[96:97], v47 offset:14336
    v_mfma_f32_16x16x32_bf16 v[140:143], v[100:103], v[80:83], v[140:143]
    ds_read_b64_tr_b16 v[98:99], v47 offset:14592
    s_waitcnt lgkmcnt(8)
    v_mfma_f32_16x16x32_bf16 v[144:147], v[84:87], v[68:71], v[144:147]
    ds_read_b64_tr_b16 v[100:101], v48 offset:12288
    v_mfma_f32_16x16x32_bf16 v[144:147], v[88:91], v[76:79], v[144:147]
    ds_read_b64_tr_b16 v[102:103], v48 offset:12544
    v_mfma_f32_16x16x32_bf16 v[148:151], v[84:87], v[72:75], v[148:151]
    ds_read_b64_tr_b16 v[84:85], v48 offset:14336
    v_mfma_f32_16x16x32_bf16 v[148:151], v[88:91], v[80:83], v[148:151]
    ds_read_b64_tr_b16 v[86:87], v48 offset:14592
    s_setprio 2
    s_waitcnt lgkmcnt(4)
    v_mfma_f32_16x16x32_bf16 v[104:107], v[92:95], v[52:55], v[104:107]
    ds_read_b64_tr_b16 v[88:89], v47 offset:16384
    v_mfma_f32_16x16x32_bf16 v[104:107], v[96:99], v[60:63], v[104:107]
    ds_read_b64_tr_b16 v[90:91], v47 offset:16640
    s_add_u32 m0, s50, 0
    s_nop 0
    buffer_load_dwordx4 v16, s[28:31], s49 offen lds
    v_mfma_f32_16x16x32_bf16 v[108:111], v[92:95], v[56:59], v[108:111]
    ds_read_b64_tr_b16 v[92:93], v47 offset:18432
    v_mfma_f32_16x16x32_bf16 v[108:111], v[96:99], v[64:67], v[108:111]
    ds_read_b64_tr_b16 v[94:95], v47 offset:18688
    s_add_u32 m0, s50, 1024
    s_nop 0
    buffer_load_dwordx4 v17, s[28:31], s49 offen lds
    s_waitcnt lgkmcnt(4)
    v_mfma_f32_16x16x32_bf16 v[112:115], v[100:103], v[52:55], v[112:115]
    ds_read_b64_tr_b16 v[96:97], v48 offset:16384
    v_mfma_f32_16x16x32_bf16 v[112:115], v[84:87], v[60:63], v[112:115]
    ds_read_b64_tr_b16 v[98:99], v48 offset:16640
    s_setprio 1
    s_add_u32 m0, s50, 2048
    s_nop 0
    buffer_load_dwordx4 v18, s[28:31], s49 offen lds
    v_mfma_f32_16x16x32_bf16 v[116:119], v[100:103], v[56:59], v[116:119]
    ds_read_b64_tr_b16 v[100:101], v48 offset:18432
    v_mfma_f32_16x16x32_bf16 v[116:119], v[84:87], v[64:67], v[116:119]
    ds_read_b64_tr_b16 v[102:103], v48 offset:18688
    s_add_u32 m0, s50, 3072
    s_nop 0
    buffer_load_dwordx4 v19, s[28:31], s49 offen lds
    s_add_u32 s49, s49, 128
    s_and_b32 s49, s49, 2047
    s_waitcnt lgkmcnt(4)
    v_mfma_f32_16x16x32_bf16 v[120:123], v[52:55], v[88:91], v[120:123]
    ds_read_b64_tr_b16 v[84:85], v47 offset:20480
    v_mfma_f32_16x16x32_bf16 v[120:123], v[60:63], v[92:95], v[120:123]
    ds_read_b64_tr_b16 v[86:87], v47 offset:20736
    v_mfma_f32_16x16x32_bf16 v[124:127], v[56:59], v[88:91], v[124:127]
    ds_read_b64_tr_b16 v[88:89], v47 offset:22528
    v_mfma_f32_16x16x32_bf16 v[124:127], v[64:67], v[92:95], v[124:127]
    ds_read_b64_tr_b16 v[90:91], v47 offset:22784
    s_setprio 0
    s_waitcnt lgkmcnt(4)
    v_mfma_f32_16x16x32_bf16 v[128:131], v[52:55], v[96:99], v[128:131]
    ds_read_b64_tr_b16 v[92:93], v48 offset:20480
    v_mfma_f32_16x16x32_bf16 v[128:131], v[60:63], v[100:103], v[128:131]
    ds_read_b64_tr_b16 v[94:95], v48 offset:20736
    v_mfma_f32_16x16x32_bf16 v[132:135], v[56:59], v[96:99], v[132:135]
    ds_read_b64_tr_b16 v[96:97], v48 offset:22528
    v_mfma_f32_16x16x32_bf16 v[132:135], v[64:67], v[100:103], v[132:135]
    ds_read_b64_tr_b16 v[98:99], v48 offset:22784
    s_waitcnt lgkmcnt(4)
    v_mfma_f32_16x16x32_bf16 v[136:139], v[84:87], v[52:55], v[136:139]
    s_barrier
    ds_read_b128 v[68:71], v45 offset:32768
    ds_read_b128 v[72:75], v45 offset:34816
    ds_read_b128 v[76:79], v46 offset:32768
    ds_read_b128 v[80:83], v46 offset:34816
    ds_read_b64_tr_b16 v[100:101], v47 offset:24576
    v_mfma_f32_16x16x32_bf16 v[136:139], v[88:91], v[60:63], v[136:139]
    ds_read_b64_tr_b16 v[102:103], v47 offset:24832
    s_setprio 3
    s_add_u32 m0, s53, 0
    s_nop 0
    buffer_load_dwordx4 v20, s[32:35], s52 offen lds
    s_add_u32 s51, s51, 1
    s_and_b32 s51, s51, 15
    s_mul_i32 s52, s51, 393216
    v_mfma_f32_16x16x32_bf16 v[140:143], v[84:87], v[56:59], v[140:143]
    ds_read_b64_tr_b16 v[84:85], v47 offset:26624
    v_mfma_f32_16x16x32_bf16 v[140:143], v[88:91], v[64:67], v[140:143]
    ds_read_b64_tr_b16 v[86:87], v47 offset:26880
    s_waitcnt lgkmcnt(8)
    v_mfma_f32_16x16x32_bf16 v[144:147], v[92:95], v[52:55], v[144:147]
    ds_read_b64_tr_b16 v[88:89], v48 offset:24576
    v_mfma_f32_16x16x32_bf16 v[144:147], v[96:99], v[60:63], v[144:147]
    ds_read_b64_tr_b16 v[90:91], v48 offset:24832
    v_mfma_f32_16x16x32_bf16 v[148:151], v[92:95], v[56:59], v[148:151]
    ds_read_b64_tr_b16 v[92:93], v48 offset:26624
    v_mfma_f32_16x16x32_bf16 v[148:151], v[96:99], v[64:67], v[148:151]
    ds_read_b64_tr_b16 v[94:95], v48 offset:26880
    s_setprio 2
    s_waitcnt lgkmcnt(4)
    v_mfma_f32_16x16x32_bf16 v[104:107], v[100:103], v[68:71], v[104:107]
    ds_read_b64_tr_b16 v[96:97], v47 offset:28672
    v_mfma_f32_16x16x32_bf16 v[104:107], v[84:87], v[76:79], v[104:107]
    ds_read_b64_tr_b16 v[98:99], v47 offset:28928
    s_add_u32 m0, s50, 32768
    s_nop 0
    buffer_load_dwordx4 v16, s[28:31], s49 offen lds
    v_mfma_f32_16x16x32_bf16 v[108:111], v[100:103], v[72:75], v[108:111]
    ds_read_b64_tr_b16 v[100:101], v47 offset:30720
    v_mfma_f32_16x16x32_bf16 v[108:111], v[84:87], v[80:83], v[108:111]
    ds_read_b64_tr_b16 v[102:103], v47 offset:30976
    s_add_u32 m0, s50, 33792
    s_nop 0
    buffer_load_dwordx4 v17, s[28:31], s49 offen lds
    s_waitcnt lgkmcnt(4)
    v_mfma_f32_16x16x32_bf16 v[112:115], v[88:91], v[68:71], v[112:115]
    ds_read_b64_tr_b16 v[84:85], v48 offset:28672
    v_mfma_f32_16x16x32_bf16 v[112:115], v[92:95], v[76:79], v[112:115]
    ds_read_b64_tr_b16 v[86:87], v48 offset:28928
    s_setprio 1
    s_add_u32 m0, s50, 34816
    s_nop 0
    buffer_load_dwordx4 v18, s[28:31], s49 offen lds
    v_mfma_f32_16x16x32_bf16 v[116:119], v[88:91], v[72:75], v[116:119]
    ds_read_b64_tr_b16 v[88:89], v48 offset:30720
    v_mfma_f32_16x16x32_bf16 v[116:119], v[92:95], v[80:83], v[116:119]
    ds_read_b64_tr_b16 v[90:91], v48 offset:30976
    s_add_u32 m0, s50, 35840
    s_nop 0
    buffer_load_dwordx4 v19, s[28:31], s49 offen lds
    s_add_u32 s49, s49, 128
    s_and_b32 s49, s49, 2047
    s_waitcnt lgkmcnt(4)
    v_mfma_f32_16x16x32_bf16 v[120:123], v[68:71], v[96:99], v[120:123]
    ds_read_b64_tr_b16 v[92:93], v47 offset:32768
    v_mfma_f32_16x16x32_bf16 v[120:123], v[76:79], v[100:103], v[120:123]
    ds_read_b64_tr_b16 v[94:95], v47 offset:33024
    v_mfma_f32_16x16x32_bf16 v[124:127], v[72:75], v[96:99], v[124:127]
    ds_read_b64_tr_b16 v[96:97], v47 offset:34816
    v_mfma_f32_16x16x32_bf16 v[124:127], v[80:83], v[100:103], v[124:127]
    ds_read_b64_tr_b16 v[98:99], v47 offset:35072
    s_setprio 0
    s_waitcnt lgkmcnt(4)
    v_mfma_f32_16x16x32_bf16 v[128:131], v[68:71], v[84:87], v[128:131]
    ds_read_b64_tr_b16 v[100:101], v48 offset:32768
    v_mfma_f32_16x16x32_bf16 v[128:131], v[76:79], v[88:91], v[128:131]
    ds_read_b64_tr_b16 v[102:103], v48 offset:33024
    v_mfma_f32_16x16x32_bf16 v[132:135], v[72:75], v[84:87], v[132:135]
    ds_read_b64_tr_b16 v[84:85], v48 offset:34816
    v_mfma_f32_16x16x32_bf16 v[132:135], v[80:83], v[88:91], v[132:135]
    ds_read_b64_tr_b16 v[86:87], v48 offset:35072
    s_waitcnt lgkmcnt(4)
    v_mfma_f32_16x16x32_bf16 v[136:139], v[92:95], v[68:71], v[136:139]
    s_waitcnt vmcnt(10)
    s_barrier
    ds_read_b128 v[52:55], v49 offset:0
    ds_read_b128 v[56:59], v49 offset:2048
    ds_read_b128 v[60:63], v50 offset:0
    ds_read_b128 v[64:67], v50 offset:2048
    ds_read_b64_tr_b16 v[88:89], v47 offset:36864
    v_mfma_f32_16x16x32_bf16 v[136:139], v[96:99], v[76:79], v[136:139]
    ds_read_b64_tr_b16 v[90:91], v47 offset:37120
    s_setprio 3
    s_add_u32 m0, s53, 12288
    s_nop 0
    buffer_load_dwordx4 v20, s[32:35], s52 offen lds
    s_add_u32 s51, s51, 1
    s_and_b32 s51, s51, 15
    s_mul_i32 s52, s51, 393216
    v_mfma_f32_16x16x32_bf16 v[140:143], v[92:95], v[72:75], v[140:143]
    ds_read_b64_tr_b16 v[92:93], v47 offset:38912
    v_mfma_f32_16x16x32_bf16 v[140:143], v[96:99], v[80:83], v[140:143]
    ds_read_b64_tr_b16 v[94:95], v47 offset:39168
    s_waitcnt lgkmcnt(8)
    v_mfma_f32_16x16x32_bf16 v[144:147], v[100:103], v[68:71], v[144:147]
    ds_read_b64_tr_b16 v[96:97], v48 offset:36864
    v_mfma_f32_16x16x32_bf16 v[144:147], v[84:87], v[76:79], v[144:147]
    ds_read_b64_tr_b16 v[98:99], v48 offset:37120
    v_mfma_f32_16x16x32_bf16 v[148:151], v[100:103], v[72:75], v[148:151]
    ds_read_b64_tr_b16 v[100:101], v48 offset:38912
    v_mfma_f32_16x16x32_bf16 v[148:151], v[84:87], v[80:83], v[148:151]
    ds_read_b64_tr_b16 v[102:103], v48 offset:39168
    s_setprio 2
    s_waitcnt lgkmcnt(4)
    v_mfma_f32_16x16x32_bf16 v[104:107], v[88:91], v[52:55], v[104:107]
    ds_read_b64_tr_b16 v[84:85], v47 offset:40960
    v_mfma_f32_16x16x32_bf16 v[104:107], v[92:95], v[60:63], v[104:107]
    ds_read_b64_tr_b16 v[86:87], v47 offset:41216
    s_add_u32 m0, s50, 65536
    s_nop 0
    buffer_load_dwordx4 v16, s[28:31], s49 offen lds
    v_mfma_f32_16x16x32_bf16 v[108:111], v[88:91], v[56:59], v[108:111]
    ds_read_b64_tr_b16 v[88:89], v47 offset:43008
    v_mfma_f32_16x16x32_bf16 v[108:111], v[92:95], v[64:67], v[108:111]
    ds_read_b64_tr_b16 v[90:91], v47 offset:43264
    s_add_u32 m0, s50, 66560
    s_nop 0
    buffer_load_dwordx4 v17, s[28:31], s49 offen lds
    s_waitcnt lgkmcnt(4)
    v_mfma_f32_16x16x32_bf16 v[112:115], v[96:99], v[52:55], v[112:115]
    ds_read_b64_tr_b16 v[92:93], v48 offset:40960
    v_mfma_f32_16x16x32_bf16 v[112:115], v[100:103], v[60:63], v[112:115]
    ds_read_b64_tr_b16 v[94:95], v48 offset:41216
    s_setprio 1
    s_add_u32 m0, s50, 67584
    s_nop 0
    buffer_load_dwordx4 v18, s[28:31], s49 offen lds
    v_mfma_f32_16x16x32_bf16 v[116:119], v[96:99], v[56:59], v[116:119]
    ds_read_b64_tr_b16 v[96:97], v48 offset:43008
    v_mfma_f32_16x16x32_bf16 v[116:119], v[100:103], v[64:67], v[116:119]
    ds_read_b64_tr_b16 v[98:99], v48 offset:43264
    s_add_u32 m0, s50, 68608
    s_nop 0
    buffer_load_dwordx4 v19, s[28:31], s49 offen lds
    s_add_u32 s49, s49, 128
    s_and_b32 s49, s49, 2047
    s_waitcnt lgkmcnt(4)
    v_mfma_f32_16x16x32_bf16 v[120:123], v[52:55], v[84:87], v[120:123]
    ds_read_b64_tr_b16 v[100:101], v47 offset:45056
    v_mfma_f32_16x16x32_bf16 v[120:123], v[60:63], v[88:91], v[120:123]
    ds_read_b64_tr_b16 v[102:103], v47 offset:45312
    v_mfma_f32_16x16x32_bf16 v[124:127], v[56:59], v[84:87], v[124:127]
    ds_read_b64_tr_b16 v[84:85], v47 offset:47104
    v_mfma_f32_16x16x32_bf16 v[124:127], v[64:67], v[88:91], v[124:127]
    ds_read_b64_tr_b16 v[86:87], v47 offset:47360
    s_setprio 0
    s_waitcnt lgkmcnt(4)
    v_mfma_f32_16x16x32_bf16 v[128:131], v[52:55], v[92:95], v[128:131]
    ds_read_b64_tr_b16 v[88:89], v48 offset:45056
    v_mfma_f32_16x16x32_bf16 v[128:131], v[60:63], v[96:99], v[128:131]
    ds_read_b64_tr_b16 v[90:91], v48 offset:45312
    v_mfma_f32_16x16x32_bf16 v[132:135], v[56:59], v[92:95], v[132:135]
    ds_read_b64_tr_b16 v[92:93], v48 offset:47104
    v_mfma_f32_16x16x32_bf16 v[132:135], v[64:67], v[96:99], v[132:135]
    ds_read_b64_tr_b16 v[94:95], v48 offset:47360
    s_waitcnt lgkmcnt(4)
    v_mfma_f32_16x16x32_bf16 v[136:139], v[100:103], v[52:55], v[136:139]
    s_waitcnt vmcnt(14)
    s_waitcnt vmcnt(10)
    s_barrier
    ds_read_b128 v[68:71], v45 offset:0
    ds_read_b128 v[72:75], v45 offset:2048
    ds_read_b128 v[76:79], v46 offset:0
    ds_read_b128 v[80:83], v46 offset:2048
    ds_read_b64_tr_b16 v[96:97], v47 offset:49152
    v_mfma_f32_16x16x32_bf16 v[136:139], v[84:87], v[60:63], v[136:139]
    ds_read_b64_tr_b16 v[98:99], v47 offset:49408
    s_setprio 3
    s_add_u32 m0, s53, 24576
    s_nop 0
    buffer_load_dwordx4 v20, s[32:35], s52 offen lds
    s_add_u32 s51, s51, 1
    s_and_b32 s51, s51, 15
    s_mul_i32 s52, s51, 393216
    v_mfma_f32_16x16x32_bf16 v[140:143], v[100:103], v[56:59], v[140:143]
    ds_read_b64_tr_b16 v[100:101], v47 offset:51200
    v_mfma_f32_16x16x32_bf16 v[140:143], v[84:87], v[64:67], v[140:143]
    ds_read_b64_tr_b16 v[102:103], v47 offset:51456
    s_waitcnt lgkmcnt(8)
    v_mfma_f32_16x16x32_bf16 v[144:147], v[88:91], v[52:55], v[144:147]
    ds_read_b64_tr_b16 v[84:85], v48 offset:49152
    v_mfma_f32_16x16x32_bf16 v[144:147], v[92:95], v[60:63], v[144:147]
    ds_read_b64_tr_b16 v[86:87], v48 offset:49408
    v_mfma_f32_16x16x32_bf16 v[148:151], v[88:91], v[56:59], v[148:151]
    ds_read_b64_tr_b16 v[88:89], v48 offset:51200
    v_mfma_f32_16x16x32_bf16 v[148:151], v[92:95], v[64:67], v[148:151]
    ds_read_b64_tr_b16 v[90:91], v48 offset:51456
    s_setprio 2
    s_waitcnt lgkmcnt(4)
    v_mfma_f32_16x16x32_bf16 v[104:107], v[96:99], v[68:71], v[104:107]
    ds_read_b64_tr_b16 v[92:93], v47 offset:53248
    v_mfma_f32_16x16x32_bf16 v[104:107], v[100:103], v[76:79], v[104:107]
    ds_read_b64_tr_b16 v[94:95], v47 offset:53504
    s_add_u32 m0, s50, 0
    s_nop 0
    buffer_load_dwordx4 v16, s[28:31], s49 offen lds
    v_mfma_f32_16x16x32_bf16 v[108:111], v[96:99], v[72:75], v[108:111]
    ds_read_b64_tr_b16 v[96:97], v47 offset:55296
    v_mfma_f32_16x16x32_bf16 v[108:111], v[100:103], v[80:83], v[108:111]
    ds_read_b64_tr_b16 v[98:99], v47 offset:55552
    s_add_u32 m0, s50, 1024
    s_nop 0
    buffer_load_dwordx4 v17, s[28:31], s49 offen lds
    s_waitcnt lgkmcnt(4)
    v_mfma_f32_16x16x32_bf16 v[112:115], v[84:87], v[68:71], v[112:115]
    ds_read_b64_tr_b16 v[100:101], v48 offset:53248
    v_mfma_f32_16x16x32_bf16 v[112:115], v[88:91], v[76:79], v[112:115]
    ds_read_b64_tr_b16 v[102:103], v48 offset:53504
    s_setprio 1
    s_add_u32 m0, s50, 2048
    s_nop 0
    buffer_load_dwordx4 v18, s[28:31], s49 offen lds
    v_mfma_f32_16x16x32_bf16 v[116:119], v[84:87], v[72:75], v[116:119]
    ds_read_b64_tr_b16 v[84:85], v48 offset:55296
    v_mfma_f32_16x16x32_bf16 v[116:119], v[88:91], v[80:83], v[116:119]
    ds_read_b64_tr_b16 v[86:87], v48 offset:55552
    s_add_u32 m0, s50, 3072
    s_nop 0
    buffer_load_dwordx4 v19, s[28:31], s49 offen lds
    s_add_u32 s49, s49, 128
    s_and_b32 s49, s49, 2047
    s_waitcnt lgkmcnt(4)
    v_mfma_f32_16x16x32_bf16 v[120:123], v[68:71], v[92:95], v[120:123]
    ds_read_b64_tr_b16 v[88:89], v47 offset:57344
    v_mfma_f32_16x16x32_bf16 v[120:123], v[76:79], v[96:99], v[120:123]
    ds_read_b64_tr_b16 v[90:91], v47 offset:57600
    v_mfma_f32_16x16x32_bf16 v[124:127], v[72:75], v[92:95], v[124:127]
    ds_read_b64_tr_b16 v[92:93], v47 offset:59392
    v_mfma_f32_16x16x32_bf16 v[124:127], v[80:83], v[96:99], v[124:127]
    ds_read_b64_tr_b16 v[94:95], v47 offset:59648
    s_setprio 0
    s_waitcnt lgkmcnt(4)
    v_mfma_f32_16x16x32_bf16 v[128:131], v[68:71], v[100:103], v[128:131]
    ds_read_b64_tr_b16 v[96:97], v48 offset:57344
    v_mfma_f32_16x16x32_bf16 v[128:131], v[76:79], v[84:87], v[128:131]
    ds_read_b64_tr_b16 v[98:99], v48 offset:57600
    v_mfma_f32_16x16x32_bf16 v[132:135], v[72:75], v[100:103], v[132:135]
    ds_read_b64_tr_b16 v[100:101], v48 offset:59392
    v_mfma_f32_16x16x32_bf16 v[132:135], v[80:83], v[84:87], v[132:135]
    ds_read_b64_tr_b16 v[102:103], v48 offset:59648
    s_waitcnt lgkmcnt(4)
    v_mfma_f32_16x16x32_bf16 v[136:139], v[88:91], v[68:71], v[136:139]
    s_waitcnt vmcnt(14)
    s_waitcnt vmcnt(10)
    s_barrier
    ds_read_b128 v[52:55], v45 offset:32768
    ds_read_b128 v[56:59], v45 offset:34816
    ds_read_b128 v[60:63], v46 offset:32768
    ds_read_b128 v[64:67], v46 offset:34816
    ds_read_b64_tr_b16 v[84:85], v47 offset:0
    v_mfma_f32_16x16x32_bf16 v[136:139], v[92:95], v[76:79], v[136:139]
    ds_read_b64_tr_b16 v[86:87], v47 offset:256
    s_setprio 3
    s_add_u32 m0, s53, 36864
    s_nop 0
    buffer_load_dwordx4 v20, s[32:35], s52 offen lds
    s_add_u32 s51, s51, 1
    s_and_b32 s51, s51, 15
    s_mul_i32 s52, s51, 393216
    v_mfma_f32_16x16x32_bf16 v[140:143], v[88:91], v[72:75], v[140:143]
    ds_read_b64_tr_b16 v[88:89], v47 offset:2048
    v_mfma_f32_16x16x32_bf16 v[140:143], v[92:95], v[80:83], v[140:143]
    ds_read_b64_tr_b16 v[90:91], v47 offset:2304
    s_waitcnt lgkmcnt(8)
    v_mfma_f32_16x16x32_bf16 v[144:147], v[96:99], v[68:71], v[144:147]
    ds_read_b64_tr_b16 v[92:93], v48 offset:0
    v_mfma_f32_16x16x32_bf16 v[144:147], v[100:103], v[76:79], v[144:147]
    ds_read_b64_tr_b16 v[94:95], v48 offset:256
    v_mfma_f32_16x16x32_bf16 v[148:151], v[96:99], v[72:75], v[148:151]
    ds_read_b64_tr_b16 v[96:97], v48 offset:2048
    v_mfma_f32_16x16x32_bf16 v[148:151], v[100:103], v[80:83], v[148:151]
    ds_read_b64_tr_b16 v[98:99], v48 offset:2304
    s_setprio 2
    s_waitcnt lgkmcnt(4)
    v_mfma_f32_16x16x32_bf16 v[104:107], v[84:87], v[52:55], v[104:107]
    ds_read_b64_tr_b16 v[100:101], v47 offset:4096
    v_mfma_f32_16x16x32_bf16 v[104:107], v[88:91], v[60:63], v[104:107]
    ds_read_b64_tr_b16 v[102:103], v47 offset:4352
    s_add_u32 m0, s50, 32768
    s_nop 0
    buffer_load_dwordx4 v16, s[28:31], s49 offen lds
    v_mfma_f32_16x16x32_bf16 v[108:111], v[84:87], v[56:59], v[108:111]
    ds_read_b64_tr_b16 v[84:85], v47 offset:6144
    v_mfma_f32_16x16x32_bf16 v[108:111], v[88:91], v[64:67], v[108:111]
    ds_read_b64_tr_b16 v[86:87], v47 offset:6400
    s_add_u32 m0, s50, 33792
    s_nop 0
    buffer_load_dwordx4 v17, s[28:31], s49 offen lds
    s_waitcnt lgkmcnt(4)
    v_mfma_f32_16x16x32_bf16 v[112:115], v[92:95], v[52:55], v[112:115]
    ds_read_b64_tr_b16 v[88:89], v48 offset:4096
    v_mfma_f32_16x16x32_bf16 v[112:115], v[96:99], v[60:63], v[112:115]
    ds_read_b64_tr_b16 v[90:91], v48 offset:4352
    s_setprio 1
    s_add_u32 m0, s50, 34816
    s_nop 0
    buffer_load_dwordx4 v18, s[28:31], s49 offen lds
    v_mfma_f32_16x16x32_bf16 v[116:119], v[92:95], v[56:59], v[116:119]
    ds_read_b64_tr_b16 v[92:93], v48 offset:6144
    v_mfma_f32_16x16x32_bf16 v[116:119], v[96:99], v[64:67], v[116:119]
    ds_read_b64_tr_b16 v[94:95], v48 offset:6400
    s_add_u32 m0, s50, 35840
    s_nop 0
    buffer_load_dwordx4 v19, s[28:31], s49 offen lds
    s_add_u32 s49, s49, 128
    s_and_b32 s49, s49, 2047
    s_waitcnt lgkmcnt(4)
    v_mfma_f32_16x16x32_bf16 v[120:123], v[52:55], v[100:103], v[120:123]
    ds_read_b64_tr_b16 v[96:97], v47 offset:8192
    v_mfma_f32_16x16x32_bf16 v[120:123], v[60:63], v[84:87], v[120:123]
    ds_read_b64_tr_b16 v[98:99], v47 offset:8448
qa_kernel_WS0_4:
    s_cbranch_execz qa_kernel_WRET0
    v_mfma_f32_16x16x32_bf16 v[124:127], v[56:59], v[100:103], v[124:127]
    ds_read_b64_tr_b16 v[100:101], v47 offset:10240
    v_mfma_f32_16x16x32_bf16 v[124:127], v[64:67], v[84:87], v[124:127]
    ds_read_b64_tr_b16 v[102:103], v47 offset:10496
    s_setprio 0
    s_waitcnt lgkmcnt(4)
    v_mfma_f32_16x16x32_bf16 v[128:131], v[52:55], v[88:91], v[128:131]
    ds_read_b64_tr_b16 v[84:85], v48 offset:8192
    v_mfma_f32_16x16x32_bf16 v[128:131], v[60:63], v[92:95], v[128:131]
    ds_read_b64_tr_b16 v[86:87], v48 offset:8448
    v_mfma_f32_16x16x32_bf16 v[132:135], v[56:59], v[88:91], v[132:135]
    ds_read_b64_tr_b16 v[88:89], v48 offset:10240
    v_mfma_f32_16x16x32_bf16 v[132:135], v[64:67], v[92:95], v[132:135]
    ds_read_b64_tr_b16 v[90:91], v48 offset:10496
    s_waitcnt lgkmcnt(4)
    v_mfma_f32_16x16x32_bf16 v[136:139], v[96:99], v[52:55], v[136:139]
    s_waitcnt vmcnt(14)
    s_waitcnt vmcnt(10)
    s_barrier
    ds_read_b128 v[68:71], v49 offset:0
    ds_read_b128 v[72:75], v49 offset:2048
    ds_read_b128 v[76:79], v50 offset:0
    ds_read_b128 v[80:83], v50 offset:2048
    ds_read_b64_tr_b16 v[92:93], v47 offset:12288
    v_mfma_f32_16x16x32_bf16 v[136:139], v[100:103], v[60:63], v[136:139]
    ds_read_b64_tr_b16 v[94:95], v47 offset:12544
    s_setprio 3
    s_add_u32 m0, s53, 49152
    s_nop 0
    buffer_load_dwordx4 v20, s[32:35], s52 offen lds
    s_add_u32 s51, s51, 1
    s_and_b32 s51, s51, 15
    s_mul_i32 s52, s51, 393216
    v_mfma_f32_16x16x32_bf16 v[140:143], v[96:99], v[56:59], v[140:143]
    ds_read_b64_tr_b16 v[96:97], v47 offset:14336
    v_mfma_f32_16x16x32_bf16 v[140:143], v[100:103], v[64:67], v[140:143]
    ds_read_b64_tr_b16 v[98:99], v47 offset:14592
    s_waitcnt lgkmcnt(8)
    v_mfma_f32_16x16x32_bf16 v[144:147], v[84:87], v[52:55], v[144:147]
    ds_read_b64_tr_b16 v[100:101], v48 offset:12288
    v_mfma_f32_16x16x32_bf16 v[144:147], v[88:91], v[60:63], v[144:147]
    ds_read_b64_tr_b16 v[102:103], v48 offset:12544
    v_mfma_f32_16x16x32_bf16 v[148:151], v[84:87], v[56:59], v[148:151]
    ds_read_b64_tr_b16 v[84:85], v48 offset:14336
    v_mfma_f32_16x16x32_bf16 v[148:151], v[88:91], v[64:67], v[148:151]
    ds_read_b64_tr_b16 v[86:87], v48 offset:14592
    s_setprio 2
    s_waitcnt lgkmcnt(4)
    v_mfma_f32_16x16x32_bf16 v[104:107], v[92:95], v[68:71], v[104:107]
    ds_read_b64_tr_b16 v[88:89], v47 offset:16384
    v_mfma_f32_16x16x32_bf16 v[104:107], v[96:99], v[76:79], v[104:107]
    ds_read_b64_tr_b16 v[90:91], v47 offset:16640
    s_add_u32 m0, s50, 65536
    s_nop 0
    buffer_load_dwordx4 v16, s[28:31], s49 offen lds
    v_mfma_f32_16x16x32_bf16 v[108:111], v[92:95], v[72:75], v[108:111]
    ds_read_b64_tr_b16 v[92:93], v47 offset:18432
    v_mfma_f32_16x16x32_bf16 v[108:111], v[96:99], v[80:83], v[108:111]
    ds_read_b64_tr_b16 v[94:95], v47 offset:18688
    s_add_u32 m0, s50, 66560
    s_nop 0
    buffer_load_dwordx4 v17, s[28:31], s49 offen lds
    s_waitcnt lgkmcnt(4)
    v_mfma_f32_16x16x32_bf16 v[112:115], v[100:103], v[68:71], v[112:115]
    ds_read_b64_tr_b16 v[96:97], v48 offset:16384
    v_mfma_f32_16x16x32_bf16 v[112:115], v[84:87], v[76:79], v[112:115]
    ds_read_b64_tr_b16 v[98:99], v48 offset:16640
    s_setprio 1
    s_add_u32 m0, s50, 67584
    s_nop 0
    buffer_load_dwordx4 v18, s[28:31], s49 offen lds
    v_mfma_f32_16x16x32_bf16 v[116:119], v[100:103], v[72:75], v[116:119]
    ds_read_b64_tr_b16 v[100:101], v48 offset:18432
    v_mfma_f32_16x16x32_bf16 v[116:119], v[84:87], v[80:83], v[116:119]
    ds_read_b64_tr_b16 v[102:103], v48 offset:18688
    s_add_u32 m0, s50, 68608
    s_nop 0
    buffer_load_dwordx4 v19, s[28:31], s49 offen lds
    s_add_u32 s49, s49, 128
    s_and_b32 s49, s49, 2047
    s_waitcnt lgkmcnt(4)
    v_mfma_f32_16x16x32_bf16 v[120:123], v[68:71], v[88:91], v[120:123]
    ds_read_b64_tr_b16 v[84:85], v47 offset:20480
    v_mfma_f32_16x16x32_bf16 v[120:123], v[76:79], v[92:95], v[120:123]
    ds_read_b64_tr_b16 v[86:87], v47 offset:20736
    v_mfma_f32_16x16x32_bf16 v[124:127], v[72:75], v[88:91], v[124:127]
    ds_read_b64_tr_b16 v[88:89], v47 offset:22528
    v_mfma_f32_16x16x32_bf16 v[124:127], v[80:83], v[92:95], v[124:127]
    ds_read_b64_tr_b16 v[90:91], v47 offset:22784
    s_setprio 0
    s_waitcnt lgkmcnt(4)
    v_mfma_f32_16x16x32_bf16 v[128:131], v[68:71], v[96:99], v[128:131]
    ds_read_b64_tr_b16 v[92:93], v48 offset:20480
    v_mfma_f32_16x16x32_bf16 v[128:131], v[76:79], v[100:103], v[128:131]
    ds_read_b64_tr_b16 v[94:95], v48 offset:20736
    v_mfma_f32_16x16x32_bf16 v[132:135], v[72:75], v[96:99], v[132:135]
    ds_read_b64_tr_b16 v[96:97], v48 offset:22528
    v_mfma_f32_16x16x32_bf16 v[132:135], v[80:83], v[100:103], v[132:135]
    ds_read_b64_tr_b16 v[98:99], v48 offset:22784
    s_waitcnt lgkmcnt(4)
    v_mfma_f32_16x16x32_bf16 v[136:139], v[84:87], v[68:71], v[136:139]
    s_waitcnt vmcnt(14)
    s_waitcnt vmcnt(10)
    s_barrier
    ds_read_b128 v[52:55], v45 offset:0
    ds_read_b128 v[56:59], v45 offset:2048
    ds_read_b128 v[60:63], v46 offset:0
    ds_read_b128 v[64:67], v46 offset:2048
    ds_read_b64_tr_b16 v[100:101], v47 offset:24576
    v_mfma_f32_16x16x32_bf16 v[136:139], v[88:91], v[76:79], v[136:139]
    ds_read_b64_tr_b16 v[102:103], v47 offset:24832
    s_setprio 3
    s_add_u32 m0, s53, 0
    s_nop 0
    buffer_load_dwordx4 v20, s[32:35], s52 offen lds
    s_add_u32 s51, s51, 1
    s_and_b32 s51, s51, 15
    s_mul_i32 s52, s51, 393216
    v_mfma_f32_16x16x32_bf16 v[140:143], v[84:87], v[72:75], v[140:143]
    ds_read_b64_tr_b16 v[84:85], v47 offset:26624
    v_mfma_f32_16x16x32_bf16 v[140:143], v[88:91], v[80:83], v[140:143]
    ds_read_b64_tr_b16 v[86:87], v47 offset:26880
    s_waitcnt lgkmcnt(8)
    v_mfma_f32_16x16x32_bf16 v[144:147], v[92:95], v[68:71], v[144:147]
    ds_read_b64_tr_b16 v[88:89], v48 offset:24576
    v_mfma_f32_16x16x32_bf16 v[144:147], v[96:99], v[76:79], v[144:147]
    ds_read_b64_tr_b16 v[90:91], v48 offset:24832
    v_mfma_f32_16x16x32_bf16 v[148:151], v[92:95], v[72:75], v[148:151]
    ds_read_b64_tr_b16 v[92:93], v48 offset:26624
    v_mfma_f32_16x16x32_bf16 v[148:151], v[96:99], v[80:83], v[148:151]
    ds_read_b64_tr_b16 v[94:95], v48 offset:26880
    s_setprio 2
    s_waitcnt lgkmcnt(4)
    v_mfma_f32_16x16x32_bf16 v[104:107], v[100:103], v[52:55], v[104:107]
    ds_read_b64_tr_b16 v[96:97], v47 offset:28672
    v_mfma_f32_16x16x32_bf16 v[104:107], v[84:87], v[60:63], v[104:107]
    ds_read_b64_tr_b16 v[98:99], v47 offset:28928
    s_add_u32 m0, s50, 0
    s_nop 0
    buffer_load_dwordx4 v16, s[28:31], s49 offen lds
    v_mfma_f32_16x16x32_bf16 v[108:111], v[100:103], v[56:59], v[108:111]
    ds_read_b64_tr_b16 v[100:101], v47 offset:30720
    v_mfma_f32_16x16x32_bf16 v[108:111], v[84:87], v[64:67], v[108:111]
    ds_read_b64_tr_b16 v[102:103], v47 offset:30976
    s_add_u32 m0, s50, 1024
    s_nop 0
    buffer_load_dwordx4 v17, s[28:31], s49 offen lds
    s_waitcnt lgkmcnt(4)
    v_mfma_f32_16x16x32_bf16 v[112:115], v[88:91], v[52:55], v[112:115]
    ds_read_b64_tr_b16 v[84:85], v48 offset:28672
    v_mfma_f32_16x16x32_bf16 v[112:115], v[92:95], v[60:63], v[112:115]
    ds_read_b64_tr_b16 v[86:87], v48 offset:28928
    s_setprio 1
    s_add_u32 m0, s50, 2048
    s_nop 0
    buffer_load_dwordx4 v18, s[28:31], s49 offen lds
    s_mul_i32 s78, s44, 6144
    s_add_u32 s78, s78, 65536
    buffer_load_dwordx4 v[156:159], v174, s[36:39], s78 offen sc1
    s_mul_i32 s78, s24, 48
    v_add_u32 v172, s78, v178
    v_mfma_f32_16x16x32_bf16 v[116:119], v[88:91], v[56:59], v[116:119]
    ds_read_b64_tr_b16 v[88:89], v48 offset:30720
    v_mfma_f32_16x16x32_bf16 v[116:119], v[92:95], v[64:67], v[116:119]
    ds_read_b64_tr_b16 v[90:91], v48 offset:30976
    s_add_u32 m0, s50, 3072
    s_nop 0
    buffer_load_dwordx4 v19, s[28:31], s49 offen lds
    s_add_u32 s49, s49, 128
    s_and_b32 s49, s49, 2047
    s_waitcnt lgkmcnt(4)
    v_mfma_f32_16x16x32_bf16 v[120:123], v[52:55], v[96:99], v[120:123]
    ds_read_b64_tr_b16 v[92:93], v47 offset:32768
    v_mfma_f32_16x16x32_bf16 v[120:123], v[60:63], v[100:103], v[120:123]
    ds_read_b64_tr_b16 v[94:95], v47 offset:33024
    v_mfma_f32_16x16x32_bf16 v[124:127], v[56:59], v[96:99], v[124:127]
    ds_read_b64_tr_b16 v[96:97], v47 offset:34816
    v_mfma_f32_16x16x32_bf16 v[124:127], v[64:67], v[100:103], v[124:127]
    ds_read_b64_tr_b16 v[98:99], v47 offset:35072
    s_setprio 0
    s_waitcnt lgkmcnt(4)
    v_mfma_f32_16x16x32_bf16 v[128:131], v[52:55], v[84:87], v[128:131]
    ds_read_b64_tr_b16 v[100:101], v48 offset:32768
    v_mfma_f32_16x16x32_bf16 v[128:131], v[60:63], v[88:91], v[128:131]
    ds_read_b64_tr_b16 v[102:103], v48 offset:33024
    buffer_load_dwordx2 v[180:181], v176, s[36:39], s74 offen offset:0 sc1
    v_mfma_f32_16x16x32_bf16 v[132:135], v[56:59], v[84:87], v[132:135]
    ds_read_b64_tr_b16 v[84:85], v48 offset:34816
    v_mfma_f32_16x16x32_bf16 v[132:135], v[64:67], v[88:91], v[132:135]
    ds_read_b64_tr_b16 v[86:87], v48 offset:35072
    buffer_load_dwordx2 v[182:183], v176, s[36:39], s74 offen offset:128 sc1
    s_waitcnt lgkmcnt(4)
    v_mfma_f32_16x16x32_bf16 v[136:139], v[92:95], v[52:55], v[136:139]
    s_waitcnt vmcnt(17)
    s_waitcnt vmcnt(13)
    s_waitcnt vmcnt(12)
    s_barrier
    ds_read_b128 v[68:71], v45 offset:32768
    ds_read_b128 v[72:75], v45 offset:34816
    ds_read_b128 v[76:79], v46 offset:32768
    ds_read_b128 v[80:83], v46 offset:34816
    ds_read_b64_tr_b16 v[88:89], v47 offset:36864
    v_mfma_f32_16x16x32_bf16 v[136:139], v[96:99], v[60:63], v[136:139]
    ds_read_b64_tr_b16 v[90:91], v47 offset:37120
    s_setprio 3
    buffer_load_dwordx4 v[184:187], v177, s[36:39], s74 offen offset:0 sc1
    v_mfma_f32_16x16x32_bf16 v[140:143], v[92:95], v[56:59], v[140:143]
    ds_read_b64_tr_b16 v[92:93], v47 offset:38912
    v_mfma_f32_16x16x32_bf16 v[140:143], v[96:99], v[64:67], v[140:143]
    ds_read_b64_tr_b16 v[94:95], v47 offset:39168
    buffer_load_dwordx4 v[188:191], v177, s[36:39], s74 offen offset:16 sc1
    s_waitcnt lgkmcnt(8)
    v_mfma_f32_16x16x32_bf16 v[144:147], v[100:103], v[52:55], v[144:147]
    ds_read_b64_tr_b16 v[96:97], v48 offset:36864
    v_mfma_f32_16x16x32_bf16 v[144:147], v[84:87], v[60:63], v[144:147]
    ds_read_b64_tr_b16 v[98:99], v48 offset:37120
    buffer_load_dwordx4 v[192:195], v177, s[36:39], s74 offen offset:128 sc1
    v_mfma_f32_16x16x32_bf16 v[148:151], v[100:103], v[56:59], v[148:151]
    ds_read_b64_tr_b16 v[100:101], v48 offset:38912
    v_mfma_f32_16x16x32_bf16 v[148:151], v[84:87], v[64:67], v[148:151]
    ds_read_b64_tr_b16 v[102:103], v48 offset:39168
    s_setprio 2
    buffer_load_dwordx4 v[196:199], v177, s[36:39], s74 offen offset:144 sc1
    s_waitcnt lgkmcnt(4)
    v_mfma_f32_16x16x32_bf16 v[104:107], v[88:91], v[68:71], v[104:107]
    ds_read_b64_tr_b16 v[84:85], v47 offset:40960
    v_mfma_f32_16x16x32_bf16 v[104:107], v[92:95], v[76:79], v[104:107]
    ds_read_b64_tr_b16 v[86:87], v47 offset:41216
    v_mfma_f32_16x16x32_bf16 v[108:111], v[88:91], v[72:75], v[108:111]
    ds_read_b64_tr_b16 v[88:89], v47 offset:43008
    v_mfma_f32_16x16x32_bf16 v[108:111], v[92:95], v[80:83], v[108:111]
    ds_read_b64_tr_b16 v[90:91], v47 offset:43264
    s_waitcnt lgkmcnt(4)
    v_mfma_f32_16x16x32_bf16 v[112:115], v[96:99], v[68:71], v[112:115]
    ds_read_b64_tr_b16 v[92:93], v48 offset:40960
    v_mfma_f32_16x16x32_bf16 v[112:115], v[100:103], v[76:79], v[112:115]
    ds_read_b64_tr_b16 v[94:95], v48 offset:41216
    s_setprio 1
    v_mfma_f32_16x16x32_bf16 v[116:119], v[96:99], v[72:75], v[116:119]
    ds_read_b64_tr_b16 v[96:97], v48 offset:43008
    v_mfma_f32_16x16x32_bf16 v[116:119], v[100:103], v[80:83], v[116:119]
    ds_read_b64_tr_b16 v[98:99], v48 offset:43264
    s_waitcnt lgkmcnt(4)
    v_mfma_f32_16x16x32_bf16 v[120:123], v[68:71], v[84:87], v[120:123]
    ds_read_b64_tr_b16 v[100:101], v47 offset:45056
    v_mfma_f32_16x16x32_bf16 v[120:123], v[76:79], v[88:91], v[120:123]
    ds_read_b64_tr_b16 v[102:103], v47 offset:45312
    v_mfma_f32_16x16x32_bf16 v[124:127], v[72:75], v[84:87], v[124:127]
    ds_read_b64_tr_b16 v[84:85], v47 offset:47104
    v_mfma_f32_16x16x32_bf16 v[124:127], v[80:83], v[88:91], v[124:127]
    ds_read_b64_tr_b16 v[86:87], v47 offset:47360
    s_setprio 0
    s_waitcnt lgkmcnt(4)
    v_mfma_f32_16x16x32_bf16 v[128:131], v[68:71], v[92:95], v[128:131]
    ds_read_b64_tr_b16 v[88:89], v48 offset:45056
    v_mfma_f32_16x16x32_bf16 v[128:131], v[76:79], v[96:99], v[128:131]
    ds_read_b64_tr_b16 v[90:91], v48 offset:45312
    v_mfma_f32_16x16x32_bf16 v[132:135], v[72:75], v[92:95], v[132:135]
    ds_read_b64_tr_b16 v[92:93], v48 offset:47104
    v_mfma_f32_16x16x32_bf16 v[132:135], v[80:83], v[96:99], v[132:135]
    ds_read_b64_tr_b16 v[94:95], v48 offset:47360
    s_waitcnt lgkmcnt(4)
    v_mfma_f32_16x16x32_bf16 v[136:139], v[100:103], v[68:71], v[136:139]
    s_waitcnt vmcnt(12)
    s_waitcnt vmcnt(11)
    s_barrier
    ds_read_b128 v[52:55], v49 offset:0
    ds_read_b128 v[56:59], v49 offset:2048
    ds_read_b128 v[60:63], v50 offset:0
    ds_read_b128 v[64:67], v50 offset:2048
    ds_read_b64_tr_b16 v[96:97], v47 offset:49152
    v_mfma_f32_16x16x32_bf16 v[136:139], v[84:87], v[76:79], v[136:139]
    ds_read_b64_tr_b16 v[98:99], v47 offset:49408
    s_setprio 3
    s_waitcnt vmcnt(7)
    v_add_f32_dpp v156, v156, v156 row_ror:8 row_mask:0xf bank_mask:0xf
    v_add_f32_dpp v157, v157, v157 row_ror:8 row_mask:0xf bank_mask:0xf
    v_mfma_f32_16x16x32_bf16 v[140:143], v[100:103], v[72:75], v[140:143]
    ds_read_b64_tr_b16 v[100:101], v47 offset:51200
    v_mfma_f32_16x16x32_bf16 v[140:143], v[84:87], v[80:83], v[140:143]
    ds_read_b64_tr_b16 v[102:103], v47 offset:51456
    v_add_f32_dpp v158, v158, v158 row_ror:8 row_mask:0xf bank_mask:0xf
    v_add_f32_dpp v159, v159, v159 row_ror:8 row_mask:0xf bank_mask:0xf
    v_add_f32_dpp v156, v156, v156 row_ror:4 row_mask:0xf bank_mask:0xf
    s_waitcnt lgkmcnt(8)
    v_mfma_f32_16x16x32_bf16 v[144:147], v[88:91], v[68:71], v[144:147]
    ds_read_b64_tr_b16 v[84:85], v48 offset:49152
    v_mfma_f32_16x16x32_bf16 v[144:147], v[92:95], v[76:79], v[144:147]
    ds_read_b64_tr_b16 v[86:87], v48 offset:49408
    s_setprio 2
    v_add_f32_dpp v157, v157, v157 row_ror:4 row_mask:0xf bank_mask:0xf
    v_add_f32_dpp v158, v158, v158 row_ror:4 row_mask:0xf bank_mask:0xf
    v_add_f32_dpp v159, v159, v159 row_ror:4 row_mask:0xf bank_mask:0xf
    v_mfma_f32_16x16x32_bf16 v[148:151], v[88:91], v[72:75], v[148:151]
    ds_read_b64_tr_b16 v[88:89], v48 offset:51200
    v_mfma_f32_16x16x32_bf16 v[148:151], v[92:95], v[80:83], v[148:151]
    ds_read_b64_tr_b16 v[90:91], v48 offset:51456
    v_add_f32_dpp v156, v156, v156 row_ror:2 row_mask:0xf bank_mask:0xf
    v_add_f32_dpp v157, v157, v157 row_ror:2 row_mask:0xf bank_mask:0xf
    v_add_f32_dpp v158, v158, v158 row_ror:2 row_mask:0xf bank_mask:0xf
    s_waitcnt lgkmcnt(4)
    v_mfma_f32_16x16x32_bf16 v[104:107], v[96:99], v[52:55], v[104:107]
    ds_read_b64_tr_b16 v[92:93], v47 offset:53248
    v_mfma_f32_16x16x32_bf16 v[104:107], v[100:103], v[60:63], v[104:107]
    ds_read_b64_tr_b16 v[94:95], v47 offset:53504
    s_setprio 1
    v_add_f32_dpp v159, v159, v159 row_ror:2 row_mask:0xf bank_mask:0xf
    v_add_f32_dpp v156, v156, v156 row_ror:1 row_mask:0xf bank_mask:0xf
    v_add_f32_dpp v157, v157, v157 row_ror:1 row_mask:0xf bank_mask:0xf
    v_mfma_f32_16x16x32_bf16 v[108:111], v[96:99], v[56:59], v[108:111]
    ds_read_b64_tr_b16 v[96:97], v47 offset:55296
    v_mfma_f32_16x16x32_bf16 v[108:111], v[100:103], v[64:67], v[108:111]
    ds_read_b64_tr_b16 v[98:99], v47 offset:55552
    v_add_f32_dpp v158, v158, v158 row_ror:1 row_mask:0xf bank_mask:0xf
    v_add_f32_dpp v159, v159, v159 row_ror:1 row_mask:0xf bank_mask:0xf
    s_mov_b32 exec_lo, 0x00010001
    s_mov_b32 exec_hi, 1
    ds_write_b128 v172, v[156:159]
    s_mov_b64 exec, -1
    s_waitcnt lgkmcnt(5)
    v_mfma_f32_16x16x32_bf16 v[112:115], v[84:87], v[52:55], v[112:115]
    ds_read_b64_tr_b16 v[100:101], v48 offset:53248
    v_mfma_f32_16x16x32_bf16 v[112:115], v[88:91], v[60:63], v[112:115]
    ds_read_b64_tr_b16 v[102:103], v48 offset:53504
    s_setprio 0
    v_mfma_f32_16x16x32_bf16 v[116:119], v[84:87], v[56:59], v[116:119]
    ds_read_b64_tr_b16 v[84:85], v48 offset:55296
    v_mfma_f32_16x16x32_bf16 v[116:119], v[88:91], v[64:67], v[116:119]
    ds_read_b64_tr_b16 v[86:87], v48 offset:55552
    s_waitcnt lgkmcnt(5)
    v_mfma_f32_16x16x32_bf16 v[120:123], v[52:55], v[92:95], v[120:123]
    s_waitcnt vmcnt(6)
    s_waitcnt lgkmcnt(4)
    s_barrier
    ds_read_b128 v[68:71], v45 offset:0
    ds_read_b128 v[72:75], v45 offset:2048
    ds_read_b128 v[76:79], v46 offset:0
    ds_read_b128 v[80:83], v46 offset:2048
    ds_read_b64_tr_b16 v[88:89], v47 offset:0
    v_mfma_f32_16x16x32_bf16 v[120:123], v[60:63], v[96:99], v[120:123]
    ds_read_b64_tr_b16 v[90:91], v47 offset:256
    s_setprio 3
    v_mfma_f32_16x16x32_bf16 v[124:127], v[56:59], v[92:95], v[124:127]
    ds_read_b64_tr_b16 v[92:93], v47 offset:2048
    v_mfma_f32_16x16x32_bf16 v[124:127], v[64:67], v[96:99], v[124:127]
    ds_read_b64_tr_b16 v[94:95], v47 offset:2304
    ds_read_b128 v[156:159], v178 offset:0
    ds_read_b128 v[160:163], v178 offset:64
    ds_read_b32 v152, v179 offset:128
    s_waitcnt lgkmcnt(11)
    v_mfma_f32_16x16x32_bf16 v[128:131], v[52:55], v[100:103], v[128:131]
    ds_read_b64_tr_b16 v[96:97], v48 offset:0
    v_mfma_f32_16x16x32_bf16 v[128:131], v[60:63], v[84:87], v[128:131]
    ds_read_b64_tr_b16 v[98:99], v48 offset:256
    ds_read_b32 v153, v179 offset:192
    ds_read_b128 v[164:167], v178 offset:256
    ds_read_b128 v[168:171], v178 offset:320
    v_mfma_f32_16x16x32_bf16 v[132:135], v[56:59], v[100:103], v[132:135]
    ds_read_b64_tr_b16 v[100:101], v48 offset:2048
    v_mfma_f32_16x16x32_bf16 v[132:135], v[64:67], v[84:87], v[132:135]
    ds_read_b64_tr_b16 v[102:103], v48 offset:2304
    s_waitcnt lgkmcnt(10)
    v_mfma_f32_16x16x32_bf16 v[104:107], v[88:91], v[68:71], v[104:107]
    ds_read_b64_tr_b16 v[84:85], v47 offset:4096
    v_mfma_f32_16x16x32_bf16 v[104:107], v[92:95], v[76:79], v[104:107]
    ds_read_b64_tr_b16 v[86:87], v47 offset:4352
    v_mfma_f32_16x16x32_bf16 v[108:111], v[88:91], v[72:75], v[108:111]
    ds_read_b64_tr_b16 v[88:89], v47 offset:6144
    v_mfma_f32_16x16x32_bf16 v[108:111], v[92:95], v[80:83], v[108:111]
    ds_read_b64_tr_b16 v[90:91], v47 offset:6400
    s_setprio 2
    s_waitcnt vmcnt(0) lgkmcnt(6)
    v_mul_f32 v208, v181, v156
    v_mul_f32 v209, v181, v157
    v_mul_f32 v210, v181, v158
    v_mul_f32 v211, v181, v159
    v_mul_f32 v212, v183, v156
    s_waitcnt lgkmcnt(4)
    v_mfma_f32_16x16x32_bf16 v[112:115], v[96:99], v[68:71], v[112:115]
    ds_read_b64_tr_b16 v[92:93], v48 offset:4096
    v_mfma_f32_16x16x32_bf16 v[112:115], v[100:103], v[76:79], v[112:115]
    ds_read_b64_tr_b16 v[94:95], v48 offset:4352
    v_mul_f32 v213, v183, v157
    v_mul_f32 v214, v183, v158
    v_mul_f32 v215, v183, v159
    v_mul_f32 v216, v181, v160
    v_mul_f32 v217, v181, v161
    v_mul_f32 v218, v181, v162
    v_mfma_f32_16x16x32_bf16 v[116:119], v[96:99], v[72:75], v[116:119]
    ds_read_b64_tr_b16 v[96:97], v48 offset:6144
    v_mfma_f32_16x16x32_bf16 v[116:119], v[100:103], v[80:83], v[116:119]
    ds_read_b64_tr_b16 v[98:99], v48 offset:6400
    v_mul_f32 v219, v181, v163
    v_mul_f32 v220, v183, v160
    v_mul_f32 v221, v183, v161
    v_mul_f32 v222, v183, v162
    v_mul_f32 v223, v183, v163
    v_mul_f32 v224, v185, v152
    s_waitcnt lgkmcnt(4)
    v_mfma_f32_16x16x32_bf16 v[120:123], v[68:71], v[84:87], v[120:123]
    ds_read_b64_tr_b16 v[100:101], v47 offset:57344
    v_mfma_f32_16x16x32_bf16 v[120:123], v[76:79], v[88:91], v[120:123]
    ds_read_b64_tr_b16 v[102:103], v47 offset:57600
    v_mul_f32 v225, v187, v152
    v_mul_f32 v226, v189, v152
    v_mul_f32 v227, v191, v152
    v_mul_f32 v228, v193, v152
    v_mul_f32 v229, v195, v152
    v_mul_f32 v230, v197, v152
    v_mfma_f32_16x16x32_bf16 v[124:127], v[72:75], v[84:87], v[124:127]
    ds_read_b64_tr_b16 v[84:85], v47 offset:59392
    v_mfma_f32_16x16x32_bf16 v[124:127], v[80:83], v[88:91], v[124:127]
    ds_read_b64_tr_b16 v[86:87], v47 offset:59648
    v_mul_f32 v231, v199, v152
    v_mul_f32 v232, v185, v153
    v_mul_f32 v233, v187, v153
    v_mul_f32 v234, v189, v153
    v_mul_f32 v235, v191, v153
    v_mul_f32 v236, v193, v153
    s_waitcnt lgkmcnt(4)
    v_mfma_f32_16x16x32_bf16 v[128:131], v[68:71], v[92:95], v[128:131]
    ds_read_b64_tr_b16 v[88:89], v48 offset:57344
    v_mfma_f32_16x16x32_bf16 v[128:131], v[76:79], v[96:99], v[128:131]
    ds_read_b64_tr_b16 v[90:91], v48 offset:57600
    s_setprio 1
    v_mul_f32 v237, v195, v153
    v_mul_f32 v238, v197, v153
    v_mul_f32 v239, v199, v153
    v_mul_f32 v154, 0x3e8293ee, v180
    v_mul_f32 v155, 0x3e8293ee, v182
    v_mul_f32 v181, 0x3e8293ee, v181
    v_mfma_f32_16x16x32_bf16 v[132:135], v[72:75], v[92:95], v[132:135]
    ds_read_b64_tr_b16 v[92:93], v48 offset:59392
    v_mfma_f32_16x16x32_bf16 v[132:135], v[80:83], v[96:99], v[132:135]
    ds_read_b64_tr_b16 v[94:95], v48 offset:59648
    v_mul_f32 v183, 0x3e8293ee, v183
    v_mul_f32 v240, v181, v164
    v_mul_f32 v241, v181, v165
    v_mul_f32 v242, v181, v166
    v_mul_f32 v243, v181, v167
    v_mul_f32 v244, v183, v164
    s_waitcnt lgkmcnt(4)
    v_mfma_f32_16x16x32_bf16 v[136:139], v[100:103], v[52:55], v[136:139]
    ds_read_b64_tr_b16 v[96:97], v47 offset:8192
    v_mfma_f32_16x16x32_bf16 v[136:139], v[84:87], v[60:63], v[136:139]
    ds_read_b64_tr_b16 v[98:99], v47 offset:8448
    v_mul_f32 v245, v183, v165
    v_mul_f32 v246, v183, v166
    v_mul_f32 v247, v183, v167
    v_mul_f32 v248, v181, v168
    v_mul_f32 v249, v181, v169
    v_mul_f32 v250, v181, v170
    v_mfma_f32_16x16x32_bf16 v[140:143], v[100:103], v[56:59], v[140:143]
    ds_read_b64_tr_b16 v[100:101], v47 offset:10240
    v_mfma_f32_16x16x32_bf16 v[140:143], v[84:87], v[64:67], v[140:143]
    ds_read_b64_tr_b16 v[102:103], v47 offset:10496
    v_mul_f32 v251, v181, v171
    v_mul_f32 v252, v183, v168
    v_mul_f32 v253, v183, v169
    v_mul_f32 v254, v183, v170
    v_mul_f32 v255, v183, v171
    s_waitcnt lgkmcnt(4)
    v_mfma_f32_16x16x32_bf16 v[144:147], v[88:91], v[52:55], v[144:147]
    ds_read_b64_tr_b16 v[84:85], v48 offset:8192
    v_mfma_f32_16x16x32_bf16 v[144:147], v[92:95], v[60:63], v[144:147]
    ds_read_b64_tr_b16 v[86:87], v48 offset:8448
    v_fma_f32 v104, v104, v180, v208
    v_fma_f32 v105, v105, v180, v209
    v_fma_f32 v106, v106, v180, v210
    v_fma_f32 v107, v107, v180, v211
    v_fma_f32 v112, v112, v180, v216
    v_fma_f32 v113, v113, v180, v217
    v_fma_f32 v114, v114, v180, v218
    v_fma_f32 v115, v115, v180, v219
    v_cvt_pk_bf16_f32 v208, v104, v105
    v_cvt_pk_bf16_f32 v209, v106, v107
    v_cvt_pk_bf16_f32 v210, v112, v113
    v_cvt_pk_bf16_f32 v211, v114, v115
    v_mfma_f32_16x16x32_bf16 v[148:151], v[88:91], v[56:59], v[148:151]
    ds_read_b64_tr_b16 v[88:89], v48 offset:10240
    v_mfma_f32_16x16x32_bf16 v[148:151], v[92:95], v[64:67], v[148:151]
    ds_read_b64_tr_b16 v[90:91], v48 offset:10496
    s_setprio 0
    buffer_store_dwordx4 v[208:211], v27, s[36:39], s63 offen offset:0 sc1
    ds_write_b128 v43, v[208:211] offset:0
    v_fma_f32 v108, v108, v182, v212
    v_fma_f32 v109, v109, v182, v213
    v_fma_f32 v110, v110, v182, v214
    v_fma_f32 v111, v111, v182, v215
    v_fma_f32 v116, v116, v182, v220
    v_fma_f32 v117, v117, v182, v221
    v_fma_f32 v118, v118, v182, v222
    v_fma_f32 v119, v119, v182, v223
    v_cvt_pk_bf16_f32 v212, v108, v109
    v_cvt_pk_bf16_f32 v213, v110, v111
    s_waitcnt lgkmcnt(5)
    v_mfma_f32_16x16x32_bf16 v[136:139], v[96:99], v[68:71], v[136:139]
    v_mfma_f32_16x16x32_bf16 v[136:139], v[100:103], v[76:79], v[136:139]
    v_cvt_pk_bf16_f32 v214, v116, v117
    v_cvt_pk_bf16_f32 v215, v118, v119
    buffer_store_dwordx4 v[212:215], v27, s[36:39], s63 offen offset:256 sc1
    ds_write_b128 v43, v[212:215] offset:256
    v_mfma_f32_16x16x32_bf16 v[140:143], v[96:99], v[72:75], v[140:143]
    v_mfma_f32_16x16x32_bf16 v[140:143], v[100:103], v[80:83], v[140:143]
    v_fma_f32 v120, v120, v184, v224
    v_fma_f32 v121, v121, v186, v225
    v_fma_f32 v122, v122, v188, v226
    v_fma_f32 v123, v123, v190, v227
    v_fma_f32 v128, v128, v184, v232
    v_fma_f32 v129, v129, v186, v233
    v_fma_f32 v130, v130, v188, v234
    v_fma_f32 v131, v131, v190, v235
    v_cvt_pk_bf16_f32 v224, v120, v121
    v_cvt_pk_bf16_f32 v225, v122, v123
    v_cvt_pk_bf16_f32 v226, v128, v129
    v_cvt_pk_bf16_f32 v227, v130, v131
    s_waitcnt lgkmcnt(2)
    v_mfma_f32_16x16x32_bf16 v[144:147], v[84:87], v[68:71], v[144:147]
    v_mfma_f32_16x16x32_bf16 v[144:147], v[88:91], v[76:79], v[144:147]
    v_permlane16_swap_b32 v224, v226
    v_permlane16_swap_b32 v225, v227
    buffer_store_dwordx4 v[224:227], v2, s[36:39], s63 offen offset:2048 sc1
    ds_write_b128 v44, v[224:227] offset:2048
    v_fma_f32 v124, v124, v192, v228
    v_fma_f32 v125, v125, v194, v229
    v_fma_f32 v126, v126, v196, v230
    v_fma_f32 v127, v127, v198, v231
    v_fma_f32 v132, v132, v192, v236
    v_fma_f32 v133, v133, v194, v237
    v_fma_f32 v134, v134, v196, v238
    v_fma_f32 v135, v135, v198, v239
    v_mfma_f32_16x16x32_bf16 v[148:151], v[84:87], v[72:75], v[148:151]
    v_mfma_f32_16x16x32_bf16 v[148:151], v[88:91], v[80:83], v[148:151]
    v_cvt_pk_bf16_f32 v228, v124, v125
    v_cvt_pk_bf16_f32 v229, v126, v127
    v_cvt_pk_bf16_f32 v230, v132, v133
    v_cvt_pk_bf16_f32 v231, v134, v135
    s_nop 0
    v_permlane16_swap_b32 v228, v230
    v_permlane16_swap_b32 v229, v231
    buffer_store_dwordx4 v[228:231], v2, s[36:39], s63 offen offset:3072 sc1
    ds_write_b128 v44, v[228:231] offset:3072
    v_fma_f32 v136, v136, v154, v240
    v_fma_f32 v137, v137, v154, v241
    v_fma_f32 v138, v138, v154, v242
    v_fma_f32 v139, v139, v154, v243
    v_fma_f32 v144, v144, v154, v248
    v_fma_f32 v145, v145, v154, v249
    v_fma_f32 v146, v146, v154, v250
    v_fma_f32 v147, v147, v154, v251
    v_cvt_pk_bf16_f32 v8, v136, v137
    v_cvt_pk_bf16_f32 v9, v138, v139
    v_cvt_pk_bf16_f32 v10, v144, v145
    v_cvt_pk_bf16_f32 v11, v146, v147
    v_fma_f32 v140, v140, v155, v244
    v_fma_f32 v141, v141, v155, v245
    v_fma_f32 v142, v142, v155, v246
    v_fma_f32 v143, v143, v155, v247
    v_fma_f32 v148, v148, v155, v252
    v_fma_f32 v149, v149, v155, v253
    v_fma_f32 v150, v150, v155, v254
    v_fma_f32 v151, v151, v155, v255
    v_cvt_pk_bf16_f32 v12, v140, v141
    v_cvt_pk_bf16_f32 v13, v142, v143
    v_cvt_pk_bf16_f32 v14, v148, v149
    v_cvt_pk_bf16_f32 v15, v150, v151
    s_waitcnt lgkmcnt(0)
qa_kernel_GE:
    s_barrier
    v_permlane16_swap_b32 v8, v12
    v_permlane16_swap_b32 v9, v13
    v_permlane16_swap_b32 v10, v14
    v_permlane16_swap_b32 v11, v15
    s_mov_b32 s32, s8
    s_mov_b32 s33, s9
    s_mov_b32 s34, 2097152
    s_mov_b32 s35, 0x20000
    s_mov_b32 s28, s16
    s_mov_b32 s29, s17
    s_mov_b32 s30, 7340032
    s_mov_b32 s31, 0x20000
    s_setprio 1
    s_lshl_b32 s63, s46, 6
    s_add_u32 s63, s63, s44
    s_lshl_b32 s63, s63, 10
    s_add_u32 s63, s63, 16777216
    v_lshlrev_b32 v52, 4, v6
    v_bfe_u32 v3, v1, 4, 1
    v_lshl_add_u32 v52, v3, 15, v52
    v_lshrrev_b32 v3, 5, v1
    v_lshl_add_u32 v52, v3, 8, v52
    v_mov_b32 v192, -1
    v_mov_b32 v193, -1
    v_mov_b32 v194, -1
    v_mov_b32 v195, -1
qa_kernel_WS0_5:
    s_cbranch_execz qa_kernel_WRET0
    v_and_b32 v3, 1, v1
    v_sub_u32 v3, 0, v3
    v_and_b32 v3, 0xaaaaaaaa, v3
    v_or_b32 v197, 0x44444444, v3
    v_mov_b32 v132, 0
    v_mov_b32 v133, 0
    v_mov_b32 v134, 0
    v_mov_b32 v135, 0
    s_and_b32 s53, s2, 3
    s_lshl_b32 s53, s53, 2
    s_bfe_u32 s47, s2, 0x20003
    s_add_u32 s53, s53, s47
    s_lshl_b32 s53, s53, 3
    s_and_b32 s47, s24, 3
    s_lshl_b32 s51, s47, 10
    s_lshl_b32 s47, s47, 1
    s_add_u32 s53, s53, s47
    s_lshr_b32 s47, s24, 2
    s_add_u32 s53, s53, s47
    s_and_b32 s52, s2, 7
    s_lshl_b32 s52, s52, 2
    s_add_u32 s52, s52, 4
    s_add_u32 s52, s52, s47
    s_and_b32 s52, s52, 31
    s_lshl_b32 s49, s52, 16
    s_lshl_b32 s52, s52, 10
    s_lshl_b32 s47, s47, 12
    s_lshl_b32 s48, s51, 4
    s_add_u32 s51, s51, s47
    s_bfe_u32 s56, s2, 0x10002
    s_lshl_b32 s56, s56, 3
    s_lshr_b32 s47, s2, 5
    s_add_u32 s56, s56, s47
    s_lshl_b32 s47, s56, 7
    s_add_u32 s48, s48, s47
    v_lshrrev_b32 v3, 3, v1
    v_lshlrev_b32 v53, 11, v3
    v_lshlrev_b32 v3, 1, v5
    v_and_b32 v4, 7, v1
    v_xor_b32 v3, v3, v4
    v_lshl_add_u32 v53, v3, 4, v53
    v_add_u32 v53, s48, v53
    s_lshl_b32 s48, s53, 15
    s_add_u32 s47, s47, s48
    s_add_u32 s48, s48, 16777216
    v_add_u32 v54, s48, v2
    v_xor_b32 v55, 0x8000, v54
    v_lshlrev_b32 v56, 11, v6
    v_and_b32 v3, 1, v5
    v_lshl_add_u32 v56, v3, 5, v56
    v_lshrrev_b32 v3, 1, v5
    v_lshl_add_u32 v56, v3, 4, v56
    v_add_u32 v56, s47, v56
    v_and_b32 v198, 7, v1
    v_lshlrev_b32 v198, 5, v198
    s_and_b32 s47, s2, 7
    s_lshl_b32 s47, s47, 5
    v_mov_b32 v199, s47
    v_mov_b32 v200, 1
    s_lshl_b32 s47, s2, 13
    s_lshl_b32 s48, s24, 10
    s_add_u32 s47, s47, s48
    v_add_u32 v202, s47, v2
    s_cmp_lt_u32 s2, 68
    s_cselect_b32 s47, 0, 0x10000000
    v_add_u32 v203, s47, v202
    s_lshr_b32 s47, s2, 1
    s_mul_i32 s47, s47, 112
    s_and_b32 s48, s2, 1
    s_mul_i32 s48, s48, 56
    s_add_u32 s47, s47, s48
    s_lshr_b32 s48, s24, 2
    s_mul_i32 s48, s48, 28
    s_add_u32 s47, s47, s48
    s_bfe_u32 s48, s24, 0x10001
    s_mul_i32 s48, s48, 7
    s_add_u32 s47, s47, s48
    s_and_b32 s48, s24, 1
    s_lshl_b32 s48, s48, 2
    s_add_u32 s47, s47, s48
    s_lshl_b32 s47, s47, 10
    v_add_u32 v204, s47, v2
    s_waitcnt vmcnt(0)
    v_mov_b32 v24, 1
    buffer_store_dword v24, v23, s[36:39], s57 offen sc1
    ds_read_b128 v[144:147], v2 offset:0
    ds_read_b128 v[148:151], v2 offset:1024
    ds_read_b128 v[152:155], v2 offset:4096
    ds_read_b128 v[156:159], v2 offset:5120
    ds_read_b128 v[160:163], v2 offset:2048
    ds_read_b128 v[164:167], v2 offset:3072
    s_waitcnt lgkmcnt(4)
    v_mfma_f32_32x32x16_bf16 v[68:83], v[144:147], v[8:11], 0
    v_mfma_f32_32x32x16_bf16 v[68:83], v[148:151], v[12:15], v[68:83]
    s_nop 11
    v_max3_f32 v3, v68, v69, v70
    v_max3_f32 v3, v3, v71, v72
    v_max3_f32 v3, v3, v73, v74
    v_max3_f32 v3, v3, v75, v76
    v_max3_f32 v3, v3, v77, v78
    v_max3_f32 v3, v3, v79, v80
    v_max3_f32 v3, v3, v81, v82
    v_max_f32 v3, v3, v83
    v_mov_b32 v4, v3
    s_nop 1
    v_permlane32_swap_b32 v3, v4
    v_max_f32 v3, v3, v4
    v_sub_f32 v100, 0, v3
    v_sub_f32 v101, 0, v3
    v_sub_f32 v102, 0, v3
    v_sub_f32 v103, 0, v3
    v_sub_f32 v104, 0, v3
    v_sub_f32 v105, 0, v3
    v_sub_f32 v106, 0, v3
    v_sub_f32 v107, 0, v3
    v_sub_f32 v108, 0, v3
    v_sub_f32 v109, 0, v3
    v_sub_f32 v110, 0, v3
    v_sub_f32 v111, 0, v3
    v_sub_f32 v112, 0, v3
    v_sub_f32 v113, 0, v3
    v_sub_f32 v114, 0, v3
    v_sub_f32 v115, 0, v3
    v_sub_f32 v68, v68, v3
    v_sub_f32 v69, v69, v3
    v_sub_f32 v70, v70, v3
    v_sub_f32 v71, v71, v3
    v_sub_f32 v72, v72, v3
    v_sub_f32 v73, v73, v3
    v_sub_f32 v74, v74, v3
    v_sub_f32 v75, v75, v3
    v_sub_f32 v76, v76, v3
    v_sub_f32 v77, v77, v3
    v_sub_f32 v78, v78, v3
    v_sub_f32 v79, v79, v3
    v_sub_f32 v80, v80, v3
    v_sub_f32 v81, v81, v3
    v_sub_f32 v82, v82, v3
    v_sub_f32 v83, v83, v3
    s_setprio 2
    v_exp_f32 v68, v68
    v_exp_f32 v69, v69
    v_exp_f32 v70, v70
    s_waitcnt lgkmcnt(2)
    v_mfma_f32_32x32x16_bf16 v[84:99], v[152:155], v[8:11], v[100:115]
    v_exp_f32 v71, v71
    v_exp_f32 v72, v72
    v_exp_f32 v73, v73
    ds_read_b128 v[168:171], v2 offset:6144
    ds_read_b128 v[172:175], v2 offset:7168
    v_exp_f32 v74, v74
    v_exp_f32 v75, v75
    v_mfma_f32_32x32x16_bf16 v[84:99], v[156:159], v[12:15], v[84:99]
    v_cvt_pk_bf16_f32 v136, v68, v69
    v_cvt_pk_bf16_f32 v137, v70, v71
    v_cvt_pk_bf16_f32 v138, v72, v73
    v_cvt_pk_bf16_f32 v139, v74, v75
    v_exp_f32 v76, v76
    ds_read_b128 v[144:147], v2 offset:8192
    ds_read_b128 v[148:151], v2 offset:9216
    s_waitcnt lgkmcnt(4)
    v_mfma_f32_32x32x16_bf16 v[116:131], v[160:163], v[136:139], 0
    v_exp_f32 v77, v77
    v_exp_f32 v78, v78
    v_exp_f32 v79, v79
    v_exp_f32 v80, v80
    v_exp_f32 v81, v81
    v_exp_f32 v82, v82
    v_exp_f32 v83, v83
    v_cvt_pk_bf16_f32 v140, v76, v77
    v_cvt_pk_bf16_f32 v141, v78, v79
    v_cvt_pk_bf16_f32 v142, v80, v81
    v_cvt_pk_bf16_f32 v143, v82, v83
    s_setprio 1
    s_nop 0
    v_mfma_f32_32x32x16_bf16 v[116:131], v[164:167], v[140:143], v[116:131]
    v_exp_f32 v84, v84
    v_exp_f32 v85, v85
    v_exp_f32 v86, v86
    s_waitcnt lgkmcnt(0)
    v_mfma_f32_32x32x16_bf16 v[68:83], v[144:147], v[8:11], v[100:115]
    v_exp_f32 v87, v87
    v_exp_f32 v88, v88
    v_exp_f32 v89, v89
    v_smfmac_f32_16x16x64_bf16 v[132:135], v[36:39], v[136:143], v197
    ds_read_b128 v[160:163], v2 offset:10240
    ds_read_b128 v[164:167], v2 offset:11264
    v_exp_f32 v90, v90
    v_exp_f32 v91, v91
    v_mfma_f32_32x32x16_bf16 v[68:83], v[148:151], v[12:15], v[68:83]
    v_cvt_pk_bf16_f32 v136, v84, v85
    v_cvt_pk_bf16_f32 v137, v86, v87
    v_cvt_pk_bf16_f32 v138, v88, v89
    v_cvt_pk_bf16_f32 v139, v90, v91
    v_exp_f32 v92, v92
    ds_read_b128 v[152:155], v2 offset:12288
    ds_read_b128 v[156:159], v2 offset:13312
    v_mfma_f32_32x32x16_bf16 v[116:131], v[168:171], v[136:139], v[116:131]
    v_exp_f32 v93, v93
    v_exp_f32 v94, v94
    v_exp_f32 v95, v95
    s_mov_b64 exec, 12
    buffer_load_dword v29, v28, s[36:39], s57 offen sc1
    s_mov_b64 exec, -1
    s_mov_b32 s47, 16777216
    buffer_store_dwordx4 v[192:195], v202, s[36:39], s47 offen sc1
    s_setprio 0
    v_exp_f32 v96, v96
    v_exp_f32 v97, v97
    v_exp_f32 v98, v98
    v_exp_f32 v99, v99
    v_cvt_pk_bf16_f32 v140, v92, v93
    v_cvt_pk_bf16_f32 v141, v94, v95
    v_cvt_pk_bf16_f32 v142, v96, v97
    v_cvt_pk_bf16_f32 v143, v98, v99
    s_setprio 3
    s_nop 0
    v_mfma_f32_32x32x16_bf16 v[116:131], v[172:175], v[140:143], v[116:131]
    v_exp_f32 v68, v68
    v_exp_f32 v69, v69
    v_exp_f32 v70, v70
    s_waitcnt lgkmcnt(0)
    v_mfma_f32_32x32x16_bf16 v[84:99], v[152:155], v[8:11], v[100:115]
    v_exp_f32 v71, v71
    v_exp_f32 v72, v72
    v_exp_f32 v73, v73
    v_smfmac_f32_16x16x64_bf16 v[132:135], v[36:39], v[136:143], v197
    ds_read_b128 v[168:171], v2 offset:14336
    ds_read_b128 v[172:175], v2 offset:15360
    v_exp_f32 v74, v74
    v_exp_f32 v75, v75
    v_mfma_f32_32x32x16_bf16 v[84:99], v[156:159], v[12:15], v[84:99]
    v_cvt_pk_bf16_f32 v136, v68, v69
    v_cvt_pk_bf16_f32 v137, v70, v71
    v_cvt_pk_bf16_f32 v138, v72, v73
    v_cvt_pk_bf16_f32 v139, v74, v75
    v_exp_f32 v76, v76
    ds_read_b128 v[144:147], v2 offset:16384
    ds_read_b128 v[148:151], v2 offset:17408
    v_mfma_f32_32x32x16_bf16 v[116:131], v[160:163], v[136:139], v[116:131]
    v_exp_f32 v77, v77
    v_exp_f32 v78, v78
    v_exp_f32 v79, v79
    s_waitcnt vmcnt(1)
    s_mov_b64 exec, 12
    v_cmp_ne_u32_e64 s[54:55], 0, v29
    s_mov_b64 exec, -1
    s_and_b32 s47, s54, 12
    s_cmp_eq_u32 s47, 12
    s_cbranch_scc1 qa_kernel_FL2_E
    s_mov_b32 s62, 262144
    s_mov_b64 exec, 12
qa_kernel_FL2:
    buffer_load_dword v29, v28, s[36:39], s57 offen sc1
    s_waitcnt vmcnt(0)
    v_cmp_ne_u32_e64 vcc, 0, v29
    s_sub_u32 s62, s62, 1
    s_cbranch_scc1 qa_kernel_FL2_X
    s_cmp_eq_u32 vcc_lo, 12
    s_cbranch_scc0 qa_kernel_FL2
qa_kernel_FL2_X:
    s_mov_b64 exec, -1
qa_kernel_FL2_E:
    s_add_u32 m0, s61, 32768
    s_nop 0
    buffer_load_dwordx4 v26, s[36:39], s59 offen sc1 lds
    buffer_load_dwordx4 v26, s[36:39], s59 offen offset:1024 sc1 lds
    s_add_u32 s60, s60, 16384
    s_and_b32 s60, s60, 0x3ffff
    s_add_u32 s59, s58, s60
    s_add_u32 m0, s61, 49152
    s_nop 0
    buffer_load_dwordx4 v26, s[36:39], s59 offen sc1 lds
    buffer_load_dwordx4 v26, s[36:39], s59 offen offset:1024 sc1 lds
    s_add_u32 s60, s60, 16384
    s_and_b32 s60, s60, 0x3ffff
    s_add_u32 s59, s58, s60
    v_exp_f32 v80, v80
    v_exp_f32 v81, v81
    v_exp_f32 v82, v82
    v_exp_f32 v83, v83
    v_cvt_pk_bf16_f32 v140, v76, v77
    v_cvt_pk_bf16_f32 v141, v78, v79
    v_cvt_pk_bf16_f32 v142, v80, v81
    v_cvt_pk_bf16_f32 v143, v82, v83
    s_nop 1
    v_mfma_f32_32x32x16_bf16 v[116:131], v[164:167], v[140:143], v[116:131]
    v_exp_f32 v84, v84
    v_exp_f32 v85, v85
    v_exp_f32 v86, v86
    s_waitcnt lgkmcnt(0)
    v_mfma_f32_32x32x16_bf16 v[68:83], v[144:147], v[8:11], v[100:115]
    v_exp_f32 v87, v87
    v_exp_f32 v88, v88
    v_exp_f32 v89, v89
    v_smfmac_f32_16x16x64_bf16 v[132:135], v[36:39], v[136:143], v197
    ds_read_b128 v[160:163], v2 offset:18432
    ds_read_b128 v[164:167], v2 offset:19456
    v_exp_f32 v90, v90
    v_exp_f32 v91, v91
    v_mfma_f32_32x32x16_bf16 v[68:83], v[148:151], v[12:15], v[68:83]
    v_cvt_pk_bf16_f32 v136, v84, v85
    v_cvt_pk_bf16_f32 v137, v86, v87
    v_cvt_pk_bf16_f32 v138, v88, v89
    v_cvt_pk_bf16_f32 v139, v90, v91
    v_exp_f32 v92, v92
    ds_read_b128 v[152:155], v2 offset:20480
    ds_read_b128 v[156:159], v2 offset:21504
    v_mfma_f32_32x32x16_bf16 v[116:131], v[168:171], v[136:139], v[116:131]
    v_exp_f32 v93, v93
    v_exp_f32 v94, v94
    v_exp_f32 v95, v95
    v_exp_f32 v96, v96
    v_exp_f32 v97, v97
    v_exp_f32 v98, v98
    v_exp_f32 v99, v99
    v_cvt_pk_bf16_f32 v140, v92, v93
    v_cvt_pk_bf16_f32 v141, v94, v95
    v_cvt_pk_bf16_f32 v142, v96, v97
    v_cvt_pk_bf16_f32 v143, v98, v99
    s_setprio 2
    s_nop 0
    v_mfma_f32_32x32x16_bf16 v[116:131], v[172:175], v[140:143], v[116:131]
    v_exp_f32 v68, v68
    v_exp_f32 v69, v69
    v_exp_f32 v70, v70
    s_waitcnt lgkmcnt(0)
    v_mfma_f32_32x32x16_bf16 v[84:99], v[152:155], v[8:11], v[100:115]
    v_exp_f32 v71, v71
    v_exp_f32 v72, v72
    v_exp_f32 v73, v73
    v_smfmac_f32_16x16x64_bf16 v[132:135], v[36:39], v[136:143], v197
    ds_read_b128 v[168:171], v2 offset:22528
    ds_read_b128 v[172:175], v2 offset:23552
    v_exp_f32 v74, v74
    v_exp_f32 v75, v75
    v_mfma_f32_32x32x16_bf16 v[84:99], v[156:159], v[12:15], v[84:99]
    v_cvt_pk_bf16_f32 v136, v68, v69
    v_cvt_pk_bf16_f32 v137, v70, v71
    v_cvt_pk_bf16_f32 v138, v72, v73
    v_cvt_pk_bf16_f32 v139, v74, v75
    v_exp_f32 v76, v76
    ds_read_b128 v[144:147], v2 offset:24576
    ds_read_b128 v[148:151], v2 offset:25600
    v_mfma_f32_32x32x16_bf16 v[116:131], v[160:163], v[136:139], v[116:131]
    v_exp_f32 v77, v77
    v_exp_f32 v78, v78
    v_exp_f32 v79, v79
    v_exp_f32 v80, v80
    v_exp_f32 v81, v81
    v_exp_f32 v82, v82
    v_exp_f32 v83, v83
    v_cvt_pk_bf16_f32 v140, v76, v77
    v_cvt_pk_bf16_f32 v141, v78, v79
    v_cvt_pk_bf16_f32 v142, v80, v81
    v_cvt_pk_bf16_f32 v143, v82, v83
    s_setprio 1
    s_nop 0
    v_mfma_f32_32x32x16_bf16 v[116:131], v[164:167], v[140:143], v[116:131]
    v_exp_f32 v84, v84
    v_exp_f32 v85, v85
    v_exp_f32 v86, v86
    s_waitcnt lgkmcnt(0)
    v_mfma_f32_32x32x16_bf16 v[68:83], v[144:147], v[8:11], v[100:115]
    v_exp_f32 v87, v87
    v_exp_f32 v88, v88
    v_exp_f32 v89, v89
    v_smfmac_f32_16x16x64_bf16 v[132:135], v[36:39], v[136:143], v197
    ds_read_b128 v[160:163], v2 offset:26624
    ds_read_b128 v[164:167], v2 offset:27648
    v_exp_f32 v90, v90
    v_exp_f32 v91, v91
    v_mfma_f32_32x32x16_bf16 v[68:83], v[148:151], v[12:15], v[68:83]
    v_cvt_pk_bf16_f32 v136, v84, v85
    v_cvt_pk_bf16_f32 v137, v86, v87
    v_cvt_pk_bf16_f32 v138, v88, v89
    v_cvt_pk_bf16_f32 v139, v90, v91
    v_exp_f32 v92, v92
    ds_read_b128 v[152:155], v2 offset:28672
    ds_read_b128 v[156:159], v2 offset:29696
    v_mfma_f32_32x32x16_bf16 v[116:131], v[168:171], v[136:139], v[116:131]
    v_exp_f32 v93, v93
    v_exp_f32 v94, v94
    v_exp_f32 v95, v95
    s_mov_b64 exec, 65520
    buffer_load_dword v29, v28, s[36:39], s57 offen sc1
    s_mov_b64 exec, -1
    s_mov_b32 s47, 18874368
    buffer_store_dwordx4 v[192:195], v202, s[36:39], s47 offen sc1
    s_setprio 0
    v_exp_f32 v96, v96
    v_exp_f32 v97, v97
    v_exp_f32 v98, v98
    v_exp_f32 v99, v99
    v_cvt_pk_bf16_f32 v140, v92, v93
    v_cvt_pk_bf16_f32 v141, v94, v95
    v_cvt_pk_bf16_f32 v142, v96, v97
    v_cvt_pk_bf16_f32 v143, v98, v99
    s_waitcnt vmcnt(4)
    s_barrier
    s_setprio 3
    v_mfma_f32_32x32x16_bf16 v[116:131], v[172:175], v[140:143], v[116:131]
    v_exp_f32 v68, v68
    v_exp_f32 v69, v69
    v_exp_f32 v70, v70
    s_waitcnt lgkmcnt(0)
    v_mfma_f32_32x32x16_bf16 v[84:99], v[152:155], v[8:11], v[100:115]
    v_exp_f32 v71, v71
    v_exp_f32 v72, v72
    v_exp_f32 v73, v73
    v_smfmac_f32_16x16x64_bf16 v[132:135], v[36:39], v[136:143], v197
    ds_read_b128 v[168:171], v2 offset:30720
    ds_read_b128 v[172:175], v2 offset:31744
    v_exp_f32 v74, v74
    v_exp_f32 v75, v75
    v_mfma_f32_32x32x16_bf16 v[84:99], v[156:159], v[12:15], v[84:99]
    v_cvt_pk_bf16_f32 v136, v68, v69
    v_cvt_pk_bf16_f32 v137, v70, v71
    v_cvt_pk_bf16_f32 v138, v72, v73
    v_cvt_pk_bf16_f32 v139, v74, v75
    v_exp_f32 v76, v76
    ds_read_b128 v[144:147], v2 offset:32768
    ds_read_b128 v[148:151], v2 offset:33792
    v_mfma_f32_32x32x16_bf16 v[116:131], v[160:163], v[136:139], v[116:131]
    v_exp_f32 v77, v77
    v_exp_f32 v78, v78
    v_exp_f32 v79, v79
    s_waitcnt vmcnt(1)
    s_mov_b64 exec, 65520
    v_cmp_ne_u32_e64 s[54:55], 0, v29
    s_mov_b64 exec, -1
    s_and_b32 s47, s54, 16
    s_cmp_eq_u32 s47, 16
    s_cbranch_scc1 qa_kernel_FL4_E
    s_mov_b32 s62, 262144
    s_mov_b64 exec, 16
qa_kernel_FL4:
    buffer_load_dword v29, v28, s[36:39], s57 offen sc1
    s_waitcnt vmcnt(0)
    v_cmp_ne_u32_e64 vcc, 0, v29
    s_sub_u32 s62, s62, 1
    s_cbranch_scc1 qa_kernel_FL4_X
    s_cmp_eq_u32 vcc_lo, 16
    s_cbranch_scc0 qa_kernel_FL4
qa_kernel_FL4_X:
    s_mov_b64 exec, -1
qa_kernel_FL4_E:
    buffer_load_dwordx4 v[180:183], v31, s[68:71], s72 offen
    s_add_u32 s72, s72, 114688
    s_add_u32 m0, s61, 0
    s_nop 0
    buffer_load_dwordx4 v26, s[36:39], s59 offen sc1 lds
    buffer_load_dwordx4 v26, s[36:39], s59 offen offset:1024 sc1 lds
    s_add_u32 s60, s60, 16384
    s_and_b32 s60, s60, 0x3ffff
    s_add_u32 s59, s58, s60
    v_exp_f32 v80, v80
    v_exp_f32 v81, v81
    v_exp_f32 v82, v82
    v_exp_f32 v83, v83
    v_cvt_pk_bf16_f32 v140, v76, v77
    v_cvt_pk_bf16_f32 v141, v78, v79
    v_cvt_pk_bf16_f32 v142, v80, v81
    v_cvt_pk_bf16_f32 v143, v82, v83
    s_nop 1
    v_mfma_f32_32x32x16_bf16 v[116:131], v[164:167], v[140:143], v[116:131]
    v_exp_f32 v84, v84
    v_exp_f32 v85, v85
    v_exp_f32 v86, v86
    s_waitcnt lgkmcnt(0)
    v_mfma_f32_32x32x16_bf16 v[68:83], v[144:147], v[8:11], v[100:115]
    v_exp_f32 v87, v87
    v_exp_f32 v88, v88
    v_exp_f32 v89, v89
    v_smfmac_f32_16x16x64_bf16 v[132:135], v[36:39], v[136:143], v197
    ds_read_b128 v[160:163], v2 offset:34816
    ds_read_b128 v[164:167], v2 offset:35840
    v_exp_f32 v90, v90
    v_exp_f32 v91, v91
    v_mfma_f32_32x32x16_bf16 v[68:83], v[148:151], v[12:15], v[68:83]
    v_cvt_pk_bf16_f32 v136, v84, v85
    v_cvt_pk_bf16_f32 v137, v86, v87
    v_cvt_pk_bf16_f32 v138, v88, v89
    v_cvt_pk_bf16_f32 v139, v90, v91
    v_exp_f32 v92, v92
    ds_read_b128 v[152:155], v2 offset:36864
    ds_read_b128 v[156:159], v2 offset:37888
    v_mfma_f32_32x32x16_bf16 v[116:131], v[168:171], v[136:139], v[116:131]
    v_exp_f32 v93, v93
    v_exp_f32 v94, v94
    v_exp_f32 v95, v95
    v_exp_f32 v96, v96
    v_exp_f32 v97, v97
    v_exp_f32 v98, v98
    v_exp_f32 v99, v99
    v_cvt_pk_bf16_f32 v140, v92, v93
    v_cvt_pk_bf16_f32 v141, v94, v95
    v_cvt_pk_bf16_f32 v142, v96, v97
    v_cvt_pk_bf16_f32 v143, v98, v99
    s_setprio 2
    s_nop 0
    v_mfma_f32_32x32x16_bf16 v[116:131], v[172:175], v[140:143], v[116:131]
    v_exp_f32 v68, v68
    v_exp_f32 v69, v69
    v_exp_f32 v70, v70
    s_waitcnt lgkmcnt(0)
    v_mfma_f32_32x32x16_bf16 v[84:99], v[152:155], v[8:11], v[100:115]
    v_exp_f32 v71, v71
    v_exp_f32 v72, v72
    v_exp_f32 v73, v73
    v_smfmac_f32_16x16x64_bf16 v[132:135], v[36:39], v[136:143], v197
    ds_read_b128 v[168:171], v2 offset:38912
    ds_read_b128 v[172:175], v2 offset:39936
    v_exp_f32 v74, v74
    v_exp_f32 v75, v75
    v_mfma_f32_32x32x16_bf16 v[84:99], v[156:159], v[12:15], v[84:99]
    v_cvt_pk_bf16_f32 v136, v68, v69
    v_cvt_pk_bf16_f32 v137, v70, v71
    v_cvt_pk_bf16_f32 v138, v72, v73
    v_cvt_pk_bf16_f32 v139, v74, v75
    v_exp_f32 v76, v76
    ds_read_b128 v[144:147], v2 offset:40960
    ds_read_b128 v[148:151], v2 offset:41984
    v_mfma_f32_32x32x16_bf16 v[116:131], v[160:163], v[136:139], v[116:131]
    v_exp_f32 v77, v77
    v_exp_f32 v78, v78
    v_exp_f32 v79, v79
    v_exp_f32 v80, v80
    v_exp_f32 v81, v81
    v_exp_f32 v82, v82
    v_exp_f32 v83, v83
    v_cvt_pk_bf16_f32 v140, v76, v77
    v_cvt_pk_bf16_f32 v141, v78, v79
    v_cvt_pk_bf16_f32 v142, v80, v81
    v_cvt_pk_bf16_f32 v143, v82, v83
    s_setprio 1
    s_nop 0
    v_mfma_f32_32x32x16_bf16 v[116:131], v[164:167], v[140:143], v[116:131]
    v_exp_f32 v84, v84
    v_exp_f32 v85, v85
    v_exp_f32 v86, v86
    s_waitcnt lgkmcnt(0)
    v_mfma_f32_32x32x16_bf16 v[68:83], v[144:147], v[8:11], v[100:115]
    v_exp_f32 v87, v87
    v_exp_f32 v88, v88
    v_exp_f32 v89, v89
    v_smfmac_f32_16x16x64_bf16 v[132:135], v[36:39], v[136:143], v197
    ds_read_b128 v[160:163], v2 offset:43008
    ds_read_b128 v[164:167], v2 offset:44032
    v_exp_f32 v90, v90
    v_exp_f32 v91, v91
    v_mfma_f32_32x32x16_bf16 v[68:83], v[148:151], v[12:15], v[68:83]
    v_cvt_pk_bf16_f32 v136, v84, v85
    v_cvt_pk_bf16_f32 v137, v86, v87
    v_cvt_pk_bf16_f32 v138, v88, v89
    v_cvt_pk_bf16_f32 v139, v90, v91
    v_exp_f32 v92, v92
    ds_read_b128 v[152:155], v2 offset:45056
    ds_read_b128 v[156:159], v2 offset:46080
    v_mfma_f32_32x32x16_bf16 v[116:131], v[168:171], v[136:139], v[116:131]
    v_exp_f32 v93, v93
    v_exp_f32 v94, v94
    v_exp_f32 v95, v95
    s_add_u32 s47, s49, 0
    s_and_b32 s47, s47, 0x1fffff
    s_add_u32 m0, s51, 65536
    s_nop 0
    buffer_load_dwordx4 v53, s[32:35], s47 offen lds
    s_mov_b32 s47, 20971520
    buffer_store_dwordx4 v[192:195], v202, s[36:39], s47 offen sc1
    s_setprio 0
    v_exp_f32 v96, v96
    v_exp_f32 v97, v97
    v_exp_f32 v98, v98
    v_exp_f32 v99, v99
    v_cvt_pk_bf16_f32 v140, v92, v93
    v_cvt_pk_bf16_f32 v141, v94, v95
    v_cvt_pk_bf16_f32 v142, v96, v97
    v_cvt_pk_bf16_f32 v143, v98, v99
    s_barrier
    s_setprio 3
    v_mfma_f32_32x32x16_bf16 v[116:131], v[172:175], v[140:143], v[116:131]
    v_exp_f32 v68, v68
    v_exp_f32 v69, v69
    v_exp_f32 v70, v70
    s_waitcnt lgkmcnt(0)
    v_mfma_f32_32x32x16_bf16 v[84:99], v[152:155], v[8:11], v[100:115]
    v_exp_f32 v71, v71
    v_exp_f32 v72, v72
    v_exp_f32 v73, v73
    v_smfmac_f32_16x16x64_bf16 v[132:135], v[36:39], v[136:143], v197
    ds_read_b128 v[168:171], v2 offset:47104
    ds_read_b128 v[172:175], v2 offset:48128
    v_exp_f32 v74, v74
    v_exp_f32 v75, v75
    v_mfma_f32_32x32x16_bf16 v[84:99], v[156:159], v[12:15], v[84:99]
    v_cvt_pk_bf16_f32 v136, v68, v69
    v_cvt_pk_bf16_f32 v137, v70, v71
    v_cvt_pk_bf16_f32 v138, v72, v73
    v_cvt_pk_bf16_f32 v139, v74, v75
    v_exp_f32 v76, v76
    ds_read_b128 v[144:147], v2 offset:49152
    ds_read_b128 v[148:151], v2 offset:50176
    v_mfma_f32_32x32x16_bf16 v[116:131], v[160:163], v[136:139], v[116:131]
    v_exp_f32 v77, v77
    v_exp_f32 v78, v78
    v_exp_f32 v79, v79
    s_and_b32 s47, s54, 32
    s_cmp_eq_u32 s47, 32
    s_cbranch_scc1 qa_kernel_FL5_E
    s_mov_b32 s62, 262144
    s_mov_b64 exec, 32
qa_kernel_FL5:
    buffer_load_dword v29, v28, s[36:39], s57 offen sc1
    s_waitcnt vmcnt(0)
    v_cmp_ne_u32_e64 vcc, 0, v29
    s_sub_u32 s62, s62, 1
    s_cbranch_scc1 qa_kernel_FL5_X
    s_cmp_eq_u32 vcc_lo, 32
    s_cbranch_scc0 qa_kernel_FL5
qa_kernel_FL5_X:
    s_mov_b64 exec, -1
qa_kernel_FL5_E:
    buffer_load_dwordx4 v[184:187], v31, s[68:71], s72 offen
    s_add_u32 s72, s72, 114688
    s_add_u32 m0, s61, 16384
    s_nop 0
    buffer_load_dwordx4 v26, s[36:39], s59 offen sc1 lds
    buffer_load_dwordx4 v26, s[36:39], s59 offen offset:1024 sc1 lds
    s_add_u32 s60, s60, 16384
    s_and_b32 s60, s60, 0x3ffff
    s_add_u32 s59, s58, s60
    v_exp_f32 v80, v80
    v_exp_f32 v81, v81
    v_exp_f32 v82, v82
    v_exp_f32 v83, v83
    v_cvt_pk_bf16_f32 v140, v76, v77
    v_cvt_pk_bf16_f32 v141, v78, v79
    v_cvt_pk_bf16_f32 v142, v80, v81
    v_cvt_pk_bf16_f32 v143, v82, v83
    s_nop 1
    v_mfma_f32_32x32x16_bf16 v[116:131], v[164:167], v[140:143], v[116:131]
    v_exp_f32 v84, v84
    v_exp_f32 v85, v85
    v_exp_f32 v86, v86
    s_waitcnt lgkmcnt(0)
    v_mfma_f32_32x32x16_bf16 v[68:83], v[144:147], v[8:11], v[100:115]
    v_exp_f32 v87, v87
    v_exp_f32 v88, v88
    v_exp_f32 v89, v89
    v_smfmac_f32_16x16x64_bf16 v[132:135], v[36:39], v[136:143], v197
    ds_read_b128 v[160:163], v2 offset:51200
    ds_read_b128 v[164:167], v2 offset:52224
    v_exp_f32 v90, v90
    v_exp_f32 v91, v91
    v_mfma_f32_32x32x16_bf16 v[68:83], v[148:151], v[12:15], v[68:83]
    v_cvt_pk_bf16_f32 v136, v84, v85
    v_cvt_pk_bf16_f32 v137, v86, v87
    v_cvt_pk_bf16_f32 v138, v88, v89
    v_cvt_pk_bf16_f32 v139, v90, v91
    v_exp_f32 v92, v92
    ds_read_b128 v[152:155], v2 offset:53248
    ds_read_b128 v[156:159], v2 offset:54272
    v_mfma_f32_32x32x16_bf16 v[116:131], v[168:171], v[136:139], v[116:131]
    v_exp_f32 v93, v93
    v_exp_f32 v94, v94
    v_exp_f32 v95, v95
    v_exp_f32 v96, v96
    v_exp_f32 v97, v97
    v_exp_f32 v98, v98
    v_exp_f32 v99, v99
    v_cvt_pk_bf16_f32 v140, v92, v93
    v_cvt_pk_bf16_f32 v141, v94, v95
    v_cvt_pk_bf16_f32 v142, v96, v97
    v_cvt_pk_bf16_f32 v143, v98, v99
    s_setprio 2
    s_nop 0
    v_mfma_f32_32x32x16_bf16 v[116:131], v[172:175], v[140:143], v[116:131]
    v_exp_f32 v68, v68
    v_exp_f32 v69, v69
    v_exp_f32 v70, v70
    s_waitcnt lgkmcnt(0)
    v_mfma_f32_32x32x16_bf16 v[84:99], v[152:155], v[8:11], v[100:115]
    v_exp_f32 v71, v71
    v_exp_f32 v72, v72
    v_exp_f32 v73, v73
    v_smfmac_f32_16x16x64_bf16 v[132:135], v[36:39], v[136:143], v197
    ds_read_b128 v[168:171], v2 offset:55296
    ds_read_b128 v[172:175], v2 offset:56320
    v_exp_f32 v74, v74
    v_exp_f32 v75, v75
    v_mfma_f32_32x32x16_bf16 v[84:99], v[156:159], v[12:15], v[84:99]
    v_cvt_pk_bf16_f32 v136, v68, v69
    v_cvt_pk_bf16_f32 v137, v70, v71
    v_cvt_pk_bf16_f32 v138, v72, v73
    v_cvt_pk_bf16_f32 v139, v74, v75
    v_exp_f32 v76, v76
    ds_read_b128 v[144:147], v2 offset:57344
    ds_read_b128 v[148:151], v2 offset:58368
    v_mfma_f32_32x32x16_bf16 v[116:131], v[160:163], v[136:139], v[116:131]
    v_exp_f32 v77, v77
    v_exp_f32 v78, v78
    v_exp_f32 v79, v79
    v_exp_f32 v80, v80
    v_exp_f32 v81, v81
    v_exp_f32 v82, v82
    v_exp_f32 v83, v83
    v_cvt_pk_bf16_f32 v140, v76, v77
    v_cvt_pk_bf16_f32 v141, v78, v79
    v_cvt_pk_bf16_f32 v142, v80, v81
    v_cvt_pk_bf16_f32 v143, v82, v83
    s_setprio 1
    s_nop 0
    v_mfma_f32_32x32x16_bf16 v[116:131], v[164:167], v[140:143], v[116:131]
    v_exp_f32 v84, v84
    v_exp_f32 v85, v85
    v_exp_f32 v86, v86
    s_waitcnt lgkmcnt(0)
    v_mfma_f32_32x32x16_bf16 v[68:83], v[144:147], v[8:11], v[100:115]
    v_exp_f32 v87, v87
    v_exp_f32 v88, v88
    v_exp_f32 v89, v89
    v_smfmac_f32_16x16x64_bf16 v[132:135], v[36:39], v[136:143], v197
    ds_read_b128 v[160:163], v2 offset:59392
    ds_read_b128 v[164:167], v2 offset:60416
    v_exp_f32 v90, v90
    v_exp_f32 v91, v91
    v_mfma_f32_32x32x16_bf16 v[68:83], v[148:151], v[12:15], v[68:83]
    v_cvt_pk_bf16_f32 v136, v84, v85
    v_cvt_pk_bf16_f32 v137, v86, v87
qa_kernel_WS0_6:
    s_cbranch_execz qa_kernel_WRET0
    v_cvt_pk_bf16_f32 v138, v88, v89
    v_cvt_pk_bf16_f32 v139, v90, v91
    v_exp_f32 v92, v92
    ds_read_b128 v[152:155], v2 offset:61440
    ds_read_b128 v[156:159], v2 offset:62464
    v_mfma_f32_32x32x16_bf16 v[116:131], v[168:171], v[136:139], v[116:131]
    v_exp_f32 v93, v93
    v_exp_f32 v94, v94
    v_exp_f32 v95, v95
    s_mov_b64 exec, 65520
    buffer_load_dword v29, v28, s[36:39], s57 offen sc1
    s_mov_b64 exec, -1
    s_add_u32 s47, s49, 131072
    s_and_b32 s47, s47, 0x1fffff
    s_add_u32 m0, s51, 73728
    s_nop 0
    buffer_load_dwordx4 v53, s[32:35], s47 offen lds
    s_mov_b32 s47, 23068672
    buffer_store_dwordx4 v[192:195], v202, s[36:39], s47 offen sc1
    s_setprio 0
    v_exp_f32 v96, v96
    v_exp_f32 v97, v97
    v_exp_f32 v98, v98
    v_exp_f32 v99, v99
    v_cvt_pk_bf16_f32 v140, v92, v93
    v_cvt_pk_bf16_f32 v141, v94, v95
    v_cvt_pk_bf16_f32 v142, v96, v97
    v_cvt_pk_bf16_f32 v143, v98, v99
    s_waitcnt vmcnt(8)
    s_barrier
    s_setprio 3
    v_mfma_f32_32x32x16_bf16 v[116:131], v[172:175], v[140:143], v[116:131]
    v_exp_f32 v68, v68
    v_exp_f32 v69, v69
    v_exp_f32 v70, v70
    s_waitcnt lgkmcnt(0)
    v_mfma_f32_32x32x16_bf16 v[84:99], v[152:155], v[8:11], v[100:115]
    v_exp_f32 v71, v71
    v_exp_f32 v72, v72
    v_exp_f32 v73, v73
    v_smfmac_f32_16x16x64_bf16 v[132:135], v[36:39], v[136:143], v197
    ds_read_b128 v[168:171], v2 offset:63488
    ds_read_b128 v[172:175], v2 offset:64512
    v_exp_f32 v74, v74
    v_exp_f32 v75, v75
    v_mfma_f32_32x32x16_bf16 v[84:99], v[156:159], v[12:15], v[84:99]
    v_cvt_pk_bf16_f32 v136, v68, v69
    v_cvt_pk_bf16_f32 v137, v70, v71
    v_cvt_pk_bf16_f32 v138, v72, v73
    v_cvt_pk_bf16_f32 v139, v74, v75
    v_exp_f32 v76, v76
    ds_read_b128 v[144:147], v2 offset:0
    ds_read_b128 v[148:151], v2 offset:1024
    v_mfma_f32_32x32x16_bf16 v[116:131], v[160:163], v[136:139], v[116:131]
    v_exp_f32 v77, v77
    v_exp_f32 v78, v78
    v_exp_f32 v79, v79
    v_mfma_f32_16x16x32_bf16 v[188:191], v[32:35], v[180:183], 0
    s_waitcnt vmcnt(2)
    s_mov_b64 exec, 65520
    v_cmp_ne_u32_e64 s[54:55], 0, v29
    s_mov_b64 exec, -1
    s_and_b32 s47, s54, 64
    s_cmp_eq_u32 s47, 64
    s_cbranch_scc1 qa_kernel_FL6_E
    s_mov_b32 s62, 262144
    s_mov_b64 exec, 64
qa_kernel_FL6:
    buffer_load_dword v29, v28, s[36:39], s57 offen sc1
    s_waitcnt vmcnt(0)
    v_cmp_ne_u32_e64 vcc, 0, v29
    s_sub_u32 s62, s62, 1
    s_cbranch_scc1 qa_kernel_FL6_X
    s_cmp_eq_u32 vcc_lo, 64
    s_cbranch_scc0 qa_kernel_FL6
qa_kernel_FL6_X:
    s_mov_b64 exec, -1
qa_kernel_FL6_E:
    buffer_load_dwordx4 v[180:183], v31, s[68:71], s72 offen
    s_add_u32 s72, s72, 114688
    s_add_u32 m0, s61, 32768
    s_nop 0
    buffer_load_dwordx4 v26, s[36:39], s59 offen sc1 lds
    buffer_load_dwordx4 v26, s[36:39], s59 offen offset:1024 sc1 lds
    s_add_u32 s60, s60, 16384
    s_and_b32 s60, s60, 0x3ffff
    s_add_u32 s59, s58, s60
    v_exp_f32 v80, v80
    v_exp_f32 v81, v81
    v_exp_f32 v82, v82
    v_exp_f32 v83, v83
    v_cvt_pk_bf16_f32 v140, v76, v77
    v_cvt_pk_bf16_f32 v141, v78, v79
    v_cvt_pk_bf16_f32 v142, v80, v81
    v_cvt_pk_bf16_f32 v143, v82, v83
    s_nop 1
    v_mfma_f32_32x32x16_bf16 v[116:131], v[164:167], v[140:143], v[116:131]
    v_exp_f32 v84, v84
    v_exp_f32 v85, v85
    v_exp_f32 v86, v86
    s_waitcnt lgkmcnt(0)
    v_mfma_f32_32x32x16_bf16 v[68:83], v[144:147], v[8:11], v[100:115]
    v_exp_f32 v87, v87
    v_exp_f32 v88, v88
    v_exp_f32 v89, v89
    v_smfmac_f32_16x16x64_bf16 v[132:135], v[36:39], v[136:143], v197
    ds_read_b128 v[160:163], v2 offset:2048
    ds_read_b128 v[164:167], v2 offset:3072
    v_exp_f32 v90, v90
    v_exp_f32 v91, v91
    v_mfma_f32_32x32x16_bf16 v[68:83], v[148:151], v[12:15], v[68:83]
    v_cvt_pk_bf16_f32 v136, v84, v85
    v_cvt_pk_bf16_f32 v137, v86, v87
    v_cvt_pk_bf16_f32 v138, v88, v89
    v_cvt_pk_bf16_f32 v139, v90, v91
    v_exp_f32 v92, v92
    ds_read_b128 v[152:155], v2 offset:4096
    ds_read_b128 v[156:159], v2 offset:5120
    v_mfma_f32_32x32x16_bf16 v[116:131], v[168:171], v[136:139], v[116:131]
    v_exp_f32 v93, v93
    v_exp_f32 v94, v94
    v_exp_f32 v95, v95
    v_exp_f32 v96, v96
    v_exp_f32 v97, v97
    v_exp_f32 v98, v98
    v_exp_f32 v99, v99
    v_cvt_pk_bf16_f32 v140, v92, v93
    v_cvt_pk_bf16_f32 v141, v94, v95
    v_cvt_pk_bf16_f32 v142, v96, v97
    v_cvt_pk_bf16_f32 v143, v98, v99
    s_setprio 2
    s_nop 0
    v_mfma_f32_32x32x16_bf16 v[116:131], v[172:175], v[140:143], v[116:131]
    v_exp_f32 v68, v68
    v_exp_f32 v69, v69
    v_exp_f32 v70, v70
    s_waitcnt lgkmcnt(0)
    v_mfma_f32_32x32x16_bf16 v[84:99], v[152:155], v[8:11], v[100:115]
    v_exp_f32 v71, v71
    v_exp_f32 v72, v72
    v_exp_f32 v73, v73
    v_smfmac_f32_16x16x64_bf16 v[132:135], v[36:39], v[136:143], v197
    ds_read_b128 v[168:171], v2 offset:6144
    ds_read_b128 v[172:175], v2 offset:7168
    v_exp_f32 v74, v74
    v_exp_f32 v75, v75
    v_mfma_f32_32x32x16_bf16 v[84:99], v[156:159], v[12:15], v[84:99]
    v_cvt_pk_bf16_f32 v136, v68, v69
    v_cvt_pk_bf16_f32 v137, v70, v71
    v_cvt_pk_bf16_f32 v138, v72, v73
    v_cvt_pk_bf16_f32 v139, v74, v75
    v_exp_f32 v76, v76
    ds_read_b128 v[144:147], v2 offset:8192
    ds_read_b128 v[148:151], v2 offset:9216
    v_mfma_f32_32x32x16_bf16 v[116:131], v[160:163], v[136:139], v[116:131]
    v_exp_f32 v77, v77
    v_exp_f32 v78, v78
    v_exp_f32 v79, v79
    v_exp_f32 v80, v80
    v_exp_f32 v81, v81
    v_exp_f32 v82, v82
    v_exp_f32 v83, v83
    v_cvt_pk_bf16_f32 v140, v76, v77
    v_cvt_pk_bf16_f32 v141, v78, v79
    v_cvt_pk_bf16_f32 v142, v80, v81
    v_cvt_pk_bf16_f32 v143, v82, v83
    s_setprio 1
    s_nop 0
    v_mfma_f32_32x32x16_bf16 v[116:131], v[164:167], v[140:143], v[116:131]
    v_exp_f32 v84, v84
    v_exp_f32 v85, v85
    v_exp_f32 v86, v86
    s_waitcnt lgkmcnt(0)
    v_mfma_f32_32x32x16_bf16 v[68:83], v[144:147], v[8:11], v[100:115]
    v_exp_f32 v87, v87
    v_exp_f32 v88, v88
    v_exp_f32 v89, v89
    v_smfmac_f32_16x16x64_bf16 v[132:135], v[36:39], v[136:143], v197
    ds_read_b128 v[160:163], v2 offset:10240
    ds_read_b128 v[164:167], v2 offset:11264
    v_exp_f32 v90, v90
    v_exp_f32 v91, v91
    v_mfma_f32_32x32x16_bf16 v[68:83], v[148:151], v[12:15], v[68:83]
    v_cvt_pk_bf16_f32 v136, v84, v85
    v_cvt_pk_bf16_f32 v137, v86, v87
    v_cvt_pk_bf16_f32 v138, v88, v89
    v_cvt_pk_bf16_f32 v139, v90, v91
    v_exp_f32 v92, v92
    ds_read_b128 v[152:155], v2 offset:12288
    ds_read_b128 v[156:159], v2 offset:13312
    v_mfma_f32_32x32x16_bf16 v[116:131], v[168:171], v[136:139], v[116:131]
    v_exp_f32 v93, v93
    v_exp_f32 v94, v94
    v_exp_f32 v95, v95
    s_add_u32 s47, s49, 262144
    s_and_b32 s47, s47, 0x1fffff
    s_add_u32 m0, s51, 81920
    s_nop 0
    buffer_load_dwordx4 v53, s[32:35], s47 offen lds
    s_mov_b32 s47, 25165824
    buffer_store_dwordx4 v[192:195], v203, s[36:39], s47 offen sc1
    s_setprio 0
    v_exp_f32 v96, v96
    v_exp_f32 v97, v97
    v_exp_f32 v98, v98
    v_exp_f32 v99, v99
    v_cvt_pk_bf16_f32 v140, v92, v93
    v_cvt_pk_bf16_f32 v141, v94, v95
    v_cvt_pk_bf16_f32 v142, v96, v97
    v_cvt_pk_bf16_f32 v143, v98, v99
    s_barrier
    s_setprio 3
    v_mfma_f32_32x32x16_bf16 v[116:131], v[172:175], v[140:143], v[116:131]
    v_exp_f32 v68, v68
    v_exp_f32 v69, v69
    v_exp_f32 v70, v70
    s_waitcnt lgkmcnt(0)
    v_mfma_f32_32x32x16_bf16 v[84:99], v[152:155], v[8:11], v[100:115]
    v_exp_f32 v71, v71
    v_exp_f32 v72, v72
    v_exp_f32 v73, v73
    v_smfmac_f32_16x16x64_bf16 v[132:135], v[36:39], v[136:143], v197
    ds_read_b128 v[168:171], v2 offset:14336
    ds_read_b128 v[172:175], v2 offset:15360
    v_exp_f32 v74, v74
    v_exp_f32 v75, v75
    v_mfma_f32_32x32x16_bf16 v[84:99], v[156:159], v[12:15], v[84:99]
    v_cvt_pk_bf16_f32 v136, v68, v69
    v_cvt_pk_bf16_f32 v137, v70, v71
    v_cvt_pk_bf16_f32 v138, v72, v73
    v_cvt_pk_bf16_f32 v139, v74, v75
    v_exp_f32 v76, v76
    ds_read_b128 v[144:147], v2 offset:16384
    ds_read_b128 v[148:151], v2 offset:17408
    v_mfma_f32_32x32x16_bf16 v[116:131], v[160:163], v[136:139], v[116:131]
    v_exp_f32 v77, v77
    v_exp_f32 v78, v78
    v_exp_f32 v79, v79
    v_mfma_f32_16x16x32_bf16 v[188:191], v[32:35], v[184:187], v[188:191]
    s_and_b32 s47, s54, 128
    s_cmp_eq_u32 s47, 128
    s_cbranch_scc1 qa_kernel_FL7_E
    s_mov_b32 s62, 262144
    s_mov_b64 exec, 128
qa_kernel_FL7:
    buffer_load_dword v29, v28, s[36:39], s57 offen sc1
    s_waitcnt vmcnt(0)
    v_cmp_ne_u32_e64 vcc, 0, v29
    s_sub_u32 s62, s62, 1
    s_cbranch_scc1 qa_kernel_FL7_X
    s_cmp_eq_u32 vcc_lo, 128
    s_cbranch_scc0 qa_kernel_FL7
qa_kernel_FL7_X:
    s_mov_b64 exec, -1
qa_kernel_FL7_E:
    buffer_load_dwordx4 v[184:187], v31, s[68:71], s72 offen
    s_add_u32 s72, s72, 114688
    s_add_u32 m0, s61, 49152
    s_nop 0
    buffer_load_dwordx4 v26, s[36:39], s59 offen sc1 lds
    buffer_load_dwordx4 v26, s[36:39], s59 offen offset:1024 sc1 lds
    s_add_u32 s60, s60, 16384
    s_and_b32 s60, s60, 0x3ffff
    s_add_u32 s59, s58, s60
    v_exp_f32 v80, v80
    v_exp_f32 v81, v81
    v_exp_f32 v82, v82
    v_exp_f32 v83, v83
    v_cvt_pk_bf16_f32 v140, v76, v77
    v_cvt_pk_bf16_f32 v141, v78, v79
    v_cvt_pk_bf16_f32 v142, v80, v81
    v_cvt_pk_bf16_f32 v143, v82, v83
    s_nop 1
    v_mfma_f32_32x32x16_bf16 v[116:131], v[164:167], v[140:143], v[116:131]
    v_exp_f32 v84, v84
    v_exp_f32 v85, v85
    v_exp_f32 v86, v86
    s_waitcnt lgkmcnt(0)
    v_mfma_f32_32x32x16_bf16 v[68:83], v[144:147], v[8:11], v[100:115]
    v_exp_f32 v87, v87
    v_exp_f32 v88, v88
    v_exp_f32 v89, v89
    v_smfmac_f32_16x16x64_bf16 v[132:135], v[36:39], v[136:143], v197
    ds_read_b128 v[160:163], v2 offset:18432
    ds_read_b128 v[164:167], v2 offset:19456
    v_exp_f32 v90, v90
    v_exp_f32 v91, v91
    v_mfma_f32_32x32x16_bf16 v[68:83], v[148:151], v[12:15], v[68:83]
    v_cvt_pk_bf16_f32 v136, v84, v85
    v_cvt_pk_bf16_f32 v137, v86, v87
    v_cvt_pk_bf16_f32 v138, v88, v89
    v_cvt_pk_bf16_f32 v139, v90, v91
    v_exp_f32 v92, v92
    ds_read_b128 v[152:155], v2 offset:20480
    ds_read_b128 v[156:159], v2 offset:21504
    v_mfma_f32_32x32x16_bf16 v[116:131], v[168:171], v[136:139], v[116:131]
    v_exp_f32 v93, v93
    v_exp_f32 v94, v94
    v_exp_f32 v95, v95
    v_exp_f32 v96, v96
    v_exp_f32 v97, v97
    v_exp_f32 v98, v98
    v_exp_f32 v99, v99
    v_cvt_pk_bf16_f32 v140, v92, v93
    v_cvt_pk_bf16_f32 v141, v94, v95
    v_cvt_pk_bf16_f32 v142, v96, v97
    v_cvt_pk_bf16_f32 v143, v98, v99
    s_setprio 2
    s_nop 0
    v_mfma_f32_32x32x16_bf16 v[116:131], v[172:175], v[140:143], v[116:131]
    v_exp_f32 v68, v68
    v_exp_f32 v69, v69
    v_exp_f32 v70, v70
    s_waitcnt lgkmcnt(0)
    v_mfma_f32_32x32x16_bf16 v[84:99], v[152:155], v[8:11], v[100:115]
    v_exp_f32 v71, v71
    v_exp_f32 v72, v72
    v_exp_f32 v73, v73
    v_smfmac_f32_16x16x64_bf16 v[132:135], v[36:39], v[136:143], v197
    ds_read_b128 v[168:171], v2 offset:22528
    ds_read_b128 v[172:175], v2 offset:23552
    v_exp_f32 v74, v74
    v_exp_f32 v75, v75
    v_mfma_f32_32x32x16_bf16 v[84:99], v[156:159], v[12:15], v[84:99]
    v_cvt_pk_bf16_f32 v136, v68, v69
    v_cvt_pk_bf16_f32 v137, v70, v71
    v_cvt_pk_bf16_f32 v138, v72, v73
    v_cvt_pk_bf16_f32 v139, v74, v75
    v_exp_f32 v76, v76
    ds_read_b128 v[144:147], v2 offset:24576
    ds_read_b128 v[148:151], v2 offset:25600
    v_mfma_f32_32x32x16_bf16 v[116:131], v[160:163], v[136:139], v[116:131]
    v_exp_f32 v77, v77
    v_exp_f32 v78, v78
    v_exp_f32 v79, v79
    v_exp_f32 v80, v80
    v_exp_f32 v81, v81
    v_exp_f32 v82, v82
    v_exp_f32 v83, v83
    v_cvt_pk_bf16_f32 v140, v76, v77
    v_cvt_pk_bf16_f32 v141, v78, v79
    v_cvt_pk_bf16_f32 v142, v80, v81
    v_cvt_pk_bf16_f32 v143, v82, v83
    s_setprio 1
    s_nop 0
    v_mfma_f32_32x32x16_bf16 v[116:131], v[164:167], v[140:143], v[116:131]
    v_exp_f32 v84, v84
    v_exp_f32 v85, v85
    v_exp_f32 v86, v86
    s_waitcnt lgkmcnt(0)
    v_mfma_f32_32x32x16_bf16 v[68:83], v[144:147], v[8:11], v[100:115]
    v_exp_f32 v87, v87
    v_exp_f32 v88, v88
    v_exp_f32 v89, v89
    v_smfmac_f32_16x16x64_bf16 v[132:135], v[36:39], v[136:143], v197
    ds_read_b128 v[160:163], v2 offset:26624
    ds_read_b128 v[164:167], v2 offset:27648
    v_exp_f32 v90, v90
    v_exp_f32 v91, v91
    v_mfma_f32_32x32x16_bf16 v[68:83], v[148:151], v[12:15], v[68:83]
    v_cvt_pk_bf16_f32 v136, v84, v85
    v_cvt_pk_bf16_f32 v137, v86, v87
    v_cvt_pk_bf16_f32 v138, v88, v89
    v_cvt_pk_bf16_f32 v139, v90, v91
    v_exp_f32 v92, v92
    ds_read_b128 v[152:155], v2 offset:28672
    ds_read_b128 v[156:159], v2 offset:29696
    v_mfma_f32_32x32x16_bf16 v[116:131], v[168:171], v[136:139], v[116:131]
    v_exp_f32 v93, v93
    v_exp_f32 v94, v94
    v_exp_f32 v95, v95
    s_add_u32 s47, s49, 393216
    s_and_b32 s47, s47, 0x1fffff
    s_add_u32 m0, s51, 90112
    s_nop 0
    buffer_load_dwordx4 v53, s[32:35], s47 offen lds
    s_mov_b32 s47, 44040192
    buffer_store_dwordx4 v[192:195], v202, s[36:39], s47 offen sc1
    s_setprio 0
    v_exp_f32 v96, v96
    v_exp_f32 v97, v97
    v_exp_f32 v98, v98
    v_exp_f32 v99, v99
    v_cvt_pk_bf16_f32 v140, v92, v93
    v_cvt_pk_bf16_f32 v141, v94, v95
    v_cvt_pk_bf16_f32 v142, v96, v97
    v_cvt_pk_bf16_f32 v143, v98, v99
    s_waitcnt vmcnt(7)
    s_barrier
    s_setprio 3
    v_mfma_f32_32x32x16_bf16 v[116:131], v[172:175], v[140:143], v[116:131]
    v_exp_f32 v68, v68
    v_exp_f32 v69, v69
    v_exp_f32 v70, v70
    s_waitcnt lgkmcnt(0)
    v_mfma_f32_32x32x16_bf16 v[84:99], v[152:155], v[8:11], v[100:115]
    v_exp_f32 v71, v71
    v_exp_f32 v72, v72
    v_exp_f32 v73, v73
    v_smfmac_f32_16x16x64_bf16 v[132:135], v[36:39], v[136:143], v197
    ds_read_b128 v[168:171], v2 offset:30720
    ds_read_b128 v[172:175], v2 offset:31744
    v_exp_f32 v74, v74
    v_exp_f32 v75, v75
    v_mfma_f32_32x32x16_bf16 v[84:99], v[156:159], v[12:15], v[84:99]
    v_cvt_pk_bf16_f32 v136, v68, v69
    v_cvt_pk_bf16_f32 v137, v70, v71
    v_cvt_pk_bf16_f32 v138, v72, v73
    v_cvt_pk_bf16_f32 v139, v74, v75
    v_exp_f32 v76, v76
    ds_read_b128 v[144:147], v2 offset:32768
    ds_read_b128 v[148:151], v2 offset:33792
    v_mfma_f32_32x32x16_bf16 v[116:131], v[160:163], v[136:139], v[116:131]
    v_exp_f32 v77, v77
    v_exp_f32 v78, v78
    v_exp_f32 v79, v79
    v_mfma_f32_16x16x32_bf16 v[188:191], v[32:35], v[180:183], v[188:191]
    s_and_b32 s47, s54, 256
    s_cmp_eq_u32 s47, 256
    s_cbranch_scc1 qa_kernel_FL8_E
    s_mov_b32 s62, 262144
    s_mov_b64 exec, 256
qa_kernel_FL8:
    buffer_load_dword v29, v28, s[36:39], s57 offen sc1
    s_waitcnt vmcnt(0)
    v_cmp_ne_u32_e64 vcc, 0, v29
    s_sub_u32 s62, s62, 1
    s_cbranch_scc1 qa_kernel_FL8_X
    s_cmp_eq_u32 vcc_lo, 256
    s_cbranch_scc0 qa_kernel_FL8
qa_kernel_FL8_X:
    s_mov_b64 exec, -1
qa_kernel_FL8_E:
    buffer_load_dwordx4 v[180:183], v31, s[68:71], s72 offen
    s_add_u32 s72, s72, 114688
    s_add_u32 m0, s61, 0
    s_nop 0
    buffer_load_dwordx4 v26, s[36:39], s59 offen sc1 lds
    buffer_load_dwordx4 v26, s[36:39], s59 offen offset:1024 sc1 lds
    s_add_u32 s60, s60, 16384
    s_and_b32 s60, s60, 0x3ffff
    s_add_u32 s59, s58, s60
    v_exp_f32 v80, v80
    v_exp_f32 v81, v81
    v_exp_f32 v82, v82
    v_exp_f32 v83, v83
    v_cvt_pk_bf16_f32 v140, v76, v77
    v_cvt_pk_bf16_f32 v141, v78, v79
    v_cvt_pk_bf16_f32 v142, v80, v81
    v_cvt_pk_bf16_f32 v143, v82, v83
    s_nop 1
    v_mfma_f32_32x32x16_bf16 v[116:131], v[164:167], v[140:143], v[116:131]
    v_exp_f32 v84, v84
    v_exp_f32 v85, v85
    v_exp_f32 v86, v86
    s_waitcnt lgkmcnt(0)
    v_mfma_f32_32x32x16_bf16 v[68:83], v[144:147], v[8:11], v[100:115]
    v_exp_f32 v87, v87
    v_exp_f32 v88, v88
    v_exp_f32 v89, v89
    v_smfmac_f32_16x16x64_bf16 v[132:135], v[36:39], v[136:143], v197
    ds_read_b128 v[160:163], v2 offset:34816
    ds_read_b128 v[164:167], v2 offset:35840
    v_exp_f32 v90, v90
    v_exp_f32 v91, v91
    v_mfma_f32_32x32x16_bf16 v[68:83], v[148:151], v[12:15], v[68:83]
    v_cvt_pk_bf16_f32 v136, v84, v85
    v_cvt_pk_bf16_f32 v137, v86, v87
    v_cvt_pk_bf16_f32 v138, v88, v89
    v_cvt_pk_bf16_f32 v139, v90, v91
    v_exp_f32 v92, v92
    ds_read_b128 v[152:155], v2 offset:36864
    ds_read_b128 v[156:159], v2 offset:37888
    v_mfma_f32_32x32x16_bf16 v[116:131], v[168:171], v[136:139], v[116:131]
    v_exp_f32 v93, v93
    v_exp_f32 v94, v94
    v_exp_f32 v95, v95
    v_exp_f32 v96, v96
    v_exp_f32 v97, v97
    v_exp_f32 v98, v98
    v_exp_f32 v99, v99
    v_cvt_pk_bf16_f32 v140, v92, v93
    v_cvt_pk_bf16_f32 v141, v94, v95
    v_cvt_pk_bf16_f32 v142, v96, v97
    v_cvt_pk_bf16_f32 v143, v98, v99
    s_setprio 2
    s_nop 0
    v_mfma_f32_32x32x16_bf16 v[116:131], v[172:175], v[140:143], v[116:131]
    v_exp_f32 v68, v68
    v_exp_f32 v69, v69
    v_exp_f32 v70, v70
    s_waitcnt lgkmcnt(0)
    v_mfma_f32_32x32x16_bf16 v[84:99], v[152:155], v[8:11], v[100:115]
    v_exp_f32 v71, v71
    v_exp_f32 v72, v72
    v_exp_f32 v73, v73
    v_smfmac_f32_16x16x64_bf16 v[132:135], v[36:39], v[136:143], v197
    ds_read_b128 v[168:171], v2 offset:38912
    ds_read_b128 v[172:175], v2 offset:39936
    v_exp_f32 v74, v74
    v_exp_f32 v75, v75
    v_mfma_f32_32x32x16_bf16 v[84:99], v[156:159], v[12:15], v[84:99]
    v_cvt_pk_bf16_f32 v136, v68, v69
    v_cvt_pk_bf16_f32 v137, v70, v71
    v_cvt_pk_bf16_f32 v138, v72, v73
    v_cvt_pk_bf16_f32 v139, v74, v75
    v_exp_f32 v76, v76
    ds_read_b128 v[144:147], v2 offset:40960
    ds_read_b128 v[148:151], v2 offset:41984
    v_mfma_f32_32x32x16_bf16 v[116:131], v[160:163], v[136:139], v[116:131]
    v_exp_f32 v77, v77
    v_exp_f32 v78, v78
    v_exp_f32 v79, v79
    v_exp_f32 v80, v80
    v_exp_f32 v81, v81
    v_exp_f32 v82, v82
    v_exp_f32 v83, v83
    v_cvt_pk_bf16_f32 v140, v76, v77
    v_cvt_pk_bf16_f32 v141, v78, v79
    v_cvt_pk_bf16_f32 v142, v80, v81
    v_cvt_pk_bf16_f32 v143, v82, v83
    s_setprio 1
    s_nop 0
    v_mfma_f32_32x32x16_bf16 v[116:131], v[164:167], v[140:143], v[116:131]
    v_exp_f32 v84, v84
    v_exp_f32 v85, v85
    v_exp_f32 v86, v86
    s_waitcnt lgkmcnt(0)
    v_mfma_f32_32x32x16_bf16 v[68:83], v[144:147], v[8:11], v[100:115]
    v_exp_f32 v87, v87
    v_exp_f32 v88, v88
    v_exp_f32 v89, v89
    v_smfmac_f32_16x16x64_bf16 v[132:135], v[36:39], v[136:143], v197
    ds_read_b128 v[160:163], v2 offset:43008
    ds_read_b128 v[164:167], v2 offset:44032
    v_exp_f32 v90, v90
    v_exp_f32 v91, v91
    v_mfma_f32_32x32x16_bf16 v[68:83], v[148:151], v[12:15], v[68:83]
    v_cvt_pk_bf16_f32 v136, v84, v85
    v_cvt_pk_bf16_f32 v137, v86, v87
    v_cvt_pk_bf16_f32 v138, v88, v89
    v_cvt_pk_bf16_f32 v139, v90, v91
    v_exp_f32 v92, v92
    ds_read_b128 v[152:155], v2 offset:45056
    ds_read_b128 v[156:159], v2 offset:46080
    v_mfma_f32_32x32x16_bf16 v[116:131], v[168:171], v[136:139], v[116:131]
    v_exp_f32 v93, v93
    v_exp_f32 v94, v94
    v_exp_f32 v95, v95
    s_add_u32 s47, s49, 524288
    s_and_b32 s47, s47, 0x1fffff
    s_add_u32 m0, s51, 98304
    s_nop 0
    buffer_load_dwordx4 v53, s[32:35], s47 offen lds
    s_mov_b32 s47, 46137344
    buffer_store_dwordx4 v[192:195], v202, s[36:39], s47 offen sc1
    s_setprio 0
    v_exp_f32 v96, v96
    v_exp_f32 v97, v97
    v_exp_f32 v98, v98
    v_exp_f32 v99, v99
    v_cvt_pk_bf16_f32 v140, v92, v93
    v_cvt_pk_bf16_f32 v141, v94, v95
    v_cvt_pk_bf16_f32 v142, v96, v97
    v_cvt_pk_bf16_f32 v143, v98, v99
    s_waitcnt vmcnt(7)
    s_barrier
    s_setprio 3
    v_mfma_f32_32x32x16_bf16 v[116:131], v[172:175], v[140:143], v[116:131]
    v_exp_f32 v68, v68
    v_exp_f32 v69, v69
    v_exp_f32 v70, v70
    s_waitcnt lgkmcnt(0)
    v_mfma_f32_32x32x16_bf16 v[84:99], v[152:155], v[8:11], v[100:115]
    v_exp_f32 v71, v71
    v_exp_f32 v72, v72
    v_exp_f32 v73, v73
    v_smfmac_f32_16x16x64_bf16 v[132:135], v[36:39], v[136:143], v197
    ds_read_b128 v[168:171], v2 offset:47104
    ds_read_b128 v[172:175], v2 offset:48128
    v_exp_f32 v74, v74
    v_exp_f32 v75, v75
    v_mfma_f32_32x32x16_bf16 v[84:99], v[156:159], v[12:15], v[84:99]
    v_cvt_pk_bf16_f32 v136, v68, v69
    v_cvt_pk_bf16_f32 v137, v70, v71
    v_cvt_pk_bf16_f32 v138, v72, v73
    v_cvt_pk_bf16_f32 v139, v74, v75
    v_exp_f32 v76, v76
    ds_read_b128 v[144:147], v2 offset:49152
    ds_read_b128 v[148:151], v2 offset:50176
    v_mfma_f32_32x32x16_bf16 v[116:131], v[160:163], v[136:139], v[116:131]
    v_exp_f32 v77, v77
    v_exp_f32 v78, v78
    v_exp_f32 v79, v79
    v_mfma_f32_16x16x32_bf16 v[188:191], v[32:35], v[184:187], v[188:191]
    s_and_b32 s47, s54, 512
    s_cmp_eq_u32 s47, 512
    s_cbranch_scc1 qa_kernel_FL9_E
    s_mov_b32 s62, 262144
    s_mov_b64 exec, 512
qa_kernel_FL9:
    buffer_load_dword v29, v28, s[36:39], s57 offen sc1
    s_waitcnt vmcnt(0)
    v_cmp_ne_u32_e64 vcc, 0, v29
    s_sub_u32 s62, s62, 1
    s_cbranch_scc1 qa_kernel_FL9_X
    s_cmp_eq_u32 vcc_lo, 512
    s_cbranch_scc0 qa_kernel_FL9
qa_kernel_FL9_X:
    s_mov_b64 exec, -1
qa_kernel_FL9_E:
    buffer_load_dwordx4 v[184:187], v31, s[68:71], s72 offen
    s_add_u32 s72, s72, 114688
    s_add_u32 m0, s61, 16384
    s_nop 0
    buffer_load_dwordx4 v26, s[36:39], s59 offen sc1 lds
    buffer_load_dwordx4 v26, s[36:39], s59 offen offset:1024 sc1 lds
    s_add_u32 s60, s60, 16384
    s_and_b32 s60, s60, 0x3ffff
    s_add_u32 s59, s58, s60
    v_exp_f32 v80, v80
    v_exp_f32 v81, v81
    v_exp_f32 v82, v82
    v_exp_f32 v83, v83
    v_cvt_pk_bf16_f32 v140, v76, v77
    v_cvt_pk_bf16_f32 v141, v78, v79
    v_cvt_pk_bf16_f32 v142, v80, v81
    v_cvt_pk_bf16_f32 v143, v82, v83
    s_nop 1
    v_mfma_f32_32x32x16_bf16 v[116:131], v[164:167], v[140:143], v[116:131]
    v_exp_f32 v84, v84
    v_exp_f32 v85, v85
    v_exp_f32 v86, v86
    s_waitcnt lgkmcnt(0)
    v_mfma_f32_32x32x16_bf16 v[68:83], v[144:147], v[8:11], v[100:115]
    v_exp_f32 v87, v87
    v_exp_f32 v88, v88
    v_exp_f32 v89, v89
    v_smfmac_f32_16x16x64_bf16 v[132:135], v[36:39], v[136:143], v197
    ds_read_b128 v[160:163], v2 offset:51200
    ds_read_b128 v[164:167], v2 offset:52224
    v_exp_f32 v90, v90
    v_exp_f32 v91, v91
    v_mfma_f32_32x32x16_bf16 v[68:83], v[148:151], v[12:15], v[68:83]
    v_cvt_pk_bf16_f32 v136, v84, v85
    v_cvt_pk_bf16_f32 v137, v86, v87
    v_cvt_pk_bf16_f32 v138, v88, v89
    v_cvt_pk_bf16_f32 v139, v90, v91
    v_exp_f32 v92, v92
    ds_read_b128 v[152:155], v2 offset:53248
    ds_read_b128 v[156:159], v2 offset:54272
    v_mfma_f32_32x32x16_bf16 v[116:131], v[168:171], v[136:139], v[116:131]
    v_exp_f32 v93, v93
    v_exp_f32 v94, v94
    v_exp_f32 v95, v95
    v_exp_f32 v96, v96
    v_exp_f32 v97, v97
    v_exp_f32 v98, v98
    v_exp_f32 v99, v99
    v_cvt_pk_bf16_f32 v140, v92, v93
    v_cvt_pk_bf16_f32 v141, v94, v95
    v_cvt_pk_bf16_f32 v142, v96, v97
    v_cvt_pk_bf16_f32 v143, v98, v99
    s_setprio 2
    s_nop 0
    v_mfma_f32_32x32x16_bf16 v[116:131], v[172:175], v[140:143], v[116:131]
    v_exp_f32 v68, v68
    v_exp_f32 v69, v69
    v_exp_f32 v70, v70
    s_waitcnt lgkmcnt(0)
    v_mfma_f32_32x32x16_bf16 v[84:99], v[152:155], v[8:11], v[100:115]
    v_exp_f32 v71, v71
    v_exp_f32 v72, v72
    v_exp_f32 v73, v73
    v_smfmac_f32_16x16x64_bf16 v[132:135], v[36:39], v[136:143], v197
    ds_read_b128 v[168:171], v2 offset:55296
    ds_read_b128 v[172:175], v2 offset:56320
    v_exp_f32 v74, v74
    v_exp_f32 v75, v75
    v_mfma_f32_32x32x16_bf16 v[84:99], v[156:159], v[12:15], v[84:99]
    v_cvt_pk_bf16_f32 v136, v68, v69
    v_cvt_pk_bf16_f32 v137, v70, v71
    v_cvt_pk_bf16_f32 v138, v72, v73
    v_cvt_pk_bf16_f32 v139, v74, v75
    v_exp_f32 v76, v76
    ds_read_b128 v[144:147], v2 offset:57344
    ds_read_b128 v[148:151], v2 offset:58368
    v_mfma_f32_32x32x16_bf16 v[116:131], v[160:163], v[136:139], v[116:131]
    v_exp_f32 v77, v77
    v_exp_f32 v78, v78
    v_exp_f32 v79, v79
qa_kernel_WS0_7:
    s_cbranch_execz qa_kernel_WRET0
    v_exp_f32 v80, v80
    v_exp_f32 v81, v81
    v_exp_f32 v82, v82
    v_exp_f32 v83, v83
    v_cvt_pk_bf16_f32 v140, v76, v77
    v_cvt_pk_bf16_f32 v141, v78, v79
    v_cvt_pk_bf16_f32 v142, v80, v81
    v_cvt_pk_bf16_f32 v143, v82, v83
    s_setprio 1
    s_nop 0
    v_mfma_f32_32x32x16_bf16 v[116:131], v[164:167], v[140:143], v[116:131]
    v_exp_f32 v84, v84
    v_exp_f32 v85, v85
    v_exp_f32 v86, v86
    s_waitcnt lgkmcnt(0)
    v_mfma_f32_32x32x16_bf16 v[68:83], v[144:147], v[8:11], v[100:115]
    v_exp_f32 v87, v87
    v_exp_f32 v88, v88
    v_exp_f32 v89, v89
    v_smfmac_f32_16x16x64_bf16 v[132:135], v[36:39], v[136:143], v197
    ds_read_b128 v[160:163], v2 offset:59392
    ds_read_b128 v[164:167], v2 offset:60416
    v_exp_f32 v90, v90
    v_exp_f32 v91, v91
    v_mfma_f32_32x32x16_bf16 v[68:83], v[148:151], v[12:15], v[68:83]
    v_cvt_pk_bf16_f32 v136, v84, v85
    v_cvt_pk_bf16_f32 v137, v86, v87
    v_cvt_pk_bf16_f32 v138, v88, v89
    v_cvt_pk_bf16_f32 v139, v90, v91
    v_exp_f32 v92, v92
    ds_read_b128 v[152:155], v2 offset:61440
    ds_read_b128 v[156:159], v2 offset:62464
    v_mfma_f32_32x32x16_bf16 v[116:131], v[168:171], v[136:139], v[116:131]
    v_exp_f32 v93, v93
    v_exp_f32 v94, v94
    v_exp_f32 v95, v95
    s_add_u32 s47, s49, 655360
    s_and_b32 s47, s47, 0x1fffff
    s_add_u32 m0, s51, 106496
    s_nop 0
    buffer_load_dwordx4 v53, s[32:35], s47 offen lds
    s_mov_b32 s47, 29360128
    buffer_store_dwordx4 v[192:195], v204, s[36:39], s47 offen sc1
    s_setprio 0
    v_exp_f32 v96, v96
    v_exp_f32 v97, v97
    v_exp_f32 v98, v98
    v_exp_f32 v99, v99
    v_cvt_pk_bf16_f32 v140, v92, v93
    v_cvt_pk_bf16_f32 v141, v94, v95
    v_cvt_pk_bf16_f32 v142, v96, v97
    v_cvt_pk_bf16_f32 v143, v98, v99
    s_waitcnt vmcnt(7)
    s_barrier
    s_setprio 3
    v_mfma_f32_32x32x16_bf16 v[116:131], v[172:175], v[140:143], v[116:131]
    v_exp_f32 v68, v68
    v_exp_f32 v69, v69
    v_exp_f32 v70, v70
    s_waitcnt lgkmcnt(0)
    v_mfma_f32_32x32x16_bf16 v[84:99], v[152:155], v[8:11], v[100:115]
    v_exp_f32 v71, v71
    v_exp_f32 v72, v72
    v_exp_f32 v73, v73
    v_smfmac_f32_16x16x64_bf16 v[132:135], v[36:39], v[136:143], v197
    ds_read_b128 v[168:171], v2 offset:63488
    ds_read_b128 v[172:175], v2 offset:64512
    v_exp_f32 v74, v74
    v_exp_f32 v75, v75
    v_mfma_f32_32x32x16_bf16 v[84:99], v[156:159], v[12:15], v[84:99]
    v_cvt_pk_bf16_f32 v136, v68, v69
    v_cvt_pk_bf16_f32 v137, v70, v71
    v_cvt_pk_bf16_f32 v138, v72, v73
    v_cvt_pk_bf16_f32 v139, v74, v75
    v_exp_f32 v76, v76
    ds_read_b128 v[144:147], v2 offset:0
    ds_read_b128 v[148:151], v2 offset:1024
    v_mfma_f32_32x32x16_bf16 v[116:131], v[160:163], v[136:139], v[116:131]
    v_exp_f32 v77, v77
    v_exp_f32 v78, v78
    v_exp_f32 v79, v79
    v_mfma_f32_16x16x32_bf16 v[188:191], v[32:35], v[180:183], v[188:191]
    s_and_b32 s47, s54, 1024
    s_cmp_eq_u32 s47, 1024
    s_cbranch_scc1 qa_kernel_FL10_E
    s_mov_b32 s62, 262144
    s_mov_b64 exec, 1024
qa_kernel_FL10:
    buffer_load_dword v29, v28, s[36:39], s57 offen sc1
    s_waitcnt vmcnt(0)
    v_cmp_ne_u32_e64 vcc, 0, v29
    s_sub_u32 s62, s62, 1
    s_cbranch_scc1 qa_kernel_FL10_X
    s_cmp_eq_u32 vcc_lo, 1024
    s_cbranch_scc0 qa_kernel_FL10
qa_kernel_FL10_X:
    s_mov_b64 exec, -1
qa_kernel_FL10_E:
    buffer_load_dwordx4 v[180:183], v31, s[68:71], s72 offen
    s_add_u32 s72, s72, 114688
    s_add_u32 m0, s61, 32768
    s_nop 0
    buffer_load_dwordx4 v26, s[36:39], s59 offen sc1 lds
    buffer_load_dwordx4 v26, s[36:39], s59 offen offset:1024 sc1 lds
    s_add_u32 s60, s60, 16384
    s_and_b32 s60, s60, 0x3ffff
    s_add_u32 s59, s58, s60
    v_exp_f32 v80, v80
    v_exp_f32 v81, v81
    v_exp_f32 v82, v82
    v_exp_f32 v83, v83
    v_cvt_pk_bf16_f32 v140, v76, v77
    v_cvt_pk_bf16_f32 v141, v78, v79
    v_cvt_pk_bf16_f32 v142, v80, v81
    v_cvt_pk_bf16_f32 v143, v82, v83
    s_nop 1
    v_mfma_f32_32x32x16_bf16 v[116:131], v[164:167], v[140:143], v[116:131]
    v_exp_f32 v84, v84
    v_exp_f32 v85, v85
    v_exp_f32 v86, v86
    s_waitcnt lgkmcnt(0)
    v_mfma_f32_32x32x16_bf16 v[68:83], v[144:147], v[8:11], v[100:115]
    v_exp_f32 v87, v87
    v_exp_f32 v88, v88
    v_exp_f32 v89, v89
    v_smfmac_f32_16x16x64_bf16 v[132:135], v[36:39], v[136:143], v197
    ds_read_b128 v[160:163], v2 offset:2048
    ds_read_b128 v[164:167], v2 offset:3072
    v_exp_f32 v90, v90
    v_exp_f32 v91, v91
    v_mfma_f32_32x32x16_bf16 v[68:83], v[148:151], v[12:15], v[68:83]
    v_cvt_pk_bf16_f32 v136, v84, v85
    v_cvt_pk_bf16_f32 v137, v86, v87
    v_cvt_pk_bf16_f32 v138, v88, v89
    v_cvt_pk_bf16_f32 v139, v90, v91
    v_exp_f32 v92, v92
    ds_read_b128 v[152:155], v2 offset:4096
    ds_read_b128 v[156:159], v2 offset:5120
    v_mfma_f32_32x32x16_bf16 v[116:131], v[168:171], v[136:139], v[116:131]
    v_exp_f32 v93, v93
    v_exp_f32 v94, v94
    v_exp_f32 v95, v95
    v_exp_f32 v96, v96
    v_exp_f32 v97, v97
    v_exp_f32 v98, v98
    v_exp_f32 v99, v99
    v_cvt_pk_bf16_f32 v140, v92, v93
    v_cvt_pk_bf16_f32 v141, v94, v95
    v_cvt_pk_bf16_f32 v142, v96, v97
    v_cvt_pk_bf16_f32 v143, v98, v99
    s_setprio 2
    s_nop 0
    v_mfma_f32_32x32x16_bf16 v[116:131], v[172:175], v[140:143], v[116:131]
    v_exp_f32 v68, v68
    v_exp_f32 v69, v69
    v_exp_f32 v70, v70
    s_waitcnt lgkmcnt(0)
    v_mfma_f32_32x32x16_bf16 v[84:99], v[152:155], v[8:11], v[100:115]
    v_exp_f32 v71, v71
    v_exp_f32 v72, v72
    v_exp_f32 v73, v73
    v_smfmac_f32_16x16x64_bf16 v[132:135], v[36:39], v[136:143], v197
    ds_read_b128 v[168:171], v2 offset:6144
    ds_read_b128 v[172:175], v2 offset:7168
    v_exp_f32 v74, v74
    v_exp_f32 v75, v75
    v_mfma_f32_32x32x16_bf16 v[84:99], v[156:159], v[12:15], v[84:99]
    v_cvt_pk_bf16_f32 v136, v68, v69
    v_cvt_pk_bf16_f32 v137, v70, v71
    v_cvt_pk_bf16_f32 v138, v72, v73
    v_cvt_pk_bf16_f32 v139, v74, v75
    v_exp_f32 v76, v76
    ds_read_b128 v[144:147], v2 offset:8192
    ds_read_b128 v[148:151], v2 offset:9216
    v_mfma_f32_32x32x16_bf16 v[116:131], v[160:163], v[136:139], v[116:131]
    v_exp_f32 v77, v77
    v_exp_f32 v78, v78
    v_exp_f32 v79, v79
    v_exp_f32 v80, v80
    v_exp_f32 v81, v81
    v_exp_f32 v82, v82
    v_exp_f32 v83, v83
    v_cvt_pk_bf16_f32 v140, v76, v77
    v_cvt_pk_bf16_f32 v141, v78, v79
    v_cvt_pk_bf16_f32 v142, v80, v81
    v_cvt_pk_bf16_f32 v143, v82, v83
    s_setprio 1
    s_nop 0
    v_mfma_f32_32x32x16_bf16 v[116:131], v[164:167], v[140:143], v[116:131]
    v_exp_f32 v84, v84
    v_exp_f32 v85, v85
    v_exp_f32 v86, v86
    s_waitcnt lgkmcnt(0)
    v_mfma_f32_32x32x16_bf16 v[68:83], v[144:147], v[8:11], v[100:115]
    v_exp_f32 v87, v87
    v_exp_f32 v88, v88
    v_exp_f32 v89, v89
    v_smfmac_f32_16x16x64_bf16 v[132:135], v[36:39], v[136:143], v197
    ds_read_b128 v[160:163], v2 offset:10240
    ds_read_b128 v[164:167], v2 offset:11264
    v_exp_f32 v90, v90
    v_exp_f32 v91, v91
    v_mfma_f32_32x32x16_bf16 v[68:83], v[148:151], v[12:15], v[68:83]
    v_cvt_pk_bf16_f32 v136, v84, v85
    v_cvt_pk_bf16_f32 v137, v86, v87
    v_cvt_pk_bf16_f32 v138, v88, v89
    v_cvt_pk_bf16_f32 v139, v90, v91
    v_exp_f32 v92, v92
    ds_read_b128 v[152:155], v2 offset:12288
    ds_read_b128 v[156:159], v2 offset:13312
    v_mfma_f32_32x32x16_bf16 v[116:131], v[168:171], v[136:139], v[116:131]
    v_exp_f32 v93, v93
    v_exp_f32 v94, v94
    v_exp_f32 v95, v95
    s_add_u32 s47, s49, 786432
    s_and_b32 s47, s47, 0x1fffff
    s_add_u32 m0, s51, 114688
    s_nop 0
    buffer_load_dwordx4 v53, s[32:35], s47 offen lds
    s_mov_b32 s47, 29374464
    buffer_store_dwordx4 v[192:195], v204, s[36:39], s47 offen sc1
    s_setprio 0
    v_exp_f32 v96, v96
    v_exp_f32 v97, v97
    v_exp_f32 v98, v98
    v_exp_f32 v99, v99
    v_cvt_pk_bf16_f32 v140, v92, v93
    v_cvt_pk_bf16_f32 v141, v94, v95
    v_cvt_pk_bf16_f32 v142, v96, v97
    v_cvt_pk_bf16_f32 v143, v98, v99
    s_waitcnt vmcnt(7)
    s_barrier
    s_setprio 3
    v_mfma_f32_32x32x16_bf16 v[116:131], v[172:175], v[140:143], v[116:131]
    v_exp_f32 v68, v68
    v_exp_f32 v69, v69
    v_exp_f32 v70, v70
    s_waitcnt lgkmcnt(0)
    v_mfma_f32_32x32x16_bf16 v[84:99], v[152:155], v[8:11], v[100:115]
    v_exp_f32 v71, v71
    v_exp_f32 v72, v72
    v_exp_f32 v73, v73
    v_smfmac_f32_16x16x64_bf16 v[132:135], v[36:39], v[136:143], v197
    ds_read_b128 v[168:171], v2 offset:14336
    ds_read_b128 v[172:175], v2 offset:15360
    v_exp_f32 v74, v74
    v_exp_f32 v75, v75
    v_mfma_f32_32x32x16_bf16 v[84:99], v[156:159], v[12:15], v[84:99]
    v_cvt_pk_bf16_f32 v136, v68, v69
    v_cvt_pk_bf16_f32 v137, v70, v71
    v_cvt_pk_bf16_f32 v138, v72, v73
    v_cvt_pk_bf16_f32 v139, v74, v75
    v_exp_f32 v76, v76
    ds_read_b128 v[144:147], v2 offset:16384
    ds_read_b128 v[148:151], v2 offset:17408
    v_mfma_f32_32x32x16_bf16 v[116:131], v[160:163], v[136:139], v[116:131]
    v_exp_f32 v77, v77
    v_exp_f32 v78, v78
    v_exp_f32 v79, v79
    v_mfma_f32_16x16x32_bf16 v[188:191], v[32:35], v[184:187], v[188:191]
    s_and_b32 s47, s54, 2048
    s_cmp_eq_u32 s47, 2048
    s_cbranch_scc1 qa_kernel_FL11_E
    s_mov_b32 s62, 262144
    s_mov_b64 exec, 2048
qa_kernel_FL11:
    buffer_load_dword v29, v28, s[36:39], s57 offen sc1
    s_waitcnt vmcnt(0)
    v_cmp_ne_u32_e64 vcc, 0, v29
    s_sub_u32 s62, s62, 1
    s_cbranch_scc1 qa_kernel_FL11_X
    s_cmp_eq_u32 vcc_lo, 2048
    s_cbranch_scc0 qa_kernel_FL11
qa_kernel_FL11_X:
    s_mov_b64 exec, -1
qa_kernel_FL11_E:
    buffer_load_dwordx4 v[184:187], v31, s[68:71], s72 offen
    s_add_u32 s72, s72, 114688
    s_add_u32 m0, s61, 49152
    s_nop 0
    buffer_load_dwordx4 v26, s[36:39], s59 offen sc1 lds
    buffer_load_dwordx4 v26, s[36:39], s59 offen offset:1024 sc1 lds
    s_add_u32 s60, s60, 16384
    s_and_b32 s60, s60, 0x3ffff
    s_add_u32 s59, s58, s60
    v_exp_f32 v80, v80
    v_exp_f32 v81, v81
    v_exp_f32 v82, v82
    v_exp_f32 v83, v83
    v_cvt_pk_bf16_f32 v140, v76, v77
    v_cvt_pk_bf16_f32 v141, v78, v79
    v_cvt_pk_bf16_f32 v142, v80, v81
    v_cvt_pk_bf16_f32 v143, v82, v83
    s_nop 1
    v_mfma_f32_32x32x16_bf16 v[116:131], v[164:167], v[140:143], v[116:131]
    v_exp_f32 v84, v84
    v_exp_f32 v85, v85
    v_exp_f32 v86, v86
    s_waitcnt lgkmcnt(0)
    v_mfma_f32_32x32x16_bf16 v[68:83], v[144:147], v[8:11], v[100:115]
    v_exp_f32 v87, v87
    v_exp_f32 v88, v88
    v_exp_f32 v89, v89
    v_smfmac_f32_16x16x64_bf16 v[132:135], v[36:39], v[136:143], v197
    ds_read_b128 v[160:163], v2 offset:18432
    ds_read_b128 v[164:167], v2 offset:19456
    v_exp_f32 v90, v90
    v_exp_f32 v91, v91
    v_mfma_f32_32x32x16_bf16 v[68:83], v[148:151], v[12:15], v[68:83]
    v_cvt_pk_bf16_f32 v136, v84, v85
    v_cvt_pk_bf16_f32 v137, v86, v87
    v_cvt_pk_bf16_f32 v138, v88, v89
    v_cvt_pk_bf16_f32 v139, v90, v91
    v_exp_f32 v92, v92
    ds_read_b128 v[152:155], v2 offset:20480
    ds_read_b128 v[156:159], v2 offset:21504
    v_mfma_f32_32x32x16_bf16 v[116:131], v[168:171], v[136:139], v[116:131]
    v_exp_f32 v93, v93
    v_exp_f32 v94, v94
    v_exp_f32 v95, v95
    v_exp_f32 v96, v96
    v_exp_f32 v97, v97
    v_exp_f32 v98, v98
    v_exp_f32 v99, v99
    v_cvt_pk_bf16_f32 v140, v92, v93
    v_cvt_pk_bf16_f32 v141, v94, v95
    v_cvt_pk_bf16_f32 v142, v96, v97
    v_cvt_pk_bf16_f32 v143, v98, v99
    s_setprio 2
    s_nop 0
    v_mfma_f32_32x32x16_bf16 v[116:131], v[172:175], v[140:143], v[116:131]
    v_exp_f32 v68, v68
    v_exp_f32 v69, v69
    v_exp_f32 v70, v70
    s_waitcnt lgkmcnt(0)
    v_mfma_f32_32x32x16_bf16 v[84:99], v[152:155], v[8:11], v[100:115]
    v_exp_f32 v71, v71
    v_exp_f32 v72, v72
    v_exp_f32 v73, v73
    v_smfmac_f32_16x16x64_bf16 v[132:135], v[36:39], v[136:143], v197
    ds_read_b128 v[168:171], v2 offset:22528
    ds_read_b128 v[172:175], v2 offset:23552
    v_exp_f32 v74, v74
    v_exp_f32 v75, v75
    v_mfma_f32_32x32x16_bf16 v[84:99], v[156:159], v[12:15], v[84:99]
    v_cvt_pk_bf16_f32 v136, v68, v69
    v_cvt_pk_bf16_f32 v137, v70, v71
    v_cvt_pk_bf16_f32 v138, v72, v73
    v_cvt_pk_bf16_f32 v139, v74, v75
    v_exp_f32 v76, v76
    ds_read_b128 v[144:147], v2 offset:24576
    ds_read_b128 v[148:151], v2 offset:25600
    v_mfma_f32_32x32x16_bf16 v[116:131], v[160:163], v[136:139], v[116:131]
    v_exp_f32 v77, v77
    v_exp_f32 v78, v78
    v_exp_f32 v79, v79
    v_exp_f32 v80, v80
    v_exp_f32 v81, v81
    v_exp_f32 v82, v82
    v_exp_f32 v83, v83
    v_cvt_pk_bf16_f32 v140, v76, v77
    v_cvt_pk_bf16_f32 v141, v78, v79
    v_cvt_pk_bf16_f32 v142, v80, v81
    v_cvt_pk_bf16_f32 v143, v82, v83
    s_setprio 1
    s_nop 0
    v_mfma_f32_32x32x16_bf16 v[116:131], v[164:167], v[140:143], v[116:131]
    v_exp_f32 v84, v84
    v_exp_f32 v85, v85
    v_exp_f32 v86, v86
    s_waitcnt lgkmcnt(0)
    v_mfma_f32_32x32x16_bf16 v[68:83], v[144:147], v[8:11], v[100:115]
    v_exp_f32 v87, v87
    v_exp_f32 v88, v88
    v_exp_f32 v89, v89
    v_smfmac_f32_16x16x64_bf16 v[132:135], v[36:39], v[136:143], v197
    ds_read_b128 v[160:163], v2 offset:26624
    ds_read_b128 v[164:167], v2 offset:27648
    v_exp_f32 v90, v90
    v_exp_f32 v91, v91
    v_mfma_f32_32x32x16_bf16 v[68:83], v[148:151], v[12:15], v[68:83]
    v_cvt_pk_bf16_f32 v136, v84, v85
    v_cvt_pk_bf16_f32 v137, v86, v87
    v_cvt_pk_bf16_f32 v138, v88, v89
    v_cvt_pk_bf16_f32 v139, v90, v91
    v_exp_f32 v92, v92
    ds_read_b128 v[152:155], v2 offset:28672
    ds_read_b128 v[156:159], v2 offset:29696
    v_mfma_f32_32x32x16_bf16 v[116:131], v[168:171], v[136:139], v[116:131]
    v_exp_f32 v93, v93
    v_exp_f32 v94, v94
    v_exp_f32 v95, v95
    s_add_u32 s47, s49, 917504
    s_and_b32 s47, s47, 0x1fffff
    s_add_u32 m0, s51, 122880
    s_nop 0
    buffer_load_dwordx4 v53, s[32:35], s47 offen lds
    s_setprio 0
    v_exp_f32 v96, v96
    v_exp_f32 v97, v97
    v_exp_f32 v98, v98
    v_exp_f32 v99, v99
    v_cvt_pk_bf16_f32 v140, v92, v93
    v_cvt_pk_bf16_f32 v141, v94, v95
    v_cvt_pk_bf16_f32 v142, v96, v97
    v_cvt_pk_bf16_f32 v143, v98, v99
    s_waitcnt vmcnt(4)
    s_barrier
    s_setprio 3
    v_mfma_f32_32x32x16_bf16 v[116:131], v[172:175], v[140:143], v[116:131]
    v_exp_f32 v68, v68
    v_exp_f32 v69, v69
    v_exp_f32 v70, v70
    s_waitcnt lgkmcnt(0)
    v_mfma_f32_32x32x16_bf16 v[84:99], v[152:155], v[8:11], v[100:115]
    v_exp_f32 v71, v71
    v_exp_f32 v72, v72
    v_exp_f32 v73, v73
    v_smfmac_f32_16x16x64_bf16 v[132:135], v[36:39], v[136:143], v197
    ds_read_b128 v[168:171], v2 offset:30720
    ds_read_b128 v[172:175], v2 offset:31744
    v_exp_f32 v74, v74
    v_exp_f32 v75, v75
    v_mfma_f32_32x32x16_bf16 v[84:99], v[156:159], v[12:15], v[84:99]
    v_cvt_pk_bf16_f32 v136, v68, v69
    v_cvt_pk_bf16_f32 v137, v70, v71
    v_cvt_pk_bf16_f32 v138, v72, v73
    v_cvt_pk_bf16_f32 v139, v74, v75
    v_exp_f32 v76, v76
    ds_read_b128 v[144:147], v2 offset:32768
    ds_read_b128 v[148:151], v2 offset:33792
    v_mfma_f32_32x32x16_bf16 v[116:131], v[160:163], v[136:139], v[116:131]
    v_exp_f32 v77, v77
    v_exp_f32 v78, v78
    v_exp_f32 v79, v79
    v_mfma_f32_16x16x32_bf16 v[188:191], v[32:35], v[180:183], v[188:191]
    s_and_b32 s47, s54, 4096
    s_cmp_eq_u32 s47, 4096
    s_cbranch_scc1 qa_kernel_FL12_E
    s_mov_b32 s62, 262144
    s_mov_b64 exec, 4096
qa_kernel_FL12:
    buffer_load_dword v29, v28, s[36:39], s57 offen sc1
    s_waitcnt vmcnt(0)
    v_cmp_ne_u32_e64 vcc, 0, v29
    s_sub_u32 s62, s62, 1
    s_cbranch_scc1 qa_kernel_FL12_X
    s_cmp_eq_u32 vcc_lo, 4096
    s_cbranch_scc0 qa_kernel_FL12
qa_kernel_FL12_X:
    s_mov_b64 exec, -1
qa_kernel_FL12_E:
    s_mov_b32 s64, 0
    buffer_load_dwordx4 v[176:179], v30, s[28:31], s64 offen
    s_add_u32 m0, s61, 0
    s_nop 0
    buffer_load_dwordx4 v26, s[36:39], s59 offen sc1 lds
    buffer_load_dwordx4 v26, s[36:39], s59 offen offset:1024 sc1 lds
    s_add_u32 s60, s60, 16384
    s_and_b32 s60, s60, 0x3ffff
    s_add_u32 s59, s58, s60
    s_cmp_lg_u32 s24, 0
    s_cbranch_scc1 qa_kernel_SG2
    s_mov_b64 exec, 1
    buffer_atomic_add v200, v199, s[40:43], 0 offen offset:4
    s_mov_b64 exec, -1
qa_kernel_SG2:
    v_exp_f32 v80, v80
    v_exp_f32 v81, v81
    v_exp_f32 v82, v82
    v_exp_f32 v83, v83
    v_cvt_pk_bf16_f32 v140, v76, v77
    v_cvt_pk_bf16_f32 v141, v78, v79
    v_cvt_pk_bf16_f32 v142, v80, v81
    v_cvt_pk_bf16_f32 v143, v82, v83
    s_nop 1
    v_mfma_f32_32x32x16_bf16 v[116:131], v[164:167], v[140:143], v[116:131]
    v_exp_f32 v84, v84
    v_exp_f32 v85, v85
    v_exp_f32 v86, v86
    s_waitcnt lgkmcnt(0)
    v_mfma_f32_32x32x16_bf16 v[68:83], v[144:147], v[8:11], v[100:115]
    v_exp_f32 v87, v87
    v_exp_f32 v88, v88
    v_exp_f32 v89, v89
    v_smfmac_f32_16x16x64_bf16 v[132:135], v[36:39], v[136:143], v197
    ds_read_b128 v[160:163], v2 offset:34816
    ds_read_b128 v[164:167], v2 offset:35840
    v_exp_f32 v90, v90
    v_exp_f32 v91, v91
    v_mfma_f32_32x32x16_bf16 v[68:83], v[148:151], v[12:15], v[68:83]
    v_cvt_pk_bf16_f32 v136, v84, v85
    v_cvt_pk_bf16_f32 v137, v86, v87
    v_cvt_pk_bf16_f32 v138, v88, v89
    v_cvt_pk_bf16_f32 v139, v90, v91
    v_exp_f32 v92, v92
    ds_read_b128 v[152:155], v2 offset:36864
    ds_read_b128 v[156:159], v2 offset:37888
    v_mfma_f32_32x32x16_bf16 v[116:131], v[168:171], v[136:139], v[116:131]
    v_exp_f32 v93, v93
    v_exp_f32 v94, v94
    v_exp_f32 v95, v95
    v_exp_f32 v96, v96
    v_exp_f32 v97, v97
    v_exp_f32 v98, v98
    v_exp_f32 v99, v99
    v_cvt_pk_bf16_f32 v140, v92, v93
    v_cvt_pk_bf16_f32 v141, v94, v95
    v_cvt_pk_bf16_f32 v142, v96, v97
    v_cvt_pk_bf16_f32 v143, v98, v99
    s_setprio 2
    s_nop 0
    v_mfma_f32_32x32x16_bf16 v[116:131], v[172:175], v[140:143], v[116:131]
    v_exp_f32 v68, v68
    v_exp_f32 v69, v69
    v_exp_f32 v70, v70
    s_waitcnt lgkmcnt(0)
    v_mfma_f32_32x32x16_bf16 v[84:99], v[152:155], v[8:11], v[100:115]
    v_exp_f32 v71, v71
    v_exp_f32 v72, v72
    v_exp_f32 v73, v73
    v_smfmac_f32_16x16x64_bf16 v[132:135], v[36:39], v[136:143], v197
    ds_read_b128 v[168:171], v2 offset:38912
    ds_read_b128 v[172:175], v2 offset:39936
    v_exp_f32 v74, v74
    v_exp_f32 v75, v75
    v_mfma_f32_32x32x16_bf16 v[84:99], v[156:159], v[12:15], v[84:99]
    v_cvt_pk_bf16_f32 v136, v68, v69
    v_cvt_pk_bf16_f32 v137, v70, v71
    v_cvt_pk_bf16_f32 v138, v72, v73
    v_cvt_pk_bf16_f32 v139, v74, v75
    v_exp_f32 v76, v76
    ds_read_b128 v[144:147], v2 offset:40960
    ds_read_b128 v[148:151], v2 offset:41984
    v_mfma_f32_32x32x16_bf16 v[116:131], v[160:163], v[136:139], v[116:131]
    v_exp_f32 v77, v77
    v_exp_f32 v78, v78
    v_exp_f32 v79, v79
    v_exp_f32 v80, v80
    v_exp_f32 v81, v81
    v_exp_f32 v82, v82
    v_exp_f32 v83, v83
    v_cvt_pk_bf16_f32 v140, v76, v77
    v_cvt_pk_bf16_f32 v141, v78, v79
    v_cvt_pk_bf16_f32 v142, v80, v81
    v_cvt_pk_bf16_f32 v143, v82, v83
    s_setprio 1
    s_nop 0
    v_mfma_f32_32x32x16_bf16 v[116:131], v[164:167], v[140:143], v[116:131]
    v_exp_f32 v84, v84
    v_exp_f32 v85, v85
    v_exp_f32 v86, v86
    s_waitcnt lgkmcnt(0)
    v_mfma_f32_32x32x16_bf16 v[68:83], v[144:147], v[8:11], v[100:115]
    v_exp_f32 v87, v87
    v_exp_f32 v88, v88
    v_exp_f32 v89, v89
    v_smfmac_f32_16x16x64_bf16 v[132:135], v[36:39], v[136:143], v197
    ds_read_b128 v[160:163], v2 offset:43008
    ds_read_b128 v[164:167], v2 offset:44032
    v_exp_f32 v90, v90
    v_exp_f32 v91, v91
    v_mfma_f32_32x32x16_bf16 v[68:83], v[148:151], v[12:15], v[68:83]
    v_cvt_pk_bf16_f32 v136, v84, v85
    v_cvt_pk_bf16_f32 v137, v86, v87
    v_cvt_pk_bf16_f32 v138, v88, v89
    v_cvt_pk_bf16_f32 v139, v90, v91
    v_exp_f32 v92, v92
    ds_read_b128 v[152:155], v2 offset:45056
    ds_read_b128 v[156:159], v2 offset:46080
    v_mfma_f32_32x32x16_bf16 v[116:131], v[168:171], v[136:139], v[116:131]
    v_exp_f32 v93, v93
    v_exp_f32 v94, v94
    v_exp_f32 v95, v95
    s_add_u32 s47, s49, 1048576
    s_and_b32 s47, s47, 0x1fffff
    s_add_u32 m0, s51, 131072
    s_nop 0
    buffer_load_dwordx4 v53, s[32:35], s47 offen lds
    s_setprio 0
    v_exp_f32 v96, v96
    v_exp_f32 v97, v97
    v_exp_f32 v98, v98
    v_exp_f32 v99, v99
    v_cvt_pk_bf16_f32 v140, v92, v93
    v_cvt_pk_bf16_f32 v141, v94, v95
    v_cvt_pk_bf16_f32 v142, v96, v97
    v_cvt_pk_bf16_f32 v143, v98, v99
    s_waitcnt vmcnt(5)
    s_barrier
    s_setprio 3
    v_mfma_f32_32x32x16_bf16 v[116:131], v[172:175], v[140:143], v[116:131]
    v_exp_f32 v68, v68
    v_exp_f32 v69, v69
    v_exp_f32 v70, v70
    s_waitcnt lgkmcnt(0)
    v_mfma_f32_32x32x16_bf16 v[84:99], v[152:155], v[8:11], v[100:115]
    v_exp_f32 v71, v71
    v_exp_f32 v72, v72
    v_exp_f32 v73, v73
    v_smfmac_f32_16x16x64_bf16 v[132:135], v[36:39], v[136:143], v197
    ds_read_b128 v[168:171], v2 offset:47104
    ds_read_b128 v[172:175], v2 offset:48128
    v_exp_f32 v74, v74
    v_exp_f32 v75, v75
    v_mfma_f32_32x32x16_bf16 v[84:99], v[156:159], v[12:15], v[84:99]
    v_cvt_pk_bf16_f32 v136, v68, v69
    v_cvt_pk_bf16_f32 v137, v70, v71
    v_cvt_pk_bf16_f32 v138, v72, v73
    v_cvt_pk_bf16_f32 v139, v74, v75
    v_exp_f32 v76, v76
    ds_read_b128 v[144:147], v2 offset:49152
    ds_read_b128 v[148:151], v2 offset:50176
    v_mfma_f32_32x32x16_bf16 v[116:131], v[160:163], v[136:139], v[116:131]
    v_exp_f32 v77, v77
    v_exp_f32 v78, v78
    v_exp_f32 v79, v79
    v_mfma_f32_16x16x32_bf16 v[188:191], v[32:35], v[184:187], v[188:191]
    s_and_b32 s47, s54, 8192
    s_cmp_eq_u32 s47, 8192
    s_cbranch_scc1 qa_kernel_FL13_E
    s_mov_b32 s62, 262144
    s_mov_b64 exec, 8192
qa_kernel_FL13:
    buffer_load_dword v29, v28, s[36:39], s57 offen sc1
    s_waitcnt vmcnt(0)
    v_cmp_ne_u32_e64 vcc, 0, v29
    s_sub_u32 s62, s62, 1
    s_cbranch_scc1 qa_kernel_FL13_X
    s_cmp_eq_u32 vcc_lo, 8192
    s_cbranch_scc0 qa_kernel_FL13
qa_kernel_FL13_X:
    s_mov_b64 exec, -1
qa_kernel_FL13_E:
    s_mov_b32 s64, 2097152
    buffer_load_dwordx4 v[176:179], v30, s[28:31], s64 offen
    s_add_u32 m0, s61, 16384
    s_nop 0
    buffer_load_dwordx4 v26, s[36:39], s59 offen sc1 lds
    buffer_load_dwordx4 v26, s[36:39], s59 offen offset:1024 sc1 lds
    s_add_u32 s60, s60, 16384
    s_and_b32 s60, s60, 0x3ffff
    s_add_u32 s59, s58, s60
    v_exp_f32 v80, v80
    v_exp_f32 v81, v81
    v_exp_f32 v82, v82
    v_exp_f32 v83, v83
    v_cvt_pk_bf16_f32 v140, v76, v77
    v_cvt_pk_bf16_f32 v141, v78, v79
    v_cvt_pk_bf16_f32 v142, v80, v81
    v_cvt_pk_bf16_f32 v143, v82, v83
    s_nop 1
    v_mfma_f32_32x32x16_bf16 v[116:131], v[164:167], v[140:143], v[116:131]
    v_exp_f32 v84, v84
    v_exp_f32 v85, v85
    v_exp_f32 v86, v86
    s_waitcnt lgkmcnt(0)
    v_mfma_f32_32x32x16_bf16 v[68:83], v[144:147], v[8:11], v[100:115]
    v_exp_f32 v87, v87
    v_exp_f32 v88, v88
    v_exp_f32 v89, v89
    v_smfmac_f32_16x16x64_bf16 v[132:135], v[36:39], v[136:143], v197
    ds_read_b128 v[160:163], v2 offset:51200
    ds_read_b128 v[164:167], v2 offset:52224
    v_exp_f32 v90, v90
    v_exp_f32 v91, v91
    v_mfma_f32_32x32x16_bf16 v[68:83], v[148:151], v[12:15], v[68:83]
    v_cvt_pk_bf16_f32 v136, v84, v85
    v_cvt_pk_bf16_f32 v137, v86, v87
    v_cvt_pk_bf16_f32 v138, v88, v89
    v_cvt_pk_bf16_f32 v139, v90, v91
    v_exp_f32 v92, v92
    ds_read_b128 v[152:155], v2 offset:53248
    ds_read_b128 v[156:159], v2 offset:54272
    v_mfma_f32_32x32x16_bf16 v[116:131], v[168:171], v[136:139], v[116:131]
    v_exp_f32 v93, v93
    v_exp_f32 v94, v94
    v_exp_f32 v95, v95
    v_exp_f32 v96, v96
    v_exp_f32 v97, v97
    v_exp_f32 v98, v98
    v_exp_f32 v99, v99
    v_cvt_pk_bf16_f32 v140, v92, v93
    v_cvt_pk_bf16_f32 v141, v94, v95
    v_cvt_pk_bf16_f32 v142, v96, v97
    v_cvt_pk_bf16_f32 v143, v98, v99
    s_setprio 2
    s_nop 0
    v_mfma_f32_32x32x16_bf16 v[116:131], v[172:175], v[140:143], v[116:131]
    v_exp_f32 v68, v68
    v_exp_f32 v69, v69
    v_exp_f32 v70, v70
    s_waitcnt lgkmcnt(0)
    v_mfma_f32_32x32x16_bf16 v[84:99], v[152:155], v[8:11], v[100:115]
    v_exp_f32 v71, v71
    v_exp_f32 v72, v72
qa_kernel_WS0_8:
    s_cbranch_execz qa_kernel_WRET0
    v_exp_f32 v73, v73
    v_smfmac_f32_16x16x64_bf16 v[132:135], v[36:39], v[136:143], v197
    ds_read_b128 v[168:171], v2 offset:55296
    ds_read_b128 v[172:175], v2 offset:56320
    v_exp_f32 v74, v74
    v_exp_f32 v75, v75
    v_mfma_f32_32x32x16_bf16 v[84:99], v[156:159], v[12:15], v[84:99]
    v_cvt_pk_bf16_f32 v136, v68, v69
    v_cvt_pk_bf16_f32 v137, v70, v71
    v_cvt_pk_bf16_f32 v138, v72, v73
    v_cvt_pk_bf16_f32 v139, v74, v75
    v_exp_f32 v76, v76
    ds_read_b128 v[144:147], v2 offset:57344
    ds_read_b128 v[148:151], v2 offset:58368
    v_mfma_f32_32x32x16_bf16 v[116:131], v[160:163], v[136:139], v[116:131]
    v_exp_f32 v77, v77
    v_exp_f32 v78, v78
    v_exp_f32 v79, v79
    v_exp_f32 v80, v80
    v_exp_f32 v81, v81
    v_exp_f32 v82, v82
    v_exp_f32 v83, v83
    v_cvt_pk_bf16_f32 v140, v76, v77
    v_cvt_pk_bf16_f32 v141, v78, v79
    v_cvt_pk_bf16_f32 v142, v80, v81
    v_cvt_pk_bf16_f32 v143, v82, v83
    s_setprio 1
    s_nop 0
    v_mfma_f32_32x32x16_bf16 v[116:131], v[164:167], v[140:143], v[116:131]
    v_exp_f32 v84, v84
    v_exp_f32 v85, v85
    v_exp_f32 v86, v86
    s_waitcnt lgkmcnt(0)
    v_mfma_f32_32x32x16_bf16 v[68:83], v[144:147], v[8:11], v[100:115]
    v_exp_f32 v87, v87
    v_exp_f32 v88, v88
    v_exp_f32 v89, v89
    v_smfmac_f32_16x16x64_bf16 v[132:135], v[36:39], v[136:143], v197
    ds_read_b128 v[160:163], v2 offset:59392
    ds_read_b128 v[164:167], v2 offset:60416
    v_exp_f32 v90, v90
    v_exp_f32 v91, v91
    v_mfma_f32_32x32x16_bf16 v[68:83], v[148:151], v[12:15], v[68:83]
    v_cvt_pk_bf16_f32 v136, v84, v85
    v_cvt_pk_bf16_f32 v137, v86, v87
    v_cvt_pk_bf16_f32 v138, v88, v89
    v_cvt_pk_bf16_f32 v139, v90, v91
    v_exp_f32 v92, v92
    ds_read_b128 v[152:155], v2 offset:61440
    ds_read_b128 v[156:159], v2 offset:62464
    v_mfma_f32_32x32x16_bf16 v[116:131], v[168:171], v[136:139], v[116:131]
    v_exp_f32 v93, v93
    v_exp_f32 v94, v94
    v_exp_f32 v95, v95
    s_add_u32 s47, s49, 1179648
    s_and_b32 s47, s47, 0x1fffff
    s_add_u32 m0, s51, 139264
    s_nop 0
    buffer_load_dwordx4 v53, s[32:35], s47 offen lds
    s_setprio 0
    v_exp_f32 v96, v96
    v_exp_f32 v97, v97
    v_exp_f32 v98, v98
    v_exp_f32 v99, v99
    v_cvt_pk_bf16_f32 v140, v92, v93
    v_cvt_pk_bf16_f32 v141, v94, v95
    v_cvt_pk_bf16_f32 v142, v96, v97
    v_cvt_pk_bf16_f32 v143, v98, v99
    s_waitcnt vmcnt(5)
    s_barrier
    s_setprio 3
    v_mfma_f32_32x32x16_bf16 v[116:131], v[172:175], v[140:143], v[116:131]
    v_exp_f32 v68, v68
    v_exp_f32 v69, v69
    v_exp_f32 v70, v70
    s_waitcnt lgkmcnt(0)
    v_mfma_f32_32x32x16_bf16 v[84:99], v[152:155], v[8:11], v[100:115]
    v_exp_f32 v71, v71
    v_exp_f32 v72, v72
    v_exp_f32 v73, v73
    v_smfmac_f32_16x16x64_bf16 v[132:135], v[36:39], v[136:143], v197
    ds_read_b128 v[168:171], v2 offset:63488
    ds_read_b128 v[172:175], v2 offset:64512
    v_exp_f32 v74, v74
    v_exp_f32 v75, v75
    v_mfma_f32_32x32x16_bf16 v[84:99], v[156:159], v[12:15], v[84:99]
    v_cvt_pk_bf16_f32 v136, v68, v69
    v_cvt_pk_bf16_f32 v137, v70, v71
    v_cvt_pk_bf16_f32 v138, v72, v73
    v_cvt_pk_bf16_f32 v139, v74, v75
    v_exp_f32 v76, v76
    ds_read_b128 v[144:147], v2 offset:0
    ds_read_b128 v[148:151], v2 offset:1024
    v_mfma_f32_32x32x16_bf16 v[116:131], v[160:163], v[136:139], v[116:131]
    v_exp_f32 v77, v77
    v_exp_f32 v78, v78
    v_exp_f32 v79, v79
    v_add_f32_dpp v188, v188, v188 row_ror:4 row_mask:0xf bank_mask:0xf
    v_add_f32_dpp v189, v189, v189 row_ror:4 row_mask:0xf bank_mask:0xf
    v_add_f32_dpp v190, v190, v190 row_ror:4 row_mask:0xf bank_mask:0xf
    v_add_f32_dpp v191, v191, v191 row_ror:4 row_mask:0xf bank_mask:0xf
    v_add_f32_dpp v188, v188, v188 row_ror:8 row_mask:0xf bank_mask:0xf
    v_add_f32_dpp v189, v189, v189 row_ror:8 row_mask:0xf bank_mask:0xf
    v_add_f32_dpp v190, v190, v190 row_ror:8 row_mask:0xf bank_mask:0xf
    v_add_f32_dpp v191, v191, v191 row_ror:8 row_mask:0xf bank_mask:0xf
    ds_write_b128 v40, v[188:191]
    s_and_b32 s47, s54, 16384
    s_cmp_eq_u32 s47, 16384
    s_cbranch_scc1 qa_kernel_FL14_E
    s_mov_b32 s62, 262144
    s_mov_b64 exec, 16384
qa_kernel_FL14:
    buffer_load_dword v29, v28, s[36:39], s57 offen sc1
    s_waitcnt vmcnt(0)
    v_cmp_ne_u32_e64 vcc, 0, v29
    s_sub_u32 s62, s62, 1
    s_cbranch_scc1 qa_kernel_FL14_X
    s_cmp_eq_u32 vcc_lo, 16384
    s_cbranch_scc0 qa_kernel_FL14
qa_kernel_FL14_X:
    s_mov_b64 exec, -1
qa_kernel_FL14_E:
    s_mov_b32 s64, 4194304
    buffer_load_dwordx4 v[176:179], v30, s[28:31], s64 offen
    s_add_u32 m0, s61, 32768
    s_nop 0
    buffer_load_dwordx4 v26, s[36:39], s59 offen sc1 lds
    buffer_load_dwordx4 v26, s[36:39], s59 offen offset:1024 sc1 lds
    s_add_u32 s60, s60, 16384
    s_and_b32 s60, s60, 0x3ffff
    s_add_u32 s59, s58, s60
    s_mov_b64 exec, s[76:77]
    buffer_load_dword v201, v198, s[40:43], 0 offen offset:4 sc1
    s_mov_b64 exec, -1
    v_exp_f32 v80, v80
    v_exp_f32 v81, v81
    v_exp_f32 v82, v82
    v_exp_f32 v83, v83
    v_cvt_pk_bf16_f32 v140, v76, v77
    v_cvt_pk_bf16_f32 v141, v78, v79
    v_cvt_pk_bf16_f32 v142, v80, v81
    v_cvt_pk_bf16_f32 v143, v82, v83
    s_nop 1
    v_mfma_f32_32x32x16_bf16 v[116:131], v[164:167], v[140:143], v[116:131]
    v_exp_f32 v84, v84
    v_exp_f32 v85, v85
    v_exp_f32 v86, v86
    s_waitcnt lgkmcnt(1)
    v_mfma_f32_32x32x16_bf16 v[68:83], v[144:147], v[8:11], v[100:115]
    v_exp_f32 v87, v87
    v_exp_f32 v88, v88
    v_exp_f32 v89, v89
    v_smfmac_f32_16x16x64_bf16 v[132:135], v[36:39], v[136:143], v197
    ds_read_b128 v[160:163], v2 offset:2048
    ds_read_b128 v[164:167], v2 offset:3072
    v_exp_f32 v90, v90
    v_exp_f32 v91, v91
    v_mfma_f32_32x32x16_bf16 v[68:83], v[148:151], v[12:15], v[68:83]
    v_cvt_pk_bf16_f32 v136, v84, v85
    v_cvt_pk_bf16_f32 v137, v86, v87
    v_cvt_pk_bf16_f32 v138, v88, v89
    v_cvt_pk_bf16_f32 v139, v90, v91
    v_exp_f32 v92, v92
    ds_read_b128 v[152:155], v2 offset:4096
    ds_read_b128 v[156:159], v2 offset:5120
    v_mfma_f32_32x32x16_bf16 v[116:131], v[168:171], v[136:139], v[116:131]
    v_exp_f32 v93, v93
    v_exp_f32 v94, v94
    v_exp_f32 v95, v95
    v_exp_f32 v96, v96
    v_exp_f32 v97, v97
    v_exp_f32 v98, v98
    v_exp_f32 v99, v99
    v_cvt_pk_bf16_f32 v140, v92, v93
    v_cvt_pk_bf16_f32 v141, v94, v95
    v_cvt_pk_bf16_f32 v142, v96, v97
    v_cvt_pk_bf16_f32 v143, v98, v99
    s_setprio 2
    s_nop 0
    v_mfma_f32_32x32x16_bf16 v[116:131], v[172:175], v[140:143], v[116:131]
    v_exp_f32 v68, v68
    v_exp_f32 v69, v69
    v_exp_f32 v70, v70
    s_waitcnt lgkmcnt(0)
    v_mfma_f32_32x32x16_bf16 v[84:99], v[152:155], v[8:11], v[100:115]
    v_exp_f32 v71, v71
    v_exp_f32 v72, v72
    v_exp_f32 v73, v73
    v_smfmac_f32_16x16x64_bf16 v[132:135], v[36:39], v[136:143], v197
    ds_read_b128 v[168:171], v2 offset:6144
    ds_read_b128 v[172:175], v2 offset:7168
    v_exp_f32 v74, v74
    v_exp_f32 v75, v75
    v_mfma_f32_32x32x16_bf16 v[84:99], v[156:159], v[12:15], v[84:99]
    v_cvt_pk_bf16_f32 v136, v68, v69
    v_cvt_pk_bf16_f32 v137, v70, v71
    v_cvt_pk_bf16_f32 v138, v72, v73
    v_cvt_pk_bf16_f32 v139, v74, v75
    v_exp_f32 v76, v76
    ds_read_b128 v[144:147], v2 offset:8192
    ds_read_b128 v[148:151], v2 offset:9216
    v_mfma_f32_32x32x16_bf16 v[116:131], v[160:163], v[136:139], v[116:131]
    v_exp_f32 v77, v77
    v_exp_f32 v78, v78
    v_exp_f32 v79, v79
    v_exp_f32 v80, v80
    v_exp_f32 v81, v81
    v_exp_f32 v82, v82
    v_exp_f32 v83, v83
    v_cvt_pk_bf16_f32 v140, v76, v77
    v_cvt_pk_bf16_f32 v141, v78, v79
    v_cvt_pk_bf16_f32 v142, v80, v81
    v_cvt_pk_bf16_f32 v143, v82, v83
    s_setprio 1
    s_nop 0
    v_mfma_f32_32x32x16_bf16 v[116:131], v[164:167], v[140:143], v[116:131]
    v_exp_f32 v84, v84
    v_exp_f32 v85, v85
    v_exp_f32 v86, v86
    s_waitcnt lgkmcnt(0)
    v_mfma_f32_32x32x16_bf16 v[68:83], v[144:147], v[8:11], v[100:115]
    v_exp_f32 v87, v87
    v_exp_f32 v88, v88
    v_exp_f32 v89, v89
    v_smfmac_f32_16x16x64_bf16 v[132:135], v[36:39], v[136:143], v197
    ds_read_b128 v[160:163], v2 offset:10240
    ds_read_b128 v[164:167], v2 offset:11264
    v_exp_f32 v90, v90
    v_exp_f32 v91, v91
    v_mfma_f32_32x32x16_bf16 v[68:83], v[148:151], v[12:15], v[68:83]
    v_cvt_pk_bf16_f32 v136, v84, v85
    v_cvt_pk_bf16_f32 v137, v86, v87
    v_cvt_pk_bf16_f32 v138, v88, v89
    v_cvt_pk_bf16_f32 v139, v90, v91
    v_exp_f32 v92, v92
    ds_read_b128 v[152:155], v2 offset:12288
    ds_read_b128 v[156:159], v2 offset:13312
    v_mfma_f32_32x32x16_bf16 v[116:131], v[168:171], v[136:139], v[116:131]
    v_exp_f32 v93, v93
    v_exp_f32 v94, v94
    v_exp_f32 v95, v95
    s_add_u32 s47, s49, 1310720
    s_and_b32 s47, s47, 0x1fffff
    s_add_u32 m0, s51, 147456
    s_nop 0
    buffer_load_dwordx4 v53, s[32:35], s47 offen lds
    s_setprio 0
    v_exp_f32 v96, v96
    v_exp_f32 v97, v97
    v_exp_f32 v98, v98
    v_exp_f32 v99, v99
    v_cvt_pk_bf16_f32 v140, v92, v93
    v_cvt_pk_bf16_f32 v141, v94, v95
    v_cvt_pk_bf16_f32 v142, v96, v97
    v_cvt_pk_bf16_f32 v143, v98, v99
    s_waitcnt vmcnt(6)
    s_barrier
    s_setprio 3
    v_mfma_f32_32x32x16_bf16 v[116:131], v[172:175], v[140:143], v[116:131]
    v_exp_f32 v68, v68
    v_exp_f32 v69, v69
    v_exp_f32 v70, v70
    s_waitcnt lgkmcnt(0)
    v_mfma_f32_32x32x16_bf16 v[84:99], v[152:155], v[8:11], v[100:115]
    v_exp_f32 v71, v71
    v_exp_f32 v72, v72
    v_exp_f32 v73, v73
    v_smfmac_f32_16x16x64_bf16 v[132:135], v[36:39], v[136:143], v197
    ds_read_b128 v[168:171], v2 offset:14336
    ds_read_b128 v[172:175], v2 offset:15360
    v_exp_f32 v74, v74
    v_exp_f32 v75, v75
    v_mfma_f32_32x32x16_bf16 v[84:99], v[156:159], v[12:15], v[84:99]
    v_cvt_pk_bf16_f32 v136, v68, v69
    v_cvt_pk_bf16_f32 v137, v70, v71
    v_cvt_pk_bf16_f32 v138, v72, v73
    v_cvt_pk_bf16_f32 v139, v74, v75
    v_exp_f32 v76, v76
    ds_read_b128 v[144:147], v2 offset:16384
    ds_read_b128 v[148:151], v2 offset:17408
    v_mfma_f32_32x32x16_bf16 v[116:131], v[160:163], v[136:139], v[116:131]
    v_exp_f32 v77, v77
    v_exp_f32 v78, v78
    v_exp_f32 v79, v79
    ds_read_b32 v188, v41 offset:0
    ds_read_b32 v189, v41 offset:256
    ds_read_b32 v190, v41 offset:512
    ds_read_b32 v191, v41 offset:768
    s_and_b32 s47, s54, 32768
    s_cmp_eq_u32 s47, 32768
    s_cbranch_scc1 qa_kernel_FL15_E
    s_mov_b32 s62, 262144
    s_mov_b64 exec, 32768
qa_kernel_FL15:
    buffer_load_dword v29, v28, s[36:39], s57 offen sc1
    s_waitcnt vmcnt(0)
    v_cmp_ne_u32_e64 vcc, 0, v29
    s_sub_u32 s62, s62, 1
    s_cbranch_scc1 qa_kernel_FL15_X
    s_cmp_eq_u32 vcc_lo, 32768
    s_cbranch_scc0 qa_kernel_FL15
qa_kernel_FL15_X:
    s_mov_b64 exec, -1
qa_kernel_FL15_E:
    s_mov_b32 s64, 6291456
    buffer_load_dwordx4 v[176:179], v30, s[28:31], s64 offen
    s_add_u32 m0, s61, 49152
    s_nop 0
    buffer_load_dwordx4 v26, s[36:39], s59 offen sc1 lds
    buffer_load_dwordx4 v26, s[36:39], s59 offen offset:1024 sc1 lds
    s_add_u32 s60, s60, 16384
    s_and_b32 s60, s60, 0x3ffff
    s_add_u32 s59, s58, s60
    v_exp_f32 v80, v80
    v_exp_f32 v81, v81
    v_exp_f32 v82, v82
    v_exp_f32 v83, v83
    v_cvt_pk_bf16_f32 v140, v76, v77
    v_cvt_pk_bf16_f32 v141, v78, v79
    v_cvt_pk_bf16_f32 v142, v80, v81
    v_cvt_pk_bf16_f32 v143, v82, v83
    s_nop 1
    v_mfma_f32_32x32x16_bf16 v[116:131], v[164:167], v[140:143], v[116:131]
    v_exp_f32 v84, v84
    v_exp_f32 v85, v85
    v_exp_f32 v86, v86
    s_waitcnt lgkmcnt(4)
    v_mfma_f32_32x32x16_bf16 v[68:83], v[144:147], v[8:11], v[100:115]
    v_exp_f32 v87, v87
    v_exp_f32 v88, v88
    v_exp_f32 v89, v89
    v_smfmac_f32_16x16x64_bf16 v[132:135], v[36:39], v[136:143], v197
    ds_read_b128 v[160:163], v2 offset:18432
    ds_read_b128 v[164:167], v2 offset:19456
    v_exp_f32 v90, v90
    v_exp_f32 v91, v91
    v_mfma_f32_32x32x16_bf16 v[68:83], v[148:151], v[12:15], v[68:83]
    v_cvt_pk_bf16_f32 v136, v84, v85
    v_cvt_pk_bf16_f32 v137, v86, v87
    v_cvt_pk_bf16_f32 v138, v88, v89
    v_cvt_pk_bf16_f32 v139, v90, v91
    v_exp_f32 v92, v92
    ds_read_b128 v[152:155], v2 offset:20480
    ds_read_b128 v[156:159], v2 offset:21504
    v_mfma_f32_32x32x16_bf16 v[116:131], v[168:171], v[136:139], v[116:131]
    v_exp_f32 v93, v93
    v_exp_f32 v94, v94
    v_exp_f32 v95, v95
    v_exp_f32 v96, v96
    v_exp_f32 v97, v97
    v_exp_f32 v98, v98
    v_exp_f32 v99, v99
    v_cvt_pk_bf16_f32 v140, v92, v93
    v_cvt_pk_bf16_f32 v141, v94, v95
    v_cvt_pk_bf16_f32 v142, v96, v97
    v_cvt_pk_bf16_f32 v143, v98, v99
    s_setprio 2
    s_nop 0
    v_mfma_f32_32x32x16_bf16 v[116:131], v[172:175], v[140:143], v[116:131]
    v_exp_f32 v68, v68
    v_exp_f32 v69, v69
    v_exp_f32 v70, v70
    s_waitcnt lgkmcnt(0)
    v_mfma_f32_32x32x16_bf16 v[84:99], v[152:155], v[8:11], v[100:115]
    v_exp_f32 v71, v71
    v_exp_f32 v72, v72
    v_exp_f32 v73, v73
    v_smfmac_f32_16x16x64_bf16 v[132:135], v[36:39], v[136:143], v197
    ds_read_b128 v[168:171], v2 offset:22528
    ds_read_b128 v[172:175], v2 offset:23552
    v_exp_f32 v74, v74
    v_exp_f32 v75, v75
    v_mfma_f32_32x32x16_bf16 v[84:99], v[156:159], v[12:15], v[84:99]
    v_cvt_pk_bf16_f32 v136, v68, v69
    v_cvt_pk_bf16_f32 v137, v70, v71
    v_cvt_pk_bf16_f32 v138, v72, v73
    v_cvt_pk_bf16_f32 v139, v74, v75
    v_exp_f32 v76, v76
    ds_read_b128 v[144:147], v2 offset:24576
    ds_read_b128 v[148:151], v2 offset:25600
    v_mfma_f32_32x32x16_bf16 v[116:131], v[160:163], v[136:139], v[116:131]
    v_exp_f32 v77, v77
    v_exp_f32 v78, v78
    v_exp_f32 v79, v79
    v_exp_f32 v80, v80
    v_exp_f32 v81, v81
    v_exp_f32 v82, v82
    v_exp_f32 v83, v83
    v_cvt_pk_bf16_f32 v140, v76, v77
    v_cvt_pk_bf16_f32 v141, v78, v79
    v_cvt_pk_bf16_f32 v142, v80, v81
    v_cvt_pk_bf16_f32 v143, v82, v83
    s_setprio 1
    s_nop 0
    v_mfma_f32_32x32x16_bf16 v[116:131], v[164:167], v[140:143], v[116:131]
    v_exp_f32 v84, v84
    v_exp_f32 v85, v85
    v_exp_f32 v86, v86
    s_waitcnt lgkmcnt(0)
    v_mfma_f32_32x32x16_bf16 v[68:83], v[144:147], v[8:11], v[100:115]
    v_exp_f32 v87, v87
    v_exp_f32 v88, v88
    v_exp_f32 v89, v89
    v_smfmac_f32_16x16x64_bf16 v[132:135], v[36:39], v[136:143], v197
    ds_read_b128 v[160:163], v2 offset:26624
    ds_read_b128 v[164:167], v2 offset:27648
    v_exp_f32 v90, v90
    v_exp_f32 v91, v91
    v_mfma_f32_32x32x16_bf16 v[68:83], v[148:151], v[12:15], v[68:83]
    v_cvt_pk_bf16_f32 v136, v84, v85
    v_cvt_pk_bf16_f32 v137, v86, v87
    v_cvt_pk_bf16_f32 v138, v88, v89
    v_cvt_pk_bf16_f32 v139, v90, v91
    v_exp_f32 v92, v92
    ds_read_b128 v[152:155], v2 offset:28672
    ds_read_b128 v[156:159], v2 offset:29696
    v_mfma_f32_32x32x16_bf16 v[116:131], v[168:171], v[136:139], v[116:131]
    v_exp_f32 v93, v93
    v_exp_f32 v94, v94
    v_exp_f32 v95, v95
    s_mov_b32 s68, s4
    s_mov_b32 s69, s5
    s_mov_b32 s70, 4194304
    s_mov_b32 s71, 0x20000
    s_setprio 0
    v_exp_f32 v96, v96
    v_exp_f32 v97, v97
    v_exp_f32 v98, v98
    v_exp_f32 v99, v99
    v_cvt_pk_bf16_f32 v140, v92, v93
    v_cvt_pk_bf16_f32 v141, v94, v95
    v_cvt_pk_bf16_f32 v142, v96, v97
    v_cvt_pk_bf16_f32 v143, v98, v99
    s_waitcnt vmcnt(4)
    s_mov_b64 exec, s[76:77]
    s_mov_b32 s62, 262144
    s_branch qa_kernel_P2_E
qa_kernel_P2:
    buffer_load_dword v201, v198, s[40:43], 0 offen offset:4 sc1
    s_waitcnt vmcnt(0)
qa_kernel_P2_E:
    v_cmp_gt_u32 vcc, 32, v201
    s_sub_u32 s62, s62, 1
    s_cselect_b64 vcc, 0, vcc
    s_cbranch_vccnz qa_kernel_P2
    s_mov_b64 exec, -1
    s_barrier
    s_setprio 3
    v_mfma_f32_32x32x16_bf16 v[116:131], v[172:175], v[140:143], v[116:131]
    v_exp_f32 v68, v68
    v_exp_f32 v69, v69
    v_exp_f32 v70, v70
    s_waitcnt lgkmcnt(0)
    v_mfma_f32_32x32x16_bf16 v[84:99], v[152:155], v[8:11], v[100:115]
    v_exp_f32 v71, v71
    v_exp_f32 v72, v72
    v_exp_f32 v73, v73
    v_smfmac_f32_16x16x64_bf16 v[132:135], v[36:39], v[136:143], v197
    ds_read_b128 v[168:171], v2 offset:30720
    ds_read_b128 v[172:175], v2 offset:31744
    v_exp_f32 v74, v74
    v_exp_f32 v75, v75
    v_mfma_f32_32x32x16_bf16 v[84:99], v[156:159], v[12:15], v[84:99]
    v_cvt_pk_bf16_f32 v136, v68, v69
    v_cvt_pk_bf16_f32 v137, v70, v71
    v_cvt_pk_bf16_f32 v138, v72, v73
    v_cvt_pk_bf16_f32 v139, v74, v75
    v_exp_f32 v76, v76
    ds_read_b128 v[144:147], v2 offset:32768
    ds_read_b128 v[148:151], v2 offset:33792
    v_mfma_f32_32x32x16_bf16 v[116:131], v[160:163], v[136:139], v[116:131]
    v_exp_f32 v77, v77
    v_exp_f32 v78, v78
    v_exp_f32 v79, v79
    v_add_f32 v188, v188, v189
    v_add_f32 v190, v190, v191
    v_add_f32 v188, v188, v190
    v_mov_b32 v189, v188
    s_nop 1
    v_permlane32_swap_b32 v188, v189
    v_add_f32 v188, v188, v189
    s_mov_b32 s72, 25427968
    v_min_u32 v188, -2, v188
    buffer_store_dword v188, v42, s[36:39], s72 offen sc1
    v_exp_f32 v80, v80
    v_exp_f32 v81, v81
    v_exp_f32 v82, v82
    v_exp_f32 v83, v83
    v_cvt_pk_bf16_f32 v140, v76, v77
    v_cvt_pk_bf16_f32 v141, v78, v79
    v_cvt_pk_bf16_f32 v142, v80, v81
    v_cvt_pk_bf16_f32 v143, v82, v83
    s_nop 1
    v_mfma_f32_32x32x16_bf16 v[116:131], v[164:167], v[140:143], v[116:131]
    v_exp_f32 v84, v84
    v_exp_f32 v85, v85
    v_exp_f32 v86, v86
    s_waitcnt lgkmcnt(0)
    v_mfma_f32_32x32x16_bf16 v[68:83], v[144:147], v[8:11], v[100:115]
    v_exp_f32 v87, v87
    v_exp_f32 v88, v88
    v_exp_f32 v89, v89
    v_smfmac_f32_16x16x64_bf16 v[132:135], v[36:39], v[136:143], v197
    ds_read_b128 v[160:163], v2 offset:34816
    ds_read_b128 v[164:167], v2 offset:35840
    v_exp_f32 v90, v90
    v_exp_f32 v91, v91
    v_mfma_f32_32x32x16_bf16 v[68:83], v[148:151], v[12:15], v[68:83]
    v_cvt_pk_bf16_f32 v136, v84, v85
    v_cvt_pk_bf16_f32 v137, v86, v87
    v_cvt_pk_bf16_f32 v138, v88, v89
    v_cvt_pk_bf16_f32 v139, v90, v91
    v_exp_f32 v92, v92
    ds_read_b128 v[152:155], v2 offset:36864
    ds_read_b128 v[156:159], v2 offset:37888
    v_mfma_f32_32x32x16_bf16 v[116:131], v[168:171], v[136:139], v[116:131]
    v_exp_f32 v93, v93
    v_exp_f32 v94, v94
    v_exp_f32 v95, v95
    s_add_u32 s47, s49, 1572864
    s_and_b32 s47, s47, 0x1fffff
    s_add_u32 m0, s51, 0
    s_nop 0
    buffer_load_dwordx4 v53, s[32:35], s47 offen lds
    v_exp_f32 v96, v96
    v_exp_f32 v97, v97
    v_exp_f32 v98, v98
    v_exp_f32 v99, v99
    v_cvt_pk_bf16_f32 v140, v92, v93
    v_cvt_pk_bf16_f32 v141, v94, v95
    v_cvt_pk_bf16_f32 v142, v96, v97
    v_cvt_pk_bf16_f32 v143, v98, v99
    s_setprio 2
    s_nop 0
    v_mfma_f32_32x32x16_bf16 v[116:131], v[172:175], v[140:143], v[116:131]
    v_exp_f32 v68, v68
    v_exp_f32 v69, v69
    v_exp_f32 v70, v70
    s_waitcnt lgkmcnt(0)
    v_mfma_f32_32x32x16_bf16 v[84:99], v[152:155], v[8:11], v[100:115]
    v_exp_f32 v71, v71
    v_exp_f32 v72, v72
    v_exp_f32 v73, v73
    v_smfmac_f32_16x16x64_bf16 v[132:135], v[36:39], v[136:143], v197
    ds_read_b128 v[168:171], v2 offset:38912
    ds_read_b128 v[172:175], v2 offset:39936
    v_exp_f32 v74, v74
    v_exp_f32 v75, v75
    v_mfma_f32_32x32x16_bf16 v[84:99], v[156:159], v[12:15], v[84:99]
    v_cvt_pk_bf16_f32 v136, v68, v69
    v_cvt_pk_bf16_f32 v137, v70, v71
    v_cvt_pk_bf16_f32 v138, v72, v73
    v_cvt_pk_bf16_f32 v139, v74, v75
    v_exp_f32 v76, v76
    ds_read_b128 v[144:147], v2 offset:40960
    ds_read_b128 v[148:151], v2 offset:41984
    v_mfma_f32_32x32x16_bf16 v[116:131], v[160:163], v[136:139], v[116:131]
    v_exp_f32 v77, v77
    v_exp_f32 v78, v78
    v_exp_f32 v79, v79
    s_add_u32 s47, s49, 1703936
    s_and_b32 s47, s47, 0x1fffff
    s_add_u32 m0, s51, 8192
    s_nop 0
    buffer_load_dwordx4 v53, s[32:35], s47 offen lds
    v_exp_f32 v80, v80
    v_exp_f32 v81, v81
    v_exp_f32 v82, v82
    v_exp_f32 v83, v83
    v_cvt_pk_bf16_f32 v140, v76, v77
    v_cvt_pk_bf16_f32 v141, v78, v79
    v_cvt_pk_bf16_f32 v142, v80, v81
    v_cvt_pk_bf16_f32 v143, v82, v83
    s_setprio 1
    s_nop 0
    v_mfma_f32_32x32x16_bf16 v[116:131], v[164:167], v[140:143], v[116:131]
    v_exp_f32 v84, v84
    v_exp_f32 v85, v85
    v_exp_f32 v86, v86
    s_waitcnt lgkmcnt(0)
    v_mfma_f32_32x32x16_bf16 v[68:83], v[144:147], v[8:11], v[100:115]
    v_exp_f32 v87, v87
    v_exp_f32 v88, v88
    v_exp_f32 v89, v89
    v_smfmac_f32_16x16x64_bf16 v[132:135], v[36:39], v[136:143], v197
    ds_read_b128 v[160:163], v2 offset:43008
    ds_read_b128 v[164:167], v2 offset:44032
    v_exp_f32 v90, v90
    v_exp_f32 v91, v91
    v_mfma_f32_32x32x16_bf16 v[68:83], v[148:151], v[12:15], v[68:83]
    v_cvt_pk_bf16_f32 v136, v84, v85
    v_cvt_pk_bf16_f32 v137, v86, v87
    v_cvt_pk_bf16_f32 v138, v88, v89
    v_cvt_pk_bf16_f32 v139, v90, v91
    v_exp_f32 v92, v92
    ds_read_b128 v[152:155], v2 offset:45056
    ds_read_b128 v[156:159], v2 offset:46080
    v_mfma_f32_32x32x16_bf16 v[116:131], v[168:171], v[136:139], v[116:131]
    v_exp_f32 v93, v93
    v_exp_f32 v94, v94
    v_exp_f32 v95, v95
    buffer_load_dwordx4 v[60:63], v56, s[68:71], 0 offen offset:0
    s_setprio 0
    v_exp_f32 v96, v96
    v_exp_f32 v97, v97
    v_exp_f32 v98, v98
    v_exp_f32 v99, v99
    v_cvt_pk_bf16_f32 v140, v92, v93
    v_cvt_pk_bf16_f32 v141, v94, v95
    v_cvt_pk_bf16_f32 v142, v96, v97
    v_cvt_pk_bf16_f32 v143, v98, v99
    s_waitcnt vmcnt(7)
    s_waitcnt vmcnt(4)
    s_barrier
    s_setprio 3
    v_mfma_f32_32x32x16_bf16 v[116:131], v[172:175], v[140:143], v[116:131]
    v_exp_f32 v68, v68
    v_exp_f32 v69, v69
    v_exp_f32 v70, v70
    s_waitcnt lgkmcnt(0)
    v_mfma_f32_32x32x16_bf16 v[84:99], v[152:155], v[8:11], v[100:115]
    v_exp_f32 v71, v71
    v_exp_f32 v72, v72
    v_exp_f32 v73, v73
    v_smfmac_f32_16x16x64_bf16 v[132:135], v[36:39], v[136:143], v197
    ds_read_b128 v[168:171], v2 offset:47104
    ds_read_b128 v[172:175], v2 offset:48128
    v_exp_f32 v74, v74
    v_exp_f32 v75, v75
    v_mfma_f32_32x32x16_bf16 v[84:99], v[156:159], v[12:15], v[84:99]
    v_cvt_pk_bf16_f32 v136, v68, v69
    v_cvt_pk_bf16_f32 v137, v70, v71
    v_cvt_pk_bf16_f32 v138, v72, v73
    v_cvt_pk_bf16_f32 v139, v74, v75
    v_exp_f32 v76, v76
    ds_read_b128 v[144:147], v2 offset:49152
    ds_read_b128 v[148:151], v2 offset:50176
    v_mfma_f32_32x32x16_bf16 v[116:131], v[160:163], v[136:139], v[116:131]
    v_exp_f32 v77, v77
    v_exp_f32 v78, v78
    v_exp_f32 v79, v79
    v_exp_f32 v80, v80
    v_exp_f32 v81, v81
    v_exp_f32 v82, v82
    v_exp_f32 v83, v83
    v_cvt_pk_bf16_f32 v140, v76, v77
    v_cvt_pk_bf16_f32 v141, v78, v79
    v_cvt_pk_bf16_f32 v142, v80, v81
    v_cvt_pk_bf16_f32 v143, v82, v83
    s_nop 1
    v_mfma_f32_32x32x16_bf16 v[116:131], v[164:167], v[140:143], v[116:131]
    v_exp_f32 v84, v84
    v_exp_f32 v85, v85
    v_exp_f32 v86, v86
    s_waitcnt lgkmcnt(0)
    v_mfma_f32_32x32x16_bf16 v[68:83], v[144:147], v[8:11], v[100:115]
    v_exp_f32 v87, v87
    v_exp_f32 v88, v88
    v_exp_f32 v89, v89
    v_smfmac_f32_16x16x64_bf16 v[132:135], v[36:39], v[136:143], v197
    ds_read_b128 v[160:163], v2 offset:51200
    ds_read_b128 v[164:167], v2 offset:52224
    v_exp_f32 v90, v90
    v_exp_f32 v91, v91
    v_mfma_f32_32x32x16_bf16 v[68:83], v[148:151], v[12:15], v[68:83]
    v_cvt_pk_bf16_f32 v136, v84, v85
    v_cvt_pk_bf16_f32 v137, v86, v87
    v_cvt_pk_bf16_f32 v138, v88, v89
    v_cvt_pk_bf16_f32 v139, v90, v91
    v_exp_f32 v92, v92
    ds_read_b128 v[152:155], v2 offset:53248
    ds_read_b128 v[156:159], v2 offset:54272
    v_mfma_f32_32x32x16_bf16 v[116:131], v[168:171], v[136:139], v[116:131]
    v_exp_f32 v93, v93
    v_exp_f32 v94, v94
    v_exp_f32 v95, v95
    s_add_u32 s47, s49, 1441792
    s_and_b32 s47, s47, 0x1fffff
    s_add_u32 m0, s51, 155648
    s_nop 0
    buffer_load_dwordx4 v53, s[32:35], s47 offen lds
    v_exp_f32 v96, v96
    v_exp_f32 v97, v97
    v_exp_f32 v98, v98
    v_exp_f32 v99, v99
    v_cvt_pk_bf16_f32 v140, v92, v93
    v_cvt_pk_bf16_f32 v141, v94, v95
    v_cvt_pk_bf16_f32 v142, v96, v97
    v_cvt_pk_bf16_f32 v143, v98, v99
    s_setprio 2
    s_nop 0
    v_mfma_f32_32x32x16_bf16 v[116:131], v[172:175], v[140:143], v[116:131]
qa_kernel_WS0_9:
    s_cbranch_execz qa_kernel_WRET0
    v_exp_f32 v68, v68
    v_exp_f32 v69, v69
    v_exp_f32 v70, v70
    s_waitcnt lgkmcnt(0)
    v_mfma_f32_32x32x16_bf16 v[84:99], v[152:155], v[8:11], v[100:115]
    v_exp_f32 v71, v71
    v_exp_f32 v72, v72
    v_exp_f32 v73, v73
    v_smfmac_f32_16x16x64_bf16 v[132:135], v[36:39], v[136:143], v197
    ds_read_b128 v[168:171], v2 offset:55296
    ds_read_b128 v[172:175], v2 offset:56320
    v_exp_f32 v74, v74
    v_exp_f32 v75, v75
    v_mfma_f32_32x32x16_bf16 v[84:99], v[156:159], v[12:15], v[84:99]
    v_cvt_pk_bf16_f32 v136, v68, v69
    v_cvt_pk_bf16_f32 v137, v70, v71
    v_cvt_pk_bf16_f32 v138, v72, v73
    v_cvt_pk_bf16_f32 v139, v74, v75
    v_exp_f32 v76, v76
    ds_read_b128 v[144:147], v2 offset:57344
    ds_read_b128 v[148:151], v2 offset:58368
    v_mfma_f32_32x32x16_bf16 v[116:131], v[160:163], v[136:139], v[116:131]
    v_exp_f32 v77, v77
    v_exp_f32 v78, v78
    v_exp_f32 v79, v79
    s_add_u32 s47, s49, 1835008
    s_and_b32 s47, s47, 0x1fffff
    s_add_u32 m0, s51, 16384
    s_nop 0
    buffer_load_dwordx4 v53, s[32:35], s47 offen lds
    v_exp_f32 v80, v80
    v_exp_f32 v81, v81
    v_exp_f32 v82, v82
    v_exp_f32 v83, v83
    v_cvt_pk_bf16_f32 v140, v76, v77
    v_cvt_pk_bf16_f32 v141, v78, v79
    v_cvt_pk_bf16_f32 v142, v80, v81
    v_cvt_pk_bf16_f32 v143, v82, v83
    s_setprio 1
    s_nop 0
    v_mfma_f32_32x32x16_bf16 v[116:131], v[164:167], v[140:143], v[116:131]
    v_exp_f32 v84, v84
    v_exp_f32 v85, v85
    v_exp_f32 v86, v86
    s_waitcnt lgkmcnt(0)
    v_mfma_f32_32x32x16_bf16 v[68:83], v[144:147], v[8:11], v[100:115]
    v_exp_f32 v87, v87
    v_exp_f32 v88, v88
    v_exp_f32 v89, v89
    v_smfmac_f32_16x16x64_bf16 v[132:135], v[36:39], v[136:143], v197
    ds_read_b128 v[160:163], v2 offset:59392
    ds_read_b128 v[164:167], v2 offset:60416
    v_exp_f32 v90, v90
    v_exp_f32 v91, v91
    v_mfma_f32_32x32x16_bf16 v[68:83], v[148:151], v[12:15], v[68:83]
    v_cvt_pk_bf16_f32 v136, v84, v85
    v_cvt_pk_bf16_f32 v137, v86, v87
    v_cvt_pk_bf16_f32 v138, v88, v89
    v_cvt_pk_bf16_f32 v139, v90, v91
    v_exp_f32 v92, v92
    ds_read_b128 v[152:155], v2 offset:61440
    ds_read_b128 v[156:159], v2 offset:62464
    v_mfma_f32_32x32x16_bf16 v[116:131], v[168:171], v[136:139], v[116:131]
    v_exp_f32 v93, v93
    v_exp_f32 v94, v94
    v_exp_f32 v95, v95
    s_add_u32 s47, s49, 1966080
    s_and_b32 s47, s47, 0x1fffff
    s_add_u32 m0, s51, 24576
    s_nop 0
    buffer_load_dwordx4 v53, s[32:35], s47 offen lds
    s_setprio 0
    v_exp_f32 v96, v96
    v_exp_f32 v97, v97
    v_exp_f32 v98, v98
    v_exp_f32 v99, v99
    v_cvt_pk_bf16_f32 v140, v92, v93
    v_cvt_pk_bf16_f32 v141, v94, v95
    v_cvt_pk_bf16_f32 v142, v96, v97
    v_cvt_pk_bf16_f32 v143, v98, v99
    s_setprio 3
    s_nop 0
    v_mfma_f32_32x32x16_bf16 v[116:131], v[172:175], v[140:143], v[116:131]
    v_exp_f32 v68, v68
    v_exp_f32 v69, v69
    v_exp_f32 v70, v70
    s_waitcnt lgkmcnt(0)
    v_mfma_f32_32x32x16_bf16 v[84:99], v[152:155], v[8:11], v[100:115]
    v_exp_f32 v71, v71
    v_exp_f32 v72, v72
    v_exp_f32 v73, v73
    v_smfmac_f32_16x16x64_bf16 v[132:135], v[36:39], v[136:143], v197
    ds_read_b128 v[168:171], v2 offset:63488
    ds_read_b128 v[172:175], v2 offset:64512
    v_exp_f32 v74, v74
    v_exp_f32 v75, v75
    v_mfma_f32_32x32x16_bf16 v[84:99], v[156:159], v[12:15], v[84:99]
    v_cvt_pk_bf16_f32 v136, v68, v69
    v_cvt_pk_bf16_f32 v137, v70, v71
    v_cvt_pk_bf16_f32 v138, v72, v73
    v_cvt_pk_bf16_f32 v139, v74, v75
    v_exp_f32 v76, v76
    s_nop 0
    v_mfma_f32_32x32x16_bf16 v[116:131], v[160:163], v[136:139], v[116:131]
    v_exp_f32 v77, v77
    v_exp_f32 v78, v78
    v_exp_f32 v79, v79
    buffer_load_dwordx4 v[64:67], v56, s[68:71], 0 offen offset:64
    v_exp_f32 v80, v80
    v_exp_f32 v81, v81
    v_exp_f32 v82, v82
    v_exp_f32 v83, v83
    v_cvt_pk_bf16_f32 v140, v76, v77
    v_cvt_pk_bf16_f32 v141, v78, v79
    v_cvt_pk_bf16_f32 v142, v80, v81
    v_cvt_pk_bf16_f32 v143, v82, v83
    s_nop 1
    v_mfma_f32_32x32x16_bf16 v[116:131], v[164:167], v[140:143], v[116:131]
    v_exp_f32 v84, v84
    v_exp_f32 v85, v85
    v_exp_f32 v86, v86
    v_exp_f32 v87, v87
    v_exp_f32 v88, v88
    v_exp_f32 v89, v89
    v_smfmac_f32_16x16x64_bf16 v[132:135], v[36:39], v[136:143], v197
    v_exp_f32 v90, v90
    v_exp_f32 v91, v91
    v_cvt_pk_bf16_f32 v136, v84, v85
    v_cvt_pk_bf16_f32 v137, v86, v87
    v_cvt_pk_bf16_f32 v138, v88, v89
    v_cvt_pk_bf16_f32 v139, v90, v91
    v_exp_f32 v92, v92
    s_waitcnt lgkmcnt(0)
    v_mfma_f32_32x32x16_bf16 v[116:131], v[168:171], v[136:139], v[116:131]
    v_exp_f32 v93, v93
    v_exp_f32 v94, v94
    v_exp_f32 v95, v95
    v_exp_f32 v96, v96
    v_exp_f32 v97, v97
    v_exp_f32 v98, v98
    v_exp_f32 v99, v99
    v_cvt_pk_bf16_f32 v140, v92, v93
    v_cvt_pk_bf16_f32 v141, v94, v95
    v_cvt_pk_bf16_f32 v142, v96, v97
    v_cvt_pk_bf16_f32 v143, v98, v99
    s_setprio 1
    s_nop 0
    v_mfma_f32_32x32x16_bf16 v[116:131], v[172:175], v[140:143], v[116:131]
    v_smfmac_f32_16x16x64_bf16 v[132:135], v[36:39], v[136:143], v197
qa_kernel_CHK:
    s_nop 7
    v_add_f32 v132, v132, v133
    s_nop 1
    v_max3_f32 v3, |v116|, |v117|, |v118|
    v_max3_f32 v3, v3, |v119|, |v120|
    v_max3_f32 v3, v3, |v121|, |v122|
    v_max3_f32 v3, v3, |v123|, |v124|
    v_max3_f32 v3, v3, |v125|, |v126|
    v_max3_f32 v3, v3, |v127|, |v128|
    v_max3_f32 v3, v3, |v129|, |v130|
    v_max_f32_e64 v3, v3, |v131|
    s_mov_b32 s47, 0x71800000
    s_mov_b32 s48, 0x7f7fffff
    v_cmp_nle_f32_e64 vcc, v132, s47
    v_cmp_nle_f32_e64 s[40:41], v3, s48
    v_add_f32 v4, v116, v117
    v_add_f32 v4, v4, v118
    v_add_f32 v4, v4, v119
    v_add_f32 v4, v4, v120
    v_add_f32 v4, v4, v121
    v_add_f32 v4, v4, v122
    v_add_f32 v4, v4, v123
    v_add_f32 v4, v4, v124
    v_add_f32 v4, v4, v125
    v_add_f32 v4, v4, v126
    v_add_f32 v4, v4, v127
    v_add_f32 v4, v4, v128
    v_add_f32 v4, v4, v129
    v_add_f32 v4, v4, v130
    v_add_f32 v4, v4, v131
    v_cmp_u_f32_e64 s[42:43], v4, v4
    s_or_b64 vcc, vcc, s[40:41]
    s_or_b64 vcc, vcc, s[42:43]
    s_cbranch_scc1 qa_kernel_SLOW
qa_kernel_OUT:
    v_rcp_f32 v3, v132
    s_nop 0
    v_mul_f32 v116, v116, v3
    v_mul_f32 v117, v117, v3
    v_mul_f32 v118, v118, v3
    v_mul_f32 v119, v119, v3
    v_mul_f32 v120, v120, v3
    v_mul_f32 v121, v121, v3
    v_mul_f32 v122, v122, v3
    v_mul_f32 v123, v123, v3
    v_mul_f32 v124, v124, v3
    v_mul_f32 v125, v125, v3
    v_mul_f32 v126, v126, v3
    v_mul_f32 v127, v127, v3
    v_mul_f32 v128, v128, v3
    v_mul_f32 v129, v129, v3
    v_mul_f32 v130, v130, v3
    v_mul_f32 v131, v131, v3
    v_cvt_pk_bf16_f32 v68, v116, v117
    v_cvt_pk_bf16_f32 v69, v118, v119
    v_cvt_pk_bf16_f32 v70, v120, v121
    v_cvt_pk_bf16_f32 v71, v122, v123
    v_cvt_pk_bf16_f32 v72, v124, v125
    v_cvt_pk_bf16_f32 v73, v126, v127
    v_cvt_pk_bf16_f32 v74, v128, v129
    v_cvt_pk_bf16_f32 v75, v130, v131
    v_min_u32 v68, -2, v68
    v_min_u32 v69, -2, v69
    v_min_u32 v70, -2, v70
    v_min_u32 v71, -2, v71
    v_min_u32 v72, -2, v72
    v_min_u32 v73, -2, v73
    v_min_u32 v74, -2, v74
    v_min_u32 v75, -2, v75
    buffer_store_dwordx4 v[68:71], v52, s[36:39], s63 offen offset:0 sc1
    buffer_store_dwordx4 v[72:75], v52, s[36:39], s63 offen offset:512 sc1
    s_setprio 0
    s_add_u32 s50, s52, 0
    s_and_b32 s50, s50, 0x7fff
    buffer_load_dwordx4 v[160:163], v54, s[36:39], s50 offen sc1
    buffer_load_dwordx4 v[164:167], v55, s[36:39], s50 offen sc1
    s_add_u32 s50, s52, 2048
    s_and_b32 s50, s50, 0x7fff
    buffer_load_dwordx4 v[168:171], v54, s[36:39], s50 offen sc1
    buffer_load_dwordx4 v[172:175], v55, s[36:39], s50 offen sc1
    s_add_u32 s50, s52, 4096
    s_and_b32 s50, s50, 0x7fff
    buffer_load_dwordx4 v[176:179], v54, s[36:39], s50 offen sc1
    buffer_load_dwordx4 v[180:183], v55, s[36:39], s50 offen sc1
    s_lshr_b32 s45, s24, 2
    v_bfe_u32 v128, v1, 2, 2
    v_and_b32 v129, 3, v1
    v_lshrrev_b32 v3, 1, v5
    v_lshlrev_b32 v3, 4, v3
    v_and_b32 v4, 1, v5
    v_lshl_add_u32 v3, v4, 2, v3
    v_add_u32 v3, v3, v128
    s_lshl_b32 s47, s45, 12
    v_lshlrev_b32 v4, 7, v3
    v_lshl_add_u32 v4, v129, 3, v4
    v_add_u32 v4, s47, v4
    v_bfe_u32 v3, v3, 1, 2
    v_xor_b32 v124, 0, v3
    v_lshl_add_u32 v124, v124, 5, v4
    v_xor_b32 v125, 1, v3
    v_lshl_add_u32 v125, v125, 5, v4
    v_xor_b32 v126, 2, v3
    v_lshl_add_u32 v126, v126, 5, v4
    v_xor_b32 v127, 3, v3
    v_lshl_add_u32 v127, v127, 5, v4
    v_add_u32 v136, 65536, v124
    v_add_u32 v137, 131072, v124
    v_add_u32 v138, 65536, v125
    v_add_u32 v139, 131072, v125
    v_add_u32 v140, 65536, v126
    v_add_u32 v141, 131072, v126
    v_add_u32 v142, 65536, v127
    v_add_u32 v143, 131072, v127
    s_lshl_b32 s46, s53, 15
    s_lshl_b32 s48, s56, 11
    s_add_u32 s46, s46, s48
    s_add_u32 s46, s46, 20971520
    s_lshl_b32 s47, s53, 11
    s_lshl_b32 s48, s56, 7
    s_add_u32 s47, s47, s48
    s_add_u32 s47, s47, 25165824
    v_lshlrev_b32 v130, 3, v6
    v_lshl_add_u32 v130, v5, 28, v130
    v_add_u32 v130, s47, v130
    s_lshl_b32 s47, s24, 12
    s_add_u32 s47, s47, 32768
    v_add_u32 v131, s47, v2
    v_xor_b32 v132, 16384, v131
    s_mov_b32 s62, 262144
    s_lshr_b32 s44, s24, 2
    s_and_b32 s49, s24, 3
    s_and_b32 s51, s2, 7
    s_lshl_b32 s51, s51, 2
    s_bfe_u32 s47, s2, 0x20003
    s_add_u32 s51, s51, s47
    s_and_b32 s55, s51, 1
    s_lshr_b32 s54, s2, 5
    s_lshl_b32 s54, s54, 3
    s_add_u32 s54, s54, s24
    s_lshl_b32 s54, s54, 1
    s_mov_b32 s57, 4682
    s_mov_b32 s58, 7168
    s_mul_i32 s47, s49, 114688
    s_mul_i32 s48, s51, 224
    s_add_u32 s47, s47, s48
    v_add_u32 v12, 0, v1
    v_mul_lo_u32 v13, v12, s57
    v_lshrrev_b32 v13, 16, v13
    v_mul_u32_u24 v14, 14, v13
    v_sub_u32 v14, v12, v14
    v_lshlrev_b32 v14, 4, v14
    v_mul_lo_u32 v13, v13, s58
    v_add3_u32 v8, v13, v14, s47
    v_add_u32 v12, 64, v1
    v_mul_lo_u32 v13, v12, s57
    v_lshrrev_b32 v13, 16, v13
    v_mul_u32_u24 v14, 14, v13
    v_sub_u32 v14, v12, v14
    v_lshlrev_b32 v14, 4, v14
    v_mul_lo_u32 v13, v13, s58
    v_add3_u32 v9, v13, v14, s47
    v_add_u32 v12, 128, v1
    v_mul_lo_u32 v13, v12, s57
    v_lshrrev_b32 v13, 16, v13
    v_mul_u32_u24 v14, 14, v13
    v_sub_u32 v14, v12, v14
    v_lshlrev_b32 v14, 4, v14
    v_mul_lo_u32 v13, v13, s58
    v_add3_u32 v10, v13, v14, s47
    v_add_u32 v12, 192, v1
    v_mul_lo_u32 v13, v12, s57
    v_lshrrev_b32 v13, 16, v13
    v_mul_u32_u24 v14, 14, v13
    v_sub_u32 v14, v12, v14
    v_lshlrev_b32 v14, 4, v14
    v_mul_lo_u32 v13, v13, s58
    v_add3_u32 v11, v13, v14, s47
    s_mov_b32 s59, 0
    s_mul_i32 s60, s44, 14336
    s_mul_i32 s47, s49, 3584
    s_add_u32 s60, s60, s47
    v_lshlrev_b32 v2, 4, v1
    s_lshl_b32 s47, s54, 15
    v_add_u32 v15, s47, v2
    v_add_u32 v16, 32768, v15
    s_mov_b32 s61, 20971520
    v_bfe_u32 v12, v1, 2, 2
    v_and_b32 v13, 3, v1
    v_lshl_add_u32 v18, v5, 2, v12
    v_mul_u32_u24 v18, 224, v18
    v_lshl_add_u32 v18, v13, 3, v18
    s_lshl_b32 s47, s55, 5
    v_add_u32 v17, s47, v18
    s_mul_i32 s47, s55, 192
    s_sub_u32 s47, 192, s47
    v_add_u32 v18, s47, v18
    s_lshl_b32 s47, s47, 1
    s_add_u32 s47, s47, 151552
    v_lshl_add_u32 v20, v5, 4, s47
    s_lshl_b32 s47, s55, 6
    s_add_u32 s47, s47, 151552
    v_lshl_add_u32 v19, v5, 4, s47
    v_add_u32 v21, 65536, v17
    v_add_u32 v22, 131072, v17
    v_add_u32 v23, 65536, v18
    v_add_u32 v24, 131072, v18
    v_and_b32 v25, 15, v1
    v_lshlrev_b32 v25, 3, v25
    v_lshl_add_u32 v25, v5, 9, v25
    s_lshl_b32 s63, s54, 11
    s_add_u32 s63, s63, 25165824
    v_cmp_le_u32 vcc, 28, v1
    v_mov_b32 v14, 13888
    s_nop 0
    v_cndmask_b32 v26, 0, v14, vcc
    v_add_u32 v26, v26, v2
    v_cmp_le_u32 vcc, 56, v1
    v_mov_b32 v14, 0x10000000
    s_nop 0
    v_cndmask_b32 v26, v26, v14, vcc
    s_mul_i32 s64, s51, 448
    s_add_u32 s64, s64, 25427968
    s_mul_i32 s72, s54, 112
    s_lshr_b32 s47, s51, 1
    s_mul_i32 s47, s47, 7
    s_add_u32 s72, s72, s47
    s_add_u32 s73, s72, 3
    s_lshl_b32 s47, s55, 2
    s_add_u32 s72, s72, s47
    s_lshl_b32 s72, s72, 10
    s_add_u32 s72, s72, 29360128
    s_lshl_b32 s73, s73, 10
    s_add_u32 s73, s73, 29360128
    s_lshl_b32 s47, s55, 3
    v_add_u32 v27, s47, v2
    v_add_u32 v28, 114688, v2
    v_add_u32 v29, 114688, v27
    v_lshrrev_b32 v27, 5, v1
    v_mul_u32_u24 v27, 114176, v27
    s_lshl_b32 s47, s55, 9
    v_add3_u32 v27, v27, v2, s47
    s_lshl_b32 s47, s54, 11
    s_lshl_b32 s48, s51, 7
    s_add_u32 s47, s47, s48
    s_add_u32 s47, s47, 25460736
    v_lshl_add_u32 v36, v1, 2, s47
    v_cmp_lt_u32 vcc, 31, v1
    v_mov_b32 v14, 0x10000000
    s_nop 0
    v_cndmask_b32 v36, v36, v14, vcc
    s_cmp_eq_u32 s44, 0
    s_cselect_b32 s32, s12, s14
    s_cselect_b32 s33, s13, s15
    s_mov_b32 s34, 7340032
    s_mov_b32 s35, 0x20000
    s_and_b32 s74, s2, 3
    s_lshl_b32 s74, s74, 2
    s_bfe_u32 s47, s2, 0x20003
    s_add_u32 s74, s74, s47
    s_bfe_u32 s77, s2, 0x10002
    s_lshr_b32 s76, s2, 5
    s_lshl_b32 s51, s76, 1
    s_add_u32 s51, s51, s77
    s_and_b32 s78, s24, 3
    s_lshr_b32 s44, s24, 2
    s_lshl_b32 s49, s74, 3
    s_lshl_b32 s47, s78, 1
    s_add_u32 s49, s49, s47
    s_add_u32 s49, s49, s44
    s_lshl_b32 s76, s77, 1
    s_add_u32 s76, s76, s44
    v_lshrrev_b32 v3, 3, v1
    v_lshlrev_b32 v37, 11, v3
    v_bfe_u32 v3, v1, 4, 2
    v_lshlrev_b32 v3, 1, v3
    v_and_b32 v4, 7, v1
    v_xor_b32 v3, v3, v4
    v_lshl_add_u32 v37, v3, 4, v37
    s_mul_i32 s47, s76, 896
    s_lshl_b32 s48, s78, 3
    s_add_u32 s47, s47, s48
    s_lshl_b32 s47, s47, 11
    s_lshl_b32 s48, s51, 7
    s_add_u32 s47, s47, s48
    v_add_u32 v38, s47, v37
    v_xor_b32 v37, 128, v38
    s_lshl_b32 s54, s44, 13
    s_lshl_b32 s47, s78, 10
    s_add_u32 s54, s54, s47
    s_mov_b32 s74, 0
    v_lshlrev_b32 v2, 4, v1
    s_cmp_eq_u32 s78, 1
    s_cselect_b32 s47, 16384, 0
    s_cmp_eq_u32 s78, 2
    s_cselect_b32 s78, 4294950912, s47
    s_mul_i32 s48, s76, 28672
    s_mul_i32 s47, s49, 114688
    s_add_u32 s47, s47, s48
    v_add_u32 v39, s47, v2
    s_xor_b32 s47, s49, 1
    s_mul_i32 s47, s47, 114688
    s_add_u32 s47, s47, s48
    v_add_u32 v40, s47, v2
    s_lshr_b32 s47, s49, 1
    s_lshl_b32 s47, s47, 12
    s_lshl_b32 s48, s76, 10
    s_add_u32 s47, s47, s48
    s_add_u32 s47, s47, 25460736
    v_and_b32 v41, 7, v1
    v_lshl_add_u32 v41, v41, 7, s47
    v_bfe_u32 v42, v1, 2, 2
    v_and_b32 v43, 3, v1
    v_lshl_add_u32 v3, v5, 2, v42
    s_lshl_b32 s47, s44, 13
    v_lshlrev_b32 v4, 7, v3
    v_lshl_add_u32 v4, v43, 3, v4
    v_add_u32 v4, s47, v4
    v_bfe_u32 v3, v3, 1, 2
    v_xor_b32 v42, 0, v3
    v_lshl_add_u32 v42, v42, 5, v4
    v_xor_b32 v43, 1, v3
    v_lshl_add_u32 v43, v43, 5, v4
    v_xor_b32 v44, 2, v3
    v_lshl_add_u32 v44, v44, 5, v4
    v_xor_b32 v45, 3, v3
    v_lshl_add_u32 v45, v45, 5, v4
    v_add_u32 v46, 98304, v42
    v_add_u32 v47, 98304, v43
    v_add_u32 v48, 98304, v44
    v_add_u32 v49, 98304, v45
    s_lshl_b32 s47, s49, 15
    s_lshl_b32 s48, s51, 7
    s_add_u32 s47, s47, s48
    v_and_b32 v50, 15, v1
    v_lshlrev_b32 v50, 11, v50
    v_and_b32 v3, 1, v5
    v_lshl_add_u32 v50, v3, 5, v50
    v_lshrrev_b32 v3, 1, v5
    v_lshl_add_u32 v50, v3, 4, v50
    v_add_u32 v50, s47, v50
    s_lshl_b32 s55, s49, 15
    s_lshl_b32 s48, s51, 11
    s_add_u32 s55, s55, s48
    s_add_u32 s55, s55, 20971520
    s_lshl_b32 s58, s2, 14
    s_lshl_b32 s47, s24, 11
    s_add_u32 s58, s58, s47
    s_add_u32 s58, s58, 44040192
    s_xor_b32 s57, s58, 65536
    s_mov_b32 s28, s16
    s_mov_b32 s29, s17
    s_mov_b32 s30, 7340032
    s_mov_b32 s31, 0x20000
    s_mov_b32 s40, s18
    s_mov_b32 s41, s19
    s_mov_b32 s42, 4194304
    s_mov_b32 s43, 0x20000
    s_branch qa_kernel_WOL
qa_kernel_AR0:
    s_add_u32 s50, s52, 0
    s_and_b32 s50, s50, 0x7fff
    buffer_load_dwordx4 v[160:163], v54, s[36:39], s50 offen sc1
    buffer_load_dwordx4 v[164:167], v55, s[36:39], s50 offen sc1
    s_add_u32 s50, s52, 2048
    s_and_b32 s50, s50, 0x7fff
    buffer_load_dwordx4 v[168:171], v54, s[36:39], s50 offen sc1
    buffer_load_dwordx4 v[172:175], v55, s[36:39], s50 offen sc1
    s_waitcnt vmcnt(0)
    v_max3_u32 v128, v160, v161, v162
    v_max3_u32 v129, v163, v164, v165
    v_max3_u32 v128, v128, v166, v167
    v_max_u32 v128, v128, v129
    v_cmp_eq_u32 vcc, -1, v128
    s_sub_u32 s62, s62, 1
    s_cselect_b64 vcc, 0, vcc
    s_cselect_b32 s62, 0, s62
    s_cbranch_vccnz qa_kernel_AR0
    s_add_u32 s50, s52, 4096
    s_and_b32 s50, s50, 0x7fff
    buffer_load_dwordx4 v[176:179], v54, s[36:39], s50 offen sc1
    buffer_load_dwordx4 v[180:183], v55, s[36:39], s50 offen sc1
    s_branch qa_kernel_AG0
qa_kernel_AR1:
    s_add_u32 s50, s52, 2048
    s_and_b32 s50, s50, 0x7fff
    buffer_load_dwordx4 v[168:171], v54, s[36:39], s50 offen sc1
    buffer_load_dwordx4 v[172:175], v55, s[36:39], s50 offen sc1
    s_add_u32 s50, s52, 4096
    s_and_b32 s50, s50, 0x7fff
    buffer_load_dwordx4 v[176:179], v54, s[36:39], s50 offen sc1
    buffer_load_dwordx4 v[180:183], v55, s[36:39], s50 offen sc1
    s_waitcnt vmcnt(0)
    v_max3_u32 v128, v168, v169, v170
    v_max3_u32 v129, v171, v172, v173
    v_max3_u32 v128, v128, v174, v175
    v_max_u32 v128, v128, v129
    v_cmp_eq_u32 vcc, -1, v128
    s_sub_u32 s62, s62, 1
    s_cselect_b64 vcc, 0, vcc
    s_cselect_b32 s62, 0, s62
    s_cbranch_vccnz qa_kernel_AR1
    s_add_u32 s50, s52, 6144
    s_and_b32 s50, s50, 0x7fff
    buffer_load_dwordx4 v[184:187], v54, s[36:39], s50 offen sc1
    buffer_load_dwordx4 v[188:191], v55, s[36:39], s50 offen sc1
    s_branch qa_kernel_AG1
qa_kernel_AR2:
    s_add_u32 s50, s52, 4096
    s_and_b32 s50, s50, 0x7fff
    buffer_load_dwordx4 v[176:179], v54, s[36:39], s50 offen sc1
    buffer_load_dwordx4 v[180:183], v55, s[36:39], s50 offen sc1
    s_add_u32 s50, s52, 6144
    s_and_b32 s50, s50, 0x7fff
    buffer_load_dwordx4 v[184:187], v54, s[36:39], s50 offen sc1
    buffer_load_dwordx4 v[188:191], v55, s[36:39], s50 offen sc1
    s_waitcnt vmcnt(0)
    v_max3_u32 v128, v176, v177, v178
    v_max3_u32 v129, v179, v180, v181
    v_max3_u32 v128, v128, v182, v183
    v_max_u32 v128, v128, v129
    v_cmp_eq_u32 vcc, -1, v128
    s_sub_u32 s62, s62, 1
    s_cselect_b64 vcc, 0, vcc
    s_cselect_b32 s62, 0, s62
    s_cbranch_vccnz qa_kernel_AR2
    s_add_u32 s50, s52, 8192
    s_and_b32 s50, s50, 0x7fff
    buffer_load_dwordx4 v[192:195], v54, s[36:39], s50 offen sc1
    buffer_load_dwordx4 v[196:199], v55, s[36:39], s50 offen sc1
    s_branch qa_kernel_AG2
qa_kernel_AR3:
    s_add_u32 s50, s52, 6144
    s_and_b32 s50, s50, 0x7fff
    buffer_load_dwordx4 v[184:187], v54, s[36:39], s50 offen sc1
    buffer_load_dwordx4 v[188:191], v55, s[36:39], s50 offen sc1
    s_add_u32 s50, s52, 8192
    s_and_b32 s50, s50, 0x7fff
    buffer_load_dwordx4 v[192:195], v54, s[36:39], s50 offen sc1
    buffer_load_dwordx4 v[196:199], v55, s[36:39], s50 offen sc1
    s_waitcnt vmcnt(0)
    v_max3_u32 v128, v184, v185, v186
    v_max3_u32 v129, v187, v188, v189
    v_max3_u32 v128, v128, v190, v191
    v_max_u32 v128, v128, v129
    v_cmp_eq_u32 vcc, -1, v128
    s_sub_u32 s62, s62, 1
    s_cselect_b64 vcc, 0, vcc
    s_cselect_b32 s62, 0, s62
    s_cbranch_vccnz qa_kernel_AR3
    s_add_u32 s50, s52, 10240
    s_and_b32 s50, s50, 0x7fff
    buffer_load_dwordx4 v[200:203], v54, s[36:39], s50 offen sc1
    buffer_load_dwordx4 v[204:207], v55, s[36:39], s50 offen sc1
    s_branch qa_kernel_AG3
qa_kernel_AR4:
    s_add_u32 s50, s52, 8192
    s_and_b32 s50, s50, 0x7fff
    buffer_load_dwordx4 v[192:195], v54, s[36:39], s50 offen sc1
    buffer_load_dwordx4 v[196:199], v55, s[36:39], s50 offen sc1
    s_add_u32 s50, s52, 10240
    s_and_b32 s50, s50, 0x7fff
    buffer_load_dwordx4 v[200:203], v54, s[36:39], s50 offen sc1
    buffer_load_dwordx4 v[204:207], v55, s[36:39], s50 offen sc1
    s_waitcnt vmcnt(0)
    v_max3_u32 v128, v192, v193, v194
    v_max3_u32 v129, v195, v196, v197
    v_max3_u32 v128, v128, v198, v199
    v_max_u32 v128, v128, v129
    v_cmp_eq_u32 vcc, -1, v128
    s_sub_u32 s62, s62, 1
    s_cselect_b64 vcc, 0, vcc
    s_cselect_b32 s62, 0, s62
    s_cbranch_vccnz qa_kernel_AR4
    s_add_u32 s50, s52, 12288
    s_and_b32 s50, s50, 0x7fff
    buffer_load_dwordx4 v[208:211], v54, s[36:39], s50 offen sc1
    buffer_load_dwordx4 v[212:215], v55, s[36:39], s50 offen sc1
    s_branch qa_kernel_AG4
qa_kernel_AR5:
    s_add_u32 s50, s52, 10240
    s_and_b32 s50, s50, 0x7fff
    buffer_load_dwordx4 v[200:203], v54, s[36:39], s50 offen sc1
    buffer_load_dwordx4 v[204:207], v55, s[36:39], s50 offen sc1
    s_add_u32 s50, s52, 12288
    s_and_b32 s50, s50, 0x7fff
    buffer_load_dwordx4 v[208:211], v54, s[36:39], s50 offen sc1
    buffer_load_dwordx4 v[212:215], v55, s[36:39], s50 offen sc1
    s_waitcnt vmcnt(0)
    v_max3_u32 v128, v200, v201, v202
    v_max3_u32 v129, v203, v204, v205
    v_max3_u32 v128, v128, v206, v207
    v_max_u32 v128, v128, v129
    v_cmp_eq_u32 vcc, -1, v128
    s_sub_u32 s62, s62, 1
    s_cselect_b64 vcc, 0, vcc
    s_cselect_b32 s62, 0, s62
    s_cbranch_vccnz qa_kernel_AR5
    s_add_u32 s50, s52, 14336
    s_and_b32 s50, s50, 0x7fff
    buffer_load_dwordx4 v[216:219], v54, s[36:39], s50 offen sc1
    buffer_load_dwordx4 v[220:223], v55, s[36:39], s50 offen sc1
    s_branch qa_kernel_AG5
qa_kernel_AR6:
    s_add_u32 s50, s52, 12288
    s_and_b32 s50, s50, 0x7fff
    buffer_load_dwordx4 v[208:211], v54, s[36:39], s50 offen sc1
    buffer_load_dwordx4 v[212:215], v55, s[36:39], s50 offen sc1
    s_add_u32 s50, s52, 14336
    s_and_b32 s50, s50, 0x7fff
    buffer_load_dwordx4 v[216:219], v54, s[36:39], s50 offen sc1
    buffer_load_dwordx4 v[220:223], v55, s[36:39], s50 offen sc1
    s_waitcnt vmcnt(0)
    v_max3_u32 v128, v208, v209, v210
    v_max3_u32 v129, v211, v212, v213
    v_max3_u32 v128, v128, v214, v215
    v_max_u32 v128, v128, v129
    v_cmp_eq_u32 vcc, -1, v128
    s_sub_u32 s62, s62, 1
    s_cselect_b64 vcc, 0, vcc
    s_cselect_b32 s62, 0, s62
    s_cbranch_vccnz qa_kernel_AR6
    s_add_u32 s50, s52, 16384
    s_and_b32 s50, s50, 0x7fff
    buffer_load_dwordx4 v[224:227], v54, s[36:39], s50 offen sc1
    buffer_load_dwordx4 v[228:231], v55, s[36:39], s50 offen sc1
    s_branch qa_kernel_AG6
qa_kernel_AR7:
    s_add_u32 s50, s52, 14336
    s_and_b32 s50, s50, 0x7fff
    buffer_load_dwordx4 v[216:219], v54, s[36:39], s50 offen sc1
    buffer_load_dwordx4 v[220:223], v55, s[36:39], s50 offen sc1
    s_add_u32 s50, s52, 16384
    s_and_b32 s50, s50, 0x7fff
    buffer_load_dwordx4 v[224:227], v54, s[36:39], s50 offen sc1
    buffer_load_dwordx4 v[228:231], v55, s[36:39], s50 offen sc1
    s_waitcnt vmcnt(0)
    v_max3_u32 v128, v216, v217, v218
    v_max3_u32 v129, v219, v220, v221
    v_max3_u32 v128, v128, v222, v223
    v_max_u32 v128, v128, v129
    v_cmp_eq_u32 vcc, -1, v128
    s_sub_u32 s62, s62, 1
    s_cselect_b64 vcc, 0, vcc
    s_cselect_b32 s62, 0, s62
    s_cbranch_vccnz qa_kernel_AR7
    s_add_u32 s50, s52, 18432
    s_and_b32 s50, s50, 0x7fff
    buffer_load_dwordx4 v[232:235], v54, s[36:39], s50 offen sc1
    buffer_load_dwordx4 v[236:239], v55, s[36:39], s50 offen sc1
qa_kernel_WS0_10:
    s_cbranch_execz qa_kernel_WRET0
    s_branch qa_kernel_AG7
qa_kernel_AR8:
    s_add_u32 s50, s52, 16384
    s_and_b32 s50, s50, 0x7fff
    buffer_load_dwordx4 v[224:227], v54, s[36:39], s50 offen sc1
    buffer_load_dwordx4 v[228:231], v55, s[36:39], s50 offen sc1
    s_add_u32 s50, s52, 18432
    s_and_b32 s50, s50, 0x7fff
    buffer_load_dwordx4 v[232:235], v54, s[36:39], s50 offen sc1
    buffer_load_dwordx4 v[236:239], v55, s[36:39], s50 offen sc1
    s_waitcnt vmcnt(0)
    v_max3_u32 v128, v224, v225, v226
    v_max3_u32 v129, v227, v228, v229
    v_max3_u32 v128, v128, v230, v231
    v_max_u32 v128, v128, v129
    v_cmp_eq_u32 vcc, -1, v128
    s_sub_u32 s62, s62, 1
    s_cselect_b64 vcc, 0, vcc
    s_cselect_b32 s62, 0, s62
    s_cbranch_vccnz qa_kernel_AR8
    s_add_u32 s50, s52, 20480
    s_and_b32 s50, s50, 0x7fff
    buffer_load_dwordx4 v[240:243], v54, s[36:39], s50 offen sc1
    buffer_load_dwordx4 v[244:247], v55, s[36:39], s50 offen sc1
    s_branch qa_kernel_AG8
qa_kernel_AR9:
    s_add_u32 s50, s52, 18432
    s_and_b32 s50, s50, 0x7fff
    buffer_load_dwordx4 v[232:235], v54, s[36:39], s50 offen sc1
    buffer_load_dwordx4 v[236:239], v55, s[36:39], s50 offen sc1
    s_add_u32 s50, s52, 20480
    s_and_b32 s50, s50, 0x7fff
    buffer_load_dwordx4 v[240:243], v54, s[36:39], s50 offen sc1
    buffer_load_dwordx4 v[244:247], v55, s[36:39], s50 offen sc1
    s_waitcnt vmcnt(0)
    v_max3_u32 v128, v232, v233, v234
    v_max3_u32 v129, v235, v236, v237
    v_max3_u32 v128, v128, v238, v239
    v_max_u32 v128, v128, v129
    v_cmp_eq_u32 vcc, -1, v128
    s_sub_u32 s62, s62, 1
    s_cselect_b64 vcc, 0, vcc
    s_cselect_b32 s62, 0, s62
    s_cbranch_vccnz qa_kernel_AR9
    s_add_u32 s50, s52, 22528
    s_and_b32 s50, s50, 0x7fff
    buffer_load_dwordx4 v[248:251], v54, s[36:39], s50 offen sc1
    buffer_load_dwordx4 v[252:255], v55, s[36:39], s50 offen sc1
    s_branch qa_kernel_AG9
qa_kernel_AR10:
    s_add_u32 s50, s52, 20480
    s_and_b32 s50, s50, 0x7fff
    buffer_load_dwordx4 v[240:243], v54, s[36:39], s50 offen sc1
    buffer_load_dwordx4 v[244:247], v55, s[36:39], s50 offen sc1
    s_add_u32 s50, s52, 22528
    s_and_b32 s50, s50, 0x7fff
    buffer_load_dwordx4 v[248:251], v54, s[36:39], s50 offen sc1
    buffer_load_dwordx4 v[252:255], v55, s[36:39], s50 offen sc1
    s_waitcnt vmcnt(0)
    v_max3_u32 v128, v240, v241, v242
    v_max3_u32 v129, v243, v244, v245
    v_max3_u32 v128, v128, v246, v247
    v_max_u32 v128, v128, v129
    v_cmp_eq_u32 vcc, -1, v128
    s_sub_u32 s62, s62, 1
    s_cselect_b64 vcc, 0, vcc
    s_cselect_b32 s62, 0, s62
    s_cbranch_vccnz qa_kernel_AR10
    s_add_u32 s50, s52, 24576
    s_and_b32 s50, s50, 0x7fff
    buffer_load_dwordx4 v[160:163], v54, s[36:39], s50 offen sc1
    buffer_load_dwordx4 v[164:167], v55, s[36:39], s50 offen sc1
    s_branch qa_kernel_AG10
qa_kernel_AR11:
    s_add_u32 s50, s52, 22528
    s_and_b32 s50, s50, 0x7fff
    buffer_load_dwordx4 v[248:251], v54, s[36:39], s50 offen sc1
    buffer_load_dwordx4 v[252:255], v55, s[36:39], s50 offen sc1
    s_add_u32 s50, s52, 24576
    s_and_b32 s50, s50, 0x7fff
    buffer_load_dwordx4 v[160:163], v54, s[36:39], s50 offen sc1
    buffer_load_dwordx4 v[164:167], v55, s[36:39], s50 offen sc1
    s_waitcnt vmcnt(0)
    v_max3_u32 v128, v248, v249, v250
    v_max3_u32 v129, v251, v252, v253
    v_max3_u32 v128, v128, v254, v255
    v_max_u32 v128, v128, v129
    v_cmp_eq_u32 vcc, -1, v128
    s_sub_u32 s62, s62, 1
    s_cselect_b64 vcc, 0, vcc
    s_cselect_b32 s62, 0, s62
    s_cbranch_vccnz qa_kernel_AR11
    s_add_u32 s50, s52, 26624
    s_and_b32 s50, s50, 0x7fff
    buffer_load_dwordx4 v[168:171], v54, s[36:39], s50 offen sc1
    buffer_load_dwordx4 v[172:175], v55, s[36:39], s50 offen sc1
    s_branch qa_kernel_AG11
qa_kernel_AR12:
    s_add_u32 s50, s52, 24576
    s_and_b32 s50, s50, 0x7fff
    buffer_load_dwordx4 v[160:163], v54, s[36:39], s50 offen sc1
    buffer_load_dwordx4 v[164:167], v55, s[36:39], s50 offen sc1
    s_add_u32 s50, s52, 26624
    s_and_b32 s50, s50, 0x7fff
    buffer_load_dwordx4 v[168:171], v54, s[36:39], s50 offen sc1
    buffer_load_dwordx4 v[172:175], v55, s[36:39], s50 offen sc1
    s_waitcnt vmcnt(0)
    v_max3_u32 v128, v160, v161, v162
    v_max3_u32 v129, v163, v164, v165
    v_max3_u32 v128, v128, v166, v167
    v_max_u32 v128, v128, v129
    v_cmp_eq_u32 vcc, -1, v128
    s_sub_u32 s62, s62, 1
    s_cselect_b64 vcc, 0, vcc
    s_cselect_b32 s62, 0, s62
    s_cbranch_vccnz qa_kernel_AR12
    s_add_u32 s50, s52, 28672
    s_and_b32 s50, s50, 0x7fff
    buffer_load_dwordx4 v[176:179], v54, s[36:39], s50 offen sc1
    buffer_load_dwordx4 v[180:183], v55, s[36:39], s50 offen sc1
    s_branch qa_kernel_AG12
qa_kernel_AR13:
    s_add_u32 s50, s52, 26624
    s_and_b32 s50, s50, 0x7fff
    buffer_load_dwordx4 v[168:171], v54, s[36:39], s50 offen sc1
    buffer_load_dwordx4 v[172:175], v55, s[36:39], s50 offen sc1
    s_add_u32 s50, s52, 28672
    s_and_b32 s50, s50, 0x7fff
    buffer_load_dwordx4 v[176:179], v54, s[36:39], s50 offen sc1
    buffer_load_dwordx4 v[180:183], v55, s[36:39], s50 offen sc1
    s_waitcnt vmcnt(0)
    v_max3_u32 v128, v168, v169, v170
    v_max3_u32 v129, v171, v172, v173
    v_max3_u32 v128, v128, v174, v175
    v_max_u32 v128, v128, v129
    v_cmp_eq_u32 vcc, -1, v128
    s_sub_u32 s62, s62, 1
    s_cselect_b64 vcc, 0, vcc
    s_cselect_b32 s62, 0, s62
    s_cbranch_vccnz qa_kernel_AR13
    s_add_u32 s50, s52, 30720
    s_and_b32 s50, s50, 0x7fff
    buffer_load_dwordx4 v[184:187], v54, s[36:39], s50 offen sc1
    buffer_load_dwordx4 v[188:191], v55, s[36:39], s50 offen sc1
    s_branch qa_kernel_AG13
qa_kernel_AR14:
    s_add_u32 s50, s52, 28672
    s_and_b32 s50, s50, 0x7fff
    buffer_load_dwordx4 v[176:179], v54, s[36:39], s50 offen sc1
    buffer_load_dwordx4 v[180:183], v55, s[36:39], s50 offen sc1
    s_add_u32 s50, s52, 30720
    s_and_b32 s50, s50, 0x7fff
    buffer_load_dwordx4 v[184:187], v54, s[36:39], s50 offen sc1
    buffer_load_dwordx4 v[188:191], v55, s[36:39], s50 offen sc1
    s_waitcnt vmcnt(0)
    v_max3_u32 v128, v176, v177, v178
    v_max3_u32 v129, v179, v180, v181
    v_max3_u32 v128, v128, v182, v183
    v_max_u32 v128, v128, v129
    v_cmp_eq_u32 vcc, -1, v128
    s_sub_u32 s62, s62, 1
    s_cselect_b64 vcc, 0, vcc
    s_cselect_b32 s62, 0, s62
    s_cbranch_vccnz qa_kernel_AR14
    s_branch qa_kernel_AG14
qa_kernel_AR15:
    s_add_u32 s50, s52, 30720
    s_and_b32 s50, s50, 0x7fff
    buffer_load_dwordx4 v[184:187], v54, s[36:39], s50 offen sc1
    buffer_load_dwordx4 v[188:191], v55, s[36:39], s50 offen sc1
    s_waitcnt vmcnt(0)
    v_max3_u32 v128, v184, v185, v186
    v_max3_u32 v129, v187, v188, v189
    v_max3_u32 v128, v128, v190, v191
    v_max_u32 v128, v128, v129
    v_cmp_eq_u32 vcc, -1, v128
    s_sub_u32 s62, s62, 1
    s_cselect_b64 vcc, 0, vcc
    s_cselect_b32 s62, 0, s62
    s_cbranch_vccnz qa_kernel_AR15
    s_branch qa_kernel_AG15
qa_kernel_WOL:
    ds_read_b64_tr_b16 v[108:109], v136 offset:0
    ds_read_b64_tr_b16 v[110:111], v136 offset:1024
    ds_read_b64_tr_b16 v[112:113], v138 offset:0
    ds_read_b64_tr_b16 v[114:115], v138 offset:1024
    ds_read_b64_tr_b16 v[116:117], v140 offset:0
    ds_read_b64_tr_b16 v[118:119], v140 offset:1024
qa_kernel_AC0:
    s_waitcnt vmcnt(4)
    v_max3_u32 v128, v160, v161, v162
    v_max3_u32 v129, v163, v164, v165
    v_max3_u32 v128, v128, v166, v167
    v_max_u32 v128, v128, v129
    v_cmp_eq_u32 vcc, -1, v128
    s_cbranch_vccnz qa_kernel_AR0
qa_kernel_AG0:
    s_waitcnt lgkmcnt(4)
    v_mfma_f32_16x16x32_bf16 v[76:79], v[108:111], v[160:163], 0
    ds_read_b64_tr_b16 v[120:121], v142 offset:0
    v_mfma_f32_16x16x32_bf16 v[92:95], v[108:111], v[164:167], 0
    ds_read_b64_tr_b16 v[122:123], v142 offset:1024
    s_add_u32 s50, s52, 6144
    s_and_b32 s50, s50, 0x7fff
    buffer_load_dwordx4 v[184:187], v54, s[36:39], s50 offen sc1
    s_waitcnt lgkmcnt(4)
    v_mfma_f32_16x16x32_bf16 v[80:83], v[112:115], v[160:163], 0
    ds_read_b64_tr_b16 v[108:109], v136 offset:8192
    v_mfma_f32_16x16x32_bf16 v[96:99], v[112:115], v[164:167], 0
    ds_read_b64_tr_b16 v[110:111], v136 offset:9216
    buffer_load_dwordx4 v[188:191], v55, s[36:39], s50 offen sc1
    s_waitcnt lgkmcnt(4)
    v_mfma_f32_16x16x32_bf16 v[84:87], v[116:119], v[160:163], 0
    ds_read_b64_tr_b16 v[112:113], v138 offset:8192
    v_mfma_f32_16x16x32_bf16 v[100:103], v[116:119], v[164:167], 0
    ds_read_b64_tr_b16 v[114:115], v138 offset:9216
    s_waitcnt lgkmcnt(4)
    v_mfma_f32_16x16x32_bf16 v[88:91], v[120:123], v[160:163], 0
    ds_read_b64_tr_b16 v[116:117], v140 offset:8192
    v_mfma_f32_16x16x32_bf16 v[104:107], v[120:123], v[164:167], 0
    ds_read_b64_tr_b16 v[118:119], v140 offset:9216
qa_kernel_AC1:
    s_waitcnt vmcnt(4)
    v_max3_u32 v128, v168, v169, v170
    v_max3_u32 v129, v171, v172, v173
    v_max3_u32 v128, v128, v174, v175
    v_max_u32 v128, v128, v129
    v_cmp_eq_u32 vcc, -1, v128
    s_cbranch_vccnz qa_kernel_AR1
qa_kernel_AG1:
    s_waitcnt lgkmcnt(4)
    v_mfma_f32_16x16x32_bf16 v[76:79], v[108:111], v[168:171], v[76:79]
    ds_read_b64_tr_b16 v[120:121], v142 offset:8192
    v_mfma_f32_16x16x32_bf16 v[92:95], v[108:111], v[172:175], v[92:95]
    ds_read_b64_tr_b16 v[122:123], v142 offset:9216
    s_add_u32 s50, s52, 8192
    s_and_b32 s50, s50, 0x7fff
    buffer_load_dwordx4 v[192:195], v54, s[36:39], s50 offen sc1
    s_waitcnt lgkmcnt(4)
    v_mfma_f32_16x16x32_bf16 v[80:83], v[112:115], v[168:171], v[80:83]
    ds_read_b64_tr_b16 v[108:109], v136 offset:16384
    v_mfma_f32_16x16x32_bf16 v[96:99], v[112:115], v[172:175], v[96:99]
    ds_read_b64_tr_b16 v[110:111], v136 offset:17408
    buffer_load_dwordx4 v[196:199], v55, s[36:39], s50 offen sc1
    s_waitcnt lgkmcnt(4)
    v_mfma_f32_16x16x32_bf16 v[84:87], v[116:119], v[168:171], v[84:87]
    ds_read_b64_tr_b16 v[112:113], v138 offset:16384
    v_mfma_f32_16x16x32_bf16 v[100:103], v[116:119], v[172:175], v[100:103]
    ds_read_b64_tr_b16 v[114:115], v138 offset:17408
    s_waitcnt lgkmcnt(4)
    v_mfma_f32_16x16x32_bf16 v[88:91], v[120:123], v[168:171], v[88:91]
    ds_read_b64_tr_b16 v[116:117], v140 offset:16384
    v_mfma_f32_16x16x32_bf16 v[104:107], v[120:123], v[172:175], v[104:107]
    ds_read_b64_tr_b16 v[118:119], v140 offset:17408
qa_kernel_AC2:
    s_waitcnt vmcnt(4)
    v_max3_u32 v128, v176, v177, v178
    v_max3_u32 v129, v179, v180, v181
    v_max3_u32 v128, v128, v182, v183
    v_max_u32 v128, v128, v129
    v_cmp_eq_u32 vcc, -1, v128
    s_cbranch_vccnz qa_kernel_AR2
qa_kernel_AG2:
    s_waitcnt lgkmcnt(4)
    v_mfma_f32_16x16x32_bf16 v[76:79], v[108:111], v[176:179], v[76:79]
    ds_read_b64_tr_b16 v[120:121], v142 offset:16384
    v_mfma_f32_16x16x32_bf16 v[92:95], v[108:111], v[180:183], v[92:95]
    ds_read_b64_tr_b16 v[122:123], v142 offset:17408
    s_add_u32 s50, s52, 10240
    s_and_b32 s50, s50, 0x7fff
    buffer_load_dwordx4 v[200:203], v54, s[36:39], s50 offen sc1
    s_waitcnt lgkmcnt(4)
    v_mfma_f32_16x16x32_bf16 v[80:83], v[112:115], v[176:179], v[80:83]
    ds_read_b64_tr_b16 v[108:109], v136 offset:24576
    v_mfma_f32_16x16x32_bf16 v[96:99], v[112:115], v[180:183], v[96:99]
    ds_read_b64_tr_b16 v[110:111], v136 offset:25600
    buffer_load_dwordx4 v[204:207], v55, s[36:39], s50 offen sc1
    s_waitcnt lgkmcnt(4)
    v_mfma_f32_16x16x32_bf16 v[84:87], v[116:119], v[176:179], v[84:87]
    ds_read_b64_tr_b16 v[112:113], v138 offset:24576
    v_mfma_f32_16x16x32_bf16 v[100:103], v[116:119], v[180:183], v[100:103]
    ds_read_b64_tr_b16 v[114:115], v138 offset:25600
    s_waitcnt lgkmcnt(4)
    v_mfma_f32_16x16x32_bf16 v[88:91], v[120:123], v[176:179], v[88:91]
    ds_read_b64_tr_b16 v[116:117], v140 offset:24576
    v_mfma_f32_16x16x32_bf16 v[104:107], v[120:123], v[180:183], v[104:107]
    ds_read_b64_tr_b16 v[118:119], v140 offset:25600
qa_kernel_AC3:
    s_waitcnt vmcnt(4)
    v_max3_u32 v128, v184, v185, v186
    v_max3_u32 v129, v187, v188, v189
    v_max3_u32 v128, v128, v190, v191
    v_max_u32 v128, v128, v129
    v_cmp_eq_u32 vcc, -1, v128
    s_cbranch_vccnz qa_kernel_AR3
qa_kernel_AG3:
    s_waitcnt lgkmcnt(4)
    v_mfma_f32_16x16x32_bf16 v[76:79], v[108:111], v[184:187], v[76:79]
    ds_read_b64_tr_b16 v[120:121], v142 offset:24576
    v_mfma_f32_16x16x32_bf16 v[92:95], v[108:111], v[188:191], v[92:95]
    ds_read_b64_tr_b16 v[122:123], v142 offset:25600
    s_add_u32 s50, s52, 12288
    s_and_b32 s50, s50, 0x7fff
    buffer_load_dwordx4 v[208:211], v54, s[36:39], s50 offen sc1
    s_waitcnt lgkmcnt(4)
    v_mfma_f32_16x16x32_bf16 v[80:83], v[112:115], v[184:187], v[80:83]
    ds_read_b64_tr_b16 v[108:109], v136 offset:32768
    v_mfma_f32_16x16x32_bf16 v[96:99], v[112:115], v[188:191], v[96:99]
    ds_read_b64_tr_b16 v[110:111], v136 offset:33792
    buffer_load_dwordx4 v[212:215], v55, s[36:39], s50 offen sc1
    s_waitcnt lgkmcnt(4)
    v_mfma_f32_16x16x32_bf16 v[84:87], v[116:119], v[184:187], v[84:87]
    ds_read_b64_tr_b16 v[112:113], v138 offset:32768
    v_mfma_f32_16x16x32_bf16 v[100:103], v[116:119], v[188:191], v[100:103]
    ds_read_b64_tr_b16 v[114:115], v138 offset:33792
    s_waitcnt lgkmcnt(4)
    v_mfma_f32_16x16x32_bf16 v[88:91], v[120:123], v[184:187], v[88:91]
    ds_read_b64_tr_b16 v[116:117], v140 offset:32768
    v_mfma_f32_16x16x32_bf16 v[104:107], v[120:123], v[188:191], v[104:107]
    ds_read_b64_tr_b16 v[118:119], v140 offset:33792
qa_kernel_AC4:
    s_waitcnt vmcnt(4)
    v_max3_u32 v128, v192, v193, v194
    v_max3_u32 v129, v195, v196, v197
    v_max3_u32 v128, v128, v198, v199
    v_max_u32 v128, v128, v129
    v_cmp_eq_u32 vcc, -1, v128
    s_cbranch_vccnz qa_kernel_AR4
qa_kernel_AG4:
    s_waitcnt lgkmcnt(4)
    v_mfma_f32_16x16x32_bf16 v[76:79], v[108:111], v[192:195], v[76:79]
    ds_read_b64_tr_b16 v[120:121], v142 offset:32768
    v_mfma_f32_16x16x32_bf16 v[92:95], v[108:111], v[196:199], v[92:95]
    ds_read_b64_tr_b16 v[122:123], v142 offset:33792
    s_add_u32 s50, s52, 14336
    s_and_b32 s50, s50, 0x7fff
    buffer_load_dwordx4 v[216:219], v54, s[36:39], s50 offen sc1
    s_waitcnt lgkmcnt(4)
    v_mfma_f32_16x16x32_bf16 v[80:83], v[112:115], v[192:195], v[80:83]
    ds_read_b64_tr_b16 v[108:109], v136 offset:40960
    v_mfma_f32_16x16x32_bf16 v[96:99], v[112:115], v[196:199], v[96:99]
    ds_read_b64_tr_b16 v[110:111], v136 offset:41984
    buffer_load_dwordx4 v[220:223], v55, s[36:39], s50 offen sc1
    s_waitcnt lgkmcnt(4)
    v_mfma_f32_16x16x32_bf16 v[84:87], v[116:119], v[192:195], v[84:87]
    ds_read_b64_tr_b16 v[112:113], v138 offset:40960
    v_mfma_f32_16x16x32_bf16 v[100:103], v[116:119], v[196:199], v[100:103]
    ds_read_b64_tr_b16 v[114:115], v138 offset:41984
    s_waitcnt lgkmcnt(4)
    v_mfma_f32_16x16x32_bf16 v[88:91], v[120:123], v[192:195], v[88:91]
    ds_read_b64_tr_b16 v[116:117], v140 offset:40960
    v_mfma_f32_16x16x32_bf16 v[104:107], v[120:123], v[196:199], v[104:107]
    ds_read_b64_tr_b16 v[118:119], v140 offset:41984
qa_kernel_AC5:
    s_waitcnt vmcnt(4)
    v_max3_u32 v128, v200, v201, v202
    v_max3_u32 v129, v203, v204, v205
    v_max3_u32 v128, v128, v206, v207
    v_max_u32 v128, v128, v129
    v_cmp_eq_u32 vcc, -1, v128
    s_cbranch_vccnz qa_kernel_AR5
qa_kernel_AG5:
    s_waitcnt lgkmcnt(4)
    v_mfma_f32_16x16x32_bf16 v[76:79], v[108:111], v[200:203], v[76:79]
    ds_read_b64_tr_b16 v[120:121], v142 offset:40960
    v_mfma_f32_16x16x32_bf16 v[92:95], v[108:111], v[204:207], v[92:95]
    ds_read_b64_tr_b16 v[122:123], v142 offset:41984
    s_add_u32 s50, s52, 16384
    s_and_b32 s50, s50, 0x7fff
    buffer_load_dwordx4 v[224:227], v54, s[36:39], s50 offen sc1
    s_waitcnt lgkmcnt(4)
    v_mfma_f32_16x16x32_bf16 v[80:83], v[112:115], v[200:203], v[80:83]
    ds_read_b64_tr_b16 v[108:109], v136 offset:49152
    v_mfma_f32_16x16x32_bf16 v[96:99], v[112:115], v[204:207], v[96:99]
    ds_read_b64_tr_b16 v[110:111], v136 offset:50176
    buffer_load_dwordx4 v[228:231], v55, s[36:39], s50 offen sc1
    s_waitcnt lgkmcnt(4)
    v_mfma_f32_16x16x32_bf16 v[84:87], v[116:119], v[200:203], v[84:87]
    ds_read_b64_tr_b16 v[112:113], v138 offset:49152
    v_mfma_f32_16x16x32_bf16 v[100:103], v[116:119], v[204:207], v[100:103]
    ds_read_b64_tr_b16 v[114:115], v138 offset:50176
    s_waitcnt lgkmcnt(4)
    v_mfma_f32_16x16x32_bf16 v[88:91], v[120:123], v[200:203], v[88:91]
    ds_read_b64_tr_b16 v[116:117], v140 offset:49152
    v_mfma_f32_16x16x32_bf16 v[104:107], v[120:123], v[204:207], v[104:107]
    ds_read_b64_tr_b16 v[118:119], v140 offset:50176
qa_kernel_AC6:
    s_waitcnt vmcnt(4)
    v_max3_u32 v128, v208, v209, v210
    v_max3_u32 v129, v211, v212, v213
    v_max3_u32 v128, v128, v214, v215
    v_max_u32 v128, v128, v129
    v_cmp_eq_u32 vcc, -1, v128
    s_cbranch_vccnz qa_kernel_AR6
qa_kernel_AG6:
    s_waitcnt lgkmcnt(4)
    v_mfma_f32_16x16x32_bf16 v[76:79], v[108:111], v[208:211], v[76:79]
    ds_read_b64_tr_b16 v[120:121], v142 offset:49152
    v_mfma_f32_16x16x32_bf16 v[92:95], v[108:111], v[212:215], v[92:95]
    ds_read_b64_tr_b16 v[122:123], v142 offset:50176
    s_add_u32 s50, s52, 18432
    s_and_b32 s50, s50, 0x7fff
    buffer_load_dwordx4 v[232:235], v54, s[36:39], s50 offen sc1
    s_waitcnt lgkmcnt(4)
    v_mfma_f32_16x16x32_bf16 v[80:83], v[112:115], v[208:211], v[80:83]
    ds_read_b64_tr_b16 v[108:109], v136 offset:57344
    v_mfma_f32_16x16x32_bf16 v[96:99], v[112:115], v[212:215], v[96:99]
    ds_read_b64_tr_b16 v[110:111], v136 offset:58368
    buffer_load_dwordx4 v[236:239], v55, s[36:39], s50 offen sc1
    s_waitcnt lgkmcnt(4)
    v_mfma_f32_16x16x32_bf16 v[84:87], v[116:119], v[208:211], v[84:87]
    ds_read_b64_tr_b16 v[112:113], v138 offset:57344
    v_mfma_f32_16x16x32_bf16 v[100:103], v[116:119], v[212:215], v[100:103]
    ds_read_b64_tr_b16 v[114:115], v138 offset:58368
    s_waitcnt lgkmcnt(4)
    v_mfma_f32_16x16x32_bf16 v[88:91], v[120:123], v[208:211], v[88:91]
    ds_read_b64_tr_b16 v[116:117], v140 offset:57344
    v_mfma_f32_16x16x32_bf16 v[104:107], v[120:123], v[212:215], v[104:107]
    ds_read_b64_tr_b16 v[118:119], v140 offset:58368
qa_kernel_AC7:
    s_waitcnt vmcnt(4)
    v_max3_u32 v128, v216, v217, v218
    v_max3_u32 v129, v219, v220, v221
    v_max3_u32 v128, v128, v222, v223
    v_max_u32 v128, v128, v129
    v_cmp_eq_u32 vcc, -1, v128
    s_cbranch_vccnz qa_kernel_AR7
qa_kernel_AG7:
    s_waitcnt lgkmcnt(4)
    v_mfma_f32_16x16x32_bf16 v[76:79], v[108:111], v[216:219], v[76:79]
    ds_read_b64_tr_b16 v[120:121], v142 offset:57344
    v_mfma_f32_16x16x32_bf16 v[92:95], v[108:111], v[220:223], v[92:95]
    ds_read_b64_tr_b16 v[122:123], v142 offset:58368
    s_add_u32 s50, s52, 20480
    s_and_b32 s50, s50, 0x7fff
    buffer_load_dwordx4 v[240:243], v54, s[36:39], s50 offen sc1
    s_waitcnt lgkmcnt(4)
    v_mfma_f32_16x16x32_bf16 v[80:83], v[112:115], v[216:219], v[80:83]
    ds_read_b64_tr_b16 v[108:109], v137 offset:0
    v_mfma_f32_16x16x32_bf16 v[96:99], v[112:115], v[220:223], v[96:99]
    ds_read_b64_tr_b16 v[110:111], v137 offset:1024
    buffer_load_dwordx4 v[244:247], v55, s[36:39], s50 offen sc1
    s_waitcnt lgkmcnt(4)
    v_mfma_f32_16x16x32_bf16 v[84:87], v[116:119], v[216:219], v[84:87]
    ds_read_b64_tr_b16 v[112:113], v139 offset:0
    v_mfma_f32_16x16x32_bf16 v[100:103], v[116:119], v[220:223], v[100:103]
    ds_read_b64_tr_b16 v[114:115], v139 offset:1024
    s_waitcnt lgkmcnt(4)
    v_mfma_f32_16x16x32_bf16 v[88:91], v[120:123], v[216:219], v[88:91]
    ds_read_b64_tr_b16 v[116:117], v141 offset:0
    v_mfma_f32_16x16x32_bf16 v[104:107], v[120:123], v[220:223], v[104:107]
    ds_read_b64_tr_b16 v[118:119], v141 offset:1024
qa_kernel_AC8:
    s_waitcnt vmcnt(4)
    v_max3_u32 v128, v224, v225, v226
    v_max3_u32 v129, v227, v228, v229
    v_max3_u32 v128, v128, v230, v231
    v_max_u32 v128, v128, v129
    v_cmp_eq_u32 vcc, -1, v128
    s_cbranch_vccnz qa_kernel_AR8
qa_kernel_AG8:
    s_waitcnt lgkmcnt(4)
    v_mfma_f32_16x16x32_bf16 v[76:79], v[108:111], v[224:227], v[76:79]
    ds_read_b64_tr_b16 v[120:121], v143 offset:0
    v_mfma_f32_16x16x32_bf16 v[92:95], v[108:111], v[228:231], v[92:95]
    ds_read_b64_tr_b16 v[122:123], v143 offset:1024
    s_add_u32 s50, s52, 22528
    s_and_b32 s50, s50, 0x7fff
    buffer_load_dwordx4 v[248:251], v54, s[36:39], s50 offen sc1
    s_waitcnt lgkmcnt(4)
    v_mfma_f32_16x16x32_bf16 v[80:83], v[112:115], v[224:227], v[80:83]
    ds_read_b64_tr_b16 v[108:109], v137 offset:8192
    v_mfma_f32_16x16x32_bf16 v[96:99], v[112:115], v[228:231], v[96:99]
    ds_read_b64_tr_b16 v[110:111], v137 offset:9216
    buffer_load_dwordx4 v[252:255], v55, s[36:39], s50 offen sc1
    s_waitcnt lgkmcnt(4)
    v_mfma_f32_16x16x32_bf16 v[84:87], v[116:119], v[224:227], v[84:87]
    ds_read_b64_tr_b16 v[112:113], v139 offset:8192
    v_mfma_f32_16x16x32_bf16 v[100:103], v[116:119], v[228:231], v[100:103]
    ds_read_b64_tr_b16 v[114:115], v139 offset:9216
    s_waitcnt lgkmcnt(4)
    v_mfma_f32_16x16x32_bf16 v[88:91], v[120:123], v[224:227], v[88:91]
    ds_read_b64_tr_b16 v[116:117], v141 offset:8192
    v_mfma_f32_16x16x32_bf16 v[104:107], v[120:123], v[228:231], v[104:107]
    ds_read_b64_tr_b16 v[118:119], v141 offset:9216
qa_kernel_AC9:
    s_waitcnt vmcnt(4)
    v_max3_u32 v128, v232, v233, v234
    v_max3_u32 v129, v235, v236, v237
    v_max3_u32 v128, v128, v238, v239
    v_max_u32 v128, v128, v129
    v_cmp_eq_u32 vcc, -1, v128
    s_cbranch_vccnz qa_kernel_AR9
qa_kernel_AG9:
    s_waitcnt lgkmcnt(4)
    v_mfma_f32_16x16x32_bf16 v[76:79], v[108:111], v[232:235], v[76:79]
    ds_read_b64_tr_b16 v[120:121], v143 offset:8192
    v_mfma_f32_16x16x32_bf16 v[92:95], v[108:111], v[236:239], v[92:95]
    ds_read_b64_tr_b16 v[122:123], v143 offset:9216
    s_add_u32 s50, s52, 24576
    s_and_b32 s50, s50, 0x7fff
    buffer_load_dwordx4 v[160:163], v54, s[36:39], s50 offen sc1
    s_waitcnt lgkmcnt(4)
    v_mfma_f32_16x16x32_bf16 v[80:83], v[112:115], v[232:235], v[80:83]
    s_barrier
    ds_read_b64_tr_b16 v[108:109], v137 offset:16384
    v_mfma_f32_16x16x32_bf16 v[96:99], v[112:115], v[236:239], v[96:99]
    ds_read_b64_tr_b16 v[110:111], v137 offset:17408
    buffer_load_dwordx4 v[164:167], v55, s[36:39], s50 offen sc1
    s_waitcnt lgkmcnt(4)
    v_mfma_f32_16x16x32_bf16 v[84:87], v[116:119], v[232:235], v[84:87]
    ds_read_b64_tr_b16 v[112:113], v139 offset:16384
    v_mfma_f32_16x16x32_bf16 v[100:103], v[116:119], v[236:239], v[100:103]
    ds_read_b64_tr_b16 v[114:115], v139 offset:17408
    s_waitcnt lgkmcnt(4)
    v_mfma_f32_16x16x32_bf16 v[88:91], v[120:123], v[232:235], v[88:91]
    ds_read_b64_tr_b16 v[116:117], v141 offset:16384
    v_mfma_f32_16x16x32_bf16 v[104:107], v[120:123], v[236:239], v[104:107]
    ds_read_b64_tr_b16 v[118:119], v141 offset:17408
qa_kernel_AC10:
    s_waitcnt vmcnt(4)
    v_max3_u32 v128, v240, v241, v242
    v_max3_u32 v129, v243, v244, v245
    v_max3_u32 v128, v128, v246, v247
    v_max_u32 v128, v128, v129
    v_cmp_eq_u32 vcc, -1, v128
    s_cbranch_vccnz qa_kernel_AR10
qa_kernel_AG10:
    s_waitcnt lgkmcnt(4)
    v_mfma_f32_16x16x32_bf16 v[76:79], v[108:111], v[240:243], v[76:79]
    ds_read_b64_tr_b16 v[120:121], v143 offset:16384
    v_mfma_f32_16x16x32_bf16 v[92:95], v[108:111], v[244:247], v[92:95]
    ds_read_b64_tr_b16 v[122:123], v143 offset:17408
    s_add_u32 s50, s52, 26624
    s_and_b32 s50, s50, 0x7fff
    buffer_load_dwordx4 v[168:171], v54, s[36:39], s50 offen sc1
    s_waitcnt lgkmcnt(4)
    v_mfma_f32_16x16x32_bf16 v[80:83], v[112:115], v[240:243], v[80:83]
    ds_read_b64_tr_b16 v[108:109], v137 offset:24576
    v_mfma_f32_16x16x32_bf16 v[96:99], v[112:115], v[244:247], v[96:99]
    ds_read_b64_tr_b16 v[110:111], v137 offset:25600
    buffer_load_dwordx4 v[172:175], v55, s[36:39], s50 offen sc1
    s_waitcnt lgkmcnt(4)
    v_mfma_f32_16x16x32_bf16 v[84:87], v[116:119], v[240:243], v[84:87]
    ds_read_b64_tr_b16 v[112:113], v139 offset:24576
    v_mfma_f32_16x16x32_bf16 v[100:103], v[116:119], v[244:247], v[100:103]
    ds_read_b64_tr_b16 v[114:115], v139 offset:25600
    s_waitcnt lgkmcnt(4)
    v_mfma_f32_16x16x32_bf16 v[88:91], v[120:123], v[240:243], v[88:91]
    ds_read_b64_tr_b16 v[116:117], v141 offset:24576
    v_mfma_f32_16x16x32_bf16 v[104:107], v[120:123], v[244:247], v[104:107]
    ds_read_b64_tr_b16 v[118:119], v141 offset:25600
qa_kernel_AC11:
    s_waitcnt vmcnt(4)
    v_max3_u32 v128, v248, v249, v250
    v_max3_u32 v129, v251, v252, v253
    v_max3_u32 v128, v128, v254, v255
    v_max_u32 v128, v128, v129
    v_cmp_eq_u32 vcc, -1, v128
    s_cbranch_vccnz qa_kernel_AR11
qa_kernel_AG11:
    s_waitcnt lgkmcnt(4)
    v_mfma_f32_16x16x32_bf16 v[76:79], v[108:111], v[248:251], v[76:79]
    ds_read_b64_tr_b16 v[120:121], v143 offset:24576
    v_mfma_f32_16x16x32_bf16 v[92:95], v[108:111], v[252:255], v[92:95]
    ds_read_b64_tr_b16 v[122:123], v143 offset:25600
    s_add_u32 s50, s52, 28672
    s_and_b32 s50, s50, 0x7fff
    buffer_load_dwordx4 v[176:179], v54, s[36:39], s50 offen sc1
    s_waitcnt lgkmcnt(4)
    v_mfma_f32_16x16x32_bf16 v[80:83], v[112:115], v[248:251], v[80:83]
    ds_read_b64_tr_b16 v[108:109], v124 offset:0
    v_mfma_f32_16x16x32_bf16 v[96:99], v[112:115], v[252:255], v[96:99]
    ds_read_b64_tr_b16 v[110:111], v124 offset:1024
    buffer_load_dwordx4 v[180:183], v55, s[36:39], s50 offen sc1
    s_waitcnt lgkmcnt(4)
    v_mfma_f32_16x16x32_bf16 v[84:87], v[116:119], v[248:251], v[84:87]
    ds_read_b64_tr_b16 v[112:113], v125 offset:0
    v_mfma_f32_16x16x32_bf16 v[100:103], v[116:119], v[252:255], v[100:103]
    ds_read_b64_tr_b16 v[114:115], v125 offset:1024
    s_waitcnt lgkmcnt(4)
    v_mfma_f32_16x16x32_bf16 v[88:91], v[120:123], v[248:251], v[88:91]
    ds_read_b64_tr_b16 v[116:117], v126 offset:0
    v_mfma_f32_16x16x32_bf16 v[104:107], v[120:123], v[252:255], v[104:107]
    ds_read_b64_tr_b16 v[118:119], v126 offset:1024
qa_kernel_AC12:
    s_waitcnt vmcnt(4)
    v_max3_u32 v128, v160, v161, v162
    v_max3_u32 v129, v163, v164, v165
    v_max3_u32 v128, v128, v166, v167
    v_max_u32 v128, v128, v129
    v_cmp_eq_u32 vcc, -1, v128
    s_cbranch_vccnz qa_kernel_AR12
qa_kernel_AG12:
    s_waitcnt lgkmcnt(4)
    v_mfma_f32_16x16x32_bf16 v[76:79], v[108:111], v[160:163], v[76:79]
    ds_read_b64_tr_b16 v[120:121], v127 offset:0
    v_mfma_f32_16x16x32_bf16 v[92:95], v[108:111], v[164:167], v[92:95]
    ds_read_b64_tr_b16 v[122:123], v127 offset:1024
    s_add_u32 s50, s52, 30720
    s_and_b32 s50, s50, 0x7fff
    buffer_load_dwordx4 v[184:187], v54, s[36:39], s50 offen sc1
    s_waitcnt lgkmcnt(4)
    v_mfma_f32_16x16x32_bf16 v[80:83], v[112:115], v[160:163], v[80:83]
    ds_read_b64_tr_b16 v[108:109], v124 offset:8192
    v_mfma_f32_16x16x32_bf16 v[96:99], v[112:115], v[164:167], v[96:99]
    ds_read_b64_tr_b16 v[110:111], v124 offset:9216
    buffer_load_dwordx4 v[188:191], v55, s[36:39], s50 offen sc1
    s_waitcnt lgkmcnt(4)
    v_mfma_f32_16x16x32_bf16 v[84:87], v[116:119], v[160:163], v[84:87]
    ds_read_b64_tr_b16 v[112:113], v125 offset:8192
    v_mfma_f32_16x16x32_bf16 v[100:103], v[116:119], v[164:167], v[100:103]
    ds_read_b64_tr_b16 v[114:115], v125 offset:9216
    s_waitcnt lgkmcnt(4)
    v_mfma_f32_16x16x32_bf16 v[88:91], v[120:123], v[160:163], v[88:91]
    ds_read_b64_tr_b16 v[116:117], v126 offset:8192
    v_mfma_f32_16x16x32_bf16 v[104:107], v[120:123], v[164:167], v[104:107]
    ds_read_b64_tr_b16 v[118:119], v126 offset:9216
qa_kernel_AC13:
    s_waitcnt vmcnt(4)
    v_max3_u32 v128, v168, v169, v170
    v_max3_u32 v129, v171, v172, v173
    v_max3_u32 v128, v128, v174, v175
    v_max_u32 v128, v128, v129
    v_cmp_eq_u32 vcc, -1, v128
    s_cbranch_vccnz qa_kernel_AR13
qa_kernel_AG13:
    s_waitcnt lgkmcnt(4)
    v_mfma_f32_16x16x32_bf16 v[76:79], v[108:111], v[168:171], v[76:79]
    ds_read_b64_tr_b16 v[120:121], v127 offset:8192
    v_mfma_f32_16x16x32_bf16 v[92:95], v[108:111], v[172:175], v[92:95]
    ds_read_b64_tr_b16 v[122:123], v127 offset:9216
    s_waitcnt lgkmcnt(4)
    v_mfma_f32_16x16x32_bf16 v[80:83], v[112:115], v[168:171], v[80:83]
    ds_read_b64_tr_b16 v[108:109], v124 offset:16384
    v_mfma_f32_16x16x32_bf16 v[96:99], v[112:115], v[172:175], v[96:99]
    ds_read_b64_tr_b16 v[110:111], v124 offset:17408
qa_kernel_WS0_11:
    s_cbranch_execz qa_kernel_WRET0
    s_waitcnt lgkmcnt(4)
    v_mfma_f32_16x16x32_bf16 v[84:87], v[116:119], v[168:171], v[84:87]
    ds_read_b64_tr_b16 v[112:113], v125 offset:16384
    v_mfma_f32_16x16x32_bf16 v[100:103], v[116:119], v[172:175], v[100:103]
    ds_read_b64_tr_b16 v[114:115], v125 offset:17408
    s_waitcnt lgkmcnt(4)
    v_mfma_f32_16x16x32_bf16 v[88:91], v[120:123], v[168:171], v[88:91]
    ds_read_b64_tr_b16 v[116:117], v126 offset:16384
    v_mfma_f32_16x16x32_bf16 v[104:107], v[120:123], v[172:175], v[104:107]
    ds_read_b64_tr_b16 v[118:119], v126 offset:17408
qa_kernel_AC14:
    s_waitcnt vmcnt(2)
    v_max3_u32 v128, v176, v177, v178
    v_max3_u32 v129, v179, v180, v181
    v_max3_u32 v128, v128, v182, v183
    v_max_u32 v128, v128, v129
    v_cmp_eq_u32 vcc, -1, v128
    s_cbranch_vccnz qa_kernel_AR14
qa_kernel_AG14:
    s_waitcnt lgkmcnt(4)
    v_mfma_f32_16x16x32_bf16 v[76:79], v[108:111], v[176:179], v[76:79]
    ds_read_b64_tr_b16 v[120:121], v127 offset:16384
    v_mfma_f32_16x16x32_bf16 v[92:95], v[108:111], v[180:183], v[92:95]
    ds_read_b64_tr_b16 v[122:123], v127 offset:17408
    s_waitcnt lgkmcnt(4)
    v_mfma_f32_16x16x32_bf16 v[80:83], v[112:115], v[176:179], v[80:83]
    ds_read_b64_tr_b16 v[108:109], v124 offset:24576
    v_mfma_f32_16x16x32_bf16 v[96:99], v[112:115], v[180:183], v[96:99]
    ds_read_b64_tr_b16 v[110:111], v124 offset:25600
    s_waitcnt lgkmcnt(4)
    v_mfma_f32_16x16x32_bf16 v[84:87], v[116:119], v[176:179], v[84:87]
    ds_read_b64_tr_b16 v[112:113], v125 offset:24576
    v_mfma_f32_16x16x32_bf16 v[100:103], v[116:119], v[180:183], v[100:103]
    ds_read_b64_tr_b16 v[114:115], v125 offset:25600
    s_waitcnt lgkmcnt(4)
    v_mfma_f32_16x16x32_bf16 v[88:91], v[120:123], v[176:179], v[88:91]
    ds_read_b64_tr_b16 v[116:117], v126 offset:24576
    v_mfma_f32_16x16x32_bf16 v[104:107], v[120:123], v[180:183], v[104:107]
    ds_read_b64_tr_b16 v[118:119], v126 offset:25600
qa_kernel_AC15:
    s_waitcnt vmcnt(0)
    v_max3_u32 v128, v184, v185, v186
    v_max3_u32 v129, v187, v188, v189
    v_max3_u32 v128, v128, v190, v191
    v_max_u32 v128, v128, v129
    v_cmp_eq_u32 vcc, -1, v128
    s_cbranch_vccnz qa_kernel_AR15
qa_kernel_AG15:
    s_waitcnt lgkmcnt(4)
    v_mfma_f32_16x16x32_bf16 v[76:79], v[108:111], v[184:187], v[76:79]
    ds_read_b64_tr_b16 v[120:121], v127 offset:24576
    v_mfma_f32_16x16x32_bf16 v[92:95], v[108:111], v[188:191], v[92:95]
    ds_read_b64_tr_b16 v[122:123], v127 offset:25600
    s_waitcnt lgkmcnt(4)
    v_mfma_f32_16x16x32_bf16 v[80:83], v[112:115], v[184:187], v[80:83]
    v_mfma_f32_16x16x32_bf16 v[96:99], v[112:115], v[188:191], v[96:99]
    s_waitcnt lgkmcnt(2)
    v_mfma_f32_16x16x32_bf16 v[84:87], v[116:119], v[184:187], v[84:87]
    v_mfma_f32_16x16x32_bf16 v[100:103], v[116:119], v[188:191], v[100:103]
    s_waitcnt lgkmcnt(0)
    v_mfma_f32_16x16x32_bf16 v[88:91], v[120:123], v[184:187], v[88:91]
    v_mfma_f32_16x16x32_bf16 v[104:107], v[120:123], v[188:191], v[104:107]
    ds_write_b128 v131, v[92:95] offset:0
    s_nop 0
    ds_write_b128 v131, v[96:99] offset:1024
    s_nop 1
    ds_write_b128 v131, v[100:103] offset:2048
    s_nop 1
    ds_write_b128 v131, v[104:107] offset:3072
    v_permlane16_swap_b32 v60, v62
    v_permlane16_swap_b32 v61, v63
    v_permlane16_swap_b32 v64, v66
    v_permlane16_swap_b32 v65, v67
    v_lshlrev_b32 v160, 16, v60
    v_and_b32 v161, 0xffff0000, v60
    v_lshlrev_b32 v162, 16, v61
    v_and_b32 v163, 0xffff0000, v61
    v_lshlrev_b32 v164, 16, v62
    v_and_b32 v165, 0xffff0000, v62
    v_lshlrev_b32 v166, 16, v63
    v_and_b32 v167, 0xffff0000, v63
    v_lshlrev_b32 v168, 16, v64
    v_and_b32 v169, 0xffff0000, v64
    v_lshlrev_b32 v170, 16, v65
    v_and_b32 v171, 0xffff0000, v65
    v_lshlrev_b32 v172, 16, v66
    v_and_b32 v173, 0xffff0000, v66
    v_lshlrev_b32 v174, 16, v67
    v_and_b32 v175, 0xffff0000, v67
    v_add_f32 v76, v76, v160
    v_add_f32 v77, v77, v161
    v_add_f32 v78, v78, v162
    v_add_f32 v79, v79, v163
    v_add_f32 v80, v80, v164
    v_add_f32 v81, v81, v165
    v_add_f32 v82, v82, v166
    v_add_f32 v83, v83, v167
    v_add_f32 v84, v84, v168
    v_add_f32 v85, v85, v169
    v_add_f32 v86, v86, v170
    v_add_f32 v87, v87, v171
    v_add_f32 v88, v88, v172
    v_add_f32 v89, v89, v173
    v_add_f32 v90, v90, v174
    v_add_f32 v91, v91, v175
    s_waitcnt lgkmcnt(0)
    s_barrier
    ds_read_b128 v[92:95], v132 offset:0
    ds_read_b128 v[96:99], v132 offset:1024
    ds_read_b128 v[100:103], v132 offset:2048
    ds_read_b128 v[104:107], v132 offset:3072
    s_waitcnt lgkmcnt(2)
    v_add_f32 v76, v76, v92
    v_add_f32 v77, v77, v93
    v_add_f32 v78, v78, v94
    v_add_f32 v79, v79, v95
    v_add_f32 v80, v80, v96
    v_add_f32 v81, v81, v97
    v_add_f32 v82, v82, v98
    v_add_f32 v83, v83, v99
    v_cvt_pk_bf16_f32 v108, v76, v77
    v_cvt_pk_bf16_f32 v109, v78, v79
    v_cvt_pk_bf16_f32 v110, v80, v81
    v_cvt_pk_bf16_f32 v111, v82, v83
    v_min_u32 v108, -2, v108
    v_min_u32 v109, -2, v109
    v_min_u32 v110, -2, v110
    v_min_u32 v111, -2, v111
    buffer_store_dwordx4 v[108:111], v2, s[36:39], s46 offen offset:0 sc1
    s_waitcnt lgkmcnt(0)
    v_add_f32 v84, v84, v100
    v_add_f32 v85, v85, v101
    v_add_f32 v86, v86, v102
    v_add_f32 v87, v87, v103
    v_add_f32 v88, v88, v104
    v_add_f32 v89, v89, v105
    v_add_f32 v90, v90, v106
    v_add_f32 v91, v91, v107
    v_cvt_pk_bf16_f32 v112, v84, v85
    v_cvt_pk_bf16_f32 v113, v86, v87
    v_cvt_pk_bf16_f32 v114, v88, v89
    v_cvt_pk_bf16_f32 v115, v90, v91
    v_min_u32 v112, -2, v112
    v_min_u32 v113, -2, v113
    v_min_u32 v114, -2, v114
    v_min_u32 v115, -2, v115
    buffer_store_dwordx4 v[112:115], v2, s[36:39], s46 offen offset:1024 sc1
    v_add_f32 v134, v76, v77
    v_mul_f32 v135, v76, v76
    v_add_f32 v3, v78, v79
    v_mul_f32 v4, v77, v77
    v_fmac_f32 v135, v78, v78
    v_fmac_f32 v4, v79, v79
    v_fmac_f32 v135, v80, v80
    v_add_f32 v134, v134, v80
    v_fmac_f32 v4, v81, v81
    v_add_f32 v3, v3, v81
    v_fmac_f32 v135, v82, v82
    v_add_f32 v134, v134, v82
    v_fmac_f32 v4, v83, v83
    v_add_f32 v3, v3, v83
    v_fmac_f32 v135, v84, v84
    v_add_f32 v134, v134, v84
    v_fmac_f32 v4, v85, v85
    v_add_f32 v3, v3, v85
    v_fmac_f32 v135, v86, v86
    v_add_f32 v134, v134, v86
    v_fmac_f32 v4, v87, v87
    v_add_f32 v3, v3, v87
    v_fmac_f32 v135, v88, v88
    v_add_f32 v134, v134, v88
    v_fmac_f32 v4, v89, v89
    v_add_f32 v3, v3, v89
    v_fmac_f32 v135, v90, v90
    v_add_f32 v134, v134, v90
    v_fmac_f32 v4, v91, v91
    v_add_f32 v3, v3, v91
    v_add_f32 v134, v134, v3
    v_add_f32 v135, v135, v4
    v_mov_b32 v3, v134
    v_mov_b32 v4, v135
    s_nop 0
    v_permlane16_swap_b32 v134, v3
    v_permlane16_swap_b32 v135, v4
    v_add_f32 v134, v134, v3
    v_add_f32 v135, v135, v4
    v_mov_b32 v3, v134
    v_mov_b32 v4, v135
    s_nop 0
    v_permlane32_swap_b32 v134, v3
    v_permlane32_swap_b32 v135, v4
    v_add_f32 v134, v134, v3
    v_add_f32 v135, v135, v4
    v_min_u32 v134, -2, v134
    v_min_u32 v135, -2, v135
    buffer_store_dwordx2 v[134:135], v130, s[36:39], 0 offen sc1
    s_add_u32 m0, s60, 65536
    s_nop 0
    buffer_load_dwordx4 v8, s[32:35], s59 offen lds
    s_add_u32 m0, s60, 66560
    s_nop 0
    buffer_load_dwordx4 v9, s[32:35], s59 offen lds
    s_add_u32 m0, s60, 67584
    s_nop 0
    buffer_load_dwordx4 v10, s[32:35], s59 offen lds
    s_add_u32 m0, s60, 68608
    s_mov_b32 exec_hi, 0
    buffer_load_dwordx4 v11, s[32:35], s59 offen lds
    s_mov_b32 exec_hi, -1
    s_add_u32 s59, s59, 458752
    buffer_load_dwordx4 v[208:211], v15, s[36:39], s61 offen offset:0 sc1
    buffer_load_dwordx4 v[212:215], v16, s[36:39], s61 offen offset:0 sc1
    buffer_load_dwordx4 v[216:219], v15, s[36:39], s61 offen offset:1024 sc1
    buffer_load_dwordx4 v[220:223], v16, s[36:39], s61 offen offset:1024 sc1
    s_mov_b64 exec, 0
    s_cmp_eq_u32 s24, 0
    s_cbranch_scc1 qa_kernel_WS1_0
    s_cmp_eq_u32 s24, 1
    s_cbranch_scc1 qa_kernel_WS1_1
    s_cmp_eq_u32 s24, 2
    s_cbranch_scc1 qa_kernel_WS1_2
    s_cmp_eq_u32 s24, 3
    s_cbranch_scc1 qa_kernel_WS1_3
    s_cmp_eq_u32 s24, 4
    s_cbranch_scc1 qa_kernel_WS1_4
    s_cmp_eq_u32 s24, 5
    s_cbranch_scc1 qa_kernel_WS1_5
    s_cmp_eq_u32 s24, 6
    s_cbranch_scc1 qa_kernel_WS1_6
    s_cmp_eq_u32 s24, 7
    s_cbranch_scc1 qa_kernel_WS1_7
qa_kernel_WRET1:
    s_mov_b64 exec, -1
qa_kernel_F1S:
qa_kernel_WS1_0:
    s_cbranch_execz qa_kernel_WS1_8
    s_cmp_ge_u32 s24, 4
    s_cbranch_scc1 qa_kernel_P1
    s_waitcnt vmcnt(4)
    s_barrier
    ds_read_b64_tr_b16 v[52:53], v21 offset:0
    ds_read_b64_tr_b16 v[54:55], v21 offset:3584
    ds_read_b64_tr_b16 v[56:57], v21 offset:7168
    ds_read_b64_tr_b16 v[58:59], v21 offset:10752
    ds_read_b64_tr_b16 v[60:61], v21 offset:14336
    ds_read_b64_tr_b16 v[62:63], v21 offset:17920
    ds_read_b64_tr_b16 v[64:65], v21 offset:21504
    ds_read_b64_tr_b16 v[66:67], v21 offset:25088
    s_waitcnt vmcnt(2)
    v_max3_u32 v12, v208, v209, v210
    v_max3_u32 v13, v211, v212, v213
    v_max3_u32 v12, v12, v214, v215
    v_max_u32 v12, v12, v13
    v_cmp_eq_u32 vcc, -1, v12
    s_cbranch_vccz qa_kernel_F0_A0_G
qa_kernel_F0_A0_R:
    s_mov_b32 s47, 20971520
    buffer_load_dwordx4 v[208:211], v15, s[36:39], s47 offen offset:0 sc1
    s_mov_b32 s47, 20971520
    buffer_load_dwordx4 v[212:215], v16, s[36:39], s47 offen offset:0 sc1
    s_mov_b32 s47, 20971520
    buffer_load_dwordx4 v[216:219], v15, s[36:39], s47 offen offset:1024 sc1
    s_mov_b32 s47, 20971520
    buffer_load_dwordx4 v[220:223], v16, s[36:39], s47 offen offset:1024 sc1
    s_waitcnt vmcnt(0)
    v_max3_u32 v12, v208, v209, v210
    v_max3_u32 v13, v211, v212, v213
    v_max3_u32 v12, v12, v214, v215
    v_max_u32 v12, v12, v13
    v_cmp_eq_u32 vcc, -1, v12
    s_sub_u32 s62, s62, 1
    s_cselect_b64 vcc, 0, vcc
    s_cselect_b32 s62, 0, s62
    s_cbranch_vccnz qa_kernel_F0_A0_R
qa_kernel_F0_A0_G:
    s_waitcnt vmcnt(0)
    v_max3_u32 v12, v216, v217, v218
    v_max3_u32 v13, v219, v220, v221
    v_max3_u32 v12, v12, v222, v223
    v_max_u32 v12, v12, v13
    v_cmp_eq_u32 vcc, -1, v12
    s_cbranch_vccz qa_kernel_F0_A1_G
qa_kernel_F0_A1_R:
    s_mov_b32 s47, 20971520
    buffer_load_dwordx4 v[216:219], v15, s[36:39], s47 offen offset:1024 sc1
    s_mov_b32 s47, 20971520
    buffer_load_dwordx4 v[220:223], v16, s[36:39], s47 offen offset:1024 sc1
    s_waitcnt vmcnt(0)
    v_max3_u32 v12, v216, v217, v218
    v_max3_u32 v13, v219, v220, v221
    v_max3_u32 v12, v12, v222, v223
    v_max_u32 v12, v12, v13
    v_cmp_eq_u32 vcc, -1, v12
    s_sub_u32 s62, s62, 1
    s_cselect_b64 vcc, 0, vcc
    s_cselect_b32 s62, 0, s62
    s_cbranch_vccnz qa_kernel_F0_A1_R
qa_kernel_F0_A1_G:
    s_waitcnt lgkmcnt(4)
    v_mfma_f32_16x16x32_bf16 v[72:75], v[52:55], v[208:211], 0
    ds_read_b64_tr_b16 v[68:69], v21 offset:32
    v_mfma_f32_16x16x32_bf16 v[72:75], v[56:59], v[216:219], v[72:75]
    ds_read_b64_tr_b16 v[70:71], v21 offset:3616
    s_setprio 3
    v_mfma_f32_16x16x32_bf16 v[76:79], v[52:55], v[212:215], 0
    ds_read_b64_tr_b16 v[52:53], v21 offset:7200
    v_mfma_f32_16x16x32_bf16 v[76:79], v[56:59], v[220:223], v[76:79]
    ds_read_b64_tr_b16 v[54:55], v21 offset:10784
    s_waitcnt lgkmcnt(4)
    v_mfma_f32_16x16x32_bf16 v[80:83], v[60:63], v[208:211], 0
    ds_read_b64_tr_b16 v[56:57], v21 offset:14368
    v_mfma_f32_16x16x32_bf16 v[80:83], v[64:67], v[216:219], v[80:83]
    ds_read_b64_tr_b16 v[58:59], v21 offset:17952
    s_add_u32 m0, s60, 94208
    s_nop 0
    buffer_load_dwordx4 v8, s[32:35], s59 offen lds
    v_mfma_f32_16x16x32_bf16 v[84:87], v[60:63], v[212:215], 0
    ds_read_b64_tr_b16 v[60:61], v21 offset:21536
    v_mfma_f32_16x16x32_bf16 v[84:87], v[64:67], v[220:223], v[84:87]
    ds_read_b64_tr_b16 v[62:63], v21 offset:25120
    s_waitcnt lgkmcnt(4)
    v_mfma_f32_16x16x32_bf16 v[88:91], v[68:71], v[208:211], 0
    ds_read_b64_tr_b16 v[64:65], v21 offset:64
    v_mfma_f32_16x16x32_bf16 v[88:91], v[52:55], v[216:219], v[88:91]
    ds_read_b64_tr_b16 v[66:67], v21 offset:3648
    v_mfma_f32_16x16x32_bf16 v[92:95], v[68:71], v[212:215], 0
    ds_read_b64_tr_b16 v[68:69], v21 offset:7232
    v_mfma_f32_16x16x32_bf16 v[92:95], v[52:55], v[220:223], v[92:95]
    ds_read_b64_tr_b16 v[70:71], v21 offset:10816
    s_add_u32 m0, s60, 95232
    s_nop 0
    buffer_load_dwordx4 v9, s[32:35], s59 offen lds
    s_waitcnt lgkmcnt(4)
    v_mfma_f32_16x16x32_bf16 v[96:99], v[56:59], v[208:211], 0
    ds_read_b64_tr_b16 v[52:53], v21 offset:14400
    v_mfma_f32_16x16x32_bf16 v[96:99], v[60:63], v[216:219], v[96:99]
    ds_read_b64_tr_b16 v[54:55], v21 offset:17984
    s_setprio 2
    v_mfma_f32_16x16x32_bf16 v[100:103], v[56:59], v[212:215], 0
    ds_read_b64_tr_b16 v[56:57], v21 offset:21568
    v_mfma_f32_16x16x32_bf16 v[100:103], v[60:63], v[220:223], v[100:103]
    ds_read_b64_tr_b16 v[58:59], v21 offset:25152
    s_waitcnt lgkmcnt(4)
    v_mfma_f32_16x16x32_bf16 v[104:107], v[64:67], v[208:211], 0
    ds_read_b64_tr_b16 v[60:61], v21 offset:96
    v_mfma_f32_16x16x32_bf16 v[104:107], v[68:71], v[216:219], v[104:107]
    ds_read_b64_tr_b16 v[62:63], v21 offset:3680
    s_add_u32 m0, s60, 96256
    s_nop 0
    buffer_load_dwordx4 v10, s[32:35], s59 offen lds
    v_mfma_f32_16x16x32_bf16 v[108:111], v[64:67], v[212:215], 0
    ds_read_b64_tr_b16 v[64:65], v21 offset:7264
    v_mfma_f32_16x16x32_bf16 v[108:111], v[68:71], v[220:223], v[108:111]
    ds_read_b64_tr_b16 v[66:67], v21 offset:10848
    s_add_u32 m0, s60, 97280
    s_mov_b32 exec_hi, 0
    buffer_load_dwordx4 v11, s[32:35], s59 offen lds
    s_mov_b32 exec_hi, -1
    s_add_u32 s59, s59, 458752
    s_waitcnt lgkmcnt(4)
    v_mfma_f32_16x16x32_bf16 v[112:115], v[52:55], v[208:211], 0
    ds_read_b64_tr_b16 v[68:69], v21 offset:14432
    v_mfma_f32_16x16x32_bf16 v[112:115], v[56:59], v[216:219], v[112:115]
    ds_read_b64_tr_b16 v[70:71], v21 offset:18016
    v_mfma_f32_16x16x32_bf16 v[116:119], v[52:55], v[212:215], 0
    ds_read_b64_tr_b16 v[52:53], v21 offset:21600
    v_mfma_f32_16x16x32_bf16 v[116:119], v[56:59], v[220:223], v[116:119]
    ds_read_b64_tr_b16 v[54:55], v21 offset:25184
    buffer_load_dwordx4 v[224:227], v15, s[36:39], s61 offen offset:2048 sc1
    s_waitcnt lgkmcnt(4)
    v_mfma_f32_16x16x32_bf16 v[120:123], v[60:63], v[208:211], 0
    ds_read_b64_tr_b16 v[56:57], v21 offset:128
    v_mfma_f32_16x16x32_bf16 v[120:123], v[64:67], v[216:219], v[120:123]
    ds_read_b64_tr_b16 v[58:59], v21 offset:3712
    s_setprio 1
    buffer_load_dwordx4 v[228:231], v16, s[36:39], s61 offen offset:2048 sc1
    v_mfma_f32_16x16x32_bf16 v[124:127], v[60:63], v[212:215], 0
    ds_read_b64_tr_b16 v[60:61], v21 offset:7296
    v_mfma_f32_16x16x32_bf16 v[124:127], v[64:67], v[220:223], v[124:127]
    ds_read_b64_tr_b16 v[62:63], v21 offset:10880
    buffer_load_dwordx4 v[232:235], v15, s[36:39], s61 offen offset:3072 sc1
    s_waitcnt lgkmcnt(4)
    v_mfma_f32_16x16x32_bf16 v[128:131], v[68:71], v[208:211], 0
    ds_read_b64_tr_b16 v[64:65], v21 offset:14464
    v_mfma_f32_16x16x32_bf16 v[128:131], v[52:55], v[216:219], v[128:131]
    ds_read_b64_tr_b16 v[66:67], v21 offset:18048
    buffer_load_dwordx4 v[236:239], v16, s[36:39], s61 offen offset:3072 sc1
    s_add_u32 s61, s61, 4096
    v_mfma_f32_16x16x32_bf16 v[132:135], v[68:71], v[212:215], 0
    ds_read_b64_tr_b16 v[68:69], v21 offset:21632
    v_mfma_f32_16x16x32_bf16 v[132:135], v[52:55], v[220:223], v[132:135]
    ds_read_b64_tr_b16 v[70:71], v21 offset:25216
    s_waitcnt lgkmcnt(4)
    v_mfma_f32_16x16x32_bf16 v[136:139], v[56:59], v[208:211], 0
    ds_read_b64_tr_b16 v[52:53], v21 offset:160
    v_mfma_f32_16x16x32_bf16 v[136:139], v[60:63], v[216:219], v[136:139]
    ds_read_b64_tr_b16 v[54:55], v21 offset:3744
    v_mfma_f32_16x16x32_bf16 v[140:143], v[56:59], v[212:215], 0
    ds_read_b64_tr_b16 v[56:57], v21 offset:7328
    v_mfma_f32_16x16x32_bf16 v[140:143], v[60:63], v[220:223], v[140:143]
    ds_read_b64_tr_b16 v[58:59], v21 offset:10912
    s_mov_b32 m0, 151552
    s_nop 0
    buffer_load_dwordx4 v26, s[36:39], s64 offen sc1 lds
    s_waitcnt lgkmcnt(4)
    v_mfma_f32_16x16x32_bf16 v[144:147], v[64:67], v[208:211], 0
    ds_read_b64_tr_b16 v[60:61], v21 offset:14496
    v_mfma_f32_16x16x32_bf16 v[144:147], v[68:71], v[216:219], v[144:147]
    ds_read_b64_tr_b16 v[62:63], v21 offset:18080
    s_setprio 0
    v_mfma_f32_16x16x32_bf16 v[148:151], v[64:67], v[212:215], 0
    ds_read_b64_tr_b16 v[64:65], v21 offset:21664
    v_mfma_f32_16x16x32_bf16 v[148:151], v[68:71], v[220:223], v[148:151]
    ds_read_b64_tr_b16 v[66:67], v21 offset:25248
    s_waitcnt lgkmcnt(4)
    v_mfma_f32_16x16x32_bf16 v[152:155], v[52:55], v[208:211], 0
    ds_read_b64_tr_b16 v[68:69], v23 offset:0
    v_mfma_f32_16x16x32_bf16 v[152:155], v[56:59], v[216:219], v[152:155]
    ds_read_b64_tr_b16 v[70:71], v23 offset:3584
    s_add_u32 m0, s60, 122880
    s_nop 0
    buffer_load_dwordx4 v8, s[32:35], s59 offen lds
    v_mfma_f32_16x16x32_bf16 v[156:159], v[52:55], v[212:215], 0
    ds_read_b64_tr_b16 v[52:53], v23 offset:7168
    v_mfma_f32_16x16x32_bf16 v[156:159], v[56:59], v[220:223], v[156:159]
    ds_read_b64_tr_b16 v[54:55], v23 offset:10752
    s_waitcnt lgkmcnt(4)
    v_mfma_f32_16x16x32_bf16 v[160:163], v[60:63], v[208:211], 0
    ds_read_b64_tr_b16 v[56:57], v23 offset:14336
    v_mfma_f32_16x16x32_bf16 v[160:163], v[64:67], v[216:219], v[160:163]
    ds_read_b64_tr_b16 v[58:59], v23 offset:17920
    v_mfma_f32_16x16x32_bf16 v[164:167], v[60:63], v[212:215], 0
    ds_read_b64_tr_b16 v[60:61], v23 offset:21504
    v_mfma_f32_16x16x32_bf16 v[164:167], v[64:67], v[220:223], v[164:167]
    ds_read_b64_tr_b16 v[62:63], v23 offset:25088
    s_add_u32 m0, s60, 123904
    s_nop 0
    buffer_load_dwordx4 v9, s[32:35], s59 offen lds
    s_waitcnt lgkmcnt(4)
    v_mfma_f32_16x16x32_bf16 v[168:171], v[68:71], v[208:211], 0
    s_waitcnt vmcnt(7)
    s_barrier
    ds_read_b64_tr_b16 v[64:65], v21 offset:28672
    v_mfma_f32_16x16x32_bf16 v[168:171], v[52:55], v[216:219], v[168:171]
    ds_read_b64_tr_b16 v[66:67], v21 offset:32256
    s_setprio 3
    s_add_u32 m0, s60, 124928
    s_nop 0
    buffer_load_dwordx4 v10, s[32:35], s59 offen lds
    v_mfma_f32_16x16x32_bf16 v[172:175], v[68:71], v[212:215], 0
    ds_read_b64_tr_b16 v[68:69], v21 offset:35840
    v_mfma_f32_16x16x32_bf16 v[172:175], v[52:55], v[220:223], v[172:175]
    ds_read_b64_tr_b16 v[70:71], v21 offset:39424
    s_waitcnt vmcnt(6)
    v_max3_u32 v12, v224, v225, v226
    v_max3_u32 v13, v227, v228, v229
    v_max3_u32 v12, v12, v230, v231
    v_max_u32 v12, v12, v13
    v_cmp_eq_u32 vcc, -1, v12
    s_cbranch_vccz qa_kernel_F0_A2_G
qa_kernel_F0_A2_R:
    s_mov_b32 s47, 20971520
    buffer_load_dwordx4 v[224:227], v15, s[36:39], s47 offen offset:2048 sc1
    s_mov_b32 s47, 20971520
    buffer_load_dwordx4 v[228:231], v16, s[36:39], s47 offen offset:2048 sc1
    s_mov_b32 s47, 20971520
    buffer_load_dwordx4 v[232:235], v15, s[36:39], s47 offen offset:3072 sc1
    s_mov_b32 s47, 20971520
    buffer_load_dwordx4 v[236:239], v16, s[36:39], s47 offen offset:3072 sc1
    s_waitcnt vmcnt(0)
    v_max3_u32 v12, v224, v225, v226
    v_max3_u32 v13, v227, v228, v229
    v_max3_u32 v12, v12, v230, v231
    v_max_u32 v12, v12, v13
    v_cmp_eq_u32 vcc, -1, v12
    s_sub_u32 s62, s62, 1
    s_cselect_b64 vcc, 0, vcc
    s_cselect_b32 s62, 0, s62
    s_cbranch_vccnz qa_kernel_F0_A2_R
qa_kernel_F0_A2_G:
    s_waitcnt lgkmcnt(4)
    v_mfma_f32_16x16x32_bf16 v[176:179], v[56:59], v[208:211], 0
    ds_read_b64_tr_b16 v[52:53], v21 offset:43008
    v_mfma_f32_16x16x32_bf16 v[176:179], v[60:63], v[216:219], v[176:179]
    ds_read_b64_tr_b16 v[54:55], v21 offset:46592
    s_waitcnt vmcnt(4)
    v_max3_u32 v12, v232, v233, v234
    v_max3_u32 v13, v235, v236, v237
    v_max3_u32 v12, v12, v238, v239
    v_max_u32 v12, v12, v13
    v_cmp_eq_u32 vcc, -1, v12
    s_cbranch_vccz qa_kernel_F0_A3_G
qa_kernel_F0_A3_R:
    s_mov_b32 s47, 20971520
    buffer_load_dwordx4 v[232:235], v15, s[36:39], s47 offen offset:3072 sc1
    s_mov_b32 s47, 20971520
    buffer_load_dwordx4 v[236:239], v16, s[36:39], s47 offen offset:3072 sc1
    s_waitcnt vmcnt(0)
    v_max3_u32 v12, v232, v233, v234
    v_max3_u32 v13, v235, v236, v237
    v_max3_u32 v12, v12, v238, v239
    v_max_u32 v12, v12, v13
    v_cmp_eq_u32 vcc, -1, v12
    s_sub_u32 s62, s62, 1
    s_cselect_b64 vcc, 0, vcc
    s_cselect_b32 s62, 0, s62
    s_cbranch_vccnz qa_kernel_F0_A3_R
qa_kernel_F0_A3_G:
    v_mfma_f32_16x16x32_bf16 v[180:183], v[56:59], v[212:215], 0
    ds_read_b64_tr_b16 v[56:57], v21 offset:50176
    v_mfma_f32_16x16x32_bf16 v[180:183], v[60:63], v[220:223], v[180:183]
    ds_read_b64_tr_b16 v[58:59], v21 offset:53760
    s_add_u32 m0, s60, 125952
    s_mov_b32 exec_hi, 0
    buffer_load_dwordx4 v11, s[32:35], s59 offen lds
    s_mov_b32 exec_hi, -1
    s_add_u32 s59, s59, 458752
    s_waitcnt lgkmcnt(4)
    v_mfma_f32_16x16x32_bf16 v[72:75], v[64:67], v[224:227], v[72:75]
    ds_read_b64_tr_b16 v[60:61], v21 offset:28704
    v_mfma_f32_16x16x32_bf16 v[72:75], v[68:71], v[232:235], v[72:75]
    ds_read_b64_tr_b16 v[62:63], v21 offset:32288
    v_mfma_f32_16x16x32_bf16 v[76:79], v[64:67], v[228:231], v[76:79]
    ds_read_b64_tr_b16 v[64:65], v21 offset:35872
    v_mfma_f32_16x16x32_bf16 v[76:79], v[68:71], v[236:239], v[76:79]
    ds_read_b64_tr_b16 v[66:67], v21 offset:39456
    s_waitcnt lgkmcnt(4)
    v_mfma_f32_16x16x32_bf16 v[80:83], v[52:55], v[224:227], v[80:83]
    ds_read_b64_tr_b16 v[68:69], v21 offset:43040
    v_mfma_f32_16x16x32_bf16 v[80:83], v[56:59], v[232:235], v[80:83]
    ds_read_b64_tr_b16 v[70:71], v21 offset:46624
    buffer_load_dwordx4 v[240:243], v15, s[36:39], s61 offen offset:0 sc1
    v_mfma_f32_16x16x32_bf16 v[84:87], v[52:55], v[228:231], v[84:87]
    ds_read_b64_tr_b16 v[52:53], v21 offset:50208
    v_mfma_f32_16x16x32_bf16 v[84:87], v[56:59], v[236:239], v[84:87]
    ds_read_b64_tr_b16 v[54:55], v21 offset:53792
    s_setprio 2
    s_waitcnt lgkmcnt(4)
    v_mfma_f32_16x16x32_bf16 v[88:91], v[60:63], v[224:227], v[88:91]
    ds_read_b64_tr_b16 v[56:57], v21 offset:28736
    v_mfma_f32_16x16x32_bf16 v[88:91], v[64:67], v[232:235], v[88:91]
    ds_read_b64_tr_b16 v[58:59], v21 offset:32320
    v_mfma_f32_16x16x32_bf16 v[92:95], v[60:63], v[228:231], v[92:95]
    ds_read_b64_tr_b16 v[60:61], v21 offset:35904
    v_mfma_f32_16x16x32_bf16 v[92:95], v[64:67], v[236:239], v[92:95]
    ds_read_b64_tr_b16 v[62:63], v21 offset:39488
    buffer_load_dwordx4 v[244:247], v16, s[36:39], s61 offen offset:0 sc1
    s_waitcnt lgkmcnt(4)
    v_mfma_f32_16x16x32_bf16 v[96:99], v[68:71], v[224:227], v[96:99]
    ds_read_b64_tr_b16 v[64:65], v21 offset:43072
    v_mfma_f32_16x16x32_bf16 v[96:99], v[52:55], v[232:235], v[96:99]
    ds_read_b64_tr_b16 v[66:67], v21 offset:46656
    v_mfma_f32_16x16x32_bf16 v[100:103], v[68:71], v[228:231], v[100:103]
    ds_read_b64_tr_b16 v[68:69], v21 offset:50240
    v_mfma_f32_16x16x32_bf16 v[100:103], v[52:55], v[236:239], v[100:103]
    ds_read_b64_tr_b16 v[70:71], v21 offset:53824
    s_waitcnt lgkmcnt(4)
    v_mfma_f32_16x16x32_bf16 v[104:107], v[56:59], v[224:227], v[104:107]
    ds_read_b64_tr_b16 v[52:53], v21 offset:28768
    v_mfma_f32_16x16x32_bf16 v[104:107], v[60:63], v[232:235], v[104:107]
    ds_read_b64_tr_b16 v[54:55], v21 offset:32352
    buffer_load_dwordx4 v[248:251], v15, s[36:39], s61 offen offset:1024 sc1
    v_mfma_f32_16x16x32_bf16 v[108:111], v[56:59], v[228:231], v[108:111]
    ds_read_b64_tr_b16 v[56:57], v21 offset:35936
    v_mfma_f32_16x16x32_bf16 v[108:111], v[60:63], v[236:239], v[108:111]
    ds_read_b64_tr_b16 v[58:59], v21 offset:39520
    s_waitcnt lgkmcnt(4)
    v_mfma_f32_16x16x32_bf16 v[112:115], v[64:67], v[224:227], v[112:115]
    ds_read_b64_tr_b16 v[60:61], v21 offset:43104
    v_mfma_f32_16x16x32_bf16 v[112:115], v[68:71], v[232:235], v[112:115]
    ds_read_b64_tr_b16 v[62:63], v21 offset:46688
    s_setprio 1
    v_mfma_f32_16x16x32_bf16 v[116:119], v[64:67], v[228:231], v[116:119]
    ds_read_b64_tr_b16 v[64:65], v21 offset:50272
    v_mfma_f32_16x16x32_bf16 v[116:119], v[68:71], v[236:239], v[116:119]
    ds_read_b64_tr_b16 v[66:67], v21 offset:53856
    buffer_load_dwordx4 v[252:255], v16, s[36:39], s61 offen offset:1024 sc1
    s_waitcnt lgkmcnt(4)
    v_mfma_f32_16x16x32_bf16 v[120:123], v[52:55], v[224:227], v[120:123]
    ds_read_b64_tr_b16 v[68:69], v21 offset:28800
    v_mfma_f32_16x16x32_bf16 v[120:123], v[56:59], v[232:235], v[120:123]
    ds_read_b64_tr_b16 v[70:71], v21 offset:32384
    v_mfma_f32_16x16x32_bf16 v[124:127], v[52:55], v[228:231], v[124:127]
    ds_read_b64_tr_b16 v[52:53], v21 offset:35968
    v_mfma_f32_16x16x32_bf16 v[124:127], v[56:59], v[236:239], v[124:127]
    ds_read_b64_tr_b16 v[54:55], v21 offset:39552
    s_waitcnt lgkmcnt(4)
    v_mfma_f32_16x16x32_bf16 v[128:131], v[60:63], v[224:227], v[128:131]
    ds_read_b64_tr_b16 v[56:57], v21 offset:43136
    v_mfma_f32_16x16x32_bf16 v[128:131], v[64:67], v[232:235], v[128:131]
    ds_read_b64_tr_b16 v[58:59], v21 offset:46720
    s_add_u32 m0, s60, 0
    s_nop 0
    buffer_load_dwordx4 v8, s[32:35], s59 offen lds
    v_mfma_f32_16x16x32_bf16 v[132:135], v[60:63], v[228:231], v[132:135]
    ds_read_b64_tr_b16 v[60:61], v21 offset:50304
    v_mfma_f32_16x16x32_bf16 v[132:135], v[64:67], v[236:239], v[132:135]
    ds_read_b64_tr_b16 v[62:63], v21 offset:53888
    s_waitcnt lgkmcnt(4)
    v_mfma_f32_16x16x32_bf16 v[136:139], v[68:71], v[224:227], v[136:139]
    ds_read_b64_tr_b16 v[64:65], v21 offset:28832
    v_mfma_f32_16x16x32_bf16 v[136:139], v[52:55], v[232:235], v[136:139]
    ds_read_b64_tr_b16 v[66:67], v21 offset:32416
    v_mfma_f32_16x16x32_bf16 v[140:143], v[68:71], v[228:231], v[140:143]
    ds_read_b64_tr_b16 v[68:69], v21 offset:36000
    v_mfma_f32_16x16x32_bf16 v[140:143], v[52:55], v[236:239], v[140:143]
    ds_read_b64_tr_b16 v[70:71], v21 offset:39584
    s_setprio 0
    s_add_u32 m0, s60, 1024
    s_nop 0
    buffer_load_dwordx4 v9, s[32:35], s59 offen lds
    s_waitcnt lgkmcnt(4)
    v_mfma_f32_16x16x32_bf16 v[144:147], v[56:59], v[224:227], v[144:147]
    ds_read_b64_tr_b16 v[52:53], v21 offset:43168
    v_mfma_f32_16x16x32_bf16 v[144:147], v[60:63], v[232:235], v[144:147]
    ds_read_b64_tr_b16 v[54:55], v21 offset:46752
    v_mfma_f32_16x16x32_bf16 v[148:151], v[56:59], v[228:231], v[148:151]
    ds_read_b64_tr_b16 v[56:57], v21 offset:50336
    v_mfma_f32_16x16x32_bf16 v[148:151], v[60:63], v[236:239], v[148:151]
    ds_read_b64_tr_b16 v[58:59], v21 offset:53920
    s_waitcnt lgkmcnt(4)
    v_mfma_f32_16x16x32_bf16 v[152:155], v[64:67], v[224:227], v[152:155]
    ds_read_b64_tr_b16 v[60:61], v23 offset:28672
    v_mfma_f32_16x16x32_bf16 v[152:155], v[68:71], v[232:235], v[152:155]
    ds_read_b64_tr_b16 v[62:63], v23 offset:32256
    s_add_u32 m0, s60, 2048
    s_nop 0
    buffer_load_dwordx4 v10, s[32:35], s59 offen lds
    v_mfma_f32_16x16x32_bf16 v[156:159], v[64:67], v[228:231], v[156:159]
    ds_read_b64_tr_b16 v[64:65], v23 offset:35840
    v_mfma_f32_16x16x32_bf16 v[156:159], v[68:71], v[236:239], v[156:159]
    ds_read_b64_tr_b16 v[66:67], v23 offset:39424
    s_waitcnt lgkmcnt(4)
    v_mfma_f32_16x16x32_bf16 v[160:163], v[52:55], v[224:227], v[160:163]
    ds_read_b64_tr_b16 v[68:69], v23 offset:43008
    v_mfma_f32_16x16x32_bf16 v[160:163], v[56:59], v[232:235], v[160:163]
    ds_read_b64_tr_b16 v[70:71], v23 offset:46592
    v_mfma_f32_16x16x32_bf16 v[164:167], v[52:55], v[228:231], v[164:167]
    ds_read_b64_tr_b16 v[52:53], v23 offset:50176
    v_mfma_f32_16x16x32_bf16 v[164:167], v[56:59], v[236:239], v[164:167]
    ds_read_b64_tr_b16 v[54:55], v23 offset:53760
    s_add_u32 m0, s60, 3072
    s_mov_b32 exec_hi, 0
    buffer_load_dwordx4 v11, s[32:35], s59 offen lds
    s_mov_b32 exec_hi, -1
    s_add_u32 s59, s59, 458752
    s_waitcnt lgkmcnt(4)
    v_mfma_f32_16x16x32_bf16 v[168:171], v[60:63], v[224:227], v[168:171]
    s_waitcnt vmcnt(8)
    s_barrier
    ds_read_b64_tr_b16 v[56:57], v21 offset:57344
    v_mfma_f32_16x16x32_bf16 v[168:171], v[64:67], v[232:235], v[168:171]
    ds_read_b64_tr_b16 v[58:59], v21 offset:60928
qa_kernel_WS1_1:
    s_cbranch_execz qa_kernel_WS1_9
    s_setprio 3
    buffer_load_dwordx4 v[208:211], v15, s[36:39], s61 offen offset:2048 sc1
    v_mfma_f32_16x16x32_bf16 v[172:175], v[60:63], v[228:231], v[172:175]
    ds_read_b64_tr_b16 v[60:61], v21 offset:64512
    v_mfma_f32_16x16x32_bf16 v[172:175], v[64:67], v[236:239], v[172:175]
    ds_read_b64_tr_b16 v[62:63], v22 offset:2560
    s_waitcnt vmcnt(7)
    v_max3_u32 v12, v240, v241, v242
    v_max3_u32 v13, v243, v244, v245
    v_max3_u32 v12, v12, v246, v247
    v_max_u32 v12, v12, v13
    v_cmp_eq_u32 vcc, -1, v12
    s_cbranch_vccnz qa_kernel_F0_A4_R
qa_kernel_F0_A4_G:
    s_waitcnt lgkmcnt(4)
    v_mfma_f32_16x16x32_bf16 v[176:179], v[68:71], v[224:227], v[176:179]
    ds_read_b64_tr_b16 v[64:65], v22 offset:6144
    v_mfma_f32_16x16x32_bf16 v[176:179], v[52:55], v[232:235], v[176:179]
    ds_read_b64_tr_b16 v[66:67], v22 offset:9728
    s_waitcnt vmcnt(5)
    v_max3_u32 v12, v248, v249, v250
    v_max3_u32 v13, v251, v252, v253
    v_max3_u32 v12, v12, v254, v255
    v_max_u32 v12, v12, v13
    v_cmp_eq_u32 vcc, -1, v12
    s_cbranch_vccnz qa_kernel_F0_A5_R
qa_kernel_F0_A5_G:
    v_mfma_f32_16x16x32_bf16 v[180:183], v[68:71], v[228:231], v[180:183]
    ds_read_b64_tr_b16 v[68:69], v22 offset:13312
    v_mfma_f32_16x16x32_bf16 v[180:183], v[52:55], v[236:239], v[180:183]
    ds_read_b64_tr_b16 v[70:71], v22 offset:16896
    buffer_load_dwordx4 v[212:215], v16, s[36:39], s61 offen offset:2048 sc1
    s_waitcnt lgkmcnt(4)
    v_mfma_f32_16x16x32_bf16 v[72:75], v[56:59], v[240:243], v[72:75]
    ds_read_b64_tr_b16 v[52:53], v21 offset:57376
    v_mfma_f32_16x16x32_bf16 v[72:75], v[60:63], v[248:251], v[72:75]
    ds_read_b64_tr_b16 v[54:55], v21 offset:60960
    v_mfma_f32_16x16x32_bf16 v[76:79], v[56:59], v[244:247], v[76:79]
    ds_read_b64_tr_b16 v[56:57], v21 offset:64544
    v_mfma_f32_16x16x32_bf16 v[76:79], v[60:63], v[252:255], v[76:79]
    ds_read_b64_tr_b16 v[58:59], v22 offset:2592
    s_waitcnt lgkmcnt(4)
    v_mfma_f32_16x16x32_bf16 v[80:83], v[64:67], v[240:243], v[80:83]
    ds_read_b64_tr_b16 v[60:61], v22 offset:6176
    v_mfma_f32_16x16x32_bf16 v[80:83], v[68:71], v[248:251], v[80:83]
    ds_read_b64_tr_b16 v[62:63], v22 offset:9760
    buffer_load_dwordx4 v[216:219], v15, s[36:39], s61 offen offset:3072 sc1
    v_min_u32 v188, 880, v2
    v_add_u32 v188, 131072, v188
    v_mfma_f32_16x16x32_bf16 v[84:87], v[64:67], v[244:247], v[84:87]
    ds_read_b64_tr_b16 v[64:65], v22 offset:13344
    v_mfma_f32_16x16x32_bf16 v[84:87], v[68:71], v[252:255], v[84:87]
    ds_read_b64_tr_b16 v[66:67], v22 offset:16928
    s_setprio 2
    ds_read_b128 v[184:187], v188 offset:20480
    s_waitcnt lgkmcnt(5)
    v_mfma_f32_16x16x32_bf16 v[88:91], v[52:55], v[240:243], v[88:91]
    ds_read_b64_tr_b16 v[68:69], v21 offset:57408
    v_mfma_f32_16x16x32_bf16 v[88:91], v[56:59], v[248:251], v[88:91]
    ds_read_b64_tr_b16 v[70:71], v21 offset:60992
    v_mfma_f32_16x16x32_bf16 v[92:95], v[52:55], v[244:247], v[92:95]
    ds_read_b64_tr_b16 v[52:53], v21 offset:64576
    v_mfma_f32_16x16x32_bf16 v[92:95], v[56:59], v[252:255], v[92:95]
    ds_read_b64_tr_b16 v[54:55], v22 offset:2624
    buffer_load_dwordx4 v[220:223], v16, s[36:39], s61 offen offset:3072 sc1
    s_add_u32 s61, s61, 4096
    s_waitcnt lgkmcnt(5)
    v_mfma_f32_16x16x32_bf16 v[96:99], v[60:63], v[240:243], v[96:99]
    ds_read_b64_tr_b16 v[56:57], v22 offset:6208
    v_mfma_f32_16x16x32_bf16 v[96:99], v[64:67], v[248:251], v[96:99]
    ds_read_b64_tr_b16 v[58:59], v22 offset:9792
    v_mfma_f32_16x16x32_bf16 v[100:103], v[60:63], v[244:247], v[100:103]
    ds_read_b64_tr_b16 v[60:61], v22 offset:13376
    v_mfma_f32_16x16x32_bf16 v[100:103], v[64:67], v[252:255], v[100:103]
    ds_read_b64_tr_b16 v[62:63], v22 offset:16960
    s_waitcnt lgkmcnt(4)
    v_mfma_f32_16x16x32_bf16 v[104:107], v[68:71], v[240:243], v[104:107]
    ds_read_b64_tr_b16 v[64:65], v21 offset:57440
    v_mfma_f32_16x16x32_bf16 v[104:107], v[52:55], v[248:251], v[104:107]
    ds_read_b64_tr_b16 v[66:67], v21 offset:61024
    s_add_u32 m0, s60, 28672
    s_nop 0
    buffer_load_dwordx4 v8, s[32:35], s59 offen lds
    v_max3_u32 v12, v184, v185, v186
    v_max_u32 v12, v12, v187
    v_cmp_eq_u32 vcc, -1, v12
    s_cbranch_vccnz qa_kernel_CK0_R
qa_kernel_CK0_G:
    v_mfma_f32_16x16x32_bf16 v[108:111], v[68:71], v[244:247], v[108:111]
    ds_read_b64_tr_b16 v[68:69], v21 offset:64608
    v_mfma_f32_16x16x32_bf16 v[108:111], v[52:55], v[252:255], v[108:111]
    ds_read_b64_tr_b16 v[70:71], v22 offset:2656
    s_waitcnt lgkmcnt(4)
    v_mfma_f32_16x16x32_bf16 v[112:115], v[56:59], v[240:243], v[112:115]
    ds_read_b64_tr_b16 v[52:53], v22 offset:6240
    v_mfma_f32_16x16x32_bf16 v[112:115], v[60:63], v[248:251], v[112:115]
    ds_read_b64_tr_b16 v[54:55], v22 offset:9824
    s_setprio 1
    v_mfma_f32_16x16x32_bf16 v[116:119], v[56:59], v[244:247], v[116:119]
    ds_read_b64_tr_b16 v[56:57], v22 offset:13408
    v_mfma_f32_16x16x32_bf16 v[116:119], v[60:63], v[252:255], v[116:119]
    ds_read_b64_tr_b16 v[58:59], v22 offset:16992
    s_add_u32 m0, s60, 29696
    s_nop 0
    buffer_load_dwordx4 v9, s[32:35], s59 offen lds
    s_waitcnt lgkmcnt(4)
    v_mfma_f32_16x16x32_bf16 v[120:123], v[64:67], v[240:243], v[120:123]
    ds_read_b64_tr_b16 v[60:61], v21 offset:57472
    v_mfma_f32_16x16x32_bf16 v[120:123], v[68:71], v[248:251], v[120:123]
    ds_read_b64_tr_b16 v[62:63], v21 offset:61056
    v_mfma_f32_16x16x32_bf16 v[124:127], v[64:67], v[244:247], v[124:127]
    ds_read_b64_tr_b16 v[64:65], v21 offset:64640
    v_mfma_f32_16x16x32_bf16 v[124:127], v[68:71], v[252:255], v[124:127]
    ds_read_b64_tr_b16 v[66:67], v22 offset:2688
    s_waitcnt lgkmcnt(4)
    v_mfma_f32_16x16x32_bf16 v[128:131], v[52:55], v[240:243], v[128:131]
    ds_read_b64_tr_b16 v[68:69], v22 offset:6272
    v_mfma_f32_16x16x32_bf16 v[128:131], v[56:59], v[248:251], v[128:131]
    ds_read_b64_tr_b16 v[70:71], v22 offset:9856
    s_add_u32 m0, s60, 30720
    s_nop 0
    buffer_load_dwordx4 v10, s[32:35], s59 offen lds
    v_mfma_f32_16x16x32_bf16 v[132:135], v[52:55], v[244:247], v[132:135]
    ds_read_b64_tr_b16 v[52:53], v22 offset:13440
    v_mfma_f32_16x16x32_bf16 v[132:135], v[56:59], v[252:255], v[132:135]
    ds_read_b64_tr_b16 v[54:55], v22 offset:17024
    s_waitcnt lgkmcnt(4)
    v_mfma_f32_16x16x32_bf16 v[136:139], v[60:63], v[240:243], v[136:139]
    ds_read_b64_tr_b16 v[56:57], v21 offset:57504
    v_mfma_f32_16x16x32_bf16 v[136:139], v[64:67], v[248:251], v[136:139]
    ds_read_b64_tr_b16 v[58:59], v21 offset:61088
    v_mfma_f32_16x16x32_bf16 v[140:143], v[60:63], v[244:247], v[140:143]
    ds_read_b64_tr_b16 v[60:61], v21 offset:64672
    v_mfma_f32_16x16x32_bf16 v[140:143], v[64:67], v[252:255], v[140:143]
    ds_read_b64_tr_b16 v[62:63], v22 offset:2720
    s_setprio 0
    s_add_u32 m0, s60, 31744
    s_mov_b32 exec_hi, 0
    buffer_load_dwordx4 v11, s[32:35], s59 offen lds
    s_mov_b32 exec_hi, -1
    s_add_u32 s59, s59, 458752
    s_waitcnt lgkmcnt(4)
    v_mfma_f32_16x16x32_bf16 v[144:147], v[68:71], v[240:243], v[144:147]
    ds_read_b64_tr_b16 v[64:65], v22 offset:6304
    v_mfma_f32_16x16x32_bf16 v[144:147], v[52:55], v[248:251], v[144:147]
    ds_read_b64_tr_b16 v[66:67], v22 offset:9888
    v_mfma_f32_16x16x32_bf16 v[148:151], v[68:71], v[244:247], v[148:151]
    ds_read_b64_tr_b16 v[68:69], v22 offset:13472
    v_mfma_f32_16x16x32_bf16 v[148:151], v[52:55], v[252:255], v[148:151]
    ds_read_b64_tr_b16 v[70:71], v22 offset:17056
    s_waitcnt lgkmcnt(4)
    v_mfma_f32_16x16x32_bf16 v[152:155], v[56:59], v[240:243], v[152:155]
    ds_read_b64_tr_b16 v[52:53], v23 offset:57344
    v_mfma_f32_16x16x32_bf16 v[152:155], v[60:63], v[248:251], v[152:155]
    ds_read_b64_tr_b16 v[54:55], v23 offset:60928
    buffer_load_dwordx4 v[224:227], v15, s[36:39], s61 offen offset:0 sc1
    v_mfma_f32_16x16x32_bf16 v[156:159], v[56:59], v[244:247], v[156:159]
    ds_read_b64_tr_b16 v[56:57], v23 offset:64512
    v_mfma_f32_16x16x32_bf16 v[156:159], v[60:63], v[252:255], v[156:159]
    ds_read_b64_tr_b16 v[58:59], v24 offset:2560
    s_waitcnt lgkmcnt(4)
    v_mfma_f32_16x16x32_bf16 v[160:163], v[64:67], v[240:243], v[160:163]
    ds_read_b64_tr_b16 v[60:61], v24 offset:6144
    v_mfma_f32_16x16x32_bf16 v[160:163], v[68:71], v[248:251], v[160:163]
    ds_read_b64_tr_b16 v[62:63], v24 offset:9728
    v_mfma_f32_16x16x32_bf16 v[164:167], v[64:67], v[244:247], v[164:167]
    ds_read_b64_tr_b16 v[64:65], v24 offset:13312
    v_mfma_f32_16x16x32_bf16 v[164:167], v[68:71], v[252:255], v[164:167]
    ds_read_b64_tr_b16 v[66:67], v24 offset:16896
    buffer_load_dwordx4 v[228:231], v16, s[36:39], s61 offen offset:0 sc1
    s_waitcnt lgkmcnt(4)
    v_mfma_f32_16x16x32_bf16 v[168:171], v[52:55], v[240:243], v[168:171]
    s_waitcnt vmcnt(10)
    s_barrier
    ds_read_b64_tr_b16 v[68:69], v17 offset:0
    v_mfma_f32_16x16x32_bf16 v[168:171], v[56:59], v[248:251], v[168:171]
    ds_read_b64_tr_b16 v[70:71], v17 offset:3584
    s_setprio 3
    buffer_load_dwordx4 v[232:235], v15, s[36:39], s61 offen offset:1024 sc1
    v_mfma_f32_16x16x32_bf16 v[172:175], v[52:55], v[244:247], v[172:175]
    ds_read_b64_tr_b16 v[52:53], v17 offset:7168
    v_mfma_f32_16x16x32_bf16 v[172:175], v[56:59], v[252:255], v[172:175]
    ds_read_b64_tr_b16 v[54:55], v17 offset:10752
    s_waitcnt vmcnt(9)
    v_max3_u32 v12, v208, v209, v210
    v_max3_u32 v13, v211, v212, v213
    v_max3_u32 v12, v12, v214, v215
    v_max_u32 v12, v12, v13
    v_cmp_eq_u32 vcc, -1, v12
    s_cbranch_vccnz qa_kernel_F0_A6_R
qa_kernel_F0_A6_G:
    s_waitcnt lgkmcnt(4)
    v_mfma_f32_16x16x32_bf16 v[176:179], v[60:63], v[240:243], v[176:179]
    ds_read_b64_tr_b16 v[56:57], v17 offset:14336
    v_mfma_f32_16x16x32_bf16 v[176:179], v[64:67], v[248:251], v[176:179]
    ds_read_b64_tr_b16 v[58:59], v17 offset:17920
    s_waitcnt vmcnt(7)
    v_max3_u32 v12, v216, v217, v218
    v_max3_u32 v13, v219, v220, v221
    v_max3_u32 v12, v12, v222, v223
    v_max_u32 v12, v12, v13
    v_cmp_eq_u32 vcc, -1, v12
    s_cbranch_vccnz qa_kernel_F0_A7_R
qa_kernel_F0_A7_G:
    v_mfma_f32_16x16x32_bf16 v[180:183], v[60:63], v[244:247], v[180:183]
    ds_read_b64_tr_b16 v[60:61], v17 offset:21504
    v_mfma_f32_16x16x32_bf16 v[180:183], v[64:67], v[252:255], v[180:183]
    ds_read_b64_tr_b16 v[62:63], v17 offset:25088
    buffer_load_dwordx4 v[236:239], v16, s[36:39], s61 offen offset:1024 sc1
    s_waitcnt lgkmcnt(4)
    v_mfma_f32_16x16x32_bf16 v[72:75], v[68:71], v[208:211], v[72:75]
    ds_read_b64_tr_b16 v[64:65], v17 offset:32
    v_mfma_f32_16x16x32_bf16 v[72:75], v[52:55], v[216:219], v[72:75]
    ds_read_b64_tr_b16 v[66:67], v17 offset:3616
    v_mfma_f32_16x16x32_bf16 v[76:79], v[68:71], v[212:215], v[76:79]
    ds_read_b64_tr_b16 v[68:69], v17 offset:7200
    v_mfma_f32_16x16x32_bf16 v[76:79], v[52:55], v[220:223], v[76:79]
    ds_read_b64_tr_b16 v[70:71], v17 offset:10784
    s_waitcnt lgkmcnt(4)
    v_mfma_f32_16x16x32_bf16 v[80:83], v[56:59], v[208:211], v[80:83]
    ds_read_b64_tr_b16 v[52:53], v17 offset:14368
    v_mfma_f32_16x16x32_bf16 v[80:83], v[60:63], v[216:219], v[80:83]
    ds_read_b64_tr_b16 v[54:55], v17 offset:17952
    s_add_u32 m0, s60, 65536
    s_nop 0
    buffer_load_dwordx4 v8, s[32:35], s59 offen lds
    v_mfma_f32_16x16x32_bf16 v[84:87], v[56:59], v[212:215], v[84:87]
    ds_read_b64_tr_b16 v[56:57], v17 offset:21536
    v_mfma_f32_16x16x32_bf16 v[84:87], v[60:63], v[220:223], v[84:87]
    ds_read_b64_tr_b16 v[58:59], v17 offset:25120
    s_setprio 2
    s_waitcnt lgkmcnt(4)
    v_mfma_f32_16x16x32_bf16 v[88:91], v[64:67], v[208:211], v[88:91]
    ds_read_b64_tr_b16 v[60:61], v17 offset:64
    v_mfma_f32_16x16x32_bf16 v[88:91], v[68:71], v[216:219], v[88:91]
    ds_read_b64_tr_b16 v[62:63], v17 offset:3648
    v_mfma_f32_16x16x32_bf16 v[92:95], v[64:67], v[212:215], v[92:95]
    ds_read_b64_tr_b16 v[64:65], v17 offset:7232
    v_mfma_f32_16x16x32_bf16 v[92:95], v[68:71], v[220:223], v[92:95]
    ds_read_b64_tr_b16 v[66:67], v17 offset:10816
    s_add_u32 m0, s60, 66560
    s_nop 0
    buffer_load_dwordx4 v9, s[32:35], s59 offen lds
    s_waitcnt lgkmcnt(4)
    v_mfma_f32_16x16x32_bf16 v[96:99], v[52:55], v[208:211], v[96:99]
    ds_read_b64_tr_b16 v[68:69], v17 offset:14400
    v_mfma_f32_16x16x32_bf16 v[96:99], v[56:59], v[216:219], v[96:99]
    ds_read_b64_tr_b16 v[70:71], v17 offset:17984
    v_mfma_f32_16x16x32_bf16 v[100:103], v[52:55], v[212:215], v[100:103]
    ds_read_b64_tr_b16 v[52:53], v17 offset:21568
    v_mfma_f32_16x16x32_bf16 v[100:103], v[56:59], v[220:223], v[100:103]
    ds_read_b64_tr_b16 v[54:55], v17 offset:25152
    s_waitcnt lgkmcnt(4)
    v_mfma_f32_16x16x32_bf16 v[104:107], v[60:63], v[208:211], v[104:107]
    ds_read_b64_tr_b16 v[56:57], v17 offset:96
    v_mfma_f32_16x16x32_bf16 v[104:107], v[64:67], v[216:219], v[104:107]
    ds_read_b64_tr_b16 v[58:59], v17 offset:3680
    s_add_u32 m0, s60, 67584
    s_nop 0
    buffer_load_dwordx4 v10, s[32:35], s59 offen lds
    v_mfma_f32_16x16x32_bf16 v[108:111], v[60:63], v[212:215], v[108:111]
    ds_read_b64_tr_b16 v[60:61], v17 offset:7264
    v_mfma_f32_16x16x32_bf16 v[108:111], v[64:67], v[220:223], v[108:111]
    ds_read_b64_tr_b16 v[62:63], v17 offset:10848
    s_waitcnt lgkmcnt(4)
    v_mfma_f32_16x16x32_bf16 v[112:115], v[68:71], v[208:211], v[112:115]
    ds_read_b64_tr_b16 v[64:65], v17 offset:14432
    v_mfma_f32_16x16x32_bf16 v[112:115], v[52:55], v[216:219], v[112:115]
    ds_read_b64_tr_b16 v[66:67], v17 offset:18016
    s_setprio 1
    v_mfma_f32_16x16x32_bf16 v[116:119], v[68:71], v[212:215], v[116:119]
    ds_read_b64_tr_b16 v[68:69], v17 offset:21600
    v_mfma_f32_16x16x32_bf16 v[116:119], v[52:55], v[220:223], v[116:119]
    ds_read_b64_tr_b16 v[70:71], v17 offset:25184
    s_add_u32 m0, s60, 68608
    s_mov_b32 exec_hi, 0
    buffer_load_dwordx4 v11, s[32:35], s59 offen lds
    s_mov_b32 exec_hi, -1
    s_add_u32 s59, s59, 458752
    s_waitcnt lgkmcnt(4)
    v_mfma_f32_16x16x32_bf16 v[120:123], v[56:59], v[208:211], v[120:123]
    ds_read_b64_tr_b16 v[52:53], v17 offset:128
    v_mfma_f32_16x16x32_bf16 v[120:123], v[60:63], v[216:219], v[120:123]
    ds_read_b64_tr_b16 v[54:55], v17 offset:3712
    v_mfma_f32_16x16x32_bf16 v[124:127], v[56:59], v[212:215], v[124:127]
    ds_read_b64_tr_b16 v[56:57], v17 offset:7296
    v_mfma_f32_16x16x32_bf16 v[124:127], v[60:63], v[220:223], v[124:127]
    ds_read_b64_tr_b16 v[58:59], v17 offset:10880
    s_waitcnt lgkmcnt(4)
    v_mfma_f32_16x16x32_bf16 v[128:131], v[64:67], v[208:211], v[128:131]
    ds_read_b64_tr_b16 v[60:61], v17 offset:14464
    v_mfma_f32_16x16x32_bf16 v[128:131], v[68:71], v[216:219], v[128:131]
    ds_read_b64_tr_b16 v[62:63], v17 offset:18048
    buffer_load_dwordx4 v[240:243], v15, s[36:39], s61 offen offset:2048 sc1
    v_mfma_f32_16x16x32_bf16 v[132:135], v[64:67], v[212:215], v[132:135]
    ds_read_b64_tr_b16 v[64:65], v17 offset:21632
    v_mfma_f32_16x16x32_bf16 v[132:135], v[68:71], v[220:223], v[132:135]
    ds_read_b64_tr_b16 v[66:67], v17 offset:25216
    s_waitcnt lgkmcnt(4)
    v_mfma_f32_16x16x32_bf16 v[136:139], v[52:55], v[208:211], v[136:139]
    ds_read_b64_tr_b16 v[68:69], v17 offset:160
    v_mfma_f32_16x16x32_bf16 v[136:139], v[56:59], v[216:219], v[136:139]
    ds_read_b64_tr_b16 v[70:71], v17 offset:3744
    v_mfma_f32_16x16x32_bf16 v[140:143], v[52:55], v[212:215], v[140:143]
    ds_read_b64_tr_b16 v[52:53], v17 offset:7328
    v_mfma_f32_16x16x32_bf16 v[140:143], v[56:59], v[220:223], v[140:143]
    ds_read_b64_tr_b16 v[54:55], v17 offset:10912
    s_setprio 0
    buffer_load_dwordx4 v[244:247], v16, s[36:39], s61 offen offset:2048 sc1
    s_waitcnt lgkmcnt(4)
    v_mfma_f32_16x16x32_bf16 v[144:147], v[60:63], v[208:211], v[144:147]
    ds_read_b64_tr_b16 v[56:57], v17 offset:14496
    v_mfma_f32_16x16x32_bf16 v[144:147], v[64:67], v[216:219], v[144:147]
    ds_read_b64_tr_b16 v[58:59], v17 offset:18080
    v_mfma_f32_16x16x32_bf16 v[148:151], v[60:63], v[212:215], v[148:151]
    ds_read_b64_tr_b16 v[60:61], v17 offset:21664
    v_mfma_f32_16x16x32_bf16 v[148:151], v[64:67], v[220:223], v[148:151]
    ds_read_b64_tr_b16 v[62:63], v17 offset:25248
    s_waitcnt lgkmcnt(4)
    v_mfma_f32_16x16x32_bf16 v[152:155], v[68:71], v[208:211], v[152:155]
    ds_read_b64_tr_b16 v[64:65], v18 offset:0
    v_mfma_f32_16x16x32_bf16 v[152:155], v[52:55], v[216:219], v[152:155]
    ds_read_b64_tr_b16 v[66:67], v18 offset:3584
    buffer_load_dwordx4 v[248:251], v15, s[36:39], s61 offen offset:3072 sc1
    v_mfma_f32_16x16x32_bf16 v[156:159], v[68:71], v[212:215], v[156:159]
    ds_read_b64_tr_b16 v[68:69], v18 offset:7168
    v_mfma_f32_16x16x32_bf16 v[156:159], v[52:55], v[220:223], v[156:159]
    ds_read_b64_tr_b16 v[70:71], v18 offset:10752
    s_waitcnt lgkmcnt(4)
    v_mfma_f32_16x16x32_bf16 v[160:163], v[56:59], v[208:211], v[160:163]
    ds_read_b64_tr_b16 v[52:53], v18 offset:14336
    v_mfma_f32_16x16x32_bf16 v[160:163], v[60:63], v[216:219], v[160:163]
    ds_read_b64_tr_b16 v[54:55], v18 offset:17920
    v_mfma_f32_16x16x32_bf16 v[164:167], v[56:59], v[212:215], v[164:167]
    ds_read_b64_tr_b16 v[56:57], v18 offset:21504
    v_mfma_f32_16x16x32_bf16 v[164:167], v[60:63], v[220:223], v[164:167]
    ds_read_b64_tr_b16 v[58:59], v18 offset:25088
    buffer_load_dwordx4 v[252:255], v16, s[36:39], s61 offen offset:3072 sc1
    s_add_u32 s61, s61, 4096
    s_waitcnt lgkmcnt(4)
    v_mfma_f32_16x16x32_bf16 v[168:171], v[64:67], v[208:211], v[168:171]
    s_waitcnt vmcnt(12)
    s_barrier
    ds_read_b64_tr_b16 v[60:61], v17 offset:28672
    v_mfma_f32_16x16x32_bf16 v[168:171], v[68:71], v[216:219], v[168:171]
    ds_read_b64_tr_b16 v[62:63], v17 offset:32256
    s_setprio 3
    s_add_u32 m0, s60, 94208
    s_nop 0
    buffer_load_dwordx4 v8, s[32:35], s59 offen lds
    v_mfma_f32_16x16x32_bf16 v[172:175], v[64:67], v[212:215], v[172:175]
    ds_read_b64_tr_b16 v[64:65], v17 offset:35840
    v_mfma_f32_16x16x32_bf16 v[172:175], v[68:71], v[220:223], v[172:175]
    ds_read_b64_tr_b16 v[66:67], v17 offset:39424
    s_waitcnt vmcnt(11)
    v_max3_u32 v12, v224, v225, v226
    v_max3_u32 v13, v227, v228, v229
    v_max3_u32 v12, v12, v230, v231
    v_max_u32 v12, v12, v13
    v_cmp_eq_u32 vcc, -1, v12
    s_cbranch_vccnz qa_kernel_F0_A8_R
qa_kernel_F0_A8_G:
    s_waitcnt lgkmcnt(4)
    v_mfma_f32_16x16x32_bf16 v[176:179], v[52:55], v[208:211], v[176:179]
    ds_read_b64_tr_b16 v[68:69], v17 offset:43008
    v_mfma_f32_16x16x32_bf16 v[176:179], v[56:59], v[216:219], v[176:179]
    ds_read_b64_tr_b16 v[70:71], v17 offset:46592
    s_waitcnt vmcnt(9)
    v_max3_u32 v12, v232, v233, v234
    v_max3_u32 v13, v235, v236, v237
    v_max3_u32 v12, v12, v238, v239
    v_max_u32 v12, v12, v13
    v_cmp_eq_u32 vcc, -1, v12
    s_cbranch_vccnz qa_kernel_F0_A9_R
qa_kernel_F0_A9_G:
    v_mfma_f32_16x16x32_bf16 v[180:183], v[52:55], v[212:215], v[180:183]
    ds_read_b64_tr_b16 v[52:53], v17 offset:50176
    v_mfma_f32_16x16x32_bf16 v[180:183], v[56:59], v[220:223], v[180:183]
    ds_read_b64_tr_b16 v[54:55], v17 offset:53760
    s_add_u32 m0, s60, 95232
    s_nop 0
    buffer_load_dwordx4 v9, s[32:35], s59 offen lds
    s_waitcnt lgkmcnt(4)
    v_mfma_f32_16x16x32_bf16 v[72:75], v[60:63], v[224:227], v[72:75]
    ds_read_b64_tr_b16 v[56:57], v17 offset:28704
    v_mfma_f32_16x16x32_bf16 v[72:75], v[64:67], v[232:235], v[72:75]
    ds_read_b64_tr_b16 v[58:59], v17 offset:32288
    v_mfma_f32_16x16x32_bf16 v[76:79], v[60:63], v[228:231], v[76:79]
    ds_read_b64_tr_b16 v[60:61], v17 offset:35872
    v_mfma_f32_16x16x32_bf16 v[76:79], v[64:67], v[236:239], v[76:79]
    ds_read_b64_tr_b16 v[62:63], v17 offset:39456
    s_waitcnt lgkmcnt(4)
    v_mfma_f32_16x16x32_bf16 v[80:83], v[68:71], v[224:227], v[80:83]
    ds_read_b64_tr_b16 v[64:65], v17 offset:43040
    v_mfma_f32_16x16x32_bf16 v[80:83], v[52:55], v[232:235], v[80:83]
    ds_read_b64_tr_b16 v[66:67], v17 offset:46624
    s_add_u32 m0, s60, 96256
    s_nop 0
    buffer_load_dwordx4 v10, s[32:35], s59 offen lds
    v_mfma_f32_16x16x32_bf16 v[84:87], v[68:71], v[228:231], v[84:87]
    ds_read_b64_tr_b16 v[68:69], v17 offset:50208
    v_mfma_f32_16x16x32_bf16 v[84:87], v[52:55], v[236:239], v[84:87]
    ds_read_b64_tr_b16 v[70:71], v17 offset:53792
    s_setprio 2
    s_waitcnt lgkmcnt(4)
    v_mfma_f32_16x16x32_bf16 v[88:91], v[56:59], v[224:227], v[88:91]
    ds_read_b64_tr_b16 v[52:53], v17 offset:28736
    v_mfma_f32_16x16x32_bf16 v[88:91], v[60:63], v[232:235], v[88:91]
    ds_read_b64_tr_b16 v[54:55], v17 offset:32320
    v_mfma_f32_16x16x32_bf16 v[92:95], v[56:59], v[228:231], v[92:95]
    ds_read_b64_tr_b16 v[56:57], v17 offset:35904
    v_mfma_f32_16x16x32_bf16 v[92:95], v[60:63], v[236:239], v[92:95]
    ds_read_b64_tr_b16 v[58:59], v17 offset:39488
    s_add_u32 m0, s60, 97280
    s_mov_b32 exec_hi, 0
    buffer_load_dwordx4 v11, s[32:35], s59 offen lds
    s_mov_b32 exec_hi, -1
    s_add_u32 s59, s59, 458752
    s_waitcnt lgkmcnt(4)
    v_mfma_f32_16x16x32_bf16 v[96:99], v[64:67], v[224:227], v[96:99]
    ds_read_b64_tr_b16 v[60:61], v17 offset:43072
    v_mfma_f32_16x16x32_bf16 v[96:99], v[68:71], v[232:235], v[96:99]
    ds_read_b64_tr_b16 v[62:63], v17 offset:46656
    v_mfma_f32_16x16x32_bf16 v[100:103], v[64:67], v[228:231], v[100:103]
    ds_read_b64_tr_b16 v[64:65], v17 offset:50240
    v_mfma_f32_16x16x32_bf16 v[100:103], v[68:71], v[236:239], v[100:103]
    ds_read_b64_tr_b16 v[66:67], v17 offset:53824
    s_waitcnt lgkmcnt(4)
    v_mfma_f32_16x16x32_bf16 v[104:107], v[52:55], v[224:227], v[104:107]
    ds_read_b64_tr_b16 v[68:69], v17 offset:28768
    v_mfma_f32_16x16x32_bf16 v[104:107], v[56:59], v[232:235], v[104:107]
    ds_read_b64_tr_b16 v[70:71], v17 offset:32352
    buffer_load_dwordx4 v[208:211], v15, s[36:39], s61 offen offset:0 sc1
    v_mfma_f32_16x16x32_bf16 v[108:111], v[52:55], v[228:231], v[108:111]
    ds_read_b64_tr_b16 v[52:53], v17 offset:35936
    v_mfma_f32_16x16x32_bf16 v[108:111], v[56:59], v[236:239], v[108:111]
    ds_read_b64_tr_b16 v[54:55], v17 offset:39520
    s_waitcnt lgkmcnt(4)
    v_mfma_f32_16x16x32_bf16 v[112:115], v[60:63], v[224:227], v[112:115]
    ds_read_b64_tr_b16 v[56:57], v17 offset:43104
    v_mfma_f32_16x16x32_bf16 v[112:115], v[64:67], v[232:235], v[112:115]
    ds_read_b64_tr_b16 v[58:59], v17 offset:46688
    s_setprio 1
    v_mfma_f32_16x16x32_bf16 v[116:119], v[60:63], v[228:231], v[116:119]
    ds_read_b64_tr_b16 v[60:61], v17 offset:50272
    v_mfma_f32_16x16x32_bf16 v[116:119], v[64:67], v[236:239], v[116:119]
    ds_read_b64_tr_b16 v[62:63], v17 offset:53856
    buffer_load_dwordx4 v[212:215], v16, s[36:39], s61 offen offset:0 sc1
    s_waitcnt lgkmcnt(4)
    v_mfma_f32_16x16x32_bf16 v[120:123], v[68:71], v[224:227], v[120:123]
    ds_read_b64_tr_b16 v[64:65], v17 offset:28800
    v_mfma_f32_16x16x32_bf16 v[120:123], v[52:55], v[232:235], v[120:123]
    ds_read_b64_tr_b16 v[66:67], v17 offset:32384
    v_mfma_f32_16x16x32_bf16 v[124:127], v[68:71], v[228:231], v[124:127]
    ds_read_b64_tr_b16 v[68:69], v17 offset:35968
    v_mfma_f32_16x16x32_bf16 v[124:127], v[52:55], v[236:239], v[124:127]
    ds_read_b64_tr_b16 v[70:71], v17 offset:39552
    s_waitcnt lgkmcnt(4)
    v_mfma_f32_16x16x32_bf16 v[128:131], v[56:59], v[224:227], v[128:131]
    ds_read_b64_tr_b16 v[52:53], v17 offset:43136
    v_mfma_f32_16x16x32_bf16 v[128:131], v[60:63], v[232:235], v[128:131]
    ds_read_b64_tr_b16 v[54:55], v17 offset:46720
    buffer_load_dwordx4 v[216:219], v15, s[36:39], s61 offen offset:1024 sc1
    v_mfma_f32_16x16x32_bf16 v[132:135], v[56:59], v[228:231], v[132:135]
    ds_read_b64_tr_b16 v[56:57], v17 offset:50304
    v_mfma_f32_16x16x32_bf16 v[132:135], v[60:63], v[236:239], v[132:135]
    ds_read_b64_tr_b16 v[58:59], v17 offset:53888
    s_waitcnt lgkmcnt(4)
    v_mfma_f32_16x16x32_bf16 v[136:139], v[64:67], v[224:227], v[136:139]
    ds_read_b64_tr_b16 v[60:61], v17 offset:28832
    v_mfma_f32_16x16x32_bf16 v[136:139], v[68:71], v[232:235], v[136:139]
    ds_read_b64_tr_b16 v[62:63], v17 offset:32416
    v_mfma_f32_16x16x32_bf16 v[140:143], v[64:67], v[228:231], v[140:143]
    ds_read_b64_tr_b16 v[64:65], v17 offset:36000
    v_mfma_f32_16x16x32_bf16 v[140:143], v[68:71], v[236:239], v[140:143]
    ds_read_b64_tr_b16 v[66:67], v17 offset:39584
    s_setprio 0
    buffer_load_dwordx4 v[220:223], v16, s[36:39], s61 offen offset:1024 sc1
    s_waitcnt lgkmcnt(4)
    v_mfma_f32_16x16x32_bf16 v[144:147], v[52:55], v[224:227], v[144:147]
    ds_read_b64_tr_b16 v[68:69], v17 offset:43168
    v_mfma_f32_16x16x32_bf16 v[144:147], v[56:59], v[232:235], v[144:147]
    ds_read_b64_tr_b16 v[70:71], v17 offset:46752
    v_mfma_f32_16x16x32_bf16 v[148:151], v[52:55], v[228:231], v[148:151]
    ds_read_b64_tr_b16 v[52:53], v17 offset:50336
    v_mfma_f32_16x16x32_bf16 v[148:151], v[56:59], v[236:239], v[148:151]
    ds_read_b64_tr_b16 v[54:55], v17 offset:53920
    s_waitcnt lgkmcnt(4)
    v_mfma_f32_16x16x32_bf16 v[152:155], v[60:63], v[224:227], v[152:155]
    ds_read_b64_tr_b16 v[56:57], v18 offset:28672
    v_mfma_f32_16x16x32_bf16 v[152:155], v[64:67], v[232:235], v[152:155]
    ds_read_b64_tr_b16 v[58:59], v18 offset:32256
    s_add_u32 m0, s60, 122880
    s_nop 0
    buffer_load_dwordx4 v8, s[32:35], s59 offen lds
    v_mfma_f32_16x16x32_bf16 v[156:159], v[60:63], v[228:231], v[156:159]
    ds_read_b64_tr_b16 v[60:61], v18 offset:35840
    v_mfma_f32_16x16x32_bf16 v[156:159], v[64:67], v[236:239], v[156:159]
    ds_read_b64_tr_b16 v[62:63], v18 offset:39424
    s_waitcnt lgkmcnt(4)
    v_mfma_f32_16x16x32_bf16 v[160:163], v[68:71], v[224:227], v[160:163]
    ds_read_b64_tr_b16 v[64:65], v18 offset:43008
    v_mfma_f32_16x16x32_bf16 v[160:163], v[52:55], v[232:235], v[160:163]
    ds_read_b64_tr_b16 v[66:67], v18 offset:46592
    v_mfma_f32_16x16x32_bf16 v[164:167], v[68:71], v[228:231], v[164:167]
    ds_read_b64_tr_b16 v[68:69], v18 offset:50176
    v_mfma_f32_16x16x32_bf16 v[164:167], v[52:55], v[236:239], v[164:167]
    ds_read_b64_tr_b16 v[70:71], v18 offset:53760
    s_add_u32 m0, s60, 123904
    s_nop 0
    buffer_load_dwordx4 v9, s[32:35], s59 offen lds
    s_waitcnt lgkmcnt(4)
    v_mfma_f32_16x16x32_bf16 v[168:171], v[56:59], v[224:227], v[168:171]
    s_waitcnt vmcnt(14)
    s_barrier
    ds_read_b64_tr_b16 v[52:53], v21 offset:0
    v_mfma_f32_16x16x32_bf16 v[168:171], v[60:63], v[232:235], v[168:171]
    ds_read_b64_tr_b16 v[54:55], v21 offset:3584
    s_setprio 3
    s_add_u32 m0, s60, 124928
    s_nop 0
    buffer_load_dwordx4 v10, s[32:35], s59 offen lds
    v_mfma_f32_16x16x32_bf16 v[172:175], v[56:59], v[228:231], v[172:175]
    ds_read_b64_tr_b16 v[56:57], v21 offset:7168
    v_mfma_f32_16x16x32_bf16 v[172:175], v[60:63], v[236:239], v[172:175]
    ds_read_b64_tr_b16 v[58:59], v21 offset:10752
    s_waitcnt vmcnt(13)
    v_max3_u32 v12, v240, v241, v242
    v_max3_u32 v13, v243, v244, v245
    v_max3_u32 v12, v12, v246, v247
    v_max_u32 v12, v12, v13
    v_cmp_eq_u32 vcc, -1, v12
    s_cbranch_vccnz qa_kernel_F0_A10_R
qa_kernel_F0_A10_G:
    s_waitcnt lgkmcnt(4)
    v_mfma_f32_16x16x32_bf16 v[176:179], v[64:67], v[224:227], v[176:179]
    ds_read_b64_tr_b16 v[60:61], v21 offset:14336
    v_mfma_f32_16x16x32_bf16 v[176:179], v[68:71], v[232:235], v[176:179]
    ds_read_b64_tr_b16 v[62:63], v21 offset:17920
    s_waitcnt vmcnt(11)
    v_max3_u32 v12, v248, v249, v250
    v_max3_u32 v13, v251, v252, v253
    v_max3_u32 v12, v12, v254, v255
    v_max_u32 v12, v12, v13
    v_cmp_eq_u32 vcc, -1, v12
    s_cbranch_vccnz qa_kernel_F0_A11_R
qa_kernel_F0_A11_G:
    v_mfma_f32_16x16x32_bf16 v[180:183], v[64:67], v[228:231], v[180:183]
    ds_read_b64_tr_b16 v[64:65], v21 offset:21504
    v_mfma_f32_16x16x32_bf16 v[180:183], v[68:71], v[236:239], v[180:183]
    ds_read_b64_tr_b16 v[66:67], v21 offset:25088
    s_add_u32 m0, s60, 125952
    s_mov_b32 exec_hi, 0
    buffer_load_dwordx4 v11, s[32:35], s59 offen lds
    s_mov_b32 exec_hi, -1
    s_add_u32 s59, s59, 458752
    s_waitcnt lgkmcnt(4)
    v_mfma_f32_16x16x32_bf16 v[72:75], v[52:55], v[240:243], v[72:75]
    ds_read_b64_tr_b16 v[68:69], v21 offset:32
    v_mfma_f32_16x16x32_bf16 v[72:75], v[56:59], v[248:251], v[72:75]
    ds_read_b64_tr_b16 v[70:71], v21 offset:3616
    v_mfma_f32_16x16x32_bf16 v[76:79], v[52:55], v[244:247], v[76:79]
    ds_read_b64_tr_b16 v[52:53], v21 offset:7200
    v_mfma_f32_16x16x32_bf16 v[76:79], v[56:59], v[252:255], v[76:79]
    ds_read_b64_tr_b16 v[54:55], v21 offset:10784
    s_waitcnt lgkmcnt(4)
    v_mfma_f32_16x16x32_bf16 v[80:83], v[60:63], v[240:243], v[80:83]
    ds_read_b64_tr_b16 v[56:57], v21 offset:14368
    v_mfma_f32_16x16x32_bf16 v[80:83], v[64:67], v[248:251], v[80:83]
    ds_read_b64_tr_b16 v[58:59], v21 offset:17952
    buffer_load_dwordx4 v[224:227], v15, s[36:39], s61 offen offset:2048 sc1
    v_mfma_f32_16x16x32_bf16 v[84:87], v[60:63], v[244:247], v[84:87]
    ds_read_b64_tr_b16 v[60:61], v21 offset:21536
    v_mfma_f32_16x16x32_bf16 v[84:87], v[64:67], v[252:255], v[84:87]
    ds_read_b64_tr_b16 v[62:63], v21 offset:25120
    s_setprio 2
    s_waitcnt lgkmcnt(4)
    v_mfma_f32_16x16x32_bf16 v[88:91], v[68:71], v[240:243], v[88:91]
    ds_read_b64_tr_b16 v[64:65], v21 offset:64
    v_mfma_f32_16x16x32_bf16 v[88:91], v[52:55], v[248:251], v[88:91]
    ds_read_b64_tr_b16 v[66:67], v21 offset:3648
qa_kernel_WS1_2:
    s_cbranch_execz qa_kernel_WS1_10
    v_mfma_f32_16x16x32_bf16 v[92:95], v[68:71], v[244:247], v[92:95]
    ds_read_b64_tr_b16 v[68:69], v21 offset:7232
    v_mfma_f32_16x16x32_bf16 v[92:95], v[52:55], v[252:255], v[92:95]
    ds_read_b64_tr_b16 v[70:71], v21 offset:10816
    buffer_load_dwordx4 v[228:231], v16, s[36:39], s61 offen offset:2048 sc1
    s_waitcnt lgkmcnt(4)
    v_mfma_f32_16x16x32_bf16 v[96:99], v[56:59], v[240:243], v[96:99]
    ds_read_b64_tr_b16 v[52:53], v21 offset:14400
    v_mfma_f32_16x16x32_bf16 v[96:99], v[60:63], v[248:251], v[96:99]
    ds_read_b64_tr_b16 v[54:55], v21 offset:17984
    v_mfma_f32_16x16x32_bf16 v[100:103], v[56:59], v[244:247], v[100:103]
    ds_read_b64_tr_b16 v[56:57], v21 offset:21568
    v_mfma_f32_16x16x32_bf16 v[100:103], v[60:63], v[252:255], v[100:103]
    ds_read_b64_tr_b16 v[58:59], v21 offset:25152
    s_waitcnt lgkmcnt(4)
    v_mfma_f32_16x16x32_bf16 v[104:107], v[64:67], v[240:243], v[104:107]
    ds_read_b64_tr_b16 v[60:61], v21 offset:96
    v_mfma_f32_16x16x32_bf16 v[104:107], v[68:71], v[248:251], v[104:107]
    ds_read_b64_tr_b16 v[62:63], v21 offset:3680
    buffer_load_dwordx4 v[232:235], v15, s[36:39], s61 offen offset:3072 sc1
    v_mfma_f32_16x16x32_bf16 v[108:111], v[64:67], v[244:247], v[108:111]
    ds_read_b64_tr_b16 v[64:65], v21 offset:7264
    v_mfma_f32_16x16x32_bf16 v[108:111], v[68:71], v[252:255], v[108:111]
    ds_read_b64_tr_b16 v[66:67], v21 offset:10848
    s_waitcnt lgkmcnt(4)
    v_mfma_f32_16x16x32_bf16 v[112:115], v[52:55], v[240:243], v[112:115]
    ds_read_b64_tr_b16 v[68:69], v21 offset:14432
    v_mfma_f32_16x16x32_bf16 v[112:115], v[56:59], v[248:251], v[112:115]
    ds_read_b64_tr_b16 v[70:71], v21 offset:18016
    s_setprio 1
    v_mfma_f32_16x16x32_bf16 v[116:119], v[52:55], v[244:247], v[116:119]
    ds_read_b64_tr_b16 v[52:53], v21 offset:21600
    v_mfma_f32_16x16x32_bf16 v[116:119], v[56:59], v[252:255], v[116:119]
    ds_read_b64_tr_b16 v[54:55], v21 offset:25184
    buffer_load_dwordx4 v[236:239], v16, s[36:39], s61 offen offset:3072 sc1
    s_add_u32 s61, s61, 4096
    s_waitcnt lgkmcnt(4)
    v_mfma_f32_16x16x32_bf16 v[120:123], v[60:63], v[240:243], v[120:123]
    ds_read_b64_tr_b16 v[56:57], v21 offset:128
    v_mfma_f32_16x16x32_bf16 v[120:123], v[64:67], v[248:251], v[120:123]
    ds_read_b64_tr_b16 v[58:59], v21 offset:3712
    v_mfma_f32_16x16x32_bf16 v[124:127], v[60:63], v[244:247], v[124:127]
    ds_read_b64_tr_b16 v[60:61], v21 offset:7296
    v_mfma_f32_16x16x32_bf16 v[124:127], v[64:67], v[252:255], v[124:127]
    ds_read_b64_tr_b16 v[62:63], v21 offset:10880
    s_waitcnt lgkmcnt(4)
    v_mfma_f32_16x16x32_bf16 v[128:131], v[68:71], v[240:243], v[128:131]
    ds_read_b64_tr_b16 v[64:65], v21 offset:14464
    v_mfma_f32_16x16x32_bf16 v[128:131], v[52:55], v[248:251], v[128:131]
    ds_read_b64_tr_b16 v[66:67], v21 offset:18048
    s_add_u32 m0, s60, 0
    s_nop 0
    buffer_load_dwordx4 v8, s[32:35], s59 offen lds
    v_mfma_f32_16x16x32_bf16 v[132:135], v[68:71], v[244:247], v[132:135]
    ds_read_b64_tr_b16 v[68:69], v21 offset:21632
    v_mfma_f32_16x16x32_bf16 v[132:135], v[52:55], v[252:255], v[132:135]
    ds_read_b64_tr_b16 v[70:71], v21 offset:25216
    s_waitcnt lgkmcnt(4)
    v_mfma_f32_16x16x32_bf16 v[136:139], v[56:59], v[240:243], v[136:139]
    ds_read_b64_tr_b16 v[52:53], v21 offset:160
    v_mfma_f32_16x16x32_bf16 v[136:139], v[60:63], v[248:251], v[136:139]
    ds_read_b64_tr_b16 v[54:55], v21 offset:3744
    v_mfma_f32_16x16x32_bf16 v[140:143], v[56:59], v[244:247], v[140:143]
    ds_read_b64_tr_b16 v[56:57], v21 offset:7328
    v_mfma_f32_16x16x32_bf16 v[140:143], v[60:63], v[252:255], v[140:143]
    ds_read_b64_tr_b16 v[58:59], v21 offset:10912
    s_setprio 0
    s_add_u32 m0, s60, 1024
    s_nop 0
    buffer_load_dwordx4 v9, s[32:35], s59 offen lds
    s_waitcnt lgkmcnt(4)
    v_mfma_f32_16x16x32_bf16 v[144:147], v[64:67], v[240:243], v[144:147]
    ds_read_b64_tr_b16 v[60:61], v21 offset:14496
    v_mfma_f32_16x16x32_bf16 v[144:147], v[68:71], v[248:251], v[144:147]
    ds_read_b64_tr_b16 v[62:63], v21 offset:18080
    v_mfma_f32_16x16x32_bf16 v[148:151], v[64:67], v[244:247], v[148:151]
    ds_read_b64_tr_b16 v[64:65], v21 offset:21664
    v_mfma_f32_16x16x32_bf16 v[148:151], v[68:71], v[252:255], v[148:151]
    ds_read_b64_tr_b16 v[66:67], v21 offset:25248
    s_waitcnt lgkmcnt(4)
    v_mfma_f32_16x16x32_bf16 v[152:155], v[52:55], v[240:243], v[152:155]
    ds_read_b64_tr_b16 v[68:69], v23 offset:0
    v_mfma_f32_16x16x32_bf16 v[152:155], v[56:59], v[248:251], v[152:155]
    ds_read_b64_tr_b16 v[70:71], v23 offset:3584
    buffer_load_dwordx2 v[184:185], v25, s[36:39], s63 offen offset:0 sc1
    buffer_load_dwordx2 v[186:187], v25, s[36:39], s63 offen offset:128 sc1
    v_mfma_f32_16x16x32_bf16 v[156:159], v[52:55], v[244:247], v[156:159]
    ds_read_b64_tr_b16 v[52:53], v23 offset:7168
    v_mfma_f32_16x16x32_bf16 v[156:159], v[56:59], v[252:255], v[156:159]
    ds_read_b64_tr_b16 v[54:55], v23 offset:10752
    s_waitcnt lgkmcnt(4)
    v_mfma_f32_16x16x32_bf16 v[160:163], v[60:63], v[240:243], v[160:163]
    ds_read_b64_tr_b16 v[56:57], v23 offset:14336
    v_mfma_f32_16x16x32_bf16 v[160:163], v[64:67], v[248:251], v[160:163]
    ds_read_b64_tr_b16 v[58:59], v23 offset:17920
    v_mfma_f32_16x16x32_bf16 v[164:167], v[60:63], v[244:247], v[164:167]
    ds_read_b64_tr_b16 v[60:61], v23 offset:21504
    v_mfma_f32_16x16x32_bf16 v[164:167], v[64:67], v[252:255], v[164:167]
    ds_read_b64_tr_b16 v[62:63], v23 offset:25088
    buffer_load_dwordx2 v[188:189], v25, s[36:39], s63 offen offset:256 sc1
    buffer_load_dwordx2 v[190:191], v25, s[36:39], s63 offen offset:384 sc1
    s_waitcnt lgkmcnt(4)
    v_mfma_f32_16x16x32_bf16 v[168:171], v[68:71], v[240:243], v[168:171]
    s_waitcnt vmcnt(18)
    s_barrier
    ds_read_b64_tr_b16 v[64:65], v21 offset:28672
    v_mfma_f32_16x16x32_bf16 v[168:171], v[52:55], v[248:251], v[168:171]
    ds_read_b64_tr_b16 v[66:67], v21 offset:32256
    s_setprio 3
    buffer_load_dwordx2 v[192:193], v25, s[36:39], s63 offen offset:2048 sc1
    buffer_load_dwordx2 v[194:195], v25, s[36:39], s63 offen offset:2176 sc1
    v_mfma_f32_16x16x32_bf16 v[172:175], v[68:71], v[244:247], v[172:175]
    ds_read_b64_tr_b16 v[68:69], v21 offset:35840
    v_mfma_f32_16x16x32_bf16 v[172:175], v[52:55], v[252:255], v[172:175]
    ds_read_b64_tr_b16 v[70:71], v21 offset:39424
    s_waitcnt vmcnt(18)
    v_max3_u32 v12, v208, v209, v210
    v_max3_u32 v13, v211, v212, v213
    v_max3_u32 v12, v12, v214, v215
    v_max_u32 v12, v12, v13
    v_cmp_eq_u32 vcc, -1, v12
    s_cbranch_vccnz qa_kernel_F0_A12_R
qa_kernel_F0_A12_G:
    s_waitcnt lgkmcnt(4)
    v_mfma_f32_16x16x32_bf16 v[176:179], v[56:59], v[240:243], v[176:179]
    ds_read_b64_tr_b16 v[52:53], v21 offset:43008
    v_mfma_f32_16x16x32_bf16 v[176:179], v[60:63], v[248:251], v[176:179]
    ds_read_b64_tr_b16 v[54:55], v21 offset:46592
    s_waitcnt vmcnt(16)
    v_max3_u32 v12, v216, v217, v218
    v_max3_u32 v13, v219, v220, v221
    v_max3_u32 v12, v12, v222, v223
    v_max_u32 v12, v12, v13
    v_cmp_eq_u32 vcc, -1, v12
    s_cbranch_vccnz qa_kernel_F0_A13_R
qa_kernel_F0_A13_G:
    v_mfma_f32_16x16x32_bf16 v[180:183], v[56:59], v[244:247], v[180:183]
    ds_read_b64_tr_b16 v[56:57], v21 offset:50176
    v_mfma_f32_16x16x32_bf16 v[180:183], v[60:63], v[252:255], v[180:183]
    ds_read_b64_tr_b16 v[58:59], v21 offset:53760
    buffer_load_dwordx2 v[196:197], v25, s[36:39], s63 offen offset:2304 sc1
    buffer_load_dwordx2 v[198:199], v25, s[36:39], s63 offen offset:2432 sc1
    s_waitcnt lgkmcnt(4)
    v_mfma_f32_16x16x32_bf16 v[72:75], v[64:67], v[208:211], v[72:75]
    ds_read_b64_tr_b16 v[60:61], v21 offset:28704
    v_mfma_f32_16x16x32_bf16 v[72:75], v[68:71], v[216:219], v[72:75]
    ds_read_b64_tr_b16 v[62:63], v21 offset:32288
    v_mfma_f32_16x16x32_bf16 v[76:79], v[64:67], v[212:215], v[76:79]
    ds_read_b64_tr_b16 v[64:65], v21 offset:35872
    v_mfma_f32_16x16x32_bf16 v[76:79], v[68:71], v[220:223], v[76:79]
    ds_read_b64_tr_b16 v[66:67], v21 offset:39456
    s_waitcnt lgkmcnt(4)
    v_mfma_f32_16x16x32_bf16 v[80:83], v[52:55], v[208:211], v[80:83]
    ds_read_b64_tr_b16 v[68:69], v21 offset:43040
    v_mfma_f32_16x16x32_bf16 v[80:83], v[56:59], v[216:219], v[80:83]
    ds_read_b64_tr_b16 v[70:71], v21 offset:46624
    s_add_u32 m0, s60, 2048
    s_nop 0
    buffer_load_dwordx4 v10, s[32:35], s59 offen lds
    v_mfma_f32_16x16x32_bf16 v[84:87], v[52:55], v[212:215], v[84:87]
    ds_read_b64_tr_b16 v[52:53], v21 offset:50208
    v_mfma_f32_16x16x32_bf16 v[84:87], v[56:59], v[220:223], v[84:87]
    ds_read_b64_tr_b16 v[54:55], v21 offset:53792
    s_setprio 2
    s_waitcnt lgkmcnt(4)
    v_mfma_f32_16x16x32_bf16 v[88:91], v[60:63], v[208:211], v[88:91]
    ds_read_b64_tr_b16 v[56:57], v21 offset:28736
    v_mfma_f32_16x16x32_bf16 v[88:91], v[64:67], v[216:219], v[88:91]
    ds_read_b64_tr_b16 v[58:59], v21 offset:32320
    v_mfma_f32_16x16x32_bf16 v[92:95], v[60:63], v[212:215], v[92:95]
    ds_read_b64_tr_b16 v[60:61], v21 offset:35904
    v_mfma_f32_16x16x32_bf16 v[92:95], v[64:67], v[220:223], v[92:95]
    ds_read_b64_tr_b16 v[62:63], v21 offset:39488
    s_add_u32 m0, s60, 3072
    s_mov_b32 exec_hi, 0
    buffer_load_dwordx4 v11, s[32:35], s59 offen lds
    s_mov_b32 exec_hi, -1
    s_add_u32 s59, s59, 458752
    s_waitcnt lgkmcnt(4)
    v_mfma_f32_16x16x32_bf16 v[96:99], v[68:71], v[208:211], v[96:99]
    ds_read_b64_tr_b16 v[64:65], v21 offset:43072
    v_mfma_f32_16x16x32_bf16 v[96:99], v[52:55], v[216:219], v[96:99]
    ds_read_b64_tr_b16 v[66:67], v21 offset:46656
    v_mfma_f32_16x16x32_bf16 v[100:103], v[68:71], v[212:215], v[100:103]
    ds_read_b64_tr_b16 v[68:69], v21 offset:50240
    v_mfma_f32_16x16x32_bf16 v[100:103], v[52:55], v[220:223], v[100:103]
    ds_read_b64_tr_b16 v[70:71], v21 offset:53824
    s_waitcnt lgkmcnt(4)
    v_mfma_f32_16x16x32_bf16 v[104:107], v[56:59], v[208:211], v[104:107]
    ds_read_b64_tr_b16 v[52:53], v21 offset:28768
    v_mfma_f32_16x16x32_bf16 v[104:107], v[60:63], v[216:219], v[104:107]
    ds_read_b64_tr_b16 v[54:55], v21 offset:32352
    buffer_load_dwordx4 v[240:243], v15, s[36:39], s61 offen offset:0 sc1
    v_mfma_f32_16x16x32_bf16 v[108:111], v[56:59], v[212:215], v[108:111]
    ds_read_b64_tr_b16 v[56:57], v21 offset:35936
    v_mfma_f32_16x16x32_bf16 v[108:111], v[60:63], v[220:223], v[108:111]
    ds_read_b64_tr_b16 v[58:59], v21 offset:39520
    s_waitcnt lgkmcnt(4)
    v_mfma_f32_16x16x32_bf16 v[112:115], v[64:67], v[208:211], v[112:115]
    ds_read_b64_tr_b16 v[60:61], v21 offset:43104
    v_mfma_f32_16x16x32_bf16 v[112:115], v[68:71], v[216:219], v[112:115]
    ds_read_b64_tr_b16 v[62:63], v21 offset:46688
    s_setprio 1
    v_mfma_f32_16x16x32_bf16 v[116:119], v[64:67], v[212:215], v[116:119]
    ds_read_b64_tr_b16 v[64:65], v21 offset:50272
    v_mfma_f32_16x16x32_bf16 v[116:119], v[68:71], v[220:223], v[116:119]
    ds_read_b64_tr_b16 v[66:67], v21 offset:53856
    buffer_load_dwordx4 v[244:247], v16, s[36:39], s61 offen offset:0 sc1
    s_waitcnt lgkmcnt(4)
    v_mfma_f32_16x16x32_bf16 v[120:123], v[52:55], v[208:211], v[120:123]
    ds_read_b64_tr_b16 v[68:69], v21 offset:28800
    v_mfma_f32_16x16x32_bf16 v[120:123], v[56:59], v[216:219], v[120:123]
    ds_read_b64_tr_b16 v[70:71], v21 offset:32384
    v_mfma_f32_16x16x32_bf16 v[124:127], v[52:55], v[212:215], v[124:127]
    ds_read_b64_tr_b16 v[52:53], v21 offset:35968
    v_mfma_f32_16x16x32_bf16 v[124:127], v[56:59], v[220:223], v[124:127]
    ds_read_b64_tr_b16 v[54:55], v21 offset:39552
    s_waitcnt lgkmcnt(4)
    v_mfma_f32_16x16x32_bf16 v[128:131], v[60:63], v[208:211], v[128:131]
    ds_read_b64_tr_b16 v[56:57], v21 offset:43136
    v_mfma_f32_16x16x32_bf16 v[128:131], v[64:67], v[216:219], v[128:131]
    ds_read_b64_tr_b16 v[58:59], v21 offset:46720
    buffer_load_dwordx4 v[248:251], v15, s[36:39], s61 offen offset:1024 sc1
    v_mfma_f32_16x16x32_bf16 v[132:135], v[60:63], v[212:215], v[132:135]
    ds_read_b64_tr_b16 v[60:61], v21 offset:50304
    v_mfma_f32_16x16x32_bf16 v[132:135], v[64:67], v[220:223], v[132:135]
    ds_read_b64_tr_b16 v[62:63], v21 offset:53888
    s_waitcnt lgkmcnt(4)
    v_mfma_f32_16x16x32_bf16 v[136:139], v[68:71], v[208:211], v[136:139]
    ds_read_b64_tr_b16 v[64:65], v21 offset:28832
    v_mfma_f32_16x16x32_bf16 v[136:139], v[52:55], v[216:219], v[136:139]
    ds_read_b64_tr_b16 v[66:67], v21 offset:32416
    v_mfma_f32_16x16x32_bf16 v[140:143], v[68:71], v[212:215], v[140:143]
    ds_read_b64_tr_b16 v[68:69], v21 offset:36000
    v_mfma_f32_16x16x32_bf16 v[140:143], v[52:55], v[220:223], v[140:143]
    ds_read_b64_tr_b16 v[70:71], v21 offset:39584
    s_setprio 0
    buffer_load_dwordx4 v[252:255], v16, s[36:39], s61 offen offset:1024 sc1
    s_waitcnt lgkmcnt(4)
    v_mfma_f32_16x16x32_bf16 v[144:147], v[56:59], v[208:211], v[144:147]
    ds_read_b64_tr_b16 v[52:53], v21 offset:43168
    v_mfma_f32_16x16x32_bf16 v[144:147], v[60:63], v[216:219], v[144:147]
    ds_read_b64_tr_b16 v[54:55], v21 offset:46752
    v_mfma_f32_16x16x32_bf16 v[148:151], v[56:59], v[212:215], v[148:151]
    ds_read_b64_tr_b16 v[56:57], v21 offset:50336
    v_mfma_f32_16x16x32_bf16 v[148:151], v[60:63], v[220:223], v[148:151]
    ds_read_b64_tr_b16 v[58:59], v21 offset:53920
    s_waitcnt lgkmcnt(4)
    v_mfma_f32_16x16x32_bf16 v[152:155], v[64:67], v[208:211], v[152:155]
    ds_read_b64_tr_b16 v[60:61], v23 offset:28672
    v_mfma_f32_16x16x32_bf16 v[152:155], v[68:71], v[216:219], v[152:155]
    ds_read_b64_tr_b16 v[62:63], v23 offset:32256
    s_add_u32 m0, s60, 28672
    s_nop 0
    buffer_load_dwordx4 v8, s[32:35], s59 offen lds
    v_mfma_f32_16x16x32_bf16 v[156:159], v[64:67], v[212:215], v[156:159]
    ds_read_b64_tr_b16 v[64:65], v23 offset:35840
    v_mfma_f32_16x16x32_bf16 v[156:159], v[68:71], v[220:223], v[156:159]
    ds_read_b64_tr_b16 v[66:67], v23 offset:39424
    s_waitcnt lgkmcnt(4)
    v_mfma_f32_16x16x32_bf16 v[160:163], v[52:55], v[208:211], v[160:163]
    ds_read_b64_tr_b16 v[68:69], v23 offset:43008
    v_mfma_f32_16x16x32_bf16 v[160:163], v[56:59], v[216:219], v[160:163]
    ds_read_b64_tr_b16 v[70:71], v23 offset:46592
    v_mfma_f32_16x16x32_bf16 v[164:167], v[52:55], v[212:215], v[164:167]
    ds_read_b64_tr_b16 v[52:53], v23 offset:50176
    v_mfma_f32_16x16x32_bf16 v[164:167], v[56:59], v[220:223], v[164:167]
    ds_read_b64_tr_b16 v[54:55], v23 offset:53760
    s_add_u32 m0, s60, 29696
    s_nop 0
    buffer_load_dwordx4 v9, s[32:35], s59 offen lds
    s_waitcnt lgkmcnt(4)
    v_mfma_f32_16x16x32_bf16 v[168:171], v[60:63], v[208:211], v[168:171]
    s_waitcnt vmcnt(22)
    s_barrier
    ds_read_b64_tr_b16 v[56:57], v21 offset:57344
    v_mfma_f32_16x16x32_bf16 v[168:171], v[64:67], v[216:219], v[168:171]
    ds_read_b64_tr_b16 v[58:59], v21 offset:60928
    s_setprio 3
    s_add_u32 m0, s60, 30720
    s_nop 0
    buffer_load_dwordx4 v10, s[32:35], s59 offen lds
    v_mfma_f32_16x16x32_bf16 v[172:175], v[60:63], v[212:215], v[172:175]
    ds_read_b64_tr_b16 v[60:61], v21 offset:64512
    v_mfma_f32_16x16x32_bf16 v[172:175], v[64:67], v[220:223], v[172:175]
    ds_read_b64_tr_b16 v[62:63], v22 offset:2560
    s_waitcnt vmcnt(21)
    v_max3_u32 v12, v224, v225, v226
    v_max3_u32 v13, v227, v228, v229
    v_max3_u32 v12, v12, v230, v231
    v_max_u32 v12, v12, v13
    v_cmp_eq_u32 vcc, -1, v12
    s_cbranch_vccnz qa_kernel_F0_A14_R
qa_kernel_F0_A14_G:
    s_waitcnt lgkmcnt(4)
    v_mfma_f32_16x16x32_bf16 v[176:179], v[68:71], v[208:211], v[176:179]
    ds_read_b64_tr_b16 v[64:65], v22 offset:6144
    v_mfma_f32_16x16x32_bf16 v[176:179], v[52:55], v[216:219], v[176:179]
    ds_read_b64_tr_b16 v[66:67], v22 offset:9728
    s_waitcnt vmcnt(19)
    v_max3_u32 v12, v232, v233, v234
    v_max3_u32 v13, v235, v236, v237
    v_max3_u32 v12, v12, v238, v239
    v_max_u32 v12, v12, v13
    v_cmp_eq_u32 vcc, -1, v12
    s_cbranch_vccnz qa_kernel_F0_A15_R
qa_kernel_F0_A15_G:
    v_mfma_f32_16x16x32_bf16 v[180:183], v[68:71], v[212:215], v[180:183]
    ds_read_b64_tr_b16 v[68:69], v22 offset:13312
    v_mfma_f32_16x16x32_bf16 v[180:183], v[52:55], v[220:223], v[180:183]
    ds_read_b64_tr_b16 v[70:71], v22 offset:16896
    s_add_u32 m0, s60, 31744
    s_mov_b32 exec_hi, 0
    buffer_load_dwordx4 v11, s[32:35], s59 offen lds
    s_mov_b32 exec_hi, -1
    s_add_u32 s59, s59, 458752
    s_waitcnt lgkmcnt(4)
    v_mfma_f32_16x16x32_bf16 v[72:75], v[56:59], v[224:227], v[72:75]
    ds_read_b64_tr_b16 v[52:53], v21 offset:57376
    v_mfma_f32_16x16x32_bf16 v[72:75], v[60:63], v[232:235], v[72:75]
    ds_read_b64_tr_b16 v[54:55], v21 offset:60960
    v_mfma_f32_16x16x32_bf16 v[76:79], v[56:59], v[228:231], v[76:79]
    ds_read_b64_tr_b16 v[56:57], v21 offset:64544
    v_mfma_f32_16x16x32_bf16 v[76:79], v[60:63], v[236:239], v[76:79]
    ds_read_b64_tr_b16 v[58:59], v22 offset:2592
    s_waitcnt lgkmcnt(4)
    v_mfma_f32_16x16x32_bf16 v[80:83], v[64:67], v[224:227], v[80:83]
    ds_read_b64_tr_b16 v[60:61], v22 offset:6176
    v_mfma_f32_16x16x32_bf16 v[80:83], v[68:71], v[232:235], v[80:83]
    ds_read_b64_tr_b16 v[62:63], v22 offset:9760
    buffer_load_dwordx4 v[208:211], v15, s[36:39], s61 offen offset:2048 sc1
    v_mfma_f32_16x16x32_bf16 v[84:87], v[64:67], v[228:231], v[84:87]
    ds_read_b64_tr_b16 v[64:65], v22 offset:13344
    v_mfma_f32_16x16x32_bf16 v[84:87], v[68:71], v[236:239], v[84:87]
    ds_read_b64_tr_b16 v[66:67], v22 offset:16928
    s_setprio 2
    s_waitcnt lgkmcnt(4)
    v_mfma_f32_16x16x32_bf16 v[88:91], v[52:55], v[224:227], v[88:91]
    ds_read_b64_tr_b16 v[68:69], v21 offset:57408
    v_mfma_f32_16x16x32_bf16 v[88:91], v[56:59], v[232:235], v[88:91]
    ds_read_b64_tr_b16 v[70:71], v21 offset:60992
    v_mfma_f32_16x16x32_bf16 v[92:95], v[52:55], v[228:231], v[92:95]
    ds_read_b64_tr_b16 v[52:53], v21 offset:64576
    v_mfma_f32_16x16x32_bf16 v[92:95], v[56:59], v[236:239], v[92:95]
    ds_read_b64_tr_b16 v[54:55], v22 offset:2624
    buffer_load_dwordx4 v[212:215], v16, s[36:39], s61 offen offset:2048 sc1
    s_waitcnt lgkmcnt(4)
    v_mfma_f32_16x16x32_bf16 v[96:99], v[60:63], v[224:227], v[96:99]
    ds_read_b64_tr_b16 v[56:57], v22 offset:6208
    v_mfma_f32_16x16x32_bf16 v[96:99], v[64:67], v[232:235], v[96:99]
    ds_read_b64_tr_b16 v[58:59], v22 offset:9792
    v_mfma_f32_16x16x32_bf16 v[100:103], v[60:63], v[228:231], v[100:103]
    ds_read_b64_tr_b16 v[60:61], v22 offset:13376
    v_mfma_f32_16x16x32_bf16 v[100:103], v[64:67], v[236:239], v[100:103]
    ds_read_b64_tr_b16 v[62:63], v22 offset:16960
    s_waitcnt lgkmcnt(4)
    v_mfma_f32_16x16x32_bf16 v[104:107], v[68:71], v[224:227], v[104:107]
    ds_read_b64_tr_b16 v[64:65], v21 offset:57440
    v_mfma_f32_16x16x32_bf16 v[104:107], v[52:55], v[232:235], v[104:107]
    ds_read_b64_tr_b16 v[66:67], v21 offset:61024
    buffer_load_dwordx4 v[216:219], v15, s[36:39], s61 offen offset:3072 sc1
    v_mfma_f32_16x16x32_bf16 v[108:111], v[68:71], v[228:231], v[108:111]
    ds_read_b64_tr_b16 v[68:69], v21 offset:64608
    v_mfma_f32_16x16x32_bf16 v[108:111], v[52:55], v[236:239], v[108:111]
    ds_read_b64_tr_b16 v[70:71], v22 offset:2656
    s_waitcnt lgkmcnt(4)
    v_mfma_f32_16x16x32_bf16 v[112:115], v[56:59], v[224:227], v[112:115]
    ds_read_b64_tr_b16 v[52:53], v22 offset:6240
    v_mfma_f32_16x16x32_bf16 v[112:115], v[60:63], v[232:235], v[112:115]
    ds_read_b64_tr_b16 v[54:55], v22 offset:9824
    s_setprio 1
    v_mfma_f32_16x16x32_bf16 v[116:119], v[56:59], v[228:231], v[116:119]
    ds_read_b64_tr_b16 v[56:57], v22 offset:13408
    v_mfma_f32_16x16x32_bf16 v[116:119], v[60:63], v[236:239], v[116:119]
    ds_read_b64_tr_b16 v[58:59], v22 offset:16992
    buffer_load_dwordx4 v[220:223], v16, s[36:39], s61 offen offset:3072 sc1
    s_add_u32 s61, s61, 4096
    s_waitcnt lgkmcnt(4)
    v_mfma_f32_16x16x32_bf16 v[120:123], v[64:67], v[224:227], v[120:123]
    ds_read_b64_tr_b16 v[60:61], v21 offset:57472
    v_mfma_f32_16x16x32_bf16 v[120:123], v[68:71], v[232:235], v[120:123]
    ds_read_b64_tr_b16 v[62:63], v21 offset:61056
    v_mfma_f32_16x16x32_bf16 v[124:127], v[64:67], v[228:231], v[124:127]
    ds_read_b64_tr_b16 v[64:65], v21 offset:64640
    v_mfma_f32_16x16x32_bf16 v[124:127], v[68:71], v[236:239], v[124:127]
    ds_read_b64_tr_b16 v[66:67], v22 offset:2688
    s_waitcnt lgkmcnt(4)
    v_mfma_f32_16x16x32_bf16 v[128:131], v[52:55], v[224:227], v[128:131]
    ds_read_b64_tr_b16 v[68:69], v22 offset:6272
    v_mfma_f32_16x16x32_bf16 v[128:131], v[56:59], v[232:235], v[128:131]
    ds_read_b64_tr_b16 v[70:71], v22 offset:9856
    s_add_u32 m0, s60, 65536
    s_nop 0
    buffer_load_dwordx4 v8, s[32:35], s59 offen lds
    s_waitcnt vmcnt(15)
    v_max3_u32 v12, v184, v185, v186
    v_max3_u32 v13, v187, v188, v189
    v_max3_u32 v12, v12, v190, v191
    v_max3_u32 v13, v13, v192, v193
    v_max3_u32 v12, v12, v194, v195
    v_max3_u32 v13, v13, v196, v197
    v_max3_u32 v12, v12, v198, v199
    v_max_u32 v12, v12, v13
    v_cmp_eq_u32 vcc, -1, v12
    s_cbranch_vccnz qa_kernel_ST0_R
qa_kernel_ST0_G:
    v_add_f32 v184, v184, v186
    v_mfma_f32_16x16x32_bf16 v[132:135], v[52:55], v[228:231], v[132:135]
    ds_read_b64_tr_b16 v[52:53], v22 offset:13440
    v_mfma_f32_16x16x32_bf16 v[132:135], v[56:59], v[236:239], v[132:135]
    ds_read_b64_tr_b16 v[54:55], v22 offset:17024
    v_add_f32 v185, v185, v187
    v_add_f32 v188, v188, v190
    s_waitcnt lgkmcnt(4)
    v_mfma_f32_16x16x32_bf16 v[136:139], v[60:63], v[224:227], v[136:139]
    ds_read_b64_tr_b16 v[56:57], v21 offset:57504
    v_mfma_f32_16x16x32_bf16 v[136:139], v[64:67], v[232:235], v[136:139]
    ds_read_b64_tr_b16 v[58:59], v21 offset:61088
    v_add_f32 v189, v189, v191
    v_add_f32 v184, v184, v188
    v_mfma_f32_16x16x32_bf16 v[140:143], v[60:63], v[228:231], v[140:143]
    ds_read_b64_tr_b16 v[60:61], v21 offset:64672
    v_mfma_f32_16x16x32_bf16 v[140:143], v[64:67], v[236:239], v[140:143]
    ds_read_b64_tr_b16 v[62:63], v22 offset:2720
    s_setprio 0
    s_add_u32 m0, s60, 66560
    s_nop 0
    buffer_load_dwordx4 v9, s[32:35], s59 offen lds
    v_add_f32 v185, v185, v189
    v_add_f32 v192, v192, v194
    s_waitcnt lgkmcnt(4)
    v_mfma_f32_16x16x32_bf16 v[144:147], v[68:71], v[224:227], v[144:147]
    ds_read_b64_tr_b16 v[64:65], v22 offset:6304
    v_mfma_f32_16x16x32_bf16 v[144:147], v[52:55], v[232:235], v[144:147]
    ds_read_b64_tr_b16 v[66:67], v22 offset:9888
    v_add_f32 v193, v193, v195
    v_add_f32 v196, v196, v198
    v_mfma_f32_16x16x32_bf16 v[148:151], v[68:71], v[228:231], v[148:151]
    ds_read_b64_tr_b16 v[68:69], v22 offset:13472
    v_mfma_f32_16x16x32_bf16 v[148:151], v[52:55], v[236:239], v[148:151]
    ds_read_b64_tr_b16 v[70:71], v22 offset:17056
    v_add_f32 v197, v197, v199
    v_add_f32 v192, v192, v196
    s_waitcnt lgkmcnt(4)
    v_mfma_f32_16x16x32_bf16 v[152:155], v[56:59], v[224:227], v[152:155]
    ds_read_b64_tr_b16 v[52:53], v23 offset:57344
    v_mfma_f32_16x16x32_bf16 v[152:155], v[60:63], v[232:235], v[152:155]
    ds_read_b64_tr_b16 v[54:55], v23 offset:60928
    s_add_u32 m0, s60, 67584
    s_nop 0
    buffer_load_dwordx4 v10, s[32:35], s59 offen lds
    v_add_f32 v193, v193, v197
    v_mov_b32 v186, v184
    v_mfma_f32_16x16x32_bf16 v[156:159], v[56:59], v[228:231], v[156:159]
    ds_read_b64_tr_b16 v[56:57], v23 offset:64512
    v_mfma_f32_16x16x32_bf16 v[156:159], v[60:63], v[236:239], v[156:159]
    ds_read_b64_tr_b16 v[58:59], v24 offset:2560
    v_mov_b32 v187, v185
    v_mov_b32 v194, v192
    s_waitcnt lgkmcnt(4)
    v_mfma_f32_16x16x32_bf16 v[160:163], v[64:67], v[224:227], v[160:163]
    ds_read_b64_tr_b16 v[60:61], v24 offset:6144
    v_mfma_f32_16x16x32_bf16 v[160:163], v[68:71], v[232:235], v[160:163]
    ds_read_b64_tr_b16 v[62:63], v24 offset:9728
    v_mov_b32 v195, v193
    v_permlane16_swap_b32 v184, v186
    v_mfma_f32_16x16x32_bf16 v[164:167], v[64:67], v[228:231], v[164:167]
    ds_read_b64_tr_b16 v[64:65], v24 offset:13312
    v_mfma_f32_16x16x32_bf16 v[164:167], v[68:71], v[236:239], v[164:167]
    ds_read_b64_tr_b16 v[66:67], v24 offset:16896
    s_add_u32 m0, s60, 68608
    s_mov_b32 exec_hi, 0
    buffer_load_dwordx4 v11, s[32:35], s59 offen lds
    s_mov_b32 exec_hi, -1
    s_add_u32 s59, s59, 458752
    v_permlane16_swap_b32 v185, v187
    v_permlane16_swap_b32 v192, v194
    s_waitcnt lgkmcnt(4)
    v_mfma_f32_16x16x32_bf16 v[168:171], v[52:55], v[224:227], v[168:171]
    s_waitcnt vmcnt(16)
    s_barrier
    ds_read_b64_tr_b16 v[68:69], v17 offset:0
    v_mfma_f32_16x16x32_bf16 v[168:171], v[56:59], v[232:235], v[168:171]
    ds_read_b64_tr_b16 v[70:71], v17 offset:3584
    s_setprio 3
    s_add_u32 m0, s60, 94208
    s_nop 0
    buffer_load_dwordx4 v8, s[32:35], s59 offen lds
    v_permlane16_swap_b32 v193, v195
    v_add_f32 v184, v184, v186
    v_mfma_f32_16x16x32_bf16 v[172:175], v[52:55], v[228:231], v[172:175]
    ds_read_b64_tr_b16 v[52:53], v17 offset:7168
    v_mfma_f32_16x16x32_bf16 v[172:175], v[56:59], v[236:239], v[172:175]
    ds_read_b64_tr_b16 v[54:55], v17 offset:10752
    s_waitcnt vmcnt(15)
    v_max3_u32 v12, v240, v241, v242
    v_max3_u32 v13, v243, v244, v245
    v_max3_u32 v12, v12, v246, v247
    v_max_u32 v12, v12, v13
    v_cmp_eq_u32 vcc, -1, v12
    s_cbranch_vccnz qa_kernel_F0_A16_R
qa_kernel_F0_A16_G:
    v_add_f32 v185, v185, v187
    v_add_f32 v192, v192, v194
    s_waitcnt lgkmcnt(4)
    v_mfma_f32_16x16x32_bf16 v[176:179], v[60:63], v[224:227], v[176:179]
    ds_read_b64_tr_b16 v[56:57], v17 offset:14336
    v_mfma_f32_16x16x32_bf16 v[176:179], v[64:67], v[232:235], v[176:179]
    ds_read_b64_tr_b16 v[58:59], v17 offset:17920
    s_waitcnt vmcnt(13)
    v_max3_u32 v12, v248, v249, v250
    v_max3_u32 v13, v251, v252, v253
    v_max3_u32 v12, v12, v254, v255
    v_max_u32 v12, v12, v13
    v_cmp_eq_u32 vcc, -1, v12
    s_cbranch_vccnz qa_kernel_F0_A17_R
qa_kernel_F0_A17_G:
    v_add_f32 v193, v193, v195
    v_mov_b32 v186, v184
    v_mfma_f32_16x16x32_bf16 v[180:183], v[60:63], v[228:231], v[180:183]
    ds_read_b64_tr_b16 v[60:61], v17 offset:21504
    v_mfma_f32_16x16x32_bf16 v[180:183], v[64:67], v[236:239], v[180:183]
    ds_read_b64_tr_b16 v[62:63], v17 offset:25088
    buffer_load_dwordx4 v[224:227], v15, s[36:39], s61 offen offset:0 sc1
    v_mov_b32 v187, v185
    v_mov_b32 v194, v192
    s_waitcnt lgkmcnt(4)
    v_mfma_f32_16x16x32_bf16 v[72:75], v[68:71], v[240:243], v[72:75]
    ds_read_b64_tr_b16 v[64:65], v17 offset:32
    v_mfma_f32_16x16x32_bf16 v[72:75], v[52:55], v[248:251], v[72:75]
    ds_read_b64_tr_b16 v[66:67], v17 offset:3616
    v_mov_b32 v195, v193
    v_permlane32_swap_b32 v184, v186
    v_mfma_f32_16x16x32_bf16 v[76:79], v[68:71], v[244:247], v[76:79]
    ds_read_b64_tr_b16 v[68:69], v17 offset:7200
    v_mfma_f32_16x16x32_bf16 v[76:79], v[52:55], v[252:255], v[76:79]
    ds_read_b64_tr_b16 v[70:71], v17 offset:10784
    v_permlane32_swap_b32 v185, v187
    v_permlane32_swap_b32 v192, v194
    s_waitcnt lgkmcnt(4)
    v_mfma_f32_16x16x32_bf16 v[80:83], v[56:59], v[240:243], v[80:83]
    ds_read_b64_tr_b16 v[52:53], v17 offset:14368
    v_mfma_f32_16x16x32_bf16 v[80:83], v[60:63], v[248:251], v[80:83]
    ds_read_b64_tr_b16 v[54:55], v17 offset:17952
    buffer_load_dwordx4 v[228:231], v16, s[36:39], s61 offen offset:0 sc1
    v_permlane32_swap_b32 v193, v195
    v_add_f32 v184, v184, v186
    v_mfma_f32_16x16x32_bf16 v[84:87], v[56:59], v[244:247], v[84:87]
    ds_read_b64_tr_b16 v[56:57], v17 offset:21536
    v_mfma_f32_16x16x32_bf16 v[84:87], v[60:63], v[252:255], v[84:87]
    ds_read_b64_tr_b16 v[58:59], v17 offset:25120
    s_setprio 2
    v_add_f32 v185, v185, v187
    v_add_f32 v192, v192, v194
    s_waitcnt lgkmcnt(4)
    v_mfma_f32_16x16x32_bf16 v[88:91], v[64:67], v[240:243], v[88:91]
    ds_read_b64_tr_b16 v[60:61], v17 offset:64
    v_mfma_f32_16x16x32_bf16 v[88:91], v[68:71], v[248:251], v[88:91]
    ds_read_b64_tr_b16 v[62:63], v17 offset:3648
    v_add_f32 v193, v193, v195
    v_mul_f32 v30, 0xba800000, v184
    v_mfma_f32_16x16x32_bf16 v[92:95], v[64:67], v[244:247], v[92:95]
    ds_read_b64_tr_b16 v[64:65], v17 offset:7232
    v_mfma_f32_16x16x32_bf16 v[92:95], v[68:71], v[252:255], v[92:95]
    ds_read_b64_tr_b16 v[66:67], v17 offset:10816
    buffer_load_dwordx4 v[232:235], v15, s[36:39], s61 offen offset:1024 sc1
    v_mul_f32 v32, 0x3a800000, v185
    v_mul_f32 v31, 0xba800000, v192
    s_waitcnt lgkmcnt(4)
    v_mfma_f32_16x16x32_bf16 v[96:99], v[52:55], v[240:243], v[96:99]
    ds_read_b64_tr_b16 v[68:69], v17 offset:14400
    v_mfma_f32_16x16x32_bf16 v[96:99], v[56:59], v[248:251], v[96:99]
    ds_read_b64_tr_b16 v[70:71], v17 offset:17984
    v_mul_f32 v33, 0x3a800000, v193
    v_fma_f32 v32, -v30, v30, v32
    v_mfma_f32_16x16x32_bf16 v[100:103], v[52:55], v[244:247], v[100:103]
    ds_read_b64_tr_b16 v[52:53], v17 offset:21568
    v_mfma_f32_16x16x32_bf16 v[100:103], v[56:59], v[252:255], v[100:103]
    ds_read_b64_tr_b16 v[54:55], v17 offset:25152
    v_fma_f32 v33, -v31, v31, v33
    v_max_f32 v32, 0, v32
    s_waitcnt lgkmcnt(4)
    v_mfma_f32_16x16x32_bf16 v[104:107], v[60:63], v[240:243], v[104:107]
    ds_read_b64_tr_b16 v[56:57], v17 offset:96
    v_mfma_f32_16x16x32_bf16 v[104:107], v[64:67], v[248:251], v[104:107]
    ds_read_b64_tr_b16 v[58:59], v17 offset:3680
    buffer_load_dwordx4 v[236:239], v16, s[36:39], s61 offen offset:1024 sc1
    v_max_f32 v33, 0, v33
    v_add_f32 v32, 0x3727c5ac, v32
    v_mfma_f32_16x16x32_bf16 v[108:111], v[60:63], v[244:247], v[108:111]
    ds_read_b64_tr_b16 v[60:61], v17 offset:7264
qa_kernel_WS1_3:
    s_cbranch_execz qa_kernel_WS1_11
    v_mfma_f32_16x16x32_bf16 v[108:111], v[64:67], v[252:255], v[108:111]
    ds_read_b64_tr_b16 v[62:63], v17 offset:10848
    v_add_f32 v33, 0x3727c5ac, v33
    v_rsq_f32 v34, v32
    s_waitcnt lgkmcnt(4)
    v_mfma_f32_16x16x32_bf16 v[112:115], v[68:71], v[240:243], v[112:115]
    ds_read_b64_tr_b16 v[64:65], v17 offset:14432
    v_mfma_f32_16x16x32_bf16 v[112:115], v[52:55], v[248:251], v[112:115]
    ds_read_b64_tr_b16 v[66:67], v17 offset:18016
    s_setprio 1
    v_rsq_f32 v35, v33
    v_mul_f32 v34, 0xbfb8aa3b, v34
    v_mfma_f32_16x16x32_bf16 v[116:119], v[68:71], v[244:247], v[116:119]
    ds_read_b64_tr_b16 v[68:69], v17 offset:21600
    v_mfma_f32_16x16x32_bf16 v[116:119], v[52:55], v[252:255], v[116:119]
    ds_read_b64_tr_b16 v[70:71], v17 offset:25184
    s_add_u32 m0, s60, 95232
    s_nop 0
    buffer_load_dwordx4 v9, s[32:35], s59 offen lds
    v_mul_f32 v35, 0xbfb8aa3b, v35
    s_waitcnt lgkmcnt(4)
    v_mfma_f32_16x16x32_bf16 v[120:123], v[56:59], v[240:243], v[120:123]
    ds_read_b64_tr_b16 v[52:53], v17 offset:128
    v_mfma_f32_16x16x32_bf16 v[120:123], v[60:63], v[248:251], v[120:123]
    ds_read_b64_tr_b16 v[54:55], v17 offset:3712
    ds_read_b128 v[184:187], v19 offset:0
    v_mfma_f32_16x16x32_bf16 v[124:127], v[56:59], v[244:247], v[124:127]
    ds_read_b64_tr_b16 v[56:57], v17 offset:7296
    v_mfma_f32_16x16x32_bf16 v[124:127], v[60:63], v[252:255], v[124:127]
    ds_read_b64_tr_b16 v[58:59], v17 offset:10880
    s_waitcnt lgkmcnt(5)
    v_mfma_f32_16x16x32_bf16 v[128:131], v[64:67], v[240:243], v[128:131]
    ds_read_b64_tr_b16 v[60:61], v17 offset:14464
    v_mfma_f32_16x16x32_bf16 v[128:131], v[68:71], v[248:251], v[128:131]
    ds_read_b64_tr_b16 v[62:63], v17 offset:18048
    s_add_u32 m0, s60, 96256
    s_nop 0
    buffer_load_dwordx4 v10, s[32:35], s59 offen lds
    v_mfma_f32_16x16x32_bf16 v[132:135], v[64:67], v[244:247], v[132:135]
    ds_read_b64_tr_b16 v[64:65], v17 offset:21632
    v_mfma_f32_16x16x32_bf16 v[132:135], v[68:71], v[252:255], v[132:135]
    ds_read_b64_tr_b16 v[66:67], v17 offset:25216
    s_waitcnt lgkmcnt(4)
    v_mfma_f32_16x16x32_bf16 v[136:139], v[52:55], v[240:243], v[136:139]
    ds_read_b64_tr_b16 v[68:69], v17 offset:160
    v_mfma_f32_16x16x32_bf16 v[136:139], v[56:59], v[248:251], v[136:139]
    ds_read_b64_tr_b16 v[70:71], v17 offset:3744
    v_fmac_f32 v72, v30, v184
    v_fmac_f32 v73, v30, v185
    ds_read_b128 v[188:191], v19 offset:448
    v_mfma_f32_16x16x32_bf16 v[140:143], v[52:55], v[244:247], v[140:143]
    ds_read_b64_tr_b16 v[52:53], v17 offset:7328
    v_mfma_f32_16x16x32_bf16 v[140:143], v[56:59], v[252:255], v[140:143]
    ds_read_b64_tr_b16 v[54:55], v17 offset:10912
    s_setprio 0
    s_add_u32 m0, s60, 97280
    s_mov_b32 exec_hi, 0
    buffer_load_dwordx4 v11, s[32:35], s59 offen lds
    s_mov_b32 exec_hi, -1
    s_add_u32 s59, s59, 458752
    v_fmac_f32 v74, v30, v186
    v_fmac_f32 v75, v30, v187
    s_waitcnt lgkmcnt(5)
    v_mfma_f32_16x16x32_bf16 v[144:147], v[60:63], v[240:243], v[144:147]
    ds_read_b64_tr_b16 v[56:57], v17 offset:14496
    v_mfma_f32_16x16x32_bf16 v[144:147], v[64:67], v[248:251], v[144:147]
    ds_read_b64_tr_b16 v[58:59], v17 offset:18080
    v_fmac_f32 v76, v31, v184
    v_fmac_f32 v77, v31, v185
    v_mfma_f32_16x16x32_bf16 v[148:151], v[60:63], v[244:247], v[148:151]
    ds_read_b64_tr_b16 v[60:61], v17 offset:21664
    v_mfma_f32_16x16x32_bf16 v[148:151], v[64:67], v[252:255], v[148:151]
    ds_read_b64_tr_b16 v[62:63], v17 offset:25248
    v_fmac_f32 v78, v31, v186
    v_fmac_f32 v79, v31, v187
    s_waitcnt lgkmcnt(4)
    v_mfma_f32_16x16x32_bf16 v[152:155], v[68:71], v[240:243], v[152:155]
    ds_read_b64_tr_b16 v[64:65], v18 offset:0
    v_mfma_f32_16x16x32_bf16 v[152:155], v[52:55], v[248:251], v[152:155]
    ds_read_b64_tr_b16 v[66:67], v18 offset:3584
    v_fmac_f32 v80, v30, v188
    v_fmac_f32 v81, v30, v189
    ds_read_b128 v[192:195], v19 offset:64
    v_mfma_f32_16x16x32_bf16 v[156:159], v[68:71], v[244:247], v[156:159]
    ds_read_b64_tr_b16 v[68:69], v18 offset:7168
    v_mfma_f32_16x16x32_bf16 v[156:159], v[52:55], v[252:255], v[156:159]
    ds_read_b64_tr_b16 v[70:71], v18 offset:10752
    v_fmac_f32 v82, v30, v190
    v_fmac_f32 v83, v30, v191
    s_waitcnt lgkmcnt(5)
    v_mfma_f32_16x16x32_bf16 v[160:163], v[56:59], v[240:243], v[160:163]
    ds_read_b64_tr_b16 v[52:53], v18 offset:14336
    v_mfma_f32_16x16x32_bf16 v[160:163], v[60:63], v[248:251], v[160:163]
    ds_read_b64_tr_b16 v[54:55], v18 offset:17920
    v_fmac_f32 v84, v31, v188
    v_fmac_f32 v85, v31, v189
    v_mfma_f32_16x16x32_bf16 v[164:167], v[56:59], v[244:247], v[164:167]
    ds_read_b64_tr_b16 v[56:57], v18 offset:21504
    v_mfma_f32_16x16x32_bf16 v[164:167], v[60:63], v[252:255], v[164:167]
    ds_read_b64_tr_b16 v[58:59], v18 offset:25088
    v_fmac_f32 v86, v31, v190
    v_fmac_f32 v87, v31, v191
    s_waitcnt lgkmcnt(4)
    v_mfma_f32_16x16x32_bf16 v[168:171], v[64:67], v[240:243], v[168:171]
    s_waitcnt vmcnt(16)
    s_barrier
    ds_read_b64_tr_b16 v[60:61], v17 offset:28672
    v_mfma_f32_16x16x32_bf16 v[168:171], v[68:71], v[248:251], v[168:171]
    ds_read_b64_tr_b16 v[62:63], v17 offset:32256
    s_setprio 3
    s_add_u32 m0, s60, 122880
    s_nop 0
    buffer_load_dwordx4 v8, s[32:35], s59 offen lds
    v_fmac_f32 v88, v30, v192
    v_fmac_f32 v89, v30, v193
    v_mfma_f32_16x16x32_bf16 v[172:175], v[64:67], v[244:247], v[172:175]
    ds_read_b64_tr_b16 v[64:65], v17 offset:35840
    v_mfma_f32_16x16x32_bf16 v[172:175], v[68:71], v[252:255], v[172:175]
    ds_read_b64_tr_b16 v[66:67], v17 offset:39424
    s_waitcnt vmcnt(15)
    v_max3_u32 v12, v208, v209, v210
    v_max3_u32 v13, v211, v212, v213
    v_max3_u32 v12, v12, v214, v215
    v_max_u32 v12, v12, v13
    v_cmp_eq_u32 vcc, -1, v12
    s_cbranch_vccnz qa_kernel_F0_A18_R
qa_kernel_F0_A18_G:
    v_fmac_f32 v90, v30, v194
    v_fmac_f32 v91, v30, v195
    s_waitcnt lgkmcnt(4)
    v_mfma_f32_16x16x32_bf16 v[176:179], v[52:55], v[240:243], v[176:179]
    ds_read_b64_tr_b16 v[68:69], v17 offset:43008
    v_mfma_f32_16x16x32_bf16 v[176:179], v[56:59], v[248:251], v[176:179]
    ds_read_b64_tr_b16 v[70:71], v17 offset:46592
    s_waitcnt vmcnt(13)
    v_max3_u32 v12, v216, v217, v218
    v_max3_u32 v13, v219, v220, v221
    v_max3_u32 v12, v12, v222, v223
    v_max_u32 v12, v12, v13
    v_cmp_eq_u32 vcc, -1, v12
    s_cbranch_vccnz qa_kernel_F0_A19_R
qa_kernel_F0_A19_G:
    v_fmac_f32 v92, v31, v192
    v_fmac_f32 v93, v31, v193
    v_mfma_f32_16x16x32_bf16 v[180:183], v[52:55], v[244:247], v[180:183]
    ds_read_b64_tr_b16 v[52:53], v17 offset:50176
    v_mfma_f32_16x16x32_bf16 v[180:183], v[56:59], v[252:255], v[180:183]
    ds_read_b64_tr_b16 v[54:55], v17 offset:53760
    buffer_load_dwordx4 v[240:243], v15, s[36:39], s61 offen offset:2048 sc1
    v_fmac_f32 v94, v31, v194
    v_fmac_f32 v95, v31, v195
    s_waitcnt lgkmcnt(4)
    v_mfma_f32_16x16x32_bf16 v[72:75], v[60:63], v[208:211], v[72:75]
    ds_read_b64_tr_b16 v[56:57], v17 offset:28704
    v_mfma_f32_16x16x32_bf16 v[72:75], v[64:67], v[216:219], v[72:75]
    ds_read_b64_tr_b16 v[58:59], v17 offset:32288
    v_mfma_f32_16x16x32_bf16 v[76:79], v[60:63], v[212:215], v[76:79]
    ds_read_b64_tr_b16 v[60:61], v17 offset:35872
    v_mfma_f32_16x16x32_bf16 v[76:79], v[64:67], v[220:223], v[76:79]
    ds_read_b64_tr_b16 v[62:63], v17 offset:39456
    s_waitcnt lgkmcnt(4)
    v_mfma_f32_16x16x32_bf16 v[80:83], v[68:71], v[208:211], v[80:83]
    ds_read_b64_tr_b16 v[64:65], v17 offset:43040
    v_mfma_f32_16x16x32_bf16 v[80:83], v[52:55], v[216:219], v[80:83]
    ds_read_b64_tr_b16 v[66:67], v17 offset:46624
    buffer_load_dwordx4 v[244:247], v16, s[36:39], s61 offen offset:2048 sc1
    v_mfma_f32_16x16x32_bf16 v[84:87], v[68:71], v[212:215], v[84:87]
    ds_read_b64_tr_b16 v[68:69], v17 offset:50208
    v_mfma_f32_16x16x32_bf16 v[84:87], v[52:55], v[220:223], v[84:87]
    ds_read_b64_tr_b16 v[70:71], v17 offset:53792
    s_setprio 2
    s_waitcnt lgkmcnt(4)
    v_mfma_f32_16x16x32_bf16 v[88:91], v[56:59], v[208:211], v[88:91]
    ds_read_b64_tr_b16 v[52:53], v17 offset:28736
    v_mfma_f32_16x16x32_bf16 v[88:91], v[60:63], v[216:219], v[88:91]
    ds_read_b64_tr_b16 v[54:55], v17 offset:32320
    v_mfma_f32_16x16x32_bf16 v[92:95], v[56:59], v[212:215], v[92:95]
    ds_read_b64_tr_b16 v[56:57], v17 offset:35904
    v_mfma_f32_16x16x32_bf16 v[92:95], v[60:63], v[220:223], v[92:95]
    ds_read_b64_tr_b16 v[58:59], v17 offset:39488
    buffer_load_dwordx4 v[248:251], v15, s[36:39], s61 offen offset:3072 sc1
    s_waitcnt lgkmcnt(4)
    v_mfma_f32_16x16x32_bf16 v[96:99], v[64:67], v[208:211], v[96:99]
    ds_read_b64_tr_b16 v[60:61], v17 offset:43072
    v_mfma_f32_16x16x32_bf16 v[96:99], v[68:71], v[216:219], v[96:99]
    ds_read_b64_tr_b16 v[62:63], v17 offset:46656
    v_mfma_f32_16x16x32_bf16 v[100:103], v[64:67], v[212:215], v[100:103]
    ds_read_b64_tr_b16 v[64:65], v17 offset:50240
    v_mfma_f32_16x16x32_bf16 v[100:103], v[68:71], v[220:223], v[100:103]
    ds_read_b64_tr_b16 v[66:67], v17 offset:53824
    s_waitcnt lgkmcnt(4)
    v_mfma_f32_16x16x32_bf16 v[104:107], v[52:55], v[208:211], v[104:107]
    ds_read_b64_tr_b16 v[68:69], v17 offset:28768
    v_mfma_f32_16x16x32_bf16 v[104:107], v[56:59], v[216:219], v[104:107]
    ds_read_b64_tr_b16 v[70:71], v17 offset:32352
    buffer_load_dwordx4 v[252:255], v16, s[36:39], s61 offen offset:3072 sc1
    s_add_u32 s61, s61, 4096
    ds_read_b128 v[196:199], v19 offset:512
    v_mfma_f32_16x16x32_bf16 v[108:111], v[52:55], v[212:215], v[108:111]
    ds_read_b64_tr_b16 v[52:53], v17 offset:35936
    v_mfma_f32_16x16x32_bf16 v[108:111], v[56:59], v[220:223], v[108:111]
    ds_read_b64_tr_b16 v[54:55], v17 offset:39520
    s_waitcnt lgkmcnt(5)
    v_mfma_f32_16x16x32_bf16 v[112:115], v[60:63], v[208:211], v[112:115]
    ds_read_b64_tr_b16 v[56:57], v17 offset:43104
    v_mfma_f32_16x16x32_bf16 v[112:115], v[64:67], v[216:219], v[112:115]
    ds_read_b64_tr_b16 v[58:59], v17 offset:46688
    s_setprio 1
    v_mfma_f32_16x16x32_bf16 v[116:119], v[60:63], v[212:215], v[116:119]
    ds_read_b64_tr_b16 v[60:61], v17 offset:50272
    v_mfma_f32_16x16x32_bf16 v[116:119], v[64:67], v[220:223], v[116:119]
    ds_read_b64_tr_b16 v[62:63], v17 offset:53856
    s_add_u32 m0, s60, 123904
    s_nop 0
    buffer_load_dwordx4 v9, s[32:35], s59 offen lds
    s_waitcnt lgkmcnt(4)
    v_mfma_f32_16x16x32_bf16 v[120:123], v[68:71], v[208:211], v[120:123]
    ds_read_b64_tr_b16 v[64:65], v17 offset:28800
    v_mfma_f32_16x16x32_bf16 v[120:123], v[52:55], v[216:219], v[120:123]
    ds_read_b64_tr_b16 v[66:67], v17 offset:32384
    v_fmac_f32 v96, v30, v196
    v_fmac_f32 v97, v30, v197
    ds_read_b128 v[184:187], v19 offset:128
    v_mfma_f32_16x16x32_bf16 v[124:127], v[68:71], v[212:215], v[124:127]
    ds_read_b64_tr_b16 v[68:69], v17 offset:35968
    v_mfma_f32_16x16x32_bf16 v[124:127], v[52:55], v[220:223], v[124:127]
    ds_read_b64_tr_b16 v[70:71], v17 offset:39552
    v_fmac_f32 v98, v30, v198
    v_fmac_f32 v99, v30, v199
    s_waitcnt lgkmcnt(5)
    v_mfma_f32_16x16x32_bf16 v[128:131], v[56:59], v[208:211], v[128:131]
    ds_read_b64_tr_b16 v[52:53], v17 offset:43136
    v_mfma_f32_16x16x32_bf16 v[128:131], v[60:63], v[216:219], v[128:131]
    ds_read_b64_tr_b16 v[54:55], v17 offset:46720
    s_add_u32 m0, s60, 124928
    s_nop 0
    buffer_load_dwordx4 v10, s[32:35], s59 offen lds
    v_fmac_f32 v100, v31, v196
    v_fmac_f32 v101, v31, v197
    v_mfma_f32_16x16x32_bf16 v[132:135], v[56:59], v[212:215], v[132:135]
    ds_read_b64_tr_b16 v[56:57], v17 offset:50304
    v_mfma_f32_16x16x32_bf16 v[132:135], v[60:63], v[220:223], v[132:135]
    ds_read_b64_tr_b16 v[58:59], v17 offset:53888
    v_fmac_f32 v102, v31, v198
    v_fmac_f32 v103, v31, v199
    s_waitcnt lgkmcnt(4)
    v_mfma_f32_16x16x32_bf16 v[136:139], v[64:67], v[208:211], v[136:139]
    ds_read_b64_tr_b16 v[60:61], v17 offset:28832
    v_mfma_f32_16x16x32_bf16 v[136:139], v[68:71], v[216:219], v[136:139]
    ds_read_b64_tr_b16 v[62:63], v17 offset:32416
    v_fmac_f32 v104, v30, v184
    v_fmac_f32 v105, v30, v185
    ds_read_b128 v[188:191], v19 offset:576
    v_mfma_f32_16x16x32_bf16 v[140:143], v[64:67], v[212:215], v[140:143]
    ds_read_b64_tr_b16 v[64:65], v17 offset:36000
    v_mfma_f32_16x16x32_bf16 v[140:143], v[68:71], v[220:223], v[140:143]
    ds_read_b64_tr_b16 v[66:67], v17 offset:39584
    s_setprio 0
    s_add_u32 m0, s60, 125952
    s_mov_b32 exec_hi, 0
    buffer_load_dwordx4 v11, s[32:35], s59 offen lds
    s_mov_b32 exec_hi, -1
    s_add_u32 s59, s59, 458752
    v_fmac_f32 v106, v30, v186
    v_fmac_f32 v107, v30, v187
    s_waitcnt lgkmcnt(5)
    v_mfma_f32_16x16x32_bf16 v[144:147], v[52:55], v[208:211], v[144:147]
    ds_read_b64_tr_b16 v[68:69], v17 offset:43168
    v_mfma_f32_16x16x32_bf16 v[144:147], v[56:59], v[216:219], v[144:147]
    ds_read_b64_tr_b16 v[70:71], v17 offset:46752
    v_fmac_f32 v108, v31, v184
    v_fmac_f32 v109, v31, v185
    v_mfma_f32_16x16x32_bf16 v[148:151], v[52:55], v[212:215], v[148:151]
    ds_read_b64_tr_b16 v[52:53], v17 offset:50336
    v_mfma_f32_16x16x32_bf16 v[148:151], v[56:59], v[220:223], v[148:151]
    ds_read_b64_tr_b16 v[54:55], v17 offset:53920
    v_fmac_f32 v110, v31, v186
    v_fmac_f32 v111, v31, v187
    s_waitcnt lgkmcnt(4)
    v_mfma_f32_16x16x32_bf16 v[152:155], v[60:63], v[208:211], v[152:155]
    ds_read_b64_tr_b16 v[56:57], v18 offset:28672
    v_mfma_f32_16x16x32_bf16 v[152:155], v[64:67], v[216:219], v[152:155]
    ds_read_b64_tr_b16 v[58:59], v18 offset:32256
    v_fmac_f32 v112, v30, v188
    v_fmac_f32 v113, v30, v189
    ds_read_b128 v[192:195], v19 offset:192
    v_mfma_f32_16x16x32_bf16 v[156:159], v[60:63], v[212:215], v[156:159]
    ds_read_b64_tr_b16 v[60:61], v18 offset:35840
    v_mfma_f32_16x16x32_bf16 v[156:159], v[64:67], v[220:223], v[156:159]
    ds_read_b64_tr_b16 v[62:63], v18 offset:39424
    v_fmac_f32 v114, v30, v190
    v_fmac_f32 v115, v30, v191
    s_waitcnt lgkmcnt(5)
    v_mfma_f32_16x16x32_bf16 v[160:163], v[68:71], v[208:211], v[160:163]
    ds_read_b64_tr_b16 v[64:65], v18 offset:43008
    v_mfma_f32_16x16x32_bf16 v[160:163], v[52:55], v[216:219], v[160:163]
    ds_read_b64_tr_b16 v[66:67], v18 offset:46592
    v_fmac_f32 v116, v31, v188
    v_fmac_f32 v117, v31, v189
    v_mfma_f32_16x16x32_bf16 v[164:167], v[68:71], v[212:215], v[164:167]
    ds_read_b64_tr_b16 v[68:69], v18 offset:50176
    v_mfma_f32_16x16x32_bf16 v[164:167], v[52:55], v[220:223], v[164:167]
    ds_read_b64_tr_b16 v[70:71], v18 offset:53760
    v_fmac_f32 v118, v31, v190
    v_fmac_f32 v119, v31, v191
    s_waitcnt lgkmcnt(4)
    v_mfma_f32_16x16x32_bf16 v[168:171], v[56:59], v[208:211], v[168:171]
    s_waitcnt vmcnt(16)
    s_barrier
    ds_read_b64_tr_b16 v[52:53], v21 offset:0
    v_mfma_f32_16x16x32_bf16 v[168:171], v[60:63], v[216:219], v[168:171]
    ds_read_b64_tr_b16 v[54:55], v21 offset:3584
    s_setprio 3
    s_add_u32 m0, s60, 0
    s_nop 0
    buffer_load_dwordx4 v8, s[32:35], s59 offen lds
    v_fmac_f32 v120, v30, v192
    v_fmac_f32 v121, v30, v193
    ds_read_b128 v[196:199], v19 offset:640
    v_mfma_f32_16x16x32_bf16 v[172:175], v[56:59], v[212:215], v[172:175]
    ds_read_b64_tr_b16 v[56:57], v21 offset:7168
    v_mfma_f32_16x16x32_bf16 v[172:175], v[60:63], v[220:223], v[172:175]
    ds_read_b64_tr_b16 v[58:59], v21 offset:10752
    s_waitcnt vmcnt(14)
    v_max3_u32 v12, v224, v225, v226
    v_max3_u32 v13, v227, v228, v229
    v_max3_u32 v12, v12, v230, v231
    v_max_u32 v12, v12, v13
    v_cmp_eq_u32 vcc, -1, v12
    s_cbranch_vccnz qa_kernel_F0_A20_R
qa_kernel_F0_A20_G:
    v_fmac_f32 v122, v30, v194
    v_fmac_f32 v123, v30, v195
    s_waitcnt lgkmcnt(5)
    v_mfma_f32_16x16x32_bf16 v[176:179], v[64:67], v[208:211], v[176:179]
    ds_read_b64_tr_b16 v[60:61], v21 offset:14336
    v_mfma_f32_16x16x32_bf16 v[176:179], v[68:71], v[216:219], v[176:179]
    ds_read_b64_tr_b16 v[62:63], v21 offset:17920
    s_waitcnt vmcnt(12)
    v_max3_u32 v12, v232, v233, v234
    v_max3_u32 v13, v235, v236, v237
    v_max3_u32 v12, v12, v238, v239
    v_max_u32 v12, v12, v13
    v_cmp_eq_u32 vcc, -1, v12
    s_cbranch_vccnz qa_kernel_F0_A21_R
qa_kernel_F0_A21_G:
    v_fmac_f32 v124, v31, v192
    v_fmac_f32 v125, v31, v193
    v_mfma_f32_16x16x32_bf16 v[180:183], v[64:67], v[212:215], v[180:183]
    ds_read_b64_tr_b16 v[64:65], v21 offset:21504
    v_mfma_f32_16x16x32_bf16 v[180:183], v[68:71], v[220:223], v[180:183]
    ds_read_b64_tr_b16 v[66:67], v21 offset:25088
    buffer_load_dwordx4 v[208:211], v15, s[36:39], s61 offen offset:0 sc1
    v_fmac_f32 v126, v31, v194
    v_fmac_f32 v127, v31, v195
    s_waitcnt lgkmcnt(4)
    v_mfma_f32_16x16x32_bf16 v[72:75], v[52:55], v[224:227], v[72:75]
    ds_read_b64_tr_b16 v[68:69], v21 offset:32
    v_mfma_f32_16x16x32_bf16 v[72:75], v[56:59], v[232:235], v[72:75]
    ds_read_b64_tr_b16 v[70:71], v21 offset:3616
    v_fmac_f32 v128, v30, v196
    v_fmac_f32 v129, v30, v197
    ds_read_b128 v[184:187], v19 offset:256
    v_mfma_f32_16x16x32_bf16 v[76:79], v[52:55], v[228:231], v[76:79]
    ds_read_b64_tr_b16 v[52:53], v21 offset:7200
    v_mfma_f32_16x16x32_bf16 v[76:79], v[56:59], v[236:239], v[76:79]
    ds_read_b64_tr_b16 v[54:55], v21 offset:10784
    v_fmac_f32 v130, v30, v198
    v_fmac_f32 v131, v30, v199
    s_waitcnt lgkmcnt(5)
    v_mfma_f32_16x16x32_bf16 v[80:83], v[60:63], v[224:227], v[80:83]
    ds_read_b64_tr_b16 v[56:57], v21 offset:14368
    v_mfma_f32_16x16x32_bf16 v[80:83], v[64:67], v[232:235], v[80:83]
    ds_read_b64_tr_b16 v[58:59], v21 offset:17952
    buffer_load_dwordx4 v[212:215], v16, s[36:39], s61 offen offset:0 sc1
    v_fmac_f32 v132, v31, v196
    v_fmac_f32 v133, v31, v197
    v_mfma_f32_16x16x32_bf16 v[84:87], v[60:63], v[228:231], v[84:87]
    ds_read_b64_tr_b16 v[60:61], v21 offset:21536
    v_mfma_f32_16x16x32_bf16 v[84:87], v[64:67], v[236:239], v[84:87]
    ds_read_b64_tr_b16 v[62:63], v21 offset:25120
    s_setprio 2
    v_fmac_f32 v134, v31, v198
    v_fmac_f32 v135, v31, v199
    s_waitcnt lgkmcnt(4)
    v_mfma_f32_16x16x32_bf16 v[88:91], v[68:71], v[224:227], v[88:91]
    ds_read_b64_tr_b16 v[64:65], v21 offset:64
    v_mfma_f32_16x16x32_bf16 v[88:91], v[52:55], v[232:235], v[88:91]
    ds_read_b64_tr_b16 v[66:67], v21 offset:3648
    v_fmac_f32 v136, v30, v184
    v_fmac_f32 v137, v30, v185
    ds_read_b128 v[188:191], v19 offset:704
    v_mfma_f32_16x16x32_bf16 v[92:95], v[68:71], v[228:231], v[92:95]
    ds_read_b64_tr_b16 v[68:69], v21 offset:7232
    v_mfma_f32_16x16x32_bf16 v[92:95], v[52:55], v[236:239], v[92:95]
    ds_read_b64_tr_b16 v[70:71], v21 offset:10816
    buffer_load_dwordx4 v[216:219], v15, s[36:39], s61 offen offset:1024 sc1
    v_fmac_f32 v138, v30, v186
    v_fmac_f32 v139, v30, v187
    s_waitcnt lgkmcnt(5)
    v_mfma_f32_16x16x32_bf16 v[96:99], v[56:59], v[224:227], v[96:99]
    ds_read_b64_tr_b16 v[52:53], v21 offset:14400
    v_mfma_f32_16x16x32_bf16 v[96:99], v[60:63], v[232:235], v[96:99]
    ds_read_b64_tr_b16 v[54:55], v21 offset:17984
    v_fmac_f32 v140, v31, v184
    v_fmac_f32 v141, v31, v185
    v_mfma_f32_16x16x32_bf16 v[100:103], v[56:59], v[228:231], v[100:103]
    ds_read_b64_tr_b16 v[56:57], v21 offset:21568
    v_mfma_f32_16x16x32_bf16 v[100:103], v[60:63], v[236:239], v[100:103]
    ds_read_b64_tr_b16 v[58:59], v21 offset:25152
    v_fmac_f32 v142, v31, v186
    v_fmac_f32 v143, v31, v187
    s_waitcnt lgkmcnt(4)
    v_mfma_f32_16x16x32_bf16 v[104:107], v[64:67], v[224:227], v[104:107]
    ds_read_b64_tr_b16 v[60:61], v21 offset:96
    v_mfma_f32_16x16x32_bf16 v[104:107], v[68:71], v[232:235], v[104:107]
    ds_read_b64_tr_b16 v[62:63], v21 offset:3680
    buffer_load_dwordx4 v[220:223], v16, s[36:39], s61 offen offset:1024 sc1
    v_fmac_f32 v144, v30, v188
    v_fmac_f32 v145, v30, v189
    ds_read_b128 v[192:195], v19 offset:320
    v_mfma_f32_16x16x32_bf16 v[108:111], v[64:67], v[228:231], v[108:111]
    ds_read_b64_tr_b16 v[64:65], v21 offset:7264
    v_mfma_f32_16x16x32_bf16 v[108:111], v[68:71], v[236:239], v[108:111]
    ds_read_b64_tr_b16 v[66:67], v21 offset:10848
    v_fmac_f32 v146, v30, v190
    v_fmac_f32 v147, v30, v191
    s_waitcnt lgkmcnt(5)
    v_mfma_f32_16x16x32_bf16 v[112:115], v[52:55], v[224:227], v[112:115]
    ds_read_b64_tr_b16 v[68:69], v21 offset:14432
    v_mfma_f32_16x16x32_bf16 v[112:115], v[56:59], v[232:235], v[112:115]
    ds_read_b64_tr_b16 v[70:71], v21 offset:18016
    s_setprio 1
    v_fmac_f32 v148, v31, v188
    v_fmac_f32 v149, v31, v189
    v_mfma_f32_16x16x32_bf16 v[116:119], v[52:55], v[228:231], v[116:119]
    ds_read_b64_tr_b16 v[52:53], v21 offset:21600
    v_mfma_f32_16x16x32_bf16 v[116:119], v[56:59], v[236:239], v[116:119]
    ds_read_b64_tr_b16 v[54:55], v21 offset:25184
    s_add_u32 m0, s60, 1024
    s_nop 0
    buffer_load_dwordx4 v9, s[32:35], s59 offen lds
    v_fmac_f32 v150, v31, v190
    v_fmac_f32 v151, v31, v191
    s_waitcnt lgkmcnt(4)
    v_mfma_f32_16x16x32_bf16 v[120:123], v[60:63], v[224:227], v[120:123]
    ds_read_b64_tr_b16 v[56:57], v21 offset:128
    v_mfma_f32_16x16x32_bf16 v[120:123], v[64:67], v[232:235], v[120:123]
    ds_read_b64_tr_b16 v[58:59], v21 offset:3712
    v_fmac_f32 v152, v30, v192
    v_fmac_f32 v153, v30, v193
    v_mfma_f32_16x16x32_bf16 v[124:127], v[60:63], v[228:231], v[124:127]
    ds_read_b64_tr_b16 v[60:61], v21 offset:7296
    v_mfma_f32_16x16x32_bf16 v[124:127], v[64:67], v[236:239], v[124:127]
    ds_read_b64_tr_b16 v[62:63], v21 offset:10880
    v_fmac_f32 v154, v30, v194
    v_fmac_f32 v155, v30, v195
    s_waitcnt lgkmcnt(4)
    v_mfma_f32_16x16x32_bf16 v[128:131], v[68:71], v[224:227], v[128:131]
    ds_read_b64_tr_b16 v[64:65], v21 offset:14464
    v_mfma_f32_16x16x32_bf16 v[128:131], v[52:55], v[232:235], v[128:131]
    ds_read_b64_tr_b16 v[66:67], v21 offset:18048
    s_add_u32 m0, s60, 2048
    s_nop 0
    buffer_load_dwordx4 v10, s[32:35], s59 offen lds
    v_fmac_f32 v156, v31, v192
    v_fmac_f32 v157, v31, v193
    v_mfma_f32_16x16x32_bf16 v[132:135], v[68:71], v[228:231], v[132:135]
    ds_read_b64_tr_b16 v[68:69], v21 offset:21632
    v_mfma_f32_16x16x32_bf16 v[132:135], v[52:55], v[236:239], v[132:135]
    ds_read_b64_tr_b16 v[70:71], v21 offset:25216
    v_fmac_f32 v158, v31, v194
    v_fmac_f32 v159, v31, v195
    s_waitcnt lgkmcnt(4)
    v_mfma_f32_16x16x32_bf16 v[136:139], v[56:59], v[224:227], v[136:139]
    ds_read_b64_tr_b16 v[52:53], v21 offset:160
    v_mfma_f32_16x16x32_bf16 v[136:139], v[60:63], v[232:235], v[136:139]
    ds_read_b64_tr_b16 v[54:55], v21 offset:3744
    v_mfma_f32_16x16x32_bf16 v[140:143], v[56:59], v[228:231], v[140:143]
    ds_read_b64_tr_b16 v[56:57], v21 offset:7328
    v_mfma_f32_16x16x32_bf16 v[140:143], v[60:63], v[236:239], v[140:143]
    ds_read_b64_tr_b16 v[58:59], v21 offset:10912
    s_setprio 0
    s_add_u32 m0, s60, 3072
    s_mov_b32 exec_hi, 0
    buffer_load_dwordx4 v11, s[32:35], s59 offen lds
    s_mov_b32 exec_hi, -1
    s_add_u32 s59, s59, 458752
    s_waitcnt lgkmcnt(4)
    v_mfma_f32_16x16x32_bf16 v[144:147], v[64:67], v[224:227], v[144:147]
    ds_read_b64_tr_b16 v[60:61], v21 offset:14496
    v_mfma_f32_16x16x32_bf16 v[144:147], v[68:71], v[232:235], v[144:147]
    ds_read_b64_tr_b16 v[62:63], v21 offset:18080
    v_mfma_f32_16x16x32_bf16 v[148:151], v[64:67], v[228:231], v[148:151]
    ds_read_b64_tr_b16 v[64:65], v21 offset:21664
    v_mfma_f32_16x16x32_bf16 v[148:151], v[68:71], v[236:239], v[148:151]
    ds_read_b64_tr_b16 v[66:67], v21 offset:25248
    s_waitcnt lgkmcnt(4)
    v_mfma_f32_16x16x32_bf16 v[152:155], v[52:55], v[224:227], v[152:155]
    ds_read_b64_tr_b16 v[68:69], v23 offset:0
    v_mfma_f32_16x16x32_bf16 v[152:155], v[56:59], v[232:235], v[152:155]
    ds_read_b64_tr_b16 v[70:71], v23 offset:3584
    v_mfma_f32_16x16x32_bf16 v[156:159], v[52:55], v[228:231], v[156:159]
    ds_read_b64_tr_b16 v[52:53], v23 offset:7168
    v_mfma_f32_16x16x32_bf16 v[156:159], v[56:59], v[236:239], v[156:159]
    ds_read_b64_tr_b16 v[54:55], v23 offset:10752
    s_waitcnt lgkmcnt(4)
    v_mfma_f32_16x16x32_bf16 v[160:163], v[60:63], v[224:227], v[160:163]
    ds_read_b64_tr_b16 v[56:57], v23 offset:14336
    v_mfma_f32_16x16x32_bf16 v[160:163], v[64:67], v[232:235], v[160:163]
    ds_read_b64_tr_b16 v[58:59], v23 offset:17920
    v_mfma_f32_16x16x32_bf16 v[164:167], v[60:63], v[228:231], v[164:167]
    ds_read_b64_tr_b16 v[60:61], v23 offset:21504
    v_mfma_f32_16x16x32_bf16 v[164:167], v[64:67], v[236:239], v[164:167]
    ds_read_b64_tr_b16 v[62:63], v23 offset:25088
    s_waitcnt lgkmcnt(4)
    v_mfma_f32_16x16x32_bf16 v[168:171], v[68:71], v[224:227], v[168:171]
    s_waitcnt vmcnt(16)
    s_barrier
    ds_read_b64_tr_b16 v[64:65], v21 offset:28672
    v_mfma_f32_16x16x32_bf16 v[168:171], v[52:55], v[232:235], v[168:171]
    ds_read_b64_tr_b16 v[66:67], v21 offset:32256
    s_setprio 3
    s_add_u32 m0, s60, 28672
    s_nop 0
    buffer_load_dwordx4 v8, s[32:35], s59 offen lds
    ds_read_b128 v[196:199], v19 offset:768
    v_mfma_f32_16x16x32_bf16 v[172:175], v[68:71], v[228:231], v[172:175]
    ds_read_b64_tr_b16 v[68:69], v21 offset:35840
    v_mfma_f32_16x16x32_bf16 v[172:175], v[52:55], v[236:239], v[172:175]
    ds_read_b64_tr_b16 v[70:71], v21 offset:39424
    s_waitcnt vmcnt(14)
    v_max3_u32 v12, v240, v241, v242
    v_max3_u32 v13, v243, v244, v245
    v_max3_u32 v12, v12, v246, v247
    v_max_u32 v12, v12, v13
    v_cmp_eq_u32 vcc, -1, v12
    s_cbranch_vccnz qa_kernel_F0_A22_R
qa_kernel_F0_A22_G:
    s_waitcnt lgkmcnt(5)
    v_mfma_f32_16x16x32_bf16 v[176:179], v[56:59], v[224:227], v[176:179]
    ds_read_b64_tr_b16 v[52:53], v21 offset:43008
    v_mfma_f32_16x16x32_bf16 v[176:179], v[60:63], v[232:235], v[176:179]
    ds_read_b64_tr_b16 v[54:55], v21 offset:46592
    s_waitcnt vmcnt(12)
    v_max3_u32 v12, v248, v249, v250
    v_max3_u32 v13, v251, v252, v253
    v_max3_u32 v12, v12, v254, v255
    v_max_u32 v12, v12, v13
    v_cmp_eq_u32 vcc, -1, v12
    s_cbranch_vccnz qa_kernel_F0_A23_R
qa_kernel_F0_A23_G:
    v_mfma_f32_16x16x32_bf16 v[180:183], v[56:59], v[228:231], v[180:183]
    ds_read_b64_tr_b16 v[56:57], v21 offset:50176
    v_mfma_f32_16x16x32_bf16 v[180:183], v[60:63], v[236:239], v[180:183]
    ds_read_b64_tr_b16 v[58:59], v21 offset:53760
    s_add_u32 m0, s60, 29696
    s_nop 0
    buffer_load_dwordx4 v9, s[32:35], s59 offen lds
    s_waitcnt lgkmcnt(4)
    v_mfma_f32_16x16x32_bf16 v[72:75], v[64:67], v[240:243], v[72:75]
    ds_read_b64_tr_b16 v[60:61], v21 offset:28704
    v_mfma_f32_16x16x32_bf16 v[72:75], v[68:71], v[248:251], v[72:75]
    ds_read_b64_tr_b16 v[62:63], v21 offset:32288
    v_fmac_f32 v160, v30, v196
    v_fmac_f32 v161, v30, v197
    ds_read_b128 v[184:187], v20 offset:0
    v_mfma_f32_16x16x32_bf16 v[76:79], v[64:67], v[244:247], v[76:79]
    ds_read_b64_tr_b16 v[64:65], v21 offset:35872
    v_mfma_f32_16x16x32_bf16 v[76:79], v[68:71], v[252:255], v[76:79]
    ds_read_b64_tr_b16 v[66:67], v21 offset:39456
    v_fmac_f32 v162, v30, v198
    v_fmac_f32 v163, v30, v199
    s_waitcnt lgkmcnt(5)
    v_mfma_f32_16x16x32_bf16 v[80:83], v[52:55], v[240:243], v[80:83]
    ds_read_b64_tr_b16 v[68:69], v21 offset:43040
    v_mfma_f32_16x16x32_bf16 v[80:83], v[56:59], v[248:251], v[80:83]
    ds_read_b64_tr_b16 v[70:71], v21 offset:46624
    s_add_u32 m0, s60, 30720
    s_nop 0
    buffer_load_dwordx4 v10, s[32:35], s59 offen lds
    v_fmac_f32 v164, v31, v196
    v_fmac_f32 v165, v31, v197
    v_mfma_f32_16x16x32_bf16 v[84:87], v[52:55], v[244:247], v[84:87]
    ds_read_b64_tr_b16 v[52:53], v21 offset:50208
    v_mfma_f32_16x16x32_bf16 v[84:87], v[56:59], v[252:255], v[84:87]
    ds_read_b64_tr_b16 v[54:55], v21 offset:53792
    s_setprio 2
    v_fmac_f32 v166, v31, v198
    v_fmac_f32 v167, v31, v199
    s_waitcnt lgkmcnt(4)
    v_mfma_f32_16x16x32_bf16 v[88:91], v[60:63], v[240:243], v[88:91]
    ds_read_b64_tr_b16 v[56:57], v21 offset:28736
    v_mfma_f32_16x16x32_bf16 v[88:91], v[64:67], v[248:251], v[88:91]
    ds_read_b64_tr_b16 v[58:59], v21 offset:32320
    v_fmac_f32 v168, v30, v184
    v_fmac_f32 v169, v30, v185
    ds_read_b128 v[188:191], v20 offset:448
    v_mfma_f32_16x16x32_bf16 v[92:95], v[60:63], v[244:247], v[92:95]
    ds_read_b64_tr_b16 v[60:61], v21 offset:35904
    v_mfma_f32_16x16x32_bf16 v[92:95], v[64:67], v[252:255], v[92:95]
    ds_read_b64_tr_b16 v[62:63], v21 offset:39488
    s_add_u32 m0, s60, 31744
    s_mov_b32 exec_hi, 0
    buffer_load_dwordx4 v11, s[32:35], s59 offen lds
    s_mov_b32 exec_hi, -1
    s_add_u32 s59, s59, 458752
    v_fmac_f32 v170, v30, v186
    v_fmac_f32 v171, v30, v187
    s_waitcnt lgkmcnt(5)
    v_mfma_f32_16x16x32_bf16 v[96:99], v[68:71], v[240:243], v[96:99]
    ds_read_b64_tr_b16 v[64:65], v21 offset:43072
    v_mfma_f32_16x16x32_bf16 v[96:99], v[52:55], v[248:251], v[96:99]
    ds_read_b64_tr_b16 v[66:67], v21 offset:46656
    v_fmac_f32 v172, v31, v184
    v_fmac_f32 v173, v31, v185
    v_mfma_f32_16x16x32_bf16 v[100:103], v[68:71], v[244:247], v[100:103]
    ds_read_b64_tr_b16 v[68:69], v21 offset:50240
    v_mfma_f32_16x16x32_bf16 v[100:103], v[52:55], v[252:255], v[100:103]
    ds_read_b64_tr_b16 v[70:71], v21 offset:53824
    v_fmac_f32 v174, v31, v186
qa_kernel_WS1_4:
    s_cbranch_execz qa_kernel_WS1_12
    v_fmac_f32 v175, v31, v187
    s_waitcnt lgkmcnt(4)
    v_mfma_f32_16x16x32_bf16 v[104:107], v[56:59], v[240:243], v[104:107]
    ds_read_b64_tr_b16 v[52:53], v21 offset:28768
    v_mfma_f32_16x16x32_bf16 v[104:107], v[60:63], v[248:251], v[104:107]
    ds_read_b64_tr_b16 v[54:55], v21 offset:32352
    buffer_load_dwordx4 v[224:227], v15, s[36:39], s61 offen offset:2048 sc1
    v_fmac_f32 v176, v30, v188
    v_fmac_f32 v177, v30, v189
    v_mfma_f32_16x16x32_bf16 v[108:111], v[56:59], v[244:247], v[108:111]
    ds_read_b64_tr_b16 v[56:57], v21 offset:35936
    v_mfma_f32_16x16x32_bf16 v[108:111], v[60:63], v[252:255], v[108:111]
    ds_read_b64_tr_b16 v[58:59], v21 offset:39520
    v_fmac_f32 v178, v30, v190
    v_fmac_f32 v179, v30, v191
    s_waitcnt lgkmcnt(4)
    v_mfma_f32_16x16x32_bf16 v[112:115], v[64:67], v[240:243], v[112:115]
    ds_read_b64_tr_b16 v[60:61], v21 offset:43104
    v_mfma_f32_16x16x32_bf16 v[112:115], v[68:71], v[248:251], v[112:115]
    ds_read_b64_tr_b16 v[62:63], v21 offset:46688
    s_setprio 1
    v_fmac_f32 v180, v31, v188
    v_fmac_f32 v181, v31, v189
    v_mfma_f32_16x16x32_bf16 v[116:119], v[64:67], v[244:247], v[116:119]
    ds_read_b64_tr_b16 v[64:65], v21 offset:50272
    v_mfma_f32_16x16x32_bf16 v[116:119], v[68:71], v[252:255], v[116:119]
    ds_read_b64_tr_b16 v[66:67], v21 offset:53856
    buffer_load_dwordx4 v[228:231], v16, s[36:39], s61 offen offset:2048 sc1
    v_fmac_f32 v182, v31, v190
    v_fmac_f32 v183, v31, v191
    s_waitcnt lgkmcnt(4)
    v_mfma_f32_16x16x32_bf16 v[120:123], v[52:55], v[240:243], v[120:123]
    ds_read_b64_tr_b16 v[68:69], v21 offset:28800
    v_mfma_f32_16x16x32_bf16 v[120:123], v[56:59], v[248:251], v[120:123]
    ds_read_b64_tr_b16 v[70:71], v21 offset:32384
    v_mfma_f32_16x16x32_bf16 v[124:127], v[52:55], v[244:247], v[124:127]
    ds_read_b64_tr_b16 v[52:53], v21 offset:35968
    v_mfma_f32_16x16x32_bf16 v[124:127], v[56:59], v[252:255], v[124:127]
    ds_read_b64_tr_b16 v[54:55], v21 offset:39552
    s_waitcnt lgkmcnt(4)
    v_mfma_f32_16x16x32_bf16 v[128:131], v[60:63], v[240:243], v[128:131]
    ds_read_b64_tr_b16 v[56:57], v21 offset:43136
    v_mfma_f32_16x16x32_bf16 v[128:131], v[64:67], v[248:251], v[128:131]
    ds_read_b64_tr_b16 v[58:59], v21 offset:46720
    buffer_load_dwordx4 v[232:235], v15, s[36:39], s61 offen offset:3072 sc1
    v_mfma_f32_16x16x32_bf16 v[132:135], v[60:63], v[244:247], v[132:135]
    ds_read_b64_tr_b16 v[60:61], v21 offset:50304
    v_mfma_f32_16x16x32_bf16 v[132:135], v[64:67], v[252:255], v[132:135]
    ds_read_b64_tr_b16 v[62:63], v21 offset:53888
    s_waitcnt lgkmcnt(4)
    v_mfma_f32_16x16x32_bf16 v[136:139], v[68:71], v[240:243], v[136:139]
    ds_read_b64_tr_b16 v[64:65], v21 offset:28832
    v_mfma_f32_16x16x32_bf16 v[136:139], v[52:55], v[248:251], v[136:139]
    ds_read_b64_tr_b16 v[66:67], v21 offset:32416
    v_mfma_f32_16x16x32_bf16 v[140:143], v[68:71], v[244:247], v[140:143]
    ds_read_b64_tr_b16 v[68:69], v21 offset:36000
    v_mfma_f32_16x16x32_bf16 v[140:143], v[52:55], v[252:255], v[140:143]
    ds_read_b64_tr_b16 v[70:71], v21 offset:39584
    s_setprio 0
    buffer_load_dwordx4 v[236:239], v16, s[36:39], s61 offen offset:3072 sc1
    s_add_u32 s61, s61, 4096
    s_waitcnt lgkmcnt(4)
    v_mfma_f32_16x16x32_bf16 v[144:147], v[56:59], v[240:243], v[144:147]
    ds_read_b64_tr_b16 v[52:53], v21 offset:43168
    v_mfma_f32_16x16x32_bf16 v[144:147], v[60:63], v[248:251], v[144:147]
    ds_read_b64_tr_b16 v[54:55], v21 offset:46752
    v_mfma_f32_16x16x32_bf16 v[148:151], v[56:59], v[244:247], v[148:151]
    ds_read_b64_tr_b16 v[56:57], v21 offset:50336
    v_mfma_f32_16x16x32_bf16 v[148:151], v[60:63], v[252:255], v[148:151]
    ds_read_b64_tr_b16 v[58:59], v21 offset:53920
    s_waitcnt lgkmcnt(4)
    v_mfma_f32_16x16x32_bf16 v[152:155], v[64:67], v[240:243], v[152:155]
    ds_read_b64_tr_b16 v[60:61], v23 offset:28672
    v_mfma_f32_16x16x32_bf16 v[152:155], v[68:71], v[248:251], v[152:155]
    ds_read_b64_tr_b16 v[62:63], v23 offset:32256
    v_mfma_f32_16x16x32_bf16 v[156:159], v[64:67], v[244:247], v[156:159]
    ds_read_b64_tr_b16 v[64:65], v23 offset:35840
    v_mfma_f32_16x16x32_bf16 v[156:159], v[68:71], v[252:255], v[156:159]
    ds_read_b64_tr_b16 v[66:67], v23 offset:39424
    s_waitcnt lgkmcnt(4)
    v_mfma_f32_16x16x32_bf16 v[160:163], v[52:55], v[240:243], v[160:163]
    ds_read_b64_tr_b16 v[68:69], v23 offset:43008
    v_mfma_f32_16x16x32_bf16 v[160:163], v[56:59], v[248:251], v[160:163]
    ds_read_b64_tr_b16 v[70:71], v23 offset:46592
    v_mfma_f32_16x16x32_bf16 v[164:167], v[52:55], v[244:247], v[164:167]
    ds_read_b64_tr_b16 v[52:53], v23 offset:50176
    v_mfma_f32_16x16x32_bf16 v[164:167], v[56:59], v[252:255], v[164:167]
    ds_read_b64_tr_b16 v[54:55], v23 offset:53760
    s_waitcnt lgkmcnt(4)
    v_mfma_f32_16x16x32_bf16 v[168:171], v[60:63], v[240:243], v[168:171]
    s_waitcnt vmcnt(16)
    s_barrier
    ds_read_b64_tr_b16 v[56:57], v21 offset:57344
    v_mfma_f32_16x16x32_bf16 v[168:171], v[64:67], v[248:251], v[168:171]
    ds_read_b64_tr_b16 v[58:59], v21 offset:60928
    s_setprio 3
    s_add_u32 m0, s60, 65536
    s_nop 0
    buffer_load_dwordx4 v8, s[32:35], s59 offen lds
    v_mfma_f32_16x16x32_bf16 v[172:175], v[60:63], v[244:247], v[172:175]
    ds_read_b64_tr_b16 v[60:61], v21 offset:64512
    v_mfma_f32_16x16x32_bf16 v[172:175], v[64:67], v[252:255], v[172:175]
    ds_read_b64_tr_b16 v[62:63], v22 offset:2560
    s_waitcnt vmcnt(14)
    v_max3_u32 v12, v208, v209, v210
    v_max3_u32 v13, v211, v212, v213
    v_max3_u32 v12, v12, v214, v215
    v_max_u32 v12, v12, v13
    v_cmp_eq_u32 vcc, -1, v12
    s_cbranch_vccnz qa_kernel_F0_A24_R
qa_kernel_F0_A24_G:
    s_waitcnt lgkmcnt(4)
    v_mfma_f32_16x16x32_bf16 v[176:179], v[68:71], v[240:243], v[176:179]
    ds_read_b64_tr_b16 v[64:65], v22 offset:6144
    v_mfma_f32_16x16x32_bf16 v[176:179], v[52:55], v[248:251], v[176:179]
    ds_read_b64_tr_b16 v[66:67], v22 offset:9728
    s_waitcnt vmcnt(12)
    v_max3_u32 v12, v216, v217, v218
    v_max3_u32 v13, v219, v220, v221
    v_max3_u32 v12, v12, v222, v223
    v_max_u32 v12, v12, v13
    v_cmp_eq_u32 vcc, -1, v12
    s_cbranch_vccnz qa_kernel_F0_A25_R
qa_kernel_F0_A25_G:
    v_mfma_f32_16x16x32_bf16 v[180:183], v[68:71], v[244:247], v[180:183]
    ds_read_b64_tr_b16 v[68:69], v22 offset:13312
    v_mfma_f32_16x16x32_bf16 v[180:183], v[52:55], v[252:255], v[180:183]
    ds_read_b64_tr_b16 v[70:71], v22 offset:16896
    s_add_u32 m0, s60, 66560
    s_nop 0
    buffer_load_dwordx4 v9, s[32:35], s59 offen lds
    s_waitcnt lgkmcnt(4)
    v_mfma_f32_16x16x32_bf16 v[72:75], v[56:59], v[208:211], v[72:75]
    ds_read_b64_tr_b16 v[52:53], v21 offset:57376
    v_mfma_f32_16x16x32_bf16 v[72:75], v[60:63], v[216:219], v[72:75]
    ds_read_b64_tr_b16 v[54:55], v21 offset:60960
    v_mfma_f32_16x16x32_bf16 v[76:79], v[56:59], v[212:215], v[76:79]
    ds_read_b64_tr_b16 v[56:57], v21 offset:64544
    v_mfma_f32_16x16x32_bf16 v[76:79], v[60:63], v[220:223], v[76:79]
    ds_read_b64_tr_b16 v[58:59], v22 offset:2592
    s_waitcnt lgkmcnt(4)
    v_mfma_f32_16x16x32_bf16 v[80:83], v[64:67], v[208:211], v[80:83]
    ds_read_b64_tr_b16 v[60:61], v22 offset:6176
    v_mfma_f32_16x16x32_bf16 v[80:83], v[68:71], v[216:219], v[80:83]
    ds_read_b64_tr_b16 v[62:63], v22 offset:9760
    s_add_u32 m0, s60, 67584
    s_nop 0
    buffer_load_dwordx4 v10, s[32:35], s59 offen lds
    v_mfma_f32_16x16x32_bf16 v[84:87], v[64:67], v[212:215], v[84:87]
    ds_read_b64_tr_b16 v[64:65], v22 offset:13344
    v_mfma_f32_16x16x32_bf16 v[84:87], v[68:71], v[220:223], v[84:87]
    ds_read_b64_tr_b16 v[66:67], v22 offset:16928
    s_setprio 2
    s_waitcnt lgkmcnt(4)
    v_mfma_f32_16x16x32_bf16 v[88:91], v[52:55], v[208:211], v[88:91]
    ds_read_b64_tr_b16 v[68:69], v21 offset:57408
    v_mfma_f32_16x16x32_bf16 v[88:91], v[56:59], v[216:219], v[88:91]
    ds_read_b64_tr_b16 v[70:71], v21 offset:60992
    v_mfma_f32_16x16x32_bf16 v[92:95], v[52:55], v[212:215], v[92:95]
    ds_read_b64_tr_b16 v[52:53], v21 offset:64576
    v_mfma_f32_16x16x32_bf16 v[92:95], v[56:59], v[220:223], v[92:95]
    ds_read_b64_tr_b16 v[54:55], v22 offset:2624
    s_add_u32 m0, s60, 68608
    s_mov_b32 exec_hi, 0
    buffer_load_dwordx4 v11, s[32:35], s59 offen lds
    s_mov_b32 exec_hi, -1
    s_add_u32 s59, s59, 458752
    s_waitcnt lgkmcnt(4)
    v_mfma_f32_16x16x32_bf16 v[96:99], v[60:63], v[208:211], v[96:99]
    ds_read_b64_tr_b16 v[56:57], v22 offset:6208
    v_mfma_f32_16x16x32_bf16 v[96:99], v[64:67], v[216:219], v[96:99]
    ds_read_b64_tr_b16 v[58:59], v22 offset:9792
    v_mfma_f32_16x16x32_bf16 v[100:103], v[60:63], v[212:215], v[100:103]
    ds_read_b64_tr_b16 v[60:61], v22 offset:13376
    v_mfma_f32_16x16x32_bf16 v[100:103], v[64:67], v[220:223], v[100:103]
    ds_read_b64_tr_b16 v[62:63], v22 offset:16960
    s_waitcnt lgkmcnt(4)
    v_mfma_f32_16x16x32_bf16 v[104:107], v[68:71], v[208:211], v[104:107]
    ds_read_b64_tr_b16 v[64:65], v21 offset:57440
    v_mfma_f32_16x16x32_bf16 v[104:107], v[52:55], v[216:219], v[104:107]
    ds_read_b64_tr_b16 v[66:67], v21 offset:61024
    buffer_load_dwordx4 v[240:243], v15, s[36:39], s61 offen offset:0 sc1
    v_mfma_f32_16x16x32_bf16 v[108:111], v[68:71], v[212:215], v[108:111]
    ds_read_b64_tr_b16 v[68:69], v21 offset:64608
    v_mfma_f32_16x16x32_bf16 v[108:111], v[52:55], v[220:223], v[108:111]
    ds_read_b64_tr_b16 v[70:71], v22 offset:2656
    s_waitcnt lgkmcnt(4)
    v_mfma_f32_16x16x32_bf16 v[112:115], v[56:59], v[208:211], v[112:115]
    ds_read_b64_tr_b16 v[52:53], v22 offset:6240
    v_mfma_f32_16x16x32_bf16 v[112:115], v[60:63], v[216:219], v[112:115]
    ds_read_b64_tr_b16 v[54:55], v22 offset:9824
    s_setprio 1
    v_mfma_f32_16x16x32_bf16 v[116:119], v[56:59], v[212:215], v[116:119]
    ds_read_b64_tr_b16 v[56:57], v22 offset:13408
    v_mfma_f32_16x16x32_bf16 v[116:119], v[60:63], v[220:223], v[116:119]
    ds_read_b64_tr_b16 v[58:59], v22 offset:16992
    buffer_load_dwordx4 v[244:247], v16, s[36:39], s61 offen offset:0 sc1
    s_waitcnt lgkmcnt(4)
    v_mfma_f32_16x16x32_bf16 v[120:123], v[64:67], v[208:211], v[120:123]
    ds_read_b64_tr_b16 v[60:61], v21 offset:57472
    v_mfma_f32_16x16x32_bf16 v[120:123], v[68:71], v[216:219], v[120:123]
    ds_read_b64_tr_b16 v[62:63], v21 offset:61056
    v_mfma_f32_16x16x32_bf16 v[124:127], v[64:67], v[212:215], v[124:127]
    ds_read_b64_tr_b16 v[64:65], v21 offset:64640
    v_mfma_f32_16x16x32_bf16 v[124:127], v[68:71], v[220:223], v[124:127]
    ds_read_b64_tr_b16 v[66:67], v22 offset:2688
    s_waitcnt lgkmcnt(4)
    v_mfma_f32_16x16x32_bf16 v[128:131], v[52:55], v[208:211], v[128:131]
    ds_read_b64_tr_b16 v[68:69], v22 offset:6272
    v_mfma_f32_16x16x32_bf16 v[128:131], v[56:59], v[216:219], v[128:131]
    ds_read_b64_tr_b16 v[70:71], v22 offset:9856
    buffer_load_dwordx4 v[248:251], v15, s[36:39], s61 offen offset:1024 sc1
    v_mfma_f32_16x16x32_bf16 v[132:135], v[52:55], v[212:215], v[132:135]
    ds_read_b64_tr_b16 v[52:53], v22 offset:13440
    v_mfma_f32_16x16x32_bf16 v[132:135], v[56:59], v[220:223], v[132:135]
    ds_read_b64_tr_b16 v[54:55], v22 offset:17024
    s_waitcnt lgkmcnt(4)
    v_mfma_f32_16x16x32_bf16 v[136:139], v[60:63], v[208:211], v[136:139]
    ds_read_b64_tr_b16 v[56:57], v21 offset:57504
    v_mfma_f32_16x16x32_bf16 v[136:139], v[64:67], v[216:219], v[136:139]
    ds_read_b64_tr_b16 v[58:59], v21 offset:61088
    buffer_load_dwordx4 v[252:255], v16, s[36:39], s61 offen offset:1024 sc1
    v_mfma_f32_16x16x32_bf16 v[140:143], v[60:63], v[212:215], v[140:143]
    ds_read_b64_tr_b16 v[60:61], v21 offset:64672
    v_mfma_f32_16x16x32_bf16 v[140:143], v[64:67], v[220:223], v[140:143]
    ds_read_b64_tr_b16 v[62:63], v22 offset:2720
    s_setprio 0
    s_waitcnt lgkmcnt(4)
    v_mfma_f32_16x16x32_bf16 v[144:147], v[68:71], v[208:211], v[144:147]
    ds_read_b64_tr_b16 v[64:65], v22 offset:6304
    v_mfma_f32_16x16x32_bf16 v[144:147], v[52:55], v[216:219], v[144:147]
    ds_read_b64_tr_b16 v[66:67], v22 offset:9888
    v_mfma_f32_16x16x32_bf16 v[148:151], v[68:71], v[212:215], v[148:151]
    ds_read_b64_tr_b16 v[68:69], v22 offset:13472
    v_mfma_f32_16x16x32_bf16 v[148:151], v[52:55], v[220:223], v[148:151]
    ds_read_b64_tr_b16 v[70:71], v22 offset:17056
    s_waitcnt lgkmcnt(4)
    v_mfma_f32_16x16x32_bf16 v[152:155], v[56:59], v[208:211], v[152:155]
    ds_read_b64_tr_b16 v[52:53], v23 offset:57344
    v_mfma_f32_16x16x32_bf16 v[152:155], v[60:63], v[216:219], v[152:155]
    ds_read_b64_tr_b16 v[54:55], v23 offset:60928
    v_mfma_f32_16x16x32_bf16 v[156:159], v[56:59], v[212:215], v[156:159]
    ds_read_b64_tr_b16 v[56:57], v23 offset:64512
    v_mfma_f32_16x16x32_bf16 v[156:159], v[60:63], v[220:223], v[156:159]
    ds_read_b64_tr_b16 v[58:59], v24 offset:2560
    s_waitcnt lgkmcnt(4)
    v_mfma_f32_16x16x32_bf16 v[160:163], v[64:67], v[208:211], v[160:163]
    ds_read_b64_tr_b16 v[60:61], v24 offset:6144
    v_mfma_f32_16x16x32_bf16 v[160:163], v[68:71], v[216:219], v[160:163]
    ds_read_b64_tr_b16 v[62:63], v24 offset:9728
    v_mfma_f32_16x16x32_bf16 v[164:167], v[64:67], v[212:215], v[164:167]
    ds_read_b64_tr_b16 v[64:65], v24 offset:13312
    v_mfma_f32_16x16x32_bf16 v[164:167], v[68:71], v[220:223], v[164:167]
    ds_read_b64_tr_b16 v[66:67], v24 offset:16896
    s_waitcnt lgkmcnt(4)
    v_mfma_f32_16x16x32_bf16 v[168:171], v[52:55], v[208:211], v[168:171]
    s_waitcnt vmcnt(16)
    s_barrier
    ds_read_b64_tr_b16 v[68:69], v17 offset:0
    v_mfma_f32_16x16x32_bf16 v[168:171], v[56:59], v[216:219], v[168:171]
    ds_read_b64_tr_b16 v[70:71], v17 offset:3584
    s_setprio 3
    v_mfma_f32_16x16x32_bf16 v[172:175], v[52:55], v[212:215], v[172:175]
    ds_read_b64_tr_b16 v[52:53], v17 offset:7168
    v_mfma_f32_16x16x32_bf16 v[172:175], v[56:59], v[220:223], v[172:175]
    ds_read_b64_tr_b16 v[54:55], v17 offset:10752
    s_setprio 2
    s_waitcnt vmcnt(10)
    v_max3_u32 v12, v224, v225, v226
    v_max3_u32 v13, v227, v228, v229
    v_max3_u32 v12, v12, v230, v231
    v_max_u32 v12, v12, v13
    v_cmp_eq_u32 vcc, -1, v12
    s_cbranch_vccnz qa_kernel_F0_A26_R
qa_kernel_F0_A26_G:
    s_waitcnt lgkmcnt(4)
    v_mfma_f32_16x16x32_bf16 v[176:179], v[60:63], v[208:211], v[176:179]
    ds_read_b64_tr_b16 v[56:57], v17 offset:14336
    v_mfma_f32_16x16x32_bf16 v[176:179], v[64:67], v[216:219], v[176:179]
    ds_read_b64_tr_b16 v[58:59], v17 offset:17920
    s_setprio 1
    s_waitcnt vmcnt(8)
    v_max3_u32 v12, v232, v233, v234
    v_max3_u32 v13, v235, v236, v237
    v_max3_u32 v12, v12, v238, v239
    v_max_u32 v12, v12, v13
    v_cmp_eq_u32 vcc, -1, v12
    s_cbranch_vccnz qa_kernel_F0_A27_R
qa_kernel_F0_A27_G:
    v_mfma_f32_16x16x32_bf16 v[180:183], v[60:63], v[212:215], v[180:183]
    ds_read_b64_tr_b16 v[60:61], v17 offset:21504
    v_mfma_f32_16x16x32_bf16 v[180:183], v[64:67], v[220:223], v[180:183]
    ds_read_b64_tr_b16 v[62:63], v17 offset:25088
    s_setprio 0
    buffer_load_dwordx4 v[208:211], v15, s[36:39], s61 offen offset:2048 sc1
    s_waitcnt lgkmcnt(4)
    v_mfma_f32_16x16x32_bf16 v[72:75], v[68:71], v[224:227], v[72:75]
    s_barrier
    ds_read_b64_tr_b16 v[64:65], v17 offset:28672
    v_mfma_f32_16x16x32_bf16 v[72:75], v[52:55], v[232:235], v[72:75]
    ds_read_b64_tr_b16 v[66:67], v17 offset:32256
    s_setprio 3
    buffer_load_dwordx4 v[212:215], v16, s[36:39], s61 offen offset:2048 sc1
    v_mfma_f32_16x16x32_bf16 v[76:79], v[68:71], v[228:231], v[76:79]
    ds_read_b64_tr_b16 v[68:69], v17 offset:35840
    v_mfma_f32_16x16x32_bf16 v[76:79], v[52:55], v[236:239], v[76:79]
    ds_read_b64_tr_b16 v[70:71], v17 offset:39424
    s_setprio 2
    buffer_load_dwordx4 v[216:219], v15, s[36:39], s61 offen offset:3072 sc1
    s_waitcnt vmcnt(5)
    v_max3_u32 v12, v240, v241, v242
    v_max3_u32 v13, v243, v244, v245
    v_max3_u32 v12, v12, v246, v247
    v_max_u32 v12, v12, v13
    v_cmp_eq_u32 vcc, -1, v12
    s_cbranch_vccnz qa_kernel_F0_A28_R
qa_kernel_F0_A28_G:
    s_waitcnt lgkmcnt(4)
    v_mfma_f32_16x16x32_bf16 v[80:83], v[56:59], v[224:227], v[80:83]
    ds_read_b64_tr_b16 v[52:53], v17 offset:43008
    v_mfma_f32_16x16x32_bf16 v[80:83], v[60:63], v[232:235], v[80:83]
    ds_read_b64_tr_b16 v[54:55], v17 offset:46592
    s_setprio 1
    buffer_load_dwordx4 v[220:223], v16, s[36:39], s61 offen offset:3072 sc1
    s_add_u32 s61, s61, 4096
    s_waitcnt vmcnt(4)
    v_max3_u32 v12, v248, v249, v250
    v_max3_u32 v13, v251, v252, v253
    v_max3_u32 v12, v12, v254, v255
    v_max_u32 v12, v12, v13
    v_cmp_eq_u32 vcc, -1, v12
    s_cbranch_vccnz qa_kernel_F0_A29_R
qa_kernel_F0_A29_G:
    v_mfma_f32_16x16x32_bf16 v[84:87], v[56:59], v[228:231], v[84:87]
    ds_read_b64_tr_b16 v[56:57], v17 offset:50176
    v_mfma_f32_16x16x32_bf16 v[84:87], v[60:63], v[236:239], v[84:87]
    ds_read_b64_tr_b16 v[58:59], v17 offset:53760
    s_setprio 0
    s_waitcnt lgkmcnt(4)
    v_mfma_f32_16x16x32_bf16 v[72:75], v[64:67], v[240:243], v[72:75]
    s_barrier
    ds_read_b64_tr_b16 v[60:61], v21 offset:0
    v_mfma_f32_16x16x32_bf16 v[72:75], v[68:71], v[248:251], v[72:75]
    ds_read_b64_tr_b16 v[62:63], v21 offset:3584
    s_setprio 3
    v_mfma_f32_16x16x32_bf16 v[76:79], v[64:67], v[244:247], v[76:79]
    ds_read_b64_tr_b16 v[64:65], v21 offset:7168
    v_mfma_f32_16x16x32_bf16 v[76:79], v[68:71], v[252:255], v[76:79]
    ds_read_b64_tr_b16 v[66:67], v21 offset:10752
    s_waitcnt vmcnt(2)
    v_max3_u32 v12, v208, v209, v210
    v_max3_u32 v13, v211, v212, v213
    v_max3_u32 v12, v12, v214, v215
    v_max_u32 v12, v12, v13
    v_cmp_eq_u32 vcc, -1, v12
    s_cbranch_vccnz qa_kernel_F0_A30_R
qa_kernel_F0_A30_G:
    s_waitcnt lgkmcnt(4)
    v_mfma_f32_16x16x32_bf16 v[80:83], v[52:55], v[240:243], v[80:83]
    ds_read_b64_tr_b16 v[68:69], v21 offset:14336
    v_mfma_f32_16x16x32_bf16 v[80:83], v[56:59], v[248:251], v[80:83]
    ds_read_b64_tr_b16 v[70:71], v21 offset:17920
    s_waitcnt vmcnt(0)
    v_max3_u32 v12, v216, v217, v218
    v_max3_u32 v13, v219, v220, v221
    v_max3_u32 v12, v12, v222, v223
    v_max_u32 v12, v12, v13
    v_cmp_eq_u32 vcc, -1, v12
    s_cbranch_vccnz qa_kernel_F0_A31_R
qa_kernel_F0_A31_G:
    v_mfma_f32_16x16x32_bf16 v[84:87], v[52:55], v[244:247], v[84:87]
    ds_read_b64_tr_b16 v[52:53], v21 offset:21504
    v_mfma_f32_16x16x32_bf16 v[84:87], v[56:59], v[252:255], v[84:87]
    ds_read_b64_tr_b16 v[54:55], v21 offset:25088
    s_waitcnt lgkmcnt(4)
    v_mfma_f32_16x16x32_bf16 v[72:75], v[60:63], v[208:211], v[72:75]
    ds_read_b64_tr_b16 v[56:57], v17 offset:32
    v_mfma_f32_16x16x32_bf16 v[72:75], v[64:67], v[216:219], v[72:75]
    ds_read_b64_tr_b16 v[58:59], v17 offset:3616
    v_mfma_f32_16x16x32_bf16 v[76:79], v[60:63], v[212:215], v[76:79]
    ds_read_b64_tr_b16 v[60:61], v17 offset:7200
    v_mfma_f32_16x16x32_bf16 v[76:79], v[64:67], v[220:223], v[76:79]
    ds_read_b64_tr_b16 v[62:63], v17 offset:10784
    s_waitcnt lgkmcnt(4)
    v_mfma_f32_16x16x32_bf16 v[80:83], v[68:71], v[208:211], v[80:83]
    ds_read_b64_tr_b16 v[64:65], v17 offset:14368
    v_mfma_f32_16x16x32_bf16 v[80:83], v[52:55], v[216:219], v[80:83]
    ds_read_b64_tr_b16 v[66:67], v17 offset:17952
    s_add_u32 m0, s54, 98304
    s_mov_b32 s74, 0
    buffer_load_dwordx4 v37, s[28:31], s74 offen lds
    v_mfma_f32_16x16x32_bf16 v[84:87], v[68:71], v[212:215], v[84:87]
    ds_read_b64_tr_b16 v[68:69], v17 offset:21536
    v_mfma_f32_16x16x32_bf16 v[84:87], v[52:55], v[220:223], v[84:87]
    ds_read_b64_tr_b16 v[70:71], v17 offset:25120
    s_waitcnt lgkmcnt(4)
    v_mfma_f32_16x16x32_bf16 v[88:91], v[56:59], v[224:227], v[88:91]
    ds_read_b64_tr_b16 v[52:53], v17 offset:28704
    v_mfma_f32_16x16x32_bf16 v[88:91], v[60:63], v[232:235], v[88:91]
    ds_read_b64_tr_b16 v[54:55], v17 offset:32288
    v_mfma_f32_16x16x32_bf16 v[92:95], v[56:59], v[228:231], v[92:95]
    ds_read_b64_tr_b16 v[56:57], v17 offset:35872
    v_mfma_f32_16x16x32_bf16 v[92:95], v[60:63], v[236:239], v[92:95]
    ds_read_b64_tr_b16 v[58:59], v17 offset:39456
    v_mul_f32 v184, v34, v72
    v_mul_f32 v185, v34, v73
    v_mul_f32 v186, v34, v74
    v_mul_f32 v187, v34, v75
    v_mul_f32 v188, v35, v76
    v_mul_f32 v189, v35, v77
    s_waitcnt lgkmcnt(4)
    v_mfma_f32_16x16x32_bf16 v[96:99], v[64:67], v[224:227], v[96:99]
    ds_read_b64_tr_b16 v[60:61], v17 offset:43040
    v_mfma_f32_16x16x32_bf16 v[96:99], v[68:71], v[232:235], v[96:99]
    ds_read_b64_tr_b16 v[62:63], v17 offset:46624
    v_mul_f32 v190, v35, v78
    v_mul_f32 v191, v35, v79
    v_exp_f32 v184, v184
    v_exp_f32 v185, v185
    v_exp_f32 v186, v186
    v_exp_f32 v187, v187
    s_add_u32 m0, s54, 102400
    s_mov_b32 s74, 0
    buffer_load_dwordx4 v38, s[28:31], s74 offen lds
    v_mfma_f32_16x16x32_bf16 v[100:103], v[64:67], v[228:231], v[100:103]
    ds_read_b64_tr_b16 v[64:65], v17 offset:50208
    v_mfma_f32_16x16x32_bf16 v[100:103], v[68:71], v[236:239], v[100:103]
    ds_read_b64_tr_b16 v[66:67], v17 offset:53792
    v_exp_f32 v188, v188
    v_exp_f32 v189, v189
    v_exp_f32 v190, v190
    v_exp_f32 v191, v191
    v_mul_f32 v72, v72, v80
    v_mul_f32 v73, v73, v81
    s_waitcnt lgkmcnt(4)
    v_mfma_f32_16x16x32_bf16 v[88:91], v[52:55], v[240:243], v[88:91]
    ds_read_b64_tr_b16 v[68:69], v21 offset:32
    v_mfma_f32_16x16x32_bf16 v[88:91], v[56:59], v[248:251], v[88:91]
    ds_read_b64_tr_b16 v[70:71], v21 offset:3616
    v_mul_f32 v74, v74, v82
    v_mul_f32 v75, v75, v83
    v_mul_f32 v76, v76, v84
    v_mul_f32 v77, v77, v85
    v_mul_f32 v78, v78, v86
    v_mul_f32 v79, v79, v87
    v_mfma_f32_16x16x32_bf16 v[92:95], v[52:55], v[244:247], v[92:95]
    ds_read_b64_tr_b16 v[52:53], v21 offset:7200
    v_mfma_f32_16x16x32_bf16 v[92:95], v[56:59], v[252:255], v[92:95]
    ds_read_b64_tr_b16 v[54:55], v21 offset:10784
    v_fma_f32 v184, v184, v32, v32
    v_fma_f32 v185, v185, v32, v32
    v_fma_f32 v186, v186, v32, v32
    v_fma_f32 v187, v187, v32, v32
    v_fma_f32 v188, v188, v33, v33
    v_fma_f32 v189, v189, v33, v33
    s_waitcnt lgkmcnt(4)
    v_mfma_f32_16x16x32_bf16 v[96:99], v[60:63], v[240:243], v[96:99]
    ds_read_b64_tr_b16 v[56:57], v21 offset:14368
    v_mfma_f32_16x16x32_bf16 v[96:99], v[64:67], v[248:251], v[96:99]
    ds_read_b64_tr_b16 v[58:59], v21 offset:17952
    v_fma_f32 v190, v190, v33, v33
    v_fma_f32 v191, v191, v33, v33
    v_rcp_f32 v184, v184
    v_rcp_f32 v185, v185
    v_rcp_f32 v186, v186
    v_rcp_f32 v187, v187
    s_add_u32 m0, s54, 114688
    s_mov_b32 s74, 262144
    buffer_load_dwordx4 v37, s[28:31], s74 offen lds
    v_mfma_f32_16x16x32_bf16 v[100:103], v[60:63], v[244:247], v[100:103]
    ds_read_b64_tr_b16 v[60:61], v21 offset:21536
    v_mfma_f32_16x16x32_bf16 v[100:103], v[64:67], v[252:255], v[100:103]
    ds_read_b64_tr_b16 v[62:63], v21 offset:25120
    v_rcp_f32 v188, v188
    v_rcp_f32 v189, v189
    v_rcp_f32 v190, v190
    v_rcp_f32 v191, v191
    v_mul_f32 v72, v72, v184
    v_mul_f32 v73, v73, v185
    s_waitcnt lgkmcnt(4)
    v_mfma_f32_16x16x32_bf16 v[88:91], v[68:71], v[208:211], v[88:91]
    ds_read_b64_tr_b16 v[64:65], v17 offset:64
    v_mfma_f32_16x16x32_bf16 v[88:91], v[52:55], v[216:219], v[88:91]
    ds_read_b64_tr_b16 v[66:67], v17 offset:3648
    v_mul_f32 v74, v74, v186
    v_mul_f32 v75, v75, v187
    v_mul_f32 v76, v76, v188
    v_mul_f32 v77, v77, v189
    v_mul_f32 v78, v78, v190
    v_mul_f32 v79, v79, v191
    v_mfma_f32_16x16x32_bf16 v[92:95], v[68:71], v[212:215], v[92:95]
    ds_read_b64_tr_b16 v[68:69], v17 offset:7232
    v_mfma_f32_16x16x32_bf16 v[92:95], v[52:55], v[220:223], v[92:95]
    ds_read_b64_tr_b16 v[70:71], v17 offset:10816
    v_cvt_pk_bf16_f32 v200, v72, v73
    v_cvt_pk_bf16_f32 v201, v74, v75
    v_cvt_pk_bf16_f32 v204, v76, v77
    v_cvt_pk_bf16_f32 v205, v78, v79
    v_min_u32 v200, -2, v200
    v_min_u32 v201, -2, v201
    s_waitcnt lgkmcnt(4)
    v_mfma_f32_16x16x32_bf16 v[96:99], v[56:59], v[208:211], v[96:99]
    ds_read_b64_tr_b16 v[52:53], v17 offset:14400
    v_mfma_f32_16x16x32_bf16 v[96:99], v[60:63], v[216:219], v[96:99]
    ds_read_b64_tr_b16 v[54:55], v17 offset:17984
    v_min_u32 v204, -2, v204
    v_min_u32 v205, -2, v205
    s_add_u32 m0, s54, 118784
    s_mov_b32 s74, 262144
    buffer_load_dwordx4 v38, s[28:31], s74 offen lds
    v_mfma_f32_16x16x32_bf16 v[100:103], v[56:59], v[212:215], v[100:103]
    ds_read_b64_tr_b16 v[56:57], v17 offset:21568
    v_mfma_f32_16x16x32_bf16 v[100:103], v[60:63], v[220:223], v[100:103]
    ds_read_b64_tr_b16 v[58:59], v17 offset:25152
    s_waitcnt lgkmcnt(4)
    v_mfma_f32_16x16x32_bf16 v[104:107], v[64:67], v[224:227], v[104:107]
    ds_read_b64_tr_b16 v[60:61], v17 offset:28736
    v_mfma_f32_16x16x32_bf16 v[104:107], v[68:71], v[232:235], v[104:107]
    ds_read_b64_tr_b16 v[62:63], v17 offset:32320
    s_setprio 2
    v_mfma_f32_16x16x32_bf16 v[108:111], v[64:67], v[228:231], v[108:111]
    ds_read_b64_tr_b16 v[64:65], v17 offset:35904
    v_mfma_f32_16x16x32_bf16 v[108:111], v[68:71], v[236:239], v[108:111]
    ds_read_b64_tr_b16 v[66:67], v17 offset:39488
    v_mul_f32 v184, v34, v88
    v_mul_f32 v185, v34, v89
    v_mul_f32 v186, v34, v90
    v_mul_f32 v187, v34, v91
    v_mul_f32 v188, v35, v92
    v_mul_f32 v189, v35, v93
    v_mul_f32 v190, v35, v94
    v_mul_f32 v191, v35, v95
    v_exp_f32 v184, v184
    v_exp_f32 v185, v185
    s_waitcnt lgkmcnt(4)
    v_mfma_f32_16x16x32_bf16 v[112:115], v[52:55], v[224:227], v[112:115]
    ds_read_b64_tr_b16 v[68:69], v17 offset:43072
    v_mfma_f32_16x16x32_bf16 v[112:115], v[56:59], v[232:235], v[112:115]
    ds_read_b64_tr_b16 v[70:71], v17 offset:46656
    v_exp_f32 v186, v186
    v_exp_f32 v187, v187
    v_exp_f32 v188, v188
    v_exp_f32 v189, v189
    v_exp_f32 v190, v190
    v_exp_f32 v191, v191
    v_mul_f32 v88, v88, v96
    v_mul_f32 v89, v89, v97
    v_mul_f32 v90, v90, v98
    v_mul_f32 v91, v91, v99
    s_add_u32 m0, s54, 131072
    s_mov_b32 s74, 458752
    buffer_load_dwordx4 v37, s[28:31], s74 offen lds
    v_mfma_f32_16x16x32_bf16 v[116:119], v[52:55], v[228:231], v[116:119]
    ds_read_b64_tr_b16 v[52:53], v17 offset:50240
    v_mfma_f32_16x16x32_bf16 v[116:119], v[56:59], v[236:239], v[116:119]
    ds_read_b64_tr_b16 v[54:55], v17 offset:53824
    v_mul_f32 v92, v92, v100
    v_mul_f32 v93, v93, v101
    v_mul_f32 v94, v94, v102
    v_mul_f32 v95, v95, v103
    v_fma_f32 v184, v184, v32, v32
    v_fma_f32 v185, v185, v32, v32
    v_fma_f32 v186, v186, v32, v32
    v_fma_f32 v187, v187, v32, v32
    v_fma_f32 v188, v188, v33, v33
    v_fma_f32 v189, v189, v33, v33
    s_waitcnt lgkmcnt(4)
    v_mfma_f32_16x16x32_bf16 v[104:107], v[60:63], v[240:243], v[104:107]
    ds_read_b64_tr_b16 v[56:57], v21 offset:64
    v_mfma_f32_16x16x32_bf16 v[104:107], v[64:67], v[248:251], v[104:107]
    ds_read_b64_tr_b16 v[58:59], v21 offset:3648
    v_fma_f32 v190, v190, v33, v33
    v_fma_f32 v191, v191, v33, v33
    v_rcp_f32 v184, v184
    v_rcp_f32 v185, v185
    v_rcp_f32 v186, v186
    v_rcp_f32 v187, v187
    v_rcp_f32 v188, v188
    v_rcp_f32 v189, v189
    v_rcp_f32 v190, v190
    v_rcp_f32 v191, v191
    v_mfma_f32_16x16x32_bf16 v[108:111], v[60:63], v[244:247], v[108:111]
    ds_read_b64_tr_b16 v[60:61], v21 offset:7232
    v_mfma_f32_16x16x32_bf16 v[108:111], v[64:67], v[252:255], v[108:111]
    ds_read_b64_tr_b16 v[62:63], v21 offset:10816
    v_mul_f32 v88, v88, v184
    v_mul_f32 v89, v89, v185
    v_mul_f32 v90, v90, v186
    v_mul_f32 v91, v91, v187
    v_mul_f32 v92, v92, v188
    v_mul_f32 v93, v93, v189
    v_mul_f32 v94, v94, v190
    v_mul_f32 v95, v95, v191
    v_cvt_pk_bf16_f32 v202, v88, v89
    v_cvt_pk_bf16_f32 v203, v90, v91
    s_waitcnt lgkmcnt(4)
    v_mfma_f32_16x16x32_bf16 v[112:115], v[68:71], v[240:243], v[112:115]
    ds_read_b64_tr_b16 v[64:65], v21 offset:14400
    v_mfma_f32_16x16x32_bf16 v[112:115], v[52:55], v[248:251], v[112:115]
    ds_read_b64_tr_b16 v[66:67], v21 offset:17984
    v_cvt_pk_bf16_f32 v206, v92, v93
    v_cvt_pk_bf16_f32 v207, v94, v95
    v_min_u32 v202, -2, v202
    v_min_u32 v203, -2, v203
    v_min_u32 v206, -2, v206
    v_min_u32 v207, -2, v207
    buffer_store_dwordx4 v[200:203], v2, s[36:39], s72 offen offset:0 sc1
    buffer_store_dwordx4 v[204:207], v28, s[36:39], s72 offen offset:0 sc1
    s_add_u32 m0, s54, 135168
    s_mov_b32 s74, 458752
    buffer_load_dwordx4 v38, s[28:31], s74 offen lds
    v_mfma_f32_16x16x32_bf16 v[116:119], v[68:71], v[244:247], v[116:119]
    ds_read_b64_tr_b16 v[68:69], v21 offset:21568
    v_mfma_f32_16x16x32_bf16 v[116:119], v[52:55], v[252:255], v[116:119]
    ds_read_b64_tr_b16 v[70:71], v21 offset:25152
    s_waitcnt lgkmcnt(4)
    v_mfma_f32_16x16x32_bf16 v[104:107], v[56:59], v[208:211], v[104:107]
    ds_read_b64_tr_b16 v[52:53], v17 offset:96
    v_mfma_f32_16x16x32_bf16 v[104:107], v[60:63], v[216:219], v[104:107]
qa_kernel_WS1_5:
    s_cbranch_execz qa_kernel_WS1_13
    ds_read_b64_tr_b16 v[54:55], v17 offset:3680
    v_mfma_f32_16x16x32_bf16 v[108:111], v[56:59], v[212:215], v[108:111]
    ds_read_b64_tr_b16 v[56:57], v17 offset:7264
    v_mfma_f32_16x16x32_bf16 v[108:111], v[60:63], v[220:223], v[108:111]
    ds_read_b64_tr_b16 v[58:59], v17 offset:10848
    s_waitcnt lgkmcnt(4)
    v_mfma_f32_16x16x32_bf16 v[112:115], v[64:67], v[208:211], v[112:115]
    ds_read_b64_tr_b16 v[60:61], v17 offset:14432
    v_mfma_f32_16x16x32_bf16 v[112:115], v[68:71], v[216:219], v[112:115]
    ds_read_b64_tr_b16 v[62:63], v17 offset:18016
    s_add_u32 m0, s54, 147456
    s_mov_b32 s74, 720896
    buffer_load_dwordx4 v37, s[28:31], s74 offen lds
    v_mfma_f32_16x16x32_bf16 v[116:119], v[64:67], v[212:215], v[116:119]
    ds_read_b64_tr_b16 v[64:65], v17 offset:21600
    v_mfma_f32_16x16x32_bf16 v[116:119], v[68:71], v[220:223], v[116:119]
    ds_read_b64_tr_b16 v[66:67], v17 offset:25184
    s_waitcnt lgkmcnt(4)
    v_mfma_f32_16x16x32_bf16 v[120:123], v[52:55], v[224:227], v[120:123]
    ds_read_b64_tr_b16 v[68:69], v17 offset:28768
    v_mfma_f32_16x16x32_bf16 v[120:123], v[56:59], v[232:235], v[120:123]
    ds_read_b64_tr_b16 v[70:71], v17 offset:32352
    v_mfma_f32_16x16x32_bf16 v[124:127], v[52:55], v[228:231], v[124:127]
    ds_read_b64_tr_b16 v[52:53], v17 offset:35936
    v_mfma_f32_16x16x32_bf16 v[124:127], v[56:59], v[236:239], v[124:127]
    ds_read_b64_tr_b16 v[54:55], v17 offset:39520
    v_mul_f32 v184, v34, v104
    v_mul_f32 v185, v34, v105
    v_mul_f32 v186, v34, v106
    v_mul_f32 v187, v34, v107
    v_mul_f32 v188, v35, v108
    s_waitcnt lgkmcnt(4)
    v_mfma_f32_16x16x32_bf16 v[128:131], v[60:63], v[224:227], v[128:131]
    ds_read_b64_tr_b16 v[56:57], v17 offset:43104
    v_mfma_f32_16x16x32_bf16 v[128:131], v[64:67], v[232:235], v[128:131]
    ds_read_b64_tr_b16 v[58:59], v17 offset:46688
    v_mul_f32 v189, v35, v109
    v_mul_f32 v190, v35, v110
    v_mul_f32 v191, v35, v111
    v_exp_f32 v184, v184
    v_exp_f32 v185, v185
    s_add_u32 m0, s54, 151552
    s_mov_b32 s74, 720896
    buffer_load_dwordx4 v38, s[28:31], s74 offen lds
    v_mfma_f32_16x16x32_bf16 v[132:135], v[60:63], v[228:231], v[132:135]
    ds_read_b64_tr_b16 v[60:61], v17 offset:50272
    v_mfma_f32_16x16x32_bf16 v[132:135], v[64:67], v[236:239], v[132:135]
    ds_read_b64_tr_b16 v[62:63], v17 offset:53856
    v_exp_f32 v186, v186
    v_exp_f32 v187, v187
    v_exp_f32 v188, v188
    v_exp_f32 v189, v189
    v_exp_f32 v190, v190
    s_waitcnt lgkmcnt(4)
    v_mfma_f32_16x16x32_bf16 v[120:123], v[68:71], v[240:243], v[120:123]
    ds_read_b64_tr_b16 v[64:65], v21 offset:96
    v_mfma_f32_16x16x32_bf16 v[120:123], v[52:55], v[248:251], v[120:123]
    ds_read_b64_tr_b16 v[66:67], v21 offset:3680
    v_exp_f32 v191, v191
    v_mul_f32 v104, v104, v112
    v_mul_f32 v105, v105, v113
    v_mul_f32 v106, v106, v114
    v_mul_f32 v107, v107, v115
    v_mfma_f32_16x16x32_bf16 v[124:127], v[68:71], v[244:247], v[124:127]
    ds_read_b64_tr_b16 v[68:69], v21 offset:7264
    v_mfma_f32_16x16x32_bf16 v[124:127], v[52:55], v[252:255], v[124:127]
    ds_read_b64_tr_b16 v[70:71], v21 offset:10848
    v_mul_f32 v108, v108, v116
    v_mul_f32 v109, v109, v117
    v_mul_f32 v110, v110, v118
    v_mul_f32 v111, v111, v119
    v_fma_f32 v184, v184, v32, v32
    s_waitcnt lgkmcnt(4)
    v_mfma_f32_16x16x32_bf16 v[128:131], v[56:59], v[240:243], v[128:131]
    ds_read_b64_tr_b16 v[52:53], v21 offset:14432
    v_mfma_f32_16x16x32_bf16 v[128:131], v[60:63], v[248:251], v[128:131]
    ds_read_b64_tr_b16 v[54:55], v21 offset:18016
    v_fma_f32 v185, v185, v32, v32
    v_fma_f32 v186, v186, v32, v32
    v_fma_f32 v187, v187, v32, v32
    v_fma_f32 v188, v188, v33, v33
    v_fma_f32 v189, v189, v33, v33
    v_mfma_f32_16x16x32_bf16 v[132:135], v[56:59], v[244:247], v[132:135]
    ds_read_b64_tr_b16 v[56:57], v21 offset:21600
    v_mfma_f32_16x16x32_bf16 v[132:135], v[60:63], v[252:255], v[132:135]
    ds_read_b64_tr_b16 v[58:59], v21 offset:25184
    v_fma_f32 v190, v190, v33, v33
    v_fma_f32 v191, v191, v33, v33
    v_rcp_f32 v184, v184
    v_rcp_f32 v185, v185
    v_rcp_f32 v186, v186
    s_waitcnt lgkmcnt(4)
    v_mfma_f32_16x16x32_bf16 v[120:123], v[64:67], v[208:211], v[120:123]
    ds_read_b64_tr_b16 v[60:61], v17 offset:128
    v_mfma_f32_16x16x32_bf16 v[120:123], v[68:71], v[216:219], v[120:123]
    ds_read_b64_tr_b16 v[62:63], v17 offset:3712
    s_setprio 1
    v_rcp_f32 v187, v187
    v_rcp_f32 v188, v188
    v_rcp_f32 v189, v189
    v_rcp_f32 v190, v190
    v_rcp_f32 v191, v191
    v_mfma_f32_16x16x32_bf16 v[124:127], v[64:67], v[212:215], v[124:127]
    ds_read_b64_tr_b16 v[64:65], v17 offset:7296
    v_mfma_f32_16x16x32_bf16 v[124:127], v[68:71], v[220:223], v[124:127]
    ds_read_b64_tr_b16 v[66:67], v17 offset:10880
    v_mul_f32 v104, v104, v184
    v_mul_f32 v105, v105, v185
    v_mul_f32 v106, v106, v186
    v_mul_f32 v107, v107, v187
    v_mul_f32 v108, v108, v188
    s_waitcnt lgkmcnt(4)
    v_mfma_f32_16x16x32_bf16 v[128:131], v[52:55], v[208:211], v[128:131]
    ds_read_b64_tr_b16 v[68:69], v17 offset:14464
    v_mfma_f32_16x16x32_bf16 v[128:131], v[56:59], v[216:219], v[128:131]
    ds_read_b64_tr_b16 v[70:71], v17 offset:18048
    v_mul_f32 v109, v109, v189
    v_mul_f32 v110, v110, v190
    v_mul_f32 v111, v111, v191
    v_cvt_pk_bf16_f32 v200, v104, v105
    v_cvt_pk_bf16_f32 v201, v106, v107
    v_mfma_f32_16x16x32_bf16 v[132:135], v[52:55], v[212:215], v[132:135]
    ds_read_b64_tr_b16 v[52:53], v17 offset:21632
    v_mfma_f32_16x16x32_bf16 v[132:135], v[56:59], v[220:223], v[132:135]
    ds_read_b64_tr_b16 v[54:55], v17 offset:25216
    v_cvt_pk_bf16_f32 v204, v108, v109
    v_cvt_pk_bf16_f32 v205, v110, v111
    s_waitcnt lgkmcnt(4)
    v_mfma_f32_16x16x32_bf16 v[136:139], v[60:63], v[224:227], v[136:139]
    ds_read_b64_tr_b16 v[56:57], v17 offset:28800
    v_mfma_f32_16x16x32_bf16 v[136:139], v[64:67], v[232:235], v[136:139]
    ds_read_b64_tr_b16 v[58:59], v17 offset:32384
    v_mfma_f32_16x16x32_bf16 v[140:143], v[60:63], v[228:231], v[140:143]
    ds_read_b64_tr_b16 v[60:61], v17 offset:35968
    v_mfma_f32_16x16x32_bf16 v[140:143], v[64:67], v[236:239], v[140:143]
    ds_read_b64_tr_b16 v[62:63], v17 offset:39552
    v_mul_f32 v184, v34, v120
    v_mul_f32 v185, v34, v121
    v_mul_f32 v186, v34, v122
    v_mul_f32 v187, v34, v123
    v_mul_f32 v188, v35, v124
    s_waitcnt lgkmcnt(4)
    v_mfma_f32_16x16x32_bf16 v[144:147], v[68:71], v[224:227], v[144:147]
    ds_read_b64_tr_b16 v[64:65], v17 offset:43136
    v_mfma_f32_16x16x32_bf16 v[144:147], v[52:55], v[232:235], v[144:147]
    ds_read_b64_tr_b16 v[66:67], v17 offset:46720
    v_mul_f32 v189, v35, v125
    v_mul_f32 v190, v35, v126
    v_mul_f32 v191, v35, v127
    v_exp_f32 v184, v184
    v_exp_f32 v185, v185
    s_mov_b32 s77, 29360128
    buffer_load_dwordx4 v[72:75], v39, s[36:39], s77 offen sc1
    v_mfma_f32_16x16x32_bf16 v[148:151], v[68:71], v[228:231], v[148:151]
    ds_read_b64_tr_b16 v[68:69], v17 offset:50304
    v_mfma_f32_16x16x32_bf16 v[148:151], v[52:55], v[236:239], v[148:151]
    ds_read_b64_tr_b16 v[70:71], v17 offset:53888
    v_exp_f32 v186, v186
    v_exp_f32 v187, v187
    v_exp_f32 v188, v188
    v_exp_f32 v189, v189
    v_exp_f32 v190, v190
    s_waitcnt lgkmcnt(4)
    v_mfma_f32_16x16x32_bf16 v[136:139], v[56:59], v[240:243], v[136:139]
    ds_read_b64_tr_b16 v[52:53], v21 offset:128
    v_mfma_f32_16x16x32_bf16 v[136:139], v[60:63], v[248:251], v[136:139]
    ds_read_b64_tr_b16 v[54:55], v21 offset:3712
    v_exp_f32 v191, v191
    v_mul_f32 v120, v120, v128
    v_mul_f32 v121, v121, v129
    v_mul_f32 v122, v122, v130
    v_mul_f32 v123, v123, v131
    buffer_load_dwordx4 v[76:79], v40, s[36:39], s77 offen sc1
    v_mfma_f32_16x16x32_bf16 v[140:143], v[56:59], v[244:247], v[140:143]
    ds_read_b64_tr_b16 v[56:57], v21 offset:7296
    v_mfma_f32_16x16x32_bf16 v[140:143], v[60:63], v[252:255], v[140:143]
    ds_read_b64_tr_b16 v[58:59], v21 offset:10880
    v_mul_f32 v124, v124, v132
    v_mul_f32 v125, v125, v133
    v_mul_f32 v126, v126, v134
    v_mul_f32 v127, v127, v135
    v_fma_f32 v184, v184, v32, v32
    s_waitcnt lgkmcnt(4)
    v_mfma_f32_16x16x32_bf16 v[144:147], v[64:67], v[240:243], v[144:147]
    ds_read_b64_tr_b16 v[60:61], v21 offset:14464
    v_mfma_f32_16x16x32_bf16 v[144:147], v[68:71], v[248:251], v[144:147]
    ds_read_b64_tr_b16 v[62:63], v21 offset:18048
    v_fma_f32 v185, v185, v32, v32
    v_fma_f32 v186, v186, v32, v32
    v_fma_f32 v187, v187, v32, v32
    v_fma_f32 v188, v188, v33, v33
    v_fma_f32 v189, v189, v33, v33
    s_mov_b32 s77, 29364224
    buffer_load_dwordx4 v[80:83], v39, s[36:39], s77 offen sc1
    v_mfma_f32_16x16x32_bf16 v[148:151], v[64:67], v[244:247], v[148:151]
    ds_read_b64_tr_b16 v[64:65], v21 offset:21632
    v_mfma_f32_16x16x32_bf16 v[148:151], v[68:71], v[252:255], v[148:151]
    ds_read_b64_tr_b16 v[66:67], v21 offset:25216
    v_fma_f32 v190, v190, v33, v33
    v_fma_f32 v191, v191, v33, v33
    v_rcp_f32 v184, v184
    v_rcp_f32 v185, v185
    v_rcp_f32 v186, v186
    s_waitcnt lgkmcnt(4)
    v_mfma_f32_16x16x32_bf16 v[136:139], v[52:55], v[208:211], v[136:139]
    ds_read_b64_tr_b16 v[68:69], v17 offset:160
    v_mfma_f32_16x16x32_bf16 v[136:139], v[56:59], v[216:219], v[136:139]
    ds_read_b64_tr_b16 v[70:71], v17 offset:3744
    v_rcp_f32 v187, v187
    v_rcp_f32 v188, v188
    v_rcp_f32 v189, v189
    v_rcp_f32 v190, v190
    v_rcp_f32 v191, v191
    buffer_load_dwordx4 v[84:87], v40, s[36:39], s77 offen sc1
    v_mfma_f32_16x16x32_bf16 v[140:143], v[52:55], v[212:215], v[140:143]
    ds_read_b64_tr_b16 v[52:53], v17 offset:7328
    v_mfma_f32_16x16x32_bf16 v[140:143], v[56:59], v[220:223], v[140:143]
    ds_read_b64_tr_b16 v[54:55], v17 offset:10912
    v_mul_f32 v120, v120, v184
    v_mul_f32 v121, v121, v185
    v_mul_f32 v122, v122, v186
    v_mul_f32 v123, v123, v187
    v_mul_f32 v124, v124, v188
    s_waitcnt lgkmcnt(4)
    v_mfma_f32_16x16x32_bf16 v[144:147], v[60:63], v[208:211], v[144:147]
    ds_read_b64_tr_b16 v[56:57], v17 offset:14496
    v_mfma_f32_16x16x32_bf16 v[144:147], v[64:67], v[216:219], v[144:147]
    ds_read_b64_tr_b16 v[58:59], v17 offset:18080
    v_mul_f32 v125, v125, v189
    v_mul_f32 v126, v126, v190
    v_mul_f32 v127, v127, v191
    v_cvt_pk_bf16_f32 v202, v120, v121
    v_cvt_pk_bf16_f32 v203, v122, v123
    s_mov_b32 s77, 29367296
    buffer_load_dwordx4 v[88:91], v39, s[36:39], s77 offen sc1
    v_mfma_f32_16x16x32_bf16 v[148:151], v[60:63], v[212:215], v[148:151]
    ds_read_b64_tr_b16 v[60:61], v17 offset:21664
    v_mfma_f32_16x16x32_bf16 v[148:151], v[64:67], v[220:223], v[148:151]
    ds_read_b64_tr_b16 v[62:63], v17 offset:25248
    v_cvt_pk_bf16_f32 v206, v124, v125
    v_cvt_pk_bf16_f32 v207, v126, v127
    buffer_store_dwordx4 v[200:203], v2, s[36:39], s72 offen offset:1024 sc1
    buffer_store_dwordx4 v[204:207], v28, s[36:39], s72 offen offset:1024 sc1
    s_waitcnt lgkmcnt(4)
    v_mfma_f32_16x16x32_bf16 v[152:155], v[68:71], v[224:227], v[152:155]
    ds_read_b64_tr_b16 v[64:65], v17 offset:28832
    v_mfma_f32_16x16x32_bf16 v[152:155], v[52:55], v[232:235], v[152:155]
    ds_read_b64_tr_b16 v[66:67], v17 offset:32416
    buffer_load_dwordx4 v[92:95], v40, s[36:39], s77 offen sc1
    v_mfma_f32_16x16x32_bf16 v[156:159], v[68:71], v[228:231], v[156:159]
    ds_read_b64_tr_b16 v[68:69], v17 offset:36000
    v_mfma_f32_16x16x32_bf16 v[156:159], v[52:55], v[236:239], v[156:159]
    ds_read_b64_tr_b16 v[70:71], v17 offset:39584
    v_mul_f32 v184, v34, v136
    v_mul_f32 v185, v34, v137
    v_mul_f32 v186, v34, v138
    v_mul_f32 v187, v34, v139
    v_mul_f32 v188, v35, v140
    s_waitcnt lgkmcnt(4)
    v_mfma_f32_16x16x32_bf16 v[160:163], v[56:59], v[224:227], v[160:163]
    ds_read_b64_tr_b16 v[52:53], v17 offset:43168
    v_mfma_f32_16x16x32_bf16 v[160:163], v[60:63], v[232:235], v[160:163]
    ds_read_b64_tr_b16 v[54:55], v17 offset:46752
    v_mul_f32 v189, v35, v141
    v_mul_f32 v190, v35, v142
    v_mul_f32 v191, v35, v143
    v_exp_f32 v184, v184
    v_exp_f32 v185, v185
    s_mov_b32 s77, 29371392
    buffer_load_dwordx4 v[96:99], v39, s[36:39], s77 offen sc1
    v_mfma_f32_16x16x32_bf16 v[164:167], v[56:59], v[228:231], v[164:167]
    ds_read_b64_tr_b16 v[56:57], v17 offset:50336
    v_mfma_f32_16x16x32_bf16 v[164:167], v[60:63], v[236:239], v[164:167]
    ds_read_b64_tr_b16 v[58:59], v17 offset:53920
    v_exp_f32 v186, v186
    v_exp_f32 v187, v187
    v_exp_f32 v188, v188
    v_exp_f32 v189, v189
    v_exp_f32 v190, v190
    s_waitcnt lgkmcnt(4)
    v_mfma_f32_16x16x32_bf16 v[152:155], v[64:67], v[240:243], v[152:155]
    ds_read_b64_tr_b16 v[60:61], v21 offset:160
    v_mfma_f32_16x16x32_bf16 v[152:155], v[68:71], v[248:251], v[152:155]
    ds_read_b64_tr_b16 v[62:63], v21 offset:3744
    s_setprio 0
    v_exp_f32 v191, v191
    v_mul_f32 v136, v136, v144
    v_mul_f32 v137, v137, v145
    v_mul_f32 v138, v138, v146
    v_mul_f32 v139, v139, v147
    buffer_load_dwordx4 v[100:103], v40, s[36:39], s77 offen sc1
    v_mfma_f32_16x16x32_bf16 v[156:159], v[64:67], v[244:247], v[156:159]
    ds_read_b64_tr_b16 v[64:65], v21 offset:7328
    v_mfma_f32_16x16x32_bf16 v[156:159], v[68:71], v[252:255], v[156:159]
    ds_read_b64_tr_b16 v[66:67], v21 offset:10912
    v_mul_f32 v140, v140, v148
    v_mul_f32 v141, v141, v149
    v_mul_f32 v142, v142, v150
    v_mul_f32 v143, v143, v151
    v_fma_f32 v184, v184, v32, v32
    s_waitcnt lgkmcnt(4)
    v_mfma_f32_16x16x32_bf16 v[160:163], v[52:55], v[240:243], v[160:163]
    ds_read_b64_tr_b16 v[68:69], v21 offset:14496
    v_mfma_f32_16x16x32_bf16 v[160:163], v[56:59], v[248:251], v[160:163]
    ds_read_b64_tr_b16 v[70:71], v21 offset:18080
    v_fma_f32 v185, v185, v32, v32
    v_fma_f32 v186, v186, v32, v32
    v_fma_f32 v187, v187, v32, v32
    v_fma_f32 v188, v188, v33, v33
    v_fma_f32 v189, v189, v33, v33
    s_mov_b32 s77, 29374464
    buffer_load_dwordx4 v[104:107], v39, s[36:39], s77 offen sc1
    v_mfma_f32_16x16x32_bf16 v[164:167], v[52:55], v[244:247], v[164:167]
    ds_read_b64_tr_b16 v[52:53], v21 offset:21664
    v_mfma_f32_16x16x32_bf16 v[164:167], v[56:59], v[252:255], v[164:167]
    ds_read_b64_tr_b16 v[54:55], v21 offset:25248
    v_fma_f32 v190, v190, v33, v33
    v_fma_f32 v191, v191, v33, v33
    v_rcp_f32 v184, v184
    v_rcp_f32 v185, v185
    v_rcp_f32 v186, v186
    s_waitcnt lgkmcnt(4)
    v_mfma_f32_16x16x32_bf16 v[152:155], v[60:63], v[208:211], v[152:155]
    ds_read_b64_tr_b16 v[56:57], v18 offset:0
    v_mfma_f32_16x16x32_bf16 v[152:155], v[64:67], v[216:219], v[152:155]
    ds_read_b64_tr_b16 v[58:59], v18 offset:3584
    v_rcp_f32 v187, v187
    v_rcp_f32 v188, v188
    v_rcp_f32 v189, v189
    v_rcp_f32 v190, v190
    v_rcp_f32 v191, v191
    buffer_load_dwordx4 v[108:111], v40, s[36:39], s77 offen sc1
    v_mfma_f32_16x16x32_bf16 v[156:159], v[60:63], v[212:215], v[156:159]
    ds_read_b64_tr_b16 v[60:61], v18 offset:7168
    v_mfma_f32_16x16x32_bf16 v[156:159], v[64:67], v[220:223], v[156:159]
    ds_read_b64_tr_b16 v[62:63], v18 offset:10752
    v_mul_f32 v136, v136, v184
    v_mul_f32 v137, v137, v185
    v_mul_f32 v138, v138, v186
    v_mul_f32 v139, v139, v187
    v_mul_f32 v140, v140, v188
    s_waitcnt lgkmcnt(4)
    v_mfma_f32_16x16x32_bf16 v[160:163], v[68:71], v[208:211], v[160:163]
    ds_read_b64_tr_b16 v[64:65], v18 offset:14336
    v_mfma_f32_16x16x32_bf16 v[160:163], v[52:55], v[216:219], v[160:163]
    ds_read_b64_tr_b16 v[66:67], v18 offset:17920
    v_mul_f32 v141, v141, v189
    v_mul_f32 v142, v142, v190
    v_mul_f32 v143, v143, v191
    v_cvt_pk_bf16_f32 v200, v136, v137
    v_cvt_pk_bf16_f32 v201, v138, v139
    s_mov_b32 s77, 29378560
    buffer_load_dwordx4 v[112:115], v39, s[36:39], s77 offen sc1
    v_mfma_f32_16x16x32_bf16 v[164:167], v[68:71], v[212:215], v[164:167]
    ds_read_b64_tr_b16 v[68:69], v18 offset:21504
    v_mfma_f32_16x16x32_bf16 v[164:167], v[52:55], v[220:223], v[164:167]
    ds_read_b64_tr_b16 v[70:71], v18 offset:25088
    v_cvt_pk_bf16_f32 v204, v140, v141
    v_cvt_pk_bf16_f32 v205, v142, v143
    s_waitcnt lgkmcnt(4)
    v_mfma_f32_16x16x32_bf16 v[168:171], v[56:59], v[224:227], v[168:171]
    ds_read_b64_tr_b16 v[52:53], v18 offset:28672
    v_mfma_f32_16x16x32_bf16 v[168:171], v[60:63], v[232:235], v[168:171]
    ds_read_b64_tr_b16 v[54:55], v18 offset:32256
    buffer_load_dwordx4 v[116:119], v40, s[36:39], s77 offen sc1
    v_mfma_f32_16x16x32_bf16 v[172:175], v[56:59], v[228:231], v[172:175]
    ds_read_b64_tr_b16 v[56:57], v18 offset:35840
    v_mfma_f32_16x16x32_bf16 v[172:175], v[60:63], v[236:239], v[172:175]
    ds_read_b64_tr_b16 v[58:59], v18 offset:39424
    v_mul_f32 v184, v34, v152
    v_mul_f32 v185, v34, v153
    v_mul_f32 v186, v34, v154
    v_mul_f32 v187, v34, v155
    v_mul_f32 v188, v35, v156
    s_waitcnt lgkmcnt(4)
    v_mfma_f32_16x16x32_bf16 v[176:179], v[64:67], v[224:227], v[176:179]
    ds_read_b64_tr_b16 v[60:61], v18 offset:43008
    v_mfma_f32_16x16x32_bf16 v[176:179], v[68:71], v[232:235], v[176:179]
    ds_read_b64_tr_b16 v[62:63], v18 offset:46592
    v_mul_f32 v189, v35, v157
    v_mul_f32 v190, v35, v158
    v_mul_f32 v191, v35, v159
    v_exp_f32 v184, v184
    v_exp_f32 v185, v185
    s_mov_b32 s77, 29381632
    buffer_load_dwordx4 v[120:123], v39, s[36:39], s77 offen sc1
    v_mfma_f32_16x16x32_bf16 v[180:183], v[64:67], v[228:231], v[180:183]
    ds_read_b64_tr_b16 v[64:65], v18 offset:50176
    v_mfma_f32_16x16x32_bf16 v[180:183], v[68:71], v[236:239], v[180:183]
    ds_read_b64_tr_b16 v[66:67], v18 offset:53760
    v_exp_f32 v186, v186
    v_exp_f32 v187, v187
    v_exp_f32 v188, v188
    v_exp_f32 v189, v189
    v_exp_f32 v190, v190
    s_waitcnt lgkmcnt(4)
    v_mfma_f32_16x16x32_bf16 v[168:171], v[52:55], v[240:243], v[168:171]
    ds_read_b64_tr_b16 v[68:69], v23 offset:0
    v_mfma_f32_16x16x32_bf16 v[168:171], v[56:59], v[248:251], v[168:171]
    ds_read_b64_tr_b16 v[70:71], v23 offset:3584
    v_exp_f32 v191, v191
    v_mul_f32 v152, v152, v160
    v_mul_f32 v153, v153, v161
    v_mul_f32 v154, v154, v162
    v_mul_f32 v155, v155, v163
    buffer_load_dwordx4 v[124:127], v40, s[36:39], s77 offen sc1
    v_mfma_f32_16x16x32_bf16 v[172:175], v[52:55], v[244:247], v[172:175]
    ds_read_b64_tr_b16 v[52:53], v23 offset:7168
    v_mfma_f32_16x16x32_bf16 v[172:175], v[56:59], v[252:255], v[172:175]
    ds_read_b64_tr_b16 v[54:55], v23 offset:10752
    v_mul_f32 v156, v156, v164
    v_mul_f32 v157, v157, v165
    v_mul_f32 v158, v158, v166
    v_mul_f32 v159, v159, v167
    v_fma_f32 v184, v184, v32, v32
    s_waitcnt lgkmcnt(4)
    v_mfma_f32_16x16x32_bf16 v[176:179], v[60:63], v[240:243], v[176:179]
    ds_read_b64_tr_b16 v[56:57], v23 offset:14336
    v_mfma_f32_16x16x32_bf16 v[176:179], v[64:67], v[248:251], v[176:179]
    ds_read_b64_tr_b16 v[58:59], v23 offset:17920
    v_fma_f32 v185, v185, v32, v32
    v_fma_f32 v186, v186, v32, v32
    v_fma_f32 v187, v187, v32, v32
    v_fma_f32 v188, v188, v33, v33
    v_fma_f32 v189, v189, v33, v33
    s_mov_b32 s77, 29385728
    buffer_load_dwordx4 v[128:131], v39, s[36:39], s77 offen sc1
    v_mfma_f32_16x16x32_bf16 v[180:183], v[60:63], v[244:247], v[180:183]
    ds_read_b64_tr_b16 v[60:61], v23 offset:21504
    v_mfma_f32_16x16x32_bf16 v[180:183], v[64:67], v[252:255], v[180:183]
    ds_read_b64_tr_b16 v[62:63], v23 offset:25088
    v_fma_f32 v190, v190, v33, v33
    v_fma_f32 v191, v191, v33, v33
    v_rcp_f32 v184, v184
    v_rcp_f32 v185, v185
    v_rcp_f32 v186, v186
    s_waitcnt lgkmcnt(4)
    v_mfma_f32_16x16x32_bf16 v[168:171], v[68:71], v[208:211], v[168:171]
    v_mfma_f32_16x16x32_bf16 v[168:171], v[52:55], v[216:219], v[168:171]
    v_rcp_f32 v187, v187
    v_rcp_f32 v188, v188
    v_rcp_f32 v189, v189
    v_rcp_f32 v190, v190
    v_rcp_f32 v191, v191
    buffer_load_dwordx4 v[132:135], v40, s[36:39], s77 offen sc1
    v_mfma_f32_16x16x32_bf16 v[172:175], v[68:71], v[212:215], v[172:175]
    v_mfma_f32_16x16x32_bf16 v[172:175], v[52:55], v[220:223], v[172:175]
    v_mul_f32 v152, v152, v184
    v_mul_f32 v153, v153, v185
    v_mul_f32 v154, v154, v186
    v_mul_f32 v155, v155, v187
    v_mul_f32 v156, v156, v188
    s_waitcnt lgkmcnt(0)
    v_mfma_f32_16x16x32_bf16 v[176:179], v[56:59], v[208:211], v[176:179]
    v_mfma_f32_16x16x32_bf16 v[176:179], v[60:63], v[216:219], v[176:179]
    v_mul_f32 v157, v157, v189
    v_mul_f32 v158, v158, v190
    v_mul_f32 v159, v159, v191
    v_cvt_pk_bf16_f32 v202, v152, v153
    v_cvt_pk_bf16_f32 v203, v154, v155
    v_mfma_f32_16x16x32_bf16 v[180:183], v[56:59], v[212:215], v[180:183]
    v_mfma_f32_16x16x32_bf16 v[180:183], v[60:63], v[220:223], v[180:183]
    v_cvt_pk_bf16_f32 v206, v156, v157
    v_cvt_pk_bf16_f32 v207, v158, v159
    buffer_store_dwordx4 v[200:203], v2, s[36:39], s72 offen offset:2048 sc1
    buffer_store_dwordx4 v[204:207], v28, s[36:39], s72 offen offset:2048 sc1
    s_branch qa_kernel_F2S
qa_kernel_P1:
    s_waitcnt vmcnt(4)
    s_barrier
    ds_read_b64_tr_b16 v[52:53], v21 offset:0
    ds_read_b64_tr_b16 v[54:55], v21 offset:3584
    ds_read_b64_tr_b16 v[56:57], v21 offset:7168
    ds_read_b64_tr_b16 v[58:59], v21 offset:10752
    ds_read_b64_tr_b16 v[60:61], v21 offset:14336
    ds_read_b64_tr_b16 v[62:63], v21 offset:17920
    ds_read_b64_tr_b16 v[64:65], v21 offset:21504
    ds_read_b64_tr_b16 v[66:67], v21 offset:25088
    s_waitcnt vmcnt(2)
    v_max3_u32 v12, v208, v209, v210
    v_max3_u32 v13, v211, v212, v213
    v_max3_u32 v12, v12, v214, v215
    v_max_u32 v12, v12, v13
    v_cmp_eq_u32 vcc, -1, v12
    s_cbranch_vccz qa_kernel_F1_A0_G
qa_kernel_F1_A0_R:
    s_mov_b32 s47, 20971520
    buffer_load_dwordx4 v[208:211], v15, s[36:39], s47 offen offset:0 sc1
    s_mov_b32 s47, 20971520
    buffer_load_dwordx4 v[212:215], v16, s[36:39], s47 offen offset:0 sc1
    s_mov_b32 s47, 20971520
    buffer_load_dwordx4 v[216:219], v15, s[36:39], s47 offen offset:1024 sc1
    s_mov_b32 s47, 20971520
    buffer_load_dwordx4 v[220:223], v16, s[36:39], s47 offen offset:1024 sc1
    s_waitcnt vmcnt(0)
    v_max3_u32 v12, v208, v209, v210
    v_max3_u32 v13, v211, v212, v213
    v_max3_u32 v12, v12, v214, v215
    v_max_u32 v12, v12, v13
    v_cmp_eq_u32 vcc, -1, v12
    s_sub_u32 s62, s62, 1
    s_cselect_b64 vcc, 0, vcc
    s_cselect_b32 s62, 0, s62
    s_cbranch_vccnz qa_kernel_F1_A0_R
qa_kernel_F1_A0_G:
    s_waitcnt vmcnt(0)
    v_max3_u32 v12, v216, v217, v218
    v_max3_u32 v13, v219, v220, v221
    v_max3_u32 v12, v12, v222, v223
    v_max_u32 v12, v12, v13
    v_cmp_eq_u32 vcc, -1, v12
    s_cbranch_vccz qa_kernel_F1_A1_G
qa_kernel_F1_A1_R:
    s_mov_b32 s47, 20971520
    buffer_load_dwordx4 v[216:219], v15, s[36:39], s47 offen offset:1024 sc1
    s_mov_b32 s47, 20971520
    buffer_load_dwordx4 v[220:223], v16, s[36:39], s47 offen offset:1024 sc1
    s_waitcnt vmcnt(0)
    v_max3_u32 v12, v216, v217, v218
    v_max3_u32 v13, v219, v220, v221
    v_max3_u32 v12, v12, v222, v223
    v_max_u32 v12, v12, v13
    v_cmp_eq_u32 vcc, -1, v12
    s_sub_u32 s62, s62, 1
    s_cselect_b64 vcc, 0, vcc
    s_cselect_b32 s62, 0, s62
    s_cbranch_vccnz qa_kernel_F1_A1_R
qa_kernel_F1_A1_G:
    s_waitcnt lgkmcnt(4)
    v_mfma_f32_16x16x32_bf16 v[72:75], v[52:55], v[208:211], 0
    ds_read_b64_tr_b16 v[68:69], v21 offset:32
    v_mfma_f32_16x16x32_bf16 v[72:75], v[56:59], v[216:219], v[72:75]
    ds_read_b64_tr_b16 v[70:71], v21 offset:3616
    s_setprio 3
    s_add_u32 m0, s60, 94208
    s_nop 0
    buffer_load_dwordx4 v8, s[32:35], s59 offen lds
    v_mfma_f32_16x16x32_bf16 v[76:79], v[52:55], v[212:215], 0
    ds_read_b64_tr_b16 v[52:53], v21 offset:7200
    v_mfma_f32_16x16x32_bf16 v[76:79], v[56:59], v[220:223], v[76:79]
    ds_read_b64_tr_b16 v[54:55], v21 offset:10784
    s_waitcnt lgkmcnt(4)
    v_mfma_f32_16x16x32_bf16 v[80:83], v[60:63], v[208:211], 0
    ds_read_b64_tr_b16 v[56:57], v21 offset:14368
    v_mfma_f32_16x16x32_bf16 v[80:83], v[64:67], v[216:219], v[80:83]
    ds_read_b64_tr_b16 v[58:59], v21 offset:17952
    v_mfma_f32_16x16x32_bf16 v[84:87], v[60:63], v[212:215], 0
    ds_read_b64_tr_b16 v[60:61], v21 offset:21536
    v_mfma_f32_16x16x32_bf16 v[84:87], v[64:67], v[220:223], v[84:87]
    ds_read_b64_tr_b16 v[62:63], v21 offset:25120
    s_add_u32 m0, s60, 95232
    s_nop 0
    buffer_load_dwordx4 v9, s[32:35], s59 offen lds
    s_waitcnt lgkmcnt(4)
    v_mfma_f32_16x16x32_bf16 v[88:91], v[68:71], v[208:211], 0
    ds_read_b64_tr_b16 v[64:65], v21 offset:64
    v_mfma_f32_16x16x32_bf16 v[88:91], v[52:55], v[216:219], v[88:91]
    ds_read_b64_tr_b16 v[66:67], v21 offset:3648
    v_mfma_f32_16x16x32_bf16 v[92:95], v[68:71], v[212:215], 0
    ds_read_b64_tr_b16 v[68:69], v21 offset:7232
    v_mfma_f32_16x16x32_bf16 v[92:95], v[52:55], v[220:223], v[92:95]
    ds_read_b64_tr_b16 v[70:71], v21 offset:10816
    s_waitcnt lgkmcnt(4)
    v_mfma_f32_16x16x32_bf16 v[96:99], v[56:59], v[208:211], 0
    ds_read_b64_tr_b16 v[52:53], v21 offset:14400
    v_mfma_f32_16x16x32_bf16 v[96:99], v[60:63], v[216:219], v[96:99]
    ds_read_b64_tr_b16 v[54:55], v21 offset:17984
    s_setprio 2
    s_add_u32 m0, s60, 96256
    s_nop 0
    buffer_load_dwordx4 v10, s[32:35], s59 offen lds
    v_mfma_f32_16x16x32_bf16 v[100:103], v[56:59], v[212:215], 0
    ds_read_b64_tr_b16 v[56:57], v21 offset:21568
    v_mfma_f32_16x16x32_bf16 v[100:103], v[60:63], v[220:223], v[100:103]
    ds_read_b64_tr_b16 v[58:59], v21 offset:25152
    s_waitcnt lgkmcnt(4)
    v_mfma_f32_16x16x32_bf16 v[104:107], v[64:67], v[208:211], 0
    ds_read_b64_tr_b16 v[60:61], v21 offset:96
    v_mfma_f32_16x16x32_bf16 v[104:107], v[68:71], v[216:219], v[104:107]
    ds_read_b64_tr_b16 v[62:63], v21 offset:3680
    s_add_u32 m0, s60, 97280
    s_mov_b32 exec_hi, 0
    buffer_load_dwordx4 v11, s[32:35], s59 offen lds
    s_mov_b32 exec_hi, -1
    s_add_u32 s59, s59, 458752
    v_mfma_f32_16x16x32_bf16 v[108:111], v[64:67], v[212:215], 0
    ds_read_b64_tr_b16 v[64:65], v21 offset:7264
    v_mfma_f32_16x16x32_bf16 v[108:111], v[68:71], v[220:223], v[108:111]
    ds_read_b64_tr_b16 v[66:67], v21 offset:10848
    buffer_load_dwordx4 v[224:227], v15, s[36:39], s61 offen offset:2048 sc1
    s_waitcnt lgkmcnt(4)
    v_mfma_f32_16x16x32_bf16 v[112:115], v[52:55], v[208:211], 0
    ds_read_b64_tr_b16 v[68:69], v21 offset:14432
    v_mfma_f32_16x16x32_bf16 v[112:115], v[56:59], v[216:219], v[112:115]
    ds_read_b64_tr_b16 v[70:71], v21 offset:18016
    v_mfma_f32_16x16x32_bf16 v[116:119], v[52:55], v[212:215], 0
    ds_read_b64_tr_b16 v[52:53], v21 offset:21600
    v_mfma_f32_16x16x32_bf16 v[116:119], v[56:59], v[220:223], v[116:119]
    ds_read_b64_tr_b16 v[54:55], v21 offset:25184
    s_waitcnt lgkmcnt(4)
    v_mfma_f32_16x16x32_bf16 v[120:123], v[60:63], v[208:211], 0
    ds_read_b64_tr_b16 v[56:57], v21 offset:128
    v_mfma_f32_16x16x32_bf16 v[120:123], v[64:67], v[216:219], v[120:123]
    ds_read_b64_tr_b16 v[58:59], v21 offset:3712
    s_setprio 1
    buffer_load_dwordx4 v[228:231], v16, s[36:39], s61 offen offset:2048 sc1
    v_mfma_f32_16x16x32_bf16 v[124:127], v[60:63], v[212:215], 0
    ds_read_b64_tr_b16 v[60:61], v21 offset:7296
    v_mfma_f32_16x16x32_bf16 v[124:127], v[64:67], v[220:223], v[124:127]
    ds_read_b64_tr_b16 v[62:63], v21 offset:10880
    buffer_load_dwordx4 v[232:235], v15, s[36:39], s61 offen offset:3072 sc1
    s_waitcnt lgkmcnt(4)
    v_mfma_f32_16x16x32_bf16 v[128:131], v[68:71], v[208:211], 0
    ds_read_b64_tr_b16 v[64:65], v21 offset:14464
    v_mfma_f32_16x16x32_bf16 v[128:131], v[52:55], v[216:219], v[128:131]
    ds_read_b64_tr_b16 v[66:67], v21 offset:18048
    buffer_load_dwordx4 v[236:239], v16, s[36:39], s61 offen offset:3072 sc1
    s_add_u32 s61, s61, 4096
    v_mfma_f32_16x16x32_bf16 v[132:135], v[68:71], v[212:215], 0
    ds_read_b64_tr_b16 v[68:69], v21 offset:21632
    v_mfma_f32_16x16x32_bf16 v[132:135], v[52:55], v[220:223], v[132:135]
    ds_read_b64_tr_b16 v[70:71], v21 offset:25216
    s_mov_b32 m0, 151552
    s_nop 0
    buffer_load_dwordx4 v26, s[36:39], s64 offen sc1 lds
    s_waitcnt lgkmcnt(4)
    v_mfma_f32_16x16x32_bf16 v[136:139], v[56:59], v[208:211], 0
    ds_read_b64_tr_b16 v[52:53], v21 offset:160
    v_mfma_f32_16x16x32_bf16 v[136:139], v[60:63], v[216:219], v[136:139]
    ds_read_b64_tr_b16 v[54:55], v21 offset:3744
    v_mfma_f32_16x16x32_bf16 v[140:143], v[56:59], v[212:215], 0
    ds_read_b64_tr_b16 v[56:57], v21 offset:7328
qa_kernel_WS1_6:
    s_cbranch_execz qa_kernel_WS1_14
    v_mfma_f32_16x16x32_bf16 v[140:143], v[60:63], v[220:223], v[140:143]
    ds_read_b64_tr_b16 v[58:59], v21 offset:10912
    s_waitcnt lgkmcnt(4)
    v_mfma_f32_16x16x32_bf16 v[144:147], v[64:67], v[208:211], 0
    ds_read_b64_tr_b16 v[60:61], v21 offset:14496
    v_mfma_f32_16x16x32_bf16 v[144:147], v[68:71], v[216:219], v[144:147]
    ds_read_b64_tr_b16 v[62:63], v21 offset:18080
    s_setprio 0
    s_add_u32 m0, s60, 122880
    s_nop 0
    buffer_load_dwordx4 v8, s[32:35], s59 offen lds
    v_mfma_f32_16x16x32_bf16 v[148:151], v[64:67], v[212:215], 0
    ds_read_b64_tr_b16 v[64:65], v21 offset:21664
    v_mfma_f32_16x16x32_bf16 v[148:151], v[68:71], v[220:223], v[148:151]
    ds_read_b64_tr_b16 v[66:67], v21 offset:25248
    s_waitcnt lgkmcnt(4)
    v_mfma_f32_16x16x32_bf16 v[152:155], v[52:55], v[208:211], 0
    ds_read_b64_tr_b16 v[68:69], v23 offset:0
    v_mfma_f32_16x16x32_bf16 v[152:155], v[56:59], v[216:219], v[152:155]
    ds_read_b64_tr_b16 v[70:71], v23 offset:3584
    v_mfma_f32_16x16x32_bf16 v[156:159], v[52:55], v[212:215], 0
    ds_read_b64_tr_b16 v[52:53], v23 offset:7168
    v_mfma_f32_16x16x32_bf16 v[156:159], v[56:59], v[220:223], v[156:159]
    ds_read_b64_tr_b16 v[54:55], v23 offset:10752
    s_add_u32 m0, s60, 123904
    s_nop 0
    buffer_load_dwordx4 v9, s[32:35], s59 offen lds
    s_waitcnt lgkmcnt(4)
    v_mfma_f32_16x16x32_bf16 v[160:163], v[60:63], v[208:211], 0
    ds_read_b64_tr_b16 v[56:57], v23 offset:14336
    v_mfma_f32_16x16x32_bf16 v[160:163], v[64:67], v[216:219], v[160:163]
    ds_read_b64_tr_b16 v[58:59], v23 offset:17920
    v_mfma_f32_16x16x32_bf16 v[164:167], v[60:63], v[212:215], 0
    ds_read_b64_tr_b16 v[60:61], v23 offset:21504
    v_mfma_f32_16x16x32_bf16 v[164:167], v[64:67], v[220:223], v[164:167]
    ds_read_b64_tr_b16 v[62:63], v23 offset:25088
    s_waitcnt lgkmcnt(4)
    v_mfma_f32_16x16x32_bf16 v[168:171], v[68:71], v[208:211], 0
    s_waitcnt vmcnt(7)
    s_barrier
    ds_read_b64_tr_b16 v[64:65], v21 offset:28672
    v_mfma_f32_16x16x32_bf16 v[168:171], v[52:55], v[216:219], v[168:171]
    ds_read_b64_tr_b16 v[66:67], v21 offset:32256
    s_setprio 3
    v_mfma_f32_16x16x32_bf16 v[172:175], v[68:71], v[212:215], 0
    ds_read_b64_tr_b16 v[68:69], v21 offset:35840
    v_mfma_f32_16x16x32_bf16 v[172:175], v[52:55], v[220:223], v[172:175]
    ds_read_b64_tr_b16 v[70:71], v21 offset:39424
    s_add_u32 m0, s60, 124928
    s_nop 0
    buffer_load_dwordx4 v10, s[32:35], s59 offen lds
    s_waitcnt vmcnt(6)
    v_max3_u32 v12, v224, v225, v226
    v_max3_u32 v13, v227, v228, v229
    v_max3_u32 v12, v12, v230, v231
    v_max_u32 v12, v12, v13
    v_cmp_eq_u32 vcc, -1, v12
    s_cbranch_vccz qa_kernel_F1_A2_G
qa_kernel_F1_A2_R:
    s_mov_b32 s47, 20971520
    buffer_load_dwordx4 v[224:227], v15, s[36:39], s47 offen offset:2048 sc1
    s_mov_b32 s47, 20971520
    buffer_load_dwordx4 v[228:231], v16, s[36:39], s47 offen offset:2048 sc1
    s_mov_b32 s47, 20971520
    buffer_load_dwordx4 v[232:235], v15, s[36:39], s47 offen offset:3072 sc1
    s_mov_b32 s47, 20971520
    buffer_load_dwordx4 v[236:239], v16, s[36:39], s47 offen offset:3072 sc1
    s_waitcnt vmcnt(0)
    v_max3_u32 v12, v224, v225, v226
    v_max3_u32 v13, v227, v228, v229
    v_max3_u32 v12, v12, v230, v231
    v_max_u32 v12, v12, v13
    v_cmp_eq_u32 vcc, -1, v12
    s_sub_u32 s62, s62, 1
    s_cselect_b64 vcc, 0, vcc
    s_cselect_b32 s62, 0, s62
    s_cbranch_vccnz qa_kernel_F1_A2_R
qa_kernel_F1_A2_G:
    s_waitcnt lgkmcnt(4)
    v_mfma_f32_16x16x32_bf16 v[176:179], v[56:59], v[208:211], 0
    ds_read_b64_tr_b16 v[52:53], v21 offset:43008
    v_mfma_f32_16x16x32_bf16 v[176:179], v[60:63], v[216:219], v[176:179]
    ds_read_b64_tr_b16 v[54:55], v21 offset:46592
    s_waitcnt vmcnt(4)
    v_max3_u32 v12, v232, v233, v234
    v_max3_u32 v13, v235, v236, v237
    v_max3_u32 v12, v12, v238, v239
    v_max_u32 v12, v12, v13
    v_cmp_eq_u32 vcc, -1, v12
    s_cbranch_vccz qa_kernel_F1_A3_G
qa_kernel_F1_A3_R:
    s_mov_b32 s47, 20971520
    buffer_load_dwordx4 v[232:235], v15, s[36:39], s47 offen offset:3072 sc1
    s_mov_b32 s47, 20971520
    buffer_load_dwordx4 v[236:239], v16, s[36:39], s47 offen offset:3072 sc1
    s_waitcnt vmcnt(0)
    v_max3_u32 v12, v232, v233, v234
    v_max3_u32 v13, v235, v236, v237
    v_max3_u32 v12, v12, v238, v239
    v_max_u32 v12, v12, v13
    v_cmp_eq_u32 vcc, -1, v12
    s_sub_u32 s62, s62, 1
    s_cselect_b64 vcc, 0, vcc
    s_cselect_b32 s62, 0, s62
    s_cbranch_vccnz qa_kernel_F1_A3_R
qa_kernel_F1_A3_G:
    v_mfma_f32_16x16x32_bf16 v[180:183], v[56:59], v[212:215], 0
    ds_read_b64_tr_b16 v[56:57], v21 offset:50176
    v_mfma_f32_16x16x32_bf16 v[180:183], v[60:63], v[220:223], v[180:183]
    ds_read_b64_tr_b16 v[58:59], v21 offset:53760
    s_waitcnt lgkmcnt(4)
    v_mfma_f32_16x16x32_bf16 v[72:75], v[64:67], v[224:227], v[72:75]
    ds_read_b64_tr_b16 v[60:61], v21 offset:28704
    v_mfma_f32_16x16x32_bf16 v[72:75], v[68:71], v[232:235], v[72:75]
    ds_read_b64_tr_b16 v[62:63], v21 offset:32288
    s_add_u32 m0, s60, 125952
    s_mov_b32 exec_hi, 0
    buffer_load_dwordx4 v11, s[32:35], s59 offen lds
    s_mov_b32 exec_hi, -1
    s_add_u32 s59, s59, 458752
    v_mfma_f32_16x16x32_bf16 v[76:79], v[64:67], v[228:231], v[76:79]
    ds_read_b64_tr_b16 v[64:65], v21 offset:35872
    v_mfma_f32_16x16x32_bf16 v[76:79], v[68:71], v[236:239], v[76:79]
    ds_read_b64_tr_b16 v[66:67], v21 offset:39456
    s_waitcnt lgkmcnt(4)
    v_mfma_f32_16x16x32_bf16 v[80:83], v[52:55], v[224:227], v[80:83]
    ds_read_b64_tr_b16 v[68:69], v21 offset:43040
    v_mfma_f32_16x16x32_bf16 v[80:83], v[56:59], v[232:235], v[80:83]
    ds_read_b64_tr_b16 v[70:71], v21 offset:46624
    v_mfma_f32_16x16x32_bf16 v[84:87], v[52:55], v[228:231], v[84:87]
    ds_read_b64_tr_b16 v[52:53], v21 offset:50208
    v_mfma_f32_16x16x32_bf16 v[84:87], v[56:59], v[236:239], v[84:87]
    ds_read_b64_tr_b16 v[54:55], v21 offset:53792
    s_setprio 2
    buffer_load_dwordx4 v[240:243], v15, s[36:39], s61 offen offset:0 sc1
    s_waitcnt lgkmcnt(4)
    v_mfma_f32_16x16x32_bf16 v[88:91], v[60:63], v[224:227], v[88:91]
    ds_read_b64_tr_b16 v[56:57], v21 offset:28736
    v_mfma_f32_16x16x32_bf16 v[88:91], v[64:67], v[232:235], v[88:91]
    ds_read_b64_tr_b16 v[58:59], v21 offset:32320
    v_mfma_f32_16x16x32_bf16 v[92:95], v[60:63], v[228:231], v[92:95]
    ds_read_b64_tr_b16 v[60:61], v21 offset:35904
    v_mfma_f32_16x16x32_bf16 v[92:95], v[64:67], v[236:239], v[92:95]
    ds_read_b64_tr_b16 v[62:63], v21 offset:39488
    s_waitcnt lgkmcnt(4)
    v_mfma_f32_16x16x32_bf16 v[96:99], v[68:71], v[224:227], v[96:99]
    ds_read_b64_tr_b16 v[64:65], v21 offset:43072
    v_mfma_f32_16x16x32_bf16 v[96:99], v[52:55], v[232:235], v[96:99]
    ds_read_b64_tr_b16 v[66:67], v21 offset:46656
    buffer_load_dwordx4 v[244:247], v16, s[36:39], s61 offen offset:0 sc1
    v_mfma_f32_16x16x32_bf16 v[100:103], v[68:71], v[228:231], v[100:103]
    ds_read_b64_tr_b16 v[68:69], v21 offset:50240
    v_mfma_f32_16x16x32_bf16 v[100:103], v[52:55], v[236:239], v[100:103]
    ds_read_b64_tr_b16 v[70:71], v21 offset:53824
    s_waitcnt lgkmcnt(4)
    v_mfma_f32_16x16x32_bf16 v[104:107], v[56:59], v[224:227], v[104:107]
    ds_read_b64_tr_b16 v[52:53], v21 offset:28768
    v_mfma_f32_16x16x32_bf16 v[104:107], v[60:63], v[232:235], v[104:107]
    ds_read_b64_tr_b16 v[54:55], v21 offset:32352
    v_mfma_f32_16x16x32_bf16 v[108:111], v[56:59], v[228:231], v[108:111]
    ds_read_b64_tr_b16 v[56:57], v21 offset:35936
    v_mfma_f32_16x16x32_bf16 v[108:111], v[60:63], v[236:239], v[108:111]
    ds_read_b64_tr_b16 v[58:59], v21 offset:39520
    buffer_load_dwordx4 v[248:251], v15, s[36:39], s61 offen offset:1024 sc1
    s_waitcnt lgkmcnt(4)
    v_mfma_f32_16x16x32_bf16 v[112:115], v[64:67], v[224:227], v[112:115]
    ds_read_b64_tr_b16 v[60:61], v21 offset:43104
    v_mfma_f32_16x16x32_bf16 v[112:115], v[68:71], v[232:235], v[112:115]
    ds_read_b64_tr_b16 v[62:63], v21 offset:46688
    s_setprio 1
    v_mfma_f32_16x16x32_bf16 v[116:119], v[64:67], v[228:231], v[116:119]
    ds_read_b64_tr_b16 v[64:65], v21 offset:50272
    v_mfma_f32_16x16x32_bf16 v[116:119], v[68:71], v[236:239], v[116:119]
    ds_read_b64_tr_b16 v[66:67], v21 offset:53856
    s_waitcnt lgkmcnt(4)
    v_mfma_f32_16x16x32_bf16 v[120:123], v[52:55], v[224:227], v[120:123]
    ds_read_b64_tr_b16 v[68:69], v21 offset:28800
    v_mfma_f32_16x16x32_bf16 v[120:123], v[56:59], v[232:235], v[120:123]
    ds_read_b64_tr_b16 v[70:71], v21 offset:32384
    buffer_load_dwordx4 v[252:255], v16, s[36:39], s61 offen offset:1024 sc1
    v_mfma_f32_16x16x32_bf16 v[124:127], v[52:55], v[228:231], v[124:127]
    ds_read_b64_tr_b16 v[52:53], v21 offset:35968
    v_mfma_f32_16x16x32_bf16 v[124:127], v[56:59], v[236:239], v[124:127]
    ds_read_b64_tr_b16 v[54:55], v21 offset:39552
    s_waitcnt lgkmcnt(4)
    v_mfma_f32_16x16x32_bf16 v[128:131], v[60:63], v[224:227], v[128:131]
    ds_read_b64_tr_b16 v[56:57], v21 offset:43136
    v_mfma_f32_16x16x32_bf16 v[128:131], v[64:67], v[232:235], v[128:131]
    ds_read_b64_tr_b16 v[58:59], v21 offset:46720
    v_mfma_f32_16x16x32_bf16 v[132:135], v[60:63], v[228:231], v[132:135]
    ds_read_b64_tr_b16 v[60:61], v21 offset:50304
    v_mfma_f32_16x16x32_bf16 v[132:135], v[64:67], v[236:239], v[132:135]
    ds_read_b64_tr_b16 v[62:63], v21 offset:53888
    s_add_u32 m0, s60, 0
    s_nop 0
    buffer_load_dwordx4 v8, s[32:35], s59 offen lds
    s_waitcnt lgkmcnt(4)
    v_mfma_f32_16x16x32_bf16 v[136:139], v[68:71], v[224:227], v[136:139]
    ds_read_b64_tr_b16 v[64:65], v21 offset:28832
    v_mfma_f32_16x16x32_bf16 v[136:139], v[52:55], v[232:235], v[136:139]
    ds_read_b64_tr_b16 v[66:67], v21 offset:32416
    v_mfma_f32_16x16x32_bf16 v[140:143], v[68:71], v[228:231], v[140:143]
    ds_read_b64_tr_b16 v[68:69], v21 offset:36000
    v_mfma_f32_16x16x32_bf16 v[140:143], v[52:55], v[236:239], v[140:143]
    ds_read_b64_tr_b16 v[70:71], v21 offset:39584
    s_setprio 0
    s_waitcnt lgkmcnt(4)
    v_mfma_f32_16x16x32_bf16 v[144:147], v[56:59], v[224:227], v[144:147]
    ds_read_b64_tr_b16 v[52:53], v21 offset:43168
    v_mfma_f32_16x16x32_bf16 v[144:147], v[60:63], v[232:235], v[144:147]
    ds_read_b64_tr_b16 v[54:55], v21 offset:46752
    s_add_u32 m0, s60, 1024
    s_nop 0
    buffer_load_dwordx4 v9, s[32:35], s59 offen lds
    v_mfma_f32_16x16x32_bf16 v[148:151], v[56:59], v[228:231], v[148:151]
    ds_read_b64_tr_b16 v[56:57], v21 offset:50336
    v_mfma_f32_16x16x32_bf16 v[148:151], v[60:63], v[236:239], v[148:151]
    ds_read_b64_tr_b16 v[58:59], v21 offset:53920
    s_waitcnt lgkmcnt(4)
    v_mfma_f32_16x16x32_bf16 v[152:155], v[64:67], v[224:227], v[152:155]
    ds_read_b64_tr_b16 v[60:61], v23 offset:28672
    v_mfma_f32_16x16x32_bf16 v[152:155], v[68:71], v[232:235], v[152:155]
    ds_read_b64_tr_b16 v[62:63], v23 offset:32256
    v_mfma_f32_16x16x32_bf16 v[156:159], v[64:67], v[228:231], v[156:159]
    ds_read_b64_tr_b16 v[64:65], v23 offset:35840
    v_mfma_f32_16x16x32_bf16 v[156:159], v[68:71], v[236:239], v[156:159]
    ds_read_b64_tr_b16 v[66:67], v23 offset:39424
    s_add_u32 m0, s60, 2048
    s_nop 0
    buffer_load_dwordx4 v10, s[32:35], s59 offen lds
    s_waitcnt lgkmcnt(4)
    v_mfma_f32_16x16x32_bf16 v[160:163], v[52:55], v[224:227], v[160:163]
    ds_read_b64_tr_b16 v[68:69], v23 offset:43008
    v_mfma_f32_16x16x32_bf16 v[160:163], v[56:59], v[232:235], v[160:163]
    ds_read_b64_tr_b16 v[70:71], v23 offset:46592
    v_mfma_f32_16x16x32_bf16 v[164:167], v[52:55], v[228:231], v[164:167]
    ds_read_b64_tr_b16 v[52:53], v23 offset:50176
    v_mfma_f32_16x16x32_bf16 v[164:167], v[56:59], v[236:239], v[164:167]
    ds_read_b64_tr_b16 v[54:55], v23 offset:53760
    s_waitcnt lgkmcnt(4)
    v_mfma_f32_16x16x32_bf16 v[168:171], v[60:63], v[224:227], v[168:171]
    s_waitcnt vmcnt(7)
    s_barrier
    ds_read_b64_tr_b16 v[56:57], v21 offset:57344
    v_mfma_f32_16x16x32_bf16 v[168:171], v[64:67], v[232:235], v[168:171]
    ds_read_b64_tr_b16 v[58:59], v21 offset:60928
    s_setprio 3
    v_mfma_f32_16x16x32_bf16 v[172:175], v[60:63], v[228:231], v[172:175]
    ds_read_b64_tr_b16 v[60:61], v21 offset:64512
    v_mfma_f32_16x16x32_bf16 v[172:175], v[64:67], v[236:239], v[172:175]
    ds_read_b64_tr_b16 v[62:63], v22 offset:2560
    s_add_u32 m0, s60, 3072
    s_mov_b32 exec_hi, 0
    buffer_load_dwordx4 v11, s[32:35], s59 offen lds
    s_mov_b32 exec_hi, -1
    s_add_u32 s59, s59, 458752
    s_waitcnt vmcnt(6)
    v_max3_u32 v12, v240, v241, v242
    v_max3_u32 v13, v243, v244, v245
    v_max3_u32 v12, v12, v246, v247
    v_max_u32 v12, v12, v13
    v_cmp_eq_u32 vcc, -1, v12
    s_cbranch_vccnz qa_kernel_F1_A4_R
qa_kernel_F1_A4_G:
    s_waitcnt lgkmcnt(4)
    v_mfma_f32_16x16x32_bf16 v[176:179], v[68:71], v[224:227], v[176:179]
    ds_read_b64_tr_b16 v[64:65], v22 offset:6144
    v_mfma_f32_16x16x32_bf16 v[176:179], v[52:55], v[232:235], v[176:179]
    ds_read_b64_tr_b16 v[66:67], v22 offset:9728
    s_waitcnt vmcnt(4)
    v_max3_u32 v12, v248, v249, v250
    v_max3_u32 v13, v251, v252, v253
    v_max3_u32 v12, v12, v254, v255
    v_max_u32 v12, v12, v13
    v_cmp_eq_u32 vcc, -1, v12
    s_cbranch_vccnz qa_kernel_F1_A5_R
qa_kernel_F1_A5_G:
    v_mfma_f32_16x16x32_bf16 v[180:183], v[68:71], v[228:231], v[180:183]
    ds_read_b64_tr_b16 v[68:69], v22 offset:13312
    v_mfma_f32_16x16x32_bf16 v[180:183], v[52:55], v[236:239], v[180:183]
    ds_read_b64_tr_b16 v[70:71], v22 offset:16896
    s_waitcnt lgkmcnt(4)
    v_mfma_f32_16x16x32_bf16 v[72:75], v[56:59], v[240:243], v[72:75]
    ds_read_b64_tr_b16 v[52:53], v21 offset:57376
    v_mfma_f32_16x16x32_bf16 v[72:75], v[60:63], v[248:251], v[72:75]
    ds_read_b64_tr_b16 v[54:55], v21 offset:60960
    buffer_load_dwordx4 v[208:211], v15, s[36:39], s61 offen offset:2048 sc1
    v_mfma_f32_16x16x32_bf16 v[76:79], v[56:59], v[244:247], v[76:79]
    ds_read_b64_tr_b16 v[56:57], v21 offset:64544
    v_mfma_f32_16x16x32_bf16 v[76:79], v[60:63], v[252:255], v[76:79]
    ds_read_b64_tr_b16 v[58:59], v22 offset:2592
    s_waitcnt lgkmcnt(4)
    v_mfma_f32_16x16x32_bf16 v[80:83], v[64:67], v[240:243], v[80:83]
    ds_read_b64_tr_b16 v[60:61], v22 offset:6176
    v_mfma_f32_16x16x32_bf16 v[80:83], v[68:71], v[248:251], v[80:83]
    ds_read_b64_tr_b16 v[62:63], v22 offset:9760
    v_min_u32 v188, 880, v2
    v_add_u32 v188, 131072, v188
    v_mfma_f32_16x16x32_bf16 v[84:87], v[64:67], v[244:247], v[84:87]
    ds_read_b64_tr_b16 v[64:65], v22 offset:13344
    v_mfma_f32_16x16x32_bf16 v[84:87], v[68:71], v[252:255], v[84:87]
    ds_read_b64_tr_b16 v[66:67], v22 offset:16928
    s_setprio 2
    buffer_load_dwordx4 v[212:215], v16, s[36:39], s61 offen offset:2048 sc1
    ds_read_b128 v[184:187], v188 offset:20480
    s_waitcnt lgkmcnt(5)
    v_mfma_f32_16x16x32_bf16 v[88:91], v[52:55], v[240:243], v[88:91]
    ds_read_b64_tr_b16 v[68:69], v21 offset:57408
    v_mfma_f32_16x16x32_bf16 v[88:91], v[56:59], v[248:251], v[88:91]
    ds_read_b64_tr_b16 v[70:71], v21 offset:60992
    v_mfma_f32_16x16x32_bf16 v[92:95], v[52:55], v[244:247], v[92:95]
    ds_read_b64_tr_b16 v[52:53], v21 offset:64576
    v_mfma_f32_16x16x32_bf16 v[92:95], v[56:59], v[252:255], v[92:95]
    ds_read_b64_tr_b16 v[54:55], v22 offset:2624
    s_waitcnt lgkmcnt(5)
    v_mfma_f32_16x16x32_bf16 v[96:99], v[60:63], v[240:243], v[96:99]
    ds_read_b64_tr_b16 v[56:57], v22 offset:6208
    v_mfma_f32_16x16x32_bf16 v[96:99], v[64:67], v[248:251], v[96:99]
    ds_read_b64_tr_b16 v[58:59], v22 offset:9792
    buffer_load_dwordx4 v[216:219], v15, s[36:39], s61 offen offset:3072 sc1
    v_mfma_f32_16x16x32_bf16 v[100:103], v[60:63], v[244:247], v[100:103]
    ds_read_b64_tr_b16 v[60:61], v22 offset:13376
    v_mfma_f32_16x16x32_bf16 v[100:103], v[64:67], v[252:255], v[100:103]
    ds_read_b64_tr_b16 v[62:63], v22 offset:16960
    s_waitcnt lgkmcnt(4)
    v_mfma_f32_16x16x32_bf16 v[104:107], v[68:71], v[240:243], v[104:107]
    ds_read_b64_tr_b16 v[64:65], v21 offset:57440
    v_mfma_f32_16x16x32_bf16 v[104:107], v[52:55], v[248:251], v[104:107]
    ds_read_b64_tr_b16 v[66:67], v21 offset:61024
    v_max3_u32 v12, v184, v185, v186
    v_max_u32 v12, v12, v187
    v_cmp_eq_u32 vcc, -1, v12
    s_cbranch_vccnz qa_kernel_CK1_R
qa_kernel_CK1_G:
    v_mfma_f32_16x16x32_bf16 v[108:111], v[68:71], v[244:247], v[108:111]
    ds_read_b64_tr_b16 v[68:69], v21 offset:64608
    v_mfma_f32_16x16x32_bf16 v[108:111], v[52:55], v[252:255], v[108:111]
    ds_read_b64_tr_b16 v[70:71], v22 offset:2656
    buffer_load_dwordx4 v[220:223], v16, s[36:39], s61 offen offset:3072 sc1
    s_add_u32 s61, s61, 4096
    s_waitcnt lgkmcnt(4)
    v_mfma_f32_16x16x32_bf16 v[112:115], v[56:59], v[240:243], v[112:115]
    ds_read_b64_tr_b16 v[52:53], v22 offset:6240
    v_mfma_f32_16x16x32_bf16 v[112:115], v[60:63], v[248:251], v[112:115]
    ds_read_b64_tr_b16 v[54:55], v22 offset:9824
    s_setprio 1
    v_mfma_f32_16x16x32_bf16 v[116:119], v[56:59], v[244:247], v[116:119]
    ds_read_b64_tr_b16 v[56:57], v22 offset:13408
    v_mfma_f32_16x16x32_bf16 v[116:119], v[60:63], v[252:255], v[116:119]
    ds_read_b64_tr_b16 v[58:59], v22 offset:16992
    s_waitcnt lgkmcnt(4)
    v_mfma_f32_16x16x32_bf16 v[120:123], v[64:67], v[240:243], v[120:123]
    ds_read_b64_tr_b16 v[60:61], v21 offset:57472
    v_mfma_f32_16x16x32_bf16 v[120:123], v[68:71], v[248:251], v[120:123]
    ds_read_b64_tr_b16 v[62:63], v21 offset:61056
    s_add_u32 m0, s60, 28672
    s_nop 0
    buffer_load_dwordx4 v8, s[32:35], s59 offen lds
    v_mfma_f32_16x16x32_bf16 v[124:127], v[64:67], v[244:247], v[124:127]
    ds_read_b64_tr_b16 v[64:65], v21 offset:64640
    v_mfma_f32_16x16x32_bf16 v[124:127], v[68:71], v[252:255], v[124:127]
    ds_read_b64_tr_b16 v[66:67], v22 offset:2688
    s_waitcnt lgkmcnt(4)
    v_mfma_f32_16x16x32_bf16 v[128:131], v[52:55], v[240:243], v[128:131]
    ds_read_b64_tr_b16 v[68:69], v22 offset:6272
    v_mfma_f32_16x16x32_bf16 v[128:131], v[56:59], v[248:251], v[128:131]
    ds_read_b64_tr_b16 v[70:71], v22 offset:9856
    v_mfma_f32_16x16x32_bf16 v[132:135], v[52:55], v[244:247], v[132:135]
    ds_read_b64_tr_b16 v[52:53], v22 offset:13440
    v_mfma_f32_16x16x32_bf16 v[132:135], v[56:59], v[252:255], v[132:135]
    ds_read_b64_tr_b16 v[54:55], v22 offset:17024
    s_add_u32 m0, s60, 29696
    s_nop 0
    buffer_load_dwordx4 v9, s[32:35], s59 offen lds
    s_waitcnt lgkmcnt(4)
    v_mfma_f32_16x16x32_bf16 v[136:139], v[60:63], v[240:243], v[136:139]
    ds_read_b64_tr_b16 v[56:57], v21 offset:57504
    v_mfma_f32_16x16x32_bf16 v[136:139], v[64:67], v[248:251], v[136:139]
    ds_read_b64_tr_b16 v[58:59], v21 offset:61088
    v_mfma_f32_16x16x32_bf16 v[140:143], v[60:63], v[244:247], v[140:143]
    ds_read_b64_tr_b16 v[60:61], v21 offset:64672
    v_mfma_f32_16x16x32_bf16 v[140:143], v[64:67], v[252:255], v[140:143]
    ds_read_b64_tr_b16 v[62:63], v22 offset:2720
    s_setprio 0
    s_waitcnt lgkmcnt(4)
    v_mfma_f32_16x16x32_bf16 v[144:147], v[68:71], v[240:243], v[144:147]
    ds_read_b64_tr_b16 v[64:65], v22 offset:6304
    v_mfma_f32_16x16x32_bf16 v[144:147], v[52:55], v[248:251], v[144:147]
    ds_read_b64_tr_b16 v[66:67], v22 offset:9888
    s_add_u32 m0, s60, 30720
    s_nop 0
    buffer_load_dwordx4 v10, s[32:35], s59 offen lds
    v_mfma_f32_16x16x32_bf16 v[148:151], v[68:71], v[244:247], v[148:151]
    ds_read_b64_tr_b16 v[68:69], v22 offset:13472
    v_mfma_f32_16x16x32_bf16 v[148:151], v[52:55], v[252:255], v[148:151]
    ds_read_b64_tr_b16 v[70:71], v22 offset:17056
    s_waitcnt lgkmcnt(4)
    v_mfma_f32_16x16x32_bf16 v[152:155], v[56:59], v[240:243], v[152:155]
    ds_read_b64_tr_b16 v[52:53], v23 offset:57344
    v_mfma_f32_16x16x32_bf16 v[152:155], v[60:63], v[248:251], v[152:155]
    ds_read_b64_tr_b16 v[54:55], v23 offset:60928
    v_mfma_f32_16x16x32_bf16 v[156:159], v[56:59], v[244:247], v[156:159]
    ds_read_b64_tr_b16 v[56:57], v23 offset:64512
    v_mfma_f32_16x16x32_bf16 v[156:159], v[60:63], v[252:255], v[156:159]
    ds_read_b64_tr_b16 v[58:59], v24 offset:2560
    s_add_u32 m0, s60, 31744
    s_mov_b32 exec_hi, 0
    buffer_load_dwordx4 v11, s[32:35], s59 offen lds
    s_mov_b32 exec_hi, -1
    s_add_u32 s59, s59, 458752
    s_waitcnt lgkmcnt(4)
    v_mfma_f32_16x16x32_bf16 v[160:163], v[64:67], v[240:243], v[160:163]
    ds_read_b64_tr_b16 v[60:61], v24 offset:6144
    v_mfma_f32_16x16x32_bf16 v[160:163], v[68:71], v[248:251], v[160:163]
    ds_read_b64_tr_b16 v[62:63], v24 offset:9728
    v_mfma_f32_16x16x32_bf16 v[164:167], v[64:67], v[244:247], v[164:167]
    ds_read_b64_tr_b16 v[64:65], v24 offset:13312
    v_mfma_f32_16x16x32_bf16 v[164:167], v[68:71], v[252:255], v[164:167]
    ds_read_b64_tr_b16 v[66:67], v24 offset:16896
    s_waitcnt lgkmcnt(4)
    v_mfma_f32_16x16x32_bf16 v[168:171], v[52:55], v[240:243], v[168:171]
    s_waitcnt vmcnt(8)
    s_barrier
    ds_read_b64_tr_b16 v[68:69], v17 offset:0
    v_mfma_f32_16x16x32_bf16 v[168:171], v[56:59], v[248:251], v[168:171]
    ds_read_b64_tr_b16 v[70:71], v17 offset:3584
    s_setprio 3
    v_mfma_f32_16x16x32_bf16 v[172:175], v[52:55], v[244:247], v[172:175]
    ds_read_b64_tr_b16 v[52:53], v17 offset:7168
    v_mfma_f32_16x16x32_bf16 v[172:175], v[56:59], v[252:255], v[172:175]
    ds_read_b64_tr_b16 v[54:55], v17 offset:10752
    buffer_load_dwordx4 v[224:227], v15, s[36:39], s61 offen offset:0 sc1
    s_waitcnt vmcnt(7)
    v_max3_u32 v12, v208, v209, v210
    v_max3_u32 v13, v211, v212, v213
    v_max3_u32 v12, v12, v214, v215
    v_max_u32 v12, v12, v13
    v_cmp_eq_u32 vcc, -1, v12
    s_cbranch_vccnz qa_kernel_F1_A6_R
qa_kernel_F1_A6_G:
    s_waitcnt lgkmcnt(4)
    v_mfma_f32_16x16x32_bf16 v[176:179], v[60:63], v[240:243], v[176:179]
    ds_read_b64_tr_b16 v[56:57], v17 offset:14336
    v_mfma_f32_16x16x32_bf16 v[176:179], v[64:67], v[248:251], v[176:179]
    ds_read_b64_tr_b16 v[58:59], v17 offset:17920
    s_waitcnt vmcnt(5)
    v_max3_u32 v12, v216, v217, v218
    v_max3_u32 v13, v219, v220, v221
    v_max3_u32 v12, v12, v222, v223
    v_max_u32 v12, v12, v13
    v_cmp_eq_u32 vcc, -1, v12
    s_cbranch_vccnz qa_kernel_F1_A7_R
qa_kernel_F1_A7_G:
    v_mfma_f32_16x16x32_bf16 v[180:183], v[60:63], v[244:247], v[180:183]
    ds_read_b64_tr_b16 v[60:61], v17 offset:21504
    v_mfma_f32_16x16x32_bf16 v[180:183], v[64:67], v[252:255], v[180:183]
    ds_read_b64_tr_b16 v[62:63], v17 offset:25088
    s_waitcnt lgkmcnt(4)
    v_mfma_f32_16x16x32_bf16 v[72:75], v[68:71], v[208:211], v[72:75]
    ds_read_b64_tr_b16 v[64:65], v17 offset:32
    v_mfma_f32_16x16x32_bf16 v[72:75], v[52:55], v[216:219], v[72:75]
    ds_read_b64_tr_b16 v[66:67], v17 offset:3616
    buffer_load_dwordx4 v[228:231], v16, s[36:39], s61 offen offset:0 sc1
    v_mfma_f32_16x16x32_bf16 v[76:79], v[68:71], v[212:215], v[76:79]
    ds_read_b64_tr_b16 v[68:69], v17 offset:7200
    v_mfma_f32_16x16x32_bf16 v[76:79], v[52:55], v[220:223], v[76:79]
    ds_read_b64_tr_b16 v[70:71], v17 offset:10784
    s_waitcnt lgkmcnt(4)
    v_mfma_f32_16x16x32_bf16 v[80:83], v[56:59], v[208:211], v[80:83]
    ds_read_b64_tr_b16 v[52:53], v17 offset:14368
    v_mfma_f32_16x16x32_bf16 v[80:83], v[60:63], v[216:219], v[80:83]
    ds_read_b64_tr_b16 v[54:55], v17 offset:17952
    v_mfma_f32_16x16x32_bf16 v[84:87], v[56:59], v[212:215], v[84:87]
    ds_read_b64_tr_b16 v[56:57], v17 offset:21536
    v_mfma_f32_16x16x32_bf16 v[84:87], v[60:63], v[220:223], v[84:87]
    ds_read_b64_tr_b16 v[58:59], v17 offset:25120
    s_setprio 2
    buffer_load_dwordx4 v[232:235], v15, s[36:39], s61 offen offset:1024 sc1
    s_waitcnt lgkmcnt(4)
    v_mfma_f32_16x16x32_bf16 v[88:91], v[64:67], v[208:211], v[88:91]
    ds_read_b64_tr_b16 v[60:61], v17 offset:64
    v_mfma_f32_16x16x32_bf16 v[88:91], v[68:71], v[216:219], v[88:91]
    ds_read_b64_tr_b16 v[62:63], v17 offset:3648
    v_mfma_f32_16x16x32_bf16 v[92:95], v[64:67], v[212:215], v[92:95]
    ds_read_b64_tr_b16 v[64:65], v17 offset:7232
    v_mfma_f32_16x16x32_bf16 v[92:95], v[68:71], v[220:223], v[92:95]
    ds_read_b64_tr_b16 v[66:67], v17 offset:10816
    s_waitcnt lgkmcnt(4)
    v_mfma_f32_16x16x32_bf16 v[96:99], v[52:55], v[208:211], v[96:99]
    ds_read_b64_tr_b16 v[68:69], v17 offset:14400
    v_mfma_f32_16x16x32_bf16 v[96:99], v[56:59], v[216:219], v[96:99]
    ds_read_b64_tr_b16 v[70:71], v17 offset:17984
    buffer_load_dwordx4 v[236:239], v16, s[36:39], s61 offen offset:1024 sc1
    v_mfma_f32_16x16x32_bf16 v[100:103], v[52:55], v[212:215], v[100:103]
    ds_read_b64_tr_b16 v[52:53], v17 offset:21568
    v_mfma_f32_16x16x32_bf16 v[100:103], v[56:59], v[220:223], v[100:103]
    ds_read_b64_tr_b16 v[54:55], v17 offset:25152
    s_waitcnt lgkmcnt(4)
    v_mfma_f32_16x16x32_bf16 v[104:107], v[60:63], v[208:211], v[104:107]
    ds_read_b64_tr_b16 v[56:57], v17 offset:96
    v_mfma_f32_16x16x32_bf16 v[104:107], v[64:67], v[216:219], v[104:107]
    ds_read_b64_tr_b16 v[58:59], v17 offset:3680
    v_mfma_f32_16x16x32_bf16 v[108:111], v[60:63], v[212:215], v[108:111]
    ds_read_b64_tr_b16 v[60:61], v17 offset:7264
    v_mfma_f32_16x16x32_bf16 v[108:111], v[64:67], v[220:223], v[108:111]
    ds_read_b64_tr_b16 v[62:63], v17 offset:10848
    s_add_u32 m0, s60, 65536
    s_nop 0
    buffer_load_dwordx4 v8, s[32:35], s59 offen lds
    s_waitcnt lgkmcnt(4)
    v_mfma_f32_16x16x32_bf16 v[112:115], v[68:71], v[208:211], v[112:115]
    ds_read_b64_tr_b16 v[64:65], v17 offset:14432
    v_mfma_f32_16x16x32_bf16 v[112:115], v[52:55], v[216:219], v[112:115]
    ds_read_b64_tr_b16 v[66:67], v17 offset:18016
    s_setprio 1
    v_mfma_f32_16x16x32_bf16 v[116:119], v[68:71], v[212:215], v[116:119]
    ds_read_b64_tr_b16 v[68:69], v17 offset:21600
    v_mfma_f32_16x16x32_bf16 v[116:119], v[52:55], v[220:223], v[116:119]
    ds_read_b64_tr_b16 v[70:71], v17 offset:25184
    s_waitcnt lgkmcnt(4)
    v_mfma_f32_16x16x32_bf16 v[120:123], v[56:59], v[208:211], v[120:123]
    ds_read_b64_tr_b16 v[52:53], v17 offset:128
    v_mfma_f32_16x16x32_bf16 v[120:123], v[60:63], v[216:219], v[120:123]
    ds_read_b64_tr_b16 v[54:55], v17 offset:3712
    s_add_u32 m0, s60, 66560
    s_nop 0
    buffer_load_dwordx4 v9, s[32:35], s59 offen lds
    v_mfma_f32_16x16x32_bf16 v[124:127], v[56:59], v[212:215], v[124:127]
    ds_read_b64_tr_b16 v[56:57], v17 offset:7296
    v_mfma_f32_16x16x32_bf16 v[124:127], v[60:63], v[220:223], v[124:127]
    ds_read_b64_tr_b16 v[58:59], v17 offset:10880
    s_waitcnt lgkmcnt(4)
    v_mfma_f32_16x16x32_bf16 v[128:131], v[64:67], v[208:211], v[128:131]
    ds_read_b64_tr_b16 v[60:61], v17 offset:14464
    v_mfma_f32_16x16x32_bf16 v[128:131], v[68:71], v[216:219], v[128:131]
    ds_read_b64_tr_b16 v[62:63], v17 offset:18048
    v_mfma_f32_16x16x32_bf16 v[132:135], v[64:67], v[212:215], v[132:135]
    ds_read_b64_tr_b16 v[64:65], v17 offset:21632
    v_mfma_f32_16x16x32_bf16 v[132:135], v[68:71], v[220:223], v[132:135]
    ds_read_b64_tr_b16 v[66:67], v17 offset:25216
    s_add_u32 m0, s60, 67584
    s_nop 0
    buffer_load_dwordx4 v10, s[32:35], s59 offen lds
    s_waitcnt lgkmcnt(4)
    v_mfma_f32_16x16x32_bf16 v[136:139], v[52:55], v[208:211], v[136:139]
    ds_read_b64_tr_b16 v[68:69], v17 offset:160
    v_mfma_f32_16x16x32_bf16 v[136:139], v[56:59], v[216:219], v[136:139]
    ds_read_b64_tr_b16 v[70:71], v17 offset:3744
    v_mfma_f32_16x16x32_bf16 v[140:143], v[52:55], v[212:215], v[140:143]
    ds_read_b64_tr_b16 v[52:53], v17 offset:7328
    v_mfma_f32_16x16x32_bf16 v[140:143], v[56:59], v[220:223], v[140:143]
    ds_read_b64_tr_b16 v[54:55], v17 offset:10912
    s_setprio 0
    s_waitcnt lgkmcnt(4)
    v_mfma_f32_16x16x32_bf16 v[144:147], v[60:63], v[208:211], v[144:147]
    ds_read_b64_tr_b16 v[56:57], v17 offset:14496
    v_mfma_f32_16x16x32_bf16 v[144:147], v[64:67], v[216:219], v[144:147]
    ds_read_b64_tr_b16 v[58:59], v17 offset:18080
    s_add_u32 m0, s60, 68608
    s_mov_b32 exec_hi, 0
    buffer_load_dwordx4 v11, s[32:35], s59 offen lds
    s_mov_b32 exec_hi, -1
    s_add_u32 s59, s59, 458752
    v_mfma_f32_16x16x32_bf16 v[148:151], v[60:63], v[212:215], v[148:151]
    ds_read_b64_tr_b16 v[60:61], v17 offset:21664
    v_mfma_f32_16x16x32_bf16 v[148:151], v[64:67], v[220:223], v[148:151]
    ds_read_b64_tr_b16 v[62:63], v17 offset:25248
    s_waitcnt lgkmcnt(4)
    v_mfma_f32_16x16x32_bf16 v[152:155], v[68:71], v[208:211], v[152:155]
    ds_read_b64_tr_b16 v[64:65], v18 offset:0
    v_mfma_f32_16x16x32_bf16 v[152:155], v[52:55], v[216:219], v[152:155]
    ds_read_b64_tr_b16 v[66:67], v18 offset:3584
    v_mfma_f32_16x16x32_bf16 v[156:159], v[68:71], v[212:215], v[156:159]
    ds_read_b64_tr_b16 v[68:69], v18 offset:7168
    v_mfma_f32_16x16x32_bf16 v[156:159], v[52:55], v[220:223], v[156:159]
    ds_read_b64_tr_b16 v[70:71], v18 offset:10752
    buffer_load_dwordx4 v[240:243], v15, s[36:39], s61 offen offset:2048 sc1
    s_waitcnt lgkmcnt(4)
    v_mfma_f32_16x16x32_bf16 v[160:163], v[56:59], v[208:211], v[160:163]
    ds_read_b64_tr_b16 v[52:53], v18 offset:14336
    v_mfma_f32_16x16x32_bf16 v[160:163], v[60:63], v[216:219], v[160:163]
    ds_read_b64_tr_b16 v[54:55], v18 offset:17920
    v_mfma_f32_16x16x32_bf16 v[164:167], v[56:59], v[212:215], v[164:167]
qa_kernel_WS1_7:
    s_cbranch_execz qa_kernel_WRET1
    ds_read_b64_tr_b16 v[56:57], v18 offset:21504
    v_mfma_f32_16x16x32_bf16 v[164:167], v[60:63], v[220:223], v[164:167]
    ds_read_b64_tr_b16 v[58:59], v18 offset:25088
    s_waitcnt lgkmcnt(4)
    v_mfma_f32_16x16x32_bf16 v[168:171], v[64:67], v[208:211], v[168:171]
    s_waitcnt vmcnt(9)
    s_barrier
    ds_read_b64_tr_b16 v[60:61], v17 offset:28672
    v_mfma_f32_16x16x32_bf16 v[168:171], v[68:71], v[216:219], v[168:171]
    ds_read_b64_tr_b16 v[62:63], v17 offset:32256
    s_setprio 3
    v_mfma_f32_16x16x32_bf16 v[172:175], v[64:67], v[212:215], v[172:175]
    ds_read_b64_tr_b16 v[64:65], v17 offset:35840
    v_mfma_f32_16x16x32_bf16 v[172:175], v[68:71], v[220:223], v[172:175]
    ds_read_b64_tr_b16 v[66:67], v17 offset:39424
    buffer_load_dwordx4 v[244:247], v16, s[36:39], s61 offen offset:2048 sc1
    s_waitcnt vmcnt(8)
    v_max3_u32 v12, v224, v225, v226
    v_max3_u32 v13, v227, v228, v229
    v_max3_u32 v12, v12, v230, v231
    v_max_u32 v12, v12, v13
    v_cmp_eq_u32 vcc, -1, v12
    s_cbranch_vccnz qa_kernel_F1_A8_R
qa_kernel_F1_A8_G:
    s_waitcnt lgkmcnt(4)
    v_mfma_f32_16x16x32_bf16 v[176:179], v[52:55], v[208:211], v[176:179]
    ds_read_b64_tr_b16 v[68:69], v17 offset:43008
    v_mfma_f32_16x16x32_bf16 v[176:179], v[56:59], v[216:219], v[176:179]
    ds_read_b64_tr_b16 v[70:71], v17 offset:46592
    s_waitcnt vmcnt(6)
    v_max3_u32 v12, v232, v233, v234
    v_max3_u32 v13, v235, v236, v237
    v_max3_u32 v12, v12, v238, v239
    v_max_u32 v12, v12, v13
    v_cmp_eq_u32 vcc, -1, v12
    s_cbranch_vccnz qa_kernel_F1_A9_R
qa_kernel_F1_A9_G:
    v_mfma_f32_16x16x32_bf16 v[180:183], v[52:55], v[212:215], v[180:183]
    ds_read_b64_tr_b16 v[52:53], v17 offset:50176
    v_mfma_f32_16x16x32_bf16 v[180:183], v[56:59], v[220:223], v[180:183]
    ds_read_b64_tr_b16 v[54:55], v17 offset:53760
    s_waitcnt lgkmcnt(4)
    v_mfma_f32_16x16x32_bf16 v[72:75], v[60:63], v[224:227], v[72:75]
    ds_read_b64_tr_b16 v[56:57], v17 offset:28704
    v_mfma_f32_16x16x32_bf16 v[72:75], v[64:67], v[232:235], v[72:75]
    ds_read_b64_tr_b16 v[58:59], v17 offset:32288
    buffer_load_dwordx4 v[248:251], v15, s[36:39], s61 offen offset:3072 sc1
    v_mfma_f32_16x16x32_bf16 v[76:79], v[60:63], v[228:231], v[76:79]
    ds_read_b64_tr_b16 v[60:61], v17 offset:35872
    v_mfma_f32_16x16x32_bf16 v[76:79], v[64:67], v[236:239], v[76:79]
    ds_read_b64_tr_b16 v[62:63], v17 offset:39456
    s_waitcnt lgkmcnt(4)
    v_mfma_f32_16x16x32_bf16 v[80:83], v[68:71], v[224:227], v[80:83]
    ds_read_b64_tr_b16 v[64:65], v17 offset:43040
    v_mfma_f32_16x16x32_bf16 v[80:83], v[52:55], v[232:235], v[80:83]
    ds_read_b64_tr_b16 v[66:67], v17 offset:46624
    v_mfma_f32_16x16x32_bf16 v[84:87], v[68:71], v[228:231], v[84:87]
    ds_read_b64_tr_b16 v[68:69], v17 offset:50208
    v_mfma_f32_16x16x32_bf16 v[84:87], v[52:55], v[236:239], v[84:87]
    ds_read_b64_tr_b16 v[70:71], v17 offset:53792
    s_setprio 2
    buffer_load_dwordx4 v[252:255], v16, s[36:39], s61 offen offset:3072 sc1
    s_add_u32 s61, s61, 4096
    s_waitcnt lgkmcnt(4)
    v_mfma_f32_16x16x32_bf16 v[88:91], v[56:59], v[224:227], v[88:91]
    ds_read_b64_tr_b16 v[52:53], v17 offset:28736
    v_mfma_f32_16x16x32_bf16 v[88:91], v[60:63], v[232:235], v[88:91]
    ds_read_b64_tr_b16 v[54:55], v17 offset:32320
    v_mfma_f32_16x16x32_bf16 v[92:95], v[56:59], v[228:231], v[92:95]
    ds_read_b64_tr_b16 v[56:57], v17 offset:35904
    v_mfma_f32_16x16x32_bf16 v[92:95], v[60:63], v[236:239], v[92:95]
    ds_read_b64_tr_b16 v[58:59], v17 offset:39488
    s_waitcnt lgkmcnt(4)
    v_mfma_f32_16x16x32_bf16 v[96:99], v[64:67], v[224:227], v[96:99]
    ds_read_b64_tr_b16 v[60:61], v17 offset:43072
    v_mfma_f32_16x16x32_bf16 v[96:99], v[68:71], v[232:235], v[96:99]
    ds_read_b64_tr_b16 v[62:63], v17 offset:46656
    s_add_u32 m0, s60, 94208
    s_nop 0
    buffer_load_dwordx4 v8, s[32:35], s59 offen lds
    v_mfma_f32_16x16x32_bf16 v[100:103], v[64:67], v[228:231], v[100:103]
    ds_read_b64_tr_b16 v[64:65], v17 offset:50240
    v_mfma_f32_16x16x32_bf16 v[100:103], v[68:71], v[236:239], v[100:103]
    ds_read_b64_tr_b16 v[66:67], v17 offset:53824
    s_waitcnt lgkmcnt(4)
    v_mfma_f32_16x16x32_bf16 v[104:107], v[52:55], v[224:227], v[104:107]
    ds_read_b64_tr_b16 v[68:69], v17 offset:28768
    v_mfma_f32_16x16x32_bf16 v[104:107], v[56:59], v[232:235], v[104:107]
    ds_read_b64_tr_b16 v[70:71], v17 offset:32352
    v_mfma_f32_16x16x32_bf16 v[108:111], v[52:55], v[228:231], v[108:111]
    ds_read_b64_tr_b16 v[52:53], v17 offset:35936
    v_mfma_f32_16x16x32_bf16 v[108:111], v[56:59], v[236:239], v[108:111]
    ds_read_b64_tr_b16 v[54:55], v17 offset:39520
    s_add_u32 m0, s60, 95232
    s_nop 0
    buffer_load_dwordx4 v9, s[32:35], s59 offen lds
    s_waitcnt lgkmcnt(4)
    v_mfma_f32_16x16x32_bf16 v[112:115], v[60:63], v[224:227], v[112:115]
    ds_read_b64_tr_b16 v[56:57], v17 offset:43104
    v_mfma_f32_16x16x32_bf16 v[112:115], v[64:67], v[232:235], v[112:115]
    ds_read_b64_tr_b16 v[58:59], v17 offset:46688
    s_setprio 1
    v_mfma_f32_16x16x32_bf16 v[116:119], v[60:63], v[228:231], v[116:119]
    ds_read_b64_tr_b16 v[60:61], v17 offset:50272
    v_mfma_f32_16x16x32_bf16 v[116:119], v[64:67], v[236:239], v[116:119]
    ds_read_b64_tr_b16 v[62:63], v17 offset:53856
    s_waitcnt lgkmcnt(4)
    v_mfma_f32_16x16x32_bf16 v[120:123], v[68:71], v[224:227], v[120:123]
    ds_read_b64_tr_b16 v[64:65], v17 offset:28800
    v_mfma_f32_16x16x32_bf16 v[120:123], v[52:55], v[232:235], v[120:123]
    ds_read_b64_tr_b16 v[66:67], v17 offset:32384
    s_add_u32 m0, s60, 96256
    s_nop 0
    buffer_load_dwordx4 v10, s[32:35], s59 offen lds
    v_mfma_f32_16x16x32_bf16 v[124:127], v[68:71], v[228:231], v[124:127]
    ds_read_b64_tr_b16 v[68:69], v17 offset:35968
    v_mfma_f32_16x16x32_bf16 v[124:127], v[52:55], v[236:239], v[124:127]
    ds_read_b64_tr_b16 v[70:71], v17 offset:39552
    s_waitcnt lgkmcnt(4)
    v_mfma_f32_16x16x32_bf16 v[128:131], v[56:59], v[224:227], v[128:131]
    ds_read_b64_tr_b16 v[52:53], v17 offset:43136
    v_mfma_f32_16x16x32_bf16 v[128:131], v[60:63], v[232:235], v[128:131]
    ds_read_b64_tr_b16 v[54:55], v17 offset:46720
    v_mfma_f32_16x16x32_bf16 v[132:135], v[56:59], v[228:231], v[132:135]
    ds_read_b64_tr_b16 v[56:57], v17 offset:50304
    v_mfma_f32_16x16x32_bf16 v[132:135], v[60:63], v[236:239], v[132:135]
    ds_read_b64_tr_b16 v[58:59], v17 offset:53888
    s_add_u32 m0, s60, 97280
    s_mov_b32 exec_hi, 0
    buffer_load_dwordx4 v11, s[32:35], s59 offen lds
    s_mov_b32 exec_hi, -1
    s_add_u32 s59, s59, 458752
    s_waitcnt lgkmcnt(4)
    v_mfma_f32_16x16x32_bf16 v[136:139], v[64:67], v[224:227], v[136:139]
    ds_read_b64_tr_b16 v[60:61], v17 offset:28832
    v_mfma_f32_16x16x32_bf16 v[136:139], v[68:71], v[232:235], v[136:139]
    ds_read_b64_tr_b16 v[62:63], v17 offset:32416
    v_mfma_f32_16x16x32_bf16 v[140:143], v[64:67], v[228:231], v[140:143]
    ds_read_b64_tr_b16 v[64:65], v17 offset:36000
    v_mfma_f32_16x16x32_bf16 v[140:143], v[68:71], v[236:239], v[140:143]
    ds_read_b64_tr_b16 v[66:67], v17 offset:39584
    s_setprio 0
    s_waitcnt lgkmcnt(4)
    v_mfma_f32_16x16x32_bf16 v[144:147], v[52:55], v[224:227], v[144:147]
    ds_read_b64_tr_b16 v[68:69], v17 offset:43168
    v_mfma_f32_16x16x32_bf16 v[144:147], v[56:59], v[232:235], v[144:147]
    ds_read_b64_tr_b16 v[70:71], v17 offset:46752
    buffer_load_dwordx4 v[208:211], v15, s[36:39], s61 offen offset:0 sc1
    v_mfma_f32_16x16x32_bf16 v[148:151], v[52:55], v[228:231], v[148:151]
    ds_read_b64_tr_b16 v[52:53], v17 offset:50336
    v_mfma_f32_16x16x32_bf16 v[148:151], v[56:59], v[236:239], v[148:151]
    ds_read_b64_tr_b16 v[54:55], v17 offset:53920
    s_waitcnt lgkmcnt(4)
    v_mfma_f32_16x16x32_bf16 v[152:155], v[60:63], v[224:227], v[152:155]
    ds_read_b64_tr_b16 v[56:57], v18 offset:28672
    v_mfma_f32_16x16x32_bf16 v[152:155], v[64:67], v[232:235], v[152:155]
    ds_read_b64_tr_b16 v[58:59], v18 offset:32256
    v_mfma_f32_16x16x32_bf16 v[156:159], v[60:63], v[228:231], v[156:159]
    ds_read_b64_tr_b16 v[60:61], v18 offset:35840
    v_mfma_f32_16x16x32_bf16 v[156:159], v[64:67], v[236:239], v[156:159]
    ds_read_b64_tr_b16 v[62:63], v18 offset:39424
    buffer_load_dwordx4 v[212:215], v16, s[36:39], s61 offen offset:0 sc1
    s_waitcnt lgkmcnt(4)
    v_mfma_f32_16x16x32_bf16 v[160:163], v[68:71], v[224:227], v[160:163]
    ds_read_b64_tr_b16 v[64:65], v18 offset:43008
    v_mfma_f32_16x16x32_bf16 v[160:163], v[52:55], v[232:235], v[160:163]
    ds_read_b64_tr_b16 v[66:67], v18 offset:46592
    v_mfma_f32_16x16x32_bf16 v[164:167], v[68:71], v[228:231], v[164:167]
    ds_read_b64_tr_b16 v[68:69], v18 offset:50176
    v_mfma_f32_16x16x32_bf16 v[164:167], v[52:55], v[236:239], v[164:167]
    ds_read_b64_tr_b16 v[70:71], v18 offset:53760
    s_waitcnt lgkmcnt(4)
    v_mfma_f32_16x16x32_bf16 v[168:171], v[56:59], v[224:227], v[168:171]
    s_waitcnt vmcnt(10)
    s_barrier
    ds_read_b64_tr_b16 v[52:53], v21 offset:0
    v_mfma_f32_16x16x32_bf16 v[168:171], v[60:63], v[232:235], v[168:171]
    ds_read_b64_tr_b16 v[54:55], v21 offset:3584
    s_setprio 3
    v_mfma_f32_16x16x32_bf16 v[172:175], v[56:59], v[228:231], v[172:175]
    ds_read_b64_tr_b16 v[56:57], v21 offset:7168
    v_mfma_f32_16x16x32_bf16 v[172:175], v[60:63], v[236:239], v[172:175]
    ds_read_b64_tr_b16 v[58:59], v21 offset:10752
    buffer_load_dwordx4 v[216:219], v15, s[36:39], s61 offen offset:1024 sc1
    s_waitcnt vmcnt(9)
    v_max3_u32 v12, v240, v241, v242
    v_max3_u32 v13, v243, v244, v245
    v_max3_u32 v12, v12, v246, v247
    v_max_u32 v12, v12, v13
    v_cmp_eq_u32 vcc, -1, v12
    s_cbranch_vccnz qa_kernel_F1_A10_R
qa_kernel_F1_A10_G:
    s_waitcnt lgkmcnt(4)
    v_mfma_f32_16x16x32_bf16 v[176:179], v[64:67], v[224:227], v[176:179]
    ds_read_b64_tr_b16 v[60:61], v21 offset:14336
    v_mfma_f32_16x16x32_bf16 v[176:179], v[68:71], v[232:235], v[176:179]
    ds_read_b64_tr_b16 v[62:63], v21 offset:17920
    s_waitcnt vmcnt(7)
    v_max3_u32 v12, v248, v249, v250
    v_max3_u32 v13, v251, v252, v253
    v_max3_u32 v12, v12, v254, v255
    v_max_u32 v12, v12, v13
    v_cmp_eq_u32 vcc, -1, v12
    s_cbranch_vccnz qa_kernel_F1_A11_R
qa_kernel_F1_A11_G:
    v_mfma_f32_16x16x32_bf16 v[180:183], v[64:67], v[228:231], v[180:183]
    ds_read_b64_tr_b16 v[64:65], v21 offset:21504
    v_mfma_f32_16x16x32_bf16 v[180:183], v[68:71], v[236:239], v[180:183]
    ds_read_b64_tr_b16 v[66:67], v21 offset:25088
    s_waitcnt lgkmcnt(4)
    v_mfma_f32_16x16x32_bf16 v[72:75], v[52:55], v[240:243], v[72:75]
    ds_read_b64_tr_b16 v[68:69], v21 offset:32
    v_mfma_f32_16x16x32_bf16 v[72:75], v[56:59], v[248:251], v[72:75]
    ds_read_b64_tr_b16 v[70:71], v21 offset:3616
    buffer_load_dwordx4 v[220:223], v16, s[36:39], s61 offen offset:1024 sc1
    v_mfma_f32_16x16x32_bf16 v[76:79], v[52:55], v[244:247], v[76:79]
    ds_read_b64_tr_b16 v[52:53], v21 offset:7200
    v_mfma_f32_16x16x32_bf16 v[76:79], v[56:59], v[252:255], v[76:79]
    ds_read_b64_tr_b16 v[54:55], v21 offset:10784
    s_waitcnt lgkmcnt(4)
    v_mfma_f32_16x16x32_bf16 v[80:83], v[60:63], v[240:243], v[80:83]
    ds_read_b64_tr_b16 v[56:57], v21 offset:14368
    v_mfma_f32_16x16x32_bf16 v[80:83], v[64:67], v[248:251], v[80:83]
    ds_read_b64_tr_b16 v[58:59], v21 offset:17952
    v_mfma_f32_16x16x32_bf16 v[84:87], v[60:63], v[244:247], v[84:87]
    ds_read_b64_tr_b16 v[60:61], v21 offset:21536
    v_mfma_f32_16x16x32_bf16 v[84:87], v[64:67], v[252:255], v[84:87]
    ds_read_b64_tr_b16 v[62:63], v21 offset:25120
    s_setprio 2
    s_add_u32 m0, s60, 122880
    s_nop 0
    buffer_load_dwordx4 v8, s[32:35], s59 offen lds
    s_waitcnt lgkmcnt(4)
    v_mfma_f32_16x16x32_bf16 v[88:91], v[68:71], v[240:243], v[88:91]
    ds_read_b64_tr_b16 v[64:65], v21 offset:64
    v_mfma_f32_16x16x32_bf16 v[88:91], v[52:55], v[248:251], v[88:91]
    ds_read_b64_tr_b16 v[66:67], v21 offset:3648
    v_mfma_f32_16x16x32_bf16 v[92:95], v[68:71], v[244:247], v[92:95]
    ds_read_b64_tr_b16 v[68:69], v21 offset:7232
    v_mfma_f32_16x16x32_bf16 v[92:95], v[52:55], v[252:255], v[92:95]
    ds_read_b64_tr_b16 v[70:71], v21 offset:10816
    s_waitcnt lgkmcnt(4)
    v_mfma_f32_16x16x32_bf16 v[96:99], v[56:59], v[240:243], v[96:99]
    ds_read_b64_tr_b16 v[52:53], v21 offset:14400
    v_mfma_f32_16x16x32_bf16 v[96:99], v[60:63], v[248:251], v[96:99]
    ds_read_b64_tr_b16 v[54:55], v21 offset:17984
    s_add_u32 m0, s60, 123904
    s_nop 0
    buffer_load_dwordx4 v9, s[32:35], s59 offen lds
    v_mfma_f32_16x16x32_bf16 v[100:103], v[56:59], v[244:247], v[100:103]
    ds_read_b64_tr_b16 v[56:57], v21 offset:21568
    v_mfma_f32_16x16x32_bf16 v[100:103], v[60:63], v[252:255], v[100:103]
    ds_read_b64_tr_b16 v[58:59], v21 offset:25152
    s_waitcnt lgkmcnt(4)
    v_mfma_f32_16x16x32_bf16 v[104:107], v[64:67], v[240:243], v[104:107]
    ds_read_b64_tr_b16 v[60:61], v21 offset:96
    v_mfma_f32_16x16x32_bf16 v[104:107], v[68:71], v[248:251], v[104:107]
    ds_read_b64_tr_b16 v[62:63], v21 offset:3680
    v_mfma_f32_16x16x32_bf16 v[108:111], v[64:67], v[244:247], v[108:111]
    ds_read_b64_tr_b16 v[64:65], v21 offset:7264
    v_mfma_f32_16x16x32_bf16 v[108:111], v[68:71], v[252:255], v[108:111]
    ds_read_b64_tr_b16 v[66:67], v21 offset:10848
    s_add_u32 m0, s60, 124928
    s_nop 0
    buffer_load_dwordx4 v10, s[32:35], s59 offen lds
    s_waitcnt lgkmcnt(4)
    v_mfma_f32_16x16x32_bf16 v[112:115], v[52:55], v[240:243], v[112:115]
    ds_read_b64_tr_b16 v[68:69], v21 offset:14432
    v_mfma_f32_16x16x32_bf16 v[112:115], v[56:59], v[248:251], v[112:115]
    ds_read_b64_tr_b16 v[70:71], v21 offset:18016
    s_setprio 1
    v_mfma_f32_16x16x32_bf16 v[116:119], v[52:55], v[244:247], v[116:119]
    ds_read_b64_tr_b16 v[52:53], v21 offset:21600
    v_mfma_f32_16x16x32_bf16 v[116:119], v[56:59], v[252:255], v[116:119]
    ds_read_b64_tr_b16 v[54:55], v21 offset:25184
    s_waitcnt lgkmcnt(4)
    v_mfma_f32_16x16x32_bf16 v[120:123], v[60:63], v[240:243], v[120:123]
    ds_read_b64_tr_b16 v[56:57], v21 offset:128
    v_mfma_f32_16x16x32_bf16 v[120:123], v[64:67], v[248:251], v[120:123]
    ds_read_b64_tr_b16 v[58:59], v21 offset:3712
    s_add_u32 m0, s60, 125952
    s_mov_b32 exec_hi, 0
    buffer_load_dwordx4 v11, s[32:35], s59 offen lds
    s_mov_b32 exec_hi, -1
    s_add_u32 s59, s59, 458752
    v_mfma_f32_16x16x32_bf16 v[124:127], v[60:63], v[244:247], v[124:127]
    ds_read_b64_tr_b16 v[60:61], v21 offset:7296
    v_mfma_f32_16x16x32_bf16 v[124:127], v[64:67], v[252:255], v[124:127]
    ds_read_b64_tr_b16 v[62:63], v21 offset:10880
    s_waitcnt lgkmcnt(4)
    v_mfma_f32_16x16x32_bf16 v[128:131], v[68:71], v[240:243], v[128:131]
    ds_read_b64_tr_b16 v[64:65], v21 offset:14464
    v_mfma_f32_16x16x32_bf16 v[128:131], v[52:55], v[248:251], v[128:131]
    ds_read_b64_tr_b16 v[66:67], v21 offset:18048
    v_mfma_f32_16x16x32_bf16 v[132:135], v[68:71], v[244:247], v[132:135]
    ds_read_b64_tr_b16 v[68:69], v21 offset:21632
    v_mfma_f32_16x16x32_bf16 v[132:135], v[52:55], v[252:255], v[132:135]
    ds_read_b64_tr_b16 v[70:71], v21 offset:25216
    buffer_load_dwordx4 v[224:227], v15, s[36:39], s61 offen offset:2048 sc1
    s_waitcnt lgkmcnt(4)
    v_mfma_f32_16x16x32_bf16 v[136:139], v[56:59], v[240:243], v[136:139]
    ds_read_b64_tr_b16 v[52:53], v21 offset:160
    v_mfma_f32_16x16x32_bf16 v[136:139], v[60:63], v[248:251], v[136:139]
    ds_read_b64_tr_b16 v[54:55], v21 offset:3744
    v_mfma_f32_16x16x32_bf16 v[140:143], v[56:59], v[244:247], v[140:143]
    ds_read_b64_tr_b16 v[56:57], v21 offset:7328
    v_mfma_f32_16x16x32_bf16 v[140:143], v[60:63], v[252:255], v[140:143]
    ds_read_b64_tr_b16 v[58:59], v21 offset:10912
    s_setprio 0
    s_waitcnt lgkmcnt(4)
    v_mfma_f32_16x16x32_bf16 v[144:147], v[64:67], v[240:243], v[144:147]
    ds_read_b64_tr_b16 v[60:61], v21 offset:14496
    v_mfma_f32_16x16x32_bf16 v[144:147], v[68:71], v[248:251], v[144:147]
    ds_read_b64_tr_b16 v[62:63], v21 offset:18080
    buffer_load_dwordx4 v[228:231], v16, s[36:39], s61 offen offset:2048 sc1
    v_mfma_f32_16x16x32_bf16 v[148:151], v[64:67], v[244:247], v[148:151]
    ds_read_b64_tr_b16 v[64:65], v21 offset:21664
    v_mfma_f32_16x16x32_bf16 v[148:151], v[68:71], v[252:255], v[148:151]
    ds_read_b64_tr_b16 v[66:67], v21 offset:25248
    s_waitcnt lgkmcnt(4)
    v_mfma_f32_16x16x32_bf16 v[152:155], v[52:55], v[240:243], v[152:155]
    ds_read_b64_tr_b16 v[68:69], v23 offset:0
    v_mfma_f32_16x16x32_bf16 v[152:155], v[56:59], v[248:251], v[152:155]
    ds_read_b64_tr_b16 v[70:71], v23 offset:3584
    v_mfma_f32_16x16x32_bf16 v[156:159], v[52:55], v[244:247], v[156:159]
    ds_read_b64_tr_b16 v[52:53], v23 offset:7168
    v_mfma_f32_16x16x32_bf16 v[156:159], v[56:59], v[252:255], v[156:159]
    ds_read_b64_tr_b16 v[54:55], v23 offset:10752
    buffer_load_dwordx2 v[184:185], v25, s[36:39], s63 offen offset:0 sc1
    buffer_load_dwordx2 v[186:187], v25, s[36:39], s63 offen offset:128 sc1
    s_waitcnt lgkmcnt(4)
    v_mfma_f32_16x16x32_bf16 v[160:163], v[60:63], v[240:243], v[160:163]
    ds_read_b64_tr_b16 v[56:57], v23 offset:14336
    v_mfma_f32_16x16x32_bf16 v[160:163], v[64:67], v[248:251], v[160:163]
    ds_read_b64_tr_b16 v[58:59], v23 offset:17920
    v_mfma_f32_16x16x32_bf16 v[164:167], v[60:63], v[244:247], v[164:167]
    ds_read_b64_tr_b16 v[60:61], v23 offset:21504
    v_mfma_f32_16x16x32_bf16 v[164:167], v[64:67], v[252:255], v[164:167]
    ds_read_b64_tr_b16 v[62:63], v23 offset:25088
    s_waitcnt lgkmcnt(4)
    v_mfma_f32_16x16x32_bf16 v[168:171], v[68:71], v[240:243], v[168:171]
    s_waitcnt vmcnt(12)
    s_barrier
    ds_read_b64_tr_b16 v[64:65], v21 offset:28672
    v_mfma_f32_16x16x32_bf16 v[168:171], v[52:55], v[248:251], v[168:171]
    ds_read_b64_tr_b16 v[66:67], v21 offset:32256
    s_setprio 3
    v_mfma_f32_16x16x32_bf16 v[172:175], v[68:71], v[244:247], v[172:175]
    ds_read_b64_tr_b16 v[68:69], v21 offset:35840
    v_mfma_f32_16x16x32_bf16 v[172:175], v[52:55], v[252:255], v[172:175]
    ds_read_b64_tr_b16 v[70:71], v21 offset:39424
    buffer_load_dwordx2 v[188:189], v25, s[36:39], s63 offen offset:256 sc1
    buffer_load_dwordx2 v[190:191], v25, s[36:39], s63 offen offset:384 sc1
    s_waitcnt vmcnt(12)
    v_max3_u32 v12, v208, v209, v210
    v_max3_u32 v13, v211, v212, v213
    v_max3_u32 v12, v12, v214, v215
    v_max_u32 v12, v12, v13
    v_cmp_eq_u32 vcc, -1, v12
    s_cbranch_vccnz qa_kernel_F1_A12_R
qa_kernel_F1_A12_G:
    s_waitcnt lgkmcnt(4)
    v_mfma_f32_16x16x32_bf16 v[176:179], v[56:59], v[240:243], v[176:179]
    ds_read_b64_tr_b16 v[52:53], v21 offset:43008
    v_mfma_f32_16x16x32_bf16 v[176:179], v[60:63], v[248:251], v[176:179]
    ds_read_b64_tr_b16 v[54:55], v21 offset:46592
    s_waitcnt vmcnt(10)
    v_max3_u32 v12, v216, v217, v218
    v_max3_u32 v13, v219, v220, v221
    v_max3_u32 v12, v12, v222, v223
    v_max_u32 v12, v12, v13
    v_cmp_eq_u32 vcc, -1, v12
    s_cbranch_vccnz qa_kernel_F1_A13_R
qa_kernel_F1_A13_G:
    v_mfma_f32_16x16x32_bf16 v[180:183], v[56:59], v[244:247], v[180:183]
    ds_read_b64_tr_b16 v[56:57], v21 offset:50176
    v_mfma_f32_16x16x32_bf16 v[180:183], v[60:63], v[252:255], v[180:183]
    ds_read_b64_tr_b16 v[58:59], v21 offset:53760
    s_waitcnt lgkmcnt(4)
    v_mfma_f32_16x16x32_bf16 v[72:75], v[64:67], v[208:211], v[72:75]
    ds_read_b64_tr_b16 v[60:61], v21 offset:28704
    v_mfma_f32_16x16x32_bf16 v[72:75], v[68:71], v[216:219], v[72:75]
    ds_read_b64_tr_b16 v[62:63], v21 offset:32288
    buffer_load_dwordx2 v[192:193], v25, s[36:39], s63 offen offset:2048 sc1
    buffer_load_dwordx2 v[194:195], v25, s[36:39], s63 offen offset:2176 sc1
    v_mfma_f32_16x16x32_bf16 v[76:79], v[64:67], v[212:215], v[76:79]
    ds_read_b64_tr_b16 v[64:65], v21 offset:35872
    v_mfma_f32_16x16x32_bf16 v[76:79], v[68:71], v[220:223], v[76:79]
    ds_read_b64_tr_b16 v[66:67], v21 offset:39456
    s_waitcnt lgkmcnt(4)
    v_mfma_f32_16x16x32_bf16 v[80:83], v[52:55], v[208:211], v[80:83]
    ds_read_b64_tr_b16 v[68:69], v21 offset:43040
    v_mfma_f32_16x16x32_bf16 v[80:83], v[56:59], v[216:219], v[80:83]
    ds_read_b64_tr_b16 v[70:71], v21 offset:46624
    v_mfma_f32_16x16x32_bf16 v[84:87], v[52:55], v[212:215], v[84:87]
    ds_read_b64_tr_b16 v[52:53], v21 offset:50208
    v_mfma_f32_16x16x32_bf16 v[84:87], v[56:59], v[220:223], v[84:87]
    ds_read_b64_tr_b16 v[54:55], v21 offset:53792
    s_setprio 2
    buffer_load_dwordx2 v[196:197], v25, s[36:39], s63 offen offset:2304 sc1
    buffer_load_dwordx2 v[198:199], v25, s[36:39], s63 offen offset:2432 sc1
    s_waitcnt lgkmcnt(4)
    v_mfma_f32_16x16x32_bf16 v[88:91], v[60:63], v[208:211], v[88:91]
    ds_read_b64_tr_b16 v[56:57], v21 offset:28736
    v_mfma_f32_16x16x32_bf16 v[88:91], v[64:67], v[216:219], v[88:91]
    ds_read_b64_tr_b16 v[58:59], v21 offset:32320
    v_mfma_f32_16x16x32_bf16 v[92:95], v[60:63], v[212:215], v[92:95]
    ds_read_b64_tr_b16 v[60:61], v21 offset:35904
    v_mfma_f32_16x16x32_bf16 v[92:95], v[64:67], v[220:223], v[92:95]
    ds_read_b64_tr_b16 v[62:63], v21 offset:39488
    s_waitcnt lgkmcnt(4)
    v_mfma_f32_16x16x32_bf16 v[96:99], v[68:71], v[208:211], v[96:99]
    ds_read_b64_tr_b16 v[64:65], v21 offset:43072
    v_mfma_f32_16x16x32_bf16 v[96:99], v[52:55], v[216:219], v[96:99]
    ds_read_b64_tr_b16 v[66:67], v21 offset:46656
    buffer_load_dwordx4 v[232:235], v15, s[36:39], s61 offen offset:3072 sc1
    v_mfma_f32_16x16x32_bf16 v[100:103], v[68:71], v[212:215], v[100:103]
    ds_read_b64_tr_b16 v[68:69], v21 offset:50240
    v_mfma_f32_16x16x32_bf16 v[100:103], v[52:55], v[220:223], v[100:103]
    ds_read_b64_tr_b16 v[70:71], v21 offset:53824
    s_waitcnt lgkmcnt(4)
    v_mfma_f32_16x16x32_bf16 v[104:107], v[56:59], v[208:211], v[104:107]
    ds_read_b64_tr_b16 v[52:53], v21 offset:28768
    v_mfma_f32_16x16x32_bf16 v[104:107], v[60:63], v[216:219], v[104:107]
    ds_read_b64_tr_b16 v[54:55], v21 offset:32352
    v_mfma_f32_16x16x32_bf16 v[108:111], v[56:59], v[212:215], v[108:111]
    ds_read_b64_tr_b16 v[56:57], v21 offset:35936
    v_mfma_f32_16x16x32_bf16 v[108:111], v[60:63], v[220:223], v[108:111]
    ds_read_b64_tr_b16 v[58:59], v21 offset:39520
    buffer_load_dwordx4 v[236:239], v16, s[36:39], s61 offen offset:3072 sc1
    s_add_u32 s61, s61, 4096
    s_waitcnt lgkmcnt(4)
    v_mfma_f32_16x16x32_bf16 v[112:115], v[64:67], v[208:211], v[112:115]
    ds_read_b64_tr_b16 v[60:61], v21 offset:43104
    v_mfma_f32_16x16x32_bf16 v[112:115], v[68:71], v[216:219], v[112:115]
    ds_read_b64_tr_b16 v[62:63], v21 offset:46688
    s_setprio 1
    v_mfma_f32_16x16x32_bf16 v[116:119], v[64:67], v[212:215], v[116:119]
    ds_read_b64_tr_b16 v[64:65], v21 offset:50272
    v_mfma_f32_16x16x32_bf16 v[116:119], v[68:71], v[220:223], v[116:119]
    ds_read_b64_tr_b16 v[66:67], v21 offset:53856
    s_waitcnt lgkmcnt(4)
    v_mfma_f32_16x16x32_bf16 v[120:123], v[52:55], v[208:211], v[120:123]
    ds_read_b64_tr_b16 v[68:69], v21 offset:28800
    v_mfma_f32_16x16x32_bf16 v[120:123], v[56:59], v[216:219], v[120:123]
    ds_read_b64_tr_b16 v[70:71], v21 offset:32384
    s_add_u32 m0, s60, 0
    s_nop 0
    buffer_load_dwordx4 v8, s[32:35], s59 offen lds
    v_mfma_f32_16x16x32_bf16 v[124:127], v[52:55], v[212:215], v[124:127]
    ds_read_b64_tr_b16 v[52:53], v21 offset:35968
    v_mfma_f32_16x16x32_bf16 v[124:127], v[56:59], v[220:223], v[124:127]
    ds_read_b64_tr_b16 v[54:55], v21 offset:39552
    s_waitcnt lgkmcnt(4)
    v_mfma_f32_16x16x32_bf16 v[128:131], v[60:63], v[208:211], v[128:131]
    ds_read_b64_tr_b16 v[56:57], v21 offset:43136
    v_mfma_f32_16x16x32_bf16 v[128:131], v[64:67], v[216:219], v[128:131]
    ds_read_b64_tr_b16 v[58:59], v21 offset:46720
    v_mfma_f32_16x16x32_bf16 v[132:135], v[60:63], v[212:215], v[132:135]
    ds_read_b64_tr_b16 v[60:61], v21 offset:50304
    v_mfma_f32_16x16x32_bf16 v[132:135], v[64:67], v[220:223], v[132:135]
    ds_read_b64_tr_b16 v[62:63], v21 offset:53888
    s_add_u32 m0, s60, 1024
    s_nop 0
    buffer_load_dwordx4 v9, s[32:35], s59 offen lds
    s_waitcnt lgkmcnt(4)
    v_mfma_f32_16x16x32_bf16 v[136:139], v[68:71], v[208:211], v[136:139]
    ds_read_b64_tr_b16 v[64:65], v21 offset:28832
    v_mfma_f32_16x16x32_bf16 v[136:139], v[52:55], v[216:219], v[136:139]
    ds_read_b64_tr_b16 v[66:67], v21 offset:32416
    v_mfma_f32_16x16x32_bf16 v[140:143], v[68:71], v[212:215], v[140:143]
    ds_read_b64_tr_b16 v[68:69], v21 offset:36000
    v_mfma_f32_16x16x32_bf16 v[140:143], v[52:55], v[220:223], v[140:143]
    ds_read_b64_tr_b16 v[70:71], v21 offset:39584
    s_setprio 0
    s_waitcnt lgkmcnt(4)
    v_mfma_f32_16x16x32_bf16 v[144:147], v[56:59], v[208:211], v[144:147]
    ds_read_b64_tr_b16 v[52:53], v21 offset:43168
    v_mfma_f32_16x16x32_bf16 v[144:147], v[60:63], v[216:219], v[144:147]
    ds_read_b64_tr_b16 v[54:55], v21 offset:46752
    s_add_u32 m0, s60, 2048
    s_nop 0
    buffer_load_dwordx4 v10, s[32:35], s59 offen lds
    v_mfma_f32_16x16x32_bf16 v[148:151], v[56:59], v[212:215], v[148:151]
    ds_read_b64_tr_b16 v[56:57], v21 offset:50336
    v_mfma_f32_16x16x32_bf16 v[148:151], v[60:63], v[220:223], v[148:151]
    ds_read_b64_tr_b16 v[58:59], v21 offset:53920
    s_waitcnt lgkmcnt(4)
    v_mfma_f32_16x16x32_bf16 v[152:155], v[64:67], v[208:211], v[152:155]
    ds_read_b64_tr_b16 v[60:61], v23 offset:28672
    v_mfma_f32_16x16x32_bf16 v[152:155], v[68:71], v[216:219], v[152:155]
    ds_read_b64_tr_b16 v[62:63], v23 offset:32256
    v_mfma_f32_16x16x32_bf16 v[156:159], v[64:67], v[212:215], v[156:159]
    ds_read_b64_tr_b16 v[64:65], v23 offset:35840
    v_mfma_f32_16x16x32_bf16 v[156:159], v[68:71], v[220:223], v[156:159]
    ds_read_b64_tr_b16 v[66:67], v23 offset:39424
    s_add_u32 m0, s60, 3072
    s_mov_b32 exec_hi, 0
    buffer_load_dwordx4 v11, s[32:35], s59 offen lds
    s_mov_b32 exec_hi, -1
    s_add_u32 s59, s59, 458752
    s_waitcnt lgkmcnt(4)
    v_mfma_f32_16x16x32_bf16 v[160:163], v[52:55], v[208:211], v[160:163]
    ds_read_b64_tr_b16 v[68:69], v23 offset:43008
    v_mfma_f32_16x16x32_bf16 v[160:163], v[56:59], v[216:219], v[160:163]
    ds_read_b64_tr_b16 v[70:71], v23 offset:46592
    v_mfma_f32_16x16x32_bf16 v[164:167], v[52:55], v[212:215], v[164:167]
    ds_read_b64_tr_b16 v[52:53], v23 offset:50176
    v_mfma_f32_16x16x32_bf16 v[164:167], v[56:59], v[220:223], v[164:167]
    ds_read_b64_tr_b16 v[54:55], v23 offset:53760
    s_waitcnt lgkmcnt(4)
    v_mfma_f32_16x16x32_bf16 v[168:171], v[60:63], v[208:211], v[168:171]
    s_waitcnt vmcnt(16)
    s_barrier
    ds_read_b64_tr_b16 v[56:57], v21 offset:57344
    v_mfma_f32_16x16x32_bf16 v[168:171], v[64:67], v[216:219], v[168:171]
    ds_read_b64_tr_b16 v[58:59], v21 offset:60928
    s_setprio 3
    v_mfma_f32_16x16x32_bf16 v[172:175], v[60:63], v[212:215], v[172:175]
    ds_read_b64_tr_b16 v[60:61], v21 offset:64512
    v_mfma_f32_16x16x32_bf16 v[172:175], v[64:67], v[220:223], v[172:175]
    ds_read_b64_tr_b16 v[62:63], v22 offset:2560
    buffer_load_dwordx4 v[240:243], v15, s[36:39], s61 offen offset:0 sc1
    s_waitcnt vmcnt(15)
    v_max3_u32 v12, v224, v225, v226
    v_max3_u32 v13, v227, v228, v229
    v_max3_u32 v12, v12, v230, v231
    v_max_u32 v12, v12, v13
    v_cmp_eq_u32 vcc, -1, v12
    s_cbranch_vccnz qa_kernel_F1_A14_R
qa_kernel_F1_A14_G:
    s_waitcnt lgkmcnt(4)
    v_mfma_f32_16x16x32_bf16 v[176:179], v[68:71], v[208:211], v[176:179]
    ds_read_b64_tr_b16 v[64:65], v22 offset:6144
    v_mfma_f32_16x16x32_bf16 v[176:179], v[52:55], v[216:219], v[176:179]
    ds_read_b64_tr_b16 v[66:67], v22 offset:9728
    s_waitcnt vmcnt(5)
    v_max3_u32 v12, v232, v233, v234
    v_max3_u32 v13, v235, v236, v237
    v_max3_u32 v12, v12, v238, v239
    v_max_u32 v12, v12, v13
    v_cmp_eq_u32 vcc, -1, v12
    s_cbranch_vccnz qa_kernel_F1_A15_R
qa_kernel_F1_A15_G:
    v_mfma_f32_16x16x32_bf16 v[180:183], v[68:71], v[212:215], v[180:183]
    ds_read_b64_tr_b16 v[68:69], v22 offset:13312
    v_mfma_f32_16x16x32_bf16 v[180:183], v[52:55], v[220:223], v[180:183]
    ds_read_b64_tr_b16 v[70:71], v22 offset:16896
    s_waitcnt lgkmcnt(4)
    v_mfma_f32_16x16x32_bf16 v[72:75], v[56:59], v[224:227], v[72:75]
    ds_read_b64_tr_b16 v[52:53], v21 offset:57376
    v_mfma_f32_16x16x32_bf16 v[72:75], v[60:63], v[232:235], v[72:75]
    ds_read_b64_tr_b16 v[54:55], v21 offset:60960
    buffer_load_dwordx4 v[244:247], v16, s[36:39], s61 offen offset:0 sc1
    v_mfma_f32_16x16x32_bf16 v[76:79], v[56:59], v[228:231], v[76:79]
    ds_read_b64_tr_b16 v[56:57], v21 offset:64544
    v_mfma_f32_16x16x32_bf16 v[76:79], v[60:63], v[236:239], v[76:79]
    ds_read_b64_tr_b16 v[58:59], v22 offset:2592
    s_waitcnt lgkmcnt(4)
    v_mfma_f32_16x16x32_bf16 v[80:83], v[64:67], v[224:227], v[80:83]
    ds_read_b64_tr_b16 v[60:61], v22 offset:6176
    v_mfma_f32_16x16x32_bf16 v[80:83], v[68:71], v[232:235], v[80:83]
    ds_read_b64_tr_b16 v[62:63], v22 offset:9760
    v_mfma_f32_16x16x32_bf16 v[84:87], v[64:67], v[228:231], v[84:87]
    ds_read_b64_tr_b16 v[64:65], v22 offset:13344
    v_mfma_f32_16x16x32_bf16 v[84:87], v[68:71], v[236:239], v[84:87]
    ds_read_b64_tr_b16 v[66:67], v22 offset:16928
    s_setprio 2
    buffer_load_dwordx4 v[248:251], v15, s[36:39], s61 offen offset:1024 sc1
    s_waitcnt lgkmcnt(4)
    v_mfma_f32_16x16x32_bf16 v[88:91], v[52:55], v[224:227], v[88:91]
    ds_read_b64_tr_b16 v[68:69], v21 offset:57408
    v_mfma_f32_16x16x32_bf16 v[88:91], v[56:59], v[232:235], v[88:91]
    ds_read_b64_tr_b16 v[70:71], v21 offset:60992
    v_mfma_f32_16x16x32_bf16 v[92:95], v[52:55], v[228:231], v[92:95]
    ds_read_b64_tr_b16 v[52:53], v21 offset:64576
    v_mfma_f32_16x16x32_bf16 v[92:95], v[56:59], v[236:239], v[92:95]
    ds_read_b64_tr_b16 v[54:55], v22 offset:2624
qa_kernel_WS1_8:
    s_cbranch_execz qa_kernel_WRET1
    s_waitcnt lgkmcnt(4)
    v_mfma_f32_16x16x32_bf16 v[96:99], v[60:63], v[224:227], v[96:99]
    ds_read_b64_tr_b16 v[56:57], v22 offset:6208
    v_mfma_f32_16x16x32_bf16 v[96:99], v[64:67], v[232:235], v[96:99]
    ds_read_b64_tr_b16 v[58:59], v22 offset:9792
    buffer_load_dwordx4 v[252:255], v16, s[36:39], s61 offen offset:1024 sc1
    v_mfma_f32_16x16x32_bf16 v[100:103], v[60:63], v[228:231], v[100:103]
    ds_read_b64_tr_b16 v[60:61], v22 offset:13376
    v_mfma_f32_16x16x32_bf16 v[100:103], v[64:67], v[236:239], v[100:103]
    ds_read_b64_tr_b16 v[62:63], v22 offset:16960
    s_waitcnt lgkmcnt(4)
    v_mfma_f32_16x16x32_bf16 v[104:107], v[68:71], v[224:227], v[104:107]
    ds_read_b64_tr_b16 v[64:65], v21 offset:57440
    v_mfma_f32_16x16x32_bf16 v[104:107], v[52:55], v[232:235], v[104:107]
    ds_read_b64_tr_b16 v[66:67], v21 offset:61024
    v_mfma_f32_16x16x32_bf16 v[108:111], v[68:71], v[228:231], v[108:111]
    ds_read_b64_tr_b16 v[68:69], v21 offset:64608
    v_mfma_f32_16x16x32_bf16 v[108:111], v[52:55], v[236:239], v[108:111]
    ds_read_b64_tr_b16 v[70:71], v22 offset:2656
    s_add_u32 m0, s60, 28672
    s_nop 0
    buffer_load_dwordx4 v8, s[32:35], s59 offen lds
    s_waitcnt lgkmcnt(4)
    v_mfma_f32_16x16x32_bf16 v[112:115], v[56:59], v[224:227], v[112:115]
    ds_read_b64_tr_b16 v[52:53], v22 offset:6240
    v_mfma_f32_16x16x32_bf16 v[112:115], v[60:63], v[232:235], v[112:115]
    ds_read_b64_tr_b16 v[54:55], v22 offset:9824
    s_setprio 1
    v_mfma_f32_16x16x32_bf16 v[116:119], v[56:59], v[228:231], v[116:119]
    ds_read_b64_tr_b16 v[56:57], v22 offset:13408
    v_mfma_f32_16x16x32_bf16 v[116:119], v[60:63], v[236:239], v[116:119]
    ds_read_b64_tr_b16 v[58:59], v22 offset:16992
    s_waitcnt lgkmcnt(4)
    v_mfma_f32_16x16x32_bf16 v[120:123], v[64:67], v[224:227], v[120:123]
    ds_read_b64_tr_b16 v[60:61], v21 offset:57472
    v_mfma_f32_16x16x32_bf16 v[120:123], v[68:71], v[232:235], v[120:123]
    ds_read_b64_tr_b16 v[62:63], v21 offset:61056
    s_add_u32 m0, s60, 29696
    s_nop 0
    buffer_load_dwordx4 v9, s[32:35], s59 offen lds
    v_mfma_f32_16x16x32_bf16 v[124:127], v[64:67], v[228:231], v[124:127]
    ds_read_b64_tr_b16 v[64:65], v21 offset:64640
    v_mfma_f32_16x16x32_bf16 v[124:127], v[68:71], v[236:239], v[124:127]
    ds_read_b64_tr_b16 v[66:67], v22 offset:2688
    s_waitcnt lgkmcnt(4)
    v_mfma_f32_16x16x32_bf16 v[128:131], v[52:55], v[224:227], v[128:131]
    ds_read_b64_tr_b16 v[68:69], v22 offset:6272
    v_mfma_f32_16x16x32_bf16 v[128:131], v[56:59], v[232:235], v[128:131]
    ds_read_b64_tr_b16 v[70:71], v22 offset:9856
    v_max3_u32 v12, v184, v185, v186
    v_max3_u32 v13, v187, v188, v189
    v_max3_u32 v12, v12, v190, v191
    v_max3_u32 v13, v13, v192, v193
    v_max3_u32 v12, v12, v194, v195
    v_max3_u32 v13, v13, v196, v197
    v_max3_u32 v12, v12, v198, v199
    v_max_u32 v12, v12, v13
    v_cmp_eq_u32 vcc, -1, v12
    s_cbranch_vccnz qa_kernel_ST1_R
qa_kernel_ST1_G:
    v_add_f32 v184, v184, v186
    v_mfma_f32_16x16x32_bf16 v[132:135], v[52:55], v[228:231], v[132:135]
    ds_read_b64_tr_b16 v[52:53], v22 offset:13440
    v_mfma_f32_16x16x32_bf16 v[132:135], v[56:59], v[236:239], v[132:135]
    ds_read_b64_tr_b16 v[54:55], v22 offset:17024
    s_add_u32 m0, s60, 30720
    s_nop 0
    buffer_load_dwordx4 v10, s[32:35], s59 offen lds
    v_add_f32 v185, v185, v187
    v_add_f32 v188, v188, v190
    s_waitcnt lgkmcnt(4)
    v_mfma_f32_16x16x32_bf16 v[136:139], v[60:63], v[224:227], v[136:139]
    ds_read_b64_tr_b16 v[56:57], v21 offset:57504
    v_mfma_f32_16x16x32_bf16 v[136:139], v[64:67], v[232:235], v[136:139]
    ds_read_b64_tr_b16 v[58:59], v21 offset:61088
    v_add_f32 v189, v189, v191
    v_add_f32 v184, v184, v188
    v_mfma_f32_16x16x32_bf16 v[140:143], v[60:63], v[228:231], v[140:143]
    ds_read_b64_tr_b16 v[60:61], v21 offset:64672
    v_mfma_f32_16x16x32_bf16 v[140:143], v[64:67], v[236:239], v[140:143]
    ds_read_b64_tr_b16 v[62:63], v22 offset:2720
    s_setprio 0
    v_add_f32 v185, v185, v189
    v_add_f32 v192, v192, v194
    s_waitcnt lgkmcnt(4)
    v_mfma_f32_16x16x32_bf16 v[144:147], v[68:71], v[224:227], v[144:147]
    ds_read_b64_tr_b16 v[64:65], v22 offset:6304
    v_mfma_f32_16x16x32_bf16 v[144:147], v[52:55], v[232:235], v[144:147]
    ds_read_b64_tr_b16 v[66:67], v22 offset:9888
    s_add_u32 m0, s60, 31744
    s_mov_b32 exec_hi, 0
    buffer_load_dwordx4 v11, s[32:35], s59 offen lds
    s_mov_b32 exec_hi, -1
    s_add_u32 s59, s59, 458752
    v_add_f32 v193, v193, v195
    v_add_f32 v196, v196, v198
    v_mfma_f32_16x16x32_bf16 v[148:151], v[68:71], v[228:231], v[148:151]
    ds_read_b64_tr_b16 v[68:69], v22 offset:13472
    v_mfma_f32_16x16x32_bf16 v[148:151], v[52:55], v[236:239], v[148:151]
    ds_read_b64_tr_b16 v[70:71], v22 offset:17056
    v_add_f32 v197, v197, v199
    v_add_f32 v192, v192, v196
    s_waitcnt lgkmcnt(4)
    v_mfma_f32_16x16x32_bf16 v[152:155], v[56:59], v[224:227], v[152:155]
    ds_read_b64_tr_b16 v[52:53], v23 offset:57344
    v_mfma_f32_16x16x32_bf16 v[152:155], v[60:63], v[232:235], v[152:155]
    ds_read_b64_tr_b16 v[54:55], v23 offset:60928
    v_add_f32 v193, v193, v197
    v_mov_b32 v186, v184
    v_mfma_f32_16x16x32_bf16 v[156:159], v[56:59], v[228:231], v[156:159]
    ds_read_b64_tr_b16 v[56:57], v23 offset:64512
    v_mfma_f32_16x16x32_bf16 v[156:159], v[60:63], v[236:239], v[156:159]
    ds_read_b64_tr_b16 v[58:59], v24 offset:2560
    buffer_load_dwordx4 v[208:211], v15, s[36:39], s61 offen offset:2048 sc1
    v_mov_b32 v187, v185
    v_mov_b32 v194, v192
    s_waitcnt lgkmcnt(4)
    v_mfma_f32_16x16x32_bf16 v[160:163], v[64:67], v[224:227], v[160:163]
    ds_read_b64_tr_b16 v[60:61], v24 offset:6144
    v_mfma_f32_16x16x32_bf16 v[160:163], v[68:71], v[232:235], v[160:163]
    ds_read_b64_tr_b16 v[62:63], v24 offset:9728
    v_mov_b32 v195, v193
    v_permlane16_swap_b32 v184, v186
    v_mfma_f32_16x16x32_bf16 v[164:167], v[64:67], v[228:231], v[164:167]
    ds_read_b64_tr_b16 v[64:65], v24 offset:13312
    v_mfma_f32_16x16x32_bf16 v[164:167], v[68:71], v[236:239], v[164:167]
    ds_read_b64_tr_b16 v[66:67], v24 offset:16896
    v_permlane16_swap_b32 v185, v187
    v_permlane16_swap_b32 v192, v194
    s_waitcnt lgkmcnt(4)
    v_mfma_f32_16x16x32_bf16 v[168:171], v[52:55], v[224:227], v[168:171]
    s_waitcnt vmcnt(9)
    s_barrier
    ds_read_b64_tr_b16 v[68:69], v17 offset:0
    v_mfma_f32_16x16x32_bf16 v[168:171], v[56:59], v[232:235], v[168:171]
    ds_read_b64_tr_b16 v[70:71], v17 offset:3584
    s_setprio 3
    v_permlane16_swap_b32 v193, v195
    v_add_f32 v184, v184, v186
    v_mfma_f32_16x16x32_bf16 v[172:175], v[52:55], v[228:231], v[172:175]
    ds_read_b64_tr_b16 v[52:53], v17 offset:7168
    v_mfma_f32_16x16x32_bf16 v[172:175], v[56:59], v[236:239], v[172:175]
    ds_read_b64_tr_b16 v[54:55], v17 offset:10752
    buffer_load_dwordx4 v[212:215], v16, s[36:39], s61 offen offset:2048 sc1
    s_waitcnt vmcnt(8)
    v_max3_u32 v12, v240, v241, v242
    v_max3_u32 v13, v243, v244, v245
    v_max3_u32 v12, v12, v246, v247
    v_max_u32 v12, v12, v13
    v_cmp_eq_u32 vcc, -1, v12
    s_cbranch_vccnz qa_kernel_F1_A16_R
qa_kernel_F1_A16_G:
    v_add_f32 v185, v185, v187
    v_add_f32 v192, v192, v194
    s_waitcnt lgkmcnt(4)
    v_mfma_f32_16x16x32_bf16 v[176:179], v[60:63], v[224:227], v[176:179]
    ds_read_b64_tr_b16 v[56:57], v17 offset:14336
    v_mfma_f32_16x16x32_bf16 v[176:179], v[64:67], v[232:235], v[176:179]
    ds_read_b64_tr_b16 v[58:59], v17 offset:17920
    s_waitcnt vmcnt(6)
    v_max3_u32 v12, v248, v249, v250
    v_max3_u32 v13, v251, v252, v253
    v_max3_u32 v12, v12, v254, v255
    v_max_u32 v12, v12, v13
    v_cmp_eq_u32 vcc, -1, v12
    s_cbranch_vccnz qa_kernel_F1_A17_R
qa_kernel_F1_A17_G:
    v_add_f32 v193, v193, v195
    v_mov_b32 v186, v184
    v_mfma_f32_16x16x32_bf16 v[180:183], v[60:63], v[228:231], v[180:183]
    ds_read_b64_tr_b16 v[60:61], v17 offset:21504
    v_mfma_f32_16x16x32_bf16 v[180:183], v[64:67], v[236:239], v[180:183]
    ds_read_b64_tr_b16 v[62:63], v17 offset:25088
    v_mov_b32 v187, v185
    v_mov_b32 v194, v192
    s_waitcnt lgkmcnt(4)
    v_mfma_f32_16x16x32_bf16 v[72:75], v[68:71], v[240:243], v[72:75]
    ds_read_b64_tr_b16 v[64:65], v17 offset:32
    v_mfma_f32_16x16x32_bf16 v[72:75], v[52:55], v[248:251], v[72:75]
    ds_read_b64_tr_b16 v[66:67], v17 offset:3616
    buffer_load_dwordx4 v[216:219], v15, s[36:39], s61 offen offset:3072 sc1
    v_mov_b32 v195, v193
    v_permlane32_swap_b32 v184, v186
    v_mfma_f32_16x16x32_bf16 v[76:79], v[68:71], v[244:247], v[76:79]
    ds_read_b64_tr_b16 v[68:69], v17 offset:7200
    v_mfma_f32_16x16x32_bf16 v[76:79], v[52:55], v[252:255], v[76:79]
    ds_read_b64_tr_b16 v[70:71], v17 offset:10784
    v_permlane32_swap_b32 v185, v187
    v_permlane32_swap_b32 v192, v194
    s_waitcnt lgkmcnt(4)
    v_mfma_f32_16x16x32_bf16 v[80:83], v[56:59], v[240:243], v[80:83]
    ds_read_b64_tr_b16 v[52:53], v17 offset:14368
    v_mfma_f32_16x16x32_bf16 v[80:83], v[60:63], v[248:251], v[80:83]
    ds_read_b64_tr_b16 v[54:55], v17 offset:17952
    v_permlane32_swap_b32 v193, v195
    v_add_f32 v184, v184, v186
    v_mfma_f32_16x16x32_bf16 v[84:87], v[56:59], v[244:247], v[84:87]
    ds_read_b64_tr_b16 v[56:57], v17 offset:21536
    v_mfma_f32_16x16x32_bf16 v[84:87], v[60:63], v[252:255], v[84:87]
    ds_read_b64_tr_b16 v[58:59], v17 offset:25120
    s_setprio 2
    buffer_load_dwordx4 v[220:223], v16, s[36:39], s61 offen offset:3072 sc1
    s_add_u32 s61, s61, 4096
    v_add_f32 v185, v185, v187
    v_add_f32 v192, v192, v194
    s_waitcnt lgkmcnt(4)
    v_mfma_f32_16x16x32_bf16 v[88:91], v[64:67], v[240:243], v[88:91]
    ds_read_b64_tr_b16 v[60:61], v17 offset:64
    v_mfma_f32_16x16x32_bf16 v[88:91], v[68:71], v[248:251], v[88:91]
    ds_read_b64_tr_b16 v[62:63], v17 offset:3648
    v_add_f32 v193, v193, v195
    v_mul_f32 v30, 0xba800000, v184
    v_mfma_f32_16x16x32_bf16 v[92:95], v[64:67], v[244:247], v[92:95]
    ds_read_b64_tr_b16 v[64:65], v17 offset:7232
    v_mfma_f32_16x16x32_bf16 v[92:95], v[68:71], v[252:255], v[92:95]
    ds_read_b64_tr_b16 v[66:67], v17 offset:10816
    v_mul_f32 v32, 0x3a800000, v185
    v_mul_f32 v31, 0xba800000, v192
    s_waitcnt lgkmcnt(4)
    v_mfma_f32_16x16x32_bf16 v[96:99], v[52:55], v[240:243], v[96:99]
    ds_read_b64_tr_b16 v[68:69], v17 offset:14400
    v_mfma_f32_16x16x32_bf16 v[96:99], v[56:59], v[248:251], v[96:99]
    ds_read_b64_tr_b16 v[70:71], v17 offset:17984
    s_add_u32 m0, s60, 65536
    s_nop 0
    buffer_load_dwordx4 v8, s[32:35], s59 offen lds
    v_mul_f32 v33, 0x3a800000, v193
    v_fma_f32 v32, -v30, v30, v32
    v_mfma_f32_16x16x32_bf16 v[100:103], v[52:55], v[244:247], v[100:103]
    ds_read_b64_tr_b16 v[52:53], v17 offset:21568
    v_mfma_f32_16x16x32_bf16 v[100:103], v[56:59], v[252:255], v[100:103]
    ds_read_b64_tr_b16 v[54:55], v17 offset:25152
    v_fma_f32 v33, -v31, v31, v33
    v_max_f32 v32, 0, v32
    s_waitcnt lgkmcnt(4)
    v_mfma_f32_16x16x32_bf16 v[104:107], v[60:63], v[240:243], v[104:107]
    ds_read_b64_tr_b16 v[56:57], v17 offset:96
    v_mfma_f32_16x16x32_bf16 v[104:107], v[64:67], v[248:251], v[104:107]
    ds_read_b64_tr_b16 v[58:59], v17 offset:3680
    v_max_f32 v33, 0, v33
    v_add_f32 v32, 0x3727c5ac, v32
    v_mfma_f32_16x16x32_bf16 v[108:111], v[60:63], v[244:247], v[108:111]
    ds_read_b64_tr_b16 v[60:61], v17 offset:7264
    v_mfma_f32_16x16x32_bf16 v[108:111], v[64:67], v[252:255], v[108:111]
    ds_read_b64_tr_b16 v[62:63], v17 offset:10848
    s_add_u32 m0, s60, 66560
    s_nop 0
    buffer_load_dwordx4 v9, s[32:35], s59 offen lds
    v_add_f32 v33, 0x3727c5ac, v33
    v_rsq_f32 v34, v32
    s_waitcnt lgkmcnt(4)
    v_mfma_f32_16x16x32_bf16 v[112:115], v[68:71], v[240:243], v[112:115]
    ds_read_b64_tr_b16 v[64:65], v17 offset:14432
    v_mfma_f32_16x16x32_bf16 v[112:115], v[52:55], v[248:251], v[112:115]
    ds_read_b64_tr_b16 v[66:67], v17 offset:18016
    s_setprio 1
    v_rsq_f32 v35, v33
    v_mul_f32 v34, 0xbfb8aa3b, v34
    v_mfma_f32_16x16x32_bf16 v[116:119], v[68:71], v[244:247], v[116:119]
    ds_read_b64_tr_b16 v[68:69], v17 offset:21600
    v_mfma_f32_16x16x32_bf16 v[116:119], v[52:55], v[252:255], v[116:119]
    ds_read_b64_tr_b16 v[70:71], v17 offset:25184
    v_mul_f32 v35, 0xbfb8aa3b, v35
    s_waitcnt lgkmcnt(4)
    v_mfma_f32_16x16x32_bf16 v[120:123], v[56:59], v[240:243], v[120:123]
    ds_read_b64_tr_b16 v[52:53], v17 offset:128
    v_mfma_f32_16x16x32_bf16 v[120:123], v[60:63], v[248:251], v[120:123]
    ds_read_b64_tr_b16 v[54:55], v17 offset:3712
    s_add_u32 m0, s60, 67584
    s_nop 0
    buffer_load_dwordx4 v10, s[32:35], s59 offen lds
    ds_read_b128 v[184:187], v19 offset:0
    v_mfma_f32_16x16x32_bf16 v[124:127], v[56:59], v[244:247], v[124:127]
    ds_read_b64_tr_b16 v[56:57], v17 offset:7296
    v_mfma_f32_16x16x32_bf16 v[124:127], v[60:63], v[252:255], v[124:127]
    ds_read_b64_tr_b16 v[58:59], v17 offset:10880
    s_waitcnt lgkmcnt(5)
    v_mfma_f32_16x16x32_bf16 v[128:131], v[64:67], v[240:243], v[128:131]
    ds_read_b64_tr_b16 v[60:61], v17 offset:14464
    v_mfma_f32_16x16x32_bf16 v[128:131], v[68:71], v[248:251], v[128:131]
    ds_read_b64_tr_b16 v[62:63], v17 offset:18048
    v_mfma_f32_16x16x32_bf16 v[132:135], v[64:67], v[244:247], v[132:135]
    ds_read_b64_tr_b16 v[64:65], v17 offset:21632
    v_mfma_f32_16x16x32_bf16 v[132:135], v[68:71], v[252:255], v[132:135]
    ds_read_b64_tr_b16 v[66:67], v17 offset:25216
    s_add_u32 m0, s60, 68608
    s_mov_b32 exec_hi, 0
    buffer_load_dwordx4 v11, s[32:35], s59 offen lds
    s_mov_b32 exec_hi, -1
    s_add_u32 s59, s59, 458752
    s_waitcnt lgkmcnt(4)
    v_mfma_f32_16x16x32_bf16 v[136:139], v[52:55], v[240:243], v[136:139]
    ds_read_b64_tr_b16 v[68:69], v17 offset:160
    v_mfma_f32_16x16x32_bf16 v[136:139], v[56:59], v[248:251], v[136:139]
    ds_read_b64_tr_b16 v[70:71], v17 offset:3744
    v_fmac_f32 v72, v30, v184
    v_fmac_f32 v73, v30, v185
    ds_read_b128 v[188:191], v19 offset:448
    v_mfma_f32_16x16x32_bf16 v[140:143], v[52:55], v[244:247], v[140:143]
    ds_read_b64_tr_b16 v[52:53], v17 offset:7328
    v_mfma_f32_16x16x32_bf16 v[140:143], v[56:59], v[252:255], v[140:143]
    ds_read_b64_tr_b16 v[54:55], v17 offset:10912
    s_setprio 0
    v_fmac_f32 v74, v30, v186
    v_fmac_f32 v75, v30, v187
    s_waitcnt lgkmcnt(5)
    v_mfma_f32_16x16x32_bf16 v[144:147], v[60:63], v[240:243], v[144:147]
    ds_read_b64_tr_b16 v[56:57], v17 offset:14496
    v_mfma_f32_16x16x32_bf16 v[144:147], v[64:67], v[248:251], v[144:147]
    ds_read_b64_tr_b16 v[58:59], v17 offset:18080
    buffer_load_dwordx4 v[224:227], v15, s[36:39], s61 offen offset:0 sc1
    v_fmac_f32 v76, v31, v184
    v_fmac_f32 v77, v31, v185
    v_mfma_f32_16x16x32_bf16 v[148:151], v[60:63], v[244:247], v[148:151]
    ds_read_b64_tr_b16 v[60:61], v17 offset:21664
    v_mfma_f32_16x16x32_bf16 v[148:151], v[64:67], v[252:255], v[148:151]
    ds_read_b64_tr_b16 v[62:63], v17 offset:25248
    v_fmac_f32 v78, v31, v186
    v_fmac_f32 v79, v31, v187
    s_waitcnt lgkmcnt(4)
    v_mfma_f32_16x16x32_bf16 v[152:155], v[68:71], v[240:243], v[152:155]
    ds_read_b64_tr_b16 v[64:65], v18 offset:0
    v_mfma_f32_16x16x32_bf16 v[152:155], v[52:55], v[248:251], v[152:155]
    ds_read_b64_tr_b16 v[66:67], v18 offset:3584
    v_fmac_f32 v80, v30, v188
    v_fmac_f32 v81, v30, v189
    ds_read_b128 v[192:195], v19 offset:64
    v_mfma_f32_16x16x32_bf16 v[156:159], v[68:71], v[244:247], v[156:159]
    ds_read_b64_tr_b16 v[68:69], v18 offset:7168
    v_mfma_f32_16x16x32_bf16 v[156:159], v[52:55], v[252:255], v[156:159]
    ds_read_b64_tr_b16 v[70:71], v18 offset:10752
    buffer_load_dwordx4 v[228:231], v16, s[36:39], s61 offen offset:0 sc1
    v_fmac_f32 v82, v30, v190
    v_fmac_f32 v83, v30, v191
    s_waitcnt lgkmcnt(5)
    v_mfma_f32_16x16x32_bf16 v[160:163], v[56:59], v[240:243], v[160:163]
    ds_read_b64_tr_b16 v[52:53], v18 offset:14336
    v_mfma_f32_16x16x32_bf16 v[160:163], v[60:63], v[248:251], v[160:163]
    ds_read_b64_tr_b16 v[54:55], v18 offset:17920
    v_fmac_f32 v84, v31, v188
    v_fmac_f32 v85, v31, v189
    v_mfma_f32_16x16x32_bf16 v[164:167], v[56:59], v[244:247], v[164:167]
    ds_read_b64_tr_b16 v[56:57], v18 offset:21504
    v_mfma_f32_16x16x32_bf16 v[164:167], v[60:63], v[252:255], v[164:167]
    ds_read_b64_tr_b16 v[58:59], v18 offset:25088
    v_fmac_f32 v86, v31, v190
    v_fmac_f32 v87, v31, v191
    s_waitcnt lgkmcnt(4)
    v_mfma_f32_16x16x32_bf16 v[168:171], v[64:67], v[240:243], v[168:171]
    s_waitcnt vmcnt(10)
    s_barrier
    ds_read_b64_tr_b16 v[60:61], v17 offset:28672
    v_mfma_f32_16x16x32_bf16 v[168:171], v[68:71], v[248:251], v[168:171]
    ds_read_b64_tr_b16 v[62:63], v17 offset:32256
    s_setprio 3
    v_fmac_f32 v88, v30, v192
    v_fmac_f32 v89, v30, v193
    v_mfma_f32_16x16x32_bf16 v[172:175], v[64:67], v[244:247], v[172:175]
    ds_read_b64_tr_b16 v[64:65], v17 offset:35840
    v_mfma_f32_16x16x32_bf16 v[172:175], v[68:71], v[252:255], v[172:175]
    ds_read_b64_tr_b16 v[66:67], v17 offset:39424
    buffer_load_dwordx4 v[232:235], v15, s[36:39], s61 offen offset:1024 sc1
    s_waitcnt vmcnt(9)
    v_max3_u32 v12, v208, v209, v210
    v_max3_u32 v13, v211, v212, v213
    v_max3_u32 v12, v12, v214, v215
    v_max_u32 v12, v12, v13
    v_cmp_eq_u32 vcc, -1, v12
    s_cbranch_vccnz qa_kernel_F1_A18_R
qa_kernel_F1_A18_G:
    v_fmac_f32 v90, v30, v194
    v_fmac_f32 v91, v30, v195
    s_waitcnt lgkmcnt(4)
    v_mfma_f32_16x16x32_bf16 v[176:179], v[52:55], v[240:243], v[176:179]
    ds_read_b64_tr_b16 v[68:69], v17 offset:43008
    v_mfma_f32_16x16x32_bf16 v[176:179], v[56:59], v[248:251], v[176:179]
    ds_read_b64_tr_b16 v[70:71], v17 offset:46592
    s_waitcnt vmcnt(7)
    v_max3_u32 v12, v216, v217, v218
    v_max3_u32 v13, v219, v220, v221
    v_max3_u32 v12, v12, v222, v223
    v_max_u32 v12, v12, v13
    v_cmp_eq_u32 vcc, -1, v12
    s_cbranch_vccnz qa_kernel_F1_A19_R
qa_kernel_F1_A19_G:
    v_fmac_f32 v92, v31, v192
    v_fmac_f32 v93, v31, v193
    v_mfma_f32_16x16x32_bf16 v[180:183], v[52:55], v[244:247], v[180:183]
    ds_read_b64_tr_b16 v[52:53], v17 offset:50176
    v_mfma_f32_16x16x32_bf16 v[180:183], v[56:59], v[252:255], v[180:183]
    ds_read_b64_tr_b16 v[54:55], v17 offset:53760
    v_fmac_f32 v94, v31, v194
    v_fmac_f32 v95, v31, v195
    s_waitcnt lgkmcnt(4)
    v_mfma_f32_16x16x32_bf16 v[72:75], v[60:63], v[208:211], v[72:75]
    ds_read_b64_tr_b16 v[56:57], v17 offset:28704
    v_mfma_f32_16x16x32_bf16 v[72:75], v[64:67], v[216:219], v[72:75]
    ds_read_b64_tr_b16 v[58:59], v17 offset:32288
    buffer_load_dwordx4 v[236:239], v16, s[36:39], s61 offen offset:1024 sc1
    v_mfma_f32_16x16x32_bf16 v[76:79], v[60:63], v[212:215], v[76:79]
    ds_read_b64_tr_b16 v[60:61], v17 offset:35872
    v_mfma_f32_16x16x32_bf16 v[76:79], v[64:67], v[220:223], v[76:79]
    ds_read_b64_tr_b16 v[62:63], v17 offset:39456
    s_waitcnt lgkmcnt(4)
    v_mfma_f32_16x16x32_bf16 v[80:83], v[68:71], v[208:211], v[80:83]
    ds_read_b64_tr_b16 v[64:65], v17 offset:43040
    v_mfma_f32_16x16x32_bf16 v[80:83], v[52:55], v[216:219], v[80:83]
    ds_read_b64_tr_b16 v[66:67], v17 offset:46624
    v_mfma_f32_16x16x32_bf16 v[84:87], v[68:71], v[212:215], v[84:87]
    ds_read_b64_tr_b16 v[68:69], v17 offset:50208
    v_mfma_f32_16x16x32_bf16 v[84:87], v[52:55], v[220:223], v[84:87]
    ds_read_b64_tr_b16 v[70:71], v17 offset:53792
    s_setprio 2
    s_add_u32 m0, s60, 94208
    s_nop 0
    buffer_load_dwordx4 v8, s[32:35], s59 offen lds
    s_waitcnt lgkmcnt(4)
    v_mfma_f32_16x16x32_bf16 v[88:91], v[56:59], v[208:211], v[88:91]
    ds_read_b64_tr_b16 v[52:53], v17 offset:28736
    v_mfma_f32_16x16x32_bf16 v[88:91], v[60:63], v[216:219], v[88:91]
    ds_read_b64_tr_b16 v[54:55], v17 offset:32320
    v_mfma_f32_16x16x32_bf16 v[92:95], v[56:59], v[212:215], v[92:95]
    ds_read_b64_tr_b16 v[56:57], v17 offset:35904
    v_mfma_f32_16x16x32_bf16 v[92:95], v[60:63], v[220:223], v[92:95]
    ds_read_b64_tr_b16 v[58:59], v17 offset:39488
    s_waitcnt lgkmcnt(4)
    v_mfma_f32_16x16x32_bf16 v[96:99], v[64:67], v[208:211], v[96:99]
    ds_read_b64_tr_b16 v[60:61], v17 offset:43072
    v_mfma_f32_16x16x32_bf16 v[96:99], v[68:71], v[216:219], v[96:99]
    ds_read_b64_tr_b16 v[62:63], v17 offset:46656
    s_add_u32 m0, s60, 95232
    s_nop 0
    buffer_load_dwordx4 v9, s[32:35], s59 offen lds
    v_mfma_f32_16x16x32_bf16 v[100:103], v[64:67], v[212:215], v[100:103]
    ds_read_b64_tr_b16 v[64:65], v17 offset:50240
    v_mfma_f32_16x16x32_bf16 v[100:103], v[68:71], v[220:223], v[100:103]
    ds_read_b64_tr_b16 v[66:67], v17 offset:53824
    s_waitcnt lgkmcnt(4)
    v_mfma_f32_16x16x32_bf16 v[104:107], v[52:55], v[208:211], v[104:107]
    ds_read_b64_tr_b16 v[68:69], v17 offset:28768
    v_mfma_f32_16x16x32_bf16 v[104:107], v[56:59], v[216:219], v[104:107]
    ds_read_b64_tr_b16 v[70:71], v17 offset:32352
    ds_read_b128 v[196:199], v19 offset:512
    v_mfma_f32_16x16x32_bf16 v[108:111], v[52:55], v[212:215], v[108:111]
    ds_read_b64_tr_b16 v[52:53], v17 offset:35936
    v_mfma_f32_16x16x32_bf16 v[108:111], v[56:59], v[220:223], v[108:111]
    ds_read_b64_tr_b16 v[54:55], v17 offset:39520
    s_add_u32 m0, s60, 96256
    s_nop 0
    buffer_load_dwordx4 v10, s[32:35], s59 offen lds
    s_waitcnt lgkmcnt(5)
    v_mfma_f32_16x16x32_bf16 v[112:115], v[60:63], v[208:211], v[112:115]
    ds_read_b64_tr_b16 v[56:57], v17 offset:43104
    v_mfma_f32_16x16x32_bf16 v[112:115], v[64:67], v[216:219], v[112:115]
    ds_read_b64_tr_b16 v[58:59], v17 offset:46688
    s_setprio 1
    v_mfma_f32_16x16x32_bf16 v[116:119], v[60:63], v[212:215], v[116:119]
    ds_read_b64_tr_b16 v[60:61], v17 offset:50272
    v_mfma_f32_16x16x32_bf16 v[116:119], v[64:67], v[220:223], v[116:119]
    ds_read_b64_tr_b16 v[62:63], v17 offset:53856
    s_waitcnt lgkmcnt(4)
    v_mfma_f32_16x16x32_bf16 v[120:123], v[68:71], v[208:211], v[120:123]
    ds_read_b64_tr_b16 v[64:65], v17 offset:28800
    v_mfma_f32_16x16x32_bf16 v[120:123], v[52:55], v[216:219], v[120:123]
    ds_read_b64_tr_b16 v[66:67], v17 offset:32384
    s_add_u32 m0, s60, 97280
    s_mov_b32 exec_hi, 0
    buffer_load_dwordx4 v11, s[32:35], s59 offen lds
    s_mov_b32 exec_hi, -1
    s_add_u32 s59, s59, 458752
    v_fmac_f32 v96, v30, v196
    v_fmac_f32 v97, v30, v197
    ds_read_b128 v[184:187], v19 offset:128
    v_mfma_f32_16x16x32_bf16 v[124:127], v[68:71], v[212:215], v[124:127]
    ds_read_b64_tr_b16 v[68:69], v17 offset:35968
    v_mfma_f32_16x16x32_bf16 v[124:127], v[52:55], v[220:223], v[124:127]
    ds_read_b64_tr_b16 v[70:71], v17 offset:39552
    v_fmac_f32 v98, v30, v198
    v_fmac_f32 v99, v30, v199
    s_waitcnt lgkmcnt(5)
    v_mfma_f32_16x16x32_bf16 v[128:131], v[56:59], v[208:211], v[128:131]
    ds_read_b64_tr_b16 v[52:53], v17 offset:43136
    v_mfma_f32_16x16x32_bf16 v[128:131], v[60:63], v[216:219], v[128:131]
    ds_read_b64_tr_b16 v[54:55], v17 offset:46720
    v_fmac_f32 v100, v31, v196
    v_fmac_f32 v101, v31, v197
    v_mfma_f32_16x16x32_bf16 v[132:135], v[56:59], v[212:215], v[132:135]
    ds_read_b64_tr_b16 v[56:57], v17 offset:50304
    v_mfma_f32_16x16x32_bf16 v[132:135], v[60:63], v[220:223], v[132:135]
    ds_read_b64_tr_b16 v[58:59], v17 offset:53888
    buffer_load_dwordx4 v[240:243], v15, s[36:39], s61 offen offset:2048 sc1
    v_fmac_f32 v102, v31, v198
    v_fmac_f32 v103, v31, v199
    s_waitcnt lgkmcnt(4)
    v_mfma_f32_16x16x32_bf16 v[136:139], v[64:67], v[208:211], v[136:139]
    ds_read_b64_tr_b16 v[60:61], v17 offset:28832
    v_mfma_f32_16x16x32_bf16 v[136:139], v[68:71], v[216:219], v[136:139]
    ds_read_b64_tr_b16 v[62:63], v17 offset:32416
    v_fmac_f32 v104, v30, v184
    v_fmac_f32 v105, v30, v185
    ds_read_b128 v[188:191], v19 offset:576
    v_mfma_f32_16x16x32_bf16 v[140:143], v[64:67], v[212:215], v[140:143]
    ds_read_b64_tr_b16 v[64:65], v17 offset:36000
    v_mfma_f32_16x16x32_bf16 v[140:143], v[68:71], v[220:223], v[140:143]
    ds_read_b64_tr_b16 v[66:67], v17 offset:39584
    s_setprio 0
    v_fmac_f32 v106, v30, v186
    v_fmac_f32 v107, v30, v187
    s_waitcnt lgkmcnt(5)
    v_mfma_f32_16x16x32_bf16 v[144:147], v[52:55], v[208:211], v[144:147]
    ds_read_b64_tr_b16 v[68:69], v17 offset:43168
    v_mfma_f32_16x16x32_bf16 v[144:147], v[56:59], v[216:219], v[144:147]
    ds_read_b64_tr_b16 v[70:71], v17 offset:46752
    buffer_load_dwordx4 v[244:247], v16, s[36:39], s61 offen offset:2048 sc1
    v_fmac_f32 v108, v31, v184
    v_fmac_f32 v109, v31, v185
    v_mfma_f32_16x16x32_bf16 v[148:151], v[52:55], v[212:215], v[148:151]
    ds_read_b64_tr_b16 v[52:53], v17 offset:50336
    v_mfma_f32_16x16x32_bf16 v[148:151], v[56:59], v[220:223], v[148:151]
    ds_read_b64_tr_b16 v[54:55], v17 offset:53920
    v_fmac_f32 v110, v31, v186
    v_fmac_f32 v111, v31, v187
    s_waitcnt lgkmcnt(4)
    v_mfma_f32_16x16x32_bf16 v[152:155], v[60:63], v[208:211], v[152:155]
    ds_read_b64_tr_b16 v[56:57], v18 offset:28672
    v_mfma_f32_16x16x32_bf16 v[152:155], v[64:67], v[216:219], v[152:155]
    ds_read_b64_tr_b16 v[58:59], v18 offset:32256
    v_fmac_f32 v112, v30, v188
    v_fmac_f32 v113, v30, v189
    ds_read_b128 v[192:195], v19 offset:192
    v_mfma_f32_16x16x32_bf16 v[156:159], v[60:63], v[212:215], v[156:159]
    ds_read_b64_tr_b16 v[60:61], v18 offset:35840
    v_mfma_f32_16x16x32_bf16 v[156:159], v[64:67], v[220:223], v[156:159]
    ds_read_b64_tr_b16 v[62:63], v18 offset:39424
    buffer_load_dwordx4 v[248:251], v15, s[36:39], s61 offen offset:3072 sc1
    v_fmac_f32 v114, v30, v190
    v_fmac_f32 v115, v30, v191
    s_waitcnt lgkmcnt(5)
    v_mfma_f32_16x16x32_bf16 v[160:163], v[68:71], v[208:211], v[160:163]
    ds_read_b64_tr_b16 v[64:65], v18 offset:43008
    v_mfma_f32_16x16x32_bf16 v[160:163], v[52:55], v[216:219], v[160:163]
    ds_read_b64_tr_b16 v[66:67], v18 offset:46592
    v_fmac_f32 v116, v31, v188
    v_fmac_f32 v117, v31, v189
    v_mfma_f32_16x16x32_bf16 v[164:167], v[68:71], v[212:215], v[164:167]
    ds_read_b64_tr_b16 v[68:69], v18 offset:50176
    v_mfma_f32_16x16x32_bf16 v[164:167], v[52:55], v[220:223], v[164:167]
    ds_read_b64_tr_b16 v[70:71], v18 offset:53760
    v_fmac_f32 v118, v31, v190
    v_fmac_f32 v119, v31, v191
    s_waitcnt lgkmcnt(4)
    v_mfma_f32_16x16x32_bf16 v[168:171], v[56:59], v[208:211], v[168:171]
    s_waitcnt vmcnt(11)
    s_barrier
    ds_read_b64_tr_b16 v[52:53], v21 offset:0
    v_mfma_f32_16x16x32_bf16 v[168:171], v[60:63], v[216:219], v[168:171]
    ds_read_b64_tr_b16 v[54:55], v21 offset:3584
    s_setprio 3
    v_fmac_f32 v120, v30, v192
    v_fmac_f32 v121, v30, v193
    ds_read_b128 v[196:199], v19 offset:640
    v_mfma_f32_16x16x32_bf16 v[172:175], v[56:59], v[212:215], v[172:175]
    ds_read_b64_tr_b16 v[56:57], v21 offset:7168
    v_mfma_f32_16x16x32_bf16 v[172:175], v[60:63], v[220:223], v[172:175]
    ds_read_b64_tr_b16 v[58:59], v21 offset:10752
    buffer_load_dwordx4 v[252:255], v16, s[36:39], s61 offen offset:3072 sc1
    s_add_u32 s61, s61, 4096
    s_waitcnt vmcnt(10)
    v_max3_u32 v12, v224, v225, v226
    v_max3_u32 v13, v227, v228, v229
    v_max3_u32 v12, v12, v230, v231
    v_max_u32 v12, v12, v13
    v_cmp_eq_u32 vcc, -1, v12
    s_cbranch_vccnz qa_kernel_F1_A20_R
qa_kernel_F1_A20_G:
    v_fmac_f32 v122, v30, v194
    v_fmac_f32 v123, v30, v195
    s_waitcnt lgkmcnt(5)
    v_mfma_f32_16x16x32_bf16 v[176:179], v[64:67], v[208:211], v[176:179]
    ds_read_b64_tr_b16 v[60:61], v21 offset:14336
    v_mfma_f32_16x16x32_bf16 v[176:179], v[68:71], v[216:219], v[176:179]
    ds_read_b64_tr_b16 v[62:63], v21 offset:17920
    s_waitcnt vmcnt(8)
    v_max3_u32 v12, v232, v233, v234
    v_max3_u32 v13, v235, v236, v237
    v_max3_u32 v12, v12, v238, v239
    v_max_u32 v12, v12, v13
    v_cmp_eq_u32 vcc, -1, v12
    s_cbranch_vccnz qa_kernel_F1_A21_R
qa_kernel_F1_A21_G:
    v_fmac_f32 v124, v31, v192
    v_fmac_f32 v125, v31, v193
    v_mfma_f32_16x16x32_bf16 v[180:183], v[64:67], v[212:215], v[180:183]
    ds_read_b64_tr_b16 v[64:65], v21 offset:21504
    v_mfma_f32_16x16x32_bf16 v[180:183], v[68:71], v[220:223], v[180:183]
    ds_read_b64_tr_b16 v[66:67], v21 offset:25088
    v_fmac_f32 v126, v31, v194
    v_fmac_f32 v127, v31, v195
    s_waitcnt lgkmcnt(4)
    v_mfma_f32_16x16x32_bf16 v[72:75], v[52:55], v[224:227], v[72:75]
    ds_read_b64_tr_b16 v[68:69], v21 offset:32
    v_mfma_f32_16x16x32_bf16 v[72:75], v[56:59], v[232:235], v[72:75]
    ds_read_b64_tr_b16 v[70:71], v21 offset:3616
    s_add_u32 m0, s60, 122880
    s_nop 0
    buffer_load_dwordx4 v8, s[32:35], s59 offen lds
    v_fmac_f32 v128, v30, v196
    v_fmac_f32 v129, v30, v197
    ds_read_b128 v[184:187], v19 offset:256
    v_mfma_f32_16x16x32_bf16 v[76:79], v[52:55], v[228:231], v[76:79]
    ds_read_b64_tr_b16 v[52:53], v21 offset:7200
    v_mfma_f32_16x16x32_bf16 v[76:79], v[56:59], v[236:239], v[76:79]
    ds_read_b64_tr_b16 v[54:55], v21 offset:10784
    v_fmac_f32 v130, v30, v198
    v_fmac_f32 v131, v30, v199
    s_waitcnt lgkmcnt(5)
    v_mfma_f32_16x16x32_bf16 v[80:83], v[60:63], v[224:227], v[80:83]
    ds_read_b64_tr_b16 v[56:57], v21 offset:14368
    v_mfma_f32_16x16x32_bf16 v[80:83], v[64:67], v[232:235], v[80:83]
qa_kernel_WS1_9:
    s_cbranch_execz qa_kernel_WRET1
    ds_read_b64_tr_b16 v[58:59], v21 offset:17952
    v_fmac_f32 v132, v31, v196
    v_fmac_f32 v133, v31, v197
    v_mfma_f32_16x16x32_bf16 v[84:87], v[60:63], v[228:231], v[84:87]
    ds_read_b64_tr_b16 v[60:61], v21 offset:21536
    v_mfma_f32_16x16x32_bf16 v[84:87], v[64:67], v[236:239], v[84:87]
    ds_read_b64_tr_b16 v[62:63], v21 offset:25120
    s_setprio 2
    s_add_u32 m0, s60, 123904
    s_nop 0
    buffer_load_dwordx4 v9, s[32:35], s59 offen lds
    v_fmac_f32 v134, v31, v198
    v_fmac_f32 v135, v31, v199
    s_waitcnt lgkmcnt(4)
    v_mfma_f32_16x16x32_bf16 v[88:91], v[68:71], v[224:227], v[88:91]
    ds_read_b64_tr_b16 v[64:65], v21 offset:64
    v_mfma_f32_16x16x32_bf16 v[88:91], v[52:55], v[232:235], v[88:91]
    ds_read_b64_tr_b16 v[66:67], v21 offset:3648
    v_fmac_f32 v136, v30, v184
    v_fmac_f32 v137, v30, v185
    ds_read_b128 v[188:191], v19 offset:704
    v_mfma_f32_16x16x32_bf16 v[92:95], v[68:71], v[228:231], v[92:95]
    ds_read_b64_tr_b16 v[68:69], v21 offset:7232
    v_mfma_f32_16x16x32_bf16 v[92:95], v[52:55], v[236:239], v[92:95]
    ds_read_b64_tr_b16 v[70:71], v21 offset:10816
    v_fmac_f32 v138, v30, v186
    v_fmac_f32 v139, v30, v187
    s_waitcnt lgkmcnt(5)
    v_mfma_f32_16x16x32_bf16 v[96:99], v[56:59], v[224:227], v[96:99]
    ds_read_b64_tr_b16 v[52:53], v21 offset:14400
    v_mfma_f32_16x16x32_bf16 v[96:99], v[60:63], v[232:235], v[96:99]
    ds_read_b64_tr_b16 v[54:55], v21 offset:17984
    s_add_u32 m0, s60, 124928
    s_nop 0
    buffer_load_dwordx4 v10, s[32:35], s59 offen lds
    v_fmac_f32 v140, v31, v184
    v_fmac_f32 v141, v31, v185
    v_mfma_f32_16x16x32_bf16 v[100:103], v[56:59], v[228:231], v[100:103]
    ds_read_b64_tr_b16 v[56:57], v21 offset:21568
    v_mfma_f32_16x16x32_bf16 v[100:103], v[60:63], v[236:239], v[100:103]
    ds_read_b64_tr_b16 v[58:59], v21 offset:25152
    v_fmac_f32 v142, v31, v186
    v_fmac_f32 v143, v31, v187
    s_waitcnt lgkmcnt(4)
    v_mfma_f32_16x16x32_bf16 v[104:107], v[64:67], v[224:227], v[104:107]
    ds_read_b64_tr_b16 v[60:61], v21 offset:96
    v_mfma_f32_16x16x32_bf16 v[104:107], v[68:71], v[232:235], v[104:107]
    ds_read_b64_tr_b16 v[62:63], v21 offset:3680
    v_fmac_f32 v144, v30, v188
    v_fmac_f32 v145, v30, v189
    ds_read_b128 v[192:195], v19 offset:320
    v_mfma_f32_16x16x32_bf16 v[108:111], v[64:67], v[228:231], v[108:111]
    ds_read_b64_tr_b16 v[64:65], v21 offset:7264
    v_mfma_f32_16x16x32_bf16 v[108:111], v[68:71], v[236:239], v[108:111]
    ds_read_b64_tr_b16 v[66:67], v21 offset:10848
    s_add_u32 m0, s60, 125952
    s_mov_b32 exec_hi, 0
    buffer_load_dwordx4 v11, s[32:35], s59 offen lds
    s_mov_b32 exec_hi, -1
    s_add_u32 s59, s59, 458752
    v_fmac_f32 v146, v30, v190
    v_fmac_f32 v147, v30, v191
    s_waitcnt lgkmcnt(5)
    v_mfma_f32_16x16x32_bf16 v[112:115], v[52:55], v[224:227], v[112:115]
    ds_read_b64_tr_b16 v[68:69], v21 offset:14432
    v_mfma_f32_16x16x32_bf16 v[112:115], v[56:59], v[232:235], v[112:115]
    ds_read_b64_tr_b16 v[70:71], v21 offset:18016
    s_setprio 1
    v_fmac_f32 v148, v31, v188
    v_fmac_f32 v149, v31, v189
    v_mfma_f32_16x16x32_bf16 v[116:119], v[52:55], v[228:231], v[116:119]
    ds_read_b64_tr_b16 v[52:53], v21 offset:21600
    v_mfma_f32_16x16x32_bf16 v[116:119], v[56:59], v[236:239], v[116:119]
    ds_read_b64_tr_b16 v[54:55], v21 offset:25184
    v_fmac_f32 v150, v31, v190
    v_fmac_f32 v151, v31, v191
    s_waitcnt lgkmcnt(4)
    v_mfma_f32_16x16x32_bf16 v[120:123], v[60:63], v[224:227], v[120:123]
    ds_read_b64_tr_b16 v[56:57], v21 offset:128
    v_mfma_f32_16x16x32_bf16 v[120:123], v[64:67], v[232:235], v[120:123]
    ds_read_b64_tr_b16 v[58:59], v21 offset:3712
    buffer_load_dwordx4 v[208:211], v15, s[36:39], s61 offen offset:0 sc1
    v_fmac_f32 v152, v30, v192
    v_fmac_f32 v153, v30, v193
    v_mfma_f32_16x16x32_bf16 v[124:127], v[60:63], v[228:231], v[124:127]
    ds_read_b64_tr_b16 v[60:61], v21 offset:7296
    v_mfma_f32_16x16x32_bf16 v[124:127], v[64:67], v[236:239], v[124:127]
    ds_read_b64_tr_b16 v[62:63], v21 offset:10880
    v_fmac_f32 v154, v30, v194
    v_fmac_f32 v155, v30, v195
    s_waitcnt lgkmcnt(4)
    v_mfma_f32_16x16x32_bf16 v[128:131], v[68:71], v[224:227], v[128:131]
    ds_read_b64_tr_b16 v[64:65], v21 offset:14464
    v_mfma_f32_16x16x32_bf16 v[128:131], v[52:55], v[232:235], v[128:131]
    ds_read_b64_tr_b16 v[66:67], v21 offset:18048
    v_fmac_f32 v156, v31, v192
    v_fmac_f32 v157, v31, v193
    v_mfma_f32_16x16x32_bf16 v[132:135], v[68:71], v[228:231], v[132:135]
    ds_read_b64_tr_b16 v[68:69], v21 offset:21632
    v_mfma_f32_16x16x32_bf16 v[132:135], v[52:55], v[236:239], v[132:135]
    ds_read_b64_tr_b16 v[70:71], v21 offset:25216
    buffer_load_dwordx4 v[212:215], v16, s[36:39], s61 offen offset:0 sc1
    v_fmac_f32 v158, v31, v194
    v_fmac_f32 v159, v31, v195
    s_waitcnt lgkmcnt(4)
    v_mfma_f32_16x16x32_bf16 v[136:139], v[56:59], v[224:227], v[136:139]
    ds_read_b64_tr_b16 v[52:53], v21 offset:160
    v_mfma_f32_16x16x32_bf16 v[136:139], v[60:63], v[232:235], v[136:139]
    ds_read_b64_tr_b16 v[54:55], v21 offset:3744
    v_mfma_f32_16x16x32_bf16 v[140:143], v[56:59], v[228:231], v[140:143]
    ds_read_b64_tr_b16 v[56:57], v21 offset:7328
    v_mfma_f32_16x16x32_bf16 v[140:143], v[60:63], v[236:239], v[140:143]
    ds_read_b64_tr_b16 v[58:59], v21 offset:10912
    s_setprio 0
    s_waitcnt lgkmcnt(4)
    v_mfma_f32_16x16x32_bf16 v[144:147], v[64:67], v[224:227], v[144:147]
    ds_read_b64_tr_b16 v[60:61], v21 offset:14496
    v_mfma_f32_16x16x32_bf16 v[144:147], v[68:71], v[232:235], v[144:147]
    ds_read_b64_tr_b16 v[62:63], v21 offset:18080
    buffer_load_dwordx4 v[216:219], v15, s[36:39], s61 offen offset:1024 sc1
    v_mfma_f32_16x16x32_bf16 v[148:151], v[64:67], v[228:231], v[148:151]
    ds_read_b64_tr_b16 v[64:65], v21 offset:21664
    v_mfma_f32_16x16x32_bf16 v[148:151], v[68:71], v[236:239], v[148:151]
    ds_read_b64_tr_b16 v[66:67], v21 offset:25248
    s_waitcnt lgkmcnt(4)
    v_mfma_f32_16x16x32_bf16 v[152:155], v[52:55], v[224:227], v[152:155]
    ds_read_b64_tr_b16 v[68:69], v23 offset:0
    v_mfma_f32_16x16x32_bf16 v[152:155], v[56:59], v[232:235], v[152:155]
    ds_read_b64_tr_b16 v[70:71], v23 offset:3584
    v_mfma_f32_16x16x32_bf16 v[156:159], v[52:55], v[228:231], v[156:159]
    ds_read_b64_tr_b16 v[52:53], v23 offset:7168
    v_mfma_f32_16x16x32_bf16 v[156:159], v[56:59], v[236:239], v[156:159]
    ds_read_b64_tr_b16 v[54:55], v23 offset:10752
    buffer_load_dwordx4 v[220:223], v16, s[36:39], s61 offen offset:1024 sc1
    s_waitcnt lgkmcnt(4)
    v_mfma_f32_16x16x32_bf16 v[160:163], v[60:63], v[224:227], v[160:163]
    ds_read_b64_tr_b16 v[56:57], v23 offset:14336
    v_mfma_f32_16x16x32_bf16 v[160:163], v[64:67], v[232:235], v[160:163]
    ds_read_b64_tr_b16 v[58:59], v23 offset:17920
    v_mfma_f32_16x16x32_bf16 v[164:167], v[60:63], v[228:231], v[164:167]
    ds_read_b64_tr_b16 v[60:61], v23 offset:21504
    v_mfma_f32_16x16x32_bf16 v[164:167], v[64:67], v[236:239], v[164:167]
    ds_read_b64_tr_b16 v[62:63], v23 offset:25088
    s_waitcnt lgkmcnt(4)
    v_mfma_f32_16x16x32_bf16 v[168:171], v[68:71], v[224:227], v[168:171]
    s_waitcnt vmcnt(12)
    s_barrier
    ds_read_b64_tr_b16 v[64:65], v21 offset:28672
    v_mfma_f32_16x16x32_bf16 v[168:171], v[52:55], v[232:235], v[168:171]
    ds_read_b64_tr_b16 v[66:67], v21 offset:32256
    s_setprio 3
    ds_read_b128 v[196:199], v19 offset:768
    v_mfma_f32_16x16x32_bf16 v[172:175], v[68:71], v[228:231], v[172:175]
    ds_read_b64_tr_b16 v[68:69], v21 offset:35840
    v_mfma_f32_16x16x32_bf16 v[172:175], v[52:55], v[236:239], v[172:175]
    ds_read_b64_tr_b16 v[70:71], v21 offset:39424
    s_add_u32 m0, s60, 0
    s_nop 0
    buffer_load_dwordx4 v8, s[32:35], s59 offen lds
    s_waitcnt vmcnt(11)
    v_max3_u32 v12, v240, v241, v242
    v_max3_u32 v13, v243, v244, v245
    v_max3_u32 v12, v12, v246, v247
    v_max_u32 v12, v12, v13
    v_cmp_eq_u32 vcc, -1, v12
    s_cbranch_vccnz qa_kernel_F1_A22_R
qa_kernel_F1_A22_G:
    s_waitcnt lgkmcnt(5)
    v_mfma_f32_16x16x32_bf16 v[176:179], v[56:59], v[224:227], v[176:179]
    ds_read_b64_tr_b16 v[52:53], v21 offset:43008
    v_mfma_f32_16x16x32_bf16 v[176:179], v[60:63], v[232:235], v[176:179]
    ds_read_b64_tr_b16 v[54:55], v21 offset:46592
    s_waitcnt vmcnt(9)
    v_max3_u32 v12, v248, v249, v250
    v_max3_u32 v13, v251, v252, v253
    v_max3_u32 v12, v12, v254, v255
    v_max_u32 v12, v12, v13
    v_cmp_eq_u32 vcc, -1, v12
    s_cbranch_vccnz qa_kernel_F1_A23_R
qa_kernel_F1_A23_G:
    v_mfma_f32_16x16x32_bf16 v[180:183], v[56:59], v[228:231], v[180:183]
    ds_read_b64_tr_b16 v[56:57], v21 offset:50176
    v_mfma_f32_16x16x32_bf16 v[180:183], v[60:63], v[236:239], v[180:183]
    ds_read_b64_tr_b16 v[58:59], v21 offset:53760
    s_waitcnt lgkmcnt(4)
    v_mfma_f32_16x16x32_bf16 v[72:75], v[64:67], v[240:243], v[72:75]
    ds_read_b64_tr_b16 v[60:61], v21 offset:28704
    v_mfma_f32_16x16x32_bf16 v[72:75], v[68:71], v[248:251], v[72:75]
    ds_read_b64_tr_b16 v[62:63], v21 offset:32288
    s_add_u32 m0, s60, 1024
    s_nop 0
    buffer_load_dwordx4 v9, s[32:35], s59 offen lds
    v_fmac_f32 v160, v30, v196
    v_fmac_f32 v161, v30, v197
    ds_read_b128 v[184:187], v20 offset:0
    v_mfma_f32_16x16x32_bf16 v[76:79], v[64:67], v[244:247], v[76:79]
    ds_read_b64_tr_b16 v[64:65], v21 offset:35872
    v_mfma_f32_16x16x32_bf16 v[76:79], v[68:71], v[252:255], v[76:79]
    ds_read_b64_tr_b16 v[66:67], v21 offset:39456
    v_fmac_f32 v162, v30, v198
    v_fmac_f32 v163, v30, v199
    s_waitcnt lgkmcnt(5)
    v_mfma_f32_16x16x32_bf16 v[80:83], v[52:55], v[240:243], v[80:83]
    ds_read_b64_tr_b16 v[68:69], v21 offset:43040
    v_mfma_f32_16x16x32_bf16 v[80:83], v[56:59], v[248:251], v[80:83]
    ds_read_b64_tr_b16 v[70:71], v21 offset:46624
    v_fmac_f32 v164, v31, v196
    v_fmac_f32 v165, v31, v197
    v_mfma_f32_16x16x32_bf16 v[84:87], v[52:55], v[244:247], v[84:87]
    ds_read_b64_tr_b16 v[52:53], v21 offset:50208
    v_mfma_f32_16x16x32_bf16 v[84:87], v[56:59], v[252:255], v[84:87]
    ds_read_b64_tr_b16 v[54:55], v21 offset:53792
    s_setprio 2
    s_add_u32 m0, s60, 2048
    s_nop 0
    buffer_load_dwordx4 v10, s[32:35], s59 offen lds
    v_fmac_f32 v166, v31, v198
    v_fmac_f32 v167, v31, v199
    s_waitcnt lgkmcnt(4)
    v_mfma_f32_16x16x32_bf16 v[88:91], v[60:63], v[240:243], v[88:91]
    ds_read_b64_tr_b16 v[56:57], v21 offset:28736
    v_mfma_f32_16x16x32_bf16 v[88:91], v[64:67], v[248:251], v[88:91]
    ds_read_b64_tr_b16 v[58:59], v21 offset:32320
    v_fmac_f32 v168, v30, v184
    v_fmac_f32 v169, v30, v185
    ds_read_b128 v[188:191], v20 offset:448
    v_mfma_f32_16x16x32_bf16 v[92:95], v[60:63], v[244:247], v[92:95]
    ds_read_b64_tr_b16 v[60:61], v21 offset:35904
    v_mfma_f32_16x16x32_bf16 v[92:95], v[64:67], v[252:255], v[92:95]
    ds_read_b64_tr_b16 v[62:63], v21 offset:39488
    v_fmac_f32 v170, v30, v186
    v_fmac_f32 v171, v30, v187
    s_waitcnt lgkmcnt(5)
    v_mfma_f32_16x16x32_bf16 v[96:99], v[68:71], v[240:243], v[96:99]
    ds_read_b64_tr_b16 v[64:65], v21 offset:43072
    v_mfma_f32_16x16x32_bf16 v[96:99], v[52:55], v[248:251], v[96:99]
    ds_read_b64_tr_b16 v[66:67], v21 offset:46656
    s_add_u32 m0, s60, 3072
    s_mov_b32 exec_hi, 0
    buffer_load_dwordx4 v11, s[32:35], s59 offen lds
    s_mov_b32 exec_hi, -1
    s_add_u32 s59, s59, 458752
    v_fmac_f32 v172, v31, v184
    v_fmac_f32 v173, v31, v185
    v_mfma_f32_16x16x32_bf16 v[100:103], v[68:71], v[244:247], v[100:103]
    ds_read_b64_tr_b16 v[68:69], v21 offset:50240
    v_mfma_f32_16x16x32_bf16 v[100:103], v[52:55], v[252:255], v[100:103]
    ds_read_b64_tr_b16 v[70:71], v21 offset:53824
    v_fmac_f32 v174, v31, v186
    v_fmac_f32 v175, v31, v187
    s_waitcnt lgkmcnt(4)
    v_mfma_f32_16x16x32_bf16 v[104:107], v[56:59], v[240:243], v[104:107]
    ds_read_b64_tr_b16 v[52:53], v21 offset:28768
    v_mfma_f32_16x16x32_bf16 v[104:107], v[60:63], v[248:251], v[104:107]
    ds_read_b64_tr_b16 v[54:55], v21 offset:32352
    v_fmac_f32 v176, v30, v188
    v_fmac_f32 v177, v30, v189
    v_mfma_f32_16x16x32_bf16 v[108:111], v[56:59], v[244:247], v[108:111]
    ds_read_b64_tr_b16 v[56:57], v21 offset:35936
    v_mfma_f32_16x16x32_bf16 v[108:111], v[60:63], v[252:255], v[108:111]
    ds_read_b64_tr_b16 v[58:59], v21 offset:39520
    s_add_u32 m0, s60, 28672
    s_nop 0
    buffer_load_dwordx4 v8, s[32:35], s59 offen lds
    v_fmac_f32 v178, v30, v190
    v_fmac_f32 v179, v30, v191
    s_waitcnt lgkmcnt(4)
    v_mfma_f32_16x16x32_bf16 v[112:115], v[64:67], v[240:243], v[112:115]
    ds_read_b64_tr_b16 v[60:61], v21 offset:43104
    v_mfma_f32_16x16x32_bf16 v[112:115], v[68:71], v[248:251], v[112:115]
    ds_read_b64_tr_b16 v[62:63], v21 offset:46688
    s_setprio 1
    v_fmac_f32 v180, v31, v188
    v_fmac_f32 v181, v31, v189
    v_mfma_f32_16x16x32_bf16 v[116:119], v[64:67], v[244:247], v[116:119]
    ds_read_b64_tr_b16 v[64:65], v21 offset:50272
    v_mfma_f32_16x16x32_bf16 v[116:119], v[68:71], v[252:255], v[116:119]
    ds_read_b64_tr_b16 v[66:67], v21 offset:53856
    v_fmac_f32 v182, v31, v190
    v_fmac_f32 v183, v31, v191
    s_waitcnt lgkmcnt(4)
    v_mfma_f32_16x16x32_bf16 v[120:123], v[52:55], v[240:243], v[120:123]
    ds_read_b64_tr_b16 v[68:69], v21 offset:28800
    v_mfma_f32_16x16x32_bf16 v[120:123], v[56:59], v[248:251], v[120:123]
    ds_read_b64_tr_b16 v[70:71], v21 offset:32384
    s_add_u32 m0, s60, 29696
    s_nop 0
    buffer_load_dwordx4 v9, s[32:35], s59 offen lds
    v_mfma_f32_16x16x32_bf16 v[124:127], v[52:55], v[244:247], v[124:127]
    ds_read_b64_tr_b16 v[52:53], v21 offset:35968
    v_mfma_f32_16x16x32_bf16 v[124:127], v[56:59], v[252:255], v[124:127]
    ds_read_b64_tr_b16 v[54:55], v21 offset:39552
    s_waitcnt lgkmcnt(4)
    v_mfma_f32_16x16x32_bf16 v[128:131], v[60:63], v[240:243], v[128:131]
    ds_read_b64_tr_b16 v[56:57], v21 offset:43136
    v_mfma_f32_16x16x32_bf16 v[128:131], v[64:67], v[248:251], v[128:131]
    ds_read_b64_tr_b16 v[58:59], v21 offset:46720
    v_mfma_f32_16x16x32_bf16 v[132:135], v[60:63], v[244:247], v[132:135]
    ds_read_b64_tr_b16 v[60:61], v21 offset:50304
    v_mfma_f32_16x16x32_bf16 v[132:135], v[64:67], v[252:255], v[132:135]
    ds_read_b64_tr_b16 v[62:63], v21 offset:53888
    s_add_u32 m0, s60, 30720
    s_nop 0
    buffer_load_dwordx4 v10, s[32:35], s59 offen lds
    s_waitcnt lgkmcnt(4)
    v_mfma_f32_16x16x32_bf16 v[136:139], v[68:71], v[240:243], v[136:139]
    ds_read_b64_tr_b16 v[64:65], v21 offset:28832
    v_mfma_f32_16x16x32_bf16 v[136:139], v[52:55], v[248:251], v[136:139]
    ds_read_b64_tr_b16 v[66:67], v21 offset:32416
    v_mfma_f32_16x16x32_bf16 v[140:143], v[68:71], v[244:247], v[140:143]
    ds_read_b64_tr_b16 v[68:69], v21 offset:36000
    v_mfma_f32_16x16x32_bf16 v[140:143], v[52:55], v[252:255], v[140:143]
    ds_read_b64_tr_b16 v[70:71], v21 offset:39584
    s_setprio 0
    s_waitcnt lgkmcnt(4)
    v_mfma_f32_16x16x32_bf16 v[144:147], v[56:59], v[240:243], v[144:147]
    ds_read_b64_tr_b16 v[52:53], v21 offset:43168
    v_mfma_f32_16x16x32_bf16 v[144:147], v[60:63], v[248:251], v[144:147]
    ds_read_b64_tr_b16 v[54:55], v21 offset:46752
    s_add_u32 m0, s60, 31744
    s_mov_b32 exec_hi, 0
    buffer_load_dwordx4 v11, s[32:35], s59 offen lds
    s_mov_b32 exec_hi, -1
    s_add_u32 s59, s59, 458752
    v_mfma_f32_16x16x32_bf16 v[148:151], v[56:59], v[244:247], v[148:151]
    ds_read_b64_tr_b16 v[56:57], v21 offset:50336
    v_mfma_f32_16x16x32_bf16 v[148:151], v[60:63], v[252:255], v[148:151]
    ds_read_b64_tr_b16 v[58:59], v21 offset:53920
    s_waitcnt lgkmcnt(4)
    v_mfma_f32_16x16x32_bf16 v[152:155], v[64:67], v[240:243], v[152:155]
    ds_read_b64_tr_b16 v[60:61], v23 offset:28672
    v_mfma_f32_16x16x32_bf16 v[152:155], v[68:71], v[248:251], v[152:155]
    ds_read_b64_tr_b16 v[62:63], v23 offset:32256
    v_mfma_f32_16x16x32_bf16 v[156:159], v[64:67], v[244:247], v[156:159]
    ds_read_b64_tr_b16 v[64:65], v23 offset:35840
    v_mfma_f32_16x16x32_bf16 v[156:159], v[68:71], v[252:255], v[156:159]
    ds_read_b64_tr_b16 v[66:67], v23 offset:39424
    buffer_load_dwordx4 v[224:227], v15, s[36:39], s61 offen offset:2048 sc1
    s_waitcnt lgkmcnt(4)
    v_mfma_f32_16x16x32_bf16 v[160:163], v[52:55], v[240:243], v[160:163]
    ds_read_b64_tr_b16 v[68:69], v23 offset:43008
    v_mfma_f32_16x16x32_bf16 v[160:163], v[56:59], v[248:251], v[160:163]
    ds_read_b64_tr_b16 v[70:71], v23 offset:46592
    v_mfma_f32_16x16x32_bf16 v[164:167], v[52:55], v[244:247], v[164:167]
    ds_read_b64_tr_b16 v[52:53], v23 offset:50176
    v_mfma_f32_16x16x32_bf16 v[164:167], v[56:59], v[252:255], v[164:167]
    ds_read_b64_tr_b16 v[54:55], v23 offset:53760
    s_waitcnt lgkmcnt(4)
    v_mfma_f32_16x16x32_bf16 v[168:171], v[60:63], v[240:243], v[168:171]
    s_waitcnt vmcnt(13)
    s_barrier
    ds_read_b64_tr_b16 v[56:57], v21 offset:57344
    v_mfma_f32_16x16x32_bf16 v[168:171], v[64:67], v[248:251], v[168:171]
    ds_read_b64_tr_b16 v[58:59], v21 offset:60928
    s_setprio 3
    v_mfma_f32_16x16x32_bf16 v[172:175], v[60:63], v[244:247], v[172:175]
    ds_read_b64_tr_b16 v[60:61], v21 offset:64512
    v_mfma_f32_16x16x32_bf16 v[172:175], v[64:67], v[252:255], v[172:175]
    ds_read_b64_tr_b16 v[62:63], v22 offset:2560
    buffer_load_dwordx4 v[228:231], v16, s[36:39], s61 offen offset:2048 sc1
    s_waitcnt vmcnt(12)
    v_max3_u32 v12, v208, v209, v210
    v_max3_u32 v13, v211, v212, v213
    v_max3_u32 v12, v12, v214, v215
    v_max_u32 v12, v12, v13
    v_cmp_eq_u32 vcc, -1, v12
    s_cbranch_vccnz qa_kernel_F1_A24_R
qa_kernel_F1_A24_G:
    s_waitcnt lgkmcnt(4)
    v_mfma_f32_16x16x32_bf16 v[176:179], v[68:71], v[240:243], v[176:179]
    ds_read_b64_tr_b16 v[64:65], v22 offset:6144
    v_mfma_f32_16x16x32_bf16 v[176:179], v[52:55], v[248:251], v[176:179]
    ds_read_b64_tr_b16 v[66:67], v22 offset:9728
    s_waitcnt vmcnt(10)
    v_max3_u32 v12, v216, v217, v218
    v_max3_u32 v13, v219, v220, v221
    v_max3_u32 v12, v12, v222, v223
    v_max_u32 v12, v12, v13
    v_cmp_eq_u32 vcc, -1, v12
    s_cbranch_vccnz qa_kernel_F1_A25_R
qa_kernel_F1_A25_G:
    v_mfma_f32_16x16x32_bf16 v[180:183], v[68:71], v[244:247], v[180:183]
    ds_read_b64_tr_b16 v[68:69], v22 offset:13312
    v_mfma_f32_16x16x32_bf16 v[180:183], v[52:55], v[252:255], v[180:183]
    ds_read_b64_tr_b16 v[70:71], v22 offset:16896
    s_waitcnt lgkmcnt(4)
    v_mfma_f32_16x16x32_bf16 v[72:75], v[56:59], v[208:211], v[72:75]
    ds_read_b64_tr_b16 v[52:53], v21 offset:57376
    v_mfma_f32_16x16x32_bf16 v[72:75], v[60:63], v[216:219], v[72:75]
    ds_read_b64_tr_b16 v[54:55], v21 offset:60960
    buffer_load_dwordx4 v[232:235], v15, s[36:39], s61 offen offset:3072 sc1
    v_mfma_f32_16x16x32_bf16 v[76:79], v[56:59], v[212:215], v[76:79]
    ds_read_b64_tr_b16 v[56:57], v21 offset:64544
    v_mfma_f32_16x16x32_bf16 v[76:79], v[60:63], v[220:223], v[76:79]
    ds_read_b64_tr_b16 v[58:59], v22 offset:2592
    s_waitcnt lgkmcnt(4)
    v_mfma_f32_16x16x32_bf16 v[80:83], v[64:67], v[208:211], v[80:83]
    ds_read_b64_tr_b16 v[60:61], v22 offset:6176
    v_mfma_f32_16x16x32_bf16 v[80:83], v[68:71], v[216:219], v[80:83]
    ds_read_b64_tr_b16 v[62:63], v22 offset:9760
    v_mfma_f32_16x16x32_bf16 v[84:87], v[64:67], v[212:215], v[84:87]
    ds_read_b64_tr_b16 v[64:65], v22 offset:13344
    v_mfma_f32_16x16x32_bf16 v[84:87], v[68:71], v[220:223], v[84:87]
    ds_read_b64_tr_b16 v[66:67], v22 offset:16928
    s_setprio 2
    buffer_load_dwordx4 v[236:239], v16, s[36:39], s61 offen offset:3072 sc1
    s_add_u32 s61, s61, 4096
    s_waitcnt lgkmcnt(4)
    v_mfma_f32_16x16x32_bf16 v[88:91], v[52:55], v[208:211], v[88:91]
    ds_read_b64_tr_b16 v[68:69], v21 offset:57408
    v_mfma_f32_16x16x32_bf16 v[88:91], v[56:59], v[216:219], v[88:91]
    ds_read_b64_tr_b16 v[70:71], v21 offset:60992
    v_mfma_f32_16x16x32_bf16 v[92:95], v[52:55], v[212:215], v[92:95]
    ds_read_b64_tr_b16 v[52:53], v21 offset:64576
    v_mfma_f32_16x16x32_bf16 v[92:95], v[56:59], v[220:223], v[92:95]
    ds_read_b64_tr_b16 v[54:55], v22 offset:2624
    s_waitcnt lgkmcnt(4)
    v_mfma_f32_16x16x32_bf16 v[96:99], v[60:63], v[208:211], v[96:99]
    ds_read_b64_tr_b16 v[56:57], v22 offset:6208
    v_mfma_f32_16x16x32_bf16 v[96:99], v[64:67], v[216:219], v[96:99]
    ds_read_b64_tr_b16 v[58:59], v22 offset:9792
    s_add_u32 m0, s60, 65536
    s_nop 0
    buffer_load_dwordx4 v8, s[32:35], s59 offen lds
    v_mfma_f32_16x16x32_bf16 v[100:103], v[60:63], v[212:215], v[100:103]
    ds_read_b64_tr_b16 v[60:61], v22 offset:13376
    v_mfma_f32_16x16x32_bf16 v[100:103], v[64:67], v[220:223], v[100:103]
    ds_read_b64_tr_b16 v[62:63], v22 offset:16960
    s_waitcnt lgkmcnt(4)
    v_mfma_f32_16x16x32_bf16 v[104:107], v[68:71], v[208:211], v[104:107]
    ds_read_b64_tr_b16 v[64:65], v21 offset:57440
    v_mfma_f32_16x16x32_bf16 v[104:107], v[52:55], v[216:219], v[104:107]
    ds_read_b64_tr_b16 v[66:67], v21 offset:61024
    v_mfma_f32_16x16x32_bf16 v[108:111], v[68:71], v[212:215], v[108:111]
    ds_read_b64_tr_b16 v[68:69], v21 offset:64608
    v_mfma_f32_16x16x32_bf16 v[108:111], v[52:55], v[220:223], v[108:111]
    ds_read_b64_tr_b16 v[70:71], v22 offset:2656
    s_add_u32 m0, s60, 66560
    s_nop 0
    buffer_load_dwordx4 v9, s[32:35], s59 offen lds
    s_waitcnt lgkmcnt(4)
    v_mfma_f32_16x16x32_bf16 v[112:115], v[56:59], v[208:211], v[112:115]
    ds_read_b64_tr_b16 v[52:53], v22 offset:6240
    v_mfma_f32_16x16x32_bf16 v[112:115], v[60:63], v[216:219], v[112:115]
    ds_read_b64_tr_b16 v[54:55], v22 offset:9824
    s_setprio 1
    v_mfma_f32_16x16x32_bf16 v[116:119], v[56:59], v[212:215], v[116:119]
    ds_read_b64_tr_b16 v[56:57], v22 offset:13408
    v_mfma_f32_16x16x32_bf16 v[116:119], v[60:63], v[220:223], v[116:119]
    ds_read_b64_tr_b16 v[58:59], v22 offset:16992
    s_waitcnt lgkmcnt(4)
    v_mfma_f32_16x16x32_bf16 v[120:123], v[64:67], v[208:211], v[120:123]
    ds_read_b64_tr_b16 v[60:61], v21 offset:57472
    v_mfma_f32_16x16x32_bf16 v[120:123], v[68:71], v[216:219], v[120:123]
    ds_read_b64_tr_b16 v[62:63], v21 offset:61056
    s_add_u32 m0, s60, 67584
    s_nop 0
    buffer_load_dwordx4 v10, s[32:35], s59 offen lds
    v_mfma_f32_16x16x32_bf16 v[124:127], v[64:67], v[212:215], v[124:127]
    ds_read_b64_tr_b16 v[64:65], v21 offset:64640
    v_mfma_f32_16x16x32_bf16 v[124:127], v[68:71], v[220:223], v[124:127]
    ds_read_b64_tr_b16 v[66:67], v22 offset:2688
    s_waitcnt lgkmcnt(4)
    v_mfma_f32_16x16x32_bf16 v[128:131], v[52:55], v[208:211], v[128:131]
    ds_read_b64_tr_b16 v[68:69], v22 offset:6272
    v_mfma_f32_16x16x32_bf16 v[128:131], v[56:59], v[216:219], v[128:131]
    ds_read_b64_tr_b16 v[70:71], v22 offset:9856
    v_mfma_f32_16x16x32_bf16 v[132:135], v[52:55], v[212:215], v[132:135]
    ds_read_b64_tr_b16 v[52:53], v22 offset:13440
    v_mfma_f32_16x16x32_bf16 v[132:135], v[56:59], v[220:223], v[132:135]
    ds_read_b64_tr_b16 v[54:55], v22 offset:17024
    s_add_u32 m0, s60, 68608
    s_mov_b32 exec_hi, 0
    buffer_load_dwordx4 v11, s[32:35], s59 offen lds
    s_mov_b32 exec_hi, -1
    s_add_u32 s59, s59, 458752
    s_waitcnt lgkmcnt(4)
    v_mfma_f32_16x16x32_bf16 v[136:139], v[60:63], v[208:211], v[136:139]
    ds_read_b64_tr_b16 v[56:57], v21 offset:57504
    v_mfma_f32_16x16x32_bf16 v[136:139], v[64:67], v[216:219], v[136:139]
    ds_read_b64_tr_b16 v[58:59], v21 offset:61088
    buffer_load_dwordx4 v[240:243], v15, s[36:39], s61 offen offset:0 sc1
    v_mfma_f32_16x16x32_bf16 v[140:143], v[60:63], v[212:215], v[140:143]
    ds_read_b64_tr_b16 v[60:61], v21 offset:64672
    v_mfma_f32_16x16x32_bf16 v[140:143], v[64:67], v[220:223], v[140:143]
    ds_read_b64_tr_b16 v[62:63], v22 offset:2720
    s_setprio 0
    buffer_load_dwordx4 v[244:247], v16, s[36:39], s61 offen offset:0 sc1
    s_waitcnt lgkmcnt(4)
    v_mfma_f32_16x16x32_bf16 v[144:147], v[68:71], v[208:211], v[144:147]
    ds_read_b64_tr_b16 v[64:65], v22 offset:6304
    v_mfma_f32_16x16x32_bf16 v[144:147], v[52:55], v[216:219], v[144:147]
    ds_read_b64_tr_b16 v[66:67], v22 offset:9888
    buffer_load_dwordx4 v[248:251], v15, s[36:39], s61 offen offset:1024 sc1
    v_mfma_f32_16x16x32_bf16 v[148:151], v[68:71], v[212:215], v[148:151]
    ds_read_b64_tr_b16 v[68:69], v22 offset:13472
    v_mfma_f32_16x16x32_bf16 v[148:151], v[52:55], v[220:223], v[148:151]
    ds_read_b64_tr_b16 v[70:71], v22 offset:17056
    buffer_load_dwordx4 v[252:255], v16, s[36:39], s61 offen offset:1024 sc1
    s_waitcnt lgkmcnt(4)
    v_mfma_f32_16x16x32_bf16 v[152:155], v[56:59], v[208:211], v[152:155]
    ds_read_b64_tr_b16 v[52:53], v23 offset:57344
    v_mfma_f32_16x16x32_bf16 v[152:155], v[60:63], v[216:219], v[152:155]
    ds_read_b64_tr_b16 v[54:55], v23 offset:60928
    v_mfma_f32_16x16x32_bf16 v[156:159], v[56:59], v[212:215], v[156:159]
    ds_read_b64_tr_b16 v[56:57], v23 offset:64512
    v_mfma_f32_16x16x32_bf16 v[156:159], v[60:63], v[220:223], v[156:159]
    ds_read_b64_tr_b16 v[58:59], v24 offset:2560
    s_waitcnt lgkmcnt(4)
    v_mfma_f32_16x16x32_bf16 v[160:163], v[64:67], v[208:211], v[160:163]
    ds_read_b64_tr_b16 v[60:61], v24 offset:6144
    v_mfma_f32_16x16x32_bf16 v[160:163], v[68:71], v[216:219], v[160:163]
    ds_read_b64_tr_b16 v[62:63], v24 offset:9728
    v_mfma_f32_16x16x32_bf16 v[164:167], v[64:67], v[212:215], v[164:167]
    ds_read_b64_tr_b16 v[64:65], v24 offset:13312
    v_mfma_f32_16x16x32_bf16 v[164:167], v[68:71], v[220:223], v[164:167]
    ds_read_b64_tr_b16 v[66:67], v24 offset:16896
    s_waitcnt lgkmcnt(4)
    v_mfma_f32_16x16x32_bf16 v[168:171], v[52:55], v[208:211], v[168:171]
    s_waitcnt vmcnt(16)
    s_barrier
    ds_read_b64_tr_b16 v[68:69], v17 offset:0
    v_mfma_f32_16x16x32_bf16 v[168:171], v[56:59], v[216:219], v[168:171]
    ds_read_b64_tr_b16 v[70:71], v17 offset:3584
    s_setprio 3
    v_mfma_f32_16x16x32_bf16 v[172:175], v[52:55], v[212:215], v[172:175]
    ds_read_b64_tr_b16 v[52:53], v17 offset:7168
    v_mfma_f32_16x16x32_bf16 v[172:175], v[56:59], v[220:223], v[172:175]
    ds_read_b64_tr_b16 v[54:55], v17 offset:10752
    s_setprio 2
    s_waitcnt vmcnt(10)
    v_max3_u32 v12, v224, v225, v226
    v_max3_u32 v13, v227, v228, v229
    v_max3_u32 v12, v12, v230, v231
    v_max_u32 v12, v12, v13
    v_cmp_eq_u32 vcc, -1, v12
    s_cbranch_vccnz qa_kernel_F1_A26_R
qa_kernel_F1_A26_G:
    s_waitcnt lgkmcnt(4)
    v_mfma_f32_16x16x32_bf16 v[176:179], v[60:63], v[208:211], v[176:179]
    ds_read_b64_tr_b16 v[56:57], v17 offset:14336
    v_mfma_f32_16x16x32_bf16 v[176:179], v[64:67], v[216:219], v[176:179]
    ds_read_b64_tr_b16 v[58:59], v17 offset:17920
    s_setprio 1
    s_waitcnt vmcnt(8)
    v_max3_u32 v12, v232, v233, v234
    v_max3_u32 v13, v235, v236, v237
    v_max3_u32 v12, v12, v238, v239
    v_max_u32 v12, v12, v13
    v_cmp_eq_u32 vcc, -1, v12
    s_cbranch_vccnz qa_kernel_F1_A27_R
qa_kernel_F1_A27_G:
    v_mfma_f32_16x16x32_bf16 v[180:183], v[60:63], v[212:215], v[180:183]
    ds_read_b64_tr_b16 v[60:61], v17 offset:21504
    v_mfma_f32_16x16x32_bf16 v[180:183], v[64:67], v[220:223], v[180:183]
    ds_read_b64_tr_b16 v[62:63], v17 offset:25088
    s_setprio 0
    buffer_load_dwordx4 v[208:211], v15, s[36:39], s61 offen offset:2048 sc1
    s_waitcnt lgkmcnt(4)
    v_mfma_f32_16x16x32_bf16 v[72:75], v[68:71], v[224:227], v[72:75]
    s_barrier
    ds_read_b64_tr_b16 v[64:65], v17 offset:28672
    v_mfma_f32_16x16x32_bf16 v[72:75], v[52:55], v[232:235], v[72:75]
    ds_read_b64_tr_b16 v[66:67], v17 offset:32256
    s_setprio 3
    buffer_load_dwordx4 v[212:215], v16, s[36:39], s61 offen offset:2048 sc1
    v_mfma_f32_16x16x32_bf16 v[76:79], v[68:71], v[228:231], v[76:79]
    ds_read_b64_tr_b16 v[68:69], v17 offset:35840
    v_mfma_f32_16x16x32_bf16 v[76:79], v[52:55], v[236:239], v[76:79]
    ds_read_b64_tr_b16 v[70:71], v17 offset:39424
    s_setprio 2
    buffer_load_dwordx4 v[216:219], v15, s[36:39], s61 offen offset:3072 sc1
    s_waitcnt vmcnt(5)
    v_max3_u32 v12, v240, v241, v242
    v_max3_u32 v13, v243, v244, v245
    v_max3_u32 v12, v12, v246, v247
    v_max_u32 v12, v12, v13
    v_cmp_eq_u32 vcc, -1, v12
    s_cbranch_vccnz qa_kernel_F1_A28_R
qa_kernel_F1_A28_G:
    s_waitcnt lgkmcnt(4)
    v_mfma_f32_16x16x32_bf16 v[80:83], v[56:59], v[224:227], v[80:83]
    ds_read_b64_tr_b16 v[52:53], v17 offset:43008
    v_mfma_f32_16x16x32_bf16 v[80:83], v[60:63], v[232:235], v[80:83]
    ds_read_b64_tr_b16 v[54:55], v17 offset:46592
    s_setprio 1
    buffer_load_dwordx4 v[220:223], v16, s[36:39], s61 offen offset:3072 sc1
    s_add_u32 s61, s61, 4096
    s_waitcnt vmcnt(4)
    v_max3_u32 v12, v248, v249, v250
    v_max3_u32 v13, v251, v252, v253
    v_max3_u32 v12, v12, v254, v255
    v_max_u32 v12, v12, v13
    v_cmp_eq_u32 vcc, -1, v12
    s_cbranch_vccnz qa_kernel_F1_A29_R
qa_kernel_F1_A29_G:
    v_mfma_f32_16x16x32_bf16 v[84:87], v[56:59], v[228:231], v[84:87]
    ds_read_b64_tr_b16 v[56:57], v17 offset:50176
    v_mfma_f32_16x16x32_bf16 v[84:87], v[60:63], v[236:239], v[84:87]
    ds_read_b64_tr_b16 v[58:59], v17 offset:53760
    s_setprio 0
    s_waitcnt lgkmcnt(4)
    v_mfma_f32_16x16x32_bf16 v[72:75], v[64:67], v[240:243], v[72:75]
    s_barrier
    ds_read_b64_tr_b16 v[60:61], v21 offset:0
    v_mfma_f32_16x16x32_bf16 v[72:75], v[68:71], v[248:251], v[72:75]
    ds_read_b64_tr_b16 v[62:63], v21 offset:3584
qa_kernel_WS1_10:
    s_cbranch_execz qa_kernel_WRET1
    s_setprio 3
    v_mfma_f32_16x16x32_bf16 v[76:79], v[64:67], v[244:247], v[76:79]
    ds_read_b64_tr_b16 v[64:65], v21 offset:7168
    v_mfma_f32_16x16x32_bf16 v[76:79], v[68:71], v[252:255], v[76:79]
    ds_read_b64_tr_b16 v[66:67], v21 offset:10752
    s_waitcnt vmcnt(2)
    v_max3_u32 v12, v208, v209, v210
    v_max3_u32 v13, v211, v212, v213
    v_max3_u32 v12, v12, v214, v215
    v_max_u32 v12, v12, v13
    v_cmp_eq_u32 vcc, -1, v12
    s_cbranch_vccnz qa_kernel_F1_A30_R
qa_kernel_F1_A30_G:
    s_waitcnt lgkmcnt(4)
    v_mfma_f32_16x16x32_bf16 v[80:83], v[52:55], v[240:243], v[80:83]
    ds_read_b64_tr_b16 v[68:69], v21 offset:14336
    v_mfma_f32_16x16x32_bf16 v[80:83], v[56:59], v[248:251], v[80:83]
    ds_read_b64_tr_b16 v[70:71], v21 offset:17920
    s_waitcnt vmcnt(0)
    v_max3_u32 v12, v216, v217, v218
    v_max3_u32 v13, v219, v220, v221
    v_max3_u32 v12, v12, v222, v223
    v_max_u32 v12, v12, v13
    v_cmp_eq_u32 vcc, -1, v12
    s_cbranch_vccnz qa_kernel_F1_A31_R
qa_kernel_F1_A31_G:
    v_mfma_f32_16x16x32_bf16 v[84:87], v[52:55], v[244:247], v[84:87]
    ds_read_b64_tr_b16 v[52:53], v21 offset:21504
    v_mfma_f32_16x16x32_bf16 v[84:87], v[56:59], v[252:255], v[84:87]
    ds_read_b64_tr_b16 v[54:55], v21 offset:25088
    s_waitcnt lgkmcnt(4)
    v_mfma_f32_16x16x32_bf16 v[72:75], v[60:63], v[208:211], v[72:75]
    ds_read_b64_tr_b16 v[56:57], v17 offset:32
    v_mfma_f32_16x16x32_bf16 v[72:75], v[64:67], v[216:219], v[72:75]
    ds_read_b64_tr_b16 v[58:59], v17 offset:3616
    v_mfma_f32_16x16x32_bf16 v[76:79], v[60:63], v[212:215], v[76:79]
    ds_read_b64_tr_b16 v[60:61], v17 offset:7200
    v_mfma_f32_16x16x32_bf16 v[76:79], v[64:67], v[220:223], v[76:79]
    ds_read_b64_tr_b16 v[62:63], v17 offset:10784
    s_waitcnt lgkmcnt(4)
    v_mfma_f32_16x16x32_bf16 v[80:83], v[68:71], v[208:211], v[80:83]
    ds_read_b64_tr_b16 v[64:65], v17 offset:14368
    v_mfma_f32_16x16x32_bf16 v[80:83], v[52:55], v[216:219], v[80:83]
    ds_read_b64_tr_b16 v[66:67], v17 offset:17952
    s_add_u32 m0, s54, 98304
    s_mov_b32 s74, 0
    buffer_load_dwordx4 v37, s[28:31], s74 offen lds
    v_mfma_f32_16x16x32_bf16 v[84:87], v[68:71], v[212:215], v[84:87]
    ds_read_b64_tr_b16 v[68:69], v17 offset:21536
    v_mfma_f32_16x16x32_bf16 v[84:87], v[52:55], v[220:223], v[84:87]
    ds_read_b64_tr_b16 v[70:71], v17 offset:25120
    s_waitcnt lgkmcnt(4)
    v_mfma_f32_16x16x32_bf16 v[88:91], v[56:59], v[224:227], v[88:91]
    ds_read_b64_tr_b16 v[52:53], v17 offset:28704
    v_mfma_f32_16x16x32_bf16 v[88:91], v[60:63], v[232:235], v[88:91]
    ds_read_b64_tr_b16 v[54:55], v17 offset:32288
    v_mfma_f32_16x16x32_bf16 v[92:95], v[56:59], v[228:231], v[92:95]
    ds_read_b64_tr_b16 v[56:57], v17 offset:35872
    v_mfma_f32_16x16x32_bf16 v[92:95], v[60:63], v[236:239], v[92:95]
    ds_read_b64_tr_b16 v[58:59], v17 offset:39456
    v_mul_f32 v184, v34, v72
    v_mul_f32 v185, v34, v73
    v_mul_f32 v186, v34, v74
    v_mul_f32 v187, v34, v75
    v_mul_f32 v188, v35, v76
    v_mul_f32 v189, v35, v77
    s_waitcnt lgkmcnt(4)
    v_mfma_f32_16x16x32_bf16 v[96:99], v[64:67], v[224:227], v[96:99]
    ds_read_b64_tr_b16 v[60:61], v17 offset:43040
    v_mfma_f32_16x16x32_bf16 v[96:99], v[68:71], v[232:235], v[96:99]
    ds_read_b64_tr_b16 v[62:63], v17 offset:46624
    v_mul_f32 v190, v35, v78
    v_mul_f32 v191, v35, v79
    v_exp_f32 v184, v184
    v_exp_f32 v185, v185
    v_exp_f32 v186, v186
    v_exp_f32 v187, v187
    s_add_u32 m0, s54, 102400
    s_mov_b32 s74, 0
    buffer_load_dwordx4 v38, s[28:31], s74 offen lds
    v_mfma_f32_16x16x32_bf16 v[100:103], v[64:67], v[228:231], v[100:103]
    ds_read_b64_tr_b16 v[64:65], v17 offset:50208
    v_mfma_f32_16x16x32_bf16 v[100:103], v[68:71], v[236:239], v[100:103]
    ds_read_b64_tr_b16 v[66:67], v17 offset:53792
    v_exp_f32 v188, v188
    v_exp_f32 v189, v189
    v_exp_f32 v190, v190
    v_exp_f32 v191, v191
    v_mul_f32 v72, v72, v80
    v_mul_f32 v73, v73, v81
    s_waitcnt lgkmcnt(4)
    v_mfma_f32_16x16x32_bf16 v[88:91], v[52:55], v[240:243], v[88:91]
    ds_read_b64_tr_b16 v[68:69], v21 offset:32
    v_mfma_f32_16x16x32_bf16 v[88:91], v[56:59], v[248:251], v[88:91]
    ds_read_b64_tr_b16 v[70:71], v21 offset:3616
    v_mul_f32 v74, v74, v82
    v_mul_f32 v75, v75, v83
    v_mul_f32 v76, v76, v84
    v_mul_f32 v77, v77, v85
    v_mul_f32 v78, v78, v86
    v_mul_f32 v79, v79, v87
    v_mfma_f32_16x16x32_bf16 v[92:95], v[52:55], v[244:247], v[92:95]
    ds_read_b64_tr_b16 v[52:53], v21 offset:7200
    v_mfma_f32_16x16x32_bf16 v[92:95], v[56:59], v[252:255], v[92:95]
    ds_read_b64_tr_b16 v[54:55], v21 offset:10784
    v_fma_f32 v184, v184, v32, v32
    v_fma_f32 v185, v185, v32, v32
    v_fma_f32 v186, v186, v32, v32
    v_fma_f32 v187, v187, v32, v32
    v_fma_f32 v188, v188, v33, v33
    v_fma_f32 v189, v189, v33, v33
    s_waitcnt lgkmcnt(4)
    v_mfma_f32_16x16x32_bf16 v[96:99], v[60:63], v[240:243], v[96:99]
    ds_read_b64_tr_b16 v[56:57], v21 offset:14368
    v_mfma_f32_16x16x32_bf16 v[96:99], v[64:67], v[248:251], v[96:99]
    ds_read_b64_tr_b16 v[58:59], v21 offset:17952
    v_fma_f32 v190, v190, v33, v33
    v_fma_f32 v191, v191, v33, v33
    v_rcp_f32 v184, v184
    v_rcp_f32 v185, v185
    v_rcp_f32 v186, v186
    v_rcp_f32 v187, v187
    s_add_u32 m0, s54, 114688
    s_mov_b32 s74, 262144
    buffer_load_dwordx4 v37, s[28:31], s74 offen lds
    v_mfma_f32_16x16x32_bf16 v[100:103], v[60:63], v[244:247], v[100:103]
    ds_read_b64_tr_b16 v[60:61], v21 offset:21536
    v_mfma_f32_16x16x32_bf16 v[100:103], v[64:67], v[252:255], v[100:103]
    ds_read_b64_tr_b16 v[62:63], v21 offset:25120
    v_rcp_f32 v188, v188
    v_rcp_f32 v189, v189
    v_rcp_f32 v190, v190
    v_rcp_f32 v191, v191
    v_mul_f32 v72, v72, v184
    v_mul_f32 v73, v73, v185
    s_waitcnt lgkmcnt(4)
    v_mfma_f32_16x16x32_bf16 v[88:91], v[68:71], v[208:211], v[88:91]
    ds_read_b64_tr_b16 v[64:65], v17 offset:64
    v_mfma_f32_16x16x32_bf16 v[88:91], v[52:55], v[216:219], v[88:91]
    ds_read_b64_tr_b16 v[66:67], v17 offset:3648
    v_mul_f32 v74, v74, v186
    v_mul_f32 v75, v75, v187
    v_mul_f32 v76, v76, v188
    v_mul_f32 v77, v77, v189
    v_mul_f32 v78, v78, v190
    v_mul_f32 v79, v79, v191
    v_mfma_f32_16x16x32_bf16 v[92:95], v[68:71], v[212:215], v[92:95]
    ds_read_b64_tr_b16 v[68:69], v17 offset:7232
    v_mfma_f32_16x16x32_bf16 v[92:95], v[52:55], v[220:223], v[92:95]
    ds_read_b64_tr_b16 v[70:71], v17 offset:10816
    v_cvt_pk_bf16_f32 v200, v72, v73
    v_cvt_pk_bf16_f32 v201, v74, v75
    v_cvt_pk_bf16_f32 v204, v76, v77
    v_cvt_pk_bf16_f32 v205, v78, v79
    v_min_u32 v200, -2, v200
    v_min_u32 v201, -2, v201
    s_waitcnt lgkmcnt(4)
    v_mfma_f32_16x16x32_bf16 v[96:99], v[56:59], v[208:211], v[96:99]
    ds_read_b64_tr_b16 v[52:53], v17 offset:14400
    v_mfma_f32_16x16x32_bf16 v[96:99], v[60:63], v[216:219], v[96:99]
    ds_read_b64_tr_b16 v[54:55], v17 offset:17984
    v_min_u32 v204, -2, v204
    v_min_u32 v205, -2, v205
    s_add_u32 m0, s54, 118784
    s_mov_b32 s74, 262144
    buffer_load_dwordx4 v38, s[28:31], s74 offen lds
    v_mfma_f32_16x16x32_bf16 v[100:103], v[56:59], v[212:215], v[100:103]
    ds_read_b64_tr_b16 v[56:57], v17 offset:21568
    v_mfma_f32_16x16x32_bf16 v[100:103], v[60:63], v[220:223], v[100:103]
    ds_read_b64_tr_b16 v[58:59], v17 offset:25152
    s_waitcnt lgkmcnt(4)
    v_mfma_f32_16x16x32_bf16 v[104:107], v[64:67], v[224:227], v[104:107]
    ds_read_b64_tr_b16 v[60:61], v17 offset:28736
    v_mfma_f32_16x16x32_bf16 v[104:107], v[68:71], v[232:235], v[104:107]
    ds_read_b64_tr_b16 v[62:63], v17 offset:32320
    s_setprio 2
    v_mfma_f32_16x16x32_bf16 v[108:111], v[64:67], v[228:231], v[108:111]
    ds_read_b64_tr_b16 v[64:65], v17 offset:35904
    v_mfma_f32_16x16x32_bf16 v[108:111], v[68:71], v[236:239], v[108:111]
    ds_read_b64_tr_b16 v[66:67], v17 offset:39488
    v_mul_f32 v184, v34, v88
    v_mul_f32 v185, v34, v89
    v_mul_f32 v186, v34, v90
    v_mul_f32 v187, v34, v91
    v_mul_f32 v188, v35, v92
    v_mul_f32 v189, v35, v93
    v_mul_f32 v190, v35, v94
    v_mul_f32 v191, v35, v95
    v_exp_f32 v184, v184
    v_exp_f32 v185, v185
    s_waitcnt lgkmcnt(4)
    v_mfma_f32_16x16x32_bf16 v[112:115], v[52:55], v[224:227], v[112:115]
    ds_read_b64_tr_b16 v[68:69], v17 offset:43072
    v_mfma_f32_16x16x32_bf16 v[112:115], v[56:59], v[232:235], v[112:115]
    ds_read_b64_tr_b16 v[70:71], v17 offset:46656
    v_exp_f32 v186, v186
    v_exp_f32 v187, v187
    v_exp_f32 v188, v188
    v_exp_f32 v189, v189
    v_exp_f32 v190, v190
    v_exp_f32 v191, v191
    v_mul_f32 v88, v88, v96
    v_mul_f32 v89, v89, v97
    v_mul_f32 v90, v90, v98
    v_mul_f32 v91, v91, v99
    s_add_u32 m0, s54, 131072
    s_mov_b32 s74, 458752
    buffer_load_dwordx4 v37, s[28:31], s74 offen lds
    v_mfma_f32_16x16x32_bf16 v[116:119], v[52:55], v[228:231], v[116:119]
    ds_read_b64_tr_b16 v[52:53], v17 offset:50240
    v_mfma_f32_16x16x32_bf16 v[116:119], v[56:59], v[236:239], v[116:119]
    ds_read_b64_tr_b16 v[54:55], v17 offset:53824
    v_mul_f32 v92, v92, v100
    v_mul_f32 v93, v93, v101
    v_mul_f32 v94, v94, v102
    v_mul_f32 v95, v95, v103
    v_fma_f32 v184, v184, v32, v32
    v_fma_f32 v185, v185, v32, v32
    v_fma_f32 v186, v186, v32, v32
    v_fma_f32 v187, v187, v32, v32
    v_fma_f32 v188, v188, v33, v33
    v_fma_f32 v189, v189, v33, v33
    s_waitcnt lgkmcnt(4)
    v_mfma_f32_16x16x32_bf16 v[104:107], v[60:63], v[240:243], v[104:107]
    ds_read_b64_tr_b16 v[56:57], v21 offset:64
    v_mfma_f32_16x16x32_bf16 v[104:107], v[64:67], v[248:251], v[104:107]
    ds_read_b64_tr_b16 v[58:59], v21 offset:3648
    v_fma_f32 v190, v190, v33, v33
    v_fma_f32 v191, v191, v33, v33
    v_rcp_f32 v184, v184
    v_rcp_f32 v185, v185
    v_rcp_f32 v186, v186
    v_rcp_f32 v187, v187
    v_rcp_f32 v188, v188
    v_rcp_f32 v189, v189
    v_rcp_f32 v190, v190
    v_rcp_f32 v191, v191
    v_mfma_f32_16x16x32_bf16 v[108:111], v[60:63], v[244:247], v[108:111]
    ds_read_b64_tr_b16 v[60:61], v21 offset:7232
    v_mfma_f32_16x16x32_bf16 v[108:111], v[64:67], v[252:255], v[108:111]
    ds_read_b64_tr_b16 v[62:63], v21 offset:10816
    v_mul_f32 v88, v88, v184
    v_mul_f32 v89, v89, v185
    v_mul_f32 v90, v90, v186
    v_mul_f32 v91, v91, v187
    v_mul_f32 v92, v92, v188
    v_mul_f32 v93, v93, v189
    v_mul_f32 v94, v94, v190
    v_mul_f32 v95, v95, v191
    v_cvt_pk_bf16_f32 v202, v88, v89
    v_cvt_pk_bf16_f32 v203, v90, v91
    s_waitcnt lgkmcnt(4)
    v_mfma_f32_16x16x32_bf16 v[112:115], v[68:71], v[240:243], v[112:115]
    ds_read_b64_tr_b16 v[64:65], v21 offset:14400
    v_mfma_f32_16x16x32_bf16 v[112:115], v[52:55], v[248:251], v[112:115]
    ds_read_b64_tr_b16 v[66:67], v21 offset:17984
    v_cvt_pk_bf16_f32 v206, v92, v93
    v_cvt_pk_bf16_f32 v207, v94, v95
    v_min_u32 v202, -2, v202
    v_min_u32 v203, -2, v203
    v_min_u32 v206, -2, v206
    v_min_u32 v207, -2, v207
    buffer_store_dwordx4 v[200:203], v2, s[36:39], s72 offen offset:0 sc1
    buffer_store_dwordx4 v[204:207], v28, s[36:39], s72 offen offset:0 sc1
    s_add_u32 m0, s54, 135168
    s_mov_b32 s74, 458752
    buffer_load_dwordx4 v38, s[28:31], s74 offen lds
    v_mfma_f32_16x16x32_bf16 v[116:119], v[68:71], v[244:247], v[116:119]
    ds_read_b64_tr_b16 v[68:69], v21 offset:21568
    v_mfma_f32_16x16x32_bf16 v[116:119], v[52:55], v[252:255], v[116:119]
    ds_read_b64_tr_b16 v[70:71], v21 offset:25152
    s_waitcnt lgkmcnt(4)
    v_mfma_f32_16x16x32_bf16 v[104:107], v[56:59], v[208:211], v[104:107]
    ds_read_b64_tr_b16 v[52:53], v17 offset:96
    v_mfma_f32_16x16x32_bf16 v[104:107], v[60:63], v[216:219], v[104:107]
    ds_read_b64_tr_b16 v[54:55], v17 offset:3680
    v_mfma_f32_16x16x32_bf16 v[108:111], v[56:59], v[212:215], v[108:111]
    ds_read_b64_tr_b16 v[56:57], v17 offset:7264
    v_mfma_f32_16x16x32_bf16 v[108:111], v[60:63], v[220:223], v[108:111]
    ds_read_b64_tr_b16 v[58:59], v17 offset:10848
    s_waitcnt lgkmcnt(4)
    v_mfma_f32_16x16x32_bf16 v[112:115], v[64:67], v[208:211], v[112:115]
    ds_read_b64_tr_b16 v[60:61], v17 offset:14432
    v_mfma_f32_16x16x32_bf16 v[112:115], v[68:71], v[216:219], v[112:115]
    ds_read_b64_tr_b16 v[62:63], v17 offset:18016
    s_add_u32 m0, s54, 147456
    s_mov_b32 s74, 720896
    buffer_load_dwordx4 v37, s[28:31], s74 offen lds
    v_mfma_f32_16x16x32_bf16 v[116:119], v[64:67], v[212:215], v[116:119]
    ds_read_b64_tr_b16 v[64:65], v17 offset:21600
    v_mfma_f32_16x16x32_bf16 v[116:119], v[68:71], v[220:223], v[116:119]
    ds_read_b64_tr_b16 v[66:67], v17 offset:25184
    s_waitcnt lgkmcnt(4)
    v_mfma_f32_16x16x32_bf16 v[120:123], v[52:55], v[224:227], v[120:123]
    ds_read_b64_tr_b16 v[68:69], v17 offset:28768
    v_mfma_f32_16x16x32_bf16 v[120:123], v[56:59], v[232:235], v[120:123]
    ds_read_b64_tr_b16 v[70:71], v17 offset:32352
    v_mfma_f32_16x16x32_bf16 v[124:127], v[52:55], v[228:231], v[124:127]
    ds_read_b64_tr_b16 v[52:53], v17 offset:35936
    v_mfma_f32_16x16x32_bf16 v[124:127], v[56:59], v[236:239], v[124:127]
    ds_read_b64_tr_b16 v[54:55], v17 offset:39520
    v_mul_f32 v184, v34, v104
    v_mul_f32 v185, v34, v105
    v_mul_f32 v186, v34, v106
    v_mul_f32 v187, v34, v107
    v_mul_f32 v188, v35, v108
    s_waitcnt lgkmcnt(4)
    v_mfma_f32_16x16x32_bf16 v[128:131], v[60:63], v[224:227], v[128:131]
    ds_read_b64_tr_b16 v[56:57], v17 offset:43104
    v_mfma_f32_16x16x32_bf16 v[128:131], v[64:67], v[232:235], v[128:131]
    ds_read_b64_tr_b16 v[58:59], v17 offset:46688
    v_mul_f32 v189, v35, v109
    v_mul_f32 v190, v35, v110
    v_mul_f32 v191, v35, v111
    v_exp_f32 v184, v184
    v_exp_f32 v185, v185
    s_add_u32 m0, s54, 151552
    s_mov_b32 s74, 720896
    buffer_load_dwordx4 v38, s[28:31], s74 offen lds
    v_mfma_f32_16x16x32_bf16 v[132:135], v[60:63], v[228:231], v[132:135]
    ds_read_b64_tr_b16 v[60:61], v17 offset:50272
    v_mfma_f32_16x16x32_bf16 v[132:135], v[64:67], v[236:239], v[132:135]
    ds_read_b64_tr_b16 v[62:63], v17 offset:53856
    v_exp_f32 v186, v186
    v_exp_f32 v187, v187
    v_exp_f32 v188, v188
    v_exp_f32 v189, v189
    v_exp_f32 v190, v190
    s_waitcnt lgkmcnt(4)
    v_mfma_f32_16x16x32_bf16 v[120:123], v[68:71], v[240:243], v[120:123]
    ds_read_b64_tr_b16 v[64:65], v21 offset:96
    v_mfma_f32_16x16x32_bf16 v[120:123], v[52:55], v[248:251], v[120:123]
    ds_read_b64_tr_b16 v[66:67], v21 offset:3680
    v_exp_f32 v191, v191
    v_mul_f32 v104, v104, v112
    v_mul_f32 v105, v105, v113
    v_mul_f32 v106, v106, v114
    v_mul_f32 v107, v107, v115
    v_mfma_f32_16x16x32_bf16 v[124:127], v[68:71], v[244:247], v[124:127]
    ds_read_b64_tr_b16 v[68:69], v21 offset:7264
    v_mfma_f32_16x16x32_bf16 v[124:127], v[52:55], v[252:255], v[124:127]
    ds_read_b64_tr_b16 v[70:71], v21 offset:10848
    v_mul_f32 v108, v108, v116
    v_mul_f32 v109, v109, v117
    v_mul_f32 v110, v110, v118
    v_mul_f32 v111, v111, v119
    v_fma_f32 v184, v184, v32, v32
    s_waitcnt lgkmcnt(4)
    v_mfma_f32_16x16x32_bf16 v[128:131], v[56:59], v[240:243], v[128:131]
    ds_read_b64_tr_b16 v[52:53], v21 offset:14432
    v_mfma_f32_16x16x32_bf16 v[128:131], v[60:63], v[248:251], v[128:131]
    ds_read_b64_tr_b16 v[54:55], v21 offset:18016
    v_fma_f32 v185, v185, v32, v32
    v_fma_f32 v186, v186, v32, v32
    v_fma_f32 v187, v187, v32, v32
    v_fma_f32 v188, v188, v33, v33
    v_fma_f32 v189, v189, v33, v33
    v_mfma_f32_16x16x32_bf16 v[132:135], v[56:59], v[244:247], v[132:135]
    ds_read_b64_tr_b16 v[56:57], v21 offset:21600
    v_mfma_f32_16x16x32_bf16 v[132:135], v[60:63], v[252:255], v[132:135]
    ds_read_b64_tr_b16 v[58:59], v21 offset:25184
    v_fma_f32 v190, v190, v33, v33
    v_fma_f32 v191, v191, v33, v33
    v_rcp_f32 v184, v184
    v_rcp_f32 v185, v185
    v_rcp_f32 v186, v186
    s_waitcnt lgkmcnt(4)
    v_mfma_f32_16x16x32_bf16 v[120:123], v[64:67], v[208:211], v[120:123]
    ds_read_b64_tr_b16 v[60:61], v17 offset:128
    v_mfma_f32_16x16x32_bf16 v[120:123], v[68:71], v[216:219], v[120:123]
    ds_read_b64_tr_b16 v[62:63], v17 offset:3712
    s_setprio 1
    v_rcp_f32 v187, v187
    v_rcp_f32 v188, v188
    v_rcp_f32 v189, v189
    v_rcp_f32 v190, v190
    v_rcp_f32 v191, v191
    v_mfma_f32_16x16x32_bf16 v[124:127], v[64:67], v[212:215], v[124:127]
    ds_read_b64_tr_b16 v[64:65], v17 offset:7296
    v_mfma_f32_16x16x32_bf16 v[124:127], v[68:71], v[220:223], v[124:127]
    ds_read_b64_tr_b16 v[66:67], v17 offset:10880
    v_mul_f32 v104, v104, v184
    v_mul_f32 v105, v105, v185
    v_mul_f32 v106, v106, v186
    v_mul_f32 v107, v107, v187
    v_mul_f32 v108, v108, v188
    s_waitcnt lgkmcnt(4)
    v_mfma_f32_16x16x32_bf16 v[128:131], v[52:55], v[208:211], v[128:131]
    ds_read_b64_tr_b16 v[68:69], v17 offset:14464
    v_mfma_f32_16x16x32_bf16 v[128:131], v[56:59], v[216:219], v[128:131]
    ds_read_b64_tr_b16 v[70:71], v17 offset:18048
    v_mul_f32 v109, v109, v189
    v_mul_f32 v110, v110, v190
    v_mul_f32 v111, v111, v191
    v_cvt_pk_bf16_f32 v200, v104, v105
    v_cvt_pk_bf16_f32 v201, v106, v107
    v_mfma_f32_16x16x32_bf16 v[132:135], v[52:55], v[212:215], v[132:135]
    ds_read_b64_tr_b16 v[52:53], v17 offset:21632
    v_mfma_f32_16x16x32_bf16 v[132:135], v[56:59], v[220:223], v[132:135]
    ds_read_b64_tr_b16 v[54:55], v17 offset:25216
    v_cvt_pk_bf16_f32 v204, v108, v109
    v_cvt_pk_bf16_f32 v205, v110, v111
    s_waitcnt lgkmcnt(4)
    v_mfma_f32_16x16x32_bf16 v[136:139], v[60:63], v[224:227], v[136:139]
    ds_read_b64_tr_b16 v[56:57], v17 offset:28800
    v_mfma_f32_16x16x32_bf16 v[136:139], v[64:67], v[232:235], v[136:139]
    ds_read_b64_tr_b16 v[58:59], v17 offset:32384
    v_mfma_f32_16x16x32_bf16 v[140:143], v[60:63], v[228:231], v[140:143]
    ds_read_b64_tr_b16 v[60:61], v17 offset:35968
    v_mfma_f32_16x16x32_bf16 v[140:143], v[64:67], v[236:239], v[140:143]
    ds_read_b64_tr_b16 v[62:63], v17 offset:39552
    v_mul_f32 v184, v34, v120
    v_mul_f32 v185, v34, v121
    v_mul_f32 v186, v34, v122
    v_mul_f32 v187, v34, v123
    v_mul_f32 v188, v35, v124
    s_waitcnt lgkmcnt(4)
    v_mfma_f32_16x16x32_bf16 v[144:147], v[68:71], v[224:227], v[144:147]
    ds_read_b64_tr_b16 v[64:65], v17 offset:43136
    v_mfma_f32_16x16x32_bf16 v[144:147], v[52:55], v[232:235], v[144:147]
    ds_read_b64_tr_b16 v[66:67], v17 offset:46720
    v_mul_f32 v189, v35, v125
    v_mul_f32 v190, v35, v126
    v_mul_f32 v191, v35, v127
    v_exp_f32 v184, v184
    v_exp_f32 v185, v185
    s_mov_b32 s77, 29360128
    buffer_load_dwordx4 v[72:75], v39, s[36:39], s77 offen sc1
    v_mfma_f32_16x16x32_bf16 v[148:151], v[68:71], v[228:231], v[148:151]
    ds_read_b64_tr_b16 v[68:69], v17 offset:50304
    v_mfma_f32_16x16x32_bf16 v[148:151], v[52:55], v[236:239], v[148:151]
    ds_read_b64_tr_b16 v[70:71], v17 offset:53888
    v_exp_f32 v186, v186
    v_exp_f32 v187, v187
    v_exp_f32 v188, v188
    v_exp_f32 v189, v189
    v_exp_f32 v190, v190
    s_waitcnt lgkmcnt(4)
    v_mfma_f32_16x16x32_bf16 v[136:139], v[56:59], v[240:243], v[136:139]
    ds_read_b64_tr_b16 v[52:53], v21 offset:128
    v_mfma_f32_16x16x32_bf16 v[136:139], v[60:63], v[248:251], v[136:139]
    ds_read_b64_tr_b16 v[54:55], v21 offset:3712
    v_exp_f32 v191, v191
    v_mul_f32 v120, v120, v128
    v_mul_f32 v121, v121, v129
    v_mul_f32 v122, v122, v130
    v_mul_f32 v123, v123, v131
    buffer_load_dwordx4 v[76:79], v40, s[36:39], s77 offen sc1
    v_mfma_f32_16x16x32_bf16 v[140:143], v[56:59], v[244:247], v[140:143]
    ds_read_b64_tr_b16 v[56:57], v21 offset:7296
    v_mfma_f32_16x16x32_bf16 v[140:143], v[60:63], v[252:255], v[140:143]
    ds_read_b64_tr_b16 v[58:59], v21 offset:10880
    v_mul_f32 v124, v124, v132
    v_mul_f32 v125, v125, v133
    v_mul_f32 v126, v126, v134
    v_mul_f32 v127, v127, v135
    v_fma_f32 v184, v184, v32, v32
    s_waitcnt lgkmcnt(4)
    v_mfma_f32_16x16x32_bf16 v[144:147], v[64:67], v[240:243], v[144:147]
    ds_read_b64_tr_b16 v[60:61], v21 offset:14464
    v_mfma_f32_16x16x32_bf16 v[144:147], v[68:71], v[248:251], v[144:147]
    ds_read_b64_tr_b16 v[62:63], v21 offset:18048
    v_fma_f32 v185, v185, v32, v32
    v_fma_f32 v186, v186, v32, v32
    v_fma_f32 v187, v187, v32, v32
    v_fma_f32 v188, v188, v33, v33
    v_fma_f32 v189, v189, v33, v33
    s_mov_b32 s77, 29364224
    buffer_load_dwordx4 v[80:83], v39, s[36:39], s77 offen sc1
    v_mfma_f32_16x16x32_bf16 v[148:151], v[64:67], v[244:247], v[148:151]
    ds_read_b64_tr_b16 v[64:65], v21 offset:21632
    v_mfma_f32_16x16x32_bf16 v[148:151], v[68:71], v[252:255], v[148:151]
    ds_read_b64_tr_b16 v[66:67], v21 offset:25216
    v_fma_f32 v190, v190, v33, v33
    v_fma_f32 v191, v191, v33, v33
    v_rcp_f32 v184, v184
    v_rcp_f32 v185, v185
    v_rcp_f32 v186, v186
    s_waitcnt lgkmcnt(4)
    v_mfma_f32_16x16x32_bf16 v[136:139], v[52:55], v[208:211], v[136:139]
    ds_read_b64_tr_b16 v[68:69], v17 offset:160
    v_mfma_f32_16x16x32_bf16 v[136:139], v[56:59], v[216:219], v[136:139]
    ds_read_b64_tr_b16 v[70:71], v17 offset:3744
    v_rcp_f32 v187, v187
    v_rcp_f32 v188, v188
    v_rcp_f32 v189, v189
    v_rcp_f32 v190, v190
    v_rcp_f32 v191, v191
    buffer_load_dwordx4 v[84:87], v40, s[36:39], s77 offen sc1
    v_mfma_f32_16x16x32_bf16 v[140:143], v[52:55], v[212:215], v[140:143]
    ds_read_b64_tr_b16 v[52:53], v17 offset:7328
    v_mfma_f32_16x16x32_bf16 v[140:143], v[56:59], v[220:223], v[140:143]
    ds_read_b64_tr_b16 v[54:55], v17 offset:10912
    v_mul_f32 v120, v120, v184
    v_mul_f32 v121, v121, v185
    v_mul_f32 v122, v122, v186
    v_mul_f32 v123, v123, v187
    v_mul_f32 v124, v124, v188
    s_waitcnt lgkmcnt(4)
    v_mfma_f32_16x16x32_bf16 v[144:147], v[60:63], v[208:211], v[144:147]
    ds_read_b64_tr_b16 v[56:57], v17 offset:14496
    v_mfma_f32_16x16x32_bf16 v[144:147], v[64:67], v[216:219], v[144:147]
    ds_read_b64_tr_b16 v[58:59], v17 offset:18080
    v_mul_f32 v125, v125, v189
    v_mul_f32 v126, v126, v190
    v_mul_f32 v127, v127, v191
    v_cvt_pk_bf16_f32 v202, v120, v121
    v_cvt_pk_bf16_f32 v203, v122, v123
    s_mov_b32 s77, 29367296
    buffer_load_dwordx4 v[88:91], v39, s[36:39], s77 offen sc1
    v_mfma_f32_16x16x32_bf16 v[148:151], v[60:63], v[212:215], v[148:151]
    ds_read_b64_tr_b16 v[60:61], v17 offset:21664
    v_mfma_f32_16x16x32_bf16 v[148:151], v[64:67], v[220:223], v[148:151]
    ds_read_b64_tr_b16 v[62:63], v17 offset:25248
    v_cvt_pk_bf16_f32 v206, v124, v125
    v_cvt_pk_bf16_f32 v207, v126, v127
    buffer_store_dwordx4 v[200:203], v2, s[36:39], s72 offen offset:1024 sc1
    buffer_store_dwordx4 v[204:207], v28, s[36:39], s72 offen offset:1024 sc1
    s_waitcnt lgkmcnt(4)
    v_mfma_f32_16x16x32_bf16 v[152:155], v[68:71], v[224:227], v[152:155]
    ds_read_b64_tr_b16 v[64:65], v17 offset:28832
    v_mfma_f32_16x16x32_bf16 v[152:155], v[52:55], v[232:235], v[152:155]
    ds_read_b64_tr_b16 v[66:67], v17 offset:32416
    buffer_load_dwordx4 v[92:95], v40, s[36:39], s77 offen sc1
    v_mfma_f32_16x16x32_bf16 v[156:159], v[68:71], v[228:231], v[156:159]
    ds_read_b64_tr_b16 v[68:69], v17 offset:36000
    v_mfma_f32_16x16x32_bf16 v[156:159], v[52:55], v[236:239], v[156:159]
    ds_read_b64_tr_b16 v[70:71], v17 offset:39584
    v_mul_f32 v184, v34, v136
    v_mul_f32 v185, v34, v137
    v_mul_f32 v186, v34, v138
    v_mul_f32 v187, v34, v139
    v_mul_f32 v188, v35, v140
    s_waitcnt lgkmcnt(4)
    v_mfma_f32_16x16x32_bf16 v[160:163], v[56:59], v[224:227], v[160:163]
    ds_read_b64_tr_b16 v[52:53], v17 offset:43168
    v_mfma_f32_16x16x32_bf16 v[160:163], v[60:63], v[232:235], v[160:163]
    ds_read_b64_tr_b16 v[54:55], v17 offset:46752
    v_mul_f32 v189, v35, v141
    v_mul_f32 v190, v35, v142
    v_mul_f32 v191, v35, v143
    v_exp_f32 v184, v184
    v_exp_f32 v185, v185
    s_mov_b32 s77, 29371392
    buffer_load_dwordx4 v[96:99], v39, s[36:39], s77 offen sc1
    v_mfma_f32_16x16x32_bf16 v[164:167], v[56:59], v[228:231], v[164:167]
    ds_read_b64_tr_b16 v[56:57], v17 offset:50336
    v_mfma_f32_16x16x32_bf16 v[164:167], v[60:63], v[236:239], v[164:167]
    ds_read_b64_tr_b16 v[58:59], v17 offset:53920
    v_exp_f32 v186, v186
    v_exp_f32 v187, v187
    v_exp_f32 v188, v188
    v_exp_f32 v189, v189
    v_exp_f32 v190, v190
    s_waitcnt lgkmcnt(4)
    v_mfma_f32_16x16x32_bf16 v[152:155], v[64:67], v[240:243], v[152:155]
    ds_read_b64_tr_b16 v[60:61], v21 offset:160
    v_mfma_f32_16x16x32_bf16 v[152:155], v[68:71], v[248:251], v[152:155]
    ds_read_b64_tr_b16 v[62:63], v21 offset:3744
    s_setprio 0
    v_exp_f32 v191, v191
    v_mul_f32 v136, v136, v144
    v_mul_f32 v137, v137, v145
    v_mul_f32 v138, v138, v146
    v_mul_f32 v139, v139, v147
    buffer_load_dwordx4 v[100:103], v40, s[36:39], s77 offen sc1
    v_mfma_f32_16x16x32_bf16 v[156:159], v[64:67], v[244:247], v[156:159]
    ds_read_b64_tr_b16 v[64:65], v21 offset:7328
    v_mfma_f32_16x16x32_bf16 v[156:159], v[68:71], v[252:255], v[156:159]
    ds_read_b64_tr_b16 v[66:67], v21 offset:10912
    v_mul_f32 v140, v140, v148
    v_mul_f32 v141, v141, v149
    v_mul_f32 v142, v142, v150
    v_mul_f32 v143, v143, v151
    v_fma_f32 v184, v184, v32, v32
    s_waitcnt lgkmcnt(4)
    v_mfma_f32_16x16x32_bf16 v[160:163], v[52:55], v[240:243], v[160:163]
    ds_read_b64_tr_b16 v[68:69], v21 offset:14496
    v_mfma_f32_16x16x32_bf16 v[160:163], v[56:59], v[248:251], v[160:163]
    ds_read_b64_tr_b16 v[70:71], v21 offset:18080
    v_fma_f32 v185, v185, v32, v32
    v_fma_f32 v186, v186, v32, v32
    v_fma_f32 v187, v187, v32, v32
    v_fma_f32 v188, v188, v33, v33
    v_fma_f32 v189, v189, v33, v33
    s_mov_b32 s77, 29374464
    buffer_load_dwordx4 v[104:107], v39, s[36:39], s77 offen sc1
    v_mfma_f32_16x16x32_bf16 v[164:167], v[52:55], v[244:247], v[164:167]
    ds_read_b64_tr_b16 v[52:53], v21 offset:21664
    v_mfma_f32_16x16x32_bf16 v[164:167], v[56:59], v[252:255], v[164:167]
    ds_read_b64_tr_b16 v[54:55], v21 offset:25248
    v_fma_f32 v190, v190, v33, v33
    v_fma_f32 v191, v191, v33, v33
    v_rcp_f32 v184, v184
    v_rcp_f32 v185, v185
    v_rcp_f32 v186, v186
    s_waitcnt lgkmcnt(4)
    v_mfma_f32_16x16x32_bf16 v[152:155], v[60:63], v[208:211], v[152:155]
    ds_read_b64_tr_b16 v[56:57], v18 offset:0
    v_mfma_f32_16x16x32_bf16 v[152:155], v[64:67], v[216:219], v[152:155]
    ds_read_b64_tr_b16 v[58:59], v18 offset:3584
    v_rcp_f32 v187, v187
    v_rcp_f32 v188, v188
    v_rcp_f32 v189, v189
    v_rcp_f32 v190, v190
    v_rcp_f32 v191, v191
    buffer_load_dwordx4 v[108:111], v40, s[36:39], s77 offen sc1
    v_mfma_f32_16x16x32_bf16 v[156:159], v[60:63], v[212:215], v[156:159]
    ds_read_b64_tr_b16 v[60:61], v18 offset:7168
    v_mfma_f32_16x16x32_bf16 v[156:159], v[64:67], v[220:223], v[156:159]
    ds_read_b64_tr_b16 v[62:63], v18 offset:10752
    v_mul_f32 v136, v136, v184
    v_mul_f32 v137, v137, v185
    v_mul_f32 v138, v138, v186
    v_mul_f32 v139, v139, v187
    v_mul_f32 v140, v140, v188
    s_waitcnt lgkmcnt(4)
    v_mfma_f32_16x16x32_bf16 v[160:163], v[68:71], v[208:211], v[160:163]
    ds_read_b64_tr_b16 v[64:65], v18 offset:14336
    v_mfma_f32_16x16x32_bf16 v[160:163], v[52:55], v[216:219], v[160:163]
    ds_read_b64_tr_b16 v[66:67], v18 offset:17920
    v_mul_f32 v141, v141, v189
    v_mul_f32 v142, v142, v190
    v_mul_f32 v143, v143, v191
    v_cvt_pk_bf16_f32 v200, v136, v137
    v_cvt_pk_bf16_f32 v201, v138, v139
    s_mov_b32 s77, 29378560
    buffer_load_dwordx4 v[112:115], v39, s[36:39], s77 offen sc1
    v_mfma_f32_16x16x32_bf16 v[164:167], v[68:71], v[212:215], v[164:167]
    ds_read_b64_tr_b16 v[68:69], v18 offset:21504
    v_mfma_f32_16x16x32_bf16 v[164:167], v[52:55], v[220:223], v[164:167]
    ds_read_b64_tr_b16 v[70:71], v18 offset:25088
    v_cvt_pk_bf16_f32 v204, v140, v141
    v_cvt_pk_bf16_f32 v205, v142, v143
    s_waitcnt lgkmcnt(4)
    v_mfma_f32_16x16x32_bf16 v[168:171], v[56:59], v[224:227], v[168:171]
    ds_read_b64_tr_b16 v[52:53], v18 offset:28672
    v_mfma_f32_16x16x32_bf16 v[168:171], v[60:63], v[232:235], v[168:171]
    ds_read_b64_tr_b16 v[54:55], v18 offset:32256
    buffer_load_dwordx4 v[116:119], v40, s[36:39], s77 offen sc1
    v_mfma_f32_16x16x32_bf16 v[172:175], v[56:59], v[228:231], v[172:175]
qa_kernel_WS1_11:
    s_cbranch_execz qa_kernel_WRET1
    ds_read_b64_tr_b16 v[56:57], v18 offset:35840
    v_mfma_f32_16x16x32_bf16 v[172:175], v[60:63], v[236:239], v[172:175]
    ds_read_b64_tr_b16 v[58:59], v18 offset:39424
    v_mul_f32 v184, v34, v152
    v_mul_f32 v185, v34, v153
    v_mul_f32 v186, v34, v154
    v_mul_f32 v187, v34, v155
    v_mul_f32 v188, v35, v156
    s_waitcnt lgkmcnt(4)
    v_mfma_f32_16x16x32_bf16 v[176:179], v[64:67], v[224:227], v[176:179]
    ds_read_b64_tr_b16 v[60:61], v18 offset:43008
    v_mfma_f32_16x16x32_bf16 v[176:179], v[68:71], v[232:235], v[176:179]
    ds_read_b64_tr_b16 v[62:63], v18 offset:46592
    v_mul_f32 v189, v35, v157
    v_mul_f32 v190, v35, v158
    v_mul_f32 v191, v35, v159
    v_exp_f32 v184, v184
    v_exp_f32 v185, v185
    s_mov_b32 s77, 29381632
    buffer_load_dwordx4 v[120:123], v39, s[36:39], s77 offen sc1
    v_mfma_f32_16x16x32_bf16 v[180:183], v[64:67], v[228:231], v[180:183]
    ds_read_b64_tr_b16 v[64:65], v18 offset:50176
    v_mfma_f32_16x16x32_bf16 v[180:183], v[68:71], v[236:239], v[180:183]
    ds_read_b64_tr_b16 v[66:67], v18 offset:53760
    v_exp_f32 v186, v186
    v_exp_f32 v187, v187
    v_exp_f32 v188, v188
    v_exp_f32 v189, v189
    v_exp_f32 v190, v190
    s_waitcnt lgkmcnt(4)
    v_mfma_f32_16x16x32_bf16 v[168:171], v[52:55], v[240:243], v[168:171]
    ds_read_b64_tr_b16 v[68:69], v23 offset:0
    v_mfma_f32_16x16x32_bf16 v[168:171], v[56:59], v[248:251], v[168:171]
    ds_read_b64_tr_b16 v[70:71], v23 offset:3584
    v_exp_f32 v191, v191
    v_mul_f32 v152, v152, v160
    v_mul_f32 v153, v153, v161
    v_mul_f32 v154, v154, v162
    v_mul_f32 v155, v155, v163
    buffer_load_dwordx4 v[124:127], v40, s[36:39], s77 offen sc1
    v_mfma_f32_16x16x32_bf16 v[172:175], v[52:55], v[244:247], v[172:175]
    ds_read_b64_tr_b16 v[52:53], v23 offset:7168
    v_mfma_f32_16x16x32_bf16 v[172:175], v[56:59], v[252:255], v[172:175]
    ds_read_b64_tr_b16 v[54:55], v23 offset:10752
    v_mul_f32 v156, v156, v164
    v_mul_f32 v157, v157, v165
    v_mul_f32 v158, v158, v166
    v_mul_f32 v159, v159, v167
    v_fma_f32 v184, v184, v32, v32
    s_waitcnt lgkmcnt(4)
    v_mfma_f32_16x16x32_bf16 v[176:179], v[60:63], v[240:243], v[176:179]
    ds_read_b64_tr_b16 v[56:57], v23 offset:14336
    v_mfma_f32_16x16x32_bf16 v[176:179], v[64:67], v[248:251], v[176:179]
    ds_read_b64_tr_b16 v[58:59], v23 offset:17920
    v_fma_f32 v185, v185, v32, v32
    v_fma_f32 v186, v186, v32, v32
    v_fma_f32 v187, v187, v32, v32
    v_fma_f32 v188, v188, v33, v33
    v_fma_f32 v189, v189, v33, v33
    s_mov_b32 s77, 29385728
    buffer_load_dwordx4 v[128:131], v39, s[36:39], s77 offen sc1
    v_mfma_f32_16x16x32_bf16 v[180:183], v[60:63], v[244:247], v[180:183]
    ds_read_b64_tr_b16 v[60:61], v23 offset:21504
    v_mfma_f32_16x16x32_bf16 v[180:183], v[64:67], v[252:255], v[180:183]
    ds_read_b64_tr_b16 v[62:63], v23 offset:25088
    v_fma_f32 v190, v190, v33, v33
    v_fma_f32 v191, v191, v33, v33
    v_rcp_f32 v184, v184
    v_rcp_f32 v185, v185
    v_rcp_f32 v186, v186
    s_waitcnt lgkmcnt(4)
    v_mfma_f32_16x16x32_bf16 v[168:171], v[68:71], v[208:211], v[168:171]
    v_mfma_f32_16x16x32_bf16 v[168:171], v[52:55], v[216:219], v[168:171]
    v_rcp_f32 v187, v187
    v_rcp_f32 v188, v188
    v_rcp_f32 v189, v189
    v_rcp_f32 v190, v190
    v_rcp_f32 v191, v191
    buffer_load_dwordx4 v[132:135], v40, s[36:39], s77 offen sc1
    v_mfma_f32_16x16x32_bf16 v[172:175], v[68:71], v[212:215], v[172:175]
    v_mfma_f32_16x16x32_bf16 v[172:175], v[52:55], v[220:223], v[172:175]
    v_mul_f32 v152, v152, v184
    v_mul_f32 v153, v153, v185
    v_mul_f32 v154, v154, v186
    v_mul_f32 v155, v155, v187
    v_mul_f32 v156, v156, v188
    s_waitcnt lgkmcnt(0)
    v_mfma_f32_16x16x32_bf16 v[176:179], v[56:59], v[208:211], v[176:179]
    v_mfma_f32_16x16x32_bf16 v[176:179], v[60:63], v[216:219], v[176:179]
    v_mul_f32 v157, v157, v189
    v_mul_f32 v158, v158, v190
    v_mul_f32 v159, v159, v191
    v_cvt_pk_bf16_f32 v202, v152, v153
    v_cvt_pk_bf16_f32 v203, v154, v155
    v_mfma_f32_16x16x32_bf16 v[180:183], v[56:59], v[212:215], v[180:183]
    v_mfma_f32_16x16x32_bf16 v[180:183], v[60:63], v[220:223], v[180:183]
    v_cvt_pk_bf16_f32 v206, v156, v157
    v_cvt_pk_bf16_f32 v207, v158, v159
    buffer_store_dwordx4 v[200:203], v2, s[36:39], s72 offen offset:2048 sc1
    buffer_store_dwordx4 v[204:207], v28, s[36:39], s72 offen offset:2048 sc1
qa_kernel_F2S:
    s_waitcnt vmcnt(13)
    v_mov_b32 v12, 2
    buffer_store_dword v12, v36, s[36:39], 0 offen sc1
    v_mul_f32 v184, v34, v168
    v_mul_f32 v185, v34, v169
    v_mul_f32 v186, v34, v170
    v_mul_f32 v187, v34, v171
    v_mul_f32 v188, v35, v172
    v_mul_f32 v189, v35, v173
    v_mul_f32 v190, v35, v174
    v_mul_f32 v191, v35, v175
    v_exp_f32 v184, v184
    v_exp_f32 v185, v185
    v_exp_f32 v186, v186
    v_exp_f32 v187, v187
    v_exp_f32 v188, v188
    v_exp_f32 v189, v189
    v_exp_f32 v190, v190
    v_exp_f32 v191, v191
    v_mul_f32 v168, v168, v176
    v_mul_f32 v169, v169, v177
    v_mul_f32 v170, v170, v178
    v_mul_f32 v171, v171, v179
    v_mul_f32 v172, v172, v180
    v_mul_f32 v173, v173, v181
    v_mul_f32 v174, v174, v182
    v_mul_f32 v175, v175, v183
    v_fma_f32 v184, v184, v32, v32
    v_fma_f32 v185, v185, v32, v32
    v_fma_f32 v186, v186, v32, v32
    v_fma_f32 v187, v187, v32, v32
    v_fma_f32 v188, v188, v33, v33
    v_fma_f32 v189, v189, v33, v33
    v_fma_f32 v190, v190, v33, v33
    v_fma_f32 v191, v191, v33, v33
    v_rcp_f32 v184, v184
    v_rcp_f32 v185, v185
    v_rcp_f32 v186, v186
    v_rcp_f32 v187, v187
    v_rcp_f32 v188, v188
    v_rcp_f32 v189, v189
    v_rcp_f32 v190, v190
    v_rcp_f32 v191, v191
    v_mul_f32 v168, v168, v184
    v_mul_f32 v169, v169, v185
    v_mul_f32 v170, v170, v186
    v_mul_f32 v171, v171, v187
    v_mul_f32 v172, v172, v188
    v_mul_f32 v173, v173, v189
    v_mul_f32 v174, v174, v190
    v_mul_f32 v175, v175, v191
    v_cvt_pk_bf16_f32 v200, v168, v169
    v_cvt_pk_bf16_f32 v201, v170, v171
    v_cvt_pk_bf16_f32 v202, v172, v173
    v_cvt_pk_bf16_f32 v203, v174, v175
    s_nop 0
    v_permlane32_swap_b32 v200, v202
    v_permlane32_swap_b32 v201, v203
    buffer_store_dwordx4 v[200:203], v27, s[36:39], s73 offen sc1
    s_barrier
    ds_read_b64_tr_b16 v[208:209], v46 offset:0
    ds_read_b64_tr_b16 v[210:211], v46 offset:2048
    ds_read_b64_tr_b16 v[212:213], v47 offset:0
    ds_read_b64_tr_b16 v[214:215], v47 offset:2048
    ds_read_b64_tr_b16 v[216:217], v48 offset:0
    ds_read_b64_tr_b16 v[218:219], v48 offset:2048
    v_max3_u32 v3, v72, v73, v74
    v_max3_u32 v4, v75, v76, v77
    v_max3_u32 v3, v3, v78, v79
    v_max_u32 v3, v3, v4
    v_cmp_eq_u32 vcc, -1, v3
    s_cbranch_vccz qa_kernel_B0_G
qa_kernel_B0_R:
    s_mov_b32 s47, 29360128
    buffer_load_dwordx4 v[72:75], v39, s[36:39], s47 offen sc1
    buffer_load_dwordx4 v[76:79], v40, s[36:39], s47 offen sc1
    s_mov_b32 s47, 29364224
    buffer_load_dwordx4 v[80:83], v39, s[36:39], s47 offen sc1
    buffer_load_dwordx4 v[84:87], v40, s[36:39], s47 offen sc1
    s_mov_b32 s47, 29367296
    buffer_load_dwordx4 v[88:91], v39, s[36:39], s47 offen sc1
    buffer_load_dwordx4 v[92:95], v40, s[36:39], s47 offen sc1
    s_mov_b32 s47, 29371392
    buffer_load_dwordx4 v[96:99], v39, s[36:39], s47 offen sc1
    buffer_load_dwordx4 v[100:103], v40, s[36:39], s47 offen sc1
    s_mov_b32 s47, 29374464
    buffer_load_dwordx4 v[104:107], v39, s[36:39], s47 offen sc1
    buffer_load_dwordx4 v[108:111], v40, s[36:39], s47 offen sc1
    s_mov_b32 s47, 29378560
    buffer_load_dwordx4 v[112:115], v39, s[36:39], s47 offen sc1
    buffer_load_dwordx4 v[116:119], v40, s[36:39], s47 offen sc1
    s_mov_b32 s47, 29381632
    buffer_load_dwordx4 v[120:123], v39, s[36:39], s47 offen sc1
    buffer_load_dwordx4 v[124:127], v40, s[36:39], s47 offen sc1
    s_mov_b32 s47, 29385728
    buffer_load_dwordx4 v[128:131], v39, s[36:39], s47 offen sc1
    buffer_load_dwordx4 v[132:135], v40, s[36:39], s47 offen sc1
    s_waitcnt vmcnt(0)
    v_max3_u32 v3, v72, v73, v74
    v_max3_u32 v4, v75, v76, v77
    v_max3_u32 v3, v3, v78, v79
    v_max_u32 v3, v3, v4
    v_cmp_eq_u32 vcc, -1, v3
    s_sub_u32 s62, s62, 1
    s_cselect_b64 vcc, 0, vcc
    s_cselect_b32 s62, 0, s62
    s_cbranch_vccnz qa_kernel_B0_R
qa_kernel_B0_G:
    s_waitcnt lgkmcnt(4)
    v_mfma_f32_16x16x32_bf16 v[136:139], v[208:211], v[72:75], 0
    ds_read_b64_tr_b16 v[220:221], v49 offset:0
    v_mfma_f32_16x16x32_bf16 v[168:171], v[208:211], v[76:79], 0
    ds_read_b64_tr_b16 v[222:223], v49 offset:2048
    s_setprio 3
    s_add_u32 m0, s54, 0
    s_mov_b32 s74, 917504
    buffer_load_dwordx4 v37, s[28:31], s74 offen lds
    s_waitcnt lgkmcnt(4)
    v_mfma_f32_16x16x32_bf16 v[140:143], v[212:215], v[72:75], 0
    ds_read_b64_tr_b16 v[208:209], v46 offset:4096
    v_mfma_f32_16x16x32_bf16 v[172:175], v[212:215], v[76:79], 0
    ds_read_b64_tr_b16 v[210:211], v46 offset:6144
    s_setprio 2
    s_waitcnt lgkmcnt(4)
    v_mfma_f32_16x16x32_bf16 v[144:147], v[216:219], v[72:75], 0
    ds_read_b64_tr_b16 v[212:213], v47 offset:4096
    v_mfma_f32_16x16x32_bf16 v[176:179], v[216:219], v[76:79], 0
    ds_read_b64_tr_b16 v[214:215], v47 offset:6144
    s_setprio 1
    s_add_u32 m0, s54, 4096
    s_mov_b32 s74, 917504
    buffer_load_dwordx4 v38, s[28:31], s74 offen lds
    s_waitcnt lgkmcnt(4)
    v_mfma_f32_16x16x32_bf16 v[148:151], v[220:223], v[72:75], 0
    ds_read_b64_tr_b16 v[216:217], v48 offset:4096
    v_mfma_f32_16x16x32_bf16 v[180:183], v[220:223], v[76:79], 0
    ds_read_b64_tr_b16 v[218:219], v48 offset:6144
    s_waitcnt lgkmcnt(4)
    v_mfma_f32_16x16x32_bf16 v[152:155], v[208:211], v[72:75], 0
    ds_read_b64_tr_b16 v[220:221], v49 offset:4096
    v_mfma_f32_16x16x32_bf16 v[184:187], v[208:211], v[76:79], 0
    ds_read_b64_tr_b16 v[222:223], v49 offset:6144
    s_setprio 0
    s_add_u32 m0, s54, 16384
    s_mov_b32 s74, 1179648
    buffer_load_dwordx4 v37, s[28:31], s74 offen lds
    s_waitcnt lgkmcnt(4)
    v_mfma_f32_16x16x32_bf16 v[156:159], v[212:215], v[72:75], 0
    s_barrier
    ds_read_b64_tr_b16 v[208:209], v46 offset:16384
    v_mfma_f32_16x16x32_bf16 v[188:191], v[212:215], v[76:79], 0
    ds_read_b64_tr_b16 v[210:211], v46 offset:18432
    s_setprio 3
    s_waitcnt lgkmcnt(4)
    v_mfma_f32_16x16x32_bf16 v[160:163], v[216:219], v[72:75], 0
    ds_read_b64_tr_b16 v[212:213], v47 offset:16384
    v_mfma_f32_16x16x32_bf16 v[192:195], v[216:219], v[76:79], 0
    ds_read_b64_tr_b16 v[214:215], v47 offset:18432
    s_add_u32 m0, s54, 20480
    s_mov_b32 s74, 1179648
    buffer_load_dwordx4 v38, s[28:31], s74 offen lds
    s_waitcnt lgkmcnt(4)
    v_mfma_f32_16x16x32_bf16 v[164:167], v[220:223], v[72:75], 0
    ds_read_b64_tr_b16 v[216:217], v48 offset:16384
    v_mfma_f32_16x16x32_bf16 v[196:199], v[220:223], v[76:79], 0
    ds_read_b64_tr_b16 v[218:219], v48 offset:18432
    s_setprio 2
    v_max3_u32 v3, v80, v81, v82
    v_max3_u32 v4, v83, v84, v85
    v_max3_u32 v3, v3, v86, v87
    v_max_u32 v3, v3, v4
    v_cmp_eq_u32 vcc, -1, v3
    s_cbranch_vccnz qa_kernel_B1_R
qa_kernel_B1_G:
    s_waitcnt lgkmcnt(4)
    v_mfma_f32_16x16x32_bf16 v[136:139], v[208:211], v[80:83], v[136:139]
    ds_read_b64_tr_b16 v[220:221], v49 offset:16384
    v_mfma_f32_16x16x32_bf16 v[168:171], v[208:211], v[84:87], v[168:171]
    ds_read_b64_tr_b16 v[222:223], v49 offset:18432
    s_add_u32 m0, s54, 32768
    s_mov_b32 s74, 1376256
    buffer_load_dwordx4 v37, s[28:31], s74 offen lds
    s_waitcnt lgkmcnt(4)
    v_mfma_f32_16x16x32_bf16 v[140:143], v[212:215], v[80:83], v[140:143]
    ds_read_b64_tr_b16 v[208:209], v46 offset:20480
    v_mfma_f32_16x16x32_bf16 v[172:175], v[212:215], v[84:87], v[172:175]
    ds_read_b64_tr_b16 v[210:211], v46 offset:22528
    s_setprio 1
    s_waitcnt lgkmcnt(4)
    v_mfma_f32_16x16x32_bf16 v[144:147], v[216:219], v[80:83], v[144:147]
    ds_read_b64_tr_b16 v[212:213], v47 offset:20480
    v_mfma_f32_16x16x32_bf16 v[176:179], v[216:219], v[84:87], v[176:179]
    ds_read_b64_tr_b16 v[214:215], v47 offset:22528
    s_add_u32 m0, s54, 36864
    s_mov_b32 s74, 1376256
    buffer_load_dwordx4 v38, s[28:31], s74 offen lds
    s_waitcnt lgkmcnt(4)
    v_mfma_f32_16x16x32_bf16 v[148:151], v[220:223], v[80:83], v[148:151]
    ds_read_b64_tr_b16 v[216:217], v48 offset:20480
    v_mfma_f32_16x16x32_bf16 v[180:183], v[220:223], v[84:87], v[180:183]
    ds_read_b64_tr_b16 v[218:219], v48 offset:22528
    s_setprio 0
    s_waitcnt lgkmcnt(4)
    v_mfma_f32_16x16x32_bf16 v[152:155], v[208:211], v[80:83], v[152:155]
    ds_read_b64_tr_b16 v[220:221], v49 offset:20480
    v_mfma_f32_16x16x32_bf16 v[184:187], v[208:211], v[84:87], v[184:187]
    ds_read_b64_tr_b16 v[222:223], v49 offset:22528
    s_add_u32 m0, s54, 49152
    s_mov_b32 s74, 1638400
    buffer_load_dwordx4 v37, s[28:31], s74 offen lds
    s_waitcnt lgkmcnt(4)
    v_mfma_f32_16x16x32_bf16 v[156:159], v[212:215], v[80:83], v[156:159]
    s_barrier
    ds_read_b64_tr_b16 v[208:209], v46 offset:32768
    v_mfma_f32_16x16x32_bf16 v[188:191], v[212:215], v[84:87], v[188:191]
    ds_read_b64_tr_b16 v[210:211], v46 offset:34816
    s_setprio 3
    s_waitcnt lgkmcnt(4)
    v_mfma_f32_16x16x32_bf16 v[160:163], v[216:219], v[80:83], v[160:163]
    ds_read_b64_tr_b16 v[212:213], v47 offset:32768
    v_mfma_f32_16x16x32_bf16 v[192:195], v[216:219], v[84:87], v[192:195]
    ds_read_b64_tr_b16 v[214:215], v47 offset:34816
    s_add_u32 m0, s54, 53248
    s_mov_b32 s74, 1638400
    buffer_load_dwordx4 v38, s[28:31], s74 offen lds
    s_waitcnt lgkmcnt(4)
    v_mfma_f32_16x16x32_bf16 v[164:167], v[220:223], v[80:83], v[164:167]
    ds_read_b64_tr_b16 v[216:217], v48 offset:32768
    v_mfma_f32_16x16x32_bf16 v[196:199], v[220:223], v[84:87], v[196:199]
    ds_read_b64_tr_b16 v[218:219], v48 offset:34816
    s_setprio 2
    s_waitcnt vmcnt(22)
    v_max3_u32 v3, v88, v89, v90
    v_max3_u32 v4, v91, v92, v93
    v_max3_u32 v3, v3, v94, v95
    v_max_u32 v3, v3, v4
    v_cmp_eq_u32 vcc, -1, v3
    s_cbranch_vccnz qa_kernel_B2_R
qa_kernel_B2_G:
    s_waitcnt lgkmcnt(4)
    v_mfma_f32_16x16x32_bf16 v[136:139], v[208:211], v[88:91], v[136:139]
    ds_read_b64_tr_b16 v[220:221], v49 offset:32768
    v_mfma_f32_16x16x32_bf16 v[168:171], v[208:211], v[92:95], v[168:171]
    ds_read_b64_tr_b16 v[222:223], v49 offset:34816
    s_add_u32 m0, s54, 98304
    s_mov_b32 s74, 65536
    buffer_load_dwordx4 v37, s[28:31], s74 offen lds
    s_waitcnt lgkmcnt(4)
    v_mfma_f32_16x16x32_bf16 v[140:143], v[212:215], v[88:91], v[140:143]
    ds_read_b64_tr_b16 v[208:209], v46 offset:36864
    v_mfma_f32_16x16x32_bf16 v[172:175], v[212:215], v[92:95], v[172:175]
    ds_read_b64_tr_b16 v[210:211], v46 offset:38912
    s_setprio 1
    s_waitcnt lgkmcnt(4)
    v_mfma_f32_16x16x32_bf16 v[144:147], v[216:219], v[88:91], v[144:147]
    ds_read_b64_tr_b16 v[212:213], v47 offset:36864
    v_mfma_f32_16x16x32_bf16 v[176:179], v[216:219], v[92:95], v[176:179]
    ds_read_b64_tr_b16 v[214:215], v47 offset:38912
    s_add_u32 m0, s54, 102400
    s_mov_b32 s74, 65536
    buffer_load_dwordx4 v38, s[28:31], s74 offen lds
    s_waitcnt lgkmcnt(4)
    v_mfma_f32_16x16x32_bf16 v[148:151], v[220:223], v[88:91], v[148:151]
    ds_read_b64_tr_b16 v[216:217], v48 offset:36864
    v_mfma_f32_16x16x32_bf16 v[180:183], v[220:223], v[92:95], v[180:183]
    ds_read_b64_tr_b16 v[218:219], v48 offset:38912
    s_setprio 0
    s_waitcnt lgkmcnt(4)
    v_mfma_f32_16x16x32_bf16 v[152:155], v[208:211], v[88:91], v[152:155]
    ds_read_b64_tr_b16 v[220:221], v49 offset:36864
    v_mfma_f32_16x16x32_bf16 v[184:187], v[208:211], v[92:95], v[184:187]
    ds_read_b64_tr_b16 v[222:223], v49 offset:38912
    s_waitcnt vmcnt(10)
    v_mov_b32 v12, 3
    buffer_store_dword v12, v36, s[36:39], 0 offen sc1
    s_waitcnt lgkmcnt(4)
    v_mfma_f32_16x16x32_bf16 v[156:159], v[212:215], v[88:91], v[156:159]
    s_barrier
    ds_read_b64_tr_b16 v[208:209], v46 offset:49152
    v_mfma_f32_16x16x32_bf16 v[188:191], v[212:215], v[92:95], v[188:191]
    ds_read_b64_tr_b16 v[210:211], v46 offset:51200
    s_setprio 3
    s_add_u32 m0, s54, 114688
    s_mov_b32 s74, 327680
    buffer_load_dwordx4 v37, s[28:31], s74 offen lds
    s_waitcnt lgkmcnt(4)
    v_mfma_f32_16x16x32_bf16 v[160:163], v[216:219], v[88:91], v[160:163]
    ds_read_b64_tr_b16 v[212:213], v47 offset:49152
    v_mfma_f32_16x16x32_bf16 v[192:195], v[216:219], v[92:95], v[192:195]
    ds_read_b64_tr_b16 v[214:215], v47 offset:51200
    s_lshl_b32 s47, s24, 12
    s_add_u32 s47, s47, 65536
    v_add_u32 v248, s47, v2
    v_xor_b32 v249, 16384, v248
    v_subrev_u32 v250, 65536, v248
    v_xor_b32 v251, 16384, v250
    s_waitcnt lgkmcnt(4)
    v_mfma_f32_16x16x32_bf16 v[164:167], v[220:223], v[88:91], v[164:167]
    ds_read_b64_tr_b16 v[216:217], v48 offset:49152
    v_mfma_f32_16x16x32_bf16 v[196:199], v[220:223], v[92:95], v[196:199]
    ds_read_b64_tr_b16 v[218:219], v48 offset:51200
    s_setprio 2
    s_add_u32 m0, s54, 118784
    s_mov_b32 s74, 327680
    buffer_load_dwordx4 v38, s[28:31], s74 offen lds
    v_max3_u32 v3, v96, v97, v98
    v_max3_u32 v4, v99, v100, v101
    v_max3_u32 v3, v3, v102, v103
    v_max_u32 v3, v3, v4
    v_cmp_eq_u32 vcc, -1, v3
    s_cbranch_vccnz qa_kernel_B3_R
qa_kernel_B3_G:
    s_waitcnt lgkmcnt(4)
    v_mfma_f32_16x16x32_bf16 v[136:139], v[208:211], v[96:99], v[136:139]
    ds_read_b64_tr_b16 v[220:221], v49 offset:49152
    v_mfma_f32_16x16x32_bf16 v[168:171], v[208:211], v[100:103], v[168:171]
    ds_read_b64_tr_b16 v[222:223], v49 offset:51200
    s_waitcnt lgkmcnt(4)
    v_mfma_f32_16x16x32_bf16 v[140:143], v[212:215], v[96:99], v[140:143]
    ds_read_b64_tr_b16 v[208:209], v46 offset:53248
    v_mfma_f32_16x16x32_bf16 v[172:175], v[212:215], v[100:103], v[172:175]
    ds_read_b64_tr_b16 v[210:211], v46 offset:55296
    s_setprio 1
    s_waitcnt lgkmcnt(4)
    v_mfma_f32_16x16x32_bf16 v[144:147], v[216:219], v[96:99], v[144:147]
    ds_read_b64_tr_b16 v[212:213], v47 offset:53248
    v_mfma_f32_16x16x32_bf16 v[176:179], v[216:219], v[100:103], v[176:179]
    ds_read_b64_tr_b16 v[214:215], v47 offset:55296
    s_waitcnt lgkmcnt(4)
    v_mfma_f32_16x16x32_bf16 v[148:151], v[220:223], v[96:99], v[148:151]
    ds_read_b64_tr_b16 v[216:217], v48 offset:53248
    v_mfma_f32_16x16x32_bf16 v[180:183], v[220:223], v[100:103], v[180:183]
    ds_read_b64_tr_b16 v[218:219], v48 offset:55296
    s_setprio 0
    s_waitcnt lgkmcnt(4)
    v_mfma_f32_16x16x32_bf16 v[152:155], v[208:211], v[96:99], v[152:155]
    ds_read_b64_tr_b16 v[220:221], v49 offset:53248
    v_mfma_f32_16x16x32_bf16 v[184:187], v[208:211], v[100:103], v[184:187]
    ds_read_b64_tr_b16 v[222:223], v49 offset:55296
    s_waitcnt lgkmcnt(4)
    v_mfma_f32_16x16x32_bf16 v[156:159], v[212:215], v[96:99], v[156:159]
    s_waitcnt vmcnt(11)
    s_barrier
    ds_read_b64_tr_b16 v[208:209], v42 offset:0
    v_mfma_f32_16x16x32_bf16 v[188:191], v[212:215], v[100:103], v[188:191]
    ds_read_b64_tr_b16 v[210:211], v42 offset:2048
    s_setprio 3
    s_add_u32 m0, s54, 131072
    s_mov_b32 s74, 524288
    buffer_load_dwordx4 v37, s[28:31], s74 offen lds
    buffer_load_dword v19, v41, s[36:39], 0 offen sc1
    s_waitcnt lgkmcnt(4)
    v_mfma_f32_16x16x32_bf16 v[160:163], v[216:219], v[96:99], v[160:163]
    ds_read_b64_tr_b16 v[212:213], v43 offset:0
    v_mfma_f32_16x16x32_bf16 v[192:195], v[216:219], v[100:103], v[192:195]
    ds_read_b64_tr_b16 v[214:215], v43 offset:2048
    s_waitcnt lgkmcnt(4)
    v_mfma_f32_16x16x32_bf16 v[164:167], v[220:223], v[96:99], v[164:167]
    ds_read_b64_tr_b16 v[216:217], v44 offset:0
    v_mfma_f32_16x16x32_bf16 v[196:199], v[220:223], v[100:103], v[196:199]
    ds_read_b64_tr_b16 v[218:219], v44 offset:2048
    s_setprio 2
    s_add_u32 m0, s54, 135168
    s_mov_b32 s74, 524288
    buffer_load_dwordx4 v38, s[28:31], s74 offen lds
    v_max3_u32 v3, v104, v105, v106
    v_max3_u32 v4, v107, v108, v109
    v_max3_u32 v3, v3, v110, v111
    v_max_u32 v3, v3, v4
    v_cmp_eq_u32 vcc, -1, v3
    s_cbranch_vccnz qa_kernel_B4_R
qa_kernel_B4_G:
    s_waitcnt lgkmcnt(4)
    v_mfma_f32_16x16x32_bf16 v[136:139], v[208:211], v[104:107], v[136:139]
    ds_read_b64_tr_b16 v[220:221], v45 offset:0
    v_mfma_f32_16x16x32_bf16 v[168:171], v[208:211], v[108:111], v[168:171]
    ds_read_b64_tr_b16 v[222:223], v45 offset:2048
    s_waitcnt lgkmcnt(4)
    v_mfma_f32_16x16x32_bf16 v[140:143], v[212:215], v[104:107], v[140:143]
    ds_read_b64_tr_b16 v[208:209], v42 offset:4096
    v_mfma_f32_16x16x32_bf16 v[172:175], v[212:215], v[108:111], v[172:175]
    ds_read_b64_tr_b16 v[210:211], v42 offset:6144
    s_setprio 1
    s_waitcnt lgkmcnt(4)
    v_mfma_f32_16x16x32_bf16 v[144:147], v[216:219], v[104:107], v[144:147]
    ds_read_b64_tr_b16 v[212:213], v43 offset:4096
    v_mfma_f32_16x16x32_bf16 v[176:179], v[216:219], v[108:111], v[176:179]
    ds_read_b64_tr_b16 v[214:215], v43 offset:6144
    s_waitcnt lgkmcnt(4)
    v_mfma_f32_16x16x32_bf16 v[148:151], v[220:223], v[104:107], v[148:151]
    ds_read_b64_tr_b16 v[216:217], v44 offset:4096
    v_mfma_f32_16x16x32_bf16 v[180:183], v[220:223], v[108:111], v[180:183]
    ds_read_b64_tr_b16 v[218:219], v44 offset:6144
    s_setprio 0
    s_waitcnt lgkmcnt(4)
    v_mfma_f32_16x16x32_bf16 v[152:155], v[208:211], v[104:107], v[152:155]
    ds_read_b64_tr_b16 v[220:221], v45 offset:4096
    v_mfma_f32_16x16x32_bf16 v[184:187], v[208:211], v[108:111], v[184:187]
    ds_read_b64_tr_b16 v[222:223], v45 offset:6144
    s_waitcnt lgkmcnt(4)
    v_mfma_f32_16x16x32_bf16 v[156:159], v[212:215], v[104:107], v[156:159]
    s_waitcnt vmcnt(12)
    s_barrier
    ds_read_b64_tr_b16 v[208:209], v42 offset:16384
    v_mfma_f32_16x16x32_bf16 v[188:191], v[212:215], v[108:111], v[188:191]
    ds_read_b64_tr_b16 v[210:211], v42 offset:18432
    s_setprio 3
    s_add_u32 m0, s54, 147456
    s_mov_b32 s74, 786432
    buffer_load_dwordx4 v37, s[28:31], s74 offen lds
    s_waitcnt lgkmcnt(4)
    v_mfma_f32_16x16x32_bf16 v[160:163], v[216:219], v[104:107], v[160:163]
    ds_read_b64_tr_b16 v[212:213], v43 offset:16384
    v_mfma_f32_16x16x32_bf16 v[192:195], v[216:219], v[108:111], v[192:195]
    ds_read_b64_tr_b16 v[214:215], v43 offset:18432
    s_waitcnt lgkmcnt(4)
    v_mfma_f32_16x16x32_bf16 v[164:167], v[220:223], v[104:107], v[164:167]
    ds_read_b64_tr_b16 v[216:217], v44 offset:16384
    v_mfma_f32_16x16x32_bf16 v[196:199], v[220:223], v[108:111], v[196:199]
    ds_read_b64_tr_b16 v[218:219], v44 offset:18432
    s_setprio 2
    s_waitcnt vmcnt(2)
    v_cmp_gt_i32 vcc, 2, v19
    s_cbranch_vccz qa_kernel_GT1_G
qa_kernel_GT1:
    buffer_load_dword v19, v41, s[36:39], 0 offen sc1
    s_waitcnt vmcnt(0)
    v_cmp_gt_i32 vcc, 2, v19
    s_sub_u32 s62, s62, 1
    s_cselect_b64 vcc, 0, vcc
    s_cselect_b32 s62, 0, s62
    s_cbranch_vccnz qa_kernel_GT1
qa_kernel_GT1_G:
    s_mov_b32 s77, 29361152
    buffer_load_dwordx4 v[72:75], v39, s[36:39], s77 offen sc1
    v_max3_u32 v3, v112, v113, v114
    v_max3_u32 v4, v115, v116, v117
    v_max3_u32 v3, v3, v118, v119
    v_max_u32 v3, v3, v4
    v_cmp_eq_u32 vcc, -1, v3
    s_cbranch_vccnz qa_kernel_B5_R
qa_kernel_B5_G:
    s_waitcnt lgkmcnt(4)
    v_mfma_f32_16x16x32_bf16 v[136:139], v[208:211], v[112:115], v[136:139]
    ds_read_b64_tr_b16 v[220:221], v45 offset:16384
    v_mfma_f32_16x16x32_bf16 v[168:171], v[208:211], v[116:119], v[168:171]
    ds_read_b64_tr_b16 v[222:223], v45 offset:18432
    s_waitcnt lgkmcnt(4)
    v_mfma_f32_16x16x32_bf16 v[140:143], v[212:215], v[112:115], v[140:143]
    ds_read_b64_tr_b16 v[208:209], v42 offset:20480
    v_mfma_f32_16x16x32_bf16 v[172:175], v[212:215], v[116:119], v[172:175]
    ds_read_b64_tr_b16 v[210:211], v42 offset:22528
    s_setprio 1
    buffer_load_dwordx4 v[76:79], v40, s[36:39], s77 offen sc1
    s_waitcnt lgkmcnt(4)
    v_mfma_f32_16x16x32_bf16 v[144:147], v[216:219], v[112:115], v[144:147]
    ds_read_b64_tr_b16 v[212:213], v43 offset:20480
    v_mfma_f32_16x16x32_bf16 v[176:179], v[216:219], v[116:119], v[176:179]
    ds_read_b64_tr_b16 v[214:215], v43 offset:22528
    s_waitcnt lgkmcnt(4)
    v_mfma_f32_16x16x32_bf16 v[148:151], v[220:223], v[112:115], v[148:151]
    ds_read_b64_tr_b16 v[216:217], v44 offset:20480
    v_mfma_f32_16x16x32_bf16 v[180:183], v[220:223], v[116:119], v[180:183]
    ds_read_b64_tr_b16 v[218:219], v44 offset:22528
    s_setprio 0
    s_mov_b32 s77, 29365248
    buffer_load_dwordx4 v[80:83], v39, s[36:39], s77 offen sc1
    s_waitcnt lgkmcnt(4)
    v_mfma_f32_16x16x32_bf16 v[152:155], v[208:211], v[112:115], v[152:155]
    ds_read_b64_tr_b16 v[220:221], v45 offset:20480
    v_mfma_f32_16x16x32_bf16 v[184:187], v[208:211], v[116:119], v[184:187]
    ds_read_b64_tr_b16 v[222:223], v45 offset:22528
    s_waitcnt lgkmcnt(4)
    v_mfma_f32_16x16x32_bf16 v[156:159], v[212:215], v[112:115], v[156:159]
    s_barrier
    ds_read_b64_tr_b16 v[208:209], v42 offset:32768
    v_mfma_f32_16x16x32_bf16 v[188:191], v[212:215], v[116:119], v[188:191]
    ds_read_b64_tr_b16 v[210:211], v42 offset:34816
    s_setprio 3
    buffer_load_dwordx4 v[84:87], v40, s[36:39], s77 offen sc1
    s_waitcnt lgkmcnt(4)
    v_mfma_f32_16x16x32_bf16 v[160:163], v[216:219], v[112:115], v[160:163]
    ds_read_b64_tr_b16 v[212:213], v43 offset:32768
    v_mfma_f32_16x16x32_bf16 v[192:195], v[216:219], v[116:119], v[192:195]
    ds_read_b64_tr_b16 v[214:215], v43 offset:34816
    s_waitcnt lgkmcnt(4)
    v_mfma_f32_16x16x32_bf16 v[164:167], v[220:223], v[112:115], v[164:167]
    ds_read_b64_tr_b16 v[216:217], v44 offset:32768
    v_mfma_f32_16x16x32_bf16 v[196:199], v[220:223], v[116:119], v[196:199]
    ds_read_b64_tr_b16 v[218:219], v44 offset:34816
    s_setprio 2
    s_mov_b32 s77, 29368320
    buffer_load_dwordx4 v[88:91], v39, s[36:39], s77 offen sc1
    v_max3_u32 v3, v120, v121, v122
    v_max3_u32 v4, v123, v124, v125
    v_max3_u32 v3, v3, v126, v127
    v_max_u32 v3, v3, v4
    v_cmp_eq_u32 vcc, -1, v3
    s_cbranch_vccnz qa_kernel_B6_R
qa_kernel_B6_G:
    s_waitcnt lgkmcnt(4)
    v_mfma_f32_16x16x32_bf16 v[136:139], v[208:211], v[120:123], v[136:139]
    ds_read_b64_tr_b16 v[220:221], v45 offset:32768
    v_mfma_f32_16x16x32_bf16 v[168:171], v[208:211], v[124:127], v[168:171]
    ds_read_b64_tr_b16 v[222:223], v45 offset:34816
    s_waitcnt lgkmcnt(4)
    v_mfma_f32_16x16x32_bf16 v[140:143], v[212:215], v[120:123], v[140:143]
    ds_read_b64_tr_b16 v[208:209], v42 offset:36864
    v_mfma_f32_16x16x32_bf16 v[172:175], v[212:215], v[124:127], v[172:175]
    ds_read_b64_tr_b16 v[210:211], v42 offset:38912
    s_setprio 1
    buffer_load_dwordx4 v[92:95], v40, s[36:39], s77 offen sc1
    s_waitcnt lgkmcnt(4)
    v_mfma_f32_16x16x32_bf16 v[144:147], v[216:219], v[120:123], v[144:147]
    ds_read_b64_tr_b16 v[212:213], v43 offset:36864
    v_mfma_f32_16x16x32_bf16 v[176:179], v[216:219], v[124:127], v[176:179]
    ds_read_b64_tr_b16 v[214:215], v43 offset:38912
    s_waitcnt lgkmcnt(4)
    v_mfma_f32_16x16x32_bf16 v[148:151], v[220:223], v[120:123], v[148:151]
    ds_read_b64_tr_b16 v[216:217], v44 offset:36864
    v_mfma_f32_16x16x32_bf16 v[180:183], v[220:223], v[124:127], v[180:183]
    ds_read_b64_tr_b16 v[218:219], v44 offset:38912
    s_setprio 0
    s_add_u32 m0, s54, 151552
    s_mov_b32 s74, 786432
    buffer_load_dwordx4 v38, s[28:31], s74 offen lds
    s_waitcnt lgkmcnt(4)
    v_mfma_f32_16x16x32_bf16 v[152:155], v[208:211], v[120:123], v[152:155]
    ds_read_b64_tr_b16 v[220:221], v45 offset:36864
    v_mfma_f32_16x16x32_bf16 v[184:187], v[208:211], v[124:127], v[184:187]
    ds_read_b64_tr_b16 v[222:223], v45 offset:38912
    s_waitcnt lgkmcnt(4)
    v_mfma_f32_16x16x32_bf16 v[156:159], v[212:215], v[120:123], v[156:159]
    s_barrier
qa_kernel_WS1_12:
    s_cbranch_execz qa_kernel_WRET1
    ds_read_b64_tr_b16 v[208:209], v42 offset:49152
    v_mfma_f32_16x16x32_bf16 v[188:191], v[212:215], v[124:127], v[188:191]
    ds_read_b64_tr_b16 v[210:211], v42 offset:51200
    s_setprio 3
    s_mov_b32 s77, 29372416
    buffer_load_dwordx4 v[96:99], v39, s[36:39], s77 offen sc1
    s_waitcnt lgkmcnt(4)
    v_mfma_f32_16x16x32_bf16 v[160:163], v[216:219], v[120:123], v[160:163]
    ds_read_b64_tr_b16 v[212:213], v43 offset:49152
    v_mfma_f32_16x16x32_bf16 v[192:195], v[216:219], v[124:127], v[192:195]
    ds_read_b64_tr_b16 v[214:215], v43 offset:51200
    s_waitcnt lgkmcnt(4)
    v_mfma_f32_16x16x32_bf16 v[164:167], v[220:223], v[120:123], v[164:167]
    ds_read_b64_tr_b16 v[216:217], v44 offset:49152
    v_mfma_f32_16x16x32_bf16 v[196:199], v[220:223], v[124:127], v[196:199]
    ds_read_b64_tr_b16 v[218:219], v44 offset:51200
    s_setprio 2
    buffer_load_dwordx4 v[100:103], v40, s[36:39], s77 offen sc1
    v_max3_u32 v3, v128, v129, v130
    v_max3_u32 v4, v131, v132, v133
    v_max3_u32 v3, v3, v134, v135
    v_max_u32 v3, v3, v4
    v_cmp_eq_u32 vcc, -1, v3
    s_cbranch_vccnz qa_kernel_B7_R
qa_kernel_B7_G:
    s_waitcnt lgkmcnt(4)
    v_mfma_f32_16x16x32_bf16 v[136:139], v[208:211], v[128:131], v[136:139]
    ds_read_b64_tr_b16 v[220:221], v45 offset:49152
    v_mfma_f32_16x16x32_bf16 v[168:171], v[208:211], v[132:135], v[168:171]
    ds_read_b64_tr_b16 v[222:223], v45 offset:51200
    s_waitcnt lgkmcnt(4)
    v_mfma_f32_16x16x32_bf16 v[140:143], v[212:215], v[128:131], v[140:143]
    ds_read_b64_tr_b16 v[208:209], v42 offset:53248
    v_mfma_f32_16x16x32_bf16 v[172:175], v[212:215], v[132:135], v[172:175]
    ds_read_b64_tr_b16 v[210:211], v42 offset:55296
    s_setprio 1
    s_add_u32 m0, s54, 0
    s_mov_b32 s74, 983040
    buffer_load_dwordx4 v37, s[28:31], s74 offen lds
    s_waitcnt lgkmcnt(4)
    v_mfma_f32_16x16x32_bf16 v[144:147], v[216:219], v[128:131], v[144:147]
    ds_read_b64_tr_b16 v[212:213], v43 offset:53248
    v_mfma_f32_16x16x32_bf16 v[176:179], v[216:219], v[132:135], v[176:179]
    ds_read_b64_tr_b16 v[214:215], v43 offset:55296
    s_waitcnt lgkmcnt(4)
    v_mfma_f32_16x16x32_bf16 v[148:151], v[220:223], v[128:131], v[148:151]
    ds_read_b64_tr_b16 v[216:217], v44 offset:53248
    v_mfma_f32_16x16x32_bf16 v[180:183], v[220:223], v[132:135], v[180:183]
    ds_read_b64_tr_b16 v[218:219], v44 offset:55296
    s_setprio 0
    s_add_u32 m0, s54, 4096
    s_mov_b32 s74, 983040
    buffer_load_dwordx4 v38, s[28:31], s74 offen lds
    s_waitcnt lgkmcnt(4)
    v_mfma_f32_16x16x32_bf16 v[152:155], v[208:211], v[128:131], v[152:155]
    ds_read_b64_tr_b16 v[220:221], v45 offset:53248
    v_mfma_f32_16x16x32_bf16 v[184:187], v[208:211], v[132:135], v[184:187]
    ds_read_b64_tr_b16 v[222:223], v45 offset:55296
    s_waitcnt lgkmcnt(4)
    v_mfma_f32_16x16x32_bf16 v[156:159], v[212:215], v[128:131], v[156:159]
    s_barrier
    ds_read_b64_tr_b16 v[208:209], v46 offset:0
    v_mfma_f32_16x16x32_bf16 v[188:191], v[212:215], v[132:135], v[188:191]
    ds_read_b64_tr_b16 v[210:211], v46 offset:2048
    s_setprio 3
    s_mov_b32 s77, 29375488
    buffer_load_dwordx4 v[104:107], v39, s[36:39], s77 offen sc1
    s_waitcnt lgkmcnt(4)
    v_mfma_f32_16x16x32_bf16 v[160:163], v[216:219], v[128:131], v[160:163]
    ds_read_b64_tr_b16 v[212:213], v47 offset:0
    v_mfma_f32_16x16x32_bf16 v[192:195], v[216:219], v[132:135], v[192:195]
    ds_read_b64_tr_b16 v[214:215], v47 offset:2048
    s_waitcnt lgkmcnt(4)
    v_mfma_f32_16x16x32_bf16 v[164:167], v[220:223], v[128:131], v[164:167]
    ds_read_b64_tr_b16 v[216:217], v48 offset:0
    v_mfma_f32_16x16x32_bf16 v[196:199], v[220:223], v[132:135], v[196:199]
    ds_read_b64_tr_b16 v[218:219], v48 offset:2048
    s_setprio 2
    buffer_load_dwordx4 v[108:111], v40, s[36:39], s77 offen sc1
    s_waitcnt vmcnt(11)
    s_waitcnt lgkmcnt(4)
    v_mfma_f32_16x16x32_bf16 v[136:139], v[208:211], v[72:75], v[136:139]
    ds_read_b64_tr_b16 v[220:221], v49 offset:0
    v_mfma_f32_16x16x32_bf16 v[168:171], v[208:211], v[76:79], v[168:171]
    ds_read_b64_tr_b16 v[222:223], v49 offset:2048
    buffer_load_dword v19, v41, s[36:39], 0 offen sc1
    s_waitcnt lgkmcnt(4)
    v_mfma_f32_16x16x32_bf16 v[140:143], v[212:215], v[72:75], v[140:143]
    ds_read_b64_tr_b16 v[208:209], v46 offset:4096
    v_mfma_f32_16x16x32_bf16 v[172:175], v[212:215], v[76:79], v[172:175]
    ds_read_b64_tr_b16 v[210:211], v46 offset:6144
    s_setprio 1
    s_add_u32 m0, s54, 16384
    s_mov_b32 s74, 1245184
    buffer_load_dwordx4 v37, s[28:31], s74 offen lds
    s_waitcnt lgkmcnt(4)
    v_mfma_f32_16x16x32_bf16 v[144:147], v[216:219], v[72:75], v[144:147]
    ds_read_b64_tr_b16 v[212:213], v47 offset:4096
    v_mfma_f32_16x16x32_bf16 v[176:179], v[216:219], v[76:79], v[176:179]
    ds_read_b64_tr_b16 v[214:215], v47 offset:6144
    s_waitcnt lgkmcnt(4)
    v_mfma_f32_16x16x32_bf16 v[148:151], v[220:223], v[72:75], v[148:151]
    ds_read_b64_tr_b16 v[216:217], v48 offset:4096
    v_mfma_f32_16x16x32_bf16 v[180:183], v[220:223], v[76:79], v[180:183]
    ds_read_b64_tr_b16 v[218:219], v48 offset:6144
    s_setprio 0
    s_add_u32 m0, s54, 20480
    s_mov_b32 s74, 1245184
    buffer_load_dwordx4 v38, s[28:31], s74 offen lds
    s_waitcnt lgkmcnt(4)
    v_mfma_f32_16x16x32_bf16 v[152:155], v[208:211], v[72:75], v[152:155]
    ds_read_b64_tr_b16 v[220:221], v49 offset:4096
    v_mfma_f32_16x16x32_bf16 v[184:187], v[208:211], v[76:79], v[184:187]
    ds_read_b64_tr_b16 v[222:223], v49 offset:6144
    s_waitcnt lgkmcnt(4)
    v_mfma_f32_16x16x32_bf16 v[156:159], v[212:215], v[72:75], v[156:159]
    s_barrier
    ds_read_b64_tr_b16 v[208:209], v46 offset:16384
    v_mfma_f32_16x16x32_bf16 v[188:191], v[212:215], v[76:79], v[188:191]
    ds_read_b64_tr_b16 v[210:211], v46 offset:18432
    s_setprio 3
    s_mov_b32 s77, 29379584
    buffer_load_dwordx4 v[112:115], v39, s[36:39], s77 offen sc1
    s_waitcnt lgkmcnt(4)
    v_mfma_f32_16x16x32_bf16 v[160:163], v[216:219], v[72:75], v[160:163]
    ds_read_b64_tr_b16 v[212:213], v47 offset:16384
    v_mfma_f32_16x16x32_bf16 v[192:195], v[216:219], v[76:79], v[192:195]
    ds_read_b64_tr_b16 v[214:215], v47 offset:18432
    s_waitcnt lgkmcnt(4)
    v_mfma_f32_16x16x32_bf16 v[164:167], v[220:223], v[72:75], v[164:167]
    ds_read_b64_tr_b16 v[216:217], v48 offset:16384
    v_mfma_f32_16x16x32_bf16 v[196:199], v[220:223], v[76:79], v[196:199]
    ds_read_b64_tr_b16 v[218:219], v48 offset:18432
    s_setprio 2
    buffer_load_dwordx4 v[116:119], v40, s[36:39], s77 offen sc1
    s_waitcnt vmcnt(14)
    s_waitcnt lgkmcnt(4)
    v_mfma_f32_16x16x32_bf16 v[136:139], v[208:211], v[80:83], v[136:139]
    ds_read_b64_tr_b16 v[220:221], v49 offset:16384
    v_mfma_f32_16x16x32_bf16 v[168:171], v[208:211], v[84:87], v[168:171]
    ds_read_b64_tr_b16 v[222:223], v49 offset:18432
    s_waitcnt lgkmcnt(4)
    v_mfma_f32_16x16x32_bf16 v[140:143], v[212:215], v[80:83], v[140:143]
    ds_read_b64_tr_b16 v[208:209], v46 offset:20480
    v_mfma_f32_16x16x32_bf16 v[172:175], v[212:215], v[84:87], v[172:175]
    ds_read_b64_tr_b16 v[210:211], v46 offset:22528
    s_setprio 1
    s_add_u32 m0, s54, 32768
    s_mov_b32 s74, 1441792
    buffer_load_dwordx4 v37, s[28:31], s74 offen lds
    s_waitcnt lgkmcnt(4)
    v_mfma_f32_16x16x32_bf16 v[144:147], v[216:219], v[80:83], v[144:147]
    ds_read_b64_tr_b16 v[212:213], v47 offset:20480
    v_mfma_f32_16x16x32_bf16 v[176:179], v[216:219], v[84:87], v[176:179]
    ds_read_b64_tr_b16 v[214:215], v47 offset:22528
    s_waitcnt lgkmcnt(4)
    v_mfma_f32_16x16x32_bf16 v[148:151], v[220:223], v[80:83], v[148:151]
    ds_read_b64_tr_b16 v[216:217], v48 offset:20480
    v_mfma_f32_16x16x32_bf16 v[180:183], v[220:223], v[84:87], v[180:183]
    ds_read_b64_tr_b16 v[218:219], v48 offset:22528
    s_setprio 0
    s_add_u32 m0, s54, 36864
    s_mov_b32 s74, 1441792
    buffer_load_dwordx4 v38, s[28:31], s74 offen lds
    s_waitcnt lgkmcnt(4)
    v_mfma_f32_16x16x32_bf16 v[152:155], v[208:211], v[80:83], v[152:155]
    ds_read_b64_tr_b16 v[220:221], v49 offset:20480
    v_mfma_f32_16x16x32_bf16 v[184:187], v[208:211], v[84:87], v[184:187]
    ds_read_b64_tr_b16 v[222:223], v49 offset:22528
    s_waitcnt lgkmcnt(4)
    v_mfma_f32_16x16x32_bf16 v[156:159], v[212:215], v[80:83], v[156:159]
    s_barrier
    ds_read_b64_tr_b16 v[208:209], v46 offset:32768
    v_mfma_f32_16x16x32_bf16 v[188:191], v[212:215], v[84:87], v[188:191]
    ds_read_b64_tr_b16 v[210:211], v46 offset:34816
    s_setprio 3
    s_mov_b32 s77, 29382656
    buffer_load_dwordx4 v[120:123], v39, s[36:39], s77 offen sc1
    s_waitcnt lgkmcnt(4)
    v_mfma_f32_16x16x32_bf16 v[160:163], v[216:219], v[80:83], v[160:163]
    ds_read_b64_tr_b16 v[212:213], v47 offset:32768
    v_mfma_f32_16x16x32_bf16 v[192:195], v[216:219], v[84:87], v[192:195]
    ds_read_b64_tr_b16 v[214:215], v47 offset:34816
    s_waitcnt lgkmcnt(4)
    v_mfma_f32_16x16x32_bf16 v[164:167], v[220:223], v[80:83], v[164:167]
    ds_read_b64_tr_b16 v[216:217], v48 offset:32768
    v_mfma_f32_16x16x32_bf16 v[196:199], v[220:223], v[84:87], v[196:199]
    ds_read_b64_tr_b16 v[218:219], v48 offset:34816
    s_setprio 2
    buffer_load_dwordx4 v[124:127], v40, s[36:39], s77 offen sc1
    s_waitcnt vmcnt(16)
    s_waitcnt lgkmcnt(4)
    v_mfma_f32_16x16x32_bf16 v[136:139], v[208:211], v[88:91], v[136:139]
    ds_read_b64_tr_b16 v[220:221], v49 offset:32768
    v_mfma_f32_16x16x32_bf16 v[168:171], v[208:211], v[92:95], v[168:171]
    ds_read_b64_tr_b16 v[222:223], v49 offset:34816
    s_waitcnt lgkmcnt(4)
    v_mfma_f32_16x16x32_bf16 v[140:143], v[212:215], v[88:91], v[140:143]
    ds_read_b64_tr_b16 v[208:209], v46 offset:36864
    v_mfma_f32_16x16x32_bf16 v[172:175], v[212:215], v[92:95], v[172:175]
    ds_read_b64_tr_b16 v[210:211], v46 offset:38912
    s_setprio 1
    s_add_u32 m0, s54, 49152
    s_mov_b32 s74, 1703936
    buffer_load_dwordx4 v37, s[28:31], s74 offen lds
    s_waitcnt lgkmcnt(4)
    v_mfma_f32_16x16x32_bf16 v[144:147], v[216:219], v[88:91], v[144:147]
    ds_read_b64_tr_b16 v[212:213], v47 offset:36864
    v_mfma_f32_16x16x32_bf16 v[176:179], v[216:219], v[92:95], v[176:179]
    ds_read_b64_tr_b16 v[214:215], v47 offset:38912
    s_waitcnt lgkmcnt(4)
    v_mfma_f32_16x16x32_bf16 v[148:151], v[220:223], v[88:91], v[148:151]
    ds_read_b64_tr_b16 v[216:217], v48 offset:36864
    v_mfma_f32_16x16x32_bf16 v[180:183], v[220:223], v[92:95], v[180:183]
    ds_read_b64_tr_b16 v[218:219], v48 offset:38912
    s_setprio 0
    s_add_u32 m0, s54, 53248
    s_mov_b32 s74, 1703936
    buffer_load_dwordx4 v38, s[28:31], s74 offen lds
    s_waitcnt lgkmcnt(4)
    v_mfma_f32_16x16x32_bf16 v[152:155], v[208:211], v[88:91], v[152:155]
    ds_read_b64_tr_b16 v[220:221], v49 offset:36864
    v_mfma_f32_16x16x32_bf16 v[184:187], v[208:211], v[92:95], v[184:187]
    ds_read_b64_tr_b16 v[222:223], v49 offset:38912
    s_waitcnt lgkmcnt(4)
    v_mfma_f32_16x16x32_bf16 v[156:159], v[212:215], v[88:91], v[156:159]
    s_waitcnt vmcnt(17)
    s_barrier
    ds_read_b64_tr_b16 v[208:209], v46 offset:49152
    v_mfma_f32_16x16x32_bf16 v[188:191], v[212:215], v[92:95], v[188:191]
    ds_read_b64_tr_b16 v[210:211], v46 offset:51200
    s_setprio 3
    s_mov_b32 s77, 29386752
    buffer_load_dwordx4 v[128:131], v39, s[36:39], s77 offen sc1
    s_waitcnt lgkmcnt(4)
    v_mfma_f32_16x16x32_bf16 v[160:163], v[216:219], v[88:91], v[160:163]
    ds_read_b64_tr_b16 v[212:213], v47 offset:49152
    v_mfma_f32_16x16x32_bf16 v[192:195], v[216:219], v[92:95], v[192:195]
    ds_read_b64_tr_b16 v[214:215], v47 offset:51200
    s_waitcnt lgkmcnt(4)
    v_mfma_f32_16x16x32_bf16 v[164:167], v[220:223], v[88:91], v[164:167]
    ds_read_b64_tr_b16 v[216:217], v48 offset:49152
    v_mfma_f32_16x16x32_bf16 v[196:199], v[220:223], v[92:95], v[196:199]
    ds_read_b64_tr_b16 v[218:219], v48 offset:51200
    s_setprio 2
    buffer_load_dwordx4 v[132:135], v40, s[36:39], s77 offen sc1
    s_waitcnt vmcnt(17)
    s_waitcnt lgkmcnt(4)
    v_mfma_f32_16x16x32_bf16 v[136:139], v[208:211], v[96:99], v[136:139]
    ds_read_b64_tr_b16 v[220:221], v49 offset:49152
    v_mfma_f32_16x16x32_bf16 v[168:171], v[208:211], v[100:103], v[168:171]
    ds_read_b64_tr_b16 v[222:223], v49 offset:51200
    s_waitcnt lgkmcnt(4)
    v_mfma_f32_16x16x32_bf16 v[140:143], v[212:215], v[96:99], v[140:143]
    ds_read_b64_tr_b16 v[208:209], v46 offset:53248
    v_mfma_f32_16x16x32_bf16 v[172:175], v[212:215], v[100:103], v[172:175]
    ds_read_b64_tr_b16 v[210:211], v46 offset:55296
    s_setprio 1
    s_add_u32 m0, s54, 98304
    s_mov_b32 s74, 131072
    buffer_load_dwordx4 v37, s[28:31], s74 offen lds
    s_waitcnt lgkmcnt(4)
    v_mfma_f32_16x16x32_bf16 v[144:147], v[216:219], v[96:99], v[144:147]
    ds_read_b64_tr_b16 v[212:213], v47 offset:53248
    v_mfma_f32_16x16x32_bf16 v[176:179], v[216:219], v[100:103], v[176:179]
    ds_read_b64_tr_b16 v[214:215], v47 offset:55296
    s_waitcnt lgkmcnt(4)
    v_mfma_f32_16x16x32_bf16 v[148:151], v[220:223], v[96:99], v[148:151]
    ds_read_b64_tr_b16 v[216:217], v48 offset:53248
    v_mfma_f32_16x16x32_bf16 v[180:183], v[220:223], v[100:103], v[180:183]
    ds_read_b64_tr_b16 v[218:219], v48 offset:55296
    s_setprio 0
    s_add_u32 m0, s54, 102400
    s_mov_b32 s74, 131072
    buffer_load_dwordx4 v38, s[28:31], s74 offen lds
    s_waitcnt lgkmcnt(4)
    v_mfma_f32_16x16x32_bf16 v[152:155], v[208:211], v[96:99], v[152:155]
    ds_read_b64_tr_b16 v[220:221], v49 offset:53248
    v_mfma_f32_16x16x32_bf16 v[184:187], v[208:211], v[100:103], v[184:187]
    ds_read_b64_tr_b16 v[222:223], v49 offset:55296
    s_waitcnt lgkmcnt(4)
    v_mfma_f32_16x16x32_bf16 v[156:159], v[212:215], v[96:99], v[156:159]
    s_waitcnt vmcnt(17)
    s_barrier
    ds_read_b64_tr_b16 v[208:209], v42 offset:0
    v_mfma_f32_16x16x32_bf16 v[188:191], v[212:215], v[100:103], v[188:191]
    ds_read_b64_tr_b16 v[210:211], v42 offset:2048
    s_setprio 3
    s_waitcnt vmcnt(14)
    v_cmp_gt_i32 vcc, 3, v19
    s_cbranch_vccz qa_kernel_GT2_G
qa_kernel_GT2:
    buffer_load_dword v19, v41, s[36:39], 0 offen sc1
    s_waitcnt vmcnt(0)
    v_cmp_gt_i32 vcc, 3, v19
    s_sub_u32 s62, s62, 1
    s_cselect_b64 vcc, 0, vcc
    s_cselect_b32 s62, 0, s62
    s_cbranch_vccnz qa_kernel_GT2
qa_kernel_GT2_G:
    s_mov_b32 s77, 29362176
    buffer_load_dwordx4 v[72:75], v39, s[36:39], s77 offen sc1
    s_waitcnt lgkmcnt(4)
    v_mfma_f32_16x16x32_bf16 v[160:163], v[216:219], v[96:99], v[160:163]
    ds_read_b64_tr_b16 v[212:213], v43 offset:0
    v_mfma_f32_16x16x32_bf16 v[192:195], v[216:219], v[100:103], v[192:195]
    ds_read_b64_tr_b16 v[214:215], v43 offset:2048
    s_waitcnt lgkmcnt(4)
    v_mfma_f32_16x16x32_bf16 v[164:167], v[220:223], v[96:99], v[164:167]
    ds_read_b64_tr_b16 v[216:217], v44 offset:0
    v_mfma_f32_16x16x32_bf16 v[196:199], v[220:223], v[100:103], v[196:199]
    ds_read_b64_tr_b16 v[218:219], v44 offset:2048
    s_setprio 2
    buffer_load_dwordx4 v[76:79], v40, s[36:39], s77 offen sc1
    s_waitcnt lgkmcnt(4)
    v_mfma_f32_16x16x32_bf16 v[136:139], v[208:211], v[104:107], v[136:139]
    ds_read_b64_tr_b16 v[220:221], v45 offset:0
    v_mfma_f32_16x16x32_bf16 v[168:171], v[208:211], v[108:111], v[168:171]
    ds_read_b64_tr_b16 v[222:223], v45 offset:2048
    s_waitcnt lgkmcnt(4)
    v_mfma_f32_16x16x32_bf16 v[140:143], v[212:215], v[104:107], v[140:143]
    ds_read_b64_tr_b16 v[208:209], v42 offset:4096
    v_mfma_f32_16x16x32_bf16 v[172:175], v[212:215], v[108:111], v[172:175]
    ds_read_b64_tr_b16 v[210:211], v42 offset:6144
    s_setprio 1
    s_add_u32 m0, s54, 114688
    s_mov_b32 s74, 393216
    buffer_load_dwordx4 v37, s[28:31], s74 offen lds
    s_waitcnt lgkmcnt(4)
    v_mfma_f32_16x16x32_bf16 v[144:147], v[216:219], v[104:107], v[144:147]
    ds_read_b64_tr_b16 v[212:213], v43 offset:4096
    v_mfma_f32_16x16x32_bf16 v[176:179], v[216:219], v[108:111], v[176:179]
    ds_read_b64_tr_b16 v[214:215], v43 offset:6144
    s_waitcnt lgkmcnt(4)
    v_mfma_f32_16x16x32_bf16 v[148:151], v[220:223], v[104:107], v[148:151]
    ds_read_b64_tr_b16 v[216:217], v44 offset:4096
    v_mfma_f32_16x16x32_bf16 v[180:183], v[220:223], v[108:111], v[180:183]
    ds_read_b64_tr_b16 v[218:219], v44 offset:6144
    s_setprio 0
    s_add_u32 m0, s54, 118784
    s_mov_b32 s74, 393216
    buffer_load_dwordx4 v38, s[28:31], s74 offen lds
    s_waitcnt lgkmcnt(4)
    v_mfma_f32_16x16x32_bf16 v[152:155], v[208:211], v[104:107], v[152:155]
    ds_read_b64_tr_b16 v[220:221], v45 offset:4096
    v_mfma_f32_16x16x32_bf16 v[184:187], v[208:211], v[108:111], v[184:187]
    ds_read_b64_tr_b16 v[222:223], v45 offset:6144
    s_waitcnt lgkmcnt(4)
    v_mfma_f32_16x16x32_bf16 v[156:159], v[212:215], v[104:107], v[156:159]
    s_waitcnt vmcnt(16)
    s_barrier
    ds_read_b64_tr_b16 v[208:209], v42 offset:16384
    v_mfma_f32_16x16x32_bf16 v[188:191], v[212:215], v[108:111], v[188:191]
    ds_read_b64_tr_b16 v[210:211], v42 offset:18432
    s_setprio 3
    s_mov_b32 s77, 29366272
    buffer_load_dwordx4 v[80:83], v39, s[36:39], s77 offen sc1
    s_waitcnt lgkmcnt(4)
    v_mfma_f32_16x16x32_bf16 v[160:163], v[216:219], v[104:107], v[160:163]
    ds_read_b64_tr_b16 v[212:213], v43 offset:16384
    v_mfma_f32_16x16x32_bf16 v[192:195], v[216:219], v[108:111], v[192:195]
    ds_read_b64_tr_b16 v[214:215], v43 offset:18432
    s_waitcnt lgkmcnt(4)
    v_mfma_f32_16x16x32_bf16 v[164:167], v[220:223], v[104:107], v[164:167]
    ds_read_b64_tr_b16 v[216:217], v44 offset:16384
    v_mfma_f32_16x16x32_bf16 v[196:199], v[220:223], v[108:111], v[196:199]
    ds_read_b64_tr_b16 v[218:219], v44 offset:18432
    s_setprio 2
    buffer_load_dwordx4 v[84:87], v40, s[36:39], s77 offen sc1
    s_waitcnt vmcnt(16)
    s_waitcnt lgkmcnt(4)
    v_mfma_f32_16x16x32_bf16 v[136:139], v[208:211], v[112:115], v[136:139]
    ds_read_b64_tr_b16 v[220:221], v45 offset:16384
    v_mfma_f32_16x16x32_bf16 v[168:171], v[208:211], v[116:119], v[168:171]
    ds_read_b64_tr_b16 v[222:223], v45 offset:18432
    s_waitcnt lgkmcnt(4)
    v_mfma_f32_16x16x32_bf16 v[140:143], v[212:215], v[112:115], v[140:143]
    ds_read_b64_tr_b16 v[208:209], v42 offset:20480
    v_mfma_f32_16x16x32_bf16 v[172:175], v[212:215], v[116:119], v[172:175]
    ds_read_b64_tr_b16 v[210:211], v42 offset:22528
    s_setprio 1
    s_add_u32 m0, s54, 131072
    s_mov_b32 s74, 589824
    buffer_load_dwordx4 v37, s[28:31], s74 offen lds
    s_waitcnt lgkmcnt(4)
    v_mfma_f32_16x16x32_bf16 v[144:147], v[216:219], v[112:115], v[144:147]
    ds_read_b64_tr_b16 v[212:213], v43 offset:20480
    v_mfma_f32_16x16x32_bf16 v[176:179], v[216:219], v[116:119], v[176:179]
    ds_read_b64_tr_b16 v[214:215], v43 offset:22528
    s_waitcnt lgkmcnt(4)
    v_mfma_f32_16x16x32_bf16 v[148:151], v[220:223], v[112:115], v[148:151]
    ds_read_b64_tr_b16 v[216:217], v44 offset:20480
    v_mfma_f32_16x16x32_bf16 v[180:183], v[220:223], v[116:119], v[180:183]
    ds_read_b64_tr_b16 v[218:219], v44 offset:22528
    s_setprio 0
    s_add_u32 m0, s54, 135168
    s_mov_b32 s74, 589824
    buffer_load_dwordx4 v38, s[28:31], s74 offen lds
    s_waitcnt lgkmcnt(4)
    v_mfma_f32_16x16x32_bf16 v[152:155], v[208:211], v[112:115], v[152:155]
    ds_read_b64_tr_b16 v[220:221], v45 offset:20480
    v_mfma_f32_16x16x32_bf16 v[184:187], v[208:211], v[116:119], v[184:187]
    ds_read_b64_tr_b16 v[222:223], v45 offset:22528
    s_waitcnt lgkmcnt(4)
    v_mfma_f32_16x16x32_bf16 v[156:159], v[212:215], v[112:115], v[156:159]
    s_waitcnt vmcnt(16)
    s_barrier
    ds_read_b64_tr_b16 v[208:209], v42 offset:32768
    v_mfma_f32_16x16x32_bf16 v[188:191], v[212:215], v[116:119], v[188:191]
    ds_read_b64_tr_b16 v[210:211], v42 offset:34816
    s_setprio 3
    s_mov_b32 s77, 29369344
    buffer_load_dwordx4 v[88:91], v39, s[36:39], s77 offen sc1
    s_waitcnt lgkmcnt(4)
    v_mfma_f32_16x16x32_bf16 v[160:163], v[216:219], v[112:115], v[160:163]
    ds_read_b64_tr_b16 v[212:213], v43 offset:32768
    v_mfma_f32_16x16x32_bf16 v[192:195], v[216:219], v[116:119], v[192:195]
    ds_read_b64_tr_b16 v[214:215], v43 offset:34816
    s_waitcnt lgkmcnt(4)
    v_mfma_f32_16x16x32_bf16 v[164:167], v[220:223], v[112:115], v[164:167]
    ds_read_b64_tr_b16 v[216:217], v44 offset:32768
    v_mfma_f32_16x16x32_bf16 v[196:199], v[220:223], v[116:119], v[196:199]
    ds_read_b64_tr_b16 v[218:219], v44 offset:34816
    s_setprio 2
    buffer_load_dwordx4 v[92:95], v40, s[36:39], s77 offen sc1
    s_waitcnt vmcnt(16)
    s_waitcnt lgkmcnt(4)
    v_mfma_f32_16x16x32_bf16 v[136:139], v[208:211], v[120:123], v[136:139]
    ds_read_b64_tr_b16 v[220:221], v45 offset:32768
    v_mfma_f32_16x16x32_bf16 v[168:171], v[208:211], v[124:127], v[168:171]
    ds_read_b64_tr_b16 v[222:223], v45 offset:34816
    s_waitcnt lgkmcnt(4)
    v_mfma_f32_16x16x32_bf16 v[140:143], v[212:215], v[120:123], v[140:143]
    ds_read_b64_tr_b16 v[208:209], v42 offset:36864
    v_mfma_f32_16x16x32_bf16 v[172:175], v[212:215], v[124:127], v[172:175]
    ds_read_b64_tr_b16 v[210:211], v42 offset:38912
    s_setprio 1
    s_add_u32 m0, s54, 147456
    s_mov_b32 s74, 851968
    buffer_load_dwordx4 v37, s[28:31], s74 offen lds
    s_waitcnt lgkmcnt(4)
    v_mfma_f32_16x16x32_bf16 v[144:147], v[216:219], v[120:123], v[144:147]
    ds_read_b64_tr_b16 v[212:213], v43 offset:36864
    v_mfma_f32_16x16x32_bf16 v[176:179], v[216:219], v[124:127], v[176:179]
    ds_read_b64_tr_b16 v[214:215], v43 offset:38912
    s_waitcnt lgkmcnt(4)
    v_mfma_f32_16x16x32_bf16 v[148:151], v[220:223], v[120:123], v[148:151]
    ds_read_b64_tr_b16 v[216:217], v44 offset:36864
    v_mfma_f32_16x16x32_bf16 v[180:183], v[220:223], v[124:127], v[180:183]
    ds_read_b64_tr_b16 v[218:219], v44 offset:38912
    s_setprio 0
    s_add_u32 m0, s54, 151552
    s_mov_b32 s74, 851968
    buffer_load_dwordx4 v38, s[28:31], s74 offen lds
    s_waitcnt lgkmcnt(4)
    v_mfma_f32_16x16x32_bf16 v[152:155], v[208:211], v[120:123], v[152:155]
    ds_read_b64_tr_b16 v[220:221], v45 offset:36864
    v_mfma_f32_16x16x32_bf16 v[184:187], v[208:211], v[124:127], v[184:187]
    ds_read_b64_tr_b16 v[222:223], v45 offset:38912
    s_waitcnt lgkmcnt(4)
    v_mfma_f32_16x16x32_bf16 v[156:159], v[212:215], v[120:123], v[156:159]
    s_waitcnt vmcnt(16)
    s_barrier
    ds_read_b64_tr_b16 v[208:209], v42 offset:49152
    v_mfma_f32_16x16x32_bf16 v[188:191], v[212:215], v[124:127], v[188:191]
    ds_read_b64_tr_b16 v[210:211], v42 offset:51200
    s_setprio 3
    s_mov_b32 s77, 29373440
    buffer_load_dwordx4 v[96:99], v39, s[36:39], s77 offen sc1
    s_waitcnt lgkmcnt(4)
    v_mfma_f32_16x16x32_bf16 v[160:163], v[216:219], v[120:123], v[160:163]
    ds_read_b64_tr_b16 v[212:213], v43 offset:49152
    v_mfma_f32_16x16x32_bf16 v[192:195], v[216:219], v[124:127], v[192:195]
    ds_read_b64_tr_b16 v[214:215], v43 offset:51200
    s_waitcnt lgkmcnt(4)
    v_mfma_f32_16x16x32_bf16 v[164:167], v[220:223], v[120:123], v[164:167]
    ds_read_b64_tr_b16 v[216:217], v44 offset:49152
    v_mfma_f32_16x16x32_bf16 v[196:199], v[220:223], v[124:127], v[196:199]
    ds_read_b64_tr_b16 v[218:219], v44 offset:51200
    s_setprio 2
    buffer_load_dwordx4 v[100:103], v40, s[36:39], s77 offen sc1
    s_waitcnt vmcnt(16)
    s_waitcnt lgkmcnt(4)
    v_mfma_f32_16x16x32_bf16 v[136:139], v[208:211], v[128:131], v[136:139]
    ds_read_b64_tr_b16 v[220:221], v45 offset:49152
    v_mfma_f32_16x16x32_bf16 v[168:171], v[208:211], v[132:135], v[168:171]
    ds_read_b64_tr_b16 v[222:223], v45 offset:51200
    s_waitcnt lgkmcnt(4)
    v_mfma_f32_16x16x32_bf16 v[140:143], v[212:215], v[128:131], v[140:143]
    ds_read_b64_tr_b16 v[208:209], v42 offset:53248
    v_mfma_f32_16x16x32_bf16 v[172:175], v[212:215], v[132:135], v[172:175]
    ds_read_b64_tr_b16 v[210:211], v42 offset:55296
    s_setprio 1
    s_add_u32 m0, s54, 0
    s_mov_b32 s74, 1048576
    buffer_load_dwordx4 v37, s[28:31], s74 offen lds
    s_waitcnt lgkmcnt(4)
    v_mfma_f32_16x16x32_bf16 v[144:147], v[216:219], v[128:131], v[144:147]
    ds_read_b64_tr_b16 v[212:213], v43 offset:53248
    v_mfma_f32_16x16x32_bf16 v[176:179], v[216:219], v[132:135], v[176:179]
    ds_read_b64_tr_b16 v[214:215], v43 offset:55296
    s_waitcnt lgkmcnt(4)
    v_mfma_f32_16x16x32_bf16 v[148:151], v[220:223], v[128:131], v[148:151]
    ds_read_b64_tr_b16 v[216:217], v44 offset:53248
    v_mfma_f32_16x16x32_bf16 v[180:183], v[220:223], v[132:135], v[180:183]
    ds_read_b64_tr_b16 v[218:219], v44 offset:55296
    s_setprio 0
    s_add_u32 m0, s54, 4096
    s_mov_b32 s74, 1048576
    buffer_load_dwordx4 v38, s[28:31], s74 offen lds
    s_waitcnt lgkmcnt(4)
    v_mfma_f32_16x16x32_bf16 v[152:155], v[208:211], v[128:131], v[152:155]
    ds_read_b64_tr_b16 v[220:221], v45 offset:53248
    v_mfma_f32_16x16x32_bf16 v[184:187], v[208:211], v[132:135], v[184:187]
    ds_read_b64_tr_b16 v[222:223], v45 offset:55296
    s_waitcnt lgkmcnt(4)
    v_mfma_f32_16x16x32_bf16 v[156:159], v[212:215], v[128:131], v[156:159]
    s_waitcnt vmcnt(16)
    s_barrier
    ds_read_b64_tr_b16 v[208:209], v46 offset:0
    v_mfma_f32_16x16x32_bf16 v[188:191], v[212:215], v[132:135], v[188:191]
    ds_read_b64_tr_b16 v[210:211], v46 offset:2048
    s_setprio 3
    s_mov_b32 s77, 29376512
    buffer_load_dwordx4 v[104:107], v39, s[36:39], s77 offen sc1
    s_waitcnt lgkmcnt(4)
    v_mfma_f32_16x16x32_bf16 v[160:163], v[216:219], v[128:131], v[160:163]
    ds_read_b64_tr_b16 v[212:213], v47 offset:0
    v_mfma_f32_16x16x32_bf16 v[192:195], v[216:219], v[132:135], v[192:195]
    ds_read_b64_tr_b16 v[214:215], v47 offset:2048
    s_waitcnt lgkmcnt(4)
    v_mfma_f32_16x16x32_bf16 v[164:167], v[220:223], v[128:131], v[164:167]
    ds_read_b64_tr_b16 v[216:217], v48 offset:0
    v_mfma_f32_16x16x32_bf16 v[196:199], v[220:223], v[132:135], v[196:199]
    ds_read_b64_tr_b16 v[218:219], v48 offset:2048
    s_setprio 2
    buffer_load_dwordx4 v[108:111], v40, s[36:39], s77 offen sc1
    s_waitcnt vmcnt(16)
    s_waitcnt lgkmcnt(4)
    v_mfma_f32_16x16x32_bf16 v[136:139], v[208:211], v[72:75], v[136:139]
    ds_read_b64_tr_b16 v[220:221], v49 offset:0
    v_mfma_f32_16x16x32_bf16 v[168:171], v[208:211], v[76:79], v[168:171]
    ds_read_b64_tr_b16 v[222:223], v49 offset:2048
    s_waitcnt lgkmcnt(4)
    v_mfma_f32_16x16x32_bf16 v[140:143], v[212:215], v[72:75], v[140:143]
    ds_read_b64_tr_b16 v[208:209], v46 offset:4096
    v_mfma_f32_16x16x32_bf16 v[172:175], v[212:215], v[76:79], v[172:175]
    ds_read_b64_tr_b16 v[210:211], v46 offset:6144
    s_setprio 1
    s_add_u32 m0, s54, 16384
    s_mov_b32 s74, 1310720
    buffer_load_dwordx4 v37, s[28:31], s74 offen lds
    s_waitcnt lgkmcnt(4)
    v_mfma_f32_16x16x32_bf16 v[144:147], v[216:219], v[72:75], v[144:147]
    ds_read_b64_tr_b16 v[212:213], v47 offset:4096
    v_mfma_f32_16x16x32_bf16 v[176:179], v[216:219], v[76:79], v[176:179]
    ds_read_b64_tr_b16 v[214:215], v47 offset:6144
    s_waitcnt lgkmcnt(4)
    v_mfma_f32_16x16x32_bf16 v[148:151], v[220:223], v[72:75], v[148:151]
    ds_read_b64_tr_b16 v[216:217], v48 offset:4096
    v_mfma_f32_16x16x32_bf16 v[180:183], v[220:223], v[76:79], v[180:183]
    ds_read_b64_tr_b16 v[218:219], v48 offset:6144
    s_setprio 0
    s_add_u32 m0, s54, 20480
    s_mov_b32 s74, 1310720
    buffer_load_dwordx4 v38, s[28:31], s74 offen lds
    s_waitcnt lgkmcnt(4)
    v_mfma_f32_16x16x32_bf16 v[152:155], v[208:211], v[72:75], v[152:155]
    ds_read_b64_tr_b16 v[220:221], v49 offset:4096
    v_mfma_f32_16x16x32_bf16 v[184:187], v[208:211], v[76:79], v[184:187]
    ds_read_b64_tr_b16 v[222:223], v49 offset:6144
    s_waitcnt lgkmcnt(4)
    v_mfma_f32_16x16x32_bf16 v[156:159], v[212:215], v[72:75], v[156:159]
    s_waitcnt vmcnt(16)
    s_barrier
    ds_read_b64_tr_b16 v[208:209], v46 offset:16384
    v_mfma_f32_16x16x32_bf16 v[188:191], v[212:215], v[76:79], v[188:191]
    ds_read_b64_tr_b16 v[210:211], v46 offset:18432
    s_setprio 3
    s_mov_b32 s77, 29380608
    buffer_load_dwordx4 v[112:115], v39, s[36:39], s77 offen sc1
    s_waitcnt lgkmcnt(4)
    v_mfma_f32_16x16x32_bf16 v[160:163], v[216:219], v[72:75], v[160:163]
    ds_read_b64_tr_b16 v[212:213], v47 offset:16384
    v_mfma_f32_16x16x32_bf16 v[192:195], v[216:219], v[76:79], v[192:195]
    ds_read_b64_tr_b16 v[214:215], v47 offset:18432
    s_waitcnt lgkmcnt(4)
    v_mfma_f32_16x16x32_bf16 v[164:167], v[220:223], v[72:75], v[164:167]
    ds_read_b64_tr_b16 v[216:217], v48 offset:16384
    v_mfma_f32_16x16x32_bf16 v[196:199], v[220:223], v[76:79], v[196:199]
    ds_read_b64_tr_b16 v[218:219], v48 offset:18432
    s_setprio 2
    buffer_load_dwordx4 v[116:119], v40, s[36:39], s77 offen sc1
    s_waitcnt vmcnt(16)
    s_waitcnt lgkmcnt(4)
    v_mfma_f32_16x16x32_bf16 v[136:139], v[208:211], v[80:83], v[136:139]
    ds_read_b64_tr_b16 v[220:221], v49 offset:16384
qa_kernel_WS1_13:
    s_cbranch_execz qa_kernel_WRET1
    v_mfma_f32_16x16x32_bf16 v[168:171], v[208:211], v[84:87], v[168:171]
    ds_read_b64_tr_b16 v[222:223], v49 offset:18432
    s_waitcnt lgkmcnt(4)
    v_mfma_f32_16x16x32_bf16 v[140:143], v[212:215], v[80:83], v[140:143]
    ds_read_b64_tr_b16 v[208:209], v46 offset:20480
    v_mfma_f32_16x16x32_bf16 v[172:175], v[212:215], v[84:87], v[172:175]
    ds_read_b64_tr_b16 v[210:211], v46 offset:22528
    s_setprio 1
    s_add_u32 m0, s54, 32768
    s_mov_b32 s74, 1507328
    buffer_load_dwordx4 v37, s[28:31], s74 offen lds
    s_waitcnt lgkmcnt(4)
    v_mfma_f32_16x16x32_bf16 v[144:147], v[216:219], v[80:83], v[144:147]
    ds_read_b64_tr_b16 v[212:213], v47 offset:20480
    v_mfma_f32_16x16x32_bf16 v[176:179], v[216:219], v[84:87], v[176:179]
    ds_read_b64_tr_b16 v[214:215], v47 offset:22528
    s_waitcnt lgkmcnt(4)
    v_mfma_f32_16x16x32_bf16 v[148:151], v[220:223], v[80:83], v[148:151]
    ds_read_b64_tr_b16 v[216:217], v48 offset:20480
    v_mfma_f32_16x16x32_bf16 v[180:183], v[220:223], v[84:87], v[180:183]
    ds_read_b64_tr_b16 v[218:219], v48 offset:22528
    s_setprio 0
    s_add_u32 m0, s54, 36864
    s_mov_b32 s74, 1507328
    buffer_load_dwordx4 v38, s[28:31], s74 offen lds
    s_waitcnt lgkmcnt(4)
    v_mfma_f32_16x16x32_bf16 v[152:155], v[208:211], v[80:83], v[152:155]
    ds_read_b64_tr_b16 v[220:221], v49 offset:20480
    v_mfma_f32_16x16x32_bf16 v[184:187], v[208:211], v[84:87], v[184:187]
    ds_read_b64_tr_b16 v[222:223], v49 offset:22528
    s_waitcnt lgkmcnt(4)
    v_mfma_f32_16x16x32_bf16 v[156:159], v[212:215], v[80:83], v[156:159]
    s_waitcnt vmcnt(16)
    s_barrier
    ds_read_b64_tr_b16 v[208:209], v46 offset:32768
    v_mfma_f32_16x16x32_bf16 v[188:191], v[212:215], v[84:87], v[188:191]
    ds_read_b64_tr_b16 v[210:211], v46 offset:34816
    s_setprio 3
    s_mov_b32 s77, 29383680
    buffer_load_dwordx4 v[120:123], v39, s[36:39], s77 offen sc1
    s_waitcnt lgkmcnt(4)
    v_mfma_f32_16x16x32_bf16 v[160:163], v[216:219], v[80:83], v[160:163]
    ds_read_b64_tr_b16 v[212:213], v47 offset:32768
    v_mfma_f32_16x16x32_bf16 v[192:195], v[216:219], v[84:87], v[192:195]
    ds_read_b64_tr_b16 v[214:215], v47 offset:34816
    s_waitcnt lgkmcnt(4)
    v_mfma_f32_16x16x32_bf16 v[164:167], v[220:223], v[80:83], v[164:167]
    ds_read_b64_tr_b16 v[216:217], v48 offset:32768
    v_mfma_f32_16x16x32_bf16 v[196:199], v[220:223], v[84:87], v[196:199]
    ds_read_b64_tr_b16 v[218:219], v48 offset:34816
    s_setprio 2
    buffer_load_dwordx4 v[124:127], v40, s[36:39], s77 offen sc1
    s_waitcnt vmcnt(16)
    s_waitcnt lgkmcnt(4)
    v_mfma_f32_16x16x32_bf16 v[136:139], v[208:211], v[88:91], v[136:139]
    ds_read_b64_tr_b16 v[220:221], v49 offset:32768
    v_mfma_f32_16x16x32_bf16 v[168:171], v[208:211], v[92:95], v[168:171]
    ds_read_b64_tr_b16 v[222:223], v49 offset:34816
    s_waitcnt lgkmcnt(4)
    v_mfma_f32_16x16x32_bf16 v[140:143], v[212:215], v[88:91], v[140:143]
    ds_read_b64_tr_b16 v[208:209], v46 offset:36864
    v_mfma_f32_16x16x32_bf16 v[172:175], v[212:215], v[92:95], v[172:175]
    ds_read_b64_tr_b16 v[210:211], v46 offset:38912
    s_setprio 1
    s_add_u32 m0, s54, 49152
    s_mov_b32 s74, 1769472
    buffer_load_dwordx4 v37, s[28:31], s74 offen lds
    s_waitcnt lgkmcnt(4)
    v_mfma_f32_16x16x32_bf16 v[144:147], v[216:219], v[88:91], v[144:147]
    ds_read_b64_tr_b16 v[212:213], v47 offset:36864
    v_mfma_f32_16x16x32_bf16 v[176:179], v[216:219], v[92:95], v[176:179]
    ds_read_b64_tr_b16 v[214:215], v47 offset:38912
    s_waitcnt lgkmcnt(4)
    v_mfma_f32_16x16x32_bf16 v[148:151], v[220:223], v[88:91], v[148:151]
    ds_read_b64_tr_b16 v[216:217], v48 offset:36864
    v_mfma_f32_16x16x32_bf16 v[180:183], v[220:223], v[92:95], v[180:183]
    ds_read_b64_tr_b16 v[218:219], v48 offset:38912
    s_setprio 0
    s_add_u32 m0, s54, 53248
    s_mov_b32 s74, 1769472
    buffer_load_dwordx4 v38, s[28:31], s74 offen lds
    s_waitcnt lgkmcnt(4)
    v_mfma_f32_16x16x32_bf16 v[152:155], v[208:211], v[88:91], v[152:155]
    ds_read_b64_tr_b16 v[220:221], v49 offset:36864
    v_mfma_f32_16x16x32_bf16 v[184:187], v[208:211], v[92:95], v[184:187]
    ds_read_b64_tr_b16 v[222:223], v49 offset:38912
    s_waitcnt lgkmcnt(4)
    v_mfma_f32_16x16x32_bf16 v[156:159], v[212:215], v[88:91], v[156:159]
    s_waitcnt vmcnt(16)
    s_barrier
    ds_read_b64_tr_b16 v[208:209], v46 offset:49152
    v_mfma_f32_16x16x32_bf16 v[188:191], v[212:215], v[92:95], v[188:191]
    ds_read_b64_tr_b16 v[210:211], v46 offset:51200
    s_setprio 3
    s_mov_b32 s77, 29387776
    buffer_load_dwordx4 v[128:131], v39, s[36:39], s77 offen sc1
    s_waitcnt lgkmcnt(4)
    v_mfma_f32_16x16x32_bf16 v[160:163], v[216:219], v[88:91], v[160:163]
    ds_read_b64_tr_b16 v[212:213], v47 offset:49152
    v_mfma_f32_16x16x32_bf16 v[192:195], v[216:219], v[92:95], v[192:195]
    ds_read_b64_tr_b16 v[214:215], v47 offset:51200
    s_waitcnt lgkmcnt(4)
    v_mfma_f32_16x16x32_bf16 v[164:167], v[220:223], v[88:91], v[164:167]
    ds_read_b64_tr_b16 v[216:217], v48 offset:49152
    v_mfma_f32_16x16x32_bf16 v[196:199], v[220:223], v[92:95], v[196:199]
    ds_read_b64_tr_b16 v[218:219], v48 offset:51200
    s_setprio 2
    buffer_load_dwordx4 v[132:135], v40, s[36:39], s77 offen sc1
    s_waitcnt vmcnt(16)
    s_waitcnt lgkmcnt(4)
    v_mfma_f32_16x16x32_bf16 v[136:139], v[208:211], v[96:99], v[136:139]
    ds_read_b64_tr_b16 v[220:221], v49 offset:49152
    v_mfma_f32_16x16x32_bf16 v[168:171], v[208:211], v[100:103], v[168:171]
    ds_read_b64_tr_b16 v[222:223], v49 offset:51200
    s_waitcnt lgkmcnt(4)
    v_mfma_f32_16x16x32_bf16 v[140:143], v[212:215], v[96:99], v[140:143]
    ds_read_b64_tr_b16 v[208:209], v46 offset:53248
    v_mfma_f32_16x16x32_bf16 v[172:175], v[212:215], v[100:103], v[172:175]
    ds_read_b64_tr_b16 v[210:211], v46 offset:55296
    s_setprio 1
    s_add_u32 m0, s54, 98304
    s_add_u32 s74, s78, 196608
    buffer_load_dwordx4 v37, s[28:31], s74 offen lds
    s_waitcnt lgkmcnt(4)
    v_mfma_f32_16x16x32_bf16 v[144:147], v[216:219], v[96:99], v[144:147]
    ds_read_b64_tr_b16 v[212:213], v47 offset:53248
    v_mfma_f32_16x16x32_bf16 v[176:179], v[216:219], v[100:103], v[176:179]
    ds_read_b64_tr_b16 v[214:215], v47 offset:55296
    s_waitcnt lgkmcnt(4)
    v_mfma_f32_16x16x32_bf16 v[148:151], v[220:223], v[96:99], v[148:151]
    ds_read_b64_tr_b16 v[216:217], v48 offset:53248
    v_mfma_f32_16x16x32_bf16 v[180:183], v[220:223], v[100:103], v[180:183]
    ds_read_b64_tr_b16 v[218:219], v48 offset:55296
    s_setprio 0
    s_add_u32 m0, s54, 102400
    s_add_u32 s74, s78, 196608
    buffer_load_dwordx4 v38, s[28:31], s74 offen lds
    s_waitcnt lgkmcnt(4)
    v_mfma_f32_16x16x32_bf16 v[152:155], v[208:211], v[96:99], v[152:155]
    ds_read_b64_tr_b16 v[220:221], v49 offset:53248
    v_mfma_f32_16x16x32_bf16 v[184:187], v[208:211], v[100:103], v[184:187]
    ds_read_b64_tr_b16 v[222:223], v49 offset:55296
    s_waitcnt lgkmcnt(4)
    v_mfma_f32_16x16x32_bf16 v[156:159], v[212:215], v[96:99], v[156:159]
    s_waitcnt vmcnt(16)
    s_barrier
    ds_read_b64_tr_b16 v[208:209], v42 offset:0
    v_mfma_f32_16x16x32_bf16 v[188:191], v[212:215], v[100:103], v[188:191]
    ds_read_b64_tr_b16 v[210:211], v42 offset:2048
    s_setprio 3
    s_mov_b32 s77, 29363200
    buffer_load_dwordx4 v[72:75], v39, s[36:39], s77 offen sc1
    s_waitcnt lgkmcnt(4)
    v_mfma_f32_16x16x32_bf16 v[160:163], v[216:219], v[96:99], v[160:163]
    ds_read_b64_tr_b16 v[212:213], v43 offset:0
    v_mfma_f32_16x16x32_bf16 v[192:195], v[216:219], v[100:103], v[192:195]
    ds_read_b64_tr_b16 v[214:215], v43 offset:2048
    s_waitcnt lgkmcnt(4)
    v_mfma_f32_16x16x32_bf16 v[164:167], v[220:223], v[96:99], v[164:167]
    ds_read_b64_tr_b16 v[216:217], v44 offset:0
    v_mfma_f32_16x16x32_bf16 v[196:199], v[220:223], v[100:103], v[196:199]
    ds_read_b64_tr_b16 v[218:219], v44 offset:2048
    s_setprio 2
    buffer_load_dwordx4 v[76:79], v40, s[36:39], s77 offen sc1
    s_waitcnt vmcnt(16)
    s_waitcnt lgkmcnt(4)
    v_mfma_f32_16x16x32_bf16 v[136:139], v[208:211], v[104:107], v[136:139]
    ds_read_b64_tr_b16 v[220:221], v45 offset:0
    v_mfma_f32_16x16x32_bf16 v[168:171], v[208:211], v[108:111], v[168:171]
    ds_read_b64_tr_b16 v[222:223], v45 offset:2048
    s_waitcnt lgkmcnt(4)
    v_mfma_f32_16x16x32_bf16 v[140:143], v[212:215], v[104:107], v[140:143]
    ds_read_b64_tr_b16 v[208:209], v42 offset:4096
    v_mfma_f32_16x16x32_bf16 v[172:175], v[212:215], v[108:111], v[172:175]
    ds_read_b64_tr_b16 v[210:211], v42 offset:6144
    s_setprio 1
    s_add_u32 m0, s54, 114688
    s_add_u32 s74, s78, 655360
    buffer_load_dwordx4 v37, s[28:31], s74 offen lds
    s_waitcnt lgkmcnt(4)
    v_mfma_f32_16x16x32_bf16 v[144:147], v[216:219], v[104:107], v[144:147]
    ds_read_b64_tr_b16 v[212:213], v43 offset:4096
    v_mfma_f32_16x16x32_bf16 v[176:179], v[216:219], v[108:111], v[176:179]
    ds_read_b64_tr_b16 v[214:215], v43 offset:6144
    s_waitcnt lgkmcnt(4)
    v_mfma_f32_16x16x32_bf16 v[148:151], v[220:223], v[104:107], v[148:151]
    ds_read_b64_tr_b16 v[216:217], v44 offset:4096
    v_mfma_f32_16x16x32_bf16 v[180:183], v[220:223], v[108:111], v[180:183]
    ds_read_b64_tr_b16 v[218:219], v44 offset:6144
    s_setprio 0
    s_add_u32 m0, s54, 118784
    s_add_u32 s74, s78, 655360
    buffer_load_dwordx4 v38, s[28:31], s74 offen lds
    s_waitcnt lgkmcnt(4)
    v_mfma_f32_16x16x32_bf16 v[152:155], v[208:211], v[104:107], v[152:155]
    ds_read_b64_tr_b16 v[220:221], v45 offset:4096
    v_mfma_f32_16x16x32_bf16 v[184:187], v[208:211], v[108:111], v[184:187]
    ds_read_b64_tr_b16 v[222:223], v45 offset:6144
    s_waitcnt lgkmcnt(4)
    v_mfma_f32_16x16x32_bf16 v[156:159], v[212:215], v[104:107], v[156:159]
    s_waitcnt vmcnt(16)
    s_barrier
    ds_read_b64_tr_b16 v[208:209], v42 offset:16384
    v_mfma_f32_16x16x32_bf16 v[188:191], v[212:215], v[108:111], v[188:191]
    ds_read_b64_tr_b16 v[210:211], v42 offset:18432
    s_setprio 3
    s_mov_b32 s77, 29370368
    buffer_load_dwordx4 v[80:83], v39, s[36:39], s77 offen sc1
    s_waitcnt lgkmcnt(4)
    v_mfma_f32_16x16x32_bf16 v[160:163], v[216:219], v[104:107], v[160:163]
    ds_read_b64_tr_b16 v[212:213], v43 offset:16384
    v_mfma_f32_16x16x32_bf16 v[192:195], v[216:219], v[108:111], v[192:195]
    ds_read_b64_tr_b16 v[214:215], v43 offset:18432
    s_waitcnt lgkmcnt(4)
    v_mfma_f32_16x16x32_bf16 v[164:167], v[220:223], v[104:107], v[164:167]
    ds_read_b64_tr_b16 v[216:217], v44 offset:16384
    v_mfma_f32_16x16x32_bf16 v[196:199], v[220:223], v[108:111], v[196:199]
    ds_read_b64_tr_b16 v[218:219], v44 offset:18432
    s_setprio 2
    buffer_load_dwordx4 v[84:87], v40, s[36:39], s77 offen sc1
    s_waitcnt vmcnt(16)
    s_waitcnt lgkmcnt(4)
    v_mfma_f32_16x16x32_bf16 v[136:139], v[208:211], v[112:115], v[136:139]
    ds_read_b64_tr_b16 v[220:221], v45 offset:16384
    v_mfma_f32_16x16x32_bf16 v[168:171], v[208:211], v[116:119], v[168:171]
    ds_read_b64_tr_b16 v[222:223], v45 offset:18432
    s_waitcnt lgkmcnt(4)
    v_mfma_f32_16x16x32_bf16 v[140:143], v[212:215], v[112:115], v[140:143]
    ds_read_b64_tr_b16 v[208:209], v42 offset:20480
    v_mfma_f32_16x16x32_bf16 v[172:175], v[212:215], v[116:119], v[172:175]
    ds_read_b64_tr_b16 v[210:211], v42 offset:22528
    s_setprio 1
    s_add_u32 m0, s54, 131072
    s_add_u32 s74, s78, 1114112
    buffer_load_dwordx4 v37, s[28:31], s74 offen lds
    s_waitcnt lgkmcnt(4)
    v_mfma_f32_16x16x32_bf16 v[144:147], v[216:219], v[112:115], v[144:147]
    ds_read_b64_tr_b16 v[212:213], v43 offset:20480
    v_mfma_f32_16x16x32_bf16 v[176:179], v[216:219], v[116:119], v[176:179]
    ds_read_b64_tr_b16 v[214:215], v43 offset:22528
    s_waitcnt lgkmcnt(4)
    v_mfma_f32_16x16x32_bf16 v[148:151], v[220:223], v[112:115], v[148:151]
    ds_read_b64_tr_b16 v[216:217], v44 offset:20480
    v_mfma_f32_16x16x32_bf16 v[180:183], v[220:223], v[116:119], v[180:183]
    ds_read_b64_tr_b16 v[218:219], v44 offset:22528
    s_setprio 0
    s_add_u32 m0, s54, 135168
    s_add_u32 s74, s78, 1114112
    buffer_load_dwordx4 v38, s[28:31], s74 offen lds
    s_waitcnt lgkmcnt(4)
    v_mfma_f32_16x16x32_bf16 v[152:155], v[208:211], v[112:115], v[152:155]
    ds_read_b64_tr_b16 v[220:221], v45 offset:20480
    v_mfma_f32_16x16x32_bf16 v[184:187], v[208:211], v[116:119], v[184:187]
    ds_read_b64_tr_b16 v[222:223], v45 offset:22528
    s_waitcnt lgkmcnt(4)
    v_mfma_f32_16x16x32_bf16 v[156:159], v[212:215], v[112:115], v[156:159]
    s_waitcnt vmcnt(16)
    s_barrier
    ds_read_b64_tr_b16 v[208:209], v42 offset:32768
    v_mfma_f32_16x16x32_bf16 v[188:191], v[212:215], v[116:119], v[188:191]
    ds_read_b64_tr_b16 v[210:211], v42 offset:34816
    s_setprio 3
    s_mov_b32 s77, 29377536
    buffer_load_dwordx4 v[88:91], v39, s[36:39], s77 offen sc1
    s_waitcnt lgkmcnt(4)
    v_mfma_f32_16x16x32_bf16 v[160:163], v[216:219], v[112:115], v[160:163]
    ds_read_b64_tr_b16 v[212:213], v43 offset:32768
    v_mfma_f32_16x16x32_bf16 v[192:195], v[216:219], v[116:119], v[192:195]
    ds_read_b64_tr_b16 v[214:215], v43 offset:34816
    s_setprio 2
    s_waitcnt lgkmcnt(4)
    v_mfma_f32_16x16x32_bf16 v[164:167], v[220:223], v[112:115], v[164:167]
    ds_read_b64_tr_b16 v[216:217], v44 offset:32768
    v_mfma_f32_16x16x32_bf16 v[196:199], v[220:223], v[116:119], v[196:199]
    ds_read_b64_tr_b16 v[218:219], v44 offset:34816
    s_setprio 1
    buffer_load_dwordx4 v[92:95], v40, s[36:39], s77 offen sc1
    s_waitcnt vmcnt(16)
    s_waitcnt lgkmcnt(4)
    v_mfma_f32_16x16x32_bf16 v[136:139], v[208:211], v[120:123], v[136:139]
    ds_read_b64_tr_b16 v[220:221], v45 offset:32768
    v_mfma_f32_16x16x32_bf16 v[168:171], v[208:211], v[124:127], v[168:171]
    ds_read_b64_tr_b16 v[222:223], v45 offset:34816
    s_setprio 0
    s_waitcnt lgkmcnt(4)
    v_mfma_f32_16x16x32_bf16 v[140:143], v[212:215], v[120:123], v[140:143]
    s_waitcnt vmcnt(14)
    s_barrier
    ds_read_b64_tr_b16 v[208:209], v42 offset:49152
    v_mfma_f32_16x16x32_bf16 v[172:175], v[212:215], v[124:127], v[172:175]
    ds_read_b64_tr_b16 v[210:211], v42 offset:51200
    s_setprio 3
    s_add_u32 m0, s54, 147456
    s_add_u32 s74, s78, 1572864
    buffer_load_dwordx4 v37, s[28:31], s74 offen lds
    s_waitcnt lgkmcnt(4)
    v_mfma_f32_16x16x32_bf16 v[144:147], v[216:219], v[120:123], v[144:147]
    ds_read_b64_tr_b16 v[212:213], v43 offset:49152
    v_mfma_f32_16x16x32_bf16 v[176:179], v[216:219], v[124:127], v[176:179]
    ds_read_b64_tr_b16 v[214:215], v43 offset:51200
    s_setprio 2
    s_waitcnt lgkmcnt(4)
    v_mfma_f32_16x16x32_bf16 v[148:151], v[220:223], v[120:123], v[148:151]
    ds_read_b64_tr_b16 v[216:217], v44 offset:49152
    v_mfma_f32_16x16x32_bf16 v[180:183], v[220:223], v[124:127], v[180:183]
    ds_read_b64_tr_b16 v[218:219], v44 offset:51200
    s_setprio 1
    s_add_u32 m0, s54, 151552
    s_add_u32 s74, s78, 1572864
    buffer_load_dwordx4 v38, s[28:31], s74 offen lds
    s_waitcnt vmcnt(14)
    s_waitcnt lgkmcnt(4)
    v_mfma_f32_16x16x32_bf16 v[136:139], v[208:211], v[128:131], v[136:139]
    ds_read_b64_tr_b16 v[220:221], v45 offset:49152
    v_mfma_f32_16x16x32_bf16 v[168:171], v[208:211], v[132:135], v[168:171]
    ds_read_b64_tr_b16 v[222:223], v45 offset:51200
    s_setprio 0
    s_waitcnt lgkmcnt(4)
    v_mfma_f32_16x16x32_bf16 v[140:143], v[212:215], v[128:131], v[140:143]
    s_waitcnt vmcnt(12)
    s_barrier
    ds_read_b64_tr_b16 v[208:209], v46 offset:0
    v_mfma_f32_16x16x32_bf16 v[172:175], v[212:215], v[132:135], v[172:175]
    ds_read_b64_tr_b16 v[210:211], v46 offset:2048
    s_setprio 3
    s_mov_b32 s77, 29384704
    buffer_load_dwordx4 v[96:99], v39, s[36:39], s77 offen sc1
    s_waitcnt lgkmcnt(4)
    v_mfma_f32_16x16x32_bf16 v[144:147], v[216:219], v[128:131], v[144:147]
    ds_read_b64_tr_b16 v[212:213], v47 offset:0
    v_mfma_f32_16x16x32_bf16 v[176:179], v[216:219], v[132:135], v[176:179]
    ds_read_b64_tr_b16 v[214:215], v47 offset:2048
    s_setprio 2
    buffer_load_dwordx4 v[100:103], v40, s[36:39], s77 offen sc1
    s_waitcnt lgkmcnt(4)
    v_mfma_f32_16x16x32_bf16 v[148:151], v[220:223], v[128:131], v[148:151]
    ds_read_b64_tr_b16 v[216:217], v48 offset:0
    v_mfma_f32_16x16x32_bf16 v[180:183], v[220:223], v[132:135], v[180:183]
    ds_read_b64_tr_b16 v[218:219], v48 offset:2048
    s_setprio 1
    s_waitcnt vmcnt(12)
    s_waitcnt lgkmcnt(4)
    v_mfma_f32_16x16x32_bf16 v[136:139], v[208:211], v[72:75], v[136:139]
    ds_read_b64_tr_b16 v[220:221], v49 offset:0
    v_mfma_f32_16x16x32_bf16 v[168:171], v[208:211], v[76:79], v[168:171]
    ds_read_b64_tr_b16 v[222:223], v49 offset:2048
    s_setprio 0
    buffer_load_dwordx4 v[224:227], v2, s[36:39], s55 offen offset:0 sc1
    s_waitcnt lgkmcnt(4)
    v_mfma_f32_16x16x32_bf16 v[140:143], v[212:215], v[72:75], v[140:143]
    s_waitcnt vmcnt(11)
    s_barrier
    ds_read_b64_tr_b16 v[208:209], v46 offset:16384
    v_mfma_f32_16x16x32_bf16 v[172:175], v[212:215], v[76:79], v[172:175]
    ds_read_b64_tr_b16 v[210:211], v46 offset:18432
    s_setprio 3
    s_waitcnt lgkmcnt(4)
    v_mfma_f32_16x16x32_bf16 v[144:147], v[216:219], v[72:75], v[144:147]
    ds_read_b64_tr_b16 v[212:213], v47 offset:16384
    v_mfma_f32_16x16x32_bf16 v[176:179], v[216:219], v[76:79], v[176:179]
    ds_read_b64_tr_b16 v[214:215], v47 offset:18432
    s_setprio 2
    buffer_load_dwordx4 v[228:231], v2, s[36:39], s55 offen offset:1024 sc1
    s_waitcnt lgkmcnt(4)
    v_mfma_f32_16x16x32_bf16 v[148:151], v[220:223], v[72:75], v[148:151]
    ds_read_b64_tr_b16 v[216:217], v48 offset:16384
    v_mfma_f32_16x16x32_bf16 v[180:183], v[220:223], v[76:79], v[180:183]
    ds_read_b64_tr_b16 v[218:219], v48 offset:18432
    s_setprio 1
    s_waitcnt vmcnt(10)
    s_waitcnt lgkmcnt(4)
    v_mfma_f32_16x16x32_bf16 v[136:139], v[208:211], v[80:83], v[136:139]
    ds_read_b64_tr_b16 v[220:221], v49 offset:16384
    v_mfma_f32_16x16x32_bf16 v[168:171], v[208:211], v[84:87], v[168:171]
    ds_read_b64_tr_b16 v[222:223], v49 offset:18432
    s_setprio 0
    s_waitcnt lgkmcnt(4)
    v_mfma_f32_16x16x32_bf16 v[140:143], v[212:215], v[80:83], v[140:143]
    s_waitcnt vmcnt(8)
    s_barrier
    ds_read_b64_tr_b16 v[208:209], v46 offset:32768
    v_mfma_f32_16x16x32_bf16 v[172:175], v[212:215], v[84:87], v[172:175]
    ds_read_b64_tr_b16 v[210:211], v46 offset:34816
    s_setprio 3
    s_waitcnt lgkmcnt(4)
    v_mfma_f32_16x16x32_bf16 v[144:147], v[216:219], v[80:83], v[144:147]
    ds_read_b64_tr_b16 v[212:213], v47 offset:32768
    v_mfma_f32_16x16x32_bf16 v[176:179], v[216:219], v[84:87], v[176:179]
    ds_read_b64_tr_b16 v[214:215], v47 offset:34816
    s_setprio 2
    s_waitcnt lgkmcnt(4)
    v_mfma_f32_16x16x32_bf16 v[148:151], v[220:223], v[80:83], v[148:151]
    ds_read_b64_tr_b16 v[216:217], v48 offset:32768
    v_mfma_f32_16x16x32_bf16 v[180:183], v[220:223], v[84:87], v[180:183]
    ds_read_b64_tr_b16 v[218:219], v48 offset:34816
    s_setprio 1
    s_waitcnt vmcnt(6)
    s_waitcnt lgkmcnt(4)
    v_mfma_f32_16x16x32_bf16 v[136:139], v[208:211], v[88:91], v[136:139]
    ds_read_b64_tr_b16 v[220:221], v49 offset:32768
    v_mfma_f32_16x16x32_bf16 v[168:171], v[208:211], v[92:95], v[168:171]
    ds_read_b64_tr_b16 v[222:223], v49 offset:34816
    s_setprio 0
    s_waitcnt lgkmcnt(4)
    v_mfma_f32_16x16x32_bf16 v[140:143], v[212:215], v[88:91], v[140:143]
    s_waitcnt vmcnt(4)
    s_barrier
    ds_read_b64_tr_b16 v[208:209], v46 offset:49152
    v_mfma_f32_16x16x32_bf16 v[172:175], v[212:215], v[92:95], v[172:175]
    ds_read_b64_tr_b16 v[210:211], v46 offset:51200
    s_setprio 3
    s_waitcnt lgkmcnt(4)
    v_mfma_f32_16x16x32_bf16 v[144:147], v[216:219], v[88:91], v[144:147]
    ds_read_b64_tr_b16 v[212:213], v47 offset:49152
    v_mfma_f32_16x16x32_bf16 v[176:179], v[216:219], v[92:95], v[176:179]
    ds_read_b64_tr_b16 v[214:215], v47 offset:51200
    s_waitcnt lgkmcnt(4)
    v_mfma_f32_16x16x32_bf16 v[148:151], v[220:223], v[88:91], v[148:151]
    ds_read_b64_tr_b16 v[216:217], v48 offset:49152
    v_mfma_f32_16x16x32_bf16 v[180:183], v[220:223], v[92:95], v[180:183]
    ds_read_b64_tr_b16 v[218:219], v48 offset:51200
    s_waitcnt vmcnt(2)
    s_waitcnt lgkmcnt(4)
    v_mfma_f32_16x16x32_bf16 v[136:139], v[208:211], v[96:99], v[136:139]
    ds_read_b64_tr_b16 v[220:221], v49 offset:49152
    v_mfma_f32_16x16x32_bf16 v[168:171], v[208:211], v[100:103], v[168:171]
    ds_read_b64_tr_b16 v[222:223], v49 offset:51200
    s_waitcnt lgkmcnt(4)
    v_mfma_f32_16x16x32_bf16 v[140:143], v[212:215], v[96:99], v[140:143]
    ds_read_b64_tr_b16 v[208:209], v42 offset:36864
    v_mfma_f32_16x16x32_bf16 v[172:175], v[212:215], v[100:103], v[172:175]
    ds_read_b64_tr_b16 v[210:211], v42 offset:38912
    s_waitcnt lgkmcnt(4)
    v_mfma_f32_16x16x32_bf16 v[144:147], v[216:219], v[96:99], v[144:147]
    ds_read_b64_tr_b16 v[212:213], v43 offset:36864
    v_mfma_f32_16x16x32_bf16 v[176:179], v[216:219], v[100:103], v[176:179]
    ds_read_b64_tr_b16 v[214:215], v43 offset:38912
    s_waitcnt lgkmcnt(4)
    v_mfma_f32_16x16x32_bf16 v[148:151], v[220:223], v[96:99], v[148:151]
    ds_read_b64_tr_b16 v[216:217], v44 offset:36864
    v_mfma_f32_16x16x32_bf16 v[180:183], v[220:223], v[100:103], v[180:183]
    ds_read_b64_tr_b16 v[218:219], v44 offset:38912
    s_waitcnt lgkmcnt(4)
    v_mfma_f32_16x16x32_bf16 v[152:155], v[208:211], v[120:123], v[152:155]
    ds_read_b64_tr_b16 v[220:221], v45 offset:36864
    v_mfma_f32_16x16x32_bf16 v[184:187], v[208:211], v[124:127], v[184:187]
    ds_read_b64_tr_b16 v[222:223], v45 offset:38912
    ds_write_b128 v248, v[168:171] offset:0
    s_waitcnt lgkmcnt(5)
    v_mfma_f32_16x16x32_bf16 v[156:159], v[212:215], v[120:123], v[156:159]
    ds_read_b64_tr_b16 v[208:209], v42 offset:53248
    v_mfma_f32_16x16x32_bf16 v[188:191], v[212:215], v[124:127], v[188:191]
    ds_read_b64_tr_b16 v[210:211], v42 offset:55296
    s_setprio 2
    ds_write_b128 v248, v[172:175] offset:1024
    s_waitcnt lgkmcnt(6)
    v_mfma_f32_16x16x32_bf16 v[160:163], v[216:219], v[120:123], v[160:163]
    ds_read_b64_tr_b16 v[212:213], v43 offset:53248
    v_mfma_f32_16x16x32_bf16 v[192:195], v[216:219], v[124:127], v[192:195]
    ds_read_b64_tr_b16 v[214:215], v43 offset:55296
    ds_write_b128 v248, v[176:179] offset:2048
    s_waitcnt lgkmcnt(7)
    v_mfma_f32_16x16x32_bf16 v[164:167], v[220:223], v[120:123], v[164:167]
    ds_read_b64_tr_b16 v[216:217], v44 offset:53248
    v_mfma_f32_16x16x32_bf16 v[196:199], v[220:223], v[124:127], v[196:199]
    ds_read_b64_tr_b16 v[218:219], v44 offset:55296
    ds_write_b128 v248, v[180:183] offset:3072
    s_waitcnt lgkmcnt(7)
    v_mfma_f32_16x16x32_bf16 v[152:155], v[208:211], v[128:131], v[152:155]
    ds_read_b64_tr_b16 v[220:221], v45 offset:53248
    v_mfma_f32_16x16x32_bf16 v[184:187], v[208:211], v[132:135], v[184:187]
    ds_read_b64_tr_b16 v[222:223], v45 offset:55296
    s_waitcnt lgkmcnt(6)
    v_mfma_f32_16x16x32_bf16 v[156:159], v[212:215], v[128:131], v[156:159]
    ds_read_b64_tr_b16 v[208:209], v46 offset:4096
    v_mfma_f32_16x16x32_bf16 v[188:191], v[212:215], v[132:135], v[188:191]
    ds_read_b64_tr_b16 v[210:211], v46 offset:6144
    s_waitcnt lgkmcnt(4)
    s_barrier
    ds_read_b128 v[168:171], v249 offset:0
    ds_read_b128 v[172:175], v249 offset:1024
    v_mfma_f32_16x16x32_bf16 v[160:163], v[216:219], v[128:131], v[160:163]
    ds_read_b64_tr_b16 v[212:213], v47 offset:4096
    v_mfma_f32_16x16x32_bf16 v[192:195], v[216:219], v[132:135], v[192:195]
    ds_read_b64_tr_b16 v[214:215], v47 offset:6144
    ds_read_b128 v[176:179], v249 offset:2048
    ds_read_b128 v[180:183], v249 offset:3072
    s_waitcnt lgkmcnt(8)
    v_mfma_f32_16x16x32_bf16 v[164:167], v[220:223], v[128:131], v[164:167]
    ds_read_b64_tr_b16 v[216:217], v48 offset:4096
    v_mfma_f32_16x16x32_bf16 v[196:199], v[220:223], v[132:135], v[196:199]
    ds_read_b64_tr_b16 v[218:219], v48 offset:6144
    s_waitcnt lgkmcnt(8)
    v_mfma_f32_16x16x32_bf16 v[152:155], v[208:211], v[72:75], v[152:155]
    ds_read_b64_tr_b16 v[220:221], v49 offset:4096
    v_mfma_f32_16x16x32_bf16 v[184:187], v[208:211], v[76:79], v[184:187]
    ds_read_b64_tr_b16 v[222:223], v49 offset:6144
    s_waitcnt lgkmcnt(9)
    v_add_f32 v136, v136, v168
    v_add_f32 v137, v137, v169
    v_add_f32 v138, v138, v170
    v_add_f32 v139, v139, v171
    v_cvt_pk_bf16_f32 v240, v136, v137
    v_cvt_pk_bf16_f32 v241, v138, v139
    v_min_u32 v240, -2, v240
    v_min_u32 v241, -2, v241
    s_waitcnt lgkmcnt(6)
    v_mfma_f32_16x16x32_bf16 v[156:159], v[212:215], v[72:75], v[156:159]
    ds_read_b64_tr_b16 v[208:209], v46 offset:20480
    v_mfma_f32_16x16x32_bf16 v[188:191], v[212:215], v[76:79], v[188:191]
    ds_read_b64_tr_b16 v[210:211], v46 offset:22528
    s_setprio 1
    v_add_f32 v140, v140, v172
    v_add_f32 v141, v141, v173
    v_add_f32 v142, v142, v174
    v_add_f32 v143, v143, v175
    v_cvt_pk_bf16_f32 v242, v140, v141
    v_cvt_pk_bf16_f32 v243, v142, v143
    v_min_u32 v242, -2, v242
    v_min_u32 v243, -2, v243
    buffer_store_dwordx4 v[240:243], v2, s[36:39], s57 offen offset:0 sc1
    s_waitcnt lgkmcnt(4)
    v_mfma_f32_16x16x32_bf16 v[160:163], v[216:219], v[72:75], v[160:163]
    ds_read_b64_tr_b16 v[212:213], v47 offset:20480
    v_mfma_f32_16x16x32_bf16 v[192:195], v[216:219], v[76:79], v[192:195]
    ds_read_b64_tr_b16 v[214:215], v47 offset:22528
    v_add_f32 v144, v144, v176
    v_add_f32 v145, v145, v177
    v_add_f32 v146, v146, v178
    v_add_f32 v147, v147, v179
    v_cvt_pk_bf16_f32 v244, v144, v145
    v_cvt_pk_bf16_f32 v245, v146, v147
    v_min_u32 v244, -2, v244
    v_min_u32 v245, -2, v245
    s_waitcnt lgkmcnt(4)
    v_mfma_f32_16x16x32_bf16 v[164:167], v[220:223], v[72:75], v[164:167]
    ds_read_b64_tr_b16 v[216:217], v48 offset:20480
    v_mfma_f32_16x16x32_bf16 v[196:199], v[220:223], v[76:79], v[196:199]
    ds_read_b64_tr_b16 v[218:219], v48 offset:22528
    v_add_f32 v148, v148, v180
    v_add_f32 v149, v149, v181
    v_add_f32 v150, v150, v182
    v_add_f32 v151, v151, v183
    v_cvt_pk_bf16_f32 v246, v148, v149
    v_cvt_pk_bf16_f32 v247, v150, v151
    v_min_u32 v246, -2, v246
    v_min_u32 v247, -2, v247
    buffer_store_dwordx4 v[244:247], v2, s[36:39], s57 offen offset:1024 sc1
    s_waitcnt lgkmcnt(4)
    v_mfma_f32_16x16x32_bf16 v[152:155], v[208:211], v[80:83], v[152:155]
    ds_read_b64_tr_b16 v[220:221], v49 offset:20480
    v_mfma_f32_16x16x32_bf16 v[184:187], v[208:211], v[84:87], v[184:187]
    ds_read_b64_tr_b16 v[222:223], v49 offset:22528
    s_waitcnt lgkmcnt(4)
    v_mfma_f32_16x16x32_bf16 v[156:159], v[212:215], v[80:83], v[156:159]
    ds_read_b64_tr_b16 v[208:209], v46 offset:36864
    v_mfma_f32_16x16x32_bf16 v[188:191], v[212:215], v[84:87], v[188:191]
    ds_read_b64_tr_b16 v[210:211], v46 offset:38912
    s_waitcnt lgkmcnt(4)
    v_mfma_f32_16x16x32_bf16 v[160:163], v[216:219], v[80:83], v[160:163]
    ds_read_b64_tr_b16 v[212:213], v47 offset:36864
    v_mfma_f32_16x16x32_bf16 v[192:195], v[216:219], v[84:87], v[192:195]
    ds_read_b64_tr_b16 v[214:215], v47 offset:38912
    s_waitcnt lgkmcnt(4)
    v_mfma_f32_16x16x32_bf16 v[164:167], v[220:223], v[80:83], v[164:167]
    ds_read_b64_tr_b16 v[216:217], v48 offset:36864
    v_mfma_f32_16x16x32_bf16 v[196:199], v[220:223], v[84:87], v[196:199]
    ds_read_b64_tr_b16 v[218:219], v48 offset:38912
    s_waitcnt lgkmcnt(4)
    v_mfma_f32_16x16x32_bf16 v[152:155], v[208:211], v[88:91], v[152:155]
    ds_read_b64_tr_b16 v[220:221], v49 offset:36864
    v_mfma_f32_16x16x32_bf16 v[184:187], v[208:211], v[92:95], v[184:187]
    ds_read_b64_tr_b16 v[222:223], v49 offset:38912
    s_waitcnt lgkmcnt(4)
    v_mfma_f32_16x16x32_bf16 v[156:159], v[212:215], v[88:91], v[156:159]
    ds_read_b64_tr_b16 v[208:209], v46 offset:53248
    v_mfma_f32_16x16x32_bf16 v[188:191], v[212:215], v[92:95], v[188:191]
    ds_read_b64_tr_b16 v[210:211], v46 offset:55296
    s_setprio 0
    s_waitcnt lgkmcnt(4)
    v_mfma_f32_16x16x32_bf16 v[160:163], v[216:219], v[88:91], v[160:163]
    ds_read_b64_tr_b16 v[212:213], v47 offset:53248
    v_mfma_f32_16x16x32_bf16 v[192:195], v[216:219], v[92:95], v[192:195]
    ds_read_b64_tr_b16 v[214:215], v47 offset:55296
    s_waitcnt lgkmcnt(4)
    v_mfma_f32_16x16x32_bf16 v[164:167], v[220:223], v[88:91], v[164:167]
    ds_read_b64_tr_b16 v[216:217], v48 offset:53248
    v_mfma_f32_16x16x32_bf16 v[196:199], v[220:223], v[92:95], v[196:199]
    ds_read_b64_tr_b16 v[218:219], v48 offset:55296
    s_waitcnt lgkmcnt(4)
    v_mfma_f32_16x16x32_bf16 v[152:155], v[208:211], v[96:99], v[152:155]
    ds_read_b64_tr_b16 v[220:221], v49 offset:53248
    v_mfma_f32_16x16x32_bf16 v[184:187], v[208:211], v[100:103], v[184:187]
    ds_read_b64_tr_b16 v[222:223], v49 offset:55296
    s_waitcnt lgkmcnt(4)
    v_mfma_f32_16x16x32_bf16 v[156:159], v[212:215], v[96:99], v[156:159]
    v_mfma_f32_16x16x32_bf16 v[188:191], v[212:215], v[100:103], v[188:191]
    s_waitcnt lgkmcnt(2)
    v_mfma_f32_16x16x32_bf16 v[160:163], v[216:219], v[96:99], v[160:163]
    v_mfma_f32_16x16x32_bf16 v[192:195], v[216:219], v[100:103], v[192:195]
    s_waitcnt lgkmcnt(0)
    v_mfma_f32_16x16x32_bf16 v[164:167], v[220:223], v[96:99], v[164:167]
    v_mfma_f32_16x16x32_bf16 v[196:199], v[220:223], v[100:103], v[196:199]
    buffer_load_dwordx4 v[232:235], v2, s[36:39], s58 offen offset:0 sc1
qa_kernel_WS1_14:
    s_cbranch_execz qa_kernel_WRET1
    buffer_load_dwordx4 v[236:239], v2, s[36:39], s58 offen offset:1024 sc1
    ds_write_b128 v250, v[184:187] offset:0
    ds_write_b128 v250, v[188:191] offset:1024
    s_nop 0
    ds_write_b128 v250, v[192:195] offset:2048
    s_nop 1
    ds_write_b128 v250, v[196:199] offset:3072
    s_waitcnt vmcnt(4)
    v_max3_u32 v3, v224, v225, v226
    v_max3_u32 v4, v227, v228, v229
    v_max3_u32 v3, v3, v230, v231
    v_max_u32 v3, v3, v4
    v_cmp_eq_u32 vcc, -1, v3
    s_cbranch_vccnz qa_kernel_RS_R
qa_kernel_RS_G:
    v_lshlrev_b32 v72, 16, v224
    v_and_b32 v73, 0xffff0000, v224
    v_lshlrev_b32 v74, 16, v225
    v_and_b32 v75, 0xffff0000, v225
    v_lshlrev_b32 v76, 16, v226
    v_and_b32 v77, 0xffff0000, v226
    v_lshlrev_b32 v78, 16, v227
    v_and_b32 v79, 0xffff0000, v227
    v_lshlrev_b32 v80, 16, v228
    v_and_b32 v81, 0xffff0000, v228
    v_lshlrev_b32 v82, 16, v229
    v_and_b32 v83, 0xffff0000, v229
    v_lshlrev_b32 v84, 16, v230
    v_and_b32 v85, 0xffff0000, v230
    v_lshlrev_b32 v86, 16, v231
    v_and_b32 v87, 0xffff0000, v231
    s_waitcnt lgkmcnt(0)
    s_barrier
    ds_read_b128 v[184:187], v251 offset:0
    ds_read_b128 v[188:191], v251 offset:1024
    ds_read_b128 v[192:195], v251 offset:2048
    ds_read_b128 v[196:199], v251 offset:3072
    v_add_f32 v152, v152, v72
    v_add_f32 v153, v153, v73
    v_add_f32 v154, v154, v74
    v_add_f32 v155, v155, v75
    v_add_f32 v156, v156, v76
    v_add_f32 v157, v157, v77
    v_add_f32 v158, v158, v78
    v_add_f32 v159, v159, v79
    v_add_f32 v160, v160, v80
    v_add_f32 v161, v161, v81
    v_add_f32 v162, v162, v82
    v_add_f32 v163, v163, v83
    v_add_f32 v164, v164, v84
    v_add_f32 v165, v165, v85
    v_add_f32 v166, v166, v86
    v_add_f32 v167, v167, v87
    s_waitcnt lgkmcnt(0)
    v_add_f32 v152, v152, v184
    v_add_f32 v153, v153, v185
    v_add_f32 v154, v154, v186
    v_add_f32 v155, v155, v187
    v_add_f32 v156, v156, v188
    v_add_f32 v157, v157, v189
    v_add_f32 v158, v158, v190
    v_add_f32 v159, v159, v191
    v_add_f32 v160, v160, v192
    v_add_f32 v161, v161, v193
    v_add_f32 v162, v162, v194
    v_add_f32 v163, v163, v195
    v_add_f32 v164, v164, v196
    v_add_f32 v165, v165, v197
    v_add_f32 v166, v166, v198
    v_add_f32 v167, v167, v199
    s_mov_b32 s62, 262144
    s_branch qa_kernel_POLL0_E
qa_kernel_POLL0:
    buffer_load_dwordx4 v[232:235], v2, s[36:39], s58 offen offset:0 sc1
    buffer_load_dwordx4 v[236:239], v2, s[36:39], s58 offen offset:1024 sc1
qa_kernel_POLL0_E:
    s_waitcnt vmcnt(0)
    v_max3_u32 v3, v232, v233, v234
    v_max3_u32 v4, v235, v236, v237
    v_max3_u32 v3, v3, v238, v239
    v_max_u32 v3, v3, v4
    v_cmp_eq_u32 vcc, -1, v3
    s_sub_u32 s62, s62, 1
    s_cselect_b64 vcc, 0, vcc
    s_cbranch_vccnz qa_kernel_POLL0
    v_lshlrev_b32 v136, 16, v232
    v_and_b32 v137, 0xffff0000, v232
    v_lshlrev_b32 v138, 16, v233
    v_and_b32 v139, 0xffff0000, v233
    v_lshlrev_b32 v140, 16, v234
    v_and_b32 v141, 0xffff0000, v234
    v_lshlrev_b32 v142, 16, v235
    v_and_b32 v143, 0xffff0000, v235
    v_lshlrev_b32 v144, 16, v236
    v_and_b32 v145, 0xffff0000, v236
    v_lshlrev_b32 v146, 16, v237
    v_and_b32 v147, 0xffff0000, v237
    v_lshlrev_b32 v148, 16, v238
    v_and_b32 v149, 0xffff0000, v238
    v_lshlrev_b32 v150, 16, v239
    v_and_b32 v151, 0xffff0000, v239
    v_add_f32 v152, v152, v136
    v_add_f32 v153, v153, v137
    v_add_f32 v154, v154, v138
    v_add_f32 v155, v155, v139
    v_add_f32 v156, v156, v140
    v_add_f32 v157, v157, v141
    v_add_f32 v158, v158, v142
    v_add_f32 v159, v159, v143
    v_cvt_pk_bf16_f32 v208, v152, v153
    v_cvt_pk_bf16_f32 v209, v154, v155
    v_cvt_pk_bf16_f32 v210, v156, v157
    v_cvt_pk_bf16_f32 v211, v158, v159
    s_nop 0
    v_permlane16_swap_b32 v208, v210
    v_permlane16_swap_b32 v209, v211
    buffer_store_dwordx4 v[208:211], v50, s[40:43], 0 offen offset:0
    v_add_f32 v160, v160, v144
    v_add_f32 v161, v161, v145
    v_add_f32 v162, v162, v146
    v_add_f32 v163, v163, v147
    v_add_f32 v164, v164, v148
    v_add_f32 v165, v165, v149
    v_add_f32 v166, v166, v150
    v_add_f32 v167, v167, v151
    v_cvt_pk_bf16_f32 v212, v160, v161
    v_cvt_pk_bf16_f32 v213, v162, v163
    v_cvt_pk_bf16_f32 v214, v164, v165
    v_cvt_pk_bf16_f32 v215, v166, v167
    s_nop 0
    v_permlane16_swap_b32 v212, v214
    v_permlane16_swap_b32 v213, v215
    buffer_store_dwordx4 v[212:215], v50, s[40:43], 0 offen offset:64
    s_endpgm
qa_kernel_SLOW:
    v_mov_b32 v196, 0xff800000
    s_mov_b32 s59, s58
    s_mov_b32 s62, 64
qa_kernel_S1:
    buffer_load_dwordx4 v[144:147], v2, s[36:39], s59 offen offset:0 sc1
    buffer_load_dwordx4 v[148:151], v2, s[36:39], s59 offen offset:1024 sc1
    s_waitcnt vmcnt(0)
    v_mfma_f32_32x32x16_bf16 v[68:83], v[144:147], v[8:11], 0
    v_mfma_f32_32x32x16_bf16 v[68:83], v[148:151], v[12:15], v[68:83]
    s_nop 11
    v_max3_f32 v3, v68, v69, v70
    v_max3_f32 v3, v3, v71, v72
    v_max3_f32 v3, v3, v73, v74
    v_max3_f32 v3, v3, v75, v76
    v_max3_f32 v3, v3, v77, v78
    v_max3_f32 v3, v3, v79, v80
    v_max3_f32 v3, v3, v81, v82
    v_max_f32 v3, v3, v83
    v_max_f32 v196, v196, v3
    s_add_u32 s59, s59, 4096
    s_sub_u32 s62, s62, 1
    s_cmp_lg_u32 s62, 0
    s_cbranch_scc1 qa_kernel_S1
    v_mov_b32 v4, v196
    s_nop 1
    v_permlane32_swap_b32 v196, v4
    v_max_f32 v196, v196, v4
    v_sub_f32 v100, 0, v196
    v_sub_f32 v101, 0, v196
    v_sub_f32 v102, 0, v196
    v_sub_f32 v103, 0, v196
    v_sub_f32 v104, 0, v196
    v_sub_f32 v105, 0, v196
    v_sub_f32 v106, 0, v196
    v_sub_f32 v107, 0, v196
    v_sub_f32 v108, 0, v196
    v_sub_f32 v109, 0, v196
    v_sub_f32 v110, 0, v196
    v_sub_f32 v111, 0, v196
    v_sub_f32 v112, 0, v196
    v_sub_f32 v113, 0, v196
    v_sub_f32 v114, 0, v196
    v_sub_f32 v115, 0, v196
    v_mov_b32 v116, 0
    v_mov_b32 v117, 0
    v_mov_b32 v118, 0
    v_mov_b32 v119, 0
    v_mov_b32 v120, 0
    v_mov_b32 v121, 0
    v_mov_b32 v122, 0
    v_mov_b32 v123, 0
    v_mov_b32 v124, 0
    v_mov_b32 v125, 0
    v_mov_b32 v126, 0
    v_mov_b32 v127, 0
    v_mov_b32 v128, 0
    v_mov_b32 v129, 0
    v_mov_b32 v130, 0
    v_mov_b32 v131, 0
    v_mov_b32 v132, 0
    v_mov_b32 v133, 0
    v_mov_b32 v134, 0
    v_mov_b32 v135, 0
    s_mov_b32 s59, s58
    s_mov_b32 s62, 64
qa_kernel_S2:
    buffer_load_dwordx4 v[144:147], v2, s[36:39], s59 offen offset:0 sc1
    buffer_load_dwordx4 v[148:151], v2, s[36:39], s59 offen offset:1024 sc1
    buffer_load_dwordx4 v[160:163], v2, s[36:39], s59 offen offset:2048 sc1
    buffer_load_dwordx4 v[164:167], v2, s[36:39], s59 offen offset:3072 sc1
    s_waitcnt vmcnt(0)
    v_mfma_f32_32x32x16_bf16 v[68:83], v[144:147], v[8:11], v[100:115]
    v_mfma_f32_32x32x16_bf16 v[68:83], v[148:151], v[12:15], v[68:83]
    s_nop 11
    v_exp_f32 v68, v68
    v_exp_f32 v69, v69
    v_exp_f32 v70, v70
    v_exp_f32 v71, v71
    v_exp_f32 v72, v72
    v_exp_f32 v73, v73
    v_exp_f32 v74, v74
    v_exp_f32 v75, v75
    v_exp_f32 v76, v76
    v_exp_f32 v77, v77
    v_exp_f32 v78, v78
    v_exp_f32 v79, v79
    v_exp_f32 v80, v80
    v_exp_f32 v81, v81
    v_exp_f32 v82, v82
    v_exp_f32 v83, v83
    v_cvt_pk_bf16_f32 v136, v68, v69
    v_cvt_pk_bf16_f32 v137, v70, v71
    v_cvt_pk_bf16_f32 v138, v72, v73
    v_cvt_pk_bf16_f32 v139, v74, v75
    v_cvt_pk_bf16_f32 v140, v76, v77
    v_cvt_pk_bf16_f32 v141, v78, v79
    v_cvt_pk_bf16_f32 v142, v80, v81
    v_cvt_pk_bf16_f32 v143, v82, v83
    v_mfma_f32_32x32x16_bf16 v[116:131], v[160:163], v[136:139], v[116:131]
    s_nop 0
    v_mfma_f32_32x32x16_bf16 v[116:131], v[164:167], v[140:143], v[116:131]
    v_smfmac_f32_16x16x64_bf16 v[132:135], v[36:39], v[136:143], v197
    s_add_u32 s59, s59, 4096
    s_sub_u32 s62, s62, 1
    s_cmp_lg_u32 s62, 0
    s_cbranch_scc1 qa_kernel_S2
    s_nop 15
    v_add_f32 v132, v132, v133
    s_branch qa_kernel_OUT
qa_kernel_F0_A4_R:
    s_mov_b32 s47, 20975616
    buffer_load_dwordx4 v[240:243], v15, s[36:39], s47 offen offset:0 sc1
    s_mov_b32 s47, 20975616
    buffer_load_dwordx4 v[244:247], v16, s[36:39], s47 offen offset:0 sc1
    s_mov_b32 s47, 20975616
    buffer_load_dwordx4 v[248:251], v15, s[36:39], s47 offen offset:1024 sc1
    s_mov_b32 s47, 20975616
    buffer_load_dwordx4 v[252:255], v16, s[36:39], s47 offen offset:1024 sc1
    s_waitcnt vmcnt(0)
    v_max3_u32 v12, v240, v241, v242
    v_max3_u32 v13, v243, v244, v245
    v_max3_u32 v12, v12, v246, v247
    v_max_u32 v12, v12, v13
    v_cmp_eq_u32 vcc, -1, v12
    s_sub_u32 s62, s62, 1
    s_cselect_b64 vcc, 0, vcc
    s_cselect_b32 s62, 0, s62
    s_cbranch_vccnz qa_kernel_F0_A4_R
    s_mov_b32 s47, 20975616
    buffer_load_dwordx4 v[208:211], v15, s[36:39], s47 offen offset:2048 sc1
    s_branch qa_kernel_F0_A4_G
qa_kernel_F0_A5_R:
    s_mov_b32 s47, 20975616
    buffer_load_dwordx4 v[248:251], v15, s[36:39], s47 offen offset:1024 sc1
    s_mov_b32 s47, 20975616
    buffer_load_dwordx4 v[252:255], v16, s[36:39], s47 offen offset:1024 sc1
    s_mov_b32 s47, 20975616
    buffer_load_dwordx4 v[208:211], v15, s[36:39], s47 offen offset:2048 sc1
    s_waitcnt vmcnt(0)
    v_max3_u32 v12, v248, v249, v250
    v_max3_u32 v13, v251, v252, v253
    v_max3_u32 v12, v12, v254, v255
    v_max_u32 v12, v12, v13
    v_cmp_eq_u32 vcc, -1, v12
    s_sub_u32 s62, s62, 1
    s_cselect_b64 vcc, 0, vcc
    s_cselect_b32 s62, 0, s62
    s_cbranch_vccnz qa_kernel_F0_A5_R
    s_branch qa_kernel_F0_A5_G
qa_kernel_CK0_R:
    s_cmp_lg_u32 s24, 0
    s_cbranch_scc1 qa_kernel_CK0_G
    s_mov_b32 m0, 151552
    s_nop 0
    buffer_load_dwordx4 v26, s[36:39], s64 offen sc1 lds
    s_waitcnt vmcnt(0)
    ds_read_b128 v[184:187], v188 offset:20480
    s_waitcnt lgkmcnt(0)
    v_max3_u32 v12, v184, v185, v186
    v_max_u32 v12, v12, v187
    v_cmp_eq_u32 vcc, -1, v12
    s_sub_u32 s62, s62, 1
    s_cselect_b64 vcc, 0, vcc
    s_cselect_b32 s62, 0, s62
    s_cbranch_vccnz qa_kernel_CK0_R
    s_branch qa_kernel_CK0_G
qa_kernel_F0_A6_R:
    s_mov_b32 s47, 20975616
    buffer_load_dwordx4 v[208:211], v15, s[36:39], s47 offen offset:2048 sc1
    s_mov_b32 s47, 20975616
    buffer_load_dwordx4 v[212:215], v16, s[36:39], s47 offen offset:2048 sc1
    s_mov_b32 s47, 20975616
    buffer_load_dwordx4 v[216:219], v15, s[36:39], s47 offen offset:3072 sc1
    s_mov_b32 s47, 20975616
    buffer_load_dwordx4 v[220:223], v16, s[36:39], s47 offen offset:3072 sc1
    s_waitcnt vmcnt(0)
    v_max3_u32 v12, v208, v209, v210
    v_max3_u32 v13, v211, v212, v213
    v_max3_u32 v12, v12, v214, v215
    v_max_u32 v12, v12, v13
    v_cmp_eq_u32 vcc, -1, v12
    s_sub_u32 s62, s62, 1
    s_cselect_b64 vcc, 0, vcc
    s_cselect_b32 s62, 0, s62
    s_cbranch_vccnz qa_kernel_F0_A6_R
    s_mov_b32 s47, 20979712
    buffer_load_dwordx4 v[224:227], v15, s[36:39], s47 offen offset:0 sc1
    s_mov_b32 s47, 20979712
    buffer_load_dwordx4 v[228:231], v16, s[36:39], s47 offen offset:0 sc1
    s_mov_b32 s47, 20979712
    buffer_load_dwordx4 v[232:235], v15, s[36:39], s47 offen offset:1024 sc1
    s_branch qa_kernel_F0_A6_G
qa_kernel_F0_A7_R:
    s_mov_b32 s47, 20975616
    buffer_load_dwordx4 v[216:219], v15, s[36:39], s47 offen offset:3072 sc1
    s_mov_b32 s47, 20975616
    buffer_load_dwordx4 v[220:223], v16, s[36:39], s47 offen offset:3072 sc1
    s_mov_b32 s47, 20979712
    buffer_load_dwordx4 v[224:227], v15, s[36:39], s47 offen offset:0 sc1
    s_mov_b32 s47, 20979712
    buffer_load_dwordx4 v[228:231], v16, s[36:39], s47 offen offset:0 sc1
    s_waitcnt vmcnt(0)
    v_max3_u32 v12, v216, v217, v218
    v_max3_u32 v13, v219, v220, v221
    v_max3_u32 v12, v12, v222, v223
    v_max_u32 v12, v12, v13
    v_cmp_eq_u32 vcc, -1, v12
    s_sub_u32 s62, s62, 1
    s_cselect_b64 vcc, 0, vcc
    s_cselect_b32 s62, 0, s62
    s_cbranch_vccnz qa_kernel_F0_A7_R
    s_mov_b32 s47, 20979712
    buffer_load_dwordx4 v[232:235], v15, s[36:39], s47 offen offset:1024 sc1
    s_branch qa_kernel_F0_A7_G
qa_kernel_F0_A8_R:
    s_mov_b32 s47, 20979712
    buffer_load_dwordx4 v[224:227], v15, s[36:39], s47 offen offset:0 sc1
    s_mov_b32 s47, 20979712
    buffer_load_dwordx4 v[228:231], v16, s[36:39], s47 offen offset:0 sc1
    s_mov_b32 s47, 20979712
    buffer_load_dwordx4 v[232:235], v15, s[36:39], s47 offen offset:1024 sc1
    s_mov_b32 s47, 20979712
    buffer_load_dwordx4 v[236:239], v16, s[36:39], s47 offen offset:1024 sc1
    s_waitcnt vmcnt(0)
    v_max3_u32 v12, v224, v225, v226
    v_max3_u32 v13, v227, v228, v229
    v_max3_u32 v12, v12, v230, v231
    v_max_u32 v12, v12, v13
    v_cmp_eq_u32 vcc, -1, v12
    s_sub_u32 s62, s62, 1
    s_cselect_b64 vcc, 0, vcc
    s_cselect_b32 s62, 0, s62
    s_cbranch_vccnz qa_kernel_F0_A8_R
    s_mov_b32 s47, 20979712
    buffer_load_dwordx4 v[240:243], v15, s[36:39], s47 offen offset:2048 sc1
    s_mov_b32 s47, 20979712
    buffer_load_dwordx4 v[244:247], v16, s[36:39], s47 offen offset:2048 sc1
    s_mov_b32 s47, 20979712
    buffer_load_dwordx4 v[248:251], v15, s[36:39], s47 offen offset:3072 sc1
    s_mov_b32 s47, 20979712
    buffer_load_dwordx4 v[252:255], v16, s[36:39], s47 offen offset:3072 sc1
    buffer_load_dword v14, v2, s[36:39], 0 offen
    s_branch qa_kernel_F0_A8_G
qa_kernel_F0_A9_R:
    s_mov_b32 s47, 20979712
    buffer_load_dwordx4 v[232:235], v15, s[36:39], s47 offen offset:1024 sc1
    s_mov_b32 s47, 20979712
    buffer_load_dwordx4 v[236:239], v16, s[36:39], s47 offen offset:1024 sc1
    s_mov_b32 s47, 20979712
    buffer_load_dwordx4 v[240:243], v15, s[36:39], s47 offen offset:2048 sc1
    s_mov_b32 s47, 20979712
    buffer_load_dwordx4 v[244:247], v16, s[36:39], s47 offen offset:2048 sc1
    s_waitcnt vmcnt(0)
    v_max3_u32 v12, v232, v233, v234
    v_max3_u32 v13, v235, v236, v237
    v_max3_u32 v12, v12, v238, v239
    v_max_u32 v12, v12, v13
    v_cmp_eq_u32 vcc, -1, v12
    s_sub_u32 s62, s62, 1
    s_cselect_b64 vcc, 0, vcc
    s_cselect_b32 s62, 0, s62
    s_cbranch_vccnz qa_kernel_F0_A9_R
    s_mov_b32 s47, 20979712
    buffer_load_dwordx4 v[248:251], v15, s[36:39], s47 offen offset:3072 sc1
    s_mov_b32 s47, 20979712
    buffer_load_dwordx4 v[252:255], v16, s[36:39], s47 offen offset:3072 sc1
    buffer_load_dword v14, v2, s[36:39], 0 offen
    s_branch qa_kernel_F0_A9_G
qa_kernel_F0_A10_R:
    s_mov_b32 s47, 20979712
    buffer_load_dwordx4 v[240:243], v15, s[36:39], s47 offen offset:2048 sc1
    s_mov_b32 s47, 20979712
    buffer_load_dwordx4 v[244:247], v16, s[36:39], s47 offen offset:2048 sc1
    s_mov_b32 s47, 20979712
    buffer_load_dwordx4 v[248:251], v15, s[36:39], s47 offen offset:3072 sc1
    s_mov_b32 s47, 20979712
    buffer_load_dwordx4 v[252:255], v16, s[36:39], s47 offen offset:3072 sc1
    s_waitcnt vmcnt(0)
    v_max3_u32 v12, v240, v241, v242
    v_max3_u32 v13, v243, v244, v245
    v_max3_u32 v12, v12, v246, v247
    v_max_u32 v12, v12, v13
    v_cmp_eq_u32 vcc, -1, v12
    s_sub_u32 s62, s62, 1
    s_cselect_b64 vcc, 0, vcc
    s_cselect_b32 s62, 0, s62
    s_cbranch_vccnz qa_kernel_F0_A10_R
    s_mov_b32 s47, 20983808
    buffer_load_dwordx4 v[208:211], v15, s[36:39], s47 offen offset:0 sc1
    s_mov_b32 s47, 20983808
    buffer_load_dwordx4 v[212:215], v16, s[36:39], s47 offen offset:0 sc1
    s_mov_b32 s47, 20983808
    buffer_load_dwordx4 v[216:219], v15, s[36:39], s47 offen offset:1024 sc1
    s_mov_b32 s47, 20983808
    buffer_load_dwordx4 v[220:223], v16, s[36:39], s47 offen offset:1024 sc1
    buffer_load_dword v14, v2, s[36:39], 0 offen
    buffer_load_dword v14, v2, s[36:39], 0 offen
    buffer_load_dword v14, v2, s[36:39], 0 offen
    s_branch qa_kernel_F0_A10_G
qa_kernel_F0_A11_R:
    s_mov_b32 s47, 20979712
    buffer_load_dwordx4 v[248:251], v15, s[36:39], s47 offen offset:3072 sc1
    s_mov_b32 s47, 20979712
    buffer_load_dwordx4 v[252:255], v16, s[36:39], s47 offen offset:3072 sc1
    s_mov_b32 s47, 20983808
    buffer_load_dwordx4 v[208:211], v15, s[36:39], s47 offen offset:0 sc1
    s_mov_b32 s47, 20983808
    buffer_load_dwordx4 v[212:215], v16, s[36:39], s47 offen offset:0 sc1
    s_waitcnt vmcnt(0)
    v_max3_u32 v12, v248, v249, v250
    v_max3_u32 v13, v251, v252, v253
    v_max3_u32 v12, v12, v254, v255
    v_max_u32 v12, v12, v13
    v_cmp_eq_u32 vcc, -1, v12
    s_sub_u32 s62, s62, 1
    s_cselect_b64 vcc, 0, vcc
    s_cselect_b32 s62, 0, s62
    s_cbranch_vccnz qa_kernel_F0_A11_R
    s_mov_b32 s47, 20983808
    buffer_load_dwordx4 v[216:219], v15, s[36:39], s47 offen offset:1024 sc1
    s_mov_b32 s47, 20983808
    buffer_load_dwordx4 v[220:223], v16, s[36:39], s47 offen offset:1024 sc1
    buffer_load_dword v14, v2, s[36:39], 0 offen
    buffer_load_dword v14, v2, s[36:39], 0 offen
    buffer_load_dword v14, v2, s[36:39], 0 offen
    s_branch qa_kernel_F0_A11_G
qa_kernel_F0_A12_R:
    s_mov_b32 s47, 20983808
    buffer_load_dwordx4 v[208:211], v15, s[36:39], s47 offen offset:0 sc1
    s_mov_b32 s47, 20983808
    buffer_load_dwordx4 v[212:215], v16, s[36:39], s47 offen offset:0 sc1
    s_mov_b32 s47, 20983808
    buffer_load_dwordx4 v[216:219], v15, s[36:39], s47 offen offset:1024 sc1
    s_mov_b32 s47, 20983808
    buffer_load_dwordx4 v[220:223], v16, s[36:39], s47 offen offset:1024 sc1
    s_waitcnt vmcnt(0)
    v_max3_u32 v12, v208, v209, v210
    v_max3_u32 v13, v211, v212, v213
    v_max3_u32 v12, v12, v214, v215
    v_max_u32 v12, v12, v13
    v_cmp_eq_u32 vcc, -1, v12
    s_sub_u32 s62, s62, 1
    s_cselect_b64 vcc, 0, vcc
    s_cselect_b32 s62, 0, s62
    s_cbranch_vccnz qa_kernel_F0_A12_R
    s_mov_b32 s47, 20983808
    buffer_load_dwordx4 v[224:227], v15, s[36:39], s47 offen offset:2048 sc1
    s_mov_b32 s47, 20983808
    buffer_load_dwordx4 v[228:231], v16, s[36:39], s47 offen offset:2048 sc1
    s_mov_b32 s47, 20983808
    buffer_load_dwordx4 v[232:235], v15, s[36:39], s47 offen offset:3072 sc1
    s_mov_b32 s47, 20983808
    buffer_load_dwordx4 v[236:239], v16, s[36:39], s47 offen offset:3072 sc1
    buffer_load_dword v14, v2, s[36:39], 0 offen
    buffer_load_dword v14, v2, s[36:39], 0 offen
    buffer_load_dword v14, v2, s[36:39], 0 offen
    buffer_load_dword v14, v2, s[36:39], 0 offen
    buffer_load_dword v14, v2, s[36:39], 0 offen
    buffer_load_dword v14, v2, s[36:39], 0 offen
    buffer_load_dword v14, v2, s[36:39], 0 offen
    buffer_load_dword v14, v2, s[36:39], 0 offen
    s_branch qa_kernel_F0_A12_G
qa_kernel_F0_A13_R:
    s_mov_b32 s47, 20983808
    buffer_load_dwordx4 v[216:219], v15, s[36:39], s47 offen offset:1024 sc1
    s_mov_b32 s47, 20983808
    buffer_load_dwordx4 v[220:223], v16, s[36:39], s47 offen offset:1024 sc1
    s_mov_b32 s47, 20983808
    buffer_load_dwordx4 v[224:227], v15, s[36:39], s47 offen offset:2048 sc1
    s_mov_b32 s47, 20983808
    buffer_load_dwordx4 v[228:231], v16, s[36:39], s47 offen offset:2048 sc1
    s_waitcnt vmcnt(0)
    v_max3_u32 v12, v216, v217, v218
    v_max3_u32 v13, v219, v220, v221
    v_max3_u32 v12, v12, v222, v223
    v_max_u32 v12, v12, v13
    v_cmp_eq_u32 vcc, -1, v12
    s_sub_u32 s62, s62, 1
    s_cselect_b64 vcc, 0, vcc
    s_cselect_b32 s62, 0, s62
    s_cbranch_vccnz qa_kernel_F0_A13_R
    s_mov_b32 s47, 20983808
    buffer_load_dwordx4 v[232:235], v15, s[36:39], s47 offen offset:3072 sc1
    s_mov_b32 s47, 20983808
    buffer_load_dwordx4 v[236:239], v16, s[36:39], s47 offen offset:3072 sc1
    buffer_load_dword v14, v2, s[36:39], 0 offen
    buffer_load_dword v14, v2, s[36:39], 0 offen
    buffer_load_dword v14, v2, s[36:39], 0 offen
    buffer_load_dword v14, v2, s[36:39], 0 offen
    buffer_load_dword v14, v2, s[36:39], 0 offen
    buffer_load_dword v14, v2, s[36:39], 0 offen
    buffer_load_dword v14, v2, s[36:39], 0 offen
    buffer_load_dword v14, v2, s[36:39], 0 offen
    s_branch qa_kernel_F0_A13_G
qa_kernel_F0_A14_R:
    s_mov_b32 s47, 20983808
    buffer_load_dwordx4 v[224:227], v15, s[36:39], s47 offen offset:2048 sc1
    s_mov_b32 s47, 20983808
    buffer_load_dwordx4 v[228:231], v16, s[36:39], s47 offen offset:2048 sc1
    s_mov_b32 s47, 20983808
    buffer_load_dwordx4 v[232:235], v15, s[36:39], s47 offen offset:3072 sc1
    s_mov_b32 s47, 20983808
    buffer_load_dwordx4 v[236:239], v16, s[36:39], s47 offen offset:3072 sc1
    s_waitcnt vmcnt(0)
    v_max3_u32 v12, v224, v225, v226
    v_max3_u32 v13, v227, v228, v229
    v_max3_u32 v12, v12, v230, v231
    v_max_u32 v12, v12, v13
    v_cmp_eq_u32 vcc, -1, v12
    s_sub_u32 s62, s62, 1
    s_cselect_b64 vcc, 0, vcc
    s_cselect_b32 s62, 0, s62
    s_cbranch_vccnz qa_kernel_F0_A14_R
    s_mov_b32 s47, 20987904
    buffer_load_dwordx4 v[240:243], v15, s[36:39], s47 offen offset:0 sc1
    s_mov_b32 s47, 20987904
    buffer_load_dwordx4 v[244:247], v16, s[36:39], s47 offen offset:0 sc1
    s_mov_b32 s47, 20987904
    buffer_load_dwordx4 v[248:251], v15, s[36:39], s47 offen offset:1024 sc1
    s_mov_b32 s47, 20987904
    buffer_load_dwordx4 v[252:255], v16, s[36:39], s47 offen offset:1024 sc1
    buffer_load_dword v14, v2, s[36:39], 0 offen
    buffer_load_dword v14, v2, s[36:39], 0 offen
    buffer_load_dword v14, v2, s[36:39], 0 offen
    s_branch qa_kernel_F0_A14_G
qa_kernel_F0_A15_R:
    s_mov_b32 s47, 20983808
    buffer_load_dwordx4 v[232:235], v15, s[36:39], s47 offen offset:3072 sc1
    s_mov_b32 s47, 20983808
    buffer_load_dwordx4 v[236:239], v16, s[36:39], s47 offen offset:3072 sc1
    s_mov_b32 s47, 20987904
    buffer_load_dwordx4 v[240:243], v15, s[36:39], s47 offen offset:0 sc1
    s_mov_b32 s47, 20987904
    buffer_load_dwordx4 v[244:247], v16, s[36:39], s47 offen offset:0 sc1
    s_waitcnt vmcnt(0)
    v_max3_u32 v12, v232, v233, v234
    v_max3_u32 v13, v235, v236, v237
    v_max3_u32 v12, v12, v238, v239
    v_max_u32 v12, v12, v13
    v_cmp_eq_u32 vcc, -1, v12
    s_sub_u32 s62, s62, 1
    s_cselect_b64 vcc, 0, vcc
    s_cselect_b32 s62, 0, s62
    s_cbranch_vccnz qa_kernel_F0_A15_R
    s_mov_b32 s47, 20987904
    buffer_load_dwordx4 v[248:251], v15, s[36:39], s47 offen offset:1024 sc1
    s_mov_b32 s47, 20987904
    buffer_load_dwordx4 v[252:255], v16, s[36:39], s47 offen offset:1024 sc1
    buffer_load_dword v14, v2, s[36:39], 0 offen
    buffer_load_dword v14, v2, s[36:39], 0 offen
    buffer_load_dword v14, v2, s[36:39], 0 offen
    s_branch qa_kernel_F0_A15_G
qa_kernel_ST0_R:
    buffer_load_dwordx2 v[184:185], v25, s[36:39], s63 offen offset:0 sc1
    buffer_load_dwordx2 v[186:187], v25, s[36:39], s63 offen offset:128 sc1
    buffer_load_dwordx2 v[188:189], v25, s[36:39], s63 offen offset:256 sc1
    buffer_load_dwordx2 v[190:191], v25, s[36:39], s63 offen offset:384 sc1
    buffer_load_dwordx2 v[192:193], v25, s[36:39], s63 offen offset:2048 sc1
    buffer_load_dwordx2 v[194:195], v25, s[36:39], s63 offen offset:2176 sc1
    buffer_load_dwordx2 v[196:197], v25, s[36:39], s63 offen offset:2304 sc1
    buffer_load_dwordx2 v[198:199], v25, s[36:39], s63 offen offset:2432 sc1
    s_waitcnt vmcnt(0)
    v_max3_u32 v12, v184, v185, v186
    v_max3_u32 v13, v187, v188, v189
    v_max3_u32 v12, v12, v190, v191
    v_max3_u32 v13, v13, v192, v193
    v_max3_u32 v12, v12, v194, v195
    v_max3_u32 v13, v13, v196, v197
    v_max3_u32 v12, v12, v198, v199
    v_max_u32 v12, v12, v13
    v_cmp_eq_u32 vcc, -1, v12
    s_sub_u32 s62, s62, 1
    s_cselect_b64 vcc, 0, vcc
    s_cselect_b32 s62, 0, s62
    s_cbranch_vccnz qa_kernel_ST0_R
    s_branch qa_kernel_ST0_G
qa_kernel_F0_A16_R:
    s_mov_b32 s47, 20987904
    buffer_load_dwordx4 v[240:243], v15, s[36:39], s47 offen offset:0 sc1
    s_mov_b32 s47, 20987904
    buffer_load_dwordx4 v[244:247], v16, s[36:39], s47 offen offset:0 sc1
    s_mov_b32 s47, 20987904
    buffer_load_dwordx4 v[248:251], v15, s[36:39], s47 offen offset:1024 sc1
    s_mov_b32 s47, 20987904
    buffer_load_dwordx4 v[252:255], v16, s[36:39], s47 offen offset:1024 sc1
    s_waitcnt vmcnt(0)
    v_max3_u32 v12, v240, v241, v242
    v_max3_u32 v13, v243, v244, v245
    v_max3_u32 v12, v12, v246, v247
    v_max_u32 v12, v12, v13
    v_cmp_eq_u32 vcc, -1, v12
    s_sub_u32 s62, s62, 1
    s_cselect_b64 vcc, 0, vcc
    s_cselect_b32 s62, 0, s62
    s_cbranch_vccnz qa_kernel_F0_A16_R
    s_mov_b32 s47, 20987904
    buffer_load_dwordx4 v[208:211], v15, s[36:39], s47 offen offset:2048 sc1
    s_mov_b32 s47, 20987904
    buffer_load_dwordx4 v[212:215], v16, s[36:39], s47 offen offset:2048 sc1
    s_mov_b32 s47, 20987904
    buffer_load_dwordx4 v[216:219], v15, s[36:39], s47 offen offset:3072 sc1
    s_mov_b32 s47, 20987904
    buffer_load_dwordx4 v[220:223], v16, s[36:39], s47 offen offset:3072 sc1
    buffer_load_dword v14, v2, s[36:39], 0 offen
    buffer_load_dword v14, v2, s[36:39], 0 offen
    buffer_load_dword v14, v2, s[36:39], 0 offen
    buffer_load_dword v14, v2, s[36:39], 0 offen
    buffer_load_dword v14, v2, s[36:39], 0 offen
    s_branch qa_kernel_F0_A16_G
qa_kernel_F0_A17_R:
    s_mov_b32 s47, 20987904
    buffer_load_dwordx4 v[248:251], v15, s[36:39], s47 offen offset:1024 sc1
    s_mov_b32 s47, 20987904
    buffer_load_dwordx4 v[252:255], v16, s[36:39], s47 offen offset:1024 sc1
    s_mov_b32 s47, 20987904
    buffer_load_dwordx4 v[208:211], v15, s[36:39], s47 offen offset:2048 sc1
    s_mov_b32 s47, 20987904
    buffer_load_dwordx4 v[212:215], v16, s[36:39], s47 offen offset:2048 sc1
    s_waitcnt vmcnt(0)
    v_max3_u32 v12, v248, v249, v250
    v_max3_u32 v13, v251, v252, v253
    v_max3_u32 v12, v12, v254, v255
    v_max_u32 v12, v12, v13
    v_cmp_eq_u32 vcc, -1, v12
    s_sub_u32 s62, s62, 1
    s_cselect_b64 vcc, 0, vcc
    s_cselect_b32 s62, 0, s62
    s_cbranch_vccnz qa_kernel_F0_A17_R
    s_mov_b32 s47, 20987904
    buffer_load_dwordx4 v[216:219], v15, s[36:39], s47 offen offset:3072 sc1
    s_mov_b32 s47, 20987904
    buffer_load_dwordx4 v[220:223], v16, s[36:39], s47 offen offset:3072 sc1
    buffer_load_dword v14, v2, s[36:39], 0 offen
    buffer_load_dword v14, v2, s[36:39], 0 offen
    buffer_load_dword v14, v2, s[36:39], 0 offen
    buffer_load_dword v14, v2, s[36:39], 0 offen
    buffer_load_dword v14, v2, s[36:39], 0 offen
    s_branch qa_kernel_F0_A17_G
qa_kernel_F0_A18_R:
    s_mov_b32 s47, 20987904
    buffer_load_dwordx4 v[208:211], v15, s[36:39], s47 offen offset:2048 sc1
    s_mov_b32 s47, 20987904
    buffer_load_dwordx4 v[212:215], v16, s[36:39], s47 offen offset:2048 sc1
    s_mov_b32 s47, 20987904
    buffer_load_dwordx4 v[216:219], v15, s[36:39], s47 offen offset:3072 sc1
    s_mov_b32 s47, 20987904
    buffer_load_dwordx4 v[220:223], v16, s[36:39], s47 offen offset:3072 sc1
    s_waitcnt vmcnt(0)
    v_max3_u32 v12, v208, v209, v210
    v_max3_u32 v13, v211, v212, v213
    v_max3_u32 v12, v12, v214, v215
    v_max_u32 v12, v12, v13
    v_cmp_eq_u32 vcc, -1, v12
    s_sub_u32 s62, s62, 1
    s_cselect_b64 vcc, 0, vcc
    s_cselect_b32 s62, 0, s62
    s_cbranch_vccnz qa_kernel_F0_A18_R
    s_mov_b32 s47, 20992000
    buffer_load_dwordx4 v[224:227], v15, s[36:39], s47 offen offset:0 sc1
    s_mov_b32 s47, 20992000
    buffer_load_dwordx4 v[228:231], v16, s[36:39], s47 offen offset:0 sc1
    s_mov_b32 s47, 20992000
    buffer_load_dwordx4 v[232:235], v15, s[36:39], s47 offen offset:1024 sc1
    s_mov_b32 s47, 20992000
    buffer_load_dwordx4 v[236:239], v16, s[36:39], s47 offen offset:1024 sc1
    buffer_load_dword v14, v2, s[36:39], 0 offen
    buffer_load_dword v14, v2, s[36:39], 0 offen
    buffer_load_dword v14, v2, s[36:39], 0 offen
    buffer_load_dword v14, v2, s[36:39], 0 offen
    s_branch qa_kernel_F0_A18_G
qa_kernel_F0_A19_R:
    s_mov_b32 s47, 20987904
    buffer_load_dwordx4 v[216:219], v15, s[36:39], s47 offen offset:3072 sc1
    s_mov_b32 s47, 20987904
    buffer_load_dwordx4 v[220:223], v16, s[36:39], s47 offen offset:3072 sc1
    s_mov_b32 s47, 20992000
    buffer_load_dwordx4 v[224:227], v15, s[36:39], s47 offen offset:0 sc1
    s_mov_b32 s47, 20992000
    buffer_load_dwordx4 v[228:231], v16, s[36:39], s47 offen offset:0 sc1
    s_waitcnt vmcnt(0)
    v_max3_u32 v12, v216, v217, v218
    v_max3_u32 v13, v219, v220, v221
    v_max3_u32 v12, v12, v222, v223
    v_max_u32 v12, v12, v13
    v_cmp_eq_u32 vcc, -1, v12
    s_sub_u32 s62, s62, 1
    s_cselect_b64 vcc, 0, vcc
    s_cselect_b32 s62, 0, s62
    s_cbranch_vccnz qa_kernel_F0_A19_R
    s_mov_b32 s47, 20992000
    buffer_load_dwordx4 v[232:235], v15, s[36:39], s47 offen offset:1024 sc1
    s_mov_b32 s47, 20992000
    buffer_load_dwordx4 v[236:239], v16, s[36:39], s47 offen offset:1024 sc1
    buffer_load_dword v14, v2, s[36:39], 0 offen
    buffer_load_dword v14, v2, s[36:39], 0 offen
    buffer_load_dword v14, v2, s[36:39], 0 offen
    buffer_load_dword v14, v2, s[36:39], 0 offen
    s_branch qa_kernel_F0_A19_G
qa_kernel_F0_A20_R:
    s_mov_b32 s47, 20992000
    buffer_load_dwordx4 v[224:227], v15, s[36:39], s47 offen offset:0 sc1
    s_mov_b32 s47, 20992000
    buffer_load_dwordx4 v[228:231], v16, s[36:39], s47 offen offset:0 sc1
    s_mov_b32 s47, 20992000
    buffer_load_dwordx4 v[232:235], v15, s[36:39], s47 offen offset:1024 sc1
    s_mov_b32 s47, 20992000
    buffer_load_dwordx4 v[236:239], v16, s[36:39], s47 offen offset:1024 sc1
    s_waitcnt vmcnt(0)
    v_max3_u32 v12, v224, v225, v226
    v_max3_u32 v13, v227, v228, v229
    v_max3_u32 v12, v12, v230, v231
    v_max_u32 v12, v12, v13
    v_cmp_eq_u32 vcc, -1, v12
    s_sub_u32 s62, s62, 1
    s_cselect_b64 vcc, 0, vcc
    s_cselect_b32 s62, 0, s62
    s_cbranch_vccnz qa_kernel_F0_A20_R
    s_mov_b32 s47, 20992000
    buffer_load_dwordx4 v[240:243], v15, s[36:39], s47 offen offset:2048 sc1
    s_mov_b32 s47, 20992000
    buffer_load_dwordx4 v[244:247], v16, s[36:39], s47 offen offset:2048 sc1
    s_mov_b32 s47, 20992000
    buffer_load_dwordx4 v[248:251], v15, s[36:39], s47 offen offset:3072 sc1
    s_mov_b32 s47, 20992000
    buffer_load_dwordx4 v[252:255], v16, s[36:39], s47 offen offset:3072 sc1
    buffer_load_dword v14, v2, s[36:39], 0 offen
    buffer_load_dword v14, v2, s[36:39], 0 offen
    buffer_load_dword v14, v2, s[36:39], 0 offen
    buffer_load_dword v14, v2, s[36:39], 0 offen
    s_branch qa_kernel_F0_A20_G
qa_kernel_F0_A21_R:
    s_mov_b32 s47, 20992000
    buffer_load_dwordx4 v[232:235], v15, s[36:39], s47 offen offset:1024 sc1
    s_mov_b32 s47, 20992000
    buffer_load_dwordx4 v[236:239], v16, s[36:39], s47 offen offset:1024 sc1
    s_mov_b32 s47, 20992000
    buffer_load_dwordx4 v[240:243], v15, s[36:39], s47 offen offset:2048 sc1
    s_mov_b32 s47, 20992000
    buffer_load_dwordx4 v[244:247], v16, s[36:39], s47 offen offset:2048 sc1
    s_waitcnt vmcnt(0)
    v_max3_u32 v12, v232, v233, v234
    v_max3_u32 v13, v235, v236, v237
    v_max3_u32 v12, v12, v238, v239
    v_max_u32 v12, v12, v13
    v_cmp_eq_u32 vcc, -1, v12
    s_sub_u32 s62, s62, 1
    s_cselect_b64 vcc, 0, vcc
    s_cselect_b32 s62, 0, s62
    s_cbranch_vccnz qa_kernel_F0_A21_R
    s_mov_b32 s47, 20992000
    buffer_load_dwordx4 v[248:251], v15, s[36:39], s47 offen offset:3072 sc1
    s_mov_b32 s47, 20992000
    buffer_load_dwordx4 v[252:255], v16, s[36:39], s47 offen offset:3072 sc1
    buffer_load_dword v14, v2, s[36:39], 0 offen
    buffer_load_dword v14, v2, s[36:39], 0 offen
    buffer_load_dword v14, v2, s[36:39], 0 offen
    buffer_load_dword v14, v2, s[36:39], 0 offen
    s_branch qa_kernel_F0_A21_G
qa_kernel_F0_A22_R:
    s_mov_b32 s47, 20992000
    buffer_load_dwordx4 v[240:243], v15, s[36:39], s47 offen offset:2048 sc1
    s_mov_b32 s47, 20992000
    buffer_load_dwordx4 v[244:247], v16, s[36:39], s47 offen offset:2048 sc1
    s_mov_b32 s47, 20992000
    buffer_load_dwordx4 v[248:251], v15, s[36:39], s47 offen offset:3072 sc1
    s_mov_b32 s47, 20992000
    buffer_load_dwordx4 v[252:255], v16, s[36:39], s47 offen offset:3072 sc1
    s_waitcnt vmcnt(0)
    v_max3_u32 v12, v240, v241, v242
    v_max3_u32 v13, v243, v244, v245
    v_max3_u32 v12, v12, v246, v247
    v_max_u32 v12, v12, v13
    v_cmp_eq_u32 vcc, -1, v12
    s_sub_u32 s62, s62, 1
    s_cselect_b64 vcc, 0, vcc
    s_cselect_b32 s62, 0, s62
    s_cbranch_vccnz qa_kernel_F0_A22_R
    s_mov_b32 s47, 20996096
    buffer_load_dwordx4 v[208:211], v15, s[36:39], s47 offen offset:0 sc1
    s_mov_b32 s47, 20996096
    buffer_load_dwordx4 v[212:215], v16, s[36:39], s47 offen offset:0 sc1
    s_mov_b32 s47, 20996096
    buffer_load_dwordx4 v[216:219], v15, s[36:39], s47 offen offset:1024 sc1
    s_mov_b32 s47, 20996096
    buffer_load_dwordx4 v[220:223], v16, s[36:39], s47 offen offset:1024 sc1
    buffer_load_dword v14, v2, s[36:39], 0 offen
    buffer_load_dword v14, v2, s[36:39], 0 offen
    buffer_load_dword v14, v2, s[36:39], 0 offen
    buffer_load_dword v14, v2, s[36:39], 0 offen
    s_branch qa_kernel_F0_A22_G
qa_kernel_F0_A23_R:
    s_mov_b32 s47, 20992000
    buffer_load_dwordx4 v[248:251], v15, s[36:39], s47 offen offset:3072 sc1
    s_mov_b32 s47, 20992000
    buffer_load_dwordx4 v[252:255], v16, s[36:39], s47 offen offset:3072 sc1
    s_mov_b32 s47, 20996096
    buffer_load_dwordx4 v[208:211], v15, s[36:39], s47 offen offset:0 sc1
    s_mov_b32 s47, 20996096
    buffer_load_dwordx4 v[212:215], v16, s[36:39], s47 offen offset:0 sc1
    s_waitcnt vmcnt(0)
    v_max3_u32 v12, v248, v249, v250
    v_max3_u32 v13, v251, v252, v253
    v_max3_u32 v12, v12, v254, v255
    v_max_u32 v12, v12, v13
    v_cmp_eq_u32 vcc, -1, v12
    s_sub_u32 s62, s62, 1
    s_cselect_b64 vcc, 0, vcc
    s_cselect_b32 s62, 0, s62
    s_cbranch_vccnz qa_kernel_F0_A23_R
    s_mov_b32 s47, 20996096
    buffer_load_dwordx4 v[216:219], v15, s[36:39], s47 offen offset:1024 sc1
    s_mov_b32 s47, 20996096
    buffer_load_dwordx4 v[220:223], v16, s[36:39], s47 offen offset:1024 sc1
    buffer_load_dword v14, v2, s[36:39], 0 offen
    buffer_load_dword v14, v2, s[36:39], 0 offen
    buffer_load_dword v14, v2, s[36:39], 0 offen
    buffer_load_dword v14, v2, s[36:39], 0 offen
    s_branch qa_kernel_F0_A23_G
qa_kernel_F0_A24_R:
    s_mov_b32 s47, 20996096
    buffer_load_dwordx4 v[208:211], v15, s[36:39], s47 offen offset:0 sc1
    s_mov_b32 s47, 20996096
    buffer_load_dwordx4 v[212:215], v16, s[36:39], s47 offen offset:0 sc1
    s_mov_b32 s47, 20996096
    buffer_load_dwordx4 v[216:219], v15, s[36:39], s47 offen offset:1024 sc1
    s_mov_b32 s47, 20996096
    buffer_load_dwordx4 v[220:223], v16, s[36:39], s47 offen offset:1024 sc1
    s_waitcnt vmcnt(0)
    v_max3_u32 v12, v208, v209, v210
    v_max3_u32 v13, v211, v212, v213
    v_max3_u32 v12, v12, v214, v215
    v_max_u32 v12, v12, v13
    v_cmp_eq_u32 vcc, -1, v12
    s_sub_u32 s62, s62, 1
    s_cselect_b64 vcc, 0, vcc
    s_cselect_b32 s62, 0, s62
    s_cbranch_vccnz qa_kernel_F0_A24_R
    s_mov_b32 s47, 20996096
    buffer_load_dwordx4 v[224:227], v15, s[36:39], s47 offen offset:2048 sc1
    s_mov_b32 s47, 20996096
    buffer_load_dwordx4 v[228:231], v16, s[36:39], s47 offen offset:2048 sc1
    s_mov_b32 s47, 20996096
    buffer_load_dwordx4 v[232:235], v15, s[36:39], s47 offen offset:3072 sc1
    s_mov_b32 s47, 20996096
    buffer_load_dwordx4 v[236:239], v16, s[36:39], s47 offen offset:3072 sc1
    buffer_load_dword v14, v2, s[36:39], 0 offen
    s_branch qa_kernel_F0_A24_G
qa_kernel_F0_A25_R:
    s_mov_b32 s47, 20996096
    buffer_load_dwordx4 v[216:219], v15, s[36:39], s47 offen offset:1024 sc1
    s_mov_b32 s47, 20996096
    buffer_load_dwordx4 v[220:223], v16, s[36:39], s47 offen offset:1024 sc1
    s_mov_b32 s47, 20996096
    buffer_load_dwordx4 v[224:227], v15, s[36:39], s47 offen offset:2048 sc1
    s_mov_b32 s47, 20996096
    buffer_load_dwordx4 v[228:231], v16, s[36:39], s47 offen offset:2048 sc1
    s_waitcnt vmcnt(0)
    v_max3_u32 v12, v216, v217, v218
    v_max3_u32 v13, v219, v220, v221
    v_max3_u32 v12, v12, v222, v223
    v_max_u32 v12, v12, v13
    v_cmp_eq_u32 vcc, -1, v12
    s_sub_u32 s62, s62, 1
    s_cselect_b64 vcc, 0, vcc
    s_cselect_b32 s62, 0, s62
    s_cbranch_vccnz qa_kernel_F0_A25_R
    s_mov_b32 s47, 20996096
    buffer_load_dwordx4 v[232:235], v15, s[36:39], s47 offen offset:3072 sc1
    s_mov_b32 s47, 20996096
    buffer_load_dwordx4 v[236:239], v16, s[36:39], s47 offen offset:3072 sc1
    buffer_load_dword v14, v2, s[36:39], 0 offen
    s_branch qa_kernel_F0_A25_G
qa_kernel_F0_A26_R:
    s_mov_b32 s47, 20996096
    buffer_load_dwordx4 v[224:227], v15, s[36:39], s47 offen offset:2048 sc1
    s_mov_b32 s47, 20996096
    buffer_load_dwordx4 v[228:231], v16, s[36:39], s47 offen offset:2048 sc1
    s_mov_b32 s47, 20996096
    buffer_load_dwordx4 v[232:235], v15, s[36:39], s47 offen offset:3072 sc1
    s_mov_b32 s47, 20996096
    buffer_load_dwordx4 v[236:239], v16, s[36:39], s47 offen offset:3072 sc1
    s_waitcnt vmcnt(0)
    v_max3_u32 v12, v224, v225, v226
    v_max3_u32 v13, v227, v228, v229
    v_max3_u32 v12, v12, v230, v231
    v_max_u32 v12, v12, v13
    v_cmp_eq_u32 vcc, -1, v12
    s_sub_u32 s62, s62, 1
    s_cselect_b64 vcc, 0, vcc
    s_cselect_b32 s62, 0, s62
    s_cbranch_vccnz qa_kernel_F0_A26_R
    s_mov_b32 s47, 21000192
    buffer_load_dwordx4 v[240:243], v15, s[36:39], s47 offen offset:0 sc1
    s_mov_b32 s47, 21000192
    buffer_load_dwordx4 v[244:247], v16, s[36:39], s47 offen offset:0 sc1
    s_mov_b32 s47, 21000192
    buffer_load_dwordx4 v[248:251], v15, s[36:39], s47 offen offset:1024 sc1
    s_mov_b32 s47, 21000192
    buffer_load_dwordx4 v[252:255], v16, s[36:39], s47 offen offset:1024 sc1
    s_branch qa_kernel_F0_A26_G
qa_kernel_F0_A27_R:
    s_mov_b32 s47, 20996096
    buffer_load_dwordx4 v[232:235], v15, s[36:39], s47 offen offset:3072 sc1
    s_mov_b32 s47, 20996096
    buffer_load_dwordx4 v[236:239], v16, s[36:39], s47 offen offset:3072 sc1
    s_mov_b32 s47, 21000192
    buffer_load_dwordx4 v[240:243], v15, s[36:39], s47 offen offset:0 sc1
    s_mov_b32 s47, 21000192
    buffer_load_dwordx4 v[244:247], v16, s[36:39], s47 offen offset:0 sc1
    s_waitcnt vmcnt(0)
    v_max3_u32 v12, v232, v233, v234
    v_max3_u32 v13, v235, v236, v237
    v_max3_u32 v12, v12, v238, v239
    v_max_u32 v12, v12, v13
    v_cmp_eq_u32 vcc, -1, v12
    s_sub_u32 s62, s62, 1
    s_cselect_b64 vcc, 0, vcc
    s_cselect_b32 s62, 0, s62
    s_cbranch_vccnz qa_kernel_F0_A27_R
    s_mov_b32 s47, 21000192
    buffer_load_dwordx4 v[248:251], v15, s[36:39], s47 offen offset:1024 sc1
    s_mov_b32 s47, 21000192
    buffer_load_dwordx4 v[252:255], v16, s[36:39], s47 offen offset:1024 sc1
    s_branch qa_kernel_F0_A27_G
qa_kernel_F0_A28_R:
    s_mov_b32 s47, 21000192
    buffer_load_dwordx4 v[240:243], v15, s[36:39], s47 offen offset:0 sc1
    s_mov_b32 s47, 21000192
    buffer_load_dwordx4 v[244:247], v16, s[36:39], s47 offen offset:0 sc1
    s_mov_b32 s47, 21000192
    buffer_load_dwordx4 v[248:251], v15, s[36:39], s47 offen offset:1024 sc1
    s_mov_b32 s47, 21000192
    buffer_load_dwordx4 v[252:255], v16, s[36:39], s47 offen offset:1024 sc1
    s_waitcnt vmcnt(0)
    v_max3_u32 v12, v240, v241, v242
    v_max3_u32 v13, v243, v244, v245
    v_max3_u32 v12, v12, v246, v247
    v_max_u32 v12, v12, v13
    v_cmp_eq_u32 vcc, -1, v12
    s_sub_u32 s62, s62, 1
    s_cselect_b64 vcc, 0, vcc
    s_cselect_b32 s62, 0, s62
    s_cbranch_vccnz qa_kernel_F0_A28_R
    s_mov_b32 s47, 21000192
    buffer_load_dwordx4 v[208:211], v15, s[36:39], s47 offen offset:2048 sc1
    s_mov_b32 s47, 21000192
    buffer_load_dwordx4 v[212:215], v16, s[36:39], s47 offen offset:2048 sc1
    s_mov_b32 s47, 21000192
    buffer_load_dwordx4 v[216:219], v15, s[36:39], s47 offen offset:3072 sc1
    s_branch qa_kernel_F0_A28_G
qa_kernel_F0_A29_R:
    s_mov_b32 s47, 21000192
    buffer_load_dwordx4 v[248:251], v15, s[36:39], s47 offen offset:1024 sc1
    s_mov_b32 s47, 21000192
    buffer_load_dwordx4 v[252:255], v16, s[36:39], s47 offen offset:1024 sc1
    s_mov_b32 s47, 21000192
    buffer_load_dwordx4 v[208:211], v15, s[36:39], s47 offen offset:2048 sc1
    s_mov_b32 s47, 21000192
    buffer_load_dwordx4 v[212:215], v16, s[36:39], s47 offen offset:2048 sc1
    s_waitcnt vmcnt(0)
    v_max3_u32 v12, v248, v249, v250
    v_max3_u32 v13, v251, v252, v253
    v_max3_u32 v12, v12, v254, v255
    v_max_u32 v12, v12, v13
    v_cmp_eq_u32 vcc, -1, v12
    s_sub_u32 s62, s62, 1
    s_cselect_b64 vcc, 0, vcc
    s_cselect_b32 s62, 0, s62
    s_cbranch_vccnz qa_kernel_F0_A29_R
    s_mov_b32 s47, 21000192
    buffer_load_dwordx4 v[216:219], v15, s[36:39], s47 offen offset:3072 sc1
    s_mov_b32 s47, 21000192
    buffer_load_dwordx4 v[220:223], v16, s[36:39], s47 offen offset:3072 sc1
    s_branch qa_kernel_F0_A29_G
qa_kernel_F0_A30_R:
    s_mov_b32 s47, 21000192
    buffer_load_dwordx4 v[208:211], v15, s[36:39], s47 offen offset:2048 sc1
    s_mov_b32 s47, 21000192
    buffer_load_dwordx4 v[212:215], v16, s[36:39], s47 offen offset:2048 sc1
    s_mov_b32 s47, 21000192
    buffer_load_dwordx4 v[216:219], v15, s[36:39], s47 offen offset:3072 sc1
    s_mov_b32 s47, 21000192
    buffer_load_dwordx4 v[220:223], v16, s[36:39], s47 offen offset:3072 sc1
    s_waitcnt vmcnt(0)
    v_max3_u32 v12, v208, v209, v210
    v_max3_u32 v13, v211, v212, v213
    v_max3_u32 v12, v12, v214, v215
    v_max_u32 v12, v12, v13
    v_cmp_eq_u32 vcc, -1, v12
    s_sub_u32 s62, s62, 1
    s_cselect_b64 vcc, 0, vcc
    s_cselect_b32 s62, 0, s62
    s_cbranch_vccnz qa_kernel_F0_A30_R
    s_branch qa_kernel_F0_A30_G
qa_kernel_F0_A31_R:
    s_mov_b32 s47, 21000192
    buffer_load_dwordx4 v[216:219], v15, s[36:39], s47 offen offset:3072 sc1
    s_mov_b32 s47, 21000192
    buffer_load_dwordx4 v[220:223], v16, s[36:39], s47 offen offset:3072 sc1
    s_waitcnt vmcnt(0)
    v_max3_u32 v12, v216, v217, v218
    v_max3_u32 v13, v219, v220, v221
    v_max3_u32 v12, v12, v222, v223
    v_max_u32 v12, v12, v13
    v_cmp_eq_u32 vcc, -1, v12
    s_sub_u32 s62, s62, 1
    s_cselect_b64 vcc, 0, vcc
    s_cselect_b32 s62, 0, s62
    s_cbranch_vccnz qa_kernel_F0_A31_R
    s_branch qa_kernel_F0_A31_G
qa_kernel_F1_A4_R:
    s_mov_b32 s47, 20975616
    buffer_load_dwordx4 v[240:243], v15, s[36:39], s47 offen offset:0 sc1
    s_mov_b32 s47, 20975616
    buffer_load_dwordx4 v[244:247], v16, s[36:39], s47 offen offset:0 sc1
    s_mov_b32 s47, 20975616
    buffer_load_dwordx4 v[248:251], v15, s[36:39], s47 offen offset:1024 sc1
    s_mov_b32 s47, 20975616
    buffer_load_dwordx4 v[252:255], v16, s[36:39], s47 offen offset:1024 sc1
    s_waitcnt vmcnt(0)
    v_max3_u32 v12, v240, v241, v242
    v_max3_u32 v13, v243, v244, v245
    v_max3_u32 v12, v12, v246, v247
    v_max_u32 v12, v12, v13
    v_cmp_eq_u32 vcc, -1, v12
    s_sub_u32 s62, s62, 1
    s_cselect_b64 vcc, 0, vcc
    s_cselect_b32 s62, 0, s62
    s_cbranch_vccnz qa_kernel_F1_A4_R
    s_branch qa_kernel_F1_A4_G
qa_kernel_F1_A5_R:
    s_mov_b32 s47, 20975616
    buffer_load_dwordx4 v[248:251], v15, s[36:39], s47 offen offset:1024 sc1
    s_mov_b32 s47, 20975616
    buffer_load_dwordx4 v[252:255], v16, s[36:39], s47 offen offset:1024 sc1
    s_waitcnt vmcnt(0)
    v_max3_u32 v12, v248, v249, v250
    v_max3_u32 v13, v251, v252, v253
    v_max3_u32 v12, v12, v254, v255
    v_max_u32 v12, v12, v13
    v_cmp_eq_u32 vcc, -1, v12
    s_sub_u32 s62, s62, 1
    s_cselect_b64 vcc, 0, vcc
    s_cselect_b32 s62, 0, s62
    s_cbranch_vccnz qa_kernel_F1_A5_R
    s_branch qa_kernel_F1_A5_G
qa_kernel_CK1_R:
    s_cmp_lg_u32 s24, 0
    s_cbranch_scc1 qa_kernel_CK1_G
    s_mov_b32 m0, 151552
    s_nop 0
    buffer_load_dwordx4 v26, s[36:39], s64 offen sc1 lds
    s_waitcnt vmcnt(0)
    ds_read_b128 v[184:187], v188 offset:20480
    s_waitcnt lgkmcnt(0)
    v_max3_u32 v12, v184, v185, v186
    v_max_u32 v12, v12, v187
    v_cmp_eq_u32 vcc, -1, v12
    s_sub_u32 s62, s62, 1
    s_cselect_b64 vcc, 0, vcc
    s_cselect_b32 s62, 0, s62
    s_cbranch_vccnz qa_kernel_CK1_R
    s_branch qa_kernel_CK1_G
qa_kernel_F1_A6_R:
    s_mov_b32 s47, 20975616
    buffer_load_dwordx4 v[208:211], v15, s[36:39], s47 offen offset:2048 sc1
    s_mov_b32 s47, 20975616
    buffer_load_dwordx4 v[212:215], v16, s[36:39], s47 offen offset:2048 sc1
    s_mov_b32 s47, 20975616
    buffer_load_dwordx4 v[216:219], v15, s[36:39], s47 offen offset:3072 sc1
    s_mov_b32 s47, 20975616
    buffer_load_dwordx4 v[220:223], v16, s[36:39], s47 offen offset:3072 sc1
    s_waitcnt vmcnt(0)
    v_max3_u32 v12, v208, v209, v210
    v_max3_u32 v13, v211, v212, v213
    v_max3_u32 v12, v12, v214, v215
    v_max_u32 v12, v12, v13
    v_cmp_eq_u32 vcc, -1, v12
    s_sub_u32 s62, s62, 1
    s_cselect_b64 vcc, 0, vcc
    s_cselect_b32 s62, 0, s62
    s_cbranch_vccnz qa_kernel_F1_A6_R
    s_mov_b32 s47, 20979712
    buffer_load_dwordx4 v[224:227], v15, s[36:39], s47 offen offset:0 sc1
    s_branch qa_kernel_F1_A6_G
qa_kernel_F1_A7_R:
    s_mov_b32 s47, 20975616
    buffer_load_dwordx4 v[216:219], v15, s[36:39], s47 offen offset:3072 sc1
    s_mov_b32 s47, 20975616
    buffer_load_dwordx4 v[220:223], v16, s[36:39], s47 offen offset:3072 sc1
    s_mov_b32 s47, 20979712
    buffer_load_dwordx4 v[224:227], v15, s[36:39], s47 offen offset:0 sc1
    s_waitcnt vmcnt(0)
    v_max3_u32 v12, v216, v217, v218
    v_max3_u32 v13, v219, v220, v221
    v_max3_u32 v12, v12, v222, v223
    v_max_u32 v12, v12, v13
    v_cmp_eq_u32 vcc, -1, v12
    s_sub_u32 s62, s62, 1
    s_cselect_b64 vcc, 0, vcc
    s_cselect_b32 s62, 0, s62
    s_cbranch_vccnz qa_kernel_F1_A7_R
    s_branch qa_kernel_F1_A7_G
qa_kernel_F1_A8_R:
    s_mov_b32 s47, 20979712
    buffer_load_dwordx4 v[224:227], v15, s[36:39], s47 offen offset:0 sc1
    s_mov_b32 s47, 20979712
    buffer_load_dwordx4 v[228:231], v16, s[36:39], s47 offen offset:0 sc1
    s_mov_b32 s47, 20979712
    buffer_load_dwordx4 v[232:235], v15, s[36:39], s47 offen offset:1024 sc1
    s_mov_b32 s47, 20979712
    buffer_load_dwordx4 v[236:239], v16, s[36:39], s47 offen offset:1024 sc1
    s_waitcnt vmcnt(0)
    v_max3_u32 v12, v224, v225, v226
    v_max3_u32 v13, v227, v228, v229
    v_max3_u32 v12, v12, v230, v231
    v_max_u32 v12, v12, v13
    v_cmp_eq_u32 vcc, -1, v12
    s_sub_u32 s62, s62, 1
    s_cselect_b64 vcc, 0, vcc
    s_cselect_b32 s62, 0, s62
    s_cbranch_vccnz qa_kernel_F1_A8_R
    s_mov_b32 s47, 20979712
    buffer_load_dwordx4 v[240:243], v15, s[36:39], s47 offen offset:2048 sc1
    s_mov_b32 s47, 20979712
    buffer_load_dwordx4 v[244:247], v16, s[36:39], s47 offen offset:2048 sc1
    s_branch qa_kernel_F1_A8_G
qa_kernel_F1_A9_R:
    s_mov_b32 s47, 20979712
    buffer_load_dwordx4 v[232:235], v15, s[36:39], s47 offen offset:1024 sc1
    s_mov_b32 s47, 20979712
    buffer_load_dwordx4 v[236:239], v16, s[36:39], s47 offen offset:1024 sc1
    s_mov_b32 s47, 20979712
    buffer_load_dwordx4 v[240:243], v15, s[36:39], s47 offen offset:2048 sc1
    s_mov_b32 s47, 20979712
    buffer_load_dwordx4 v[244:247], v16, s[36:39], s47 offen offset:2048 sc1
    s_waitcnt vmcnt(0)
    v_max3_u32 v12, v232, v233, v234
    v_max3_u32 v13, v235, v236, v237
    v_max3_u32 v12, v12, v238, v239
    v_max_u32 v12, v12, v13
    v_cmp_eq_u32 vcc, -1, v12
    s_sub_u32 s62, s62, 1
    s_cselect_b64 vcc, 0, vcc
    s_cselect_b32 s62, 0, s62
    s_cbranch_vccnz qa_kernel_F1_A9_R
    s_branch qa_kernel_F1_A9_G
qa_kernel_F1_A10_R:
    s_mov_b32 s47, 20979712
    buffer_load_dwordx4 v[240:243], v15, s[36:39], s47 offen offset:2048 sc1
    s_mov_b32 s47, 20979712
    buffer_load_dwordx4 v[244:247], v16, s[36:39], s47 offen offset:2048 sc1
    s_mov_b32 s47, 20979712
    buffer_load_dwordx4 v[248:251], v15, s[36:39], s47 offen offset:3072 sc1
    s_mov_b32 s47, 20979712
    buffer_load_dwordx4 v[252:255], v16, s[36:39], s47 offen offset:3072 sc1
    s_waitcnt vmcnt(0)
    v_max3_u32 v12, v240, v241, v242
    v_max3_u32 v13, v243, v244, v245
    v_max3_u32 v12, v12, v246, v247
    v_max_u32 v12, v12, v13
    v_cmp_eq_u32 vcc, -1, v12
    s_sub_u32 s62, s62, 1
    s_cselect_b64 vcc, 0, vcc
    s_cselect_b32 s62, 0, s62
    s_cbranch_vccnz qa_kernel_F1_A10_R
    s_mov_b32 s47, 20983808
    buffer_load_dwordx4 v[208:211], v15, s[36:39], s47 offen offset:0 sc1
    s_mov_b32 s47, 20983808
    buffer_load_dwordx4 v[212:215], v16, s[36:39], s47 offen offset:0 sc1
    s_mov_b32 s47, 20983808
    buffer_load_dwordx4 v[216:219], v15, s[36:39], s47 offen offset:1024 sc1
    s_branch qa_kernel_F1_A10_G
qa_kernel_F1_A11_R:
    s_mov_b32 s47, 20979712
    buffer_load_dwordx4 v[248:251], v15, s[36:39], s47 offen offset:3072 sc1
    s_mov_b32 s47, 20979712
    buffer_load_dwordx4 v[252:255], v16, s[36:39], s47 offen offset:3072 sc1
    s_mov_b32 s47, 20983808
    buffer_load_dwordx4 v[208:211], v15, s[36:39], s47 offen offset:0 sc1
    s_mov_b32 s47, 20983808
    buffer_load_dwordx4 v[212:215], v16, s[36:39], s47 offen offset:0 sc1
    s_waitcnt vmcnt(0)
    v_max3_u32 v12, v248, v249, v250
    v_max3_u32 v13, v251, v252, v253
    v_max3_u32 v12, v12, v254, v255
    v_max_u32 v12, v12, v13
    v_cmp_eq_u32 vcc, -1, v12
    s_sub_u32 s62, s62, 1
    s_cselect_b64 vcc, 0, vcc
    s_cselect_b32 s62, 0, s62
    s_cbranch_vccnz qa_kernel_F1_A11_R
    s_mov_b32 s47, 20983808
    buffer_load_dwordx4 v[216:219], v15, s[36:39], s47 offen offset:1024 sc1
    s_branch qa_kernel_F1_A11_G
qa_kernel_F1_A12_R:
    s_mov_b32 s47, 20983808
    buffer_load_dwordx4 v[208:211], v15, s[36:39], s47 offen offset:0 sc1
    s_mov_b32 s47, 20983808
    buffer_load_dwordx4 v[212:215], v16, s[36:39], s47 offen offset:0 sc1
    s_mov_b32 s47, 20983808
    buffer_load_dwordx4 v[216:219], v15, s[36:39], s47 offen offset:1024 sc1
    s_mov_b32 s47, 20983808
    buffer_load_dwordx4 v[220:223], v16, s[36:39], s47 offen offset:1024 sc1
    s_waitcnt vmcnt(0)
    v_max3_u32 v12, v208, v209, v210
    v_max3_u32 v13, v211, v212, v213
    v_max3_u32 v12, v12, v214, v215
    v_max_u32 v12, v12, v13
    v_cmp_eq_u32 vcc, -1, v12
    s_sub_u32 s62, s62, 1
    s_cselect_b64 vcc, 0, vcc
    s_cselect_b32 s62, 0, s62
    s_cbranch_vccnz qa_kernel_F1_A12_R
    s_mov_b32 s47, 20983808
    buffer_load_dwordx4 v[224:227], v15, s[36:39], s47 offen offset:2048 sc1
    s_mov_b32 s47, 20983808
    buffer_load_dwordx4 v[228:231], v16, s[36:39], s47 offen offset:2048 sc1
    buffer_load_dword v14, v2, s[36:39], 0 offen
    buffer_load_dword v14, v2, s[36:39], 0 offen
    buffer_load_dword v14, v2, s[36:39], 0 offen
    buffer_load_dword v14, v2, s[36:39], 0 offen
    s_branch qa_kernel_F1_A12_G
qa_kernel_F1_A13_R:
    s_mov_b32 s47, 20983808
    buffer_load_dwordx4 v[216:219], v15, s[36:39], s47 offen offset:1024 sc1
    s_mov_b32 s47, 20983808
    buffer_load_dwordx4 v[220:223], v16, s[36:39], s47 offen offset:1024 sc1
    s_mov_b32 s47, 20983808
    buffer_load_dwordx4 v[224:227], v15, s[36:39], s47 offen offset:2048 sc1
    s_mov_b32 s47, 20983808
    buffer_load_dwordx4 v[228:231], v16, s[36:39], s47 offen offset:2048 sc1
    s_waitcnt vmcnt(0)
    v_max3_u32 v12, v216, v217, v218
    v_max3_u32 v13, v219, v220, v221
    v_max3_u32 v12, v12, v222, v223
    v_max_u32 v12, v12, v13
    v_cmp_eq_u32 vcc, -1, v12
    s_sub_u32 s62, s62, 1
    s_cselect_b64 vcc, 0, vcc
    s_cselect_b32 s62, 0, s62
    s_cbranch_vccnz qa_kernel_F1_A13_R
    s_branch qa_kernel_F1_A13_G
qa_kernel_F1_A14_R:
    s_mov_b32 s47, 20983808
    buffer_load_dwordx4 v[224:227], v15, s[36:39], s47 offen offset:2048 sc1
    s_mov_b32 s47, 20983808
    buffer_load_dwordx4 v[228:231], v16, s[36:39], s47 offen offset:2048 sc1
    s_mov_b32 s47, 20983808
    buffer_load_dwordx4 v[232:235], v15, s[36:39], s47 offen offset:3072 sc1
    s_mov_b32 s47, 20983808
    buffer_load_dwordx4 v[236:239], v16, s[36:39], s47 offen offset:3072 sc1
    s_waitcnt vmcnt(0)
    v_max3_u32 v12, v224, v225, v226
    v_max3_u32 v13, v227, v228, v229
    v_max3_u32 v12, v12, v230, v231
    v_max_u32 v12, v12, v13
    v_cmp_eq_u32 vcc, -1, v12
    s_sub_u32 s62, s62, 1
    s_cselect_b64 vcc, 0, vcc
    s_cselect_b32 s62, 0, s62
    s_cbranch_vccnz qa_kernel_F1_A14_R
    s_mov_b32 s47, 20987904
    buffer_load_dwordx4 v[240:243], v15, s[36:39], s47 offen offset:0 sc1
    s_branch qa_kernel_F1_A14_G
qa_kernel_F1_A15_R:
    s_mov_b32 s47, 20983808
    buffer_load_dwordx4 v[232:235], v15, s[36:39], s47 offen offset:3072 sc1
    s_mov_b32 s47, 20983808
    buffer_load_dwordx4 v[236:239], v16, s[36:39], s47 offen offset:3072 sc1
    s_mov_b32 s47, 20987904
    buffer_load_dwordx4 v[240:243], v15, s[36:39], s47 offen offset:0 sc1
    s_waitcnt vmcnt(0)
    v_max3_u32 v12, v232, v233, v234
    v_max3_u32 v13, v235, v236, v237
    v_max3_u32 v12, v12, v238, v239
    v_max_u32 v12, v12, v13
    v_cmp_eq_u32 vcc, -1, v12
    s_sub_u32 s62, s62, 1
    s_cselect_b64 vcc, 0, vcc
    s_cselect_b32 s62, 0, s62
    s_cbranch_vccnz qa_kernel_F1_A15_R
    s_branch qa_kernel_F1_A15_G
qa_kernel_ST1_R:
    buffer_load_dwordx2 v[184:185], v25, s[36:39], s63 offen offset:0 sc1
    buffer_load_dwordx2 v[186:187], v25, s[36:39], s63 offen offset:128 sc1
    buffer_load_dwordx2 v[188:189], v25, s[36:39], s63 offen offset:256 sc1
    buffer_load_dwordx2 v[190:191], v25, s[36:39], s63 offen offset:384 sc1
    buffer_load_dwordx2 v[192:193], v25, s[36:39], s63 offen offset:2048 sc1
    buffer_load_dwordx2 v[194:195], v25, s[36:39], s63 offen offset:2176 sc1
    buffer_load_dwordx2 v[196:197], v25, s[36:39], s63 offen offset:2304 sc1
    buffer_load_dwordx2 v[198:199], v25, s[36:39], s63 offen offset:2432 sc1
    s_waitcnt vmcnt(0)
    v_max3_u32 v12, v184, v185, v186
    v_max3_u32 v13, v187, v188, v189
    v_max3_u32 v12, v12, v190, v191
    v_max3_u32 v13, v13, v192, v193
    v_max3_u32 v12, v12, v194, v195
    v_max3_u32 v13, v13, v196, v197
    v_max3_u32 v12, v12, v198, v199
    v_max_u32 v12, v12, v13
    v_cmp_eq_u32 vcc, -1, v12
    s_sub_u32 s62, s62, 1
    s_cselect_b64 vcc, 0, vcc
    s_cselect_b32 s62, 0, s62
    s_cbranch_vccnz qa_kernel_ST1_R
    s_branch qa_kernel_ST1_G
qa_kernel_F1_A16_R:
    s_mov_b32 s47, 20987904
    buffer_load_dwordx4 v[240:243], v15, s[36:39], s47 offen offset:0 sc1
    s_mov_b32 s47, 20987904
    buffer_load_dwordx4 v[244:247], v16, s[36:39], s47 offen offset:0 sc1
    s_mov_b32 s47, 20987904
    buffer_load_dwordx4 v[248:251], v15, s[36:39], s47 offen offset:1024 sc1
    s_mov_b32 s47, 20987904
    buffer_load_dwordx4 v[252:255], v16, s[36:39], s47 offen offset:1024 sc1
    s_waitcnt vmcnt(0)
    v_max3_u32 v12, v240, v241, v242
    v_max3_u32 v13, v243, v244, v245
    v_max3_u32 v12, v12, v246, v247
    v_max_u32 v12, v12, v13
    v_cmp_eq_u32 vcc, -1, v12
    s_sub_u32 s62, s62, 1
    s_cselect_b64 vcc, 0, vcc
    s_cselect_b32 s62, 0, s62
    s_cbranch_vccnz qa_kernel_F1_A16_R
    s_mov_b32 s47, 20987904
    buffer_load_dwordx4 v[208:211], v15, s[36:39], s47 offen offset:2048 sc1
    s_mov_b32 s47, 20987904
    buffer_load_dwordx4 v[212:215], v16, s[36:39], s47 offen offset:2048 sc1
    s_branch qa_kernel_F1_A16_G
qa_kernel_F1_A17_R:
    s_mov_b32 s47, 20987904
    buffer_load_dwordx4 v[248:251], v15, s[36:39], s47 offen offset:1024 sc1
    s_mov_b32 s47, 20987904
    buffer_load_dwordx4 v[252:255], v16, s[36:39], s47 offen offset:1024 sc1
    s_mov_b32 s47, 20987904
    buffer_load_dwordx4 v[208:211], v15, s[36:39], s47 offen offset:2048 sc1
    s_mov_b32 s47, 20987904
    buffer_load_dwordx4 v[212:215], v16, s[36:39], s47 offen offset:2048 sc1
    s_waitcnt vmcnt(0)
    v_max3_u32 v12, v248, v249, v250
    v_max3_u32 v13, v251, v252, v253
    v_max3_u32 v12, v12, v254, v255
    v_max_u32 v12, v12, v13
    v_cmp_eq_u32 vcc, -1, v12
    s_sub_u32 s62, s62, 1
    s_cselect_b64 vcc, 0, vcc
    s_cselect_b32 s62, 0, s62
    s_cbranch_vccnz qa_kernel_F1_A17_R
    s_branch qa_kernel_F1_A17_G
qa_kernel_F1_A18_R:
    s_mov_b32 s47, 20987904
    buffer_load_dwordx4 v[208:211], v15, s[36:39], s47 offen offset:2048 sc1
    s_mov_b32 s47, 20987904
    buffer_load_dwordx4 v[212:215], v16, s[36:39], s47 offen offset:2048 sc1
    s_mov_b32 s47, 20987904
    buffer_load_dwordx4 v[216:219], v15, s[36:39], s47 offen offset:3072 sc1
    s_mov_b32 s47, 20987904
    buffer_load_dwordx4 v[220:223], v16, s[36:39], s47 offen offset:3072 sc1
    s_waitcnt vmcnt(0)
    v_max3_u32 v12, v208, v209, v210
    v_max3_u32 v13, v211, v212, v213
    v_max3_u32 v12, v12, v214, v215
    v_max_u32 v12, v12, v13
    v_cmp_eq_u32 vcc, -1, v12
    s_sub_u32 s62, s62, 1
    s_cselect_b64 vcc, 0, vcc
    s_cselect_b32 s62, 0, s62
    s_cbranch_vccnz qa_kernel_F1_A18_R
    s_mov_b32 s47, 20992000
    buffer_load_dwordx4 v[224:227], v15, s[36:39], s47 offen offset:0 sc1
    s_mov_b32 s47, 20992000
    buffer_load_dwordx4 v[228:231], v16, s[36:39], s47 offen offset:0 sc1
    s_mov_b32 s47, 20992000
    buffer_load_dwordx4 v[232:235], v15, s[36:39], s47 offen offset:1024 sc1
    s_branch qa_kernel_F1_A18_G
qa_kernel_F1_A19_R:
    s_mov_b32 s47, 20987904
    buffer_load_dwordx4 v[216:219], v15, s[36:39], s47 offen offset:3072 sc1
    s_mov_b32 s47, 20987904
    buffer_load_dwordx4 v[220:223], v16, s[36:39], s47 offen offset:3072 sc1
    s_mov_b32 s47, 20992000
    buffer_load_dwordx4 v[224:227], v15, s[36:39], s47 offen offset:0 sc1
    s_mov_b32 s47, 20992000
    buffer_load_dwordx4 v[228:231], v16, s[36:39], s47 offen offset:0 sc1
    s_waitcnt vmcnt(0)
    v_max3_u32 v12, v216, v217, v218
    v_max3_u32 v13, v219, v220, v221
    v_max3_u32 v12, v12, v222, v223
    v_max_u32 v12, v12, v13
    v_cmp_eq_u32 vcc, -1, v12
    s_sub_u32 s62, s62, 1
    s_cselect_b64 vcc, 0, vcc
    s_cselect_b32 s62, 0, s62
    s_cbranch_vccnz qa_kernel_F1_A19_R
    s_mov_b32 s47, 20992000
    buffer_load_dwordx4 v[232:235], v15, s[36:39], s47 offen offset:1024 sc1
    s_branch qa_kernel_F1_A19_G
qa_kernel_F1_A20_R:
    s_mov_b32 s47, 20992000
    buffer_load_dwordx4 v[224:227], v15, s[36:39], s47 offen offset:0 sc1
    s_mov_b32 s47, 20992000
    buffer_load_dwordx4 v[228:231], v16, s[36:39], s47 offen offset:0 sc1
    s_mov_b32 s47, 20992000
    buffer_load_dwordx4 v[232:235], v15, s[36:39], s47 offen offset:1024 sc1
    s_mov_b32 s47, 20992000
    buffer_load_dwordx4 v[236:239], v16, s[36:39], s47 offen offset:1024 sc1
    s_waitcnt vmcnt(0)
    v_max3_u32 v12, v224, v225, v226
    v_max3_u32 v13, v227, v228, v229
    v_max3_u32 v12, v12, v230, v231
    v_max_u32 v12, v12, v13
    v_cmp_eq_u32 vcc, -1, v12
    s_sub_u32 s62, s62, 1
    s_cselect_b64 vcc, 0, vcc
    s_cselect_b32 s62, 0, s62
    s_cbranch_vccnz qa_kernel_F1_A20_R
    s_mov_b32 s47, 20992000
    buffer_load_dwordx4 v[240:243], v15, s[36:39], s47 offen offset:2048 sc1
    s_mov_b32 s47, 20992000
    buffer_load_dwordx4 v[244:247], v16, s[36:39], s47 offen offset:2048 sc1
    s_mov_b32 s47, 20992000
    buffer_load_dwordx4 v[248:251], v15, s[36:39], s47 offen offset:3072 sc1
    s_mov_b32 s47, 20992000
    buffer_load_dwordx4 v[252:255], v16, s[36:39], s47 offen offset:3072 sc1
    s_branch qa_kernel_F1_A20_G
qa_kernel_F1_A21_R:
    s_mov_b32 s47, 20992000
    buffer_load_dwordx4 v[232:235], v15, s[36:39], s47 offen offset:1024 sc1
    s_mov_b32 s47, 20992000
    buffer_load_dwordx4 v[236:239], v16, s[36:39], s47 offen offset:1024 sc1
    s_mov_b32 s47, 20992000
    buffer_load_dwordx4 v[240:243], v15, s[36:39], s47 offen offset:2048 sc1
    s_mov_b32 s47, 20992000
    buffer_load_dwordx4 v[244:247], v16, s[36:39], s47 offen offset:2048 sc1
    s_waitcnt vmcnt(0)
    v_max3_u32 v12, v232, v233, v234
    v_max3_u32 v13, v235, v236, v237
    v_max3_u32 v12, v12, v238, v239
    v_max_u32 v12, v12, v13
    v_cmp_eq_u32 vcc, -1, v12
    s_sub_u32 s62, s62, 1
    s_cselect_b64 vcc, 0, vcc
    s_cselect_b32 s62, 0, s62
    s_cbranch_vccnz qa_kernel_F1_A21_R
    s_mov_b32 s47, 20992000
    buffer_load_dwordx4 v[248:251], v15, s[36:39], s47 offen offset:3072 sc1
    s_mov_b32 s47, 20992000
    buffer_load_dwordx4 v[252:255], v16, s[36:39], s47 offen offset:3072 sc1
    s_branch qa_kernel_F1_A21_G
qa_kernel_F1_A22_R:
    s_mov_b32 s47, 20992000
    buffer_load_dwordx4 v[240:243], v15, s[36:39], s47 offen offset:2048 sc1
    s_mov_b32 s47, 20992000
    buffer_load_dwordx4 v[244:247], v16, s[36:39], s47 offen offset:2048 sc1
    s_mov_b32 s47, 20992000
    buffer_load_dwordx4 v[248:251], v15, s[36:39], s47 offen offset:3072 sc1
    s_mov_b32 s47, 20992000
    buffer_load_dwordx4 v[252:255], v16, s[36:39], s47 offen offset:3072 sc1
    s_waitcnt vmcnt(0)
    v_max3_u32 v12, v240, v241, v242
    v_max3_u32 v13, v243, v244, v245
    v_max3_u32 v12, v12, v246, v247
    v_max_u32 v12, v12, v13
    v_cmp_eq_u32 vcc, -1, v12
    s_sub_u32 s62, s62, 1
    s_cselect_b64 vcc, 0, vcc
    s_cselect_b32 s62, 0, s62
    s_cbranch_vccnz qa_kernel_F1_A22_R
    s_mov_b32 s47, 20996096
    buffer_load_dwordx4 v[208:211], v15, s[36:39], s47 offen offset:0 sc1
    s_mov_b32 s47, 20996096
    buffer_load_dwordx4 v[212:215], v16, s[36:39], s47 offen offset:0 sc1
    s_mov_b32 s47, 20996096
    buffer_load_dwordx4 v[216:219], v15, s[36:39], s47 offen offset:1024 sc1
    s_mov_b32 s47, 20996096
    buffer_load_dwordx4 v[220:223], v16, s[36:39], s47 offen offset:1024 sc1
    buffer_load_dword v14, v2, s[36:39], 0 offen
    s_branch qa_kernel_F1_A22_G
qa_kernel_F1_A23_R:
    s_mov_b32 s47, 20992000
    buffer_load_dwordx4 v[248:251], v15, s[36:39], s47 offen offset:3072 sc1
    s_mov_b32 s47, 20992000
    buffer_load_dwordx4 v[252:255], v16, s[36:39], s47 offen offset:3072 sc1
    s_mov_b32 s47, 20996096
    buffer_load_dwordx4 v[208:211], v15, s[36:39], s47 offen offset:0 sc1
    s_mov_b32 s47, 20996096
    buffer_load_dwordx4 v[212:215], v16, s[36:39], s47 offen offset:0 sc1
    s_waitcnt vmcnt(0)
    v_max3_u32 v12, v248, v249, v250
    v_max3_u32 v13, v251, v252, v253
    v_max3_u32 v12, v12, v254, v255
    v_max_u32 v12, v12, v13
    v_cmp_eq_u32 vcc, -1, v12
    s_sub_u32 s62, s62, 1
    s_cselect_b64 vcc, 0, vcc
    s_cselect_b32 s62, 0, s62
    s_cbranch_vccnz qa_kernel_F1_A23_R
    s_mov_b32 s47, 20996096
    buffer_load_dwordx4 v[216:219], v15, s[36:39], s47 offen offset:1024 sc1
    s_mov_b32 s47, 20996096
    buffer_load_dwordx4 v[220:223], v16, s[36:39], s47 offen offset:1024 sc1
    buffer_load_dword v14, v2, s[36:39], 0 offen
    s_branch qa_kernel_F1_A23_G
qa_kernel_F1_A24_R:
    s_mov_b32 s47, 20996096
    buffer_load_dwordx4 v[208:211], v15, s[36:39], s47 offen offset:0 sc1
    s_mov_b32 s47, 20996096
    buffer_load_dwordx4 v[212:215], v16, s[36:39], s47 offen offset:0 sc1
    s_mov_b32 s47, 20996096
    buffer_load_dwordx4 v[216:219], v15, s[36:39], s47 offen offset:1024 sc1
    s_mov_b32 s47, 20996096
    buffer_load_dwordx4 v[220:223], v16, s[36:39], s47 offen offset:1024 sc1
    s_waitcnt vmcnt(0)
    v_max3_u32 v12, v208, v209, v210
    v_max3_u32 v13, v211, v212, v213
    v_max3_u32 v12, v12, v214, v215
    v_max_u32 v12, v12, v13
    v_cmp_eq_u32 vcc, -1, v12
    s_sub_u32 s62, s62, 1
    s_cselect_b64 vcc, 0, vcc
    s_cselect_b32 s62, 0, s62
    s_cbranch_vccnz qa_kernel_F1_A24_R
    s_mov_b32 s47, 20996096
    buffer_load_dwordx4 v[224:227], v15, s[36:39], s47 offen offset:2048 sc1
    s_mov_b32 s47, 20996096
    buffer_load_dwordx4 v[228:231], v16, s[36:39], s47 offen offset:2048 sc1
    s_branch qa_kernel_F1_A24_G
qa_kernel_F1_A25_R:
    s_mov_b32 s47, 20996096
    buffer_load_dwordx4 v[216:219], v15, s[36:39], s47 offen offset:1024 sc1
    s_mov_b32 s47, 20996096
    buffer_load_dwordx4 v[220:223], v16, s[36:39], s47 offen offset:1024 sc1
    s_mov_b32 s47, 20996096
    buffer_load_dwordx4 v[224:227], v15, s[36:39], s47 offen offset:2048 sc1
    s_mov_b32 s47, 20996096
    buffer_load_dwordx4 v[228:231], v16, s[36:39], s47 offen offset:2048 sc1
    s_waitcnt vmcnt(0)
    v_max3_u32 v12, v216, v217, v218
    v_max3_u32 v13, v219, v220, v221
    v_max3_u32 v12, v12, v222, v223
    v_max_u32 v12, v12, v13
    v_cmp_eq_u32 vcc, -1, v12
    s_sub_u32 s62, s62, 1
    s_cselect_b64 vcc, 0, vcc
    s_cselect_b32 s62, 0, s62
    s_cbranch_vccnz qa_kernel_F1_A25_R
    s_branch qa_kernel_F1_A25_G
qa_kernel_F1_A26_R:
    s_mov_b32 s47, 20996096
    buffer_load_dwordx4 v[224:227], v15, s[36:39], s47 offen offset:2048 sc1
    s_mov_b32 s47, 20996096
    buffer_load_dwordx4 v[228:231], v16, s[36:39], s47 offen offset:2048 sc1
    s_mov_b32 s47, 20996096
    buffer_load_dwordx4 v[232:235], v15, s[36:39], s47 offen offset:3072 sc1
    s_mov_b32 s47, 20996096
    buffer_load_dwordx4 v[236:239], v16, s[36:39], s47 offen offset:3072 sc1
    s_waitcnt vmcnt(0)
    v_max3_u32 v12, v224, v225, v226
    v_max3_u32 v13, v227, v228, v229
    v_max3_u32 v12, v12, v230, v231
    v_max_u32 v12, v12, v13
    v_cmp_eq_u32 vcc, -1, v12
    s_sub_u32 s62, s62, 1
    s_cselect_b64 vcc, 0, vcc
    s_cselect_b32 s62, 0, s62
    s_cbranch_vccnz qa_kernel_F1_A26_R
    s_mov_b32 s47, 21000192
    buffer_load_dwordx4 v[240:243], v15, s[36:39], s47 offen offset:0 sc1
    s_mov_b32 s47, 21000192
    buffer_load_dwordx4 v[244:247], v16, s[36:39], s47 offen offset:0 sc1
    s_mov_b32 s47, 21000192
    buffer_load_dwordx4 v[248:251], v15, s[36:39], s47 offen offset:1024 sc1
    s_mov_b32 s47, 21000192
    buffer_load_dwordx4 v[252:255], v16, s[36:39], s47 offen offset:1024 sc1
    s_branch qa_kernel_F1_A26_G
qa_kernel_F1_A27_R:
    s_mov_b32 s47, 20996096
    buffer_load_dwordx4 v[232:235], v15, s[36:39], s47 offen offset:3072 sc1
    s_mov_b32 s47, 20996096
    buffer_load_dwordx4 v[236:239], v16, s[36:39], s47 offen offset:3072 sc1
    s_mov_b32 s47, 21000192
    buffer_load_dwordx4 v[240:243], v15, s[36:39], s47 offen offset:0 sc1
    s_mov_b32 s47, 21000192
    buffer_load_dwordx4 v[244:247], v16, s[36:39], s47 offen offset:0 sc1
    s_waitcnt vmcnt(0)
    v_max3_u32 v12, v232, v233, v234
    v_max3_u32 v13, v235, v236, v237
    v_max3_u32 v12, v12, v238, v239
    v_max_u32 v12, v12, v13
    v_cmp_eq_u32 vcc, -1, v12
    s_sub_u32 s62, s62, 1
    s_cselect_b64 vcc, 0, vcc
    s_cselect_b32 s62, 0, s62
    s_cbranch_vccnz qa_kernel_F1_A27_R
    s_mov_b32 s47, 21000192
    buffer_load_dwordx4 v[248:251], v15, s[36:39], s47 offen offset:1024 sc1
    s_mov_b32 s47, 21000192
    buffer_load_dwordx4 v[252:255], v16, s[36:39], s47 offen offset:1024 sc1
    s_branch qa_kernel_F1_A27_G
qa_kernel_F1_A28_R:
    s_mov_b32 s47, 21000192
    buffer_load_dwordx4 v[240:243], v15, s[36:39], s47 offen offset:0 sc1
    s_mov_b32 s47, 21000192
    buffer_load_dwordx4 v[244:247], v16, s[36:39], s47 offen offset:0 sc1
    s_mov_b32 s47, 21000192
    buffer_load_dwordx4 v[248:251], v15, s[36:39], s47 offen offset:1024 sc1
    s_mov_b32 s47, 21000192
    buffer_load_dwordx4 v[252:255], v16, s[36:39], s47 offen offset:1024 sc1
    s_waitcnt vmcnt(0)
    v_max3_u32 v12, v240, v241, v242
    v_max3_u32 v13, v243, v244, v245
    v_max3_u32 v12, v12, v246, v247
    v_max_u32 v12, v12, v13
    v_cmp_eq_u32 vcc, -1, v12
    s_sub_u32 s62, s62, 1
    s_cselect_b64 vcc, 0, vcc
    s_cselect_b32 s62, 0, s62
    s_cbranch_vccnz qa_kernel_F1_A28_R
    s_mov_b32 s47, 21000192
    buffer_load_dwordx4 v[208:211], v15, s[36:39], s47 offen offset:2048 sc1
    s_mov_b32 s47, 21000192
    buffer_load_dwordx4 v[212:215], v16, s[36:39], s47 offen offset:2048 sc1
    s_mov_b32 s47, 21000192
    buffer_load_dwordx4 v[216:219], v15, s[36:39], s47 offen offset:3072 sc1
    s_branch qa_kernel_F1_A28_G
qa_kernel_F1_A29_R:
    s_mov_b32 s47, 21000192
    buffer_load_dwordx4 v[248:251], v15, s[36:39], s47 offen offset:1024 sc1
    s_mov_b32 s47, 21000192
    buffer_load_dwordx4 v[252:255], v16, s[36:39], s47 offen offset:1024 sc1
    s_mov_b32 s47, 21000192
    buffer_load_dwordx4 v[208:211], v15, s[36:39], s47 offen offset:2048 sc1
    s_mov_b32 s47, 21000192
    buffer_load_dwordx4 v[212:215], v16, s[36:39], s47 offen offset:2048 sc1
    s_waitcnt vmcnt(0)
    v_max3_u32 v12, v248, v249, v250
    v_max3_u32 v13, v251, v252, v253
    v_max3_u32 v12, v12, v254, v255
    v_max_u32 v12, v12, v13
    v_cmp_eq_u32 vcc, -1, v12
    s_sub_u32 s62, s62, 1
    s_cselect_b64 vcc, 0, vcc
    s_cselect_b32 s62, 0, s62
    s_cbranch_vccnz qa_kernel_F1_A29_R
    s_mov_b32 s47, 21000192
    buffer_load_dwordx4 v[216:219], v15, s[36:39], s47 offen offset:3072 sc1
    s_mov_b32 s47, 21000192
    buffer_load_dwordx4 v[220:223], v16, s[36:39], s47 offen offset:3072 sc1
    s_branch qa_kernel_F1_A29_G
qa_kernel_F1_A30_R:
    s_mov_b32 s47, 21000192
    buffer_load_dwordx4 v[208:211], v15, s[36:39], s47 offen offset:2048 sc1
    s_mov_b32 s47, 21000192
    buffer_load_dwordx4 v[212:215], v16, s[36:39], s47 offen offset:2048 sc1
    s_mov_b32 s47, 21000192
    buffer_load_dwordx4 v[216:219], v15, s[36:39], s47 offen offset:3072 sc1
    s_mov_b32 s47, 21000192
    buffer_load_dwordx4 v[220:223], v16, s[36:39], s47 offen offset:3072 sc1
    s_waitcnt vmcnt(0)
    v_max3_u32 v12, v208, v209, v210
    v_max3_u32 v13, v211, v212, v213
    v_max3_u32 v12, v12, v214, v215
    v_max_u32 v12, v12, v13
    v_cmp_eq_u32 vcc, -1, v12
    s_sub_u32 s62, s62, 1
    s_cselect_b64 vcc, 0, vcc
    s_cselect_b32 s62, 0, s62
    s_cbranch_vccnz qa_kernel_F1_A30_R
    s_branch qa_kernel_F1_A30_G
qa_kernel_F1_A31_R:
    s_mov_b32 s47, 21000192
    buffer_load_dwordx4 v[216:219], v15, s[36:39], s47 offen offset:3072 sc1
    s_mov_b32 s47, 21000192
    buffer_load_dwordx4 v[220:223], v16, s[36:39], s47 offen offset:3072 sc1
    s_waitcnt vmcnt(0)
    v_max3_u32 v12, v216, v217, v218
    v_max3_u32 v13, v219, v220, v221
    v_max3_u32 v12, v12, v222, v223
    v_max_u32 v12, v12, v13
    v_cmp_eq_u32 vcc, -1, v12
    s_sub_u32 s62, s62, 1
    s_cselect_b64 vcc, 0, vcc
    s_cselect_b32 s62, 0, s62
    s_cbranch_vccnz qa_kernel_F1_A31_R
    s_branch qa_kernel_F1_A31_G
qa_kernel_B1_R:
    s_mov_b32 s47, 29364224
    buffer_load_dwordx4 v[80:83], v39, s[36:39], s47 offen sc1
    buffer_load_dwordx4 v[84:87], v40, s[36:39], s47 offen sc1
    s_mov_b32 s47, 29367296
    buffer_load_dwordx4 v[88:91], v39, s[36:39], s47 offen sc1
    buffer_load_dwordx4 v[92:95], v40, s[36:39], s47 offen sc1
    s_mov_b32 s47, 29371392
    buffer_load_dwordx4 v[96:99], v39, s[36:39], s47 offen sc1
    buffer_load_dwordx4 v[100:103], v40, s[36:39], s47 offen sc1
    s_mov_b32 s47, 29374464
    buffer_load_dwordx4 v[104:107], v39, s[36:39], s47 offen sc1
    buffer_load_dwordx4 v[108:111], v40, s[36:39], s47 offen sc1
    s_mov_b32 s47, 29378560
    buffer_load_dwordx4 v[112:115], v39, s[36:39], s47 offen sc1
    buffer_load_dwordx4 v[116:119], v40, s[36:39], s47 offen sc1
    s_mov_b32 s47, 29381632
    buffer_load_dwordx4 v[120:123], v39, s[36:39], s47 offen sc1
    buffer_load_dwordx4 v[124:127], v40, s[36:39], s47 offen sc1
    s_mov_b32 s47, 29385728
    buffer_load_dwordx4 v[128:131], v39, s[36:39], s47 offen sc1
    buffer_load_dwordx4 v[132:135], v40, s[36:39], s47 offen sc1
    s_waitcnt vmcnt(0)
    v_max3_u32 v3, v80, v81, v82
    v_max3_u32 v4, v83, v84, v85
    v_max3_u32 v3, v3, v86, v87
    v_max_u32 v3, v3, v4
    v_cmp_eq_u32 vcc, -1, v3
    s_sub_u32 s62, s62, 1
    s_cselect_b64 vcc, 0, vcc
    s_cselect_b32 s62, 0, s62
    s_cbranch_vccnz qa_kernel_B1_R
    s_branch qa_kernel_B1_G
qa_kernel_B2_R:
    s_mov_b32 s47, 29367296
    buffer_load_dwordx4 v[88:91], v39, s[36:39], s47 offen sc1
    buffer_load_dwordx4 v[92:95], v40, s[36:39], s47 offen sc1
    s_mov_b32 s47, 29371392
    buffer_load_dwordx4 v[96:99], v39, s[36:39], s47 offen sc1
    buffer_load_dwordx4 v[100:103], v40, s[36:39], s47 offen sc1
    s_mov_b32 s47, 29374464
    buffer_load_dwordx4 v[104:107], v39, s[36:39], s47 offen sc1
    buffer_load_dwordx4 v[108:111], v40, s[36:39], s47 offen sc1
    s_mov_b32 s47, 29378560
    buffer_load_dwordx4 v[112:115], v39, s[36:39], s47 offen sc1
    buffer_load_dwordx4 v[116:119], v40, s[36:39], s47 offen sc1
    s_mov_b32 s47, 29381632
    buffer_load_dwordx4 v[120:123], v39, s[36:39], s47 offen sc1
    buffer_load_dwordx4 v[124:127], v40, s[36:39], s47 offen sc1
    s_mov_b32 s47, 29385728
    buffer_load_dwordx4 v[128:131], v39, s[36:39], s47 offen sc1
    buffer_load_dwordx4 v[132:135], v40, s[36:39], s47 offen sc1
    s_waitcnt vmcnt(0)
    v_max3_u32 v3, v88, v89, v90
    v_max3_u32 v4, v91, v92, v93
    v_max3_u32 v3, v3, v94, v95
    v_max_u32 v3, v3, v4
    v_cmp_eq_u32 vcc, -1, v3
    s_sub_u32 s62, s62, 1
    s_cselect_b64 vcc, 0, vcc
    s_cselect_b32 s62, 0, s62
    s_cbranch_vccnz qa_kernel_B2_R
    s_branch qa_kernel_B2_G
qa_kernel_B3_R:
    s_mov_b32 s47, 29371392
    buffer_load_dwordx4 v[96:99], v39, s[36:39], s47 offen sc1
    buffer_load_dwordx4 v[100:103], v40, s[36:39], s47 offen sc1
    s_mov_b32 s47, 29374464
    buffer_load_dwordx4 v[104:107], v39, s[36:39], s47 offen sc1
    buffer_load_dwordx4 v[108:111], v40, s[36:39], s47 offen sc1
    s_mov_b32 s47, 29378560
    buffer_load_dwordx4 v[112:115], v39, s[36:39], s47 offen sc1
    buffer_load_dwordx4 v[116:119], v40, s[36:39], s47 offen sc1
    s_mov_b32 s47, 29381632
    buffer_load_dwordx4 v[120:123], v39, s[36:39], s47 offen sc1
    buffer_load_dwordx4 v[124:127], v40, s[36:39], s47 offen sc1
    s_mov_b32 s47, 29385728
    buffer_load_dwordx4 v[128:131], v39, s[36:39], s47 offen sc1
    buffer_load_dwordx4 v[132:135], v40, s[36:39], s47 offen sc1
    s_waitcnt vmcnt(0)
    v_max3_u32 v3, v96, v97, v98
    v_max3_u32 v4, v99, v100, v101
    v_max3_u32 v3, v3, v102, v103
    v_max_u32 v3, v3, v4
    v_cmp_eq_u32 vcc, -1, v3
    s_sub_u32 s62, s62, 1
    s_cselect_b64 vcc, 0, vcc
    s_cselect_b32 s62, 0, s62
    s_cbranch_vccnz qa_kernel_B3_R
    s_branch qa_kernel_B3_G
qa_kernel_B4_R:
    s_mov_b32 s47, 29374464
    buffer_load_dwordx4 v[104:107], v39, s[36:39], s47 offen sc1
    buffer_load_dwordx4 v[108:111], v40, s[36:39], s47 offen sc1
    s_mov_b32 s47, 29378560
    buffer_load_dwordx4 v[112:115], v39, s[36:39], s47 offen sc1
    buffer_load_dwordx4 v[116:119], v40, s[36:39], s47 offen sc1
    s_mov_b32 s47, 29381632
    buffer_load_dwordx4 v[120:123], v39, s[36:39], s47 offen sc1
    buffer_load_dwordx4 v[124:127], v40, s[36:39], s47 offen sc1
    s_mov_b32 s47, 29385728
    buffer_load_dwordx4 v[128:131], v39, s[36:39], s47 offen sc1
    buffer_load_dwordx4 v[132:135], v40, s[36:39], s47 offen sc1
    s_waitcnt vmcnt(0)
    v_max3_u32 v3, v104, v105, v106
    v_max3_u32 v4, v107, v108, v109
    v_max3_u32 v3, v3, v110, v111
    v_max_u32 v3, v3, v4
    v_cmp_eq_u32 vcc, -1, v3
    s_sub_u32 s62, s62, 1
    s_cselect_b64 vcc, 0, vcc
    s_cselect_b32 s62, 0, s62
    s_cbranch_vccnz qa_kernel_B4_R
    s_branch qa_kernel_B4_G
qa_kernel_B5_R:
    s_mov_b32 s47, 29378560
    buffer_load_dwordx4 v[112:115], v39, s[36:39], s47 offen sc1
    buffer_load_dwordx4 v[116:119], v40, s[36:39], s47 offen sc1
    s_mov_b32 s47, 29381632
    buffer_load_dwordx4 v[120:123], v39, s[36:39], s47 offen sc1
    buffer_load_dwordx4 v[124:127], v40, s[36:39], s47 offen sc1
    s_mov_b32 s47, 29385728
    buffer_load_dwordx4 v[128:131], v39, s[36:39], s47 offen sc1
    buffer_load_dwordx4 v[132:135], v40, s[36:39], s47 offen sc1
    s_waitcnt vmcnt(0)
    v_max3_u32 v3, v112, v113, v114
    v_max3_u32 v4, v115, v116, v117
    v_max3_u32 v3, v3, v118, v119
    v_max_u32 v3, v3, v4
    v_cmp_eq_u32 vcc, -1, v3
    s_sub_u32 s62, s62, 1
    s_cselect_b64 vcc, 0, vcc
    s_cselect_b32 s62, 0, s62
    s_cbranch_vccnz qa_kernel_B5_R
    s_branch qa_kernel_B5_G
qa_kernel_B6_R:
    s_mov_b32 s47, 29381632
    buffer_load_dwordx4 v[120:123], v39, s[36:39], s47 offen sc1
    buffer_load_dwordx4 v[124:127], v40, s[36:39], s47 offen sc1
    s_mov_b32 s47, 29385728
    buffer_load_dwordx4 v[128:131], v39, s[36:39], s47 offen sc1
    buffer_load_dwordx4 v[132:135], v40, s[36:39], s47 offen sc1
    s_waitcnt vmcnt(0)
    v_max3_u32 v3, v120, v121, v122
    v_max3_u32 v4, v123, v124, v125
    v_max3_u32 v3, v3, v126, v127
    v_max_u32 v3, v3, v4
    v_cmp_eq_u32 vcc, -1, v3
    s_sub_u32 s62, s62, 1
    s_cselect_b64 vcc, 0, vcc
    s_cselect_b32 s62, 0, s62
    s_cbranch_vccnz qa_kernel_B6_R
    s_branch qa_kernel_B6_G
qa_kernel_B7_R:
    s_mov_b32 s47, 29385728
    buffer_load_dwordx4 v[128:131], v39, s[36:39], s47 offen sc1
    buffer_load_dwordx4 v[132:135], v40, s[36:39], s47 offen sc1
    s_waitcnt vmcnt(0)
    v_max3_u32 v3, v128, v129, v130
    v_max3_u32 v4, v131, v132, v133
    v_max3_u32 v3, v3, v134, v135
    v_max_u32 v3, v3, v4
    v_cmp_eq_u32 vcc, -1, v3
    s_sub_u32 s62, s62, 1
    s_cselect_b64 vcc, 0, vcc
    s_cselect_b32 s62, 0, s62
    s_cbranch_vccnz qa_kernel_B7_R
    s_branch qa_kernel_B7_G
qa_kernel_RS_R:
    buffer_load_dwordx4 v[224:227], v2, s[36:39], s55 offen offset:0 sc1
    buffer_load_dwordx4 v[228:231], v2, s[36:39], s55 offen offset:1024 sc1
    s_waitcnt vmcnt(0)
    v_max3_u32 v3, v224, v225, v226
    v_max3_u32 v4, v227, v228, v229
    v_max3_u32 v3, v3, v230, v231
    v_max_u32 v3, v3, v4
    v_cmp_eq_u32 vcc, -1, v3
    s_sub_u32 s62, s62, 1
    s_cselect_b64 vcc, 0, vcc
    s_cselect_b32 s62, 0, s62
    s_cbranch_vccnz qa_kernel_RS_R
    s_branch qa_kernel_RS_G
qa_kernel_END:
    s_endpgm
.section .rodata,"a"
.p2align 6
.amdhsa_kernel qa_kernel
  .amdhsa_next_free_vgpr 256
  .amdhsa_next_free_sgpr 102
  .amdhsa_accum_offset 256
  .amdhsa_group_segment_fixed_size 0
  .amdhsa_kernarg_size 80
  .amdhsa_user_sgpr_count 2
  .amdhsa_user_sgpr_kernarg_segment_ptr 1
  .amdhsa_system_sgpr_workgroup_id_x 1
.end_amdhsa_kernel
```
